```python
import torch

def _softmax(x, axis=-1):
    return torch.softmax(x, dim=axis)
def _gelu(x):
    return torch.nn.functional.gelu(x, approximate="tanh")
def _silu(x):
    return torch.nn.functional.silu(x)
def _sigmoid(x):
    return torch.sigmoid(x)
def _layernorm(x, axis=-1, eps=1e-5):
    m = x.mean(dim=axis, keepdim=True)
    v = x.var(dim=axis, keepdim=True, unbiased=False)
    return (x - m) / torch.sqrt(v + eps)
def _scatter_add(tgt, idx, src, axis=0):
    return tgt.clone().index_add_(axis, idx, src)
def _segment_sum(src, seg, n):
    out = torch.zeros((n,) + src.shape[1:], dtype=src.dtype)
    return out.index_add_(0, seg, src)
def _pad(x, pw):
    flat = tuple(v for pair in reversed(pw) for v in pair)
    return torch.nn.functional.pad(x, flat)

kernel_name = 'concat_heads__mha_block_cached__mha_block_cached__near_ridge'

def setup_inputs():

    _w = (lambda a: (lambda t: t.to(torch.bfloat16) if t.is_floating_point() else t)(torch.as_tensor(a)))
    def _A_setup():
        B, Sq, D = 8, 240, 512
        H, Sk, Dh = 32, 512, 128
        return {
            "x": _w((lambda *s: torch.randn(*s, dtype=torch.bfloat16) * 0.8)(B, Sq, D)),
            "k_cache": _w((lambda *s: torch.randn(*s, dtype=torch.bfloat16) * 0.8)(B, H, Sk, Dh)),
            "v_cache": _w((lambda *s: torch.randn(*s, dtype=torch.bfloat16) * 0.05)(B, H, Sk, Dh)),
            "wq": _w((lambda *s: torch.randn(*s, dtype=torch.bfloat16) * 0.8)(D, H * Dh) * (D ** -0.5)),
            "wo": _w((lambda *s: torch.randn(*s, dtype=torch.bfloat16) * 0.05)(H * Dh, D) * ((H * Dh) ** -0.5)),
        }
    _A_in = _A_setup()

    def _B_setup():
        B, Sq, D = 8, 240, 512
        H, Sk, Dh = 32, 512, 128
        return {
            "x": _w((lambda *s: torch.randn(*s, dtype=torch.bfloat16) * 0.8)(B, Sq, D)),
            "k_cache": _w((lambda *s: torch.randn(*s, dtype=torch.bfloat16) * 0.8)(B, H, Sk, Dh)),
            "v_cache": _w((lambda *s: torch.randn(*s, dtype=torch.bfloat16) * 0.05)(B, H, Sk, Dh)),
            "wq": _w((lambda *s: torch.randn(*s, dtype=torch.bfloat16) * 0.8)(D, H * Dh) * (D ** -0.5)),
            "wo": _w((lambda *s: torch.randn(*s, dtype=torch.bfloat16) * 0.05)(H * Dh, D) * ((H * Dh) ** -0.5)),
        }
    _B_in = _B_setup()

    return {
        "A_x": _A_in["x"],
        "A_k_cache": _A_in["k_cache"],
        "A_v_cache": _A_in["v_cache"],
        "A_wq": _A_in["wq"],
        "A_wo": _A_in["wo"],
        "B_x": _B_in["x"],
        "B_k_cache": _B_in["k_cache"],
        "B_v_cache": _B_in["v_cache"],
        "B_wq": _B_in["wq"],
        "B_wo": _B_in["wo"],
    }

def reference(A_x, A_k_cache, A_v_cache, A_wq, A_wo, B_x, B_k_cache, B_v_cache, B_wq, B_wo):
    def _A_ref(x, k_cache, v_cache, wq, wo):
        B, Sq, D = x.shape
        H, Dh = 32, 128
        q = (lambda x, *d: x.permute(*d))((x @ wq).reshape(B, Sq, H, Dh), 0, 2, 1, 3)
        scores = torch.einsum("bhqd,bhkd->bhqk", q, k_cache) * (Dh ** -0.5)
        p = _softmax(scores, axis=-1)
        o = torch.einsum("bhqk,bhkd->bhqd", p, v_cache)
        return (lambda x, *d: x.permute(*d))(o, 0, 2, 1, 3).reshape(B, Sq, H * Dh) @ wo

    def _B_ref(x, k_cache, v_cache, wq, wo):
        B, Sq, D = x.shape
        H, Dh = 32, 128
        q = (lambda x, *d: x.permute(*d))((x @ wq).reshape(B, Sq, H, Dh), 0, 2, 1, 3)
        scores = torch.einsum("bhqd,bhkd->bhqk", q, k_cache) * (Dh ** -0.5)
        p = _softmax(scores, axis=-1)
        o = torch.einsum("bhqk,bhkd->bhqd", p, v_cache)
        return (lambda x, *d: x.permute(*d))(o, 0, 2, 1, 3).reshape(B, Sq, H * Dh) @ wo

    a = _A_ref(A_x, A_k_cache, A_v_cache, A_wq, A_wo)
    b = _B_ref(B_x, B_k_cache, B_v_cache, B_wq, B_wo)
    return torch.concatenate([a, b], axis=-1)
```

```asm
; @launch grid=(256,1,1) block=(256,1,1) lds=163840
.amdgcn_target "amdgcn-amd-amdhsa--gfx950"
.text
.macro M d,x,y,z
v_mfma_f32_16x16x32_bf16 \d,\x,\y,\z
.endm
.globl concat_heads__mha_block_cached__mha_block_cached__near_ridge_kernel
.p2align 8
.type concat_heads__mha_block_cached__mha_block_cached__near_ridge_kernel,@function
concat_heads__mha_block_cached__mha_block_cached__near_ridge_kernel:
v_mov_b32 v192,v0
s_cmp_lt_u32 s2,256
s_cbranch_scc1 K1_GO
s_endpgm
K1_GO:
s_load_dwordx4 s[56:59],s[0:1],0
s_load_dwordx4 s[60:63],s[0:1],16
s_load_dwordx2 s[64:65],s[0:1],40
s_load_dwordx2 s[70:71],s[0:1],64
v_lshrrev_b32 v194,6,v192
v_and_b32 v193,63,v192
s_and_b32 s74,s2,7
s_lshr_b32 s75,s2,3
v_readfirstlane_b32 s28,v194
s_lshr_b32 s76,s74,2
s_and_b32 s77,s74,3
s_and_b32 s78,s77,1
s_lshl_b32 s78,s78,2
s_and_b32 s80,s75,3
s_add_u32 s78,s78,s80
s_lshr_b32 s79,s77,1
s_lshl_b32 s79,s79,3
s_lshr_b32 s80,s75,2
s_add_u32 s79,s79,s80
v_and_b32 v195,15,v193
v_lshrrev_b32 v196,4,v193
v_lshrrev_b32 v197,2,v193
v_and_b32 v197,3,v197
v_and_b32 v198,3,v193
v_lshrrev_b32 v203,2,v193
v_and_b32 v203,7,v203
v_lshrrev_b32 v201,2,v203
v_sub_u32 v201,0,v201
v_and_b32 v201,3,v201
v_xor_b32 v201,v201,v198
v_lshlrev_b32 v201,4,v201
v_lshlrev_b32 v202,10,v203
v_add_u32 v201,v201,v202
v_lshrrev_b32 v202,5,v193
v_lshlrev_b32 v202,6,v202
v_add_u32 v205,v201,v202
v_lshrrev_b32 v203,3,v193
v_and_b32 v204,7,v193
v_lshrrev_b32 v201,1,v203
v_and_b32 v201,1,v201
v_lshlrev_b32 v201,2,v201
v_xor_b32 v201,v201,v204
v_lshlrev_b32 v201,4,v201
v_lshlrev_b32 v202,13,v203
v_add_u32 v206,v201,v202
s_cmp_lt_u32 s28,2
s_cselect_b64 s[84:85],-1,0
s_cselect_b32 s54,32,16
s_mov_b32 s87,64512
s_cselect_b32 s55,7168,s87
s_cselect_b32 s29,0,1
s_lshl_b32 s87,s55,1
v_cndmask_b32 v16,v206,v205,s[84:85]
v_xor_b32 v201,s54,v16
v_add_u32 v17,s55,v201
v_add_u32 v18,s87,v16
v_add_u32 v19,s87,v17
s_mul_i32 s86,s28,14336
s_and_b32 s54,1,s28
s_lshl_b32 s55,s54,13
s_add_u32 s87,s86,106496
s_add_u32 s30,s55,49152
s_cmp_lt_u32 s28,2
s_cselect_b32 s30,s87,s30
s_add_u32 s87,s86,131072
s_add_u32 s31,s55,81920
s_cmp_lt_u32 s28,2
s_cselect_b32 s31,s87,s31
s_add_u32 s87,s86,139264
s_add_u32 s32,s55,49152
s_cmp_lt_u32 s28,2
s_cselect_b32 s32,s87,s32
s_add_u32 s87,s86,98304
s_add_u32 s33,s55,81920
s_cmp_lt_u32 s28,2
s_cselect_b32 s33,s87,s33
s_mul_i32 s86,s28,114688
s_add_u32 s87,s86,32768
s_lshl_b32 s54,s54,8
s_add_u32 s55,s54,128
s_cmp_lt_u32 s28,2
s_cselect_b32 s34,s86,s54
s_cselect_b32 s35,s87,s55
s_mov_b32 s86,262144
s_mov_b32 s87,65536
s_cselect_b32 s36,s87,s86
s_mov_b32 s87,0xffff0080
s_cselect_b32 s39,s87,s86
s_mul_i32 s80,s78,245760
s_lshl_b32 s81,s79,9
s_mov_b32 s6,245760
s_mov_b32 s7,0x20000
s_sub_u32 s10,4194304,s81
s_mov_b32 s11,0x20000
s_cmp_eq_u32 s76,0
s_waitcnt lgkmcnt(0)
s_cselect_b32 s4,s56,s64
s_cselect_b32 s5,s57,s65
s_cselect_b32 s8,s62,s70
s_cselect_b32 s9,s63,s71
s_add_u32 s8,s8,s81
s_addc_u32 s9,s9,0
s_add_u32 s4,s4,s80
s_addc_u32 s5,s5,0
s_cmp_lt_u32 s28,2
s_cselect_b32 s24,s4,s8
s_cselect_b32 s25,s5,s9
s_cselect_b32 s26,s6,s10
s_mov_b32 s27,0x20000
s_cmp_eq_u32 s29,0
s_cbranch_scc0 L_cg1
s_mov_b32 m0,s31
s_nop 0
buffer_load_dwordx4 v16,s[24:27],s34 offen nt lds
buffer_load_dwordx4 v17,s[24:27],s34 offen offset:1024 nt lds
buffer_load_dwordx4 v18,s[24:27],s34 offen offset:2048 nt lds
buffer_load_dwordx4 v19,s[24:27],s34 offen offset:3072 nt lds
s_add_u32 s34,s34,s36
s_add_u32 m0,s31,4096
s_nop 0
buffer_load_dwordx4 v16,s[24:27],s35 offen nt lds
buffer_load_dwordx4 v17,s[24:27],s35 offen offset:1024 nt lds
buffer_load_dwordx4 v18,s[24:27],s35 offen offset:2048 nt lds
buffer_load_dwordx4 v19,s[24:27],s35 offen offset:3072 nt lds
s_add_u32 s35,s35,s36
L_cg1:
s_mov_b32 m0,s32
s_nop 0
buffer_load_dwordx4 v16,s[24:27],s34 offen nt lds
buffer_load_dwordx4 v17,s[24:27],s34 offen offset:1024 nt lds
buffer_load_dwordx4 v18,s[24:27],s34 offen offset:2048 nt lds
buffer_load_dwordx4 v19,s[24:27],s34 offen offset:3072 nt lds
s_add_u32 s34,s34,s39
s_add_u32 m0,s32,4096
s_nop 0
buffer_load_dwordx4 v16,s[24:27],s35 offen nt lds
buffer_load_dwordx4 v17,s[24:27],s35 offen offset:1024 nt lds
buffer_load_dwordx4 v18,s[24:27],s35 offen offset:2048 nt lds
buffer_load_dwordx4 v19,s[24:27],s35 offen offset:3072 nt lds
s_add_u32 s35,s35,s39
s_load_dwordx2 s[66:67],s[0:1],48
s_load_dwordx2 s[68:69],s[0:1],56
s_load_dwordx2 s[72:73],s[0:1],96
s_load_dwordx2 s[82:83],s[0:1],32
s_load_dwordx2 s[100:101],s[0:1],72
s_load_dwordx2 s[94:95],s[0:1],80
s_load_dwordx2 s[92:93],s[0:1],88
s_cmp_eq_u32 s28,3
s_cbranch_scc1 K1_B
K1_A:
s_cmp_eq_u32 s76,0
s_waitcnt lgkmcnt(0)
s_cselect_b32 s12,s58,s66
s_cselect_b32 s13,s59,s67
s_cselect_b32 s16,s60,s68
s_cselect_b32 s17,s61,s69
s_cselect_b32 s37,s82,s100
s_cselect_b32 s53,s83,s101
s_lshl_b32 s80,s78,5
s_lshl_b32 s81,s79,1
s_add_u32 s80,s80,s81
s_lshl_b32 s80,s80,17
s_add_u32 s12,s12,s80
s_addc_u32 s13,s13,0
s_mov_b32 s14,262144
s_mov_b32 s15,0x20000
s_add_u32 s16,s16,s80
s_addc_u32 s17,s17,0
s_mov_b32 s18,262144
s_mov_b32 s19,0x20000
s_mul_i32 s80,s76,120
s_mul_i32 s81,s78,15
s_add_u32 s80,s80,s81
s_mul_i32 s80,s80,131072
s_lshl_b32 s81,s79,13
s_add_u32 s80,s80,s81
s_add_u32 s20,s72,s80
s_addc_u32 s21,s73,0
s_sub_u32 s86,1966080,s81
s_mov_b32 s22,s86
s_mov_b32 s23,0x20000
s_lshl_b32 s80,s77,5
s_add_u32 s80,s80,s75
s_lshl_b32 s89,s80,15
s_mov_b32 s52,0x3e0293ee
s_mov_b32 s84,0xffff0000
s_mov_b32 s85,0xffff0000
s_mov_b32 s43,0
v_sub_u32 v200,0,v197
v_and_b32 v200,3,v200
v_xor_b32 v200,v200,v196
v_lshlrev_b32 v200,4,v200
v_lshlrev_b32 v201,10,v197
v_lshlrev_b32 v202,6,v198
v_add_u32 v201,v201,v202
v_add_u32 v8,v201,v200
v_lshrrev_b32 v201,3,v195
v_lshlrev_b32 v201,10,v201
v_and_b32 v202,7,v195
v_lshlrev_b32 v202,6,v202
v_add_u32 v201,v201,v202
v_add_u32 v201,v201,v200
s_lshl_b32 s80,s28,13
s_add_u32 s80,s80,98304
v_add_u32 v11,s80,v201
v_lshlrev_b32 v201,10,v196
v_lshlrev_b32 v202,6,v197
v_add_u32 v201,v201,v202
v_and_b32 v202,1,v198
v_lshlrev_b32 v202,3,v202
v_add_u32 v201,v201,v202
v_and_b32 v199,1,v196
v_lshlrev_b32 v199,1,v199
v_lshrrev_b32 v202,1,v198
v_xor_b32 v202,v202,v199
v_lshlrev_b32 v202,4,v202
v_add_u32 v201,v201,v202
v_add_u32 v9,65536,v201
v_xor_b32 v10,32,v9
v_lshrrev_b32 v201,1,v197
v_lshlrev_b32 v201,2,v201
v_and_b32 v202,1,v196
v_add_u32 v201,v201,v202
v_xor_b32 v201,v201,v198
v_lshlrev_b32 v201,4,v201
v_lshlrev_b32 v202,10,v196
v_add_u32 v201,v201,v202
v_lshlrev_b32 v202,7,v197
v_add_u32 v201,v201,v202
v_add_u32 v12,49152,v201
v_xor_b32 v13,8,v12
v_xor_b32 v14,64,v12
v_xor_b32 v15,72,v12
v_lshlrev_b32 v201,8,v197
v_lshlrev_b32 v202,6,v196
v_add_u32 v201,v201,v202
v_xor_b32 v202,0,v198
v_lshlrev_b32 v202,4,v202
v_add_u32 v21,v201,v202
v_xor_b32 v202,3,v198
v_lshlrev_b32 v202,4,v202
v_add_u32 v22,v201,v202
v_xor_b32 v202,2,v198
v_lshlrev_b32 v202,4,v202
v_add_u32 v23,v201,v202
v_xor_b32 v202,1,v198
v_lshlrev_b32 v202,4,v202
v_add_u32 v24,v201,v202
v_xor_b32 v202,0,v198
v_lshlrev_b32 v202,4,v202
v_add_u32 v25,v201,v202
v_xor_b32 v202,2,v198
v_lshlrev_b32 v202,4,v202
v_add_u32 v26,v201,v202
s_mul_i32 s80,s28,524288
v_lshlrev_b32 v201,4,v193
v_add_u32 v20,s80,v201
s_lshl_b32 s80,s76,3
s_add_u32 s80,s80,s78
s_lshl_b32 s80,s80,7
s_lshl_b32 s81,s79,2
s_add_u32 s80,s80,s81
s_add_u32 s82,s80,8454144
s_lshr_b32 s54,s74,1
s_and_b32 s54,1,s54
s_and_b32 s55,1,s74
s_mul_i32 s55,s55,30
s_add_u32 s55,s55,s75
s_lshr_b32 s87,s55,2
s_and_b32 s55,3,s55
s_lshl_b32 s80,s76,3
s_lshr_b32 s81,s87,1
s_add_u32 s80,s80,s81
s_lshl_b32 s80,s80,7
s_and_b32 s81,1,s87
s_add_u32 s80,s80,s81
s_add_u32 s83,s80,8454144
s_mul_i32 s80,s76,120
s_lshl_b32 s81,s87,3
s_add_u32 s80,s80,s81
s_lshl_b32 s81,s28,1
s_add_u32 s80,s80,s81
s_mul_i32 s80,s80,131072
s_add_u32 s60,s72,s80
s_addc_u32 s61,s73,0
s_cmp_lt_u32 s2,240
s_cselect_b32 s62,262144,0
s_mov_b32 s63,0x20000
s_add_u32 s64,s72,33554432
s_addc_u32 s65,s73,0
s_mov_b32 s66,8458240
s_mov_b32 s67,0x20000
s_lshl_b32 s80,s55,8
s_add_u32 s56,s37,s80
s_addc_u32 s57,s53,0
s_sub_u32 s80,4194304,s80
s_cmp_lt_u32 s2,240
s_cselect_b32 s58,s80,0
s_mov_b32 s59,0x20000
s_lshl_b32 s80,s76,10
s_lshl_b32 s81,s55,8
s_add_u32 s80,s80,s81
s_lshl_b32 s81,s54,7
s_add_u32 s80,s80,s81
s_lshl_b32 s81,s87,18
s_add_u32 s80,s80,s81
s_add_u32 s68,s94,s80
s_addc_u32 s69,s95,0
s_sub_u32 s80,3932160,s80
s_cmp_lt_u32 s2,240
s_cselect_b32 s70,s80,0
s_mov_b32 s71,0x20000
s_mov_b32 s94,256
s_mov_b32 s95,0x20000
s_lshl_b32 s80,s54,16
s_lshl_b32 s81,s55,10
s_or_b32 s72,s80,s81
s_and_b32 s81,7,s87
s_lshl_b32 s80,s54,21
s_lshl_b32 s54,s81,12
s_or_b32 s73,s80,s54
s_lshl_b32 s81,s81,10
s_lshl_b32 s80,s28,13
s_or_b32 s74,s80,s81
s_and_b32 s81,0xc00,s81
s_lshl_b32 s55,s28,12
s_or_b32 s75,s55,s81
s_lshl_b32 s81,s2,15
s_add_u32 s76,s81,s80
s_xor_b32 s77,s76,65536
s_lshl_b32 s81,s2,8
s_add_u32 s78,s81,8388608
s_xor_b32 s79,s78,512
s_mov_b32 s3,0
s_mov_b32 s44,0
s_mov_b32 s45,131072
s_mov_b32 s46,262144
s_mov_b32 s47,393216
s_waitcnt vmcnt(0)
s_barrier
ds_read_b128 a[192:195],v11 offset:32768
ds_read_b128 a[196:199],v11 offset:34816
ds_read_b128 a[200:203],v11 offset:36864
ds_read_b128 a[204:207],v11 offset:38912
ds_read_b64_tr_b16 v[192:193],v12
ds_read_b64_tr_b16 v[194:195],v12 offset:512
ds_read_b64_tr_b16 v[196:197],v13
ds_read_b64_tr_b16 v[198:199],v13 offset:512
ds_read_b64_tr_b16 v[200:201],v14
ds_read_b64_tr_b16 v[202:203],v14 offset:512
ds_read_b64_tr_b16 v[204:205],v15
ds_read_b64_tr_b16 v[206:207],v15 offset:512
A_MAIN:
s_waitcnt lgkmcnt(4)
M v[64:67],v[192:195],a[192:195],0
ds_read_b64_tr_b16 v[208:209],v12 offset:4096
s_mov_b32 m0,s33
M v[96:99],v[192:195],a[196:199],0
ds_read_b64_tr_b16 v[210:211],v12 offset:4608
buffer_load_dwordx4 v16,s[24:27],s34 offen nt lds
M v[128:131],v[192:195],a[200:203],0
ds_read_b64_tr_b16 v[212:213],v13 offset:4096
buffer_load_dwordx4 v17,s[24:27],s34 offen offset:1024 nt lds
M v[160:163],v[192:195],a[204:207],0
ds_read_b64_tr_b16 v[214:215],v13 offset:4608
M v[68:71],v[196:199],a[192:195],0
buffer_load_dwordx4 v18,s[24:27],s34 offen offset:2048 nt lds
M v[100:103],v[196:199],a[196:199],0
M v[132:135],v[196:199],a[200:203],0
buffer_load_dwordx4 v19,s[24:27],s34 offen offset:3072 nt lds
s_add_u32 s34,s34,s36
M v[164:167],v[196:199],a[204:207],0
s_add_u32 m0,s33,4096
s_waitcnt lgkmcnt(4)
M v[72:75],v[200:203],a[192:195],0
ds_read_b64_tr_b16 v[192:193],v14 offset:4096
buffer_load_dwordx4 v16,s[24:27],s35 offen nt lds
M v[104:107],v[200:203],a[196:199],0
ds_read_b64_tr_b16 v[194:195],v14 offset:4608
M v[136:139],v[200:203],a[200:203],0
ds_read_b64_tr_b16 v[196:197],v15 offset:4096
buffer_load_dwordx4 v17,s[24:27],s35 offen offset:1024 nt lds
M v[168:171],v[200:203],a[204:207],0
ds_read_b64_tr_b16 v[198:199],v15 offset:4608
M v[76:79],v[204:207],a[192:195],0
buffer_load_dwordx4 v18,s[24:27],s35 offen offset:2048 nt lds
M v[108:111],v[204:207],a[196:199],0
M v[140:143],v[204:207],a[200:203],0
buffer_load_dwordx4 v19,s[24:27],s35 offen offset:3072 nt lds
s_add_u32 s35,s35,s36
M v[172:175],v[204:207],a[204:207],0
s_waitcnt lgkmcnt(0)
s_barrier
M v[80:83],v[208:211],a[192:195],0
ds_read_b64_tr_b16 v[200:201],v12 offset:8192
s_mov_b32 m0,s30
M v[112:115],v[208:211],a[196:199],0
ds_read_b64_tr_b16 v[202:203],v12 offset:8704
buffer_load_dwordx4 v16,s[24:27],s34 offen lds
M v[144:147],v[208:211],a[200:203],0
ds_read_b64_tr_b16 v[204:205],v13 offset:8192
M v[176:179],v[208:211],a[204:207],0
ds_read_b64_tr_b16 v[206:207],v13 offset:8704
buffer_load_dwordx4 v17,s[24:27],s34 offen offset:1024 lds
M v[84:87],v[212:215],a[192:195],0
M v[116:119],v[212:215],a[196:199],0
M v[148:151],v[212:215],a[200:203],0
buffer_load_dwordx4 v18,s[24:27],s34 offen offset:2048 lds
M v[180:183],v[212:215],a[204:207],0
M v[88:91],v[192:195],a[192:195],0
ds_read_b64_tr_b16 v[208:209],v14 offset:8192
M v[120:123],v[192:195],a[196:199],0
ds_read_b64_tr_b16 v[210:211],v14 offset:8704
buffer_load_dwordx4 v19,s[24:27],s34 offen offset:3072 lds
s_add_u32 s34,s34,s39
M v[152:155],v[192:195],a[200:203],0
ds_read_b64_tr_b16 v[212:213],v15 offset:8192
M v[184:187],v[192:195],a[204:207],0
ds_read_b64_tr_b16 v[214:215],v15 offset:8704
s_add_u32 m0,s30,4096
M v[92:95],v[196:199],a[192:195],0
buffer_load_dwordx4 v16,s[24:27],s35 offen lds
M v[124:127],v[196:199],a[196:199],0
M v[156:159],v[196:199],a[200:203],0
M v[188:191],v[196:199],a[204:207],0
buffer_load_dwordx4 v17,s[24:27],s35 offen offset:1024 lds
s_waitcnt lgkmcnt(4)
M a[0:3],v[200:203],a[192:195],0
ds_read_b64_tr_b16 v[192:193],v12 offset:12288
M a[32:35],v[200:203],a[196:199],0
ds_read_b64_tr_b16 v[194:195],v12 offset:12800
M a[64:67],v[200:203],a[200:203],0
ds_read_b64_tr_b16 v[196:197],v13 offset:12288
buffer_load_dwordx4 v18,s[24:27],s35 offen offset:2048 lds
M a[96:99],v[200:203],a[204:207],0
ds_read_b64_tr_b16 v[198:199],v13 offset:12800
M a[4:7],v[204:207],a[192:195],0
M a[36:39],v[204:207],a[196:199],0
buffer_load_dwordx4 v19,s[24:27],s35 offen offset:3072 lds
s_add_u32 s35,s35,s39
M a[68:71],v[204:207],a[200:203],0
M a[100:103],v[204:207],a[204:207],0
s_waitcnt lgkmcnt(4)
M a[8:11],v[208:211],a[192:195],0
ds_read_b64_tr_b16 v[200:201],v14 offset:12288
M a[40:43],v[208:211],a[196:199],0
ds_read_b64_tr_b16 v[202:203],v14 offset:12800
M a[72:75],v[208:211],a[200:203],0
ds_read_b64_tr_b16 v[204:205],v15 offset:12288
M a[104:107],v[208:211],a[204:207],0
ds_read_b64_tr_b16 v[206:207],v15 offset:12800
M a[12:15],v[212:215],a[192:195],0
M a[44:47],v[212:215],a[196:199],0
M a[76:79],v[212:215],a[200:203],0
M a[108:111],v[212:215],a[204:207],0
s_waitcnt vmcnt(8) lgkmcnt(0)
s_barrier
M a[16:19],v[192:195],a[192:195],0
ds_read_b64_tr_b16 v[208:209],v12 offset:32768
M a[48:51],v[192:195],a[196:199],0
ds_read_b64_tr_b16 v[210:211],v12 offset:33280
M a[80:83],v[192:195],a[200:203],0
ds_read_b64_tr_b16 v[212:213],v13 offset:32768
M a[112:115],v[192:195],a[204:207],0
ds_read_b64_tr_b16 v[214:215],v13 offset:33280
M a[20:23],v[196:199],a[192:195],0
ds_read_b128 a[208:211],v11 offset:33280
M a[52:55],v[196:199],a[196:199],0
ds_read_b128 a[212:215],v11 offset:35328
M a[84:87],v[196:199],a[200:203],0
ds_read_b128 a[216:219],v11 offset:37376
M a[116:119],v[196:199],a[204:207],0
ds_read_b128 a[220:223],v11 offset:39424
M a[24:27],v[200:203],a[192:195],0
ds_read_b64_tr_b16 v[192:193],v14 offset:32768
M a[56:59],v[200:203],a[196:199],0
ds_read_b64_tr_b16 v[194:195],v14 offset:33280
M a[88:91],v[200:203],a[200:203],0
ds_read_b64_tr_b16 v[196:197],v15 offset:32768
M a[120:123],v[200:203],a[204:207],0
ds_read_b64_tr_b16 v[198:199],v15 offset:33280
M a[28:31],v[204:207],a[192:195],0
M a[60:63],v[204:207],a[196:199],0
M a[92:95],v[204:207],a[200:203],0
M a[124:127],v[204:207],a[204:207],0
s_waitcnt lgkmcnt(4)
M v[64:67],v[208:211],a[208:211],v[64:67]
ds_read_b64_tr_b16 v[200:201],v12 offset:36864
M v[96:99],v[208:211],a[212:215],v[96:99]
ds_read_b64_tr_b16 v[202:203],v12 offset:37376
M v[128:131],v[208:211],a[216:219],v[128:131]
ds_read_b64_tr_b16 v[204:205],v13 offset:36864
M v[160:163],v[208:211],a[220:223],v[160:163]
ds_read_b64_tr_b16 v[206:207],v13 offset:37376
M v[68:71],v[212:215],a[208:211],v[68:71]
M v[100:103],v[212:215],a[212:215],v[100:103]
M v[132:135],v[212:215],a[216:219],v[132:135]
M v[164:167],v[212:215],a[220:223],v[164:167]
s_waitcnt lgkmcnt(4)
M v[72:75],v[192:195],a[208:211],v[72:75]
ds_read_b64_tr_b16 v[208:209],v14 offset:36864
M v[104:107],v[192:195],a[212:215],v[104:107]
ds_read_b64_tr_b16 v[210:211],v14 offset:37376
M v[136:139],v[192:195],a[216:219],v[136:139]
ds_read_b64_tr_b16 v[212:213],v15 offset:36864
M v[168:171],v[192:195],a[220:223],v[168:171]
ds_read_b64_tr_b16 v[214:215],v15 offset:37376
M v[76:79],v[196:199],a[208:211],v[76:79]
M v[108:111],v[196:199],a[212:215],v[108:111]
M v[140:143],v[196:199],a[216:219],v[140:143]
M v[172:175],v[196:199],a[220:223],v[172:175]
s_waitcnt lgkmcnt(0)
s_barrier
M v[80:83],v[200:203],a[208:211],v[80:83]
ds_read_b64_tr_b16 v[192:193],v12 offset:40960
s_mov_b32 m0,s31
M v[112:115],v[200:203],a[212:215],v[112:115]
ds_read_b64_tr_b16 v[194:195],v12 offset:41472
buffer_load_dwordx4 v16,s[24:27],s34 offen lds
M v[144:147],v[200:203],a[216:219],v[144:147]
ds_read_b64_tr_b16 v[196:197],v13 offset:40960
M v[176:179],v[200:203],a[220:223],v[176:179]
ds_read_b64_tr_b16 v[198:199],v13 offset:41472
buffer_load_dwordx4 v17,s[24:27],s34 offen offset:1024 lds
M v[84:87],v[204:207],a[208:211],v[84:87]
M v[116:119],v[204:207],a[212:215],v[116:119]
M v[148:151],v[204:207],a[216:219],v[148:151]
buffer_load_dwordx4 v18,s[24:27],s34 offen offset:2048 lds
M v[180:183],v[204:207],a[220:223],v[180:183]
M v[88:91],v[208:211],a[208:211],v[88:91]
ds_read_b64_tr_b16 v[200:201],v14 offset:40960
M v[120:123],v[208:211],a[212:215],v[120:123]
ds_read_b64_tr_b16 v[202:203],v14 offset:41472
buffer_load_dwordx4 v19,s[24:27],s34 offen offset:3072 lds
s_add_u32 s34,s34,s36
M v[152:155],v[208:211],a[216:219],v[152:155]
ds_read_b64_tr_b16 v[204:205],v15 offset:40960
M v[184:187],v[208:211],a[220:223],v[184:187]
ds_read_b64_tr_b16 v[206:207],v15 offset:41472
s_add_u32 m0,s31,4096
M v[92:95],v[212:215],a[208:211],v[92:95]
buffer_load_dwordx4 v16,s[24:27],s35 offen lds
M v[124:127],v[212:215],a[212:215],v[124:127]
M v[156:159],v[212:215],a[216:219],v[156:159]
M v[188:191],v[212:215],a[220:223],v[188:191]
buffer_load_dwordx4 v17,s[24:27],s35 offen offset:1024 lds
s_waitcnt lgkmcnt(4)
M a[0:3],v[192:195],a[208:211],a[0:3]
ds_read_b64_tr_b16 v[208:209],v12 offset:45056
M a[32:35],v[192:195],a[212:215],a[32:35]
ds_read_b64_tr_b16 v[210:211],v12 offset:45568
M a[64:67],v[192:195],a[216:219],a[64:67]
ds_read_b64_tr_b16 v[212:213],v13 offset:45056
buffer_load_dwordx4 v18,s[24:27],s35 offen offset:2048 lds
M a[96:99],v[192:195],a[220:223],a[96:99]
ds_read_b64_tr_b16 v[214:215],v13 offset:45568
M a[4:7],v[196:199],a[208:211],a[4:7]
M a[36:39],v[196:199],a[212:215],a[36:39]
buffer_load_dwordx4 v19,s[24:27],s35 offen offset:3072 lds
s_add_u32 s35,s35,s36
M a[68:71],v[196:199],a[216:219],a[68:71]
M a[100:103],v[196:199],a[220:223],a[100:103]
s_waitcnt lgkmcnt(4)
M a[8:11],v[200:203],a[208:211],a[8:11]
ds_read_b64_tr_b16 v[192:193],v14 offset:45056
M a[40:43],v[200:203],a[212:215],a[40:43]
ds_read_b64_tr_b16 v[194:195],v14 offset:45568
M a[72:75],v[200:203],a[216:219],a[72:75]
ds_read_b64_tr_b16 v[196:197],v15 offset:45056
M a[104:107],v[200:203],a[220:223],a[104:107]
ds_read_b64_tr_b16 v[198:199],v15 offset:45568
M a[12:15],v[204:207],a[208:211],a[12:15]
M a[44:47],v[204:207],a[212:215],a[44:47]
M a[76:79],v[204:207],a[216:219],a[76:79]
M a[108:111],v[204:207],a[220:223],a[108:111]
s_waitcnt vmcnt(8) lgkmcnt(0)
s_barrier
M a[16:19],v[208:211],a[208:211],a[16:19]
ds_read_b64_tr_b16 v[200:201],v12
M a[48:51],v[208:211],a[212:215],a[48:51]
ds_read_b64_tr_b16 v[202:203],v12 offset:512
M a[80:83],v[208:211],a[216:219],a[80:83]
ds_read_b64_tr_b16 v[204:205],v13
M a[112:115],v[208:211],a[220:223],a[112:115]
ds_read_b64_tr_b16 v[206:207],v13 offset:512
M a[20:23],v[212:215],a[208:211],a[20:23]
ds_read_b128 a[192:195],v11
M a[52:55],v[212:215],a[212:215],a[52:55]
ds_read_b128 a[196:199],v11 offset:2048
M a[84:87],v[212:215],a[216:219],a[84:87]
ds_read_b128 a[200:203],v11 offset:4096
M a[116:119],v[212:215],a[220:223],a[116:119]
ds_read_b128 a[204:207],v11 offset:6144
M a[24:27],v[192:195],a[208:211],a[24:27]
ds_read_b64_tr_b16 v[208:209],v14
M a[56:59],v[192:195],a[212:215],a[56:59]
ds_read_b64_tr_b16 v[210:211],v14 offset:512
M a[88:91],v[192:195],a[216:219],a[88:91]
ds_read_b64_tr_b16 v[212:213],v15
M a[120:123],v[192:195],a[220:223],a[120:123]
ds_read_b64_tr_b16 v[214:215],v15 offset:512
M a[28:31],v[196:199],a[208:211],a[28:31]
M a[60:63],v[196:199],a[212:215],a[60:63]
M a[92:95],v[196:199],a[216:219],a[92:95]
M a[124:127],v[196:199],a[220:223],a[124:127]
s_waitcnt lgkmcnt(4)
M v[64:67],v[200:203],a[192:195],v[64:67]
ds_read_b64_tr_b16 v[192:193],v12 offset:4096
M v[96:99],v[200:203],a[196:199],v[96:99]
ds_read_b64_tr_b16 v[194:195],v12 offset:4608
M v[128:131],v[200:203],a[200:203],v[128:131]
ds_read_b64_tr_b16 v[196:197],v13 offset:4096
M v[160:163],v[200:203],a[204:207],v[160:163]
ds_read_b64_tr_b16 v[198:199],v13 offset:4608
M v[68:71],v[204:207],a[192:195],v[68:71]
M v[100:103],v[204:207],a[196:199],v[100:103]
M v[132:135],v[204:207],a[200:203],v[132:135]
M v[164:167],v[204:207],a[204:207],v[164:167]
s_waitcnt lgkmcnt(4)
M v[72:75],v[208:211],a[192:195],v[72:75]
ds_read_b64_tr_b16 v[200:201],v14 offset:4096
M v[104:107],v[208:211],a[196:199],v[104:107]
ds_read_b64_tr_b16 v[202:203],v14 offset:4608
M v[136:139],v[208:211],a[200:203],v[136:139]
ds_read_b64_tr_b16 v[204:205],v15 offset:4096
M v[168:171],v[208:211],a[204:207],v[168:171]
ds_read_b64_tr_b16 v[206:207],v15 offset:4608
M v[76:79],v[212:215],a[192:195],v[76:79]
M v[108:111],v[212:215],a[196:199],v[108:111]
M v[140:143],v[212:215],a[200:203],v[140:143]
M v[172:175],v[212:215],a[204:207],v[172:175]
s_waitcnt lgkmcnt(0)
s_barrier
M v[80:83],v[192:195],a[192:195],v[80:83]
ds_read_b64_tr_b16 v[208:209],v12 offset:8192
s_mov_b32 m0,s32
M v[112:115],v[192:195],a[196:199],v[112:115]
ds_read_b64_tr_b16 v[210:211],v12 offset:8704
buffer_load_dwordx4 v16,s[24:27],s34 offen lds
M v[144:147],v[192:195],a[200:203],v[144:147]
ds_read_b64_tr_b16 v[212:213],v13 offset:8192
M v[176:179],v[192:195],a[204:207],v[176:179]
ds_read_b64_tr_b16 v[214:215],v13 offset:8704
buffer_load_dwordx4 v17,s[24:27],s34 offen offset:1024 lds
M v[84:87],v[196:199],a[192:195],v[84:87]
M v[116:119],v[196:199],a[196:199],v[116:119]
M v[148:151],v[196:199],a[200:203],v[148:151]
buffer_load_dwordx4 v18,s[24:27],s34 offen offset:2048 lds
M v[180:183],v[196:199],a[204:207],v[180:183]
M v[88:91],v[200:203],a[192:195],v[88:91]
ds_read_b64_tr_b16 v[192:193],v14 offset:8192
M v[120:123],v[200:203],a[196:199],v[120:123]
ds_read_b64_tr_b16 v[194:195],v14 offset:8704
buffer_load_dwordx4 v19,s[24:27],s34 offen offset:3072 lds
s_add_u32 s34,s34,s39
M v[152:155],v[200:203],a[200:203],v[152:155]
ds_read_b64_tr_b16 v[196:197],v15 offset:8192
M v[184:187],v[200:203],a[204:207],v[184:187]
ds_read_b64_tr_b16 v[198:199],v15 offset:8704
s_add_u32 m0,s32,4096
M v[92:95],v[204:207],a[192:195],v[92:95]
buffer_load_dwordx4 v16,s[24:27],s35 offen lds
M v[124:127],v[204:207],a[196:199],v[124:127]
M v[156:159],v[204:207],a[200:203],v[156:159]
M v[188:191],v[204:207],a[204:207],v[188:191]
buffer_load_dwordx4 v17,s[24:27],s35 offen offset:1024 lds
s_waitcnt lgkmcnt(4)
M a[0:3],v[208:211],a[192:195],a[0:3]
ds_read_b64_tr_b16 v[200:201],v12 offset:12288
M a[32:35],v[208:211],a[196:199],a[32:35]
ds_read_b64_tr_b16 v[202:203],v12 offset:12800
M a[64:67],v[208:211],a[200:203],a[64:67]
ds_read_b64_tr_b16 v[204:205],v13 offset:12288
buffer_load_dwordx4 v18,s[24:27],s35 offen offset:2048 lds
M a[96:99],v[208:211],a[204:207],a[96:99]
ds_read_b64_tr_b16 v[206:207],v13 offset:12800
M a[4:7],v[212:215],a[192:195],a[4:7]
M a[36:39],v[212:215],a[196:199],a[36:39]
buffer_load_dwordx4 v19,s[24:27],s35 offen offset:3072 lds
s_add_u32 s35,s35,s39
M a[68:71],v[212:215],a[200:203],a[68:71]
M a[100:103],v[212:215],a[204:207],a[100:103]
s_waitcnt lgkmcnt(4)
M a[8:11],v[192:195],a[192:195],a[8:11]
ds_read_b64_tr_b16 v[208:209],v14 offset:12288
M a[40:43],v[192:195],a[196:199],a[40:43]
ds_read_b64_tr_b16 v[210:211],v14 offset:12800
M a[72:75],v[192:195],a[200:203],a[72:75]
ds_read_b64_tr_b16 v[212:213],v15 offset:12288
M a[104:107],v[192:195],a[204:207],a[104:107]
ds_read_b64_tr_b16 v[214:215],v15 offset:12800
M a[12:15],v[196:199],a[192:195],a[12:15]
M a[44:47],v[196:199],a[196:199],a[44:47]
M a[76:79],v[196:199],a[200:203],a[76:79]
M a[108:111],v[196:199],a[204:207],a[108:111]
s_waitcnt vmcnt(8) lgkmcnt(0)
s_barrier
M a[16:19],v[200:203],a[192:195],a[16:19]
ds_read_b64_tr_b16 v[192:193],v12 offset:32768
M a[48:51],v[200:203],a[196:199],a[48:51]
ds_read_b64_tr_b16 v[194:195],v12 offset:33280
M a[80:83],v[200:203],a[200:203],a[80:83]
ds_read_b64_tr_b16 v[196:197],v13 offset:32768
M a[112:115],v[200:203],a[204:207],a[112:115]
ds_read_b64_tr_b16 v[198:199],v13 offset:33280
M a[20:23],v[204:207],a[192:195],a[20:23]
ds_read_b128 a[208:211],v11 offset:512
M a[52:55],v[204:207],a[196:199],a[52:55]
ds_read_b128 a[212:215],v11 offset:2560
M a[84:87],v[204:207],a[200:203],a[84:87]
ds_read_b128 a[216:219],v11 offset:4608
M a[116:119],v[204:207],a[204:207],a[116:119]
ds_read_b128 a[220:223],v11 offset:6656
M a[24:27],v[208:211],a[192:195],a[24:27]
ds_read_b64_tr_b16 v[200:201],v14 offset:32768
M a[56:59],v[208:211],a[196:199],a[56:59]
ds_read_b64_tr_b16 v[202:203],v14 offset:33280
M a[88:91],v[208:211],a[200:203],a[88:91]
ds_read_b64_tr_b16 v[204:205],v15 offset:32768
M a[120:123],v[208:211],a[204:207],a[120:123]
ds_read_b64_tr_b16 v[206:207],v15 offset:33280
M a[28:31],v[212:215],a[192:195],a[28:31]
M a[60:63],v[212:215],a[196:199],a[60:63]
M a[92:95],v[212:215],a[200:203],a[92:95]
M a[124:127],v[212:215],a[204:207],a[124:127]
s_waitcnt lgkmcnt(4)
M v[64:67],v[192:195],a[208:211],v[64:67]
ds_read_b64_tr_b16 v[208:209],v12 offset:36864
M v[96:99],v[192:195],a[212:215],v[96:99]
ds_read_b64_tr_b16 v[210:211],v12 offset:37376
M v[128:131],v[192:195],a[216:219],v[128:131]
ds_read_b64_tr_b16 v[212:213],v13 offset:36864
M v[160:163],v[192:195],a[220:223],v[160:163]
ds_read_b64_tr_b16 v[214:215],v13 offset:37376
M v[68:71],v[196:199],a[208:211],v[68:71]
M v[100:103],v[196:199],a[212:215],v[100:103]
M v[132:135],v[196:199],a[216:219],v[132:135]
M v[164:167],v[196:199],a[220:223],v[164:167]
s_waitcnt lgkmcnt(4)
M v[72:75],v[200:203],a[208:211],v[72:75]
ds_read_b64_tr_b16 v[192:193],v14 offset:36864
M v[104:107],v[200:203],a[212:215],v[104:107]
ds_read_b64_tr_b16 v[194:195],v14 offset:37376
M v[136:139],v[200:203],a[216:219],v[136:139]
ds_read_b64_tr_b16 v[196:197],v15 offset:36864
M v[168:171],v[200:203],a[220:223],v[168:171]
ds_read_b64_tr_b16 v[198:199],v15 offset:37376
M v[76:79],v[204:207],a[208:211],v[76:79]
M v[108:111],v[204:207],a[212:215],v[108:111]
M v[140:143],v[204:207],a[216:219],v[140:143]
M v[172:175],v[204:207],a[220:223],v[172:175]
s_waitcnt lgkmcnt(0)
s_barrier
M v[80:83],v[208:211],a[208:211],v[80:83]
ds_read_b64_tr_b16 v[200:201],v12 offset:40960
s_mov_b32 m0,s33
M v[112:115],v[208:211],a[212:215],v[112:115]
ds_read_b64_tr_b16 v[202:203],v12 offset:41472
buffer_load_dwordx4 v16,s[24:27],s34 offen lds
M v[144:147],v[208:211],a[216:219],v[144:147]
ds_read_b64_tr_b16 v[204:205],v13 offset:40960
M v[176:179],v[208:211],a[220:223],v[176:179]
ds_read_b64_tr_b16 v[206:207],v13 offset:41472
buffer_load_dwordx4 v17,s[24:27],s34 offen offset:1024 lds
M v[84:87],v[212:215],a[208:211],v[84:87]
M v[116:119],v[212:215],a[212:215],v[116:119]
M v[148:151],v[212:215],a[216:219],v[148:151]
buffer_load_dwordx4 v18,s[24:27],s34 offen offset:2048 lds
M v[180:183],v[212:215],a[220:223],v[180:183]
M v[88:91],v[192:195],a[208:211],v[88:91]
ds_read_b64_tr_b16 v[208:209],v14 offset:40960
M v[120:123],v[192:195],a[212:215],v[120:123]
ds_read_b64_tr_b16 v[210:211],v14 offset:41472
buffer_load_dwordx4 v19,s[24:27],s34 offen offset:3072 lds
s_add_u32 s34,s34,s36
M v[152:155],v[192:195],a[216:219],v[152:155]
ds_read_b64_tr_b16 v[212:213],v15 offset:40960
M v[184:187],v[192:195],a[220:223],v[184:187]
ds_read_b64_tr_b16 v[214:215],v15 offset:41472
s_add_u32 m0,s33,4096
M v[92:95],v[196:199],a[208:211],v[92:95]
buffer_load_dwordx4 v16,s[24:27],s35 offen lds
M v[124:127],v[196:199],a[212:215],v[124:127]
M v[156:159],v[196:199],a[216:219],v[156:159]
M v[188:191],v[196:199],a[220:223],v[188:191]
buffer_load_dwordx4 v17,s[24:27],s35 offen offset:1024 lds
s_waitcnt lgkmcnt(4)
M a[0:3],v[200:203],a[208:211],a[0:3]
ds_read_b64_tr_b16 v[192:193],v12 offset:45056
M a[32:35],v[200:203],a[212:215],a[32:35]
ds_read_b64_tr_b16 v[194:195],v12 offset:45568
M a[64:67],v[200:203],a[216:219],a[64:67]
ds_read_b64_tr_b16 v[196:197],v13 offset:45056
buffer_load_dwordx4 v18,s[24:27],s35 offen offset:2048 lds
M a[96:99],v[200:203],a[220:223],a[96:99]
ds_read_b64_tr_b16 v[198:199],v13 offset:45568
M a[4:7],v[204:207],a[208:211],a[4:7]
M a[36:39],v[204:207],a[212:215],a[36:39]
buffer_load_dwordx4 v19,s[24:27],s35 offen offset:3072 lds
s_add_u32 s35,s35,s36
M a[68:71],v[204:207],a[216:219],a[68:71]
M a[100:103],v[204:207],a[220:223],a[100:103]
s_waitcnt lgkmcnt(4)
M a[8:11],v[208:211],a[208:211],a[8:11]
ds_read_b64_tr_b16 v[200:201],v14 offset:45056
M a[40:43],v[208:211],a[212:215],a[40:43]
ds_read_b64_tr_b16 v[202:203],v14 offset:45568
M a[72:75],v[208:211],a[216:219],a[72:75]
ds_read_b64_tr_b16 v[204:205],v15 offset:45056
M a[104:107],v[208:211],a[220:223],a[104:107]
ds_read_b64_tr_b16 v[206:207],v15 offset:45568
M a[12:15],v[212:215],a[208:211],a[12:15]
M a[44:47],v[212:215],a[212:215],a[44:47]
M a[76:79],v[212:215],a[216:219],a[76:79]
M a[108:111],v[212:215],a[220:223],a[108:111]
s_waitcnt vmcnt(8) lgkmcnt(0)
s_barrier
M a[16:19],v[192:195],a[208:211],a[16:19]
ds_read_b64_tr_b16 v[208:209],v12
M a[48:51],v[192:195],a[212:215],a[48:51]
ds_read_b64_tr_b16 v[210:211],v12 offset:512
M a[80:83],v[192:195],a[216:219],a[80:83]
ds_read_b64_tr_b16 v[212:213],v13
M a[112:115],v[192:195],a[220:223],a[112:115]
ds_read_b64_tr_b16 v[214:215],v13 offset:512
M a[20:23],v[196:199],a[208:211],a[20:23]
ds_read_b128 a[192:195],v11 offset:32768
M a[52:55],v[196:199],a[212:215],a[52:55]
ds_read_b128 a[196:199],v11 offset:34816
M a[84:87],v[196:199],a[216:219],a[84:87]
ds_read_b128 a[200:203],v11 offset:36864
M a[116:119],v[196:199],a[220:223],a[116:119]
ds_read_b128 a[204:207],v11 offset:38912
M a[24:27],v[200:203],a[208:211],a[24:27]
ds_read_b64_tr_b16 v[192:193],v14
M a[56:59],v[200:203],a[212:215],a[56:59]
ds_read_b64_tr_b16 v[194:195],v14 offset:512
M a[88:91],v[200:203],a[216:219],a[88:91]
ds_read_b64_tr_b16 v[196:197],v15
M a[120:123],v[200:203],a[220:223],a[120:123]
ds_read_b64_tr_b16 v[198:199],v15 offset:512
M a[28:31],v[204:207],a[208:211],a[28:31]
M a[60:63],v[204:207],a[212:215],a[60:63]
M a[92:95],v[204:207],a[216:219],a[92:95]
M a[124:127],v[204:207],a[220:223],a[124:127]
s_waitcnt lgkmcnt(4)
M v[64:67],v[208:211],a[192:195],v[64:67]
ds_read_b64_tr_b16 v[200:201],v12 offset:4096
M v[96:99],v[208:211],a[196:199],v[96:99]
ds_read_b64_tr_b16 v[202:203],v12 offset:4608
M v[128:131],v[208:211],a[200:203],v[128:131]
ds_read_b64_tr_b16 v[204:205],v13 offset:4096
M v[160:163],v[208:211],a[204:207],v[160:163]
ds_read_b64_tr_b16 v[206:207],v13 offset:4608
M v[68:71],v[212:215],a[192:195],v[68:71]
M v[100:103],v[212:215],a[196:199],v[100:103]
M v[132:135],v[212:215],a[200:203],v[132:135]
M v[164:167],v[212:215],a[204:207],v[164:167]
s_waitcnt lgkmcnt(4)
M v[72:75],v[192:195],a[192:195],v[72:75]
ds_read_b64_tr_b16 v[208:209],v14 offset:4096
M v[104:107],v[192:195],a[196:199],v[104:107]
ds_read_b64_tr_b16 v[210:211],v14 offset:4608
M v[136:139],v[192:195],a[200:203],v[136:139]
ds_read_b64_tr_b16 v[212:213],v15 offset:4096
M v[168:171],v[192:195],a[204:207],v[168:171]
ds_read_b64_tr_b16 v[214:215],v15 offset:4608
M v[76:79],v[196:199],a[192:195],v[76:79]
M v[108:111],v[196:199],a[196:199],v[108:111]
M v[140:143],v[196:199],a[200:203],v[140:143]
M v[172:175],v[196:199],a[204:207],v[172:175]
s_waitcnt lgkmcnt(0)
s_barrier
M v[80:83],v[200:203],a[192:195],v[80:83]
ds_read_b64_tr_b16 v[192:193],v12 offset:8192
s_mov_b32 m0,s30
M v[112:115],v[200:203],a[196:199],v[112:115]
ds_read_b64_tr_b16 v[194:195],v12 offset:8704
buffer_load_dwordx4 v16,s[24:27],s34 offen lds
M v[144:147],v[200:203],a[200:203],v[144:147]
ds_read_b64_tr_b16 v[196:197],v13 offset:8192
M v[176:179],v[200:203],a[204:207],v[176:179]
ds_read_b64_tr_b16 v[198:199],v13 offset:8704
buffer_load_dwordx4 v17,s[24:27],s34 offen offset:1024 lds
M v[84:87],v[204:207],a[192:195],v[84:87]
M v[116:119],v[204:207],a[196:199],v[116:119]
M v[148:151],v[204:207],a[200:203],v[148:151]
buffer_load_dwordx4 v18,s[24:27],s34 offen offset:2048 lds
M v[180:183],v[204:207],a[204:207],v[180:183]
M v[88:91],v[208:211],a[192:195],v[88:91]
ds_read_b64_tr_b16 v[200:201],v14 offset:8192
M v[120:123],v[208:211],a[196:199],v[120:123]
ds_read_b64_tr_b16 v[202:203],v14 offset:8704
buffer_load_dwordx4 v19,s[24:27],s34 offen offset:3072 lds
s_add_u32 s34,s34,s39
M v[152:155],v[208:211],a[200:203],v[152:155]
ds_read_b64_tr_b16 v[204:205],v15 offset:8192
M v[184:187],v[208:211],a[204:207],v[184:187]
ds_read_b64_tr_b16 v[206:207],v15 offset:8704
s_add_u32 m0,s30,4096
M v[92:95],v[212:215],a[192:195],v[92:95]
buffer_load_dwordx4 v16,s[24:27],s35 offen lds
M v[124:127],v[212:215],a[196:199],v[124:127]
M v[156:159],v[212:215],a[200:203],v[156:159]
M v[188:191],v[212:215],a[204:207],v[188:191]
buffer_load_dwordx4 v17,s[24:27],s35 offen offset:1024 lds
s_waitcnt lgkmcnt(4)
M a[0:3],v[192:195],a[192:195],a[0:3]
ds_read_b64_tr_b16 v[208:209],v12 offset:12288
M a[32:35],v[192:195],a[196:199],a[32:35]
ds_read_b64_tr_b16 v[210:211],v12 offset:12800
M a[64:67],v[192:195],a[200:203],a[64:67]
ds_read_b64_tr_b16 v[212:213],v13 offset:12288
buffer_load_dwordx4 v18,s[24:27],s35 offen offset:2048 lds
M a[96:99],v[192:195],a[204:207],a[96:99]
ds_read_b64_tr_b16 v[214:215],v13 offset:12800
M a[4:7],v[196:199],a[192:195],a[4:7]
M a[36:39],v[196:199],a[196:199],a[36:39]
buffer_load_dwordx4 v19,s[24:27],s35 offen offset:3072 lds
s_add_u32 s35,s35,s39
M a[68:71],v[196:199],a[200:203],a[68:71]
M a[100:103],v[196:199],a[204:207],a[100:103]
s_waitcnt lgkmcnt(4)
M a[8:11],v[200:203],a[192:195],a[8:11]
ds_read_b64_tr_b16 v[192:193],v14 offset:12288
M a[40:43],v[200:203],a[196:199],a[40:43]
ds_read_b64_tr_b16 v[194:195],v14 offset:12800
M a[72:75],v[200:203],a[200:203],a[72:75]
ds_read_b64_tr_b16 v[196:197],v15 offset:12288
M a[104:107],v[200:203],a[204:207],a[104:107]
ds_read_b64_tr_b16 v[198:199],v15 offset:12800
M a[12:15],v[204:207],a[192:195],a[12:15]
M a[44:47],v[204:207],a[196:199],a[44:47]
M a[76:79],v[204:207],a[200:203],a[76:79]
M a[108:111],v[204:207],a[204:207],a[108:111]
s_waitcnt vmcnt(8) lgkmcnt(0)
s_barrier
M a[16:19],v[208:211],a[192:195],a[16:19]
ds_read_b64_tr_b16 v[200:201],v12 offset:32768
M a[48:51],v[208:211],a[196:199],a[48:51]
ds_read_b64_tr_b16 v[202:203],v12 offset:33280
M a[80:83],v[208:211],a[200:203],a[80:83]
ds_read_b64_tr_b16 v[204:205],v13 offset:32768
M a[112:115],v[208:211],a[204:207],a[112:115]
ds_read_b64_tr_b16 v[206:207],v13 offset:33280
M a[20:23],v[212:215],a[192:195],a[20:23]
ds_read_b128 a[208:211],v11 offset:33280
M a[52:55],v[212:215],a[196:199],a[52:55]
ds_read_b128 a[212:215],v11 offset:35328
M a[84:87],v[212:215],a[200:203],a[84:87]
ds_read_b128 a[216:219],v11 offset:37376
M a[116:119],v[212:215],a[204:207],a[116:119]
ds_read_b128 a[220:223],v11 offset:39424
M a[24:27],v[192:195],a[192:195],a[24:27]
ds_read_b64_tr_b16 v[208:209],v14 offset:32768
M a[56:59],v[192:195],a[196:199],a[56:59]
ds_read_b64_tr_b16 v[210:211],v14 offset:33280
M a[88:91],v[192:195],a[200:203],a[88:91]
ds_read_b64_tr_b16 v[212:213],v15 offset:32768
M a[120:123],v[192:195],a[204:207],a[120:123]
ds_read_b64_tr_b16 v[214:215],v15 offset:33280
M a[28:31],v[196:199],a[192:195],a[28:31]
M a[60:63],v[196:199],a[196:199],a[60:63]
M a[92:95],v[196:199],a[200:203],a[92:95]
M a[124:127],v[196:199],a[204:207],a[124:127]
s_waitcnt lgkmcnt(4)
M v[64:67],v[200:203],a[208:211],v[64:67]
ds_read_b64_tr_b16 v[192:193],v12 offset:36864
M v[96:99],v[200:203],a[212:215],v[96:99]
ds_read_b64_tr_b16 v[194:195],v12 offset:37376
M v[128:131],v[200:203],a[216:219],v[128:131]
ds_read_b64_tr_b16 v[196:197],v13 offset:36864
M v[160:163],v[200:203],a[220:223],v[160:163]
ds_read_b64_tr_b16 v[198:199],v13 offset:37376
M v[68:71],v[204:207],a[208:211],v[68:71]
M v[100:103],v[204:207],a[212:215],v[100:103]
M v[132:135],v[204:207],a[216:219],v[132:135]
M v[164:167],v[204:207],a[220:223],v[164:167]
s_waitcnt lgkmcnt(4)
M v[72:75],v[208:211],a[208:211],v[72:75]
ds_read_b64_tr_b16 v[200:201],v14 offset:36864
M v[104:107],v[208:211],a[212:215],v[104:107]
ds_read_b64_tr_b16 v[202:203],v14 offset:37376
M v[136:139],v[208:211],a[216:219],v[136:139]
ds_read_b64_tr_b16 v[204:205],v15 offset:36864
M v[168:171],v[208:211],a[220:223],v[168:171]
ds_read_b64_tr_b16 v[206:207],v15 offset:37376
M v[76:79],v[212:215],a[208:211],v[76:79]
M v[108:111],v[212:215],a[212:215],v[108:111]
M v[140:143],v[212:215],a[216:219],v[140:143]
M v[172:175],v[212:215],a[220:223],v[172:175]
s_waitcnt lgkmcnt(0)
s_barrier
M v[80:83],v[192:195],a[208:211],v[80:83]
ds_read_b64_tr_b16 v[208:209],v12 offset:40960
s_mov_b32 m0,s31
M v[112:115],v[192:195],a[212:215],v[112:115]
ds_read_b64_tr_b16 v[210:211],v12 offset:41472
buffer_load_dwordx4 v16,s[24:27],s34 offen lds
M v[144:147],v[192:195],a[216:219],v[144:147]
ds_read_b64_tr_b16 v[212:213],v13 offset:40960
M v[176:179],v[192:195],a[220:223],v[176:179]
ds_read_b64_tr_b16 v[214:215],v13 offset:41472
buffer_load_dwordx4 v17,s[24:27],s34 offen offset:1024 lds
M v[84:87],v[196:199],a[208:211],v[84:87]
M v[116:119],v[196:199],a[212:215],v[116:119]
M v[148:151],v[196:199],a[216:219],v[148:151]
buffer_load_dwordx4 v18,s[24:27],s34 offen offset:2048 lds
M v[180:183],v[196:199],a[220:223],v[180:183]
M v[88:91],v[200:203],a[208:211],v[88:91]
ds_read_b64_tr_b16 v[192:193],v14 offset:40960
M v[120:123],v[200:203],a[212:215],v[120:123]
ds_read_b64_tr_b16 v[194:195],v14 offset:41472
buffer_load_dwordx4 v19,s[24:27],s34 offen offset:3072 lds
s_add_u32 s34,s34,s36
M v[152:155],v[200:203],a[216:219],v[152:155]
ds_read_b64_tr_b16 v[196:197],v15 offset:40960
M v[184:187],v[200:203],a[220:223],v[184:187]
ds_read_b64_tr_b16 v[198:199],v15 offset:41472
s_add_u32 m0,s31,4096
M v[92:95],v[204:207],a[208:211],v[92:95]
buffer_load_dwordx4 v16,s[24:27],s35 offen lds
M v[124:127],v[204:207],a[212:215],v[124:127]
M v[156:159],v[204:207],a[216:219],v[156:159]
M v[188:191],v[204:207],a[220:223],v[188:191]
buffer_load_dwordx4 v17,s[24:27],s35 offen offset:1024 lds
s_waitcnt lgkmcnt(4)
M a[0:3],v[208:211],a[208:211],a[0:3]
ds_read_b64_tr_b16 v[200:201],v12 offset:45056
M a[32:35],v[208:211],a[212:215],a[32:35]
ds_read_b64_tr_b16 v[202:203],v12 offset:45568
M a[64:67],v[208:211],a[216:219],a[64:67]
ds_read_b64_tr_b16 v[204:205],v13 offset:45056
buffer_load_dwordx4 v18,s[24:27],s35 offen offset:2048 lds
M a[96:99],v[208:211],a[220:223],a[96:99]
ds_read_b64_tr_b16 v[206:207],v13 offset:45568
M a[4:7],v[212:215],a[208:211],a[4:7]
M a[36:39],v[212:215],a[212:215],a[36:39]
buffer_load_dwordx4 v19,s[24:27],s35 offen offset:3072 lds
s_add_u32 s35,s35,s36
M a[68:71],v[212:215],a[216:219],a[68:71]
M a[100:103],v[212:215],a[220:223],a[100:103]
s_waitcnt lgkmcnt(4)
M a[8:11],v[192:195],a[208:211],a[8:11]
ds_read_b64_tr_b16 v[208:209],v14 offset:45056
M a[40:43],v[192:195],a[212:215],a[40:43]
ds_read_b64_tr_b16 v[210:211],v14 offset:45568
M a[72:75],v[192:195],a[216:219],a[72:75]
ds_read_b64_tr_b16 v[212:213],v15 offset:45056
M a[104:107],v[192:195],a[220:223],a[104:107]
ds_read_b64_tr_b16 v[214:215],v15 offset:45568
M a[12:15],v[196:199],a[208:211],a[12:15]
M a[44:47],v[196:199],a[212:215],a[44:47]
M a[76:79],v[196:199],a[216:219],a[76:79]
M a[108:111],v[196:199],a[220:223],a[108:111]
s_waitcnt vmcnt(8) lgkmcnt(0)
s_barrier
M a[16:19],v[200:203],a[208:211],a[16:19]
ds_read_b64_tr_b16 v[192:193],v12
M a[48:51],v[200:203],a[212:215],a[48:51]
ds_read_b64_tr_b16 v[194:195],v12 offset:512
M a[80:83],v[200:203],a[216:219],a[80:83]
ds_read_b64_tr_b16 v[196:197],v13
M a[112:115],v[200:203],a[220:223],a[112:115]
ds_read_b64_tr_b16 v[198:199],v13 offset:512
M a[20:23],v[204:207],a[208:211],a[20:23]
ds_read_b128 a[192:195],v11
M a[52:55],v[204:207],a[212:215],a[52:55]
ds_read_b128 a[196:199],v11 offset:2048
M a[84:87],v[204:207],a[216:219],a[84:87]
ds_read_b128 a[200:203],v11 offset:4096
M a[116:119],v[204:207],a[220:223],a[116:119]
ds_read_b128 a[204:207],v11 offset:6144
M a[24:27],v[208:211],a[208:211],a[24:27]
ds_read_b64_tr_b16 v[200:201],v14
M a[56:59],v[208:211],a[212:215],a[56:59]
ds_read_b64_tr_b16 v[202:203],v14 offset:512
M a[88:91],v[208:211],a[216:219],a[88:91]
ds_read_b64_tr_b16 v[204:205],v15
M a[120:123],v[208:211],a[220:223],a[120:123]
ds_read_b64_tr_b16 v[206:207],v15 offset:512
M a[28:31],v[212:215],a[208:211],a[28:31]
M a[60:63],v[212:215],a[212:215],a[60:63]
M a[92:95],v[212:215],a[216:219],a[92:95]
M a[124:127],v[212:215],a[220:223],a[124:127]
s_waitcnt lgkmcnt(4)
M v[64:67],v[192:195],a[192:195],v[64:67]
ds_read_b64_tr_b16 v[208:209],v12 offset:4096
M v[96:99],v[192:195],a[196:199],v[96:99]
ds_read_b64_tr_b16 v[210:211],v12 offset:4608
M v[128:131],v[192:195],a[200:203],v[128:131]
ds_read_b64_tr_b16 v[212:213],v13 offset:4096
M v[160:163],v[192:195],a[204:207],v[160:163]
ds_read_b64_tr_b16 v[214:215],v13 offset:4608
M v[68:71],v[196:199],a[192:195],v[68:71]
M v[100:103],v[196:199],a[196:199],v[100:103]
M v[132:135],v[196:199],a[200:203],v[132:135]
M v[164:167],v[196:199],a[204:207],v[164:167]
s_waitcnt lgkmcnt(4)
M v[72:75],v[200:203],a[192:195],v[72:75]
ds_read_b64_tr_b16 v[192:193],v14 offset:4096
M v[104:107],v[200:203],a[196:199],v[104:107]
ds_read_b64_tr_b16 v[194:195],v14 offset:4608
M v[136:139],v[200:203],a[200:203],v[136:139]
ds_read_b64_tr_b16 v[196:197],v15 offset:4096
M v[168:171],v[200:203],a[204:207],v[168:171]
ds_read_b64_tr_b16 v[198:199],v15 offset:4608
M v[76:79],v[204:207],a[192:195],v[76:79]
M v[108:111],v[204:207],a[196:199],v[108:111]
M v[140:143],v[204:207],a[200:203],v[140:143]
M v[172:175],v[204:207],a[204:207],v[172:175]
s_waitcnt lgkmcnt(0)
s_barrier
M v[80:83],v[208:211],a[192:195],v[80:83]
ds_read_b64_tr_b16 v[200:201],v12 offset:8192
s_mov_b32 m0,s32
M v[112:115],v[208:211],a[196:199],v[112:115]
ds_read_b64_tr_b16 v[202:203],v12 offset:8704
buffer_load_dwordx4 v16,s[24:27],s34 offen lds
M v[144:147],v[208:211],a[200:203],v[144:147]
ds_read_b64_tr_b16 v[204:205],v13 offset:8192
M v[176:179],v[208:211],a[204:207],v[176:179]
ds_read_b64_tr_b16 v[206:207],v13 offset:8704
buffer_load_dwordx4 v17,s[24:27],s34 offen offset:1024 lds
M v[84:87],v[212:215],a[192:195],v[84:87]
M v[116:119],v[212:215],a[196:199],v[116:119]
M v[148:151],v[212:215],a[200:203],v[148:151]
buffer_load_dwordx4 v18,s[24:27],s34 offen offset:2048 lds
M v[180:183],v[212:215],a[204:207],v[180:183]
M v[88:91],v[192:195],a[192:195],v[88:91]
ds_read_b64_tr_b16 v[208:209],v14 offset:8192
M v[120:123],v[192:195],a[196:199],v[120:123]
ds_read_b64_tr_b16 v[210:211],v14 offset:8704
buffer_load_dwordx4 v19,s[24:27],s34 offen offset:3072 lds
s_add_u32 s34,s34,s39
M v[152:155],v[192:195],a[200:203],v[152:155]
ds_read_b64_tr_b16 v[212:213],v15 offset:8192
M v[184:187],v[192:195],a[204:207],v[184:187]
ds_read_b64_tr_b16 v[214:215],v15 offset:8704
s_add_u32 m0,s32,4096
M v[92:95],v[196:199],a[192:195],v[92:95]
buffer_load_dwordx4 v16,s[24:27],s35 offen lds
M v[124:127],v[196:199],a[196:199],v[124:127]
M v[156:159],v[196:199],a[200:203],v[156:159]
M v[188:191],v[196:199],a[204:207],v[188:191]
buffer_load_dwordx4 v17,s[24:27],s35 offen offset:1024 lds
s_waitcnt lgkmcnt(4)
M a[0:3],v[200:203],a[192:195],a[0:3]
ds_read_b64_tr_b16 v[192:193],v12 offset:12288
M a[32:35],v[200:203],a[196:199],a[32:35]
ds_read_b64_tr_b16 v[194:195],v12 offset:12800
M a[64:67],v[200:203],a[200:203],a[64:67]
ds_read_b64_tr_b16 v[196:197],v13 offset:12288
buffer_load_dwordx4 v18,s[24:27],s35 offen offset:2048 lds
M a[96:99],v[200:203],a[204:207],a[96:99]
ds_read_b64_tr_b16 v[198:199],v13 offset:12800
M a[4:7],v[204:207],a[192:195],a[4:7]
M a[36:39],v[204:207],a[196:199],a[36:39]
buffer_load_dwordx4 v19,s[24:27],s35 offen offset:3072 lds
s_add_u32 s35,s35,s39
M a[68:71],v[204:207],a[200:203],a[68:71]
M a[100:103],v[204:207],a[204:207],a[100:103]
s_waitcnt lgkmcnt(4)
M a[8:11],v[208:211],a[192:195],a[8:11]
ds_read_b64_tr_b16 v[200:201],v14 offset:12288
M a[40:43],v[208:211],a[196:199],a[40:43]
ds_read_b64_tr_b16 v[202:203],v14 offset:12800
M a[72:75],v[208:211],a[200:203],a[72:75]
ds_read_b64_tr_b16 v[204:205],v15 offset:12288
M a[104:107],v[208:211],a[204:207],a[104:107]
ds_read_b64_tr_b16 v[206:207],v15 offset:12800
M a[12:15],v[212:215],a[192:195],a[12:15]
M a[44:47],v[212:215],a[196:199],a[44:47]
M a[76:79],v[212:215],a[200:203],a[76:79]
M a[108:111],v[212:215],a[204:207],a[108:111]
s_waitcnt vmcnt(8) lgkmcnt(0)
s_barrier
M a[16:19],v[192:195],a[192:195],a[16:19]
ds_read_b64_tr_b16 v[208:209],v12 offset:32768
M a[48:51],v[192:195],a[196:199],a[48:51]
ds_read_b64_tr_b16 v[210:211],v12 offset:33280
M a[80:83],v[192:195],a[200:203],a[80:83]
ds_read_b64_tr_b16 v[212:213],v13 offset:32768
M a[112:115],v[192:195],a[204:207],a[112:115]
ds_read_b64_tr_b16 v[214:215],v13 offset:33280
M a[20:23],v[196:199],a[192:195],a[20:23]
ds_read_b128 a[208:211],v11 offset:512
M a[52:55],v[196:199],a[196:199],a[52:55]
ds_read_b128 a[212:215],v11 offset:2560
M a[84:87],v[196:199],a[200:203],a[84:87]
ds_read_b128 a[216:219],v11 offset:4608
M a[116:119],v[196:199],a[204:207],a[116:119]
ds_read_b128 a[220:223],v11 offset:6656
M a[24:27],v[200:203],a[192:195],a[24:27]
ds_read_b64_tr_b16 v[192:193],v14 offset:32768
M a[56:59],v[200:203],a[196:199],a[56:59]
ds_read_b64_tr_b16 v[194:195],v14 offset:33280
M a[88:91],v[200:203],a[200:203],a[88:91]
ds_read_b64_tr_b16 v[196:197],v15 offset:32768
M a[120:123],v[200:203],a[204:207],a[120:123]
ds_read_b64_tr_b16 v[198:199],v15 offset:33280
M a[28:31],v[204:207],a[192:195],a[28:31]
M a[60:63],v[204:207],a[196:199],a[60:63]
M a[92:95],v[204:207],a[200:203],a[92:95]
M a[124:127],v[204:207],a[204:207],a[124:127]
s_waitcnt lgkmcnt(4)
M v[64:67],v[208:211],a[208:211],v[64:67]
ds_read_b64_tr_b16 v[200:201],v12 offset:36864
M v[96:99],v[208:211],a[212:215],v[96:99]
ds_read_b64_tr_b16 v[202:203],v12 offset:37376
M v[128:131],v[208:211],a[216:219],v[128:131]
ds_read_b64_tr_b16 v[204:205],v13 offset:36864
M v[160:163],v[208:211],a[220:223],v[160:163]
ds_read_b64_tr_b16 v[206:207],v13 offset:37376
M v[68:71],v[212:215],a[208:211],v[68:71]
M v[100:103],v[212:215],a[212:215],v[100:103]
M v[132:135],v[212:215],a[216:219],v[132:135]
M v[164:167],v[212:215],a[220:223],v[164:167]
s_waitcnt lgkmcnt(4)
M v[72:75],v[192:195],a[208:211],v[72:75]
ds_read_b64_tr_b16 v[208:209],v14 offset:36864
M v[104:107],v[192:195],a[212:215],v[104:107]
ds_read_b64_tr_b16 v[210:211],v14 offset:37376
M v[136:139],v[192:195],a[216:219],v[136:139]
ds_read_b64_tr_b16 v[212:213],v15 offset:36864
M v[168:171],v[192:195],a[220:223],v[168:171]
ds_read_b64_tr_b16 v[214:215],v15 offset:37376
M v[76:79],v[196:199],a[208:211],v[76:79]
M v[108:111],v[196:199],a[212:215],v[108:111]
M v[140:143],v[196:199],a[216:219],v[140:143]
M v[172:175],v[196:199],a[220:223],v[172:175]
s_waitcnt lgkmcnt(0)
s_barrier
M v[80:83],v[200:203],a[208:211],v[80:83]
ds_read_b64_tr_b16 v[192:193],v12 offset:40960
s_mov_b32 m0,s33
M v[112:115],v[200:203],a[212:215],v[112:115]
ds_read_b64_tr_b16 v[194:195],v12 offset:41472
buffer_load_dwordx4 v16,s[24:27],s34 offen lds
M v[144:147],v[200:203],a[216:219],v[144:147]
ds_read_b64_tr_b16 v[196:197],v13 offset:40960
M v[176:179],v[200:203],a[220:223],v[176:179]
ds_read_b64_tr_b16 v[198:199],v13 offset:41472
buffer_load_dwordx4 v17,s[24:27],s34 offen offset:1024 lds
M v[84:87],v[204:207],a[208:211],v[84:87]
M v[116:119],v[204:207],a[212:215],v[116:119]
M v[148:151],v[204:207],a[216:219],v[148:151]
buffer_load_dwordx4 v18,s[24:27],s34 offen offset:2048 lds
M v[180:183],v[204:207],a[220:223],v[180:183]
M v[88:91],v[208:211],a[208:211],v[88:91]
ds_read_b64_tr_b16 v[200:201],v14 offset:40960
M v[120:123],v[208:211],a[212:215],v[120:123]
ds_read_b64_tr_b16 v[202:203],v14 offset:41472
buffer_load_dwordx4 v19,s[24:27],s34 offen offset:3072 lds
s_add_u32 s34,s34,s36
M v[152:155],v[208:211],a[216:219],v[152:155]
ds_read_b64_tr_b16 v[204:205],v15 offset:40960
M v[184:187],v[208:211],a[220:223],v[184:187]
ds_read_b64_tr_b16 v[206:207],v15 offset:41472
s_add_u32 m0,s33,4096
M v[92:95],v[212:215],a[208:211],v[92:95]
buffer_load_dwordx4 v16,s[24:27],s35 offen lds
M v[124:127],v[212:215],a[212:215],v[124:127]
M v[156:159],v[212:215],a[216:219],v[156:159]
M v[188:191],v[212:215],a[220:223],v[188:191]
buffer_load_dwordx4 v17,s[24:27],s35 offen offset:1024 lds
s_waitcnt lgkmcnt(4)
M a[0:3],v[192:195],a[208:211],a[0:3]
ds_read_b64_tr_b16 v[208:209],v12 offset:45056
M a[32:35],v[192:195],a[212:215],a[32:35]
ds_read_b64_tr_b16 v[210:211],v12 offset:45568
M a[64:67],v[192:195],a[216:219],a[64:67]
ds_read_b64_tr_b16 v[212:213],v13 offset:45056
buffer_load_dwordx4 v18,s[24:27],s35 offen offset:2048 lds
M a[96:99],v[192:195],a[220:223],a[96:99]
ds_read_b64_tr_b16 v[214:215],v13 offset:45568
M a[4:7],v[196:199],a[208:211],a[4:7]
M a[36:39],v[196:199],a[212:215],a[36:39]
buffer_load_dwordx4 v19,s[24:27],s35 offen offset:3072 lds
s_add_u32 s35,s35,s36
M a[68:71],v[196:199],a[216:219],a[68:71]
M a[100:103],v[196:199],a[220:223],a[100:103]
s_waitcnt lgkmcnt(4)
M a[8:11],v[200:203],a[208:211],a[8:11]
ds_read_b64_tr_b16 v[192:193],v14 offset:45056
M a[40:43],v[200:203],a[212:215],a[40:43]
ds_read_b64_tr_b16 v[194:195],v14 offset:45568
M a[72:75],v[200:203],a[216:219],a[72:75]
ds_read_b64_tr_b16 v[196:197],v15 offset:45056
M a[104:107],v[200:203],a[220:223],a[104:107]
ds_read_b64_tr_b16 v[198:199],v15 offset:45568
M a[12:15],v[204:207],a[208:211],a[12:15]
M a[44:47],v[204:207],a[212:215],a[44:47]
M a[76:79],v[204:207],a[216:219],a[76:79]
M a[108:111],v[204:207],a[220:223],a[108:111]
s_waitcnt vmcnt(8) lgkmcnt(0)
s_barrier
M a[16:19],v[208:211],a[208:211],a[16:19]
ds_read_b64_tr_b16 v[200:201],v12
M a[48:51],v[208:211],a[212:215],a[48:51]
ds_read_b64_tr_b16 v[202:203],v12 offset:512
M a[80:83],v[208:211],a[216:219],a[80:83]
ds_read_b64_tr_b16 v[204:205],v13
M a[112:115],v[208:211],a[220:223],a[112:115]
ds_read_b64_tr_b16 v[206:207],v13 offset:512
M a[20:23],v[212:215],a[208:211],a[20:23]
ds_read_b128 a[192:195],v11 offset:32768
M a[52:55],v[212:215],a[212:215],a[52:55]
ds_read_b128 a[196:199],v11 offset:34816
M a[84:87],v[212:215],a[216:219],a[84:87]
ds_read_b128 a[200:203],v11 offset:36864
M a[116:119],v[212:215],a[220:223],a[116:119]
ds_read_b128 a[204:207],v11 offset:38912
M a[24:27],v[192:195],a[208:211],a[24:27]
ds_read_b64_tr_b16 v[208:209],v14
M a[56:59],v[192:195],a[212:215],a[56:59]
ds_read_b64_tr_b16 v[210:211],v14 offset:512
M a[88:91],v[192:195],a[216:219],a[88:91]
ds_read_b64_tr_b16 v[212:213],v15
M a[120:123],v[192:195],a[220:223],a[120:123]
ds_read_b64_tr_b16 v[214:215],v15 offset:512
M a[28:31],v[196:199],a[208:211],a[28:31]
M a[60:63],v[196:199],a[212:215],a[60:63]
M a[92:95],v[196:199],a[216:219],a[92:95]
M a[124:127],v[196:199],a[220:223],a[124:127]
s_waitcnt lgkmcnt(4)
M v[64:67],v[200:203],a[192:195],v[64:67]
ds_read_b64_tr_b16 v[192:193],v12 offset:4096
M v[96:99],v[200:203],a[196:199],v[96:99]
ds_read_b64_tr_b16 v[194:195],v12 offset:4608
M v[128:131],v[200:203],a[200:203],v[128:131]
ds_read_b64_tr_b16 v[196:197],v13 offset:4096
M v[160:163],v[200:203],a[204:207],v[160:163]
ds_read_b64_tr_b16 v[198:199],v13 offset:4608
M v[68:71],v[204:207],a[192:195],v[68:71]
M v[100:103],v[204:207],a[196:199],v[100:103]
M v[132:135],v[204:207],a[200:203],v[132:135]
M v[164:167],v[204:207],a[204:207],v[164:167]
s_waitcnt lgkmcnt(4)
M v[72:75],v[208:211],a[192:195],v[72:75]
ds_read_b64_tr_b16 v[200:201],v14 offset:4096
M v[104:107],v[208:211],a[196:199],v[104:107]
ds_read_b64_tr_b16 v[202:203],v14 offset:4608
M v[136:139],v[208:211],a[200:203],v[136:139]
ds_read_b64_tr_b16 v[204:205],v15 offset:4096
M v[168:171],v[208:211],a[204:207],v[168:171]
ds_read_b64_tr_b16 v[206:207],v15 offset:4608
M v[76:79],v[212:215],a[192:195],v[76:79]
M v[108:111],v[212:215],a[196:199],v[108:111]
M v[140:143],v[212:215],a[200:203],v[140:143]
M v[172:175],v[212:215],a[204:207],v[172:175]
s_waitcnt lgkmcnt(0)
s_barrier
M v[80:83],v[192:195],a[192:195],v[80:83]
ds_read_b64_tr_b16 v[208:209],v12 offset:8192
s_mov_b32 m0,s30
M v[112:115],v[192:195],a[196:199],v[112:115]
ds_read_b64_tr_b16 v[210:211],v12 offset:8704
buffer_load_dwordx4 v16,s[24:27],s34 offen lds
M v[144:147],v[192:195],a[200:203],v[144:147]
ds_read_b64_tr_b16 v[212:213],v13 offset:8192
M v[176:179],v[192:195],a[204:207],v[176:179]
ds_read_b64_tr_b16 v[214:215],v13 offset:8704
buffer_load_dwordx4 v17,s[24:27],s34 offen offset:1024 lds
M v[84:87],v[196:199],a[192:195],v[84:87]
M v[116:119],v[196:199],a[196:199],v[116:119]
M v[148:151],v[196:199],a[200:203],v[148:151]
buffer_load_dwordx4 v18,s[24:27],s34 offen offset:2048 lds
M v[180:183],v[196:199],a[204:207],v[180:183]
M v[88:91],v[200:203],a[192:195],v[88:91]
ds_read_b64_tr_b16 v[192:193],v14 offset:8192
M v[120:123],v[200:203],a[196:199],v[120:123]
ds_read_b64_tr_b16 v[194:195],v14 offset:8704
buffer_load_dwordx4 v19,s[24:27],s34 offen offset:3072 lds
s_add_u32 s34,s34,s39
M v[152:155],v[200:203],a[200:203],v[152:155]
ds_read_b64_tr_b16 v[196:197],v15 offset:8192
M v[184:187],v[200:203],a[204:207],v[184:187]
ds_read_b64_tr_b16 v[198:199],v15 offset:8704
s_add_u32 m0,s30,4096
M v[92:95],v[204:207],a[192:195],v[92:95]
buffer_load_dwordx4 v16,s[24:27],s35 offen lds
M v[124:127],v[204:207],a[196:199],v[124:127]
M v[156:159],v[204:207],a[200:203],v[156:159]
M v[188:191],v[204:207],a[204:207],v[188:191]
buffer_load_dwordx4 v17,s[24:27],s35 offen offset:1024 lds
s_waitcnt lgkmcnt(4)
M a[0:3],v[208:211],a[192:195],a[0:3]
ds_read_b64_tr_b16 v[200:201],v12 offset:12288
M a[32:35],v[208:211],a[196:199],a[32:35]
ds_read_b64_tr_b16 v[202:203],v12 offset:12800
M a[64:67],v[208:211],a[200:203],a[64:67]
ds_read_b64_tr_b16 v[204:205],v13 offset:12288
buffer_load_dwordx4 v18,s[24:27],s35 offen offset:2048 lds
M a[96:99],v[208:211],a[204:207],a[96:99]
ds_read_b64_tr_b16 v[206:207],v13 offset:12800
M a[4:7],v[212:215],a[192:195],a[4:7]
M a[36:39],v[212:215],a[196:199],a[36:39]
buffer_load_dwordx4 v19,s[24:27],s35 offen offset:3072 lds
s_add_u32 s35,s35,s39
M a[68:71],v[212:215],a[200:203],a[68:71]
M a[100:103],v[212:215],a[204:207],a[100:103]
s_waitcnt lgkmcnt(4)
M a[8:11],v[192:195],a[192:195],a[8:11]
ds_read_b64_tr_b16 v[208:209],v14 offset:12288
M a[40:43],v[192:195],a[196:199],a[40:43]
ds_read_b64_tr_b16 v[210:211],v14 offset:12800
M a[72:75],v[192:195],a[200:203],a[72:75]
ds_read_b64_tr_b16 v[212:213],v15 offset:12288
M a[104:107],v[192:195],a[204:207],a[104:107]
ds_read_b64_tr_b16 v[214:215],v15 offset:12800
M a[12:15],v[196:199],a[192:195],a[12:15]
M a[44:47],v[196:199],a[196:199],a[44:47]
M a[76:79],v[196:199],a[200:203],a[76:79]
M a[108:111],v[196:199],a[204:207],a[108:111]
s_waitcnt vmcnt(8) lgkmcnt(0)
s_barrier
M a[16:19],v[200:203],a[192:195],a[16:19]
ds_read_b64_tr_b16 v[192:193],v12 offset:32768
M a[48:51],v[200:203],a[196:199],a[48:51]
ds_read_b64_tr_b16 v[194:195],v12 offset:33280
M a[80:83],v[200:203],a[200:203],a[80:83]
ds_read_b64_tr_b16 v[196:197],v13 offset:32768
M a[112:115],v[200:203],a[204:207],a[112:115]
ds_read_b64_tr_b16 v[198:199],v13 offset:33280
M a[20:23],v[204:207],a[192:195],a[20:23]
ds_read_b128 a[208:211],v11 offset:33280
M a[52:55],v[204:207],a[196:199],a[52:55]
ds_read_b128 a[212:215],v11 offset:35328
M a[84:87],v[204:207],a[200:203],a[84:87]
ds_read_b128 a[216:219],v11 offset:37376
M a[116:119],v[204:207],a[204:207],a[116:119]
ds_read_b128 a[220:223],v11 offset:39424
M a[24:27],v[208:211],a[192:195],a[24:27]
ds_read_b64_tr_b16 v[200:201],v14 offset:32768
M a[56:59],v[208:211],a[196:199],a[56:59]
ds_read_b64_tr_b16 v[202:203],v14 offset:33280
M a[88:91],v[208:211],a[200:203],a[88:91]
ds_read_b64_tr_b16 v[204:205],v15 offset:32768
M a[120:123],v[208:211],a[204:207],a[120:123]
ds_read_b64_tr_b16 v[206:207],v15 offset:33280
M a[28:31],v[212:215],a[192:195],a[28:31]
M a[60:63],v[212:215],a[196:199],a[60:63]
M a[92:95],v[212:215],a[200:203],a[92:95]
M a[124:127],v[212:215],a[204:207],a[124:127]
s_waitcnt lgkmcnt(4)
M v[64:67],v[192:195],a[208:211],v[64:67]
ds_read_b64_tr_b16 v[208:209],v12 offset:36864
M v[96:99],v[192:195],a[212:215],v[96:99]
ds_read_b64_tr_b16 v[210:211],v12 offset:37376
M v[128:131],v[192:195],a[216:219],v[128:131]
ds_read_b64_tr_b16 v[212:213],v13 offset:36864
M v[160:163],v[192:195],a[220:223],v[160:163]
ds_read_b64_tr_b16 v[214:215],v13 offset:37376
M v[68:71],v[196:199],a[208:211],v[68:71]
M v[100:103],v[196:199],a[212:215],v[100:103]
M v[132:135],v[196:199],a[216:219],v[132:135]
M v[164:167],v[196:199],a[220:223],v[164:167]
s_waitcnt lgkmcnt(4)
M v[72:75],v[200:203],a[208:211],v[72:75]
ds_read_b64_tr_b16 v[192:193],v14 offset:36864
M v[104:107],v[200:203],a[212:215],v[104:107]
ds_read_b64_tr_b16 v[194:195],v14 offset:37376
M v[136:139],v[200:203],a[216:219],v[136:139]
ds_read_b64_tr_b16 v[196:197],v15 offset:36864
M v[168:171],v[200:203],a[220:223],v[168:171]
ds_read_b64_tr_b16 v[198:199],v15 offset:37376
M v[76:79],v[204:207],a[208:211],v[76:79]
M v[108:111],v[204:207],a[212:215],v[108:111]
M v[140:143],v[204:207],a[216:219],v[140:143]
M v[172:175],v[204:207],a[220:223],v[172:175]
s_waitcnt lgkmcnt(0)
s_barrier
M v[80:83],v[208:211],a[208:211],v[80:83]
ds_read_b64_tr_b16 v[200:201],v12 offset:40960
s_mov_b32 m0,s31
M v[112:115],v[208:211],a[212:215],v[112:115]
ds_read_b64_tr_b16 v[202:203],v12 offset:41472
buffer_load_dwordx4 v16,s[24:27],s34 offen lds
M v[144:147],v[208:211],a[216:219],v[144:147]
ds_read_b64_tr_b16 v[204:205],v13 offset:40960
M v[176:179],v[208:211],a[220:223],v[176:179]
ds_read_b64_tr_b16 v[206:207],v13 offset:41472
buffer_load_dwordx4 v17,s[24:27],s34 offen offset:1024 lds
M v[84:87],v[212:215],a[208:211],v[84:87]
M v[116:119],v[212:215],a[212:215],v[116:119]
M v[148:151],v[212:215],a[216:219],v[148:151]
buffer_load_dwordx4 v18,s[24:27],s34 offen offset:2048 lds
M v[180:183],v[212:215],a[220:223],v[180:183]
M v[88:91],v[192:195],a[208:211],v[88:91]
ds_read_b64_tr_b16 v[208:209],v14 offset:40960
M v[120:123],v[192:195],a[212:215],v[120:123]
ds_read_b64_tr_b16 v[210:211],v14 offset:41472
buffer_load_dwordx4 v19,s[24:27],s34 offen offset:3072 lds
s_add_u32 s34,s34,s36
M v[152:155],v[192:195],a[216:219],v[152:155]
ds_read_b64_tr_b16 v[212:213],v15 offset:40960
M v[184:187],v[192:195],a[220:223],v[184:187]
ds_read_b64_tr_b16 v[214:215],v15 offset:41472
s_add_u32 m0,s31,4096
M v[92:95],v[196:199],a[208:211],v[92:95]
buffer_load_dwordx4 v16,s[24:27],s35 offen lds
M v[124:127],v[196:199],a[212:215],v[124:127]
M v[156:159],v[196:199],a[216:219],v[156:159]
M v[188:191],v[196:199],a[220:223],v[188:191]
buffer_load_dwordx4 v17,s[24:27],s35 offen offset:1024 lds
s_waitcnt lgkmcnt(4)
M a[0:3],v[200:203],a[208:211],a[0:3]
ds_read_b64_tr_b16 v[192:193],v12 offset:45056
M a[32:35],v[200:203],a[212:215],a[32:35]
ds_read_b64_tr_b16 v[194:195],v12 offset:45568
M a[64:67],v[200:203],a[216:219],a[64:67]
ds_read_b64_tr_b16 v[196:197],v13 offset:45056
buffer_load_dwordx4 v18,s[24:27],s35 offen offset:2048 lds
M a[96:99],v[200:203],a[220:223],a[96:99]
ds_read_b64_tr_b16 v[198:199],v13 offset:45568
M a[4:7],v[204:207],a[208:211],a[4:7]
M a[36:39],v[204:207],a[212:215],a[36:39]
buffer_load_dwordx4 v19,s[24:27],s35 offen offset:3072 lds
s_add_u32 s35,s35,s36
M a[68:71],v[204:207],a[216:219],a[68:71]
M a[100:103],v[204:207],a[220:223],a[100:103]
s_waitcnt lgkmcnt(4)
M a[8:11],v[208:211],a[208:211],a[8:11]
ds_read_b64_tr_b16 v[200:201],v14 offset:45056
M a[40:43],v[208:211],a[212:215],a[40:43]
ds_read_b64_tr_b16 v[202:203],v14 offset:45568
M a[72:75],v[208:211],a[216:219],a[72:75]
ds_read_b64_tr_b16 v[204:205],v15 offset:45056
M a[104:107],v[208:211],a[220:223],a[104:107]
ds_read_b64_tr_b16 v[206:207],v15 offset:45568
M a[12:15],v[212:215],a[208:211],a[12:15]
M a[44:47],v[212:215],a[212:215],a[44:47]
M a[76:79],v[212:215],a[216:219],a[76:79]
M a[108:111],v[212:215],a[220:223],a[108:111]
s_waitcnt vmcnt(8) lgkmcnt(0)
s_barrier
M a[16:19],v[192:195],a[208:211],a[16:19]
ds_read_b64_tr_b16 v[208:209],v12
M a[48:51],v[192:195],a[212:215],a[48:51]
ds_read_b64_tr_b16 v[210:211],v12 offset:512
M a[80:83],v[192:195],a[216:219],a[80:83]
ds_read_b64_tr_b16 v[212:213],v13
M a[112:115],v[192:195],a[220:223],a[112:115]
ds_read_b64_tr_b16 v[214:215],v13 offset:512
M a[20:23],v[196:199],a[208:211],a[20:23]
ds_read_b128 a[192:195],v11
M a[52:55],v[196:199],a[212:215],a[52:55]
ds_read_b128 a[196:199],v11 offset:2048
M a[84:87],v[196:199],a[216:219],a[84:87]
ds_read_b128 a[200:203],v11 offset:4096
M a[116:119],v[196:199],a[220:223],a[116:119]
ds_read_b128 a[204:207],v11 offset:6144
M a[24:27],v[200:203],a[208:211],a[24:27]
ds_read_b64_tr_b16 v[192:193],v14
M a[56:59],v[200:203],a[212:215],a[56:59]
ds_read_b64_tr_b16 v[194:195],v14 offset:512
M a[88:91],v[200:203],a[216:219],a[88:91]
ds_read_b64_tr_b16 v[196:197],v15
M a[120:123],v[200:203],a[220:223],a[120:123]
ds_read_b64_tr_b16 v[198:199],v15 offset:512
M a[28:31],v[204:207],a[208:211],a[28:31]
M a[60:63],v[204:207],a[212:215],a[60:63]
M a[92:95],v[204:207],a[216:219],a[92:95]
M a[124:127],v[204:207],a[220:223],a[124:127]
s_waitcnt lgkmcnt(4)
M v[64:67],v[208:211],a[192:195],v[64:67]
ds_read_b64_tr_b16 v[200:201],v12 offset:4096
M v[96:99],v[208:211],a[196:199],v[96:99]
ds_read_b64_tr_b16 v[202:203],v12 offset:4608
M v[128:131],v[208:211],a[200:203],v[128:131]
ds_read_b64_tr_b16 v[204:205],v13 offset:4096
M v[160:163],v[208:211],a[204:207],v[160:163]
ds_read_b64_tr_b16 v[206:207],v13 offset:4608
M v[68:71],v[212:215],a[192:195],v[68:71]
M v[100:103],v[212:215],a[196:199],v[100:103]
M v[132:135],v[212:215],a[200:203],v[132:135]
M v[164:167],v[212:215],a[204:207],v[164:167]
s_waitcnt lgkmcnt(4)
M v[72:75],v[192:195],a[192:195],v[72:75]
ds_read_b64_tr_b16 v[208:209],v14 offset:4096
M v[104:107],v[192:195],a[196:199],v[104:107]
ds_read_b64_tr_b16 v[210:211],v14 offset:4608
M v[136:139],v[192:195],a[200:203],v[136:139]
ds_read_b64_tr_b16 v[212:213],v15 offset:4096
M v[168:171],v[192:195],a[204:207],v[168:171]
ds_read_b64_tr_b16 v[214:215],v15 offset:4608
M v[76:79],v[196:199],a[192:195],v[76:79]
M v[108:111],v[196:199],a[196:199],v[108:111]
M v[140:143],v[196:199],a[200:203],v[140:143]
M v[172:175],v[196:199],a[204:207],v[172:175]
s_waitcnt lgkmcnt(0)
s_barrier
M v[80:83],v[200:203],a[192:195],v[80:83]
ds_read_b64_tr_b16 v[192:193],v12 offset:8192
s_mov_b32 m0,s32
M v[112:115],v[200:203],a[196:199],v[112:115]
ds_read_b64_tr_b16 v[194:195],v12 offset:8704
buffer_load_dwordx4 v16,s[24:27],s34 offen lds
M v[144:147],v[200:203],a[200:203],v[144:147]
ds_read_b64_tr_b16 v[196:197],v13 offset:8192
M v[176:179],v[200:203],a[204:207],v[176:179]
ds_read_b64_tr_b16 v[198:199],v13 offset:8704
buffer_load_dwordx4 v17,s[24:27],s34 offen offset:1024 lds
M v[84:87],v[204:207],a[192:195],v[84:87]
M v[116:119],v[204:207],a[196:199],v[116:119]
M v[148:151],v[204:207],a[200:203],v[148:151]
buffer_load_dwordx4 v18,s[24:27],s34 offen offset:2048 lds
M v[180:183],v[204:207],a[204:207],v[180:183]
M v[88:91],v[208:211],a[192:195],v[88:91]
ds_read_b64_tr_b16 v[200:201],v14 offset:8192
M v[120:123],v[208:211],a[196:199],v[120:123]
ds_read_b64_tr_b16 v[202:203],v14 offset:8704
buffer_load_dwordx4 v19,s[24:27],s34 offen offset:3072 lds
s_add_u32 s34,s34,s39
M v[152:155],v[208:211],a[200:203],v[152:155]
ds_read_b64_tr_b16 v[204:205],v15 offset:8192
M v[184:187],v[208:211],a[204:207],v[184:187]
ds_read_b64_tr_b16 v[206:207],v15 offset:8704
s_add_u32 m0,s32,4096
M v[92:95],v[212:215],a[192:195],v[92:95]
buffer_load_dwordx4 v16,s[24:27],s35 offen lds
M v[124:127],v[212:215],a[196:199],v[124:127]
M v[156:159],v[212:215],a[200:203],v[156:159]
M v[188:191],v[212:215],a[204:207],v[188:191]
buffer_load_dwordx4 v17,s[24:27],s35 offen offset:1024 lds
s_waitcnt lgkmcnt(4)
M a[0:3],v[192:195],a[192:195],a[0:3]
ds_read_b64_tr_b16 v[208:209],v12 offset:12288
M a[32:35],v[192:195],a[196:199],a[32:35]
ds_read_b64_tr_b16 v[210:211],v12 offset:12800
M a[64:67],v[192:195],a[200:203],a[64:67]
ds_read_b64_tr_b16 v[212:213],v13 offset:12288
buffer_load_dwordx4 v18,s[24:27],s35 offen offset:2048 lds
M a[96:99],v[192:195],a[204:207],a[96:99]
ds_read_b64_tr_b16 v[214:215],v13 offset:12800
M a[4:7],v[196:199],a[192:195],a[4:7]
M a[36:39],v[196:199],a[196:199],a[36:39]
buffer_load_dwordx4 v19,s[24:27],s35 offen offset:3072 lds
s_add_u32 s35,s35,s39
M a[68:71],v[196:199],a[200:203],a[68:71]
M a[100:103],v[196:199],a[204:207],a[100:103]
s_waitcnt lgkmcnt(4)
M a[8:11],v[200:203],a[192:195],a[8:11]
ds_read_b64_tr_b16 v[192:193],v14 offset:12288
M a[40:43],v[200:203],a[196:199],a[40:43]
ds_read_b64_tr_b16 v[194:195],v14 offset:12800
M a[72:75],v[200:203],a[200:203],a[72:75]
ds_read_b64_tr_b16 v[196:197],v15 offset:12288
M a[104:107],v[200:203],a[204:207],a[104:107]
ds_read_b64_tr_b16 v[198:199],v15 offset:12800
M a[12:15],v[204:207],a[192:195],a[12:15]
M a[44:47],v[204:207],a[196:199],a[44:47]
M a[76:79],v[204:207],a[200:203],a[76:79]
M a[108:111],v[204:207],a[204:207],a[108:111]
s_waitcnt vmcnt(8) lgkmcnt(0)
s_barrier
M a[16:19],v[208:211],a[192:195],a[16:19]
ds_read_b64_tr_b16 v[200:201],v12 offset:32768
M a[48:51],v[208:211],a[196:199],a[48:51]
ds_read_b64_tr_b16 v[202:203],v12 offset:33280
M a[80:83],v[208:211],a[200:203],a[80:83]
ds_read_b64_tr_b16 v[204:205],v13 offset:32768
M a[112:115],v[208:211],a[204:207],a[112:115]
ds_read_b64_tr_b16 v[206:207],v13 offset:33280
M a[20:23],v[212:215],a[192:195],a[20:23]
ds_read_b128 a[208:211],v11 offset:512
M a[52:55],v[212:215],a[196:199],a[52:55]
ds_read_b128 a[212:215],v11 offset:2560
M a[84:87],v[212:215],a[200:203],a[84:87]
ds_read_b128 a[216:219],v11 offset:4608
M a[116:119],v[212:215],a[204:207],a[116:119]
ds_read_b128 a[220:223],v11 offset:6656
M a[24:27],v[192:195],a[192:195],a[24:27]
ds_read_b64_tr_b16 v[208:209],v14 offset:32768
M a[56:59],v[192:195],a[196:199],a[56:59]
ds_read_b64_tr_b16 v[210:211],v14 offset:33280
M a[88:91],v[192:195],a[200:203],a[88:91]
ds_read_b64_tr_b16 v[212:213],v15 offset:32768
M a[120:123],v[192:195],a[204:207],a[120:123]
ds_read_b64_tr_b16 v[214:215],v15 offset:33280
M a[28:31],v[196:199],a[192:195],a[28:31]
M a[60:63],v[196:199],a[196:199],a[60:63]
M a[92:95],v[196:199],a[200:203],a[92:95]
M a[124:127],v[196:199],a[204:207],a[124:127]
s_waitcnt lgkmcnt(4)
M v[64:67],v[200:203],a[208:211],v[64:67]
ds_read_b64_tr_b16 v[192:193],v12 offset:36864
M v[96:99],v[200:203],a[212:215],v[96:99]
ds_read_b64_tr_b16 v[194:195],v12 offset:37376
M v[128:131],v[200:203],a[216:219],v[128:131]
ds_read_b64_tr_b16 v[196:197],v13 offset:36864
M v[160:163],v[200:203],a[220:223],v[160:163]
ds_read_b64_tr_b16 v[198:199],v13 offset:37376
M v[68:71],v[204:207],a[208:211],v[68:71]
M v[100:103],v[204:207],a[212:215],v[100:103]
M v[132:135],v[204:207],a[216:219],v[132:135]
M v[164:167],v[204:207],a[220:223],v[164:167]
s_waitcnt lgkmcnt(4)
M v[72:75],v[208:211],a[208:211],v[72:75]
ds_read_b64_tr_b16 v[200:201],v14 offset:36864
M v[104:107],v[208:211],a[212:215],v[104:107]
ds_read_b64_tr_b16 v[202:203],v14 offset:37376
M v[136:139],v[208:211],a[216:219],v[136:139]
ds_read_b64_tr_b16 v[204:205],v15 offset:36864
M v[168:171],v[208:211],a[220:223],v[168:171]
ds_read_b64_tr_b16 v[206:207],v15 offset:37376
M v[76:79],v[212:215],a[208:211],v[76:79]
M v[108:111],v[212:215],a[212:215],v[108:111]
M v[140:143],v[212:215],a[216:219],v[140:143]
M v[172:175],v[212:215],a[220:223],v[172:175]
s_waitcnt lgkmcnt(0)
s_barrier
M v[80:83],v[192:195],a[208:211],v[80:83]
ds_read_b64_tr_b16 v[208:209],v12 offset:40960
s_mov_b32 m0,s33
M v[112:115],v[192:195],a[212:215],v[112:115]
ds_read_b64_tr_b16 v[210:211],v12 offset:41472
buffer_load_dwordx4 v16,s[24:27],s34 offen lds
M v[144:147],v[192:195],a[216:219],v[144:147]
ds_read_b64_tr_b16 v[212:213],v13 offset:40960
M v[176:179],v[192:195],a[220:223],v[176:179]
ds_read_b64_tr_b16 v[214:215],v13 offset:41472
buffer_load_dwordx4 v17,s[24:27],s34 offen offset:1024 lds
M v[84:87],v[196:199],a[208:211],v[84:87]
M v[116:119],v[196:199],a[212:215],v[116:119]
M v[148:151],v[196:199],a[216:219],v[148:151]
buffer_load_dwordx4 v18,s[24:27],s34 offen offset:2048 lds
M v[180:183],v[196:199],a[220:223],v[180:183]
M v[88:91],v[200:203],a[208:211],v[88:91]
ds_read_b64_tr_b16 v[192:193],v14 offset:40960
M v[120:123],v[200:203],a[212:215],v[120:123]
ds_read_b64_tr_b16 v[194:195],v14 offset:41472
buffer_load_dwordx4 v19,s[24:27],s34 offen offset:3072 lds
s_add_u32 s34,s34,s36
M v[152:155],v[200:203],a[216:219],v[152:155]
ds_read_b64_tr_b16 v[196:197],v15 offset:40960
M v[184:187],v[200:203],a[220:223],v[184:187]
ds_read_b64_tr_b16 v[198:199],v15 offset:41472
s_add_u32 m0,s33,4096
M v[92:95],v[204:207],a[208:211],v[92:95]
buffer_load_dwordx4 v16,s[24:27],s35 offen lds
M v[124:127],v[204:207],a[212:215],v[124:127]
M v[156:159],v[204:207],a[216:219],v[156:159]
M v[188:191],v[204:207],a[220:223],v[188:191]
buffer_load_dwordx4 v17,s[24:27],s35 offen offset:1024 lds
s_waitcnt lgkmcnt(4)
M a[0:3],v[208:211],a[208:211],a[0:3]
ds_read_b64_tr_b16 v[200:201],v12 offset:45056
M a[32:35],v[208:211],a[212:215],a[32:35]
ds_read_b64_tr_b16 v[202:203],v12 offset:45568
M a[64:67],v[208:211],a[216:219],a[64:67]
ds_read_b64_tr_b16 v[204:205],v13 offset:45056
buffer_load_dwordx4 v18,s[24:27],s35 offen offset:2048 lds
M a[96:99],v[208:211],a[220:223],a[96:99]
ds_read_b64_tr_b16 v[206:207],v13 offset:45568
M a[4:7],v[212:215],a[208:211],a[4:7]
M a[36:39],v[212:215],a[212:215],a[36:39]
buffer_load_dwordx4 v19,s[24:27],s35 offen offset:3072 lds
s_add_u32 s35,s35,s36
M a[68:71],v[212:215],a[216:219],a[68:71]
M a[100:103],v[212:215],a[220:223],a[100:103]
s_waitcnt lgkmcnt(4)
M a[8:11],v[192:195],a[208:211],a[8:11]
ds_read_b64_tr_b16 v[208:209],v14 offset:45056
M a[40:43],v[192:195],a[212:215],a[40:43]
ds_read_b64_tr_b16 v[210:211],v14 offset:45568
M a[72:75],v[192:195],a[216:219],a[72:75]
ds_read_b64_tr_b16 v[212:213],v15 offset:45056
M a[104:107],v[192:195],a[220:223],a[104:107]
ds_read_b64_tr_b16 v[214:215],v15 offset:45568
M a[12:15],v[196:199],a[208:211],a[12:15]
M a[44:47],v[196:199],a[212:215],a[44:47]
M a[76:79],v[196:199],a[216:219],a[76:79]
M a[108:111],v[196:199],a[220:223],a[108:111]
s_waitcnt vmcnt(8) lgkmcnt(0)
s_barrier
M a[16:19],v[200:203],a[208:211],a[16:19]
ds_read_b64_tr_b16 v[192:193],v12
M a[48:51],v[200:203],a[212:215],a[48:51]
ds_read_b64_tr_b16 v[194:195],v12 offset:512
M a[80:83],v[200:203],a[216:219],a[80:83]
ds_read_b64_tr_b16 v[196:197],v13
M a[112:115],v[200:203],a[220:223],a[112:115]
ds_read_b64_tr_b16 v[198:199],v13 offset:512
M a[20:23],v[204:207],a[208:211],a[20:23]
ds_read_b128 a[192:195],v11 offset:32768
M a[52:55],v[204:207],a[212:215],a[52:55]
ds_read_b128 a[196:199],v11 offset:34816
M a[84:87],v[204:207],a[216:219],a[84:87]
ds_read_b128 a[200:203],v11 offset:36864
M a[116:119],v[204:207],a[220:223],a[116:119]
ds_read_b128 a[204:207],v11 offset:38912
M a[24:27],v[208:211],a[208:211],a[24:27]
ds_read_b64_tr_b16 v[200:201],v14
M a[56:59],v[208:211],a[212:215],a[56:59]
ds_read_b64_tr_b16 v[202:203],v14 offset:512
M a[88:91],v[208:211],a[216:219],a[88:91]
ds_read_b64_tr_b16 v[204:205],v15
M a[120:123],v[208:211],a[220:223],a[120:123]
ds_read_b64_tr_b16 v[206:207],v15 offset:512
M a[28:31],v[212:215],a[208:211],a[28:31]
M a[60:63],v[212:215],a[212:215],a[60:63]
M a[92:95],v[212:215],a[216:219],a[92:95]
M a[124:127],v[212:215],a[220:223],a[124:127]
s_waitcnt lgkmcnt(4)
M v[64:67],v[192:195],a[192:195],v[64:67]
ds_read_b64_tr_b16 v[208:209],v12 offset:4096
M v[96:99],v[192:195],a[196:199],v[96:99]
ds_read_b64_tr_b16 v[210:211],v12 offset:4608
M v[128:131],v[192:195],a[200:203],v[128:131]
ds_read_b64_tr_b16 v[212:213],v13 offset:4096
M v[160:163],v[192:195],a[204:207],v[160:163]
ds_read_b64_tr_b16 v[214:215],v13 offset:4608
M v[68:71],v[196:199],a[192:195],v[68:71]
M v[100:103],v[196:199],a[196:199],v[100:103]
M v[132:135],v[196:199],a[200:203],v[132:135]
M v[164:167],v[196:199],a[204:207],v[164:167]
s_waitcnt lgkmcnt(4)
M v[72:75],v[200:203],a[192:195],v[72:75]
ds_read_b64_tr_b16 v[192:193],v14 offset:4096
M v[104:107],v[200:203],a[196:199],v[104:107]
ds_read_b64_tr_b16 v[194:195],v14 offset:4608
M v[136:139],v[200:203],a[200:203],v[136:139]
ds_read_b64_tr_b16 v[196:197],v15 offset:4096
M v[168:171],v[200:203],a[204:207],v[168:171]
ds_read_b64_tr_b16 v[198:199],v15 offset:4608
M v[76:79],v[204:207],a[192:195],v[76:79]
M v[108:111],v[204:207],a[196:199],v[108:111]
M v[140:143],v[204:207],a[200:203],v[140:143]
M v[172:175],v[204:207],a[204:207],v[172:175]
s_waitcnt lgkmcnt(0)
s_barrier
M v[80:83],v[208:211],a[192:195],v[80:83]
ds_read_b64_tr_b16 v[200:201],v12 offset:8192
s_mov_b32 m0,s30
M v[112:115],v[208:211],a[196:199],v[112:115]
ds_read_b64_tr_b16 v[202:203],v12 offset:8704
buffer_load_dwordx4 v16,s[24:27],s34 offen lds
M v[144:147],v[208:211],a[200:203],v[144:147]
ds_read_b64_tr_b16 v[204:205],v13 offset:8192
M v[176:179],v[208:211],a[204:207],v[176:179]
ds_read_b64_tr_b16 v[206:207],v13 offset:8704
buffer_load_dwordx4 v17,s[24:27],s34 offen offset:1024 lds
M v[84:87],v[212:215],a[192:195],v[84:87]
M v[116:119],v[212:215],a[196:199],v[116:119]
M v[148:151],v[212:215],a[200:203],v[148:151]
buffer_load_dwordx4 v18,s[24:27],s34 offen offset:2048 lds
M v[180:183],v[212:215],a[204:207],v[180:183]
M v[88:91],v[192:195],a[192:195],v[88:91]
ds_read_b64_tr_b16 v[208:209],v14 offset:8192
M v[120:123],v[192:195],a[196:199],v[120:123]
ds_read_b64_tr_b16 v[210:211],v14 offset:8704
buffer_load_dwordx4 v19,s[24:27],s34 offen offset:3072 lds
s_add_u32 s34,s34,s39
M v[152:155],v[192:195],a[200:203],v[152:155]
ds_read_b64_tr_b16 v[212:213],v15 offset:8192
M v[184:187],v[192:195],a[204:207],v[184:187]
ds_read_b64_tr_b16 v[214:215],v15 offset:8704
s_add_u32 m0,s30,4096
M v[92:95],v[196:199],a[192:195],v[92:95]
buffer_load_dwordx4 v16,s[24:27],s35 offen lds
M v[124:127],v[196:199],a[196:199],v[124:127]
M v[156:159],v[196:199],a[200:203],v[156:159]
M v[188:191],v[196:199],a[204:207],v[188:191]
buffer_load_dwordx4 v17,s[24:27],s35 offen offset:1024 lds
s_waitcnt lgkmcnt(4)
M a[0:3],v[200:203],a[192:195],a[0:3]
ds_read_b64_tr_b16 v[192:193],v12 offset:12288
M a[32:35],v[200:203],a[196:199],a[32:35]
ds_read_b64_tr_b16 v[194:195],v12 offset:12800
M a[64:67],v[200:203],a[200:203],a[64:67]
ds_read_b64_tr_b16 v[196:197],v13 offset:12288
buffer_load_dwordx4 v18,s[24:27],s35 offen offset:2048 lds
M a[96:99],v[200:203],a[204:207],a[96:99]
ds_read_b64_tr_b16 v[198:199],v13 offset:12800
M a[4:7],v[204:207],a[192:195],a[4:7]
M a[36:39],v[204:207],a[196:199],a[36:39]
buffer_load_dwordx4 v19,s[24:27],s35 offen offset:3072 lds
s_add_u32 s35,s35,s39
M a[68:71],v[204:207],a[200:203],a[68:71]
M a[100:103],v[204:207],a[204:207],a[100:103]
s_waitcnt lgkmcnt(4)
M a[8:11],v[208:211],a[192:195],a[8:11]
ds_read_b64_tr_b16 v[200:201],v14 offset:12288
M a[40:43],v[208:211],a[196:199],a[40:43]
ds_read_b64_tr_b16 v[202:203],v14 offset:12800
M a[72:75],v[208:211],a[200:203],a[72:75]
ds_read_b64_tr_b16 v[204:205],v15 offset:12288
M a[104:107],v[208:211],a[204:207],a[104:107]
ds_read_b64_tr_b16 v[206:207],v15 offset:12800
M a[12:15],v[212:215],a[192:195],a[12:15]
M a[44:47],v[212:215],a[196:199],a[44:47]
M a[76:79],v[212:215],a[200:203],a[76:79]
M a[108:111],v[212:215],a[204:207],a[108:111]
s_waitcnt vmcnt(8) lgkmcnt(0)
s_barrier
M a[16:19],v[192:195],a[192:195],a[16:19]
ds_read_b64_tr_b16 v[208:209],v12 offset:32768
M a[48:51],v[192:195],a[196:199],a[48:51]
ds_read_b64_tr_b16 v[210:211],v12 offset:33280
M a[80:83],v[192:195],a[200:203],a[80:83]
ds_read_b64_tr_b16 v[212:213],v13 offset:32768
M a[112:115],v[192:195],a[204:207],a[112:115]
ds_read_b64_tr_b16 v[214:215],v13 offset:33280
M a[20:23],v[196:199],a[192:195],a[20:23]
ds_read_b128 a[208:211],v11 offset:33280
M a[52:55],v[196:199],a[196:199],a[52:55]
ds_read_b128 a[212:215],v11 offset:35328
M a[84:87],v[196:199],a[200:203],a[84:87]
ds_read_b128 a[216:219],v11 offset:37376
M a[116:119],v[196:199],a[204:207],a[116:119]
ds_read_b128 a[220:223],v11 offset:39424
M a[24:27],v[200:203],a[192:195],a[24:27]
ds_read_b64_tr_b16 v[192:193],v14 offset:32768
M a[56:59],v[200:203],a[196:199],a[56:59]
ds_read_b64_tr_b16 v[194:195],v14 offset:33280
M a[88:91],v[200:203],a[200:203],a[88:91]
ds_read_b64_tr_b16 v[196:197],v15 offset:32768
M a[120:123],v[200:203],a[204:207],a[120:123]
ds_read_b64_tr_b16 v[198:199],v15 offset:33280
M a[28:31],v[204:207],a[192:195],a[28:31]
M a[60:63],v[204:207],a[196:199],a[60:63]
M a[92:95],v[204:207],a[200:203],a[92:95]
M a[124:127],v[204:207],a[204:207],a[124:127]
s_waitcnt lgkmcnt(4)
M v[64:67],v[208:211],a[208:211],v[64:67]
ds_read_b64_tr_b16 v[200:201],v12 offset:36864
M v[96:99],v[208:211],a[212:215],v[96:99]
ds_read_b64_tr_b16 v[202:203],v12 offset:37376
M v[128:131],v[208:211],a[216:219],v[128:131]
ds_read_b64_tr_b16 v[204:205],v13 offset:36864
M v[160:163],v[208:211],a[220:223],v[160:163]
ds_read_b64_tr_b16 v[206:207],v13 offset:37376
M v[68:71],v[212:215],a[208:211],v[68:71]
M v[100:103],v[212:215],a[212:215],v[100:103]
M v[132:135],v[212:215],a[216:219],v[132:135]
M v[164:167],v[212:215],a[220:223],v[164:167]
s_waitcnt lgkmcnt(4)
M v[72:75],v[192:195],a[208:211],v[72:75]
ds_read_b64_tr_b16 v[208:209],v14 offset:36864
M v[104:107],v[192:195],a[212:215],v[104:107]
ds_read_b64_tr_b16 v[210:211],v14 offset:37376
M v[136:139],v[192:195],a[216:219],v[136:139]
ds_read_b64_tr_b16 v[212:213],v15 offset:36864
M v[168:171],v[192:195],a[220:223],v[168:171]
ds_read_b64_tr_b16 v[214:215],v15 offset:37376
M v[76:79],v[196:199],a[208:211],v[76:79]
M v[108:111],v[196:199],a[212:215],v[108:111]
M v[140:143],v[196:199],a[216:219],v[140:143]
M v[172:175],v[196:199],a[220:223],v[172:175]
s_waitcnt lgkmcnt(0)
s_barrier
M v[80:83],v[200:203],a[208:211],v[80:83]
ds_read_b64_tr_b16 v[192:193],v12 offset:40960
M v[112:115],v[200:203],a[212:215],v[112:115]
ds_read_b64_tr_b16 v[194:195],v12 offset:41472
s_cmp_eq_u32 s29,1
s_cbranch_scc0 L_cg2
s_mov_b32 m0,s31
s_nop 0
buffer_load_dwordx4 v16,s[24:27],s34 offen lds
buffer_load_dwordx4 v17,s[24:27],s34 offen offset:1024 lds
buffer_load_dwordx4 v18,s[24:27],s34 offen offset:2048 lds
buffer_load_dwordx4 v19,s[24:27],s34 offen offset:3072 lds
s_add_u32 s34,s34,s36
s_add_u32 m0,s31,4096
s_nop 0
buffer_load_dwordx4 v16,s[24:27],s35 offen lds
buffer_load_dwordx4 v17,s[24:27],s35 offen offset:1024 lds
buffer_load_dwordx4 v18,s[24:27],s35 offen offset:2048 lds
buffer_load_dwordx4 v19,s[24:27],s35 offen offset:3072 lds
s_add_u32 s35,s35,s36
L_cg2:
M v[144:147],v[200:203],a[216:219],v[144:147]
ds_read_b64_tr_b16 v[196:197],v13 offset:40960
M v[176:179],v[200:203],a[220:223],v[176:179]
ds_read_b64_tr_b16 v[198:199],v13 offset:41472
M v[84:87],v[204:207],a[208:211],v[84:87]
M v[116:119],v[204:207],a[212:215],v[116:119]
M v[148:151],v[204:207],a[216:219],v[148:151]
M v[180:183],v[204:207],a[220:223],v[180:183]
M v[88:91],v[208:211],a[208:211],v[88:91]
ds_read_b64_tr_b16 v[200:201],v14 offset:40960
M v[120:123],v[208:211],a[212:215],v[120:123]
ds_read_b64_tr_b16 v[202:203],v14 offset:41472
M v[152:155],v[208:211],a[216:219],v[152:155]
ds_read_b64_tr_b16 v[204:205],v15 offset:40960
M v[184:187],v[208:211],a[220:223],v[184:187]
ds_read_b64_tr_b16 v[206:207],v15 offset:41472
M v[92:95],v[212:215],a[208:211],v[92:95]
M v[124:127],v[212:215],a[212:215],v[124:127]
M v[156:159],v[212:215],a[216:219],v[156:159]
M v[188:191],v[212:215],a[220:223],v[188:191]
s_waitcnt lgkmcnt(4)
M a[0:3],v[192:195],a[208:211],a[0:3]
ds_read_b64_tr_b16 v[208:209],v12 offset:45056
M a[32:35],v[192:195],a[212:215],a[32:35]
ds_read_b64_tr_b16 v[210:211],v12 offset:45568
M a[64:67],v[192:195],a[216:219],a[64:67]
ds_read_b64_tr_b16 v[212:213],v13 offset:45056
M a[96:99],v[192:195],a[220:223],a[96:99]
ds_read_b64_tr_b16 v[214:215],v13 offset:45568
M a[4:7],v[196:199],a[208:211],a[4:7]
M a[36:39],v[196:199],a[212:215],a[36:39]
M a[68:71],v[196:199],a[216:219],a[68:71]
M a[100:103],v[196:199],a[220:223],a[100:103]
s_waitcnt lgkmcnt(4)
M a[8:11],v[200:203],a[208:211],a[8:11]
ds_read_b64_tr_b16 v[192:193],v14 offset:45056
M a[40:43],v[200:203],a[212:215],a[40:43]
ds_read_b64_tr_b16 v[194:195],v14 offset:45568
M a[72:75],v[200:203],a[216:219],a[72:75]
ds_read_b64_tr_b16 v[196:197],v15 offset:45056
M a[104:107],v[200:203],a[220:223],a[104:107]
ds_read_b64_tr_b16 v[198:199],v15 offset:45568
M a[12:15],v[204:207],a[208:211],a[12:15]
M a[44:47],v[204:207],a[212:215],a[44:47]
M a[76:79],v[204:207],a[216:219],a[76:79]
M a[108:111],v[204:207],a[220:223],a[108:111]
s_waitcnt vmcnt(0) lgkmcnt(0)
s_barrier
M a[16:19],v[208:211],a[208:211],a[16:19]
ds_read_b64_tr_b16 v[200:201],v12
M a[48:51],v[208:211],a[212:215],a[48:51]
ds_read_b64_tr_b16 v[202:203],v12 offset:512
M a[80:83],v[208:211],a[216:219],a[80:83]
ds_read_b64_tr_b16 v[204:205],v13
M a[112:115],v[208:211],a[220:223],a[112:115]
ds_read_b64_tr_b16 v[206:207],v13 offset:512
M a[20:23],v[212:215],a[208:211],a[20:23]
ds_read_b128 a[192:195],v11
M a[52:55],v[212:215],a[212:215],a[52:55]
ds_read_b128 a[196:199],v11 offset:2048
M a[84:87],v[212:215],a[216:219],a[84:87]
ds_read_b128 a[200:203],v11 offset:4096
M a[116:119],v[212:215],a[220:223],a[116:119]
ds_read_b128 a[204:207],v11 offset:6144
M a[24:27],v[192:195],a[208:211],a[24:27]
ds_read_b64_tr_b16 v[208:209],v14
M a[56:59],v[192:195],a[212:215],a[56:59]
ds_read_b64_tr_b16 v[210:211],v14 offset:512
M a[88:91],v[192:195],a[216:219],a[88:91]
ds_read_b64_tr_b16 v[212:213],v15
M a[120:123],v[192:195],a[220:223],a[120:123]
ds_read_b64_tr_b16 v[214:215],v15 offset:512
M a[28:31],v[196:199],a[208:211],a[28:31]
M a[60:63],v[196:199],a[212:215],a[60:63]
M a[92:95],v[196:199],a[216:219],a[92:95]
M a[124:127],v[196:199],a[220:223],a[124:127]
s_waitcnt lgkmcnt(4)
M v[64:67],v[200:203],a[192:195],v[64:67]
ds_read_b64_tr_b16 v[192:193],v12 offset:4096
M v[96:99],v[200:203],a[196:199],v[96:99]
ds_read_b64_tr_b16 v[194:195],v12 offset:4608
M v[128:131],v[200:203],a[200:203],v[128:131]
ds_read_b64_tr_b16 v[196:197],v13 offset:4096
M v[160:163],v[200:203],a[204:207],v[160:163]
ds_read_b64_tr_b16 v[198:199],v13 offset:4608
M v[68:71],v[204:207],a[192:195],v[68:71]
M v[100:103],v[204:207],a[196:199],v[100:103]
M v[132:135],v[204:207],a[200:203],v[132:135]
M v[164:167],v[204:207],a[204:207],v[164:167]
s_waitcnt lgkmcnt(4)
M v[72:75],v[208:211],a[192:195],v[72:75]
ds_read_b64_tr_b16 v[200:201],v14 offset:4096
M v[104:107],v[208:211],a[196:199],v[104:107]
ds_read_b64_tr_b16 v[202:203],v14 offset:4608
M v[136:139],v[208:211],a[200:203],v[136:139]
ds_read_b64_tr_b16 v[204:205],v15 offset:4096
M v[168:171],v[208:211],a[204:207],v[168:171]
ds_read_b64_tr_b16 v[206:207],v15 offset:4608
M v[76:79],v[212:215],a[192:195],v[76:79]
M v[108:111],v[212:215],a[196:199],v[108:111]
M v[140:143],v[212:215],a[200:203],v[140:143]
M v[172:175],v[212:215],a[204:207],v[172:175]
s_waitcnt lgkmcnt(0)
s_barrier
M v[80:83],v[192:195],a[192:195],v[80:83]
ds_read_b64_tr_b16 v[208:209],v12 offset:8192
M v[112:115],v[192:195],a[196:199],v[112:115]
ds_read_b64_tr_b16 v[210:211],v12 offset:8704
M v[144:147],v[192:195],a[200:203],v[144:147]
ds_read_b64_tr_b16 v[212:213],v13 offset:8192
M v[176:179],v[192:195],a[204:207],v[176:179]
ds_read_b64_tr_b16 v[214:215],v13 offset:8704
M v[84:87],v[196:199],a[192:195],v[84:87]
M v[116:119],v[196:199],a[196:199],v[116:119]
M v[148:151],v[196:199],a[200:203],v[148:151]
M v[180:183],v[196:199],a[204:207],v[180:183]
M v[88:91],v[200:203],a[192:195],v[88:91]
ds_read_b64_tr_b16 v[192:193],v14 offset:8192
M v[120:123],v[200:203],a[196:199],v[120:123]
ds_read_b64_tr_b16 v[194:195],v14 offset:8704
M v[152:155],v[200:203],a[200:203],v[152:155]
ds_read_b64_tr_b16 v[196:197],v15 offset:8192
M v[184:187],v[200:203],a[204:207],v[184:187]
ds_read_b64_tr_b16 v[198:199],v15 offset:8704
M v[92:95],v[204:207],a[192:195],v[92:95]
M v[124:127],v[204:207],a[196:199],v[124:127]
M v[156:159],v[204:207],a[200:203],v[156:159]
M v[188:191],v[204:207],a[204:207],v[188:191]
s_waitcnt lgkmcnt(4)
M a[0:3],v[208:211],a[192:195],a[0:3]
ds_read_b64_tr_b16 v[200:201],v12 offset:12288
M a[32:35],v[208:211],a[196:199],a[32:35]
ds_read_b64_tr_b16 v[202:203],v12 offset:12800
M a[64:67],v[208:211],a[200:203],a[64:67]
ds_read_b64_tr_b16 v[204:205],v13 offset:12288
M a[96:99],v[208:211],a[204:207],a[96:99]
ds_read_b64_tr_b16 v[206:207],v13 offset:12800
M a[4:7],v[212:215],a[192:195],a[4:7]
M a[36:39],v[212:215],a[196:199],a[36:39]
M a[68:71],v[212:215],a[200:203],a[68:71]
M a[100:103],v[212:215],a[204:207],a[100:103]
s_waitcnt lgkmcnt(4)
M a[8:11],v[192:195],a[192:195],a[8:11]
ds_read_b64_tr_b16 v[208:209],v14 offset:12288
M a[40:43],v[192:195],a[196:199],a[40:43]
ds_read_b64_tr_b16 v[210:211],v14 offset:12800
M a[72:75],v[192:195],a[200:203],a[72:75]
ds_read_b64_tr_b16 v[212:213],v15 offset:12288
M a[104:107],v[192:195],a[204:207],a[104:107]
ds_read_b64_tr_b16 v[214:215],v15 offset:12800
M a[12:15],v[196:199],a[192:195],a[12:15]
M a[44:47],v[196:199],a[196:199],a[44:47]
M a[76:79],v[196:199],a[200:203],a[76:79]
M a[108:111],v[196:199],a[204:207],a[108:111]
s_waitcnt vmcnt(0) lgkmcnt(0)
s_barrier
M a[16:19],v[200:203],a[192:195],a[16:19]
ds_read_b64_tr_b16 v[192:193],v12 offset:32768
M a[48:51],v[200:203],a[196:199],a[48:51]
ds_read_b64_tr_b16 v[194:195],v12 offset:33280
M a[80:83],v[200:203],a[200:203],a[80:83]
ds_read_b64_tr_b16 v[196:197],v13 offset:32768
M a[112:115],v[200:203],a[204:207],a[112:115]
ds_read_b64_tr_b16 v[198:199],v13 offset:33280
M a[20:23],v[204:207],a[192:195],a[20:23]
ds_read_b128 a[208:211],v11 offset:512
M a[52:55],v[204:207],a[196:199],a[52:55]
ds_read_b128 a[212:215],v11 offset:2560
M a[84:87],v[204:207],a[200:203],a[84:87]
ds_read_b128 a[216:219],v11 offset:4608
M a[116:119],v[204:207],a[204:207],a[116:119]
ds_read_b128 a[220:223],v11 offset:6656
M a[24:27],v[208:211],a[192:195],a[24:27]
ds_read_b64_tr_b16 v[200:201],v14 offset:32768
M a[56:59],v[208:211],a[196:199],a[56:59]
ds_read_b64_tr_b16 v[202:203],v14 offset:33280
M a[88:91],v[208:211],a[200:203],a[88:91]
ds_read_b64_tr_b16 v[204:205],v15 offset:32768
M a[120:123],v[208:211],a[204:207],a[120:123]
ds_read_b64_tr_b16 v[206:207],v15 offset:33280
M a[28:31],v[212:215],a[192:195],a[28:31]
M a[60:63],v[212:215],a[196:199],a[60:63]
M a[92:95],v[212:215],a[200:203],a[92:95]
M a[124:127],v[212:215],a[204:207],a[124:127]
s_waitcnt lgkmcnt(4)
M v[64:67],v[192:195],a[208:211],v[64:67]
ds_read_b64_tr_b16 v[208:209],v12 offset:36864
M v[96:99],v[192:195],a[212:215],v[96:99]
ds_read_b64_tr_b16 v[210:211],v12 offset:37376
M v[128:131],v[192:195],a[216:219],v[128:131]
ds_read_b64_tr_b16 v[212:213],v13 offset:36864
M v[160:163],v[192:195],a[220:223],v[160:163]
ds_read_b64_tr_b16 v[214:215],v13 offset:37376
M v[68:71],v[196:199],a[208:211],v[68:71]
v_mul_f32 v64,s52,v64
v_mul_f32 v65,s52,v65
M v[100:103],v[196:199],a[212:215],v[100:103]
v_mul_f32 v66,s52,v66
v_mul_f32 v67,s52,v67
M v[132:135],v[196:199],a[216:219],v[132:135]
v_cvt_pk_bf16_f32 v244,v64,v65
v_cvt_pk_bf16_f32 v245,v66,v67
M v[164:167],v[196:199],a[220:223],v[164:167]
s_waitcnt lgkmcnt(4)
v_mul_f32 v68,s52,v68
M v[72:75],v[200:203],a[208:211],v[72:75]
ds_read_b64_tr_b16 v[192:193],v14 offset:36864
v_mul_f32 v69,s52,v69
M v[104:107],v[200:203],a[212:215],v[104:107]
ds_read_b64_tr_b16 v[194:195],v14 offset:37376
v_mul_f32 v70,s52,v70
M v[136:139],v[200:203],a[216:219],v[136:139]
ds_read_b64_tr_b16 v[196:197],v15 offset:36864
v_mul_f32 v71,s52,v71
M v[168:171],v[200:203],a[220:223],v[168:171]
ds_read_b64_tr_b16 v[198:199],v15 offset:37376
v_cvt_pk_bf16_f32 v246,v68,v69
M v[76:79],v[204:207],a[208:211],v[76:79]
v_cvt_pk_bf16_f32 v247,v70,v71
v_accvgpr_write_b32 a128,v244
M v[108:111],v[204:207],a[212:215],v[108:111]
v_accvgpr_write_b32 a129,v245
v_accvgpr_write_b32 a130,v246
M v[140:143],v[204:207],a[216:219],v[140:143]
v_accvgpr_write_b32 a131,v247
v_mul_f32 v96,s52,v96
M v[172:175],v[204:207],a[220:223],v[172:175]
s_waitcnt lgkmcnt(0)
s_barrier
M v[80:83],v[208:211],a[208:211],v[80:83]
ds_read_b64_tr_b16 v[200:201],v12 offset:40960
v_mul_f32 v97,s52,v97
M v[112:115],v[208:211],a[212:215],v[112:115]
ds_read_b64_tr_b16 v[202:203],v12 offset:41472
v_mul_f32 v98,s52,v98
M v[144:147],v[208:211],a[216:219],v[144:147]
ds_read_b64_tr_b16 v[204:205],v13 offset:40960
v_mul_f32 v99,s52,v99
M v[176:179],v[208:211],a[220:223],v[176:179]
ds_read_b64_tr_b16 v[206:207],v13 offset:41472
v_mul_f32 v100,s52,v100
M v[84:87],v[212:215],a[208:211],v[84:87]
v_mul_f32 v101,s52,v101
v_mul_f32 v102,s52,v102
M v[116:119],v[212:215],a[212:215],v[116:119]
v_mul_f32 v103,s52,v103
v_cvt_pk_bf16_f32 v248,v96,v97
M v[148:151],v[212:215],a[216:219],v[148:151]
v_cvt_pk_bf16_f32 v249,v98,v99
v_cvt_pk_bf16_f32 v250,v100,v101
M v[180:183],v[212:215],a[220:223],v[180:183]
v_cvt_pk_bf16_f32 v251,v102,v103
M v[88:91],v[192:195],a[208:211],v[88:91]
ds_read_b64_tr_b16 v[208:209],v14 offset:40960
v_accvgpr_write_b32 a144,v248
M v[120:123],v[192:195],a[212:215],v[120:123]
ds_read_b64_tr_b16 v[210:211],v14 offset:41472
v_accvgpr_write_b32 a145,v249
M v[152:155],v[192:195],a[216:219],v[152:155]
ds_read_b64_tr_b16 v[212:213],v15 offset:40960
v_accvgpr_write_b32 a146,v250
M v[184:187],v[192:195],a[220:223],v[184:187]
ds_read_b64_tr_b16 v[214:215],v15 offset:41472
v_accvgpr_write_b32 a147,v251
M v[92:95],v[196:199],a[208:211],v[92:95]
v_mul_f32 v128,s52,v128
v_mul_f32 v129,s52,v129
M v[124:127],v[196:199],a[212:215],v[124:127]
v_mul_f32 v130,s52,v130
v_mul_f32 v131,s52,v131
M v[156:159],v[196:199],a[216:219],v[156:159]
v_mul_f32 v132,s52,v132
v_mul_f32 v133,s52,v133
M v[188:191],v[196:199],a[220:223],v[188:191]
s_waitcnt lgkmcnt(4)
v_mul_f32 v134,s52,v134
M a[0:3],v[200:203],a[208:211],a[0:3]
ds_read_b64_tr_b16 v[192:193],v12 offset:45056
v_mul_f32 v135,s52,v135
M a[32:35],v[200:203],a[212:215],a[32:35]
ds_read_b64_tr_b16 v[194:195],v12 offset:45568
v_cvt_pk_bf16_f32 v244,v128,v129
M a[64:67],v[200:203],a[216:219],a[64:67]
ds_read_b64_tr_b16 v[196:197],v13 offset:45056
v_cvt_pk_bf16_f32 v245,v130,v131
M a[96:99],v[200:203],a[220:223],a[96:99]
ds_read_b64_tr_b16 v[198:199],v13 offset:45568
v_cvt_pk_bf16_f32 v246,v132,v133
M a[4:7],v[204:207],a[208:211],a[4:7]
v_cvt_pk_bf16_f32 v247,v134,v135
v_accvgpr_write_b32 a160,v244
M a[36:39],v[204:207],a[212:215],a[36:39]
v_accvgpr_write_b32 a161,v245
v_accvgpr_write_b32 a162,v246
M a[68:71],v[204:207],a[216:219],a[68:71]
v_accvgpr_write_b32 a163,v247
v_mul_f32 v160,s52,v160
M a[100:103],v[204:207],a[220:223],a[100:103]
s_waitcnt lgkmcnt(4)
v_mul_f32 v161,s52,v161
M a[8:11],v[208:211],a[208:211],a[8:11]
ds_read_b64_tr_b16 v[200:201],v14 offset:45056
v_mul_f32 v162,s52,v162
M a[40:43],v[208:211],a[212:215],a[40:43]
ds_read_b64_tr_b16 v[202:203],v14 offset:45568
v_mul_f32 v163,s52,v163
M a[72:75],v[208:211],a[216:219],a[72:75]
ds_read_b64_tr_b16 v[204:205],v15 offset:45056
v_mul_f32 v164,s52,v164
M a[104:107],v[208:211],a[220:223],a[104:107]
ds_read_b64_tr_b16 v[206:207],v15 offset:45568
v_mul_f32 v165,s52,v165
M a[12:15],v[212:215],a[208:211],a[12:15]
v_mul_f32 v166,s52,v166
v_mul_f32 v167,s52,v167
M a[44:47],v[212:215],a[212:215],a[44:47]
v_cvt_pk_bf16_f32 v248,v160,v161
v_cvt_pk_bf16_f32 v249,v162,v163
M a[76:79],v[212:215],a[216:219],a[76:79]
v_cvt_pk_bf16_f32 v250,v164,v165
v_cvt_pk_bf16_f32 v251,v166,v167
M a[108:111],v[212:215],a[220:223],a[108:111]
s_waitcnt lgkmcnt(0)
s_barrier
M a[16:19],v[192:195],a[208:211],a[16:19]
ds_read_b128 v[32:35],v8
v_accvgpr_write_b32 a176,v248
M a[48:51],v[192:195],a[212:215],a[48:51]
ds_read_b128 v[36:39],v8 offset:256
v_accvgpr_write_b32 a177,v249
M a[80:83],v[192:195],a[216:219],a[80:83]
ds_read_b128 v[40:43],v8 offset:512
v_accvgpr_write_b32 a178,v250
M a[112:115],v[192:195],a[220:223],a[112:115]
ds_read_b128 v[44:47],v8 offset:768
v_accvgpr_write_b32 a179,v251
M a[20:23],v[196:199],a[208:211],a[20:23]
v_mul_f32 v72,s52,v72
v_mul_f32 v73,s52,v73
M a[52:55],v[196:199],a[212:215],a[52:55]
v_mul_f32 v74,s52,v74
v_mul_f32 v75,s52,v75
M a[84:87],v[196:199],a[216:219],a[84:87]
v_mul_f32 v76,s52,v76
v_mul_f32 v77,s52,v77
M a[116:119],v[196:199],a[220:223],a[116:119]
v_mul_f32 v78,s52,v78
M a[24:27],v[200:203],a[208:211],a[24:27]
v_mul_f32 v79,s52,v79
v_cvt_pk_bf16_f32 v244,v72,v73
M a[56:59],v[200:203],a[212:215],a[56:59]
v_cvt_pk_bf16_f32 v245,v74,v75
v_cvt_pk_bf16_f32 v246,v76,v77
M a[88:91],v[200:203],a[216:219],a[88:91]
v_cvt_pk_bf16_f32 v247,v78,v79
v_accvgpr_write_b32 a132,v244
M a[120:123],v[200:203],a[220:223],a[120:123]
v_accvgpr_write_b32 a133,v245
v_accvgpr_write_b32 a134,v246
M a[28:31],v[204:207],a[208:211],a[28:31]
v_accvgpr_write_b32 a135,v247
v_mul_f32 v104,s52,v104
M a[60:63],v[204:207],a[212:215],a[60:63]
v_mul_f32 v105,s52,v105
v_mul_f32 v106,s52,v106
M a[92:95],v[204:207],a[216:219],a[92:95]
v_mul_f32 v107,s52,v107
v_mul_f32 v108,s52,v108
M a[124:127],v[204:207],a[220:223],a[124:127]
s_waitcnt lgkmcnt(0)
v_mul_f32 v109,s52,v109
M v[64:67],v[32:35],a[128:131],0
ds_read_b128 v[48:51],v8 offset:4096
v_mul_f32 v110,s52,v110
M v[64:67],v[36:39],a[132:135],v[64:67]
v_mul_f32 v111,s52,v111
v_cvt_pk_bf16_f32 v248,v104,v105
v_mul_f32 v136,s52,v136
v_mul_f32 v137,s52,v137
v_cvt_pk_bf16_f32 v244,v136,v137
v_accvgpr_write_b32 a164,v244
v_mul_f32 v80,s52,v80
v_mul_f32 v81,s52,v81
v_cvt_pk_bf16_f32 v244,v80,v81
v_accvgpr_write_b32 a136,v244
v_mul_f32 v138,s52,v138
v_mul_f32 v139,s52,v139
v_cvt_pk_bf16_f32 v245,v138,v139
v_accvgpr_write_b32 a165,v245
v_mul_f32 v82,s52,v82
v_mul_f32 v83,s52,v83
v_cvt_pk_bf16_f32 v245,v82,v83
v_accvgpr_write_b32 a137,v245
v_mul_f32 v140,s52,v140
v_mul_f32 v141,s52,v141
v_cvt_pk_bf16_f32 v246,v140,v141
v_accvgpr_write_b32 a166,v246
v_mul_f32 v84,s52,v84
v_mul_f32 v85,s52,v85
v_cvt_pk_bf16_f32 v246,v84,v85
v_accvgpr_write_b32 a138,v246
v_mul_f32 v142,s52,v142
v_mul_f32 v143,s52,v143
v_cvt_pk_bf16_f32 v247,v142,v143
v_accvgpr_write_b32 a167,v247
v_mul_f32 v86,s52,v86
v_mul_f32 v87,s52,v87
v_cvt_pk_bf16_f32 v247,v86,v87
v_accvgpr_write_b32 a139,v247
s_nop 1
M v[64:67],v[40:43],a[136:139],v[64:67]
ds_read_b128 v[52:55],v8 offset:4352
v_cvt_pk_bf16_f32 v249,v106,v107
v_mul_f32 v144,s52,v144
v_mul_f32 v145,s52,v145
v_cvt_pk_bf16_f32 v244,v144,v145
v_accvgpr_write_b32 a168,v244
v_mul_f32 v88,s52,v88
v_mul_f32 v89,s52,v89
v_cvt_pk_bf16_f32 v244,v88,v89
v_accvgpr_write_b32 a140,v244
v_mul_f32 v146,s52,v146
v_mul_f32 v147,s52,v147
v_cvt_pk_bf16_f32 v245,v146,v147
v_accvgpr_write_b32 a169,v245
v_mul_f32 v90,s52,v90
v_mul_f32 v91,s52,v91
v_cvt_pk_bf16_f32 v245,v90,v91
v_accvgpr_write_b32 a141,v245
v_mul_f32 v148,s52,v148
v_mul_f32 v149,s52,v149
v_cvt_pk_bf16_f32 v246,v148,v149
v_accvgpr_write_b32 a170,v246
v_mul_f32 v92,s52,v92
v_mul_f32 v93,s52,v93
v_cvt_pk_bf16_f32 v246,v92,v93
v_accvgpr_write_b32 a142,v246
v_mul_f32 v150,s52,v150
v_mul_f32 v151,s52,v151
v_cvt_pk_bf16_f32 v247,v150,v151
v_accvgpr_write_b32 a171,v247
v_mul_f32 v94,s52,v94
v_mul_f32 v95,s52,v95
v_cvt_pk_bf16_f32 v247,v94,v95
v_accvgpr_write_b32 a143,v247
s_nop 1
M v[64:67],v[44:47],a[140:143],v[64:67]
v_cvt_pk_bf16_f32 v250,v108,v109
v_cvt_pk_bf16_f32 v251,v110,v111
M v[68:71],v[32:35],a[144:147],0
ds_read_b128 v[56:59],v8 offset:4608
v_accvgpr_write_b32 a148,v248
v_accvgpr_write_b32 a149,v249
v_accvgpr_write_b32 a150,v250
v_accvgpr_write_b32 a151,v251
s_nop 1
M v[68:71],v[36:39],a[148:151],v[68:71]
v_mul_f32 v168,s52,v168
v_mul_f32 v169,s52,v169
v_cvt_pk_bf16_f32 v248,v168,v169
v_accvgpr_write_b32 a180,v248
v_mul_f32 v112,s52,v112
v_mul_f32 v113,s52,v113
v_cvt_pk_bf16_f32 v248,v112,v113
v_accvgpr_write_b32 a152,v248
v_mul_f32 v170,s52,v170
v_mul_f32 v171,s52,v171
v_cvt_pk_bf16_f32 v249,v170,v171
v_accvgpr_write_b32 a181,v249
v_mul_f32 v114,s52,v114
v_mul_f32 v115,s52,v115
v_cvt_pk_bf16_f32 v249,v114,v115
v_accvgpr_write_b32 a153,v249
v_mul_f32 v172,s52,v172
v_mul_f32 v173,s52,v173
v_cvt_pk_bf16_f32 v250,v172,v173
v_accvgpr_write_b32 a182,v250
v_mul_f32 v116,s52,v116
v_mul_f32 v117,s52,v117
v_cvt_pk_bf16_f32 v250,v116,v117
v_accvgpr_write_b32 a154,v250
v_mul_f32 v174,s52,v174
v_mul_f32 v175,s52,v175
v_cvt_pk_bf16_f32 v251,v174,v175
v_accvgpr_write_b32 a183,v251
v_mul_f32 v118,s52,v118
v_mul_f32 v119,s52,v119
v_cvt_pk_bf16_f32 v251,v118,v119
v_accvgpr_write_b32 a155,v251
s_nop 1
M v[68:71],v[40:43],a[152:155],v[68:71]
ds_read_b128 v[60:63],v8 offset:4864
v_mul_f32 v176,s52,v176
v_mul_f32 v177,s52,v177
v_cvt_pk_bf16_f32 v248,v176,v177
v_accvgpr_write_b32 a184,v248
v_mul_f32 v120,s52,v120
v_mul_f32 v121,s52,v121
v_cvt_pk_bf16_f32 v248,v120,v121
v_accvgpr_write_b32 a156,v248
v_mul_f32 v178,s52,v178
v_mul_f32 v179,s52,v179
v_cvt_pk_bf16_f32 v249,v178,v179
v_accvgpr_write_b32 a185,v249
v_mul_f32 v122,s52,v122
v_mul_f32 v123,s52,v123
v_cvt_pk_bf16_f32 v249,v122,v123
v_accvgpr_write_b32 a157,v249
v_mul_f32 v180,s52,v180
v_mul_f32 v181,s52,v181
v_cvt_pk_bf16_f32 v250,v180,v181
v_accvgpr_write_b32 a186,v250
v_mul_f32 v124,s52,v124
v_mul_f32 v125,s52,v125
v_cvt_pk_bf16_f32 v250,v124,v125
v_accvgpr_write_b32 a158,v250
v_mul_f32 v182,s52,v182
v_mul_f32 v183,s52,v183
v_cvt_pk_bf16_f32 v251,v182,v183
v_accvgpr_write_b32 a187,v251
v_mul_f32 v126,s52,v126
v_mul_f32 v127,s52,v127
v_cvt_pk_bf16_f32 v251,v126,v127
v_accvgpr_write_b32 a159,v251
s_nop 1
M v[68:71],v[44:47],a[156:159],v[68:71]
v_exp_f32 v64,v64
M v[72:75],v[32:35],a[160:163],0
v_exp_f32 v65,v65
M v[72:75],v[36:39],a[164:167],v[72:75]
v_exp_f32 v66,v66
M v[72:75],v[40:43],a[168:171],v[72:75]
v_exp_f32 v67,v67
v_mul_f32 v152,s52,v152
v_mul_f32 v153,s52,v153
v_cvt_pk_bf16_f32 v244,v152,v153
v_accvgpr_write_b32 a172,v244
v_mul_f32 v154,s52,v154
v_mul_f32 v155,s52,v155
v_cvt_pk_bf16_f32 v245,v154,v155
v_accvgpr_write_b32 a173,v245
v_mul_f32 v156,s52,v156
v_mul_f32 v157,s52,v157
v_cvt_pk_bf16_f32 v246,v156,v157
v_accvgpr_write_b32 a174,v246
v_mul_f32 v158,s52,v158
v_mul_f32 v159,s52,v159
v_cvt_pk_bf16_f32 v247,v158,v159
v_accvgpr_write_b32 a175,v247
s_nop 1
M v[72:75],v[44:47],a[172:175],v[72:75]
v_exp_f32 v68,v68
M v[76:79],v[32:35],a[176:179],0
v_exp_f32 v69,v69
M v[76:79],v[36:39],a[180:183],v[76:79]
v_exp_f32 v70,v70
M v[76:79],v[40:43],a[184:187],v[76:79]
v_exp_f32 v71,v71
v_mul_f32 v184,s52,v184
v_mul_f32 v185,s52,v185
v_cvt_pk_bf16_f32 v248,v184,v185
v_accvgpr_write_b32 a188,v248
v_mul_f32 v186,s52,v186
v_mul_f32 v187,s52,v187
v_cvt_pk_bf16_f32 v249,v186,v187
v_accvgpr_write_b32 a189,v249
v_mul_f32 v188,s52,v188
v_mul_f32 v189,s52,v189
v_cvt_pk_bf16_f32 v250,v188,v189
v_accvgpr_write_b32 a190,v250
v_mul_f32 v190,s52,v190
v_mul_f32 v191,s52,v191
v_cvt_pk_bf16_f32 v251,v190,v191
v_accvgpr_write_b32 a191,v251
s_nop 1
M v[76:79],v[44:47],a[188:191],v[76:79]
s_waitcnt lgkmcnt(0)
v_mov_b32 v176,0x3f803f80
M v[80:83],v[48:51],a[128:131],0
ds_read_b128 v[32:35],v8 offset:8192
v_mov_b32 v177,0x3f803f80
M v[80:83],v[52:55],a[132:135],v[80:83]
v_exp_f32 v72,v72
M v[80:83],v[56:59],a[136:139],v[80:83]
ds_read_b128 v[36:39],v8 offset:8448
v_mov_b32 v178,0x3f803f80
M v[80:83],v[60:63],a[140:143],v[80:83]
v_exp_f32 v73,v73
M v[84:87],v[48:51],a[144:147],0
ds_read_b128 v[40:43],v8 offset:8704
v_mov_b32 v179,0x3f803f80
M v[84:87],v[52:55],a[148:151],v[84:87]
v_exp_f32 v74,v74
M v[84:87],v[56:59],a[152:155],v[84:87]
ds_read_b128 v[44:47],v8 offset:8960
v_cvt_pk_bf16_f32 v192,v64,v65
M v[84:87],v[60:63],a[156:159],v[84:87]
v_exp_f32 v75,v75
M v[88:91],v[48:51],a[160:163],0
v_exp_f32 v76,v76
M v[88:91],v[52:55],a[164:167],v[88:91]
v_exp_f32 v77,v77
M v[88:91],v[56:59],a[168:171],v[88:91]
v_exp_f32 v78,v78
M v[88:91],v[60:63],a[172:175],v[88:91]
v_exp_f32 v79,v79
M v[92:95],v[48:51],a[176:179],0
v_exp_f32 v80,v80
M v[92:95],v[52:55],a[180:183],v[92:95]
v_exp_f32 v81,v81
M v[92:95],v[56:59],a[184:187],v[92:95]
v_exp_f32 v82,v82
M v[92:95],v[60:63],a[188:191],v[92:95]
s_waitcnt lgkmcnt(0)
v_cvt_pk_bf16_f32 v193,v66,v67
M v[96:99],v[32:35],a[128:131],0
ds_read_b128 v[48:51],v8 offset:12288
v_cvt_pk_bf16_f32 v200,v68,v69
M v[96:99],v[36:39],a[132:135],v[96:99]
v_exp_f32 v83,v83
M v[96:99],v[40:43],a[136:139],v[96:99]
ds_read_b128 v[52:55],v8 offset:12544
v_cvt_pk_bf16_f32 v201,v70,v71
M v[96:99],v[44:47],a[140:143],v[96:99]
v_exp_f32 v84,v84
M v[100:103],v[32:35],a[144:147],0
ds_read_b128 v[56:59],v8 offset:12800
v_cvt_pk_bf16_f32 v208,v72,v73
M v[100:103],v[36:39],a[148:151],v[100:103]
v_exp_f32 v85,v85
M v[100:103],v[40:43],a[152:155],v[100:103]
ds_read_b128 v[60:63],v8 offset:13056
v_cvt_pk_bf16_f32 v209,v74,v75
M v[100:103],v[44:47],a[156:159],v[100:103]
v_exp_f32 v86,v86
M v[104:107],v[32:35],a[160:163],0
v_exp_f32 v87,v87
M v[104:107],v[36:39],a[164:167],v[104:107]
v_exp_f32 v88,v88
M v[104:107],v[40:43],a[168:171],v[104:107]
v_exp_f32 v89,v89
M v[104:107],v[44:47],a[172:175],v[104:107]
v_exp_f32 v90,v90
M v[108:111],v[32:35],a[176:179],0
v_exp_f32 v91,v91
M v[108:111],v[36:39],a[180:183],v[108:111]
v_exp_f32 v92,v92
M v[108:111],v[40:43],a[184:187],v[108:111]
v_exp_f32 v93,v93
M v[108:111],v[44:47],a[188:191],v[108:111]
s_waitcnt lgkmcnt(0)
v_cvt_pk_bf16_f32 v216,v76,v77
M v[112:115],v[48:51],a[128:131],0
ds_read_b128 v[32:35],v8 offset:16384
v_cvt_pk_bf16_f32 v217,v78,v79
M v[112:115],v[52:55],a[132:135],v[112:115]
v_exp_f32 v94,v94
M v[112:115],v[56:59],a[136:139],v[112:115]
ds_read_b128 v[36:39],v8 offset:16640
v_cvt_pk_bf16_f32 v194,v80,v81
M v[112:115],v[60:63],a[140:143],v[112:115]
v_exp_f32 v95,v95
M v[116:119],v[48:51],a[144:147],0
ds_read_b128 v[40:43],v8 offset:16896
v_cvt_pk_bf16_f32 v195,v82,v83
M v[116:119],v[52:55],a[148:151],v[116:119]
v_exp_f32 v96,v96
M v[116:119],v[56:59],a[152:155],v[116:119]
ds_read_b128 v[44:47],v8 offset:17152
v_cvt_pk_bf16_f32 v202,v84,v85
M v[116:119],v[60:63],a[156:159],v[116:119]
v_exp_f32 v97,v97
M v[120:123],v[48:51],a[160:163],0
v_exp_f32 v98,v98
M v[120:123],v[52:55],a[164:167],v[120:123]
v_exp_f32 v99,v99
M v[120:123],v[56:59],a[168:171],v[120:123]
v_exp_f32 v100,v100
M v[120:123],v[60:63],a[172:175],v[120:123]
v_exp_f32 v101,v101
M v[124:127],v[48:51],a[176:179],0
v_exp_f32 v102,v102
M v[124:127],v[52:55],a[180:183],v[124:127]
v_exp_f32 v103,v103
M v[124:127],v[56:59],a[184:187],v[124:127]
v_exp_f32 v104,v104
M v[124:127],v[60:63],a[188:191],v[124:127]
s_waitcnt lgkmcnt(0)
v_cvt_pk_bf16_f32 v203,v86,v87
M v[128:131],v[32:35],a[128:131],0
ds_read_b128 v[48:51],v8 offset:20480
v_cvt_pk_bf16_f32 v210,v88,v89
M v[128:131],v[36:39],a[132:135],v[128:131]
v_exp_f32 v105,v105
M v[128:131],v[40:43],a[136:139],v[128:131]
ds_read_b128 v[52:55],v8 offset:20736
v_cvt_pk_bf16_f32 v211,v90,v91
M v[128:131],v[44:47],a[140:143],v[128:131]
v_exp_f32 v106,v106
M v[132:135],v[32:35],a[144:147],0
ds_read_b128 v[56:59],v8 offset:20992
v_cvt_pk_bf16_f32 v218,v92,v93
M v[132:135],v[36:39],a[148:151],v[132:135]
v_exp_f32 v107,v107
M v[132:135],v[40:43],a[152:155],v[132:135]
ds_read_b128 v[60:63],v8 offset:21248
v_cvt_pk_bf16_f32 v219,v94,v95
M v[132:135],v[44:47],a[156:159],v[132:135]
v_exp_f32 v108,v108
M v[136:139],v[32:35],a[160:163],0
v_exp_f32 v109,v109
M v[136:139],v[36:39],a[164:167],v[136:139]
v_exp_f32 v110,v110
M v[136:139],v[40:43],a[168:171],v[136:139]
v_exp_f32 v111,v111
M v[136:139],v[44:47],a[172:175],v[136:139]
v_exp_f32 v112,v112
M v[140:143],v[32:35],a[176:179],0
v_exp_f32 v113,v113
M v[140:143],v[36:39],a[180:183],v[140:143]
v_exp_f32 v114,v114
M v[140:143],v[40:43],a[184:187],v[140:143]
v_exp_f32 v115,v115
M v[140:143],v[44:47],a[188:191],v[140:143]
s_waitcnt lgkmcnt(0)
v_cvt_pk_bf16_f32 v196,v96,v97
M v[144:147],v[48:51],a[128:131],0
ds_read_b128 v[32:35],v8 offset:24576
v_cvt_pk_bf16_f32 v197,v98,v99
M v[144:147],v[52:55],a[132:135],v[144:147]
v_exp_f32 v116,v116
M v[144:147],v[56:59],a[136:139],v[144:147]
ds_read_b128 v[36:39],v8 offset:24832
v_cvt_pk_bf16_f32 v204,v100,v101
M v[144:147],v[60:63],a[140:143],v[144:147]
v_exp_f32 v117,v117
M v[148:151],v[48:51],a[144:147],0
ds_read_b128 v[40:43],v8 offset:25088
v_cvt_pk_bf16_f32 v205,v102,v103
M v[148:151],v[52:55],a[148:151],v[148:151]
v_exp_f32 v118,v118
M v[148:151],v[56:59],a[152:155],v[148:151]
ds_read_b128 v[44:47],v8 offset:25344
v_cvt_pk_bf16_f32 v212,v104,v105
M v[148:151],v[60:63],a[156:159],v[148:151]
v_exp_f32 v119,v119
M v[152:155],v[48:51],a[160:163],0
v_exp_f32 v120,v120
M v[152:155],v[52:55],a[164:167],v[152:155]
v_exp_f32 v121,v121
M v[152:155],v[56:59],a[168:171],v[152:155]
v_exp_f32 v122,v122
M v[152:155],v[60:63],a[172:175],v[152:155]
v_exp_f32 v123,v123
M v[156:159],v[48:51],a[176:179],0
v_exp_f32 v124,v124
M v[156:159],v[52:55],a[180:183],v[156:159]
v_exp_f32 v125,v125
M v[156:159],v[56:59],a[184:187],v[156:159]
v_exp_f32 v126,v126
M v[156:159],v[60:63],a[188:191],v[156:159]
s_waitcnt lgkmcnt(0)
v_cvt_pk_bf16_f32 v213,v106,v107
M v[64:67],v[32:35],a[128:131],0
ds_read_b128 v[48:51],v8 offset:28672
v_cvt_pk_bf16_f32 v220,v108,v109
M v[64:67],v[36:39],a[132:135],v[64:67]
v_exp_f32 v127,v127
M v[64:67],v[40:43],a[136:139],v[64:67]
ds_read_b128 v[52:55],v8 offset:28928
v_cvt_pk_bf16_f32 v221,v110,v111
M v[64:67],v[44:47],a[140:143],v[64:67]
v_cvt_pk_bf16_f32 v198,v112,v113
v_cvt_pk_bf16_f32 v199,v114,v115
M v[68:71],v[32:35],a[144:147],0
ds_read_b128 v[56:59],v8 offset:29184
v_cvt_pk_bf16_f32 v206,v116,v117
M v[68:71],v[36:39],a[148:151],v[68:71]
v_cvt_pk_bf16_f32 v207,v118,v119
v_cvt_pk_bf16_f32 v214,v120,v121
M v[68:71],v[40:43],a[152:155],v[68:71]
ds_read_b128 v[60:63],v8 offset:29440
v_cvt_pk_bf16_f32 v215,v122,v123
M v[68:71],v[44:47],a[156:159],v[68:71]
v_cvt_pk_bf16_f32 v222,v124,v125
v_cvt_pk_bf16_f32 v223,v126,v127
M v[72:75],v[32:35],a[160:163],0
v_accvgpr_read_b32 v11,a0
v_accvgpr_read_b32 v21,a1
M v[72:75],v[36:39],a[164:167],v[72:75]
v_accvgpr_read_b32 v22,a2
v_accvgpr_read_b32 v23,a3
M v[72:75],v[40:43],a[168:171],v[72:75]
v_accvgpr_read_b32 v24,a4
v_accvgpr_read_b32 v25,a5
M v[72:75],v[44:47],a[172:175],v[72:75]
v_accvgpr_read_b32 v26,a6
v_accvgpr_read_b32 v27,a7
M v[76:79],v[32:35],a[176:179],0
v_mul_f32 v11,s52,v11
v_mul_f32 v21,s52,v21
M v[76:79],v[36:39],a[180:183],v[76:79]
v_mul_f32 v22,s52,v22
v_mul_f32 v23,s52,v23
M v[76:79],v[40:43],a[184:187],v[76:79]
v_mul_f32 v24,s52,v24
v_mul_f32 v25,s52,v25
M v[76:79],v[44:47],a[188:191],v[76:79]
s_waitcnt lgkmcnt(0)
s_barrier
M v[80:83],v[48:51],a[128:131],0
ds_read_b128 v[32:35],v8 offset:32768
v_mul_f32 v26,s52,v26
M v[80:83],v[52:55],a[132:135],v[80:83]
v_mul_f32 v27,s52,v27
v_cvt_pk_bf16_f32 v12,v11,v21
M v[80:83],v[56:59],a[136:139],v[80:83]
ds_read_b128 v[36:39],v8 offset:33024
v_cvt_pk_bf16_f32 v13,v22,v23
M v[80:83],v[60:63],a[140:143],v[80:83]
v_cvt_pk_bf16_f32 v14,v24,v25
v_cvt_pk_bf16_f32 v15,v26,v27
M v[84:87],v[48:51],a[144:147],0
ds_read_b128 v[40:43],v8 offset:33280
v_accvgpr_write_b32 a192,v12
M v[84:87],v[52:55],a[148:151],v[84:87]
v_accvgpr_write_b32 a193,v13
v_accvgpr_write_b32 a194,v14
M v[84:87],v[56:59],a[152:155],v[84:87]
ds_read_b128 v[44:47],v8 offset:33536
v_accvgpr_write_b32 a195,v15
M v[84:87],v[60:63],a[156:159],v[84:87]
v_accvgpr_read_b32 v11,a32
v_accvgpr_read_b32 v21,a33
M v[88:91],v[48:51],a[160:163],0
v_accvgpr_read_b32 v22,a34
v_accvgpr_read_b32 v23,a35
M v[88:91],v[52:55],a[164:167],v[88:91]
v_accvgpr_read_b32 v24,a36
v_accvgpr_read_b32 v25,a37
M v[88:91],v[56:59],a[168:171],v[88:91]
v_accvgpr_read_b32 v26,a38
v_accvgpr_read_b32 v27,a39
M v[88:91],v[60:63],a[172:175],v[88:91]
v_mul_f32 v11,s52,v11
v_mul_f32 v21,s52,v21
M v[92:95],v[48:51],a[176:179],0
v_mul_f32 v22,s52,v22
v_mul_f32 v23,s52,v23
M v[92:95],v[52:55],a[180:183],v[92:95]
v_mul_f32 v24,s52,v24
v_mul_f32 v25,s52,v25
M v[92:95],v[56:59],a[184:187],v[92:95]
v_mul_f32 v26,s52,v26
v_mul_f32 v27,s52,v27
M v[92:95],v[60:63],a[188:191],v[92:95]
s_waitcnt lgkmcnt(0)
v_cvt_pk_bf16_f32 v12,v11,v21
M v[96:99],v[32:35],a[128:131],0
ds_read_b64_tr_b16 v[48:49],v9
v_cvt_pk_bf16_f32 v13,v22,v23
M v[96:99],v[36:39],a[132:135],v[96:99]
ds_read_b64_tr_b16 v[50:51],v9 offset:4096
v_cvt_pk_bf16_f32 v14,v24,v25
M v[96:99],v[40:43],a[136:139],v[96:99]
ds_read_b64_tr_b16 v[52:53],v9 offset:8192
v_cvt_pk_bf16_f32 v15,v26,v27
M v[96:99],v[44:47],a[140:143],v[96:99]
ds_read_b64_tr_b16 v[54:55],v9 offset:12288
v_accvgpr_write_b32 a208,v12
M v[100:103],v[32:35],a[144:147],0
ds_read_b64_tr_b16 v[56:57],v10
v_accvgpr_write_b32 a209,v13
M v[100:103],v[36:39],a[148:151],v[100:103]
ds_read_b64_tr_b16 v[58:59],v10 offset:4096
v_accvgpr_write_b32 a210,v14
M v[100:103],v[40:43],a[152:155],v[100:103]
ds_read_b64_tr_b16 v[60:61],v10 offset:8192
v_accvgpr_write_b32 a211,v15
M v[100:103],v[44:47],a[156:159],v[100:103]
ds_read_b64_tr_b16 v[62:63],v10 offset:12288
v_accvgpr_read_b32 v11,a64
M v[104:107],v[32:35],a[160:163],0
v_accvgpr_read_b32 v21,a65
v_accvgpr_read_b32 v22,a66
M v[104:107],v[36:39],a[164:167],v[104:107]
v_accvgpr_read_b32 v23,a67
v_accvgpr_read_b32 v24,a68
M v[104:107],v[40:43],a[168:171],v[104:107]
v_accvgpr_read_b32 v25,a69
v_accvgpr_read_b32 v26,a70
M v[104:107],v[44:47],a[172:175],v[104:107]
v_accvgpr_read_b32 v27,a71
v_mul_f32 v11,s52,v11
M v[108:111],v[32:35],a[176:179],0
v_mul_f32 v21,s52,v21
v_mul_f32 v22,s52,v22
M v[108:111],v[36:39],a[180:183],v[108:111]
v_mul_f32 v23,s52,v23
v_mul_f32 v24,s52,v24
M v[108:111],v[40:43],a[184:187],v[108:111]
v_mul_f32 v25,s52,v25
v_mul_f32 v26,s52,v26
M v[108:111],v[44:47],a[188:191],v[108:111]
s_waitcnt lgkmcnt(0)
v_mul_f32 v27,s52,v27
M a[0:3],v[48:51],v[192:195],0
ds_read_b128 v[32:35],v8 offset:36864
v_cvt_pk_bf16_f32 v12,v11,v21
M a[0:3],v[52:55],v[196:199],a[0:3]
v_cvt_pk_bf16_f32 v13,v22,v23
v_cvt_pk_bf16_f32 v14,v24,v25
M a[32:35],v[48:51],v[200:203],0
ds_read_b128 v[36:39],v8 offset:37120
v_cvt_pk_bf16_f32 v15,v26,v27
M a[32:35],v[52:55],v[204:207],a[32:35]
v_accvgpr_write_b32 a224,v12
v_accvgpr_write_b32 a225,v13
M a[64:67],v[48:51],v[208:211],0
ds_read_b128 v[40:43],v8 offset:37376
v_accvgpr_write_b32 a226,v14
M a[64:67],v[52:55],v[212:215],a[64:67]
v_accvgpr_write_b32 a227,v15
v_accvgpr_read_b32 v11,a96
v_accvgpr_read_b32 v21,a97
v_accvgpr_read_b32 v22,a98
v_accvgpr_read_b32 v23,a99
M a[96:99],v[48:51],v[216:219],0
ds_read_b128 v[44:47],v8 offset:37632
v_accvgpr_read_b32 v24,a100
M a[96:99],v[52:55],v[220:223],a[96:99]
v_accvgpr_read_b32 v25,a101
v_accvgpr_read_b32 v26,a102
M a[4:7],v[56:59],v[192:195],0
v_accvgpr_read_b32 v27,a103
v_mul_f32 v11,s52,v11
M a[4:7],v[60:63],v[196:199],a[4:7]
v_mul_f32 v21,s52,v21
v_mul_f32 v22,s52,v22
M a[36:39],v[56:59],v[200:203],0
v_mul_f32 v23,s52,v23
v_mul_f32 v24,s52,v24
M a[36:39],v[60:63],v[204:207],a[36:39]
v_mul_f32 v25,s52,v25
v_mul_f32 v26,s52,v26
M a[68:71],v[56:59],v[208:211],0
v_mul_f32 v27,s52,v27
v_cvt_pk_bf16_f32 v12,v11,v21
M a[68:71],v[60:63],v[212:215],a[68:71]
v_cvt_pk_bf16_f32 v13,v22,v23
v_cvt_pk_bf16_f32 v14,v24,v25
M a[100:103],v[56:59],v[216:219],0
v_cvt_pk_bf16_f32 v15,v26,v27
v_accvgpr_write_b32 a240,v12
M a[100:103],v[60:63],v[220:223],a[100:103]
v_accvgpr_write_b32 a241,v13
v_accvgpr_write_b32 a242,v14
M v[160:163],v[176:179],v[192:195],0
v_accvgpr_write_b32 a243,v15
v_accvgpr_read_b32 v11,a8
M v[160:163],v[176:179],v[196:199],v[160:163]
s_waitcnt lgkmcnt(0)
v_accvgpr_read_b32 v21,a9
M v[112:115],v[32:35],a[128:131],0
ds_read_b64_tr_b16 v[48:49],v9 offset:256
v_accvgpr_read_b32 v22,a10
M v[112:115],v[36:39],a[132:135],v[112:115]
ds_read_b64_tr_b16 v[50:51],v9 offset:4352
v_accvgpr_read_b32 v23,a11
M v[112:115],v[40:43],a[136:139],v[112:115]
ds_read_b64_tr_b16 v[52:53],v9 offset:8448
v_accvgpr_read_b32 v24,a12
M v[112:115],v[44:47],a[140:143],v[112:115]
ds_read_b64_tr_b16 v[54:55],v9 offset:12544
v_accvgpr_read_b32 v25,a13
M v[116:119],v[32:35],a[144:147],0
ds_read_b64_tr_b16 v[56:57],v10 offset:256
v_accvgpr_read_b32 v26,a14
M v[116:119],v[36:39],a[148:151],v[116:119]
ds_read_b64_tr_b16 v[58:59],v10 offset:4352
v_accvgpr_read_b32 v27,a15
M v[116:119],v[40:43],a[152:155],v[116:119]
ds_read_b64_tr_b16 v[60:61],v10 offset:8448
v_mul_f32 v11,s52,v11
M v[116:119],v[44:47],a[156:159],v[116:119]
ds_read_b64_tr_b16 v[62:63],v10 offset:12544
v_mul_f32 v21,s52,v21
M v[120:123],v[32:35],a[160:163],0
v_mul_f32 v22,s52,v22
v_mul_f32 v23,s52,v23
M v[120:123],v[36:39],a[164:167],v[120:123]
v_mul_f32 v24,s52,v24
v_mul_f32 v25,s52,v25
M v[120:123],v[40:43],a[168:171],v[120:123]
v_mul_f32 v26,s52,v26
v_mul_f32 v27,s52,v27
M v[120:123],v[44:47],a[172:175],v[120:123]
v_cvt_pk_bf16_f32 v12,v11,v21
v_cvt_pk_bf16_f32 v13,v22,v23
M v[124:127],v[32:35],a[176:179],0
v_cvt_pk_bf16_f32 v14,v24,v25
v_cvt_pk_bf16_f32 v15,v26,v27
M v[124:127],v[36:39],a[180:183],v[124:127]
v_accvgpr_write_b32 a196,v12
v_accvgpr_write_b32 a197,v13
M v[124:127],v[40:43],a[184:187],v[124:127]
v_accvgpr_write_b32 a198,v14
v_accvgpr_write_b32 a199,v15
M v[124:127],v[44:47],a[188:191],v[124:127]
s_waitcnt lgkmcnt(0)
v_accvgpr_read_b32 v11,a40
M a[8:11],v[48:51],v[192:195],0
ds_read_b128 v[32:35],v8 offset:40960
v_accvgpr_read_b32 v21,a41
M a[8:11],v[52:55],v[196:199],a[8:11]
v_accvgpr_read_b32 v22,a42
v_accvgpr_read_b32 v23,a43
M a[40:43],v[48:51],v[200:203],0
ds_read_b128 v[36:39],v8 offset:41216
v_accvgpr_read_b32 v24,a44
M a[40:43],v[52:55],v[204:207],a[40:43]
v_accvgpr_read_b32 v25,a45
v_accvgpr_read_b32 v26,a46
v_mul_f32 v11,s52,v11
v_mul_f32 v21,s52,v21
v_cvt_pk_bf16_f32 v12,v11,v21
v_accvgpr_read_b32 v11,a72
v_accvgpr_read_b32 v21,a73
v_mul_f32 v22,s52,v22
v_mul_f32 v23,s52,v23
v_cvt_pk_bf16_f32 v13,v22,v23
v_accvgpr_read_b32 v22,a74
v_accvgpr_read_b32 v23,a75
M a[72:75],v[48:51],v[208:211],0
ds_read_b128 v[40:43],v8 offset:41472
v_accvgpr_read_b32 v27,a47
M a[72:75],v[52:55],v[212:215],a[72:75]
v_mul_f32 v24,s52,v24
v_mul_f32 v25,s52,v25
v_mul_f32 v11,s52,v11
v_accvgpr_write_b32 a212,v12
v_mul_f32 v21,s52,v21
v_cvt_pk_bf16_f32 v12,v11,v21
v_accvgpr_read_b32 v11,a104
v_accvgpr_read_b32 v21,a105
v_mul_f32 v22,s52,v22
v_accvgpr_write_b32 a213,v13
v_mul_f32 v23,s52,v23
v_cvt_pk_bf16_f32 v13,v22,v23
v_accvgpr_read_b32 v22,a106
v_accvgpr_read_b32 v23,a107
M a[104:107],v[48:51],v[216:219],0
ds_read_b128 v[44:47],v8 offset:41728
v_mul_f32 v26,s52,v26
M a[104:107],v[52:55],v[220:223],a[104:107]
v_mul_f32 v27,s52,v27
v_cvt_pk_bf16_f32 v14,v24,v25
M a[12:15],v[56:59],v[192:195],0
v_cvt_pk_bf16_f32 v15,v26,v27
v_accvgpr_write_b32 a214,v14
M a[12:15],v[60:63],v[196:199],a[12:15]
v_accvgpr_write_b32 a215,v15
v_accvgpr_read_b32 v24,a76
M a[44:47],v[56:59],v[200:203],0
v_accvgpr_read_b32 v25,a77
v_accvgpr_read_b32 v26,a78
M a[44:47],v[60:63],v[204:207],a[44:47]
v_accvgpr_read_b32 v27,a79
v_mul_f32 v24,s52,v24
M a[76:79],v[56:59],v[208:211],0
v_mul_f32 v25,s52,v25
v_mul_f32 v26,s52,v26
M a[76:79],v[60:63],v[212:215],a[76:79]
v_mul_f32 v27,s52,v27
v_cvt_pk_bf16_f32 v14,v24,v25
v_accvgpr_read_b32 v24,a108
v_accvgpr_read_b32 v25,a109
v_cvt_pk_bf16_f32 v15,v26,v27
v_accvgpr_read_b32 v26,a110
v_accvgpr_read_b32 v27,a111
M a[108:111],v[56:59],v[216:219],0
v_accvgpr_write_b32 a228,v12
v_accvgpr_write_b32 a229,v13
M a[108:111],v[60:63],v[220:223],a[108:111]
v_accvgpr_write_b32 a230,v14
v_accvgpr_write_b32 a231,v15
M v[164:167],v[176:179],v[200:203],0
v_mul_f32 v11,s52,v11
v_mul_f32 v21,s52,v21
M v[164:167],v[176:179],v[204:207],v[164:167]
s_waitcnt lgkmcnt(0)
v_mul_f32 v22,s52,v22
v_exp_f32 v128,v128
v_exp_f32 v129,v129
v_exp_f32 v130,v130
v_exp_f32 v131,v131
v_cvt_pk_bf16_f32 v224,v128,v129
v_cvt_pk_bf16_f32 v225,v130,v131
M v[128:131],v[32:35],a[128:131],0
ds_read_b64_tr_b16 v[48:49],v9 offset:512
v_mul_f32 v23,s52,v23
M v[128:131],v[36:39],a[132:135],v[128:131]
ds_read_b64_tr_b16 v[50:51],v9 offset:4608
v_mul_f32 v24,s52,v24
M v[128:131],v[40:43],a[136:139],v[128:131]
ds_read_b64_tr_b16 v[52:53],v9 offset:8704
v_mul_f32 v25,s52,v25
M v[128:131],v[44:47],a[140:143],v[128:131]
ds_read_b64_tr_b16 v[54:55],v9 offset:12800
v_mul_f32 v26,s52,v26
v_exp_f32 v132,v132
v_exp_f32 v133,v133
v_exp_f32 v134,v134
v_exp_f32 v135,v135
v_cvt_pk_bf16_f32 v232,v132,v133
v_cvt_pk_bf16_f32 v233,v134,v135
M v[132:135],v[32:35],a[144:147],0
ds_read_b64_tr_b16 v[56:57],v10 offset:512
v_mul_f32 v27,s52,v27
M v[132:135],v[36:39],a[148:151],v[132:135]
ds_read_b64_tr_b16 v[58:59],v10 offset:4608
v_cvt_pk_bf16_f32 v12,v11,v21
M v[132:135],v[40:43],a[152:155],v[132:135]
ds_read_b64_tr_b16 v[60:61],v10 offset:8704
v_cvt_pk_bf16_f32 v13,v22,v23
M v[132:135],v[44:47],a[156:159],v[132:135]
ds_read_b64_tr_b16 v[62:63],v10 offset:12800
v_cvt_pk_bf16_f32 v14,v24,v25
v_exp_f32 v136,v136
v_exp_f32 v137,v137
v_exp_f32 v138,v138
v_exp_f32 v139,v139
v_cvt_pk_bf16_f32 v240,v136,v137
v_cvt_pk_bf16_f32 v241,v138,v139
M v[136:139],v[32:35],a[160:163],0
v_cvt_pk_bf16_f32 v15,v26,v27
v_accvgpr_write_b32 a244,v12
M v[136:139],v[36:39],a[164:167],v[136:139]
v_accvgpr_write_b32 a245,v13
v_accvgpr_write_b32 a246,v14
M v[136:139],v[40:43],a[168:171],v[136:139]
v_accvgpr_write_b32 a247,v15
v_accvgpr_read_b32 v11,a16
M v[136:139],v[44:47],a[172:175],v[136:139]
v_accvgpr_read_b32 v21,a17
v_accvgpr_read_b32 v22,a18
v_exp_f32 v140,v140
v_exp_f32 v141,v141
v_exp_f32 v142,v142
v_exp_f32 v143,v143
v_cvt_pk_bf16_f32 v248,v140,v141
v_cvt_pk_bf16_f32 v249,v142,v143
M v[140:143],v[32:35],a[176:179],0
v_accvgpr_read_b32 v23,a19
v_accvgpr_read_b32 v24,a20
M v[140:143],v[36:39],a[180:183],v[140:143]
v_accvgpr_read_b32 v25,a21
v_accvgpr_read_b32 v26,a22
M v[140:143],v[40:43],a[184:187],v[140:143]
v_accvgpr_read_b32 v27,a23
v_mul_f32 v11,s52,v11
M v[140:143],v[44:47],a[188:191],v[140:143]
s_waitcnt lgkmcnt(0)
v_mul_f32 v21,s52,v21
M a[16:19],v[48:51],v[192:195],0
ds_read_b128 v[32:35],v8 offset:45056
v_mul_f32 v22,s52,v22
M a[16:19],v[52:55],v[196:199],a[16:19]
v_mul_f32 v23,s52,v23
v_mul_f32 v24,s52,v24
v_cvt_pk_bf16_f32 v12,v11,v21
v_accvgpr_read_b32 v11,a48
v_accvgpr_read_b32 v21,a49
v_cvt_pk_bf16_f32 v13,v22,v23
v_accvgpr_read_b32 v22,a50
v_accvgpr_read_b32 v23,a51
M a[48:51],v[48:51],v[200:203],0
ds_read_b128 v[36:39],v8 offset:45312
v_mul_f32 v25,s52,v25
M a[48:51],v[52:55],v[204:207],a[48:51]
v_mul_f32 v26,s52,v26
v_mul_f32 v27,s52,v27
v_mul_f32 v11,s52,v11
v_accvgpr_write_b32 a200,v12
v_mul_f32 v21,s52,v21
v_cvt_pk_bf16_f32 v12,v11,v21
v_accvgpr_read_b32 v11,a80
v_accvgpr_read_b32 v21,a81
v_mul_f32 v22,s52,v22
v_accvgpr_write_b32 a201,v13
v_mul_f32 v23,s52,v23
v_cvt_pk_bf16_f32 v13,v22,v23
v_accvgpr_read_b32 v22,a82
v_accvgpr_read_b32 v23,a83
M a[80:83],v[48:51],v[208:211],0
ds_read_b128 v[40:43],v8 offset:45568
v_cvt_pk_bf16_f32 v14,v24,v25
M a[80:83],v[52:55],v[212:215],a[80:83]
v_cvt_pk_bf16_f32 v15,v26,v27
v_accvgpr_write_b32 a202,v14
v_mul_f32 v11,s52,v11
v_accvgpr_write_b32 a216,v12
v_mul_f32 v21,s52,v21
v_cvt_pk_bf16_f32 v12,v11,v21
v_accvgpr_read_b32 v11,a112
v_accvgpr_read_b32 v21,a113
v_mul_f32 v22,s52,v22
v_accvgpr_write_b32 a217,v13
v_mul_f32 v23,s52,v23
v_cvt_pk_bf16_f32 v13,v22,v23
v_accvgpr_read_b32 v22,a114
v_accvgpr_read_b32 v23,a115
M a[112:115],v[48:51],v[216:219],0
ds_read_b128 v[44:47],v8 offset:45824
v_accvgpr_write_b32 a203,v15
M a[112:115],v[52:55],v[220:223],a[112:115]
v_accvgpr_read_b32 v24,a52
v_accvgpr_read_b32 v25,a53
M a[20:23],v[56:59],v[192:195],0
v_accvgpr_read_b32 v26,a54
v_accvgpr_read_b32 v27,a55
M a[20:23],v[60:63],v[196:199],a[20:23]
v_mul_f32 v24,s52,v24
v_mul_f32 v25,s52,v25
M a[52:55],v[56:59],v[200:203],0
v_mul_f32 v26,s52,v26
v_mul_f32 v27,s52,v27
M a[52:55],v[60:63],v[204:207],a[52:55]
v_cvt_pk_bf16_f32 v14,v24,v25
v_cvt_pk_bf16_f32 v15,v26,v27
v_accvgpr_read_b32 v24,a84
v_accvgpr_read_b32 v25,a85
v_accvgpr_read_b32 v26,a86
v_accvgpr_read_b32 v27,a87
M a[84:87],v[56:59],v[208:211],0
v_accvgpr_write_b32 a218,v14
v_accvgpr_write_b32 a219,v15
M a[84:87],v[60:63],v[212:215],a[84:87]
v_mul_f32 v24,s52,v24
v_mul_f32 v25,s52,v25
v_cvt_pk_bf16_f32 v14,v24,v25
v_accvgpr_read_b32 v24,a116
v_accvgpr_read_b32 v25,a117
v_mul_f32 v26,s52,v26
v_mul_f32 v27,s52,v27
v_cvt_pk_bf16_f32 v15,v26,v27
v_accvgpr_read_b32 v26,a118
v_accvgpr_read_b32 v27,a119
M a[116:119],v[56:59],v[216:219],0
v_accvgpr_write_b32 a232,v12
v_accvgpr_write_b32 a233,v13
M a[116:119],v[60:63],v[220:223],a[116:119]
v_accvgpr_write_b32 a234,v14
v_accvgpr_write_b32 a235,v15
M v[168:171],v[176:179],v[208:211],0
v_mul_f32 v11,s52,v11
v_mul_f32 v21,s52,v21
M v[168:171],v[176:179],v[212:215],v[168:171]
s_waitcnt lgkmcnt(0)
v_mul_f32 v22,s52,v22
v_exp_f32 v144,v144
v_exp_f32 v145,v145
v_exp_f32 v146,v146
v_exp_f32 v147,v147
v_cvt_pk_bf16_f32 v226,v144,v145
v_cvt_pk_bf16_f32 v227,v146,v147
M v[144:147],v[32:35],a[128:131],0
ds_read_b64_tr_b16 v[48:49],v9 offset:768
v_mul_f32 v23,s52,v23
M v[144:147],v[36:39],a[132:135],v[144:147]
ds_read_b64_tr_b16 v[50:51],v9 offset:4864
v_mul_f32 v24,s52,v24
M v[144:147],v[40:43],a[136:139],v[144:147]
ds_read_b64_tr_b16 v[52:53],v9 offset:8960
v_mul_f32 v25,s52,v25
M v[144:147],v[44:47],a[140:143],v[144:147]
ds_read_b64_tr_b16 v[54:55],v9 offset:13056
v_mul_f32 v26,s52,v26
v_exp_f32 v148,v148
v_exp_f32 v149,v149
v_exp_f32 v150,v150
v_exp_f32 v151,v151
v_cvt_pk_bf16_f32 v234,v148,v149
v_cvt_pk_bf16_f32 v235,v150,v151
M v[148:151],v[32:35],a[144:147],0
ds_read_b64_tr_b16 v[56:57],v10 offset:768
v_mul_f32 v27,s52,v27
M v[148:151],v[36:39],a[148:151],v[148:151]
ds_read_b64_tr_b16 v[58:59],v10 offset:4864
v_cvt_pk_bf16_f32 v12,v11,v21
M v[148:151],v[40:43],a[152:155],v[148:151]
ds_read_b64_tr_b16 v[60:61],v10 offset:8960
v_cvt_pk_bf16_f32 v13,v22,v23
M v[148:151],v[44:47],a[156:159],v[148:151]
ds_read_b64_tr_b16 v[62:63],v10 offset:13056
v_cvt_pk_bf16_f32 v14,v24,v25
v_exp_f32 v152,v152
v_exp_f32 v153,v153
v_exp_f32 v154,v154
v_exp_f32 v155,v155
v_cvt_pk_bf16_f32 v242,v152,v153
v_cvt_pk_bf16_f32 v243,v154,v155
M v[152:155],v[32:35],a[160:163],0
v_cvt_pk_bf16_f32 v15,v26,v27
v_accvgpr_write_b32 a248,v12
M v[152:155],v[36:39],a[164:167],v[152:155]
v_accvgpr_write_b32 a249,v13
v_accvgpr_write_b32 a250,v14
M v[152:155],v[40:43],a[168:171],v[152:155]
v_accvgpr_write_b32 a251,v15
v_accvgpr_read_b32 v11,a24
M v[152:155],v[44:47],a[172:175],v[152:155]
v_accvgpr_read_b32 v21,a25
v_accvgpr_read_b32 v22,a26
v_exp_f32 v156,v156
v_exp_f32 v157,v157
v_exp_f32 v158,v158
v_exp_f32 v159,v159
v_cvt_pk_bf16_f32 v250,v156,v157
v_cvt_pk_bf16_f32 v251,v158,v159
M v[156:159],v[32:35],a[176:179],0
v_accvgpr_read_b32 v23,a27
v_accvgpr_read_b32 v24,a28
M v[156:159],v[36:39],a[180:183],v[156:159]
v_accvgpr_read_b32 v25,a29
v_accvgpr_read_b32 v26,a30
M v[156:159],v[40:43],a[184:187],v[156:159]
v_accvgpr_read_b32 v27,a31
v_mul_f32 v11,s52,v11
M v[156:159],v[44:47],a[188:191],v[156:159]
s_waitcnt lgkmcnt(0)
s_barrier
M a[24:27],v[48:51],v[192:195],0
ds_read_b128 v[32:35],v8 offset:49152
v_mul_f32 v21,s52,v21
M a[24:27],v[52:55],v[196:199],a[24:27]
v_mul_f32 v22,s52,v22
v_mul_f32 v23,s52,v23
v_cvt_pk_bf16_f32 v12,v11,v21
v_accvgpr_read_b32 v11,a56
v_accvgpr_read_b32 v21,a57
v_cvt_pk_bf16_f32 v13,v22,v23
v_accvgpr_read_b32 v22,a58
v_accvgpr_read_b32 v23,a59
M a[56:59],v[48:51],v[200:203],0
ds_read_b128 v[36:39],v8 offset:49408
v_mul_f32 v24,s52,v24
M a[56:59],v[52:55],v[204:207],a[56:59]
v_mul_f32 v25,s52,v25
v_mul_f32 v26,s52,v26
v_mul_f32 v11,s52,v11
v_accvgpr_write_b32 a204,v12
v_mul_f32 v21,s52,v21
v_cvt_pk_bf16_f32 v12,v11,v21
v_accvgpr_read_b32 v11,a88
v_accvgpr_read_b32 v21,a89
v_mul_f32 v22,s52,v22
v_accvgpr_write_b32 a205,v13
v_mul_f32 v23,s52,v23
v_cvt_pk_bf16_f32 v13,v22,v23
v_accvgpr_read_b32 v22,a90
v_accvgpr_read_b32 v23,a91
M a[88:91],v[48:51],v[208:211],0
ds_read_b128 v[40:43],v8 offset:49664
v_mul_f32 v27,s52,v27
M a[88:91],v[52:55],v[212:215],a[88:91]
v_cvt_pk_bf16_f32 v14,v24,v25
v_cvt_pk_bf16_f32 v15,v26,v27
v_mul_f32 v11,s52,v11
v_accvgpr_write_b32 a220,v12
v_mul_f32 v21,s52,v21
v_cvt_pk_bf16_f32 v12,v11,v21
v_accvgpr_read_b32 v11,a120
v_accvgpr_read_b32 v21,a121
v_mul_f32 v22,s52,v22
v_accvgpr_write_b32 a221,v13
v_mul_f32 v23,s52,v23
v_cvt_pk_bf16_f32 v13,v22,v23
v_accvgpr_read_b32 v22,a122
v_accvgpr_read_b32 v23,a123
M a[120:123],v[48:51],v[216:219],0
ds_read_b128 v[44:47],v8 offset:49920
v_accvgpr_write_b32 a206,v14
M a[120:123],v[52:55],v[220:223],a[120:123]
v_exp_f32 v64,v64
M a[28:31],v[56:59],v[192:195],0
v_exp_f32 v65,v65
M a[28:31],v[60:63],v[196:199],a[28:31]
v_exp_f32 v66,v66
v_accvgpr_read_b32 v24,a60
v_accvgpr_read_b32 v25,a61
v_accvgpr_read_b32 v26,a62
v_accvgpr_read_b32 v27,a63
M a[60:63],v[56:59],v[200:203],0
v_exp_f32 v67,v67
M a[60:63],v[60:63],v[204:207],a[60:63]
v_exp_f32 v68,v68
v_mul_f32 v24,s52,v24
v_mul_f32 v25,s52,v25
v_cvt_pk_bf16_f32 v14,v24,v25
v_accvgpr_read_b32 v24,a92
v_accvgpr_read_b32 v25,a93
v_mul_f32 v26,s52,v26
v_accvgpr_write_b32 a207,v15
v_mul_f32 v27,s52,v27
v_cvt_pk_bf16_f32 v15,v26,v27
v_accvgpr_read_b32 v26,a94
v_accvgpr_read_b32 v27,a95
M a[92:95],v[56:59],v[208:211],0
v_exp_f32 v69,v69
M a[92:95],v[60:63],v[212:215],a[92:95]
v_exp_f32 v70,v70
v_mul_f32 v24,s52,v24
v_accvgpr_write_b32 a222,v14
v_mul_f32 v25,s52,v25
v_cvt_pk_bf16_f32 v14,v24,v25
v_accvgpr_read_b32 v24,a124
v_accvgpr_read_b32 v25,a125
v_mul_f32 v26,s52,v26
v_accvgpr_write_b32 a223,v15
v_mul_f32 v27,s52,v27
v_cvt_pk_bf16_f32 v15,v26,v27
v_accvgpr_read_b32 v26,a126
v_accvgpr_read_b32 v27,a127
M a[124:127],v[56:59],v[216:219],0
v_exp_f32 v71,v71
M a[124:127],v[60:63],v[220:223],a[124:127]
v_exp_f32 v72,v72
M v[172:175],v[176:179],v[216:219],0
v_exp_f32 v73,v73
M v[172:175],v[176:179],v[220:223],v[172:175]
s_waitcnt lgkmcnt(0)
v_accvgpr_write_b32 a236,v12
v_cvt_pk_bf16_f32 v228,v64,v65
v_cvt_pk_bf16_f32 v229,v66,v67
M v[64:67],v[32:35],a[128:131],0
ds_read_b64_tr_b16 v[48:49],v9 offset:16384
v_accvgpr_write_b32 a237,v13
M v[64:67],v[36:39],a[132:135],v[64:67]
ds_read_b64_tr_b16 v[50:51],v9 offset:20480
v_accvgpr_write_b32 a238,v14
M v[64:67],v[40:43],a[136:139],v[64:67]
ds_read_b64_tr_b16 v[52:53],v9 offset:24576
v_accvgpr_write_b32 a239,v15
M v[64:67],v[44:47],a[140:143],v[64:67]
ds_read_b64_tr_b16 v[54:55],v9 offset:28672
v_mul_f32 v11,s52,v11
v_cvt_pk_bf16_f32 v236,v68,v69
v_cvt_pk_bf16_f32 v237,v70,v71
M v[68:71],v[32:35],a[144:147],0
ds_read_b64_tr_b16 v[56:57],v10 offset:16384
v_mul_f32 v21,s52,v21
M v[68:71],v[36:39],a[148:151],v[68:71]
ds_read_b64_tr_b16 v[58:59],v10 offset:20480
v_mul_f32 v22,s52,v22
M v[68:71],v[40:43],a[152:155],v[68:71]
ds_read_b64_tr_b16 v[60:61],v10 offset:24576
v_mul_f32 v23,s52,v23
M v[68:71],v[44:47],a[156:159],v[68:71]
ds_read_b64_tr_b16 v[62:63],v10 offset:28672
v_mul_f32 v24,s52,v24
v_exp_f32 v74,v74
v_exp_f32 v75,v75
v_cvt_pk_bf16_f32 v244,v72,v73
v_cvt_pk_bf16_f32 v245,v74,v75
M v[72:75],v[32:35],a[160:163],0
v_exp_f32 v76,v76
M v[72:75],v[36:39],a[164:167],v[72:75]
v_exp_f32 v77,v77
M v[72:75],v[40:43],a[168:171],v[72:75]
v_exp_f32 v78,v78
M v[72:75],v[44:47],a[172:175],v[72:75]
v_exp_f32 v79,v79
v_cvt_pk_bf16_f32 v252,v76,v77
v_cvt_pk_bf16_f32 v253,v78,v79
M v[76:79],v[32:35],a[176:179],0
v_exp_f32 v80,v80
M v[76:79],v[36:39],a[180:183],v[76:79]
v_exp_f32 v81,v81
M v[76:79],v[40:43],a[184:187],v[76:79]
v_exp_f32 v82,v82
M v[76:79],v[44:47],a[188:191],v[76:79]
s_waitcnt lgkmcnt(0)
v_mul_f32 v25,s52,v25
M a[0:3],v[48:51],v[224:227],a[0:3]
ds_read_b128 v[32:35],v8 offset:53248
v_mul_f32 v26,s52,v26
v_cvt_pk_bf16_f32 v230,v80,v81
v_exp_f32 v83,v83
s_nop 0
v_cvt_pk_bf16_f32 v231,v82,v83
s_nop 1
M a[0:3],v[52:55],v[228:231],a[0:3]
v_exp_f32 v84,v84
M a[32:35],v[48:51],v[232:235],a[32:35]
ds_read_b128 v[36:39],v8 offset:53504
v_mul_f32 v27,s52,v27
v_exp_f32 v85,v85
s_nop 0
v_cvt_pk_bf16_f32 v238,v84,v85
v_exp_f32 v86,v86
v_exp_f32 v87,v87
s_nop 0
v_cvt_pk_bf16_f32 v239,v86,v87
s_nop 1
M a[32:35],v[52:55],v[236:239],a[32:35]
v_exp_f32 v88,v88
M a[64:67],v[48:51],v[240:243],a[64:67]
ds_read_b128 v[40:43],v8 offset:53760
v_cvt_pk_bf16_f32 v12,v11,v21
v_exp_f32 v89,v89
s_nop 0
v_cvt_pk_bf16_f32 v246,v88,v89
v_exp_f32 v90,v90
v_exp_f32 v91,v91
s_nop 0
v_cvt_pk_bf16_f32 v247,v90,v91
s_nop 1
M a[64:67],v[52:55],v[244:247],a[64:67]
v_exp_f32 v92,v92
M a[96:99],v[48:51],v[248:251],a[96:99]
ds_read_b128 v[44:47],v8 offset:54016
v_cvt_pk_bf16_f32 v13,v22,v23
v_exp_f32 v93,v93
s_nop 0
v_cvt_pk_bf16_f32 v254,v92,v93
v_exp_f32 v94,v94
v_exp_f32 v95,v95
s_nop 0
v_cvt_pk_bf16_f32 v255,v94,v95
s_nop 1
M a[96:99],v[52:55],v[252:255],a[96:99]
v_exp_f32 v96,v96
M a[4:7],v[56:59],v[224:227],a[4:7]
v_exp_f32 v97,v97
M a[4:7],v[60:63],v[228:231],a[4:7]
v_exp_f32 v98,v98
M a[36:39],v[56:59],v[232:235],a[36:39]
v_exp_f32 v99,v99
M a[36:39],v[60:63],v[236:239],a[36:39]
v_exp_f32 v100,v100
M a[68:71],v[56:59],v[240:243],a[68:71]
v_exp_f32 v101,v101
M a[68:71],v[60:63],v[244:247],a[68:71]
v_exp_f32 v102,v102
M a[100:103],v[56:59],v[248:251],a[100:103]
v_exp_f32 v103,v103
M a[100:103],v[60:63],v[252:255],a[100:103]
v_exp_f32 v104,v104
M v[160:163],v[176:179],v[224:227],v[160:163]
v_exp_f32 v105,v105
M v[160:163],v[176:179],v[228:231],v[160:163]
s_waitcnt lgkmcnt(0)
v_cvt_pk_bf16_f32 v14,v24,v25
M v[80:83],v[32:35],a[128:131],0
ds_read_b64_tr_b16 v[48:49],v9 offset:16640
v_cvt_pk_bf16_f32 v15,v26,v27
M v[80:83],v[36:39],a[132:135],v[80:83]
ds_read_b64_tr_b16 v[50:51],v9 offset:20736
v_accvgpr_write_b32 a252,v12
M v[80:83],v[40:43],a[136:139],v[80:83]
ds_read_b64_tr_b16 v[52:53],v9 offset:24832
v_accvgpr_write_b32 a253,v13
M v[80:83],v[44:47],a[140:143],v[80:83]
ds_read_b64_tr_b16 v[54:55],v9 offset:28928
v_accvgpr_write_b32 a254,v14
M v[84:87],v[32:35],a[144:147],0
ds_read_b64_tr_b16 v[56:57],v10 offset:16640
v_accvgpr_write_b32 a255,v15
M v[84:87],v[36:39],a[148:151],v[84:87]
ds_read_b64_tr_b16 v[58:59],v10 offset:20736
v_cvt_pk_bf16_f32 v192,v96,v97
M v[84:87],v[40:43],a[152:155],v[84:87]
ds_read_b64_tr_b16 v[60:61],v10 offset:24832
v_cvt_pk_bf16_f32 v193,v98,v99
M v[84:87],v[44:47],a[156:159],v[84:87]
ds_read_b64_tr_b16 v[62:63],v10 offset:28928
v_cvt_pk_bf16_f32 v200,v100,v101
M v[88:91],v[32:35],a[160:163],0
v_exp_f32 v106,v106
M v[88:91],v[36:39],a[164:167],v[88:91]
v_exp_f32 v107,v107
M v[88:91],v[40:43],a[168:171],v[88:91]
v_exp_f32 v108,v108
M v[88:91],v[44:47],a[172:175],v[88:91]
v_exp_f32 v109,v109
M v[92:95],v[32:35],a[176:179],0
v_exp_f32 v110,v110
M v[92:95],v[36:39],a[180:183],v[92:95]
v_exp_f32 v111,v111
M v[92:95],v[40:43],a[184:187],v[92:95]
v_exp_f32 v112,v112
M v[92:95],v[44:47],a[188:191],v[92:95]
s_waitcnt lgkmcnt(0)
v_cvt_pk_bf16_f32 v201,v102,v103
M a[8:11],v[48:51],v[224:227],a[8:11]
ds_read_b128 v[32:35],v8 offset:57344
v_cvt_pk_bf16_f32 v208,v104,v105
M a[8:11],v[52:55],v[228:231],a[8:11]
v_exp_f32 v113,v113
M a[40:43],v[48:51],v[232:235],a[40:43]
ds_read_b128 v[36:39],v8 offset:57600
v_cvt_pk_bf16_f32 v209,v106,v107
M a[40:43],v[52:55],v[236:239],a[40:43]
v_exp_f32 v114,v114
M a[72:75],v[48:51],v[240:243],a[72:75]
ds_read_b128 v[40:43],v8 offset:57856
v_cvt_pk_bf16_f32 v216,v108,v109
M a[72:75],v[52:55],v[244:247],a[72:75]
v_exp_f32 v115,v115
M a[104:107],v[48:51],v[248:251],a[104:107]
ds_read_b128 v[44:47],v8 offset:58112
v_cvt_pk_bf16_f32 v217,v110,v111
M a[104:107],v[52:55],v[252:255],a[104:107]
v_exp_f32 v116,v116
M a[12:15],v[56:59],v[224:227],a[12:15]
v_exp_f32 v117,v117
M a[12:15],v[60:63],v[228:231],a[12:15]
v_exp_f32 v118,v118
M a[44:47],v[56:59],v[232:235],a[44:47]
v_exp_f32 v119,v119
M a[44:47],v[60:63],v[236:239],a[44:47]
v_exp_f32 v120,v120
M a[76:79],v[56:59],v[240:243],a[76:79]
v_exp_f32 v121,v121
M a[76:79],v[60:63],v[244:247],a[76:79]
v_exp_f32 v122,v122
M a[108:111],v[56:59],v[248:251],a[108:111]
v_exp_f32 v123,v123
M a[108:111],v[60:63],v[252:255],a[108:111]
v_exp_f32 v124,v124
M v[164:167],v[176:179],v[232:235],v[164:167]
v_exp_f32 v125,v125
M v[164:167],v[176:179],v[236:239],v[164:167]
s_waitcnt lgkmcnt(0)
v_cvt_pk_bf16_f32 v194,v112,v113
M v[96:99],v[32:35],a[128:131],0
ds_read_b64_tr_b16 v[48:49],v9 offset:16896
v_cvt_pk_bf16_f32 v195,v114,v115
M v[96:99],v[36:39],a[132:135],v[96:99]
ds_read_b64_tr_b16 v[50:51],v9 offset:20992
v_cvt_pk_bf16_f32 v202,v116,v117
M v[96:99],v[40:43],a[136:139],v[96:99]
ds_read_b64_tr_b16 v[52:53],v9 offset:25088
v_cvt_pk_bf16_f32 v203,v118,v119
M v[96:99],v[44:47],a[140:143],v[96:99]
ds_read_b64_tr_b16 v[54:55],v9 offset:29184
v_cvt_pk_bf16_f32 v210,v120,v121
M v[100:103],v[32:35],a[144:147],0
ds_read_b64_tr_b16 v[56:57],v10 offset:16896
v_cvt_pk_bf16_f32 v211,v122,v123
M v[100:103],v[36:39],a[148:151],v[100:103]
ds_read_b64_tr_b16 v[58:59],v10 offset:20992
v_cvt_pk_bf16_f32 v218,v124,v125
M v[100:103],v[40:43],a[152:155],v[100:103]
ds_read_b64_tr_b16 v[60:61],v10 offset:25088
M v[100:103],v[44:47],a[156:159],v[100:103]
ds_read_b64_tr_b16 v[62:63],v10 offset:29184
M v[104:107],v[32:35],a[160:163],0
v_exp_f32 v126,v126
M v[104:107],v[36:39],a[164:167],v[104:107]
v_exp_f32 v127,v127
M v[104:107],v[40:43],a[168:171],v[104:107]
v_exp_f32 v128,v128
M v[104:107],v[44:47],a[172:175],v[104:107]
v_exp_f32 v129,v129
M v[108:111],v[32:35],a[176:179],0
v_exp_f32 v130,v130
M v[108:111],v[36:39],a[180:183],v[108:111]
v_exp_f32 v131,v131
M v[108:111],v[40:43],a[184:187],v[108:111]
v_exp_f32 v132,v132
M v[108:111],v[44:47],a[188:191],v[108:111]
s_waitcnt lgkmcnt(0)
v_cvt_pk_bf16_f32 v219,v126,v127
M a[16:19],v[48:51],v[224:227],a[16:19]
ds_read_b128 v[32:35],v8 offset:61440
v_cvt_pk_bf16_f32 v196,v128,v129
M a[16:19],v[52:55],v[228:231],a[16:19]
v_exp_f32 v133,v133
M a[48:51],v[48:51],v[232:235],a[48:51]
ds_read_b128 v[36:39],v8 offset:61696
v_cvt_pk_bf16_f32 v197,v130,v131
M a[48:51],v[52:55],v[236:239],a[48:51]
v_exp_f32 v134,v134
M a[80:83],v[48:51],v[240:243],a[80:83]
ds_read_b128 v[40:43],v8 offset:61952
v_cvt_pk_bf16_f32 v204,v132,v133
M a[80:83],v[52:55],v[244:247],a[80:83]
v_exp_f32 v135,v135
M a[112:115],v[48:51],v[248:251],a[112:115]
ds_read_b128 v[44:47],v8 offset:62208
v_cvt_pk_bf16_f32 v205,v134,v135
M a[112:115],v[52:55],v[252:255],a[112:115]
v_exp_f32 v136,v136
M a[20:23],v[56:59],v[224:227],a[20:23]
v_exp_f32 v137,v137
M a[20:23],v[60:63],v[228:231],a[20:23]
v_exp_f32 v138,v138
M a[52:55],v[56:59],v[232:235],a[52:55]
v_exp_f32 v139,v139
M a[52:55],v[60:63],v[236:239],a[52:55]
v_exp_f32 v140,v140
M a[84:87],v[56:59],v[240:243],a[84:87]
v_exp_f32 v141,v141
M a[84:87],v[60:63],v[244:247],a[84:87]
v_exp_f32 v142,v142
M a[116:119],v[56:59],v[248:251],a[116:119]
v_exp_f32 v143,v143
M a[116:119],v[60:63],v[252:255],a[116:119]
v_exp_f32 v144,v144
M v[168:171],v[176:179],v[240:243],v[168:171]
v_exp_f32 v145,v145
M v[168:171],v[176:179],v[244:247],v[168:171]
s_waitcnt lgkmcnt(0)
v_cvt_pk_bf16_f32 v212,v136,v137
M v[112:115],v[32:35],a[128:131],0
ds_read_b64_tr_b16 v[48:49],v9 offset:17152
v_cvt_pk_bf16_f32 v213,v138,v139
M v[112:115],v[36:39],a[132:135],v[112:115]
ds_read_b64_tr_b16 v[50:51],v9 offset:21248
v_cvt_pk_bf16_f32 v220,v140,v141
M v[112:115],v[40:43],a[136:139],v[112:115]
ds_read_b64_tr_b16 v[52:53],v9 offset:25344
v_cvt_pk_bf16_f32 v221,v142,v143
M v[112:115],v[44:47],a[140:143],v[112:115]
ds_read_b64_tr_b16 v[54:55],v9 offset:29440
v_cvt_pk_bf16_f32 v198,v144,v145
M v[116:119],v[32:35],a[144:147],0
ds_read_b64_tr_b16 v[56:57],v10 offset:17152
M v[116:119],v[36:39],a[148:151],v[116:119]
ds_read_b64_tr_b16 v[58:59],v10 offset:21248
M v[116:119],v[40:43],a[152:155],v[116:119]
ds_read_b64_tr_b16 v[60:61],v10 offset:25344
M v[116:119],v[44:47],a[156:159],v[116:119]
ds_read_b64_tr_b16 v[62:63],v10 offset:29440
M v[120:123],v[32:35],a[160:163],0
v_exp_f32 v146,v146
M v[120:123],v[36:39],a[164:167],v[120:123]
v_exp_f32 v147,v147
M v[120:123],v[40:43],a[168:171],v[120:123]
v_exp_f32 v148,v148
M v[120:123],v[44:47],a[172:175],v[120:123]
v_exp_f32 v149,v149
M v[124:127],v[32:35],a[176:179],0
v_exp_f32 v150,v150
M v[124:127],v[36:39],a[180:183],v[124:127]
v_exp_f32 v151,v151
M v[124:127],v[40:43],a[184:187],v[124:127]
v_exp_f32 v152,v152
M v[124:127],v[44:47],a[188:191],v[124:127]
s_waitcnt lgkmcnt(0)
s_barrier
M a[24:27],v[48:51],v[224:227],a[24:27]
ds_read_b128 v[32:35],v8
v_cvt_pk_bf16_f32 v199,v146,v147
M a[24:27],v[52:55],v[228:231],a[24:27]
v_exp_f32 v153,v153
M a[56:59],v[48:51],v[232:235],a[56:59]
ds_read_b128 v[36:39],v8 offset:256
v_cvt_pk_bf16_f32 v206,v148,v149
M a[56:59],v[52:55],v[236:239],a[56:59]
v_exp_f32 v154,v154
M a[88:91],v[48:51],v[240:243],a[88:91]
ds_read_b128 v[40:43],v8 offset:512
v_cvt_pk_bf16_f32 v207,v150,v151
M a[88:91],v[52:55],v[244:247],a[88:91]
v_exp_f32 v155,v155
M a[120:123],v[48:51],v[248:251],a[120:123]
ds_read_b128 v[44:47],v8 offset:768
v_cvt_pk_bf16_f32 v214,v152,v153
M a[120:123],v[52:55],v[252:255],a[120:123]
v_exp_f32 v156,v156
M a[28:31],v[56:59],v[224:227],a[28:31]
v_exp_f32 v157,v157
M a[28:31],v[60:63],v[228:231],a[28:31]
v_exp_f32 v158,v158
M a[60:63],v[56:59],v[232:235],a[60:63]
v_exp_f32 v159,v159
M a[60:63],v[60:63],v[236:239],a[60:63]
v_exp_f32 v64,v64
M a[92:95],v[56:59],v[240:243],a[92:95]
v_exp_f32 v65,v65
M a[92:95],v[60:63],v[244:247],a[92:95]
v_exp_f32 v66,v66
M a[124:127],v[56:59],v[248:251],a[124:127]
v_exp_f32 v67,v67
M a[124:127],v[60:63],v[252:255],a[124:127]
v_exp_f32 v68,v68
M v[172:175],v[176:179],v[248:251],v[172:175]
v_exp_f32 v69,v69
M v[172:175],v[176:179],v[252:255],v[172:175]
s_waitcnt lgkmcnt(0)
v_cvt_pk_bf16_f32 v215,v154,v155
M v[128:131],v[32:35],a[128:131],0
ds_read_b64_tr_b16 v[48:49],v9 offset:32768
v_cvt_pk_bf16_f32 v222,v156,v157
M v[128:131],v[36:39],a[132:135],v[128:131]
ds_read_b64_tr_b16 v[50:51],v9 offset:36864
v_cvt_pk_bf16_f32 v223,v158,v159
M v[128:131],v[40:43],a[136:139],v[128:131]
ds_read_b64_tr_b16 v[52:53],v9 offset:40960
v_cvt_pk_bf16_f32 v224,v64,v65
M v[128:131],v[44:47],a[140:143],v[128:131]
ds_read_b64_tr_b16 v[54:55],v9 offset:45056
v_cvt_pk_bf16_f32 v225,v66,v67
M v[132:135],v[32:35],a[144:147],0
ds_read_b64_tr_b16 v[56:57],v10 offset:32768
v_cvt_pk_bf16_f32 v232,v68,v69
M v[132:135],v[36:39],a[148:151],v[132:135]
ds_read_b64_tr_b16 v[58:59],v10 offset:36864
M v[132:135],v[40:43],a[152:155],v[132:135]
ds_read_b64_tr_b16 v[60:61],v10 offset:40960
M v[132:135],v[44:47],a[156:159],v[132:135]
ds_read_b64_tr_b16 v[62:63],v10 offset:45056
M v[136:139],v[32:35],a[160:163],0
v_exp_f32 v70,v70
M v[136:139],v[36:39],a[164:167],v[136:139]
v_exp_f32 v71,v71
M v[136:139],v[40:43],a[168:171],v[136:139]
v_exp_f32 v72,v72
M v[136:139],v[44:47],a[172:175],v[136:139]
v_exp_f32 v73,v73
M v[140:143],v[32:35],a[176:179],0
v_exp_f32 v74,v74
M v[140:143],v[36:39],a[180:183],v[140:143]
v_exp_f32 v75,v75
M v[140:143],v[40:43],a[184:187],v[140:143]
v_exp_f32 v76,v76
M v[140:143],v[44:47],a[188:191],v[140:143]
s_waitcnt lgkmcnt(0)
v_cvt_pk_bf16_f32 v233,v70,v71
M a[0:3],v[48:51],v[192:195],a[0:3]
ds_read_b128 v[32:35],v8 offset:4096
v_cvt_pk_bf16_f32 v240,v72,v73
M a[0:3],v[52:55],v[196:199],a[0:3]
v_exp_f32 v77,v77
M a[32:35],v[48:51],v[200:203],a[32:35]
ds_read_b128 v[36:39],v8 offset:4352
v_cvt_pk_bf16_f32 v241,v74,v75
M a[32:35],v[52:55],v[204:207],a[32:35]
v_exp_f32 v78,v78
M a[64:67],v[48:51],v[208:211],a[64:67]
ds_read_b128 v[40:43],v8 offset:4608
v_cvt_pk_bf16_f32 v248,v76,v77
M a[64:67],v[52:55],v[212:215],a[64:67]
v_exp_f32 v79,v79
M a[96:99],v[48:51],v[216:219],a[96:99]
ds_read_b128 v[44:47],v8 offset:4864
v_cvt_pk_bf16_f32 v249,v78,v79
M a[96:99],v[52:55],v[220:223],a[96:99]
v_exp_f32 v80,v80
M a[4:7],v[56:59],v[192:195],a[4:7]
v_exp_f32 v81,v81
M a[4:7],v[60:63],v[196:199],a[4:7]
v_exp_f32 v82,v82
M a[36:39],v[56:59],v[200:203],a[36:39]
v_exp_f32 v83,v83
M a[36:39],v[60:63],v[204:207],a[36:39]
v_exp_f32 v84,v84
M a[68:71],v[56:59],v[208:211],a[68:71]
v_exp_f32 v85,v85
M a[68:71],v[60:63],v[212:215],a[68:71]
v_exp_f32 v86,v86
M a[100:103],v[56:59],v[216:219],a[100:103]
v_exp_f32 v87,v87
M a[100:103],v[60:63],v[220:223],a[100:103]
v_exp_f32 v88,v88
M v[160:163],v[176:179],v[192:195],v[160:163]
v_exp_f32 v89,v89
M v[160:163],v[176:179],v[196:199],v[160:163]
s_waitcnt lgkmcnt(0)
v_cvt_pk_bf16_f32 v226,v80,v81
M v[144:147],v[32:35],a[128:131],0
ds_read_b64_tr_b16 v[48:49],v9 offset:33024
v_cvt_pk_bf16_f32 v227,v82,v83
M v[144:147],v[36:39],a[132:135],v[144:147]
ds_read_b64_tr_b16 v[50:51],v9 offset:37120
v_cvt_pk_bf16_f32 v234,v84,v85
M v[144:147],v[40:43],a[136:139],v[144:147]
ds_read_b64_tr_b16 v[52:53],v9 offset:41216
v_cvt_pk_bf16_f32 v235,v86,v87
M v[144:147],v[44:47],a[140:143],v[144:147]
ds_read_b64_tr_b16 v[54:55],v9 offset:45312
v_cvt_pk_bf16_f32 v242,v88,v89
M v[148:151],v[32:35],a[144:147],0
ds_read_b64_tr_b16 v[56:57],v10 offset:33024
M v[148:151],v[36:39],a[148:151],v[148:151]
ds_read_b64_tr_b16 v[58:59],v10 offset:37120
M v[148:151],v[40:43],a[152:155],v[148:151]
ds_read_b64_tr_b16 v[60:61],v10 offset:41216
M v[148:151],v[44:47],a[156:159],v[148:151]
ds_read_b64_tr_b16 v[62:63],v10 offset:45312
M v[152:155],v[32:35],a[160:163],0
v_exp_f32 v90,v90
M v[152:155],v[36:39],a[164:167],v[152:155]
v_exp_f32 v91,v91
M v[152:155],v[40:43],a[168:171],v[152:155]
v_exp_f32 v92,v92
M v[152:155],v[44:47],a[172:175],v[152:155]
v_exp_f32 v93,v93
M v[156:159],v[32:35],a[176:179],0
v_exp_f32 v94,v94
M v[156:159],v[36:39],a[180:183],v[156:159]
v_exp_f32 v95,v95
M v[156:159],v[40:43],a[184:187],v[156:159]
v_exp_f32 v96,v96
M v[156:159],v[44:47],a[188:191],v[156:159]
s_waitcnt lgkmcnt(0)
v_cvt_pk_bf16_f32 v243,v90,v91
M a[8:11],v[48:51],v[192:195],a[8:11]
ds_read_b128 v[32:35],v8 offset:8192
v_cvt_pk_bf16_f32 v250,v92,v93
M a[8:11],v[52:55],v[196:199],a[8:11]
v_exp_f32 v97,v97
M a[40:43],v[48:51],v[200:203],a[40:43]
ds_read_b128 v[36:39],v8 offset:8448
v_cvt_pk_bf16_f32 v251,v94,v95
M a[40:43],v[52:55],v[204:207],a[40:43]
v_exp_f32 v98,v98
M a[72:75],v[48:51],v[208:211],a[72:75]
ds_read_b128 v[40:43],v8 offset:8704
v_cvt_pk_bf16_f32 v228,v96,v97
M a[72:75],v[52:55],v[212:215],a[72:75]
v_exp_f32 v99,v99
M a[104:107],v[48:51],v[216:219],a[104:107]
ds_read_b128 v[44:47],v8 offset:8960
v_cvt_pk_bf16_f32 v229,v98,v99
M a[104:107],v[52:55],v[220:223],a[104:107]
v_exp_f32 v100,v100
M a[12:15],v[56:59],v[192:195],a[12:15]
v_exp_f32 v101,v101
M a[12:15],v[60:63],v[196:199],a[12:15]
v_exp_f32 v102,v102
M a[44:47],v[56:59],v[200:203],a[44:47]
v_exp_f32 v103,v103
M a[44:47],v[60:63],v[204:207],a[44:47]
v_exp_f32 v104,v104
M a[76:79],v[56:59],v[208:211],a[76:79]
v_exp_f32 v105,v105
M a[76:79],v[60:63],v[212:215],a[76:79]
v_exp_f32 v106,v106
M a[108:111],v[56:59],v[216:219],a[108:111]
v_exp_f32 v107,v107
M a[108:111],v[60:63],v[220:223],a[108:111]
v_exp_f32 v108,v108
M v[164:167],v[176:179],v[200:203],v[164:167]
v_exp_f32 v109,v109
M v[164:167],v[176:179],v[204:207],v[164:167]
s_waitcnt lgkmcnt(0)
v_cvt_pk_bf16_f32 v236,v100,v101
M v[64:67],v[32:35],a[128:131],0
ds_read_b64_tr_b16 v[48:49],v9 offset:33280
v_cvt_pk_bf16_f32 v237,v102,v103
M v[64:67],v[36:39],a[132:135],v[64:67]
ds_read_b64_tr_b16 v[50:51],v9 offset:37376
v_cvt_pk_bf16_f32 v244,v104,v105
M v[64:67],v[40:43],a[136:139],v[64:67]
ds_read_b64_tr_b16 v[52:53],v9 offset:41472
v_cvt_pk_bf16_f32 v245,v106,v107
M v[64:67],v[44:47],a[140:143],v[64:67]
ds_read_b64_tr_b16 v[54:55],v9 offset:45568
v_cvt_pk_bf16_f32 v252,v108,v109
M v[68:71],v[32:35],a[144:147],0
ds_read_b64_tr_b16 v[56:57],v10 offset:33280
M v[68:71],v[36:39],a[148:151],v[68:71]
ds_read_b64_tr_b16 v[58:59],v10 offset:37376
M v[68:71],v[40:43],a[152:155],v[68:71]
ds_read_b64_tr_b16 v[60:61],v10 offset:41472
M v[68:71],v[44:47],a[156:159],v[68:71]
ds_read_b64_tr_b16 v[62:63],v10 offset:45568
M v[72:75],v[32:35],a[160:163],0
v_exp_f32 v110,v110
M v[72:75],v[36:39],a[164:167],v[72:75]
v_exp_f32 v111,v111
M v[72:75],v[40:43],a[168:171],v[72:75]
v_exp_f32 v112,v112
M v[72:75],v[44:47],a[172:175],v[72:75]
v_exp_f32 v113,v113
M v[76:79],v[32:35],a[176:179],0
v_exp_f32 v114,v114
M v[76:79],v[36:39],a[180:183],v[76:79]
v_exp_f32 v115,v115
M v[76:79],v[40:43],a[184:187],v[76:79]
v_exp_f32 v116,v116
M v[76:79],v[44:47],a[188:191],v[76:79]
s_waitcnt lgkmcnt(0)
v_cvt_pk_bf16_f32 v253,v110,v111
M a[16:19],v[48:51],v[192:195],a[16:19]
ds_read_b128 v[32:35],v8 offset:12288
v_cvt_pk_bf16_f32 v230,v112,v113
M a[16:19],v[52:55],v[196:199],a[16:19]
v_exp_f32 v117,v117
M a[48:51],v[48:51],v[200:203],a[48:51]
ds_read_b128 v[36:39],v8 offset:12544
v_cvt_pk_bf16_f32 v231,v114,v115
M a[48:51],v[52:55],v[204:207],a[48:51]
v_exp_f32 v118,v118
M a[80:83],v[48:51],v[208:211],a[80:83]
ds_read_b128 v[40:43],v8 offset:12800
v_cvt_pk_bf16_f32 v238,v116,v117
M a[80:83],v[52:55],v[212:215],a[80:83]
v_exp_f32 v119,v119
M a[112:115],v[48:51],v[216:219],a[112:115]
ds_read_b128 v[44:47],v8 offset:13056
v_cvt_pk_bf16_f32 v239,v118,v119
M a[112:115],v[52:55],v[220:223],a[112:115]
v_exp_f32 v120,v120
M a[20:23],v[56:59],v[192:195],a[20:23]
v_exp_f32 v121,v121
M a[20:23],v[60:63],v[196:199],a[20:23]
v_exp_f32 v122,v122
M a[52:55],v[56:59],v[200:203],a[52:55]
v_exp_f32 v123,v123
M a[52:55],v[60:63],v[204:207],a[52:55]
v_exp_f32 v124,v124
M a[84:87],v[56:59],v[208:211],a[84:87]
v_exp_f32 v125,v125
M a[84:87],v[60:63],v[212:215],a[84:87]
v_exp_f32 v126,v126
M a[116:119],v[56:59],v[216:219],a[116:119]
v_exp_f32 v127,v127
M a[116:119],v[60:63],v[220:223],a[116:119]
v_exp_f32 v128,v128
M v[168:171],v[176:179],v[208:211],v[168:171]
v_exp_f32 v129,v129
M v[168:171],v[176:179],v[212:215],v[168:171]
s_waitcnt lgkmcnt(0)
v_cvt_pk_bf16_f32 v246,v120,v121
M v[80:83],v[32:35],a[128:131],0
ds_read_b64_tr_b16 v[48:49],v9 offset:33536
v_cvt_pk_bf16_f32 v247,v122,v123
M v[80:83],v[36:39],a[132:135],v[80:83]
ds_read_b64_tr_b16 v[50:51],v9 offset:37632
v_cvt_pk_bf16_f32 v254,v124,v125
M v[80:83],v[40:43],a[136:139],v[80:83]
ds_read_b64_tr_b16 v[52:53],v9 offset:41728
v_cvt_pk_bf16_f32 v255,v126,v127
M v[80:83],v[44:47],a[140:143],v[80:83]
ds_read_b64_tr_b16 v[54:55],v9 offset:45824
M v[84:87],v[32:35],a[144:147],0
ds_read_b64_tr_b16 v[56:57],v10 offset:33536
M v[84:87],v[36:39],a[148:151],v[84:87]
ds_read_b64_tr_b16 v[58:59],v10 offset:37632
M v[84:87],v[40:43],a[152:155],v[84:87]
ds_read_b64_tr_b16 v[60:61],v10 offset:41728
M v[84:87],v[44:47],a[156:159],v[84:87]
ds_read_b64_tr_b16 v[62:63],v10 offset:45824
M v[88:91],v[32:35],a[160:163],0
v_exp_f32 v130,v130
M v[88:91],v[36:39],a[164:167],v[88:91]
v_exp_f32 v131,v131
M v[88:91],v[40:43],a[168:171],v[88:91]
v_exp_f32 v132,v132
M v[88:91],v[44:47],a[172:175],v[88:91]
v_exp_f32 v133,v133
M v[92:95],v[32:35],a[176:179],0
v_exp_f32 v134,v134
M v[92:95],v[36:39],a[180:183],v[92:95]
v_exp_f32 v135,v135
M v[92:95],v[40:43],a[184:187],v[92:95]
v_exp_f32 v136,v136
M v[92:95],v[44:47],a[188:191],v[92:95]
s_waitcnt lgkmcnt(0)
s_barrier
M a[24:27],v[48:51],v[192:195],a[24:27]
ds_read_b128 v[32:35],v8 offset:16384
M a[24:27],v[52:55],v[196:199],a[24:27]
v_exp_f32 v137,v137
M a[56:59],v[48:51],v[200:203],a[56:59]
ds_read_b128 v[36:39],v8 offset:16640
M a[56:59],v[52:55],v[204:207],a[56:59]
v_exp_f32 v138,v138
M a[88:91],v[48:51],v[208:211],a[88:91]
ds_read_b128 v[40:43],v8 offset:16896
M a[88:91],v[52:55],v[212:215],a[88:91]
v_exp_f32 v139,v139
M a[120:123],v[48:51],v[216:219],a[120:123]
ds_read_b128 v[44:47],v8 offset:17152
M a[120:123],v[52:55],v[220:223],a[120:123]
v_exp_f32 v140,v140
M a[28:31],v[56:59],v[192:195],a[28:31]
v_exp_f32 v141,v141
M a[28:31],v[60:63],v[196:199],a[28:31]
v_exp_f32 v142,v142
M a[60:63],v[56:59],v[200:203],a[60:63]
v_exp_f32 v143,v143
M a[60:63],v[60:63],v[204:207],a[60:63]
v_exp_f32 v144,v144
M a[92:95],v[56:59],v[208:211],a[92:95]
v_exp_f32 v145,v145
M a[92:95],v[60:63],v[212:215],a[92:95]
v_exp_f32 v146,v146
M a[124:127],v[56:59],v[216:219],a[124:127]
v_exp_f32 v147,v147
M a[124:127],v[60:63],v[220:223],a[124:127]
v_exp_f32 v148,v148
M v[172:175],v[176:179],v[216:219],v[172:175]
v_exp_f32 v149,v149
M v[172:175],v[176:179],v[220:223],v[172:175]
s_waitcnt lgkmcnt(0)
v_cvt_pk_bf16_f32 v192,v128,v129
M v[96:99],v[32:35],a[128:131],0
ds_read_b64_tr_b16 v[48:49],v9 offset:49152
v_cvt_pk_bf16_f32 v193,v130,v131
M v[96:99],v[36:39],a[132:135],v[96:99]
ds_read_b64_tr_b16 v[50:51],v9 offset:53248
v_cvt_pk_bf16_f32 v200,v132,v133
M v[96:99],v[40:43],a[136:139],v[96:99]
ds_read_b64_tr_b16 v[52:53],v9 offset:57344
v_cvt_pk_bf16_f32 v201,v134,v135
M v[96:99],v[44:47],a[140:143],v[96:99]
ds_read_b64_tr_b16 v[54:55],v9 offset:61440
v_cvt_pk_bf16_f32 v208,v136,v137
M v[100:103],v[32:35],a[144:147],0
ds_read_b64_tr_b16 v[56:57],v10 offset:49152
v_cvt_pk_bf16_f32 v209,v138,v139
M v[100:103],v[36:39],a[148:151],v[100:103]
ds_read_b64_tr_b16 v[58:59],v10 offset:53248
v_cvt_pk_bf16_f32 v216,v140,v141
M v[100:103],v[40:43],a[152:155],v[100:103]
ds_read_b64_tr_b16 v[60:61],v10 offset:57344
v_cvt_pk_bf16_f32 v217,v142,v143
M v[100:103],v[44:47],a[156:159],v[100:103]
ds_read_b64_tr_b16 v[62:63],v10 offset:61440
v_cvt_pk_bf16_f32 v194,v144,v145
M v[104:107],v[32:35],a[160:163],0
v_exp_f32 v150,v150
M v[104:107],v[36:39],a[164:167],v[104:107]
v_exp_f32 v151,v151
M v[104:107],v[40:43],a[168:171],v[104:107]
v_exp_f32 v152,v152
M v[104:107],v[44:47],a[172:175],v[104:107]
v_exp_f32 v153,v153
M v[108:111],v[32:35],a[176:179],0
v_exp_f32 v154,v154
M v[108:111],v[36:39],a[180:183],v[108:111]
v_exp_f32 v155,v155
M v[108:111],v[40:43],a[184:187],v[108:111]
v_exp_f32 v156,v156
M v[108:111],v[44:47],a[188:191],v[108:111]
s_waitcnt lgkmcnt(0)
v_cvt_pk_bf16_f32 v195,v146,v147
M a[0:3],v[48:51],v[224:227],a[0:3]
ds_read_b128 v[32:35],v8 offset:20480
v_cvt_pk_bf16_f32 v202,v148,v149
M a[0:3],v[52:55],v[228:231],a[0:3]
v_exp_f32 v157,v157
M a[32:35],v[48:51],v[232:235],a[32:35]
ds_read_b128 v[36:39],v8 offset:20736
v_cvt_pk_bf16_f32 v203,v150,v151
M a[32:35],v[52:55],v[236:239],a[32:35]
v_exp_f32 v158,v158
M a[64:67],v[48:51],v[240:243],a[64:67]
ds_read_b128 v[40:43],v8 offset:20992
v_cvt_pk_bf16_f32 v210,v152,v153
M a[64:67],v[52:55],v[244:247],a[64:67]
v_exp_f32 v159,v159
M a[96:99],v[48:51],v[248:251],a[96:99]
ds_read_b128 v[44:47],v8 offset:21248
v_cvt_pk_bf16_f32 v211,v154,v155
M a[96:99],v[52:55],v[252:255],a[96:99]
v_exp_f32 v64,v64
M a[4:7],v[56:59],v[224:227],a[4:7]
v_exp_f32 v65,v65
M a[4:7],v[60:63],v[228:231],a[4:7]
v_exp_f32 v66,v66
M a[36:39],v[56:59],v[232:235],a[36:39]
v_exp_f32 v67,v67
M a[36:39],v[60:63],v[236:239],a[36:39]
v_exp_f32 v68,v68
M a[68:71],v[56:59],v[240:243],a[68:71]
v_exp_f32 v69,v69
M a[68:71],v[60:63],v[244:247],a[68:71]
v_exp_f32 v70,v70
M a[100:103],v[56:59],v[248:251],a[100:103]
v_exp_f32 v71,v71
M a[100:103],v[60:63],v[252:255],a[100:103]
v_exp_f32 v72,v72
M v[160:163],v[176:179],v[224:227],v[160:163]
v_exp_f32 v73,v73
M v[160:163],v[176:179],v[228:231],v[160:163]
s_waitcnt lgkmcnt(0)
v_cvt_pk_bf16_f32 v218,v156,v157
M v[112:115],v[32:35],a[128:131],0
ds_read_b64_tr_b16 v[48:49],v9 offset:49408
v_cvt_pk_bf16_f32 v219,v158,v159
M v[112:115],v[36:39],a[132:135],v[112:115]
ds_read_b64_tr_b16 v[50:51],v9 offset:53504
v_cvt_pk_bf16_f32 v196,v64,v65
M v[112:115],v[40:43],a[136:139],v[112:115]
ds_read_b64_tr_b16 v[52:53],v9 offset:57600
v_cvt_pk_bf16_f32 v197,v66,v67
M v[112:115],v[44:47],a[140:143],v[112:115]
ds_read_b64_tr_b16 v[54:55],v9 offset:61696
v_cvt_pk_bf16_f32 v204,v68,v69
M v[116:119],v[32:35],a[144:147],0
ds_read_b64_tr_b16 v[56:57],v10 offset:49408
v_cvt_pk_bf16_f32 v205,v70,v71
M v[116:119],v[36:39],a[148:151],v[116:119]
ds_read_b64_tr_b16 v[58:59],v10 offset:53504
v_cvt_pk_bf16_f32 v212,v72,v73
M v[116:119],v[40:43],a[152:155],v[116:119]
ds_read_b64_tr_b16 v[60:61],v10 offset:57600
M v[116:119],v[44:47],a[156:159],v[116:119]
ds_read_b64_tr_b16 v[62:63],v10 offset:61696
M v[120:123],v[32:35],a[160:163],0
v_exp_f32 v74,v74
M v[120:123],v[36:39],a[164:167],v[120:123]
v_exp_f32 v75,v75
M v[120:123],v[40:43],a[168:171],v[120:123]
v_exp_f32 v76,v76
M v[120:123],v[44:47],a[172:175],v[120:123]
v_exp_f32 v77,v77
M v[124:127],v[32:35],a[176:179],0
v_exp_f32 v78,v78
M v[124:127],v[36:39],a[180:183],v[124:127]
v_exp_f32 v79,v79
M v[124:127],v[40:43],a[184:187],v[124:127]
v_exp_f32 v80,v80
M v[124:127],v[44:47],a[188:191],v[124:127]
s_waitcnt lgkmcnt(0)
v_cvt_pk_bf16_f32 v213,v74,v75
M a[8:11],v[48:51],v[224:227],a[8:11]
ds_read_b128 v[32:35],v8 offset:24576
v_cvt_pk_bf16_f32 v220,v76,v77
M a[8:11],v[52:55],v[228:231],a[8:11]
v_exp_f32 v81,v81
M a[40:43],v[48:51],v[232:235],a[40:43]
ds_read_b128 v[36:39],v8 offset:24832
v_cvt_pk_bf16_f32 v221,v78,v79
M a[40:43],v[52:55],v[236:239],a[40:43]
v_exp_f32 v82,v82
M a[72:75],v[48:51],v[240:243],a[72:75]
ds_read_b128 v[40:43],v8 offset:25088
v_cvt_pk_bf16_f32 v198,v80,v81
M a[72:75],v[52:55],v[244:247],a[72:75]
v_exp_f32 v83,v83
M a[104:107],v[48:51],v[248:251],a[104:107]
ds_read_b128 v[44:47],v8 offset:25344
v_cvt_pk_bf16_f32 v199,v82,v83
M a[104:107],v[52:55],v[252:255],a[104:107]
v_exp_f32 v84,v84
M a[12:15],v[56:59],v[224:227],a[12:15]
v_exp_f32 v85,v85
M a[12:15],v[60:63],v[228:231],a[12:15]
v_exp_f32 v86,v86
M a[44:47],v[56:59],v[232:235],a[44:47]
v_exp_f32 v87,v87
M a[44:47],v[60:63],v[236:239],a[44:47]
v_exp_f32 v88,v88
M a[76:79],v[56:59],v[240:243],a[76:79]
v_exp_f32 v89,v89
M a[76:79],v[60:63],v[244:247],a[76:79]
v_exp_f32 v90,v90
M a[108:111],v[56:59],v[248:251],a[108:111]
v_exp_f32 v91,v91
M a[108:111],v[60:63],v[252:255],a[108:111]
v_exp_f32 v92,v92
M v[164:167],v[176:179],v[232:235],v[164:167]
v_exp_f32 v93,v93
M v[164:167],v[176:179],v[236:239],v[164:167]
s_waitcnt lgkmcnt(0)
v_cvt_pk_bf16_f32 v206,v84,v85
M v[128:131],v[32:35],a[128:131],0
ds_read_b64_tr_b16 v[48:49],v9 offset:49664
v_cvt_pk_bf16_f32 v207,v86,v87
M v[128:131],v[36:39],a[132:135],v[128:131]
ds_read_b64_tr_b16 v[50:51],v9 offset:53760
v_cvt_pk_bf16_f32 v214,v88,v89
M v[128:131],v[40:43],a[136:139],v[128:131]
ds_read_b64_tr_b16 v[52:53],v9 offset:57856
v_cvt_pk_bf16_f32 v215,v90,v91
M v[128:131],v[44:47],a[140:143],v[128:131]
ds_read_b64_tr_b16 v[54:55],v9 offset:61952
v_cvt_pk_bf16_f32 v222,v92,v93
M v[132:135],v[32:35],a[144:147],0
ds_read_b64_tr_b16 v[56:57],v10 offset:49664
M v[132:135],v[36:39],a[148:151],v[132:135]
ds_read_b64_tr_b16 v[58:59],v10 offset:53760
M v[132:135],v[40:43],a[152:155],v[132:135]
ds_read_b64_tr_b16 v[60:61],v10 offset:57856
M v[132:135],v[44:47],a[156:159],v[132:135]
ds_read_b64_tr_b16 v[62:63],v10 offset:61952
M v[136:139],v[32:35],a[160:163],0
v_exp_f32 v94,v94
M v[136:139],v[36:39],a[164:167],v[136:139]
v_exp_f32 v95,v95
M v[136:139],v[40:43],a[168:171],v[136:139]
v_exp_f32 v96,v96
M v[136:139],v[44:47],a[172:175],v[136:139]
v_exp_f32 v97,v97
M v[140:143],v[32:35],a[176:179],0
v_exp_f32 v98,v98
M v[140:143],v[36:39],a[180:183],v[140:143]
v_exp_f32 v99,v99
M v[140:143],v[40:43],a[184:187],v[140:143]
v_exp_f32 v100,v100
M v[140:143],v[44:47],a[188:191],v[140:143]
s_waitcnt lgkmcnt(0)
v_cvt_pk_bf16_f32 v223,v94,v95
M a[16:19],v[48:51],v[224:227],a[16:19]
ds_read_b128 v[32:35],v8 offset:28672
M a[16:19],v[52:55],v[228:231],a[16:19]
v_exp_f32 v101,v101
M a[48:51],v[48:51],v[232:235],a[48:51]
ds_read_b128 v[36:39],v8 offset:28928
M a[48:51],v[52:55],v[236:239],a[48:51]
v_exp_f32 v102,v102
M a[80:83],v[48:51],v[240:243],a[80:83]
ds_read_b128 v[40:43],v8 offset:29184
M a[80:83],v[52:55],v[244:247],a[80:83]
v_exp_f32 v103,v103
M a[112:115],v[48:51],v[248:251],a[112:115]
ds_read_b128 v[44:47],v8 offset:29440
M a[112:115],v[52:55],v[252:255],a[112:115]
v_exp_f32 v104,v104
M a[20:23],v[56:59],v[224:227],a[20:23]
v_exp_f32 v105,v105
M a[20:23],v[60:63],v[228:231],a[20:23]
v_exp_f32 v106,v106
M a[52:55],v[56:59],v[232:235],a[52:55]
v_exp_f32 v107,v107
M a[52:55],v[60:63],v[236:239],a[52:55]
v_exp_f32 v108,v108
M a[84:87],v[56:59],v[240:243],a[84:87]
v_exp_f32 v109,v109
M a[84:87],v[60:63],v[244:247],a[84:87]
v_exp_f32 v110,v110
M a[116:119],v[56:59],v[248:251],a[116:119]
v_exp_f32 v111,v111
M a[116:119],v[60:63],v[252:255],a[116:119]
v_exp_f32 v112,v112
M v[168:171],v[176:179],v[240:243],v[168:171]
v_exp_f32 v113,v113
M v[168:171],v[176:179],v[244:247],v[168:171]
s_waitcnt lgkmcnt(0)
M v[144:147],v[32:35],a[128:131],0
ds_read_b64_tr_b16 v[48:49],v9 offset:49920
M v[144:147],v[36:39],a[132:135],v[144:147]
ds_read_b64_tr_b16 v[50:51],v9 offset:54016
M v[144:147],v[40:43],a[136:139],v[144:147]
ds_read_b64_tr_b16 v[52:53],v9 offset:58112
M v[144:147],v[44:47],a[140:143],v[144:147]
ds_read_b64_tr_b16 v[54:55],v9 offset:62208
M v[148:151],v[32:35],a[144:147],0
ds_read_b64_tr_b16 v[56:57],v10 offset:49920
M v[148:151],v[36:39],a[148:151],v[148:151]
ds_read_b64_tr_b16 v[58:59],v10 offset:54016
M v[148:151],v[40:43],a[152:155],v[148:151]
ds_read_b64_tr_b16 v[60:61],v10 offset:58112
M v[148:151],v[44:47],a[156:159],v[148:151]
ds_read_b64_tr_b16 v[62:63],v10 offset:62208
M v[152:155],v[32:35],a[160:163],0
v_exp_f32 v114,v114
M v[152:155],v[36:39],a[164:167],v[152:155]
v_exp_f32 v115,v115
M v[152:155],v[40:43],a[168:171],v[152:155]
v_exp_f32 v116,v116
M v[152:155],v[44:47],a[172:175],v[152:155]
v_exp_f32 v117,v117
M v[156:159],v[32:35],a[176:179],0
v_exp_f32 v118,v118
M v[156:159],v[36:39],a[180:183],v[156:159]
v_exp_f32 v119,v119
M v[156:159],v[40:43],a[184:187],v[156:159]
v_exp_f32 v120,v120
M v[156:159],v[44:47],a[188:191],v[156:159]
s_waitcnt lgkmcnt(0)
s_barrier
M a[24:27],v[48:51],v[224:227],a[24:27]
ds_read_b128 v[32:35],v8 offset:32768
M a[24:27],v[52:55],v[228:231],a[24:27]
v_exp_f32 v121,v121
M a[56:59],v[48:51],v[232:235],a[56:59]
ds_read_b128 v[36:39],v8 offset:33024
M a[56:59],v[52:55],v[236:239],a[56:59]
v_exp_f32 v122,v122
M a[88:91],v[48:51],v[240:243],a[88:91]
ds_read_b128 v[40:43],v8 offset:33280
M a[88:91],v[52:55],v[244:247],a[88:91]
v_exp_f32 v123,v123
M a[120:123],v[48:51],v[248:251],a[120:123]
ds_read_b128 v[44:47],v8 offset:33536
M a[120:123],v[52:55],v[252:255],a[120:123]
v_exp_f32 v124,v124
M a[28:31],v[56:59],v[224:227],a[28:31]
v_exp_f32 v125,v125
M a[28:31],v[60:63],v[228:231],a[28:31]
v_exp_f32 v126,v126
M a[60:63],v[56:59],v[232:235],a[60:63]
v_exp_f32 v127,v127
M a[60:63],v[60:63],v[236:239],a[60:63]
v_exp_f32 v128,v128
M a[92:95],v[56:59],v[240:243],a[92:95]
v_exp_f32 v129,v129
M a[92:95],v[60:63],v[244:247],a[92:95]
v_exp_f32 v130,v130
M a[124:127],v[56:59],v[248:251],a[124:127]
v_exp_f32 v131,v131
M a[124:127],v[60:63],v[252:255],a[124:127]
v_exp_f32 v132,v132
M v[172:175],v[176:179],v[248:251],v[172:175]
v_exp_f32 v133,v133
M v[172:175],v[176:179],v[252:255],v[172:175]
s_waitcnt lgkmcnt(0)
v_cvt_pk_bf16_f32 v224,v96,v97
M v[64:67],v[32:35],a[128:131],0
ds_read_b64_tr_b16 v[48:49],v9
v_cvt_pk_bf16_f32 v225,v98,v99
M v[64:67],v[36:39],a[132:135],v[64:67]
ds_read_b64_tr_b16 v[50:51],v9 offset:4096
v_cvt_pk_bf16_f32 v232,v100,v101
M v[64:67],v[40:43],a[136:139],v[64:67]
ds_read_b64_tr_b16 v[52:53],v9 offset:8192
v_cvt_pk_bf16_f32 v233,v102,v103
M v[64:67],v[44:47],a[140:143],v[64:67]
ds_read_b64_tr_b16 v[54:55],v9 offset:12288
v_cvt_pk_bf16_f32 v240,v104,v105
M v[68:71],v[32:35],a[144:147],0
ds_read_b64_tr_b16 v[56:57],v10
v_cvt_pk_bf16_f32 v241,v106,v107
M v[68:71],v[36:39],a[148:151],v[68:71]
ds_read_b64_tr_b16 v[58:59],v10 offset:4096
v_cvt_pk_bf16_f32 v248,v108,v109
M v[68:71],v[40:43],a[152:155],v[68:71]
ds_read_b64_tr_b16 v[60:61],v10 offset:8192
v_cvt_pk_bf16_f32 v249,v110,v111
M v[68:71],v[44:47],a[156:159],v[68:71]
ds_read_b64_tr_b16 v[62:63],v10 offset:12288
v_cvt_pk_bf16_f32 v226,v112,v113
M v[72:75],v[32:35],a[160:163],0
v_exp_f32 v134,v134
M v[72:75],v[36:39],a[164:167],v[72:75]
v_exp_f32 v135,v135
M v[72:75],v[40:43],a[168:171],v[72:75]
v_exp_f32 v136,v136
M v[72:75],v[44:47],a[172:175],v[72:75]
v_exp_f32 v137,v137
M v[76:79],v[32:35],a[176:179],0
v_exp_f32 v138,v138
M v[76:79],v[36:39],a[180:183],v[76:79]
v_exp_f32 v139,v139
M v[76:79],v[40:43],a[184:187],v[76:79]
v_exp_f32 v140,v140
M v[76:79],v[44:47],a[188:191],v[76:79]
s_waitcnt lgkmcnt(0)
v_cvt_pk_bf16_f32 v227,v114,v115
M a[0:3],v[48:51],v[192:195],a[0:3]
ds_read_b128 v[32:35],v8 offset:36864
v_cvt_pk_bf16_f32 v234,v116,v117
M a[0:3],v[52:55],v[196:199],a[0:3]
v_exp_f32 v141,v141
M a[32:35],v[48:51],v[200:203],a[32:35]
ds_read_b128 v[36:39],v8 offset:37120
v_cvt_pk_bf16_f32 v235,v118,v119
M a[32:35],v[52:55],v[204:207],a[32:35]
v_exp_f32 v142,v142
M a[64:67],v[48:51],v[208:211],a[64:67]
ds_read_b128 v[40:43],v8 offset:37376
v_cvt_pk_bf16_f32 v242,v120,v121
M a[64:67],v[52:55],v[212:215],a[64:67]
v_exp_f32 v143,v143
M a[96:99],v[48:51],v[216:219],a[96:99]
ds_read_b128 v[44:47],v8 offset:37632
v_cvt_pk_bf16_f32 v243,v122,v123
M a[96:99],v[52:55],v[220:223],a[96:99]
v_exp_f32 v144,v144
M a[4:7],v[56:59],v[192:195],a[4:7]
v_exp_f32 v145,v145
M a[4:7],v[60:63],v[196:199],a[4:7]
v_exp_f32 v146,v146
M a[36:39],v[56:59],v[200:203],a[36:39]
v_exp_f32 v147,v147
M a[36:39],v[60:63],v[204:207],a[36:39]
v_exp_f32 v148,v148
M a[68:71],v[56:59],v[208:211],a[68:71]
v_exp_f32 v149,v149
M a[68:71],v[60:63],v[212:215],a[68:71]
v_exp_f32 v150,v150
M a[100:103],v[56:59],v[216:219],a[100:103]
v_exp_f32 v151,v151
M a[100:103],v[60:63],v[220:223],a[100:103]
v_exp_f32 v152,v152
M v[160:163],v[176:179],v[192:195],v[160:163]
v_exp_f32 v153,v153
M v[160:163],v[176:179],v[196:199],v[160:163]
s_waitcnt lgkmcnt(0)
v_cvt_pk_bf16_f32 v250,v124,v125
M v[80:83],v[32:35],a[128:131],0
ds_read_b64_tr_b16 v[48:49],v9 offset:256
v_cvt_pk_bf16_f32 v251,v126,v127
M v[80:83],v[36:39],a[132:135],v[80:83]
ds_read_b64_tr_b16 v[50:51],v9 offset:4352
v_cvt_pk_bf16_f32 v228,v128,v129
M v[80:83],v[40:43],a[136:139],v[80:83]
ds_read_b64_tr_b16 v[52:53],v9 offset:8448
v_cvt_pk_bf16_f32 v229,v130,v131
M v[80:83],v[44:47],a[140:143],v[80:83]
ds_read_b64_tr_b16 v[54:55],v9 offset:12544
v_cvt_pk_bf16_f32 v236,v132,v133
M v[84:87],v[32:35],a[144:147],0
ds_read_b64_tr_b16 v[56:57],v10 offset:256
v_cvt_pk_bf16_f32 v237,v134,v135
M v[84:87],v[36:39],a[148:151],v[84:87]
ds_read_b64_tr_b16 v[58:59],v10 offset:4352
v_cvt_pk_bf16_f32 v244,v136,v137
M v[84:87],v[40:43],a[152:155],v[84:87]
ds_read_b64_tr_b16 v[60:61],v10 offset:8448
v_cvt_pk_bf16_f32 v245,v138,v139
M v[84:87],v[44:47],a[156:159],v[84:87]
ds_read_b64_tr_b16 v[62:63],v10 offset:12544
v_cvt_pk_bf16_f32 v252,v140,v141
M v[88:91],v[32:35],a[160:163],0
v_exp_f32 v154,v154
M v[88:91],v[36:39],a[164:167],v[88:91]
v_exp_f32 v155,v155
M v[88:91],v[40:43],a[168:171],v[88:91]
v_exp_f32 v156,v156
M v[88:91],v[44:47],a[172:175],v[88:91]
v_exp_f32 v157,v157
M v[92:95],v[32:35],a[176:179],0
v_exp_f32 v158,v158
M v[92:95],v[36:39],a[180:183],v[92:95]
v_exp_f32 v159,v159
M v[92:95],v[40:43],a[184:187],v[92:95]
v_exp_f32 v64,v64
M v[92:95],v[44:47],a[188:191],v[92:95]
s_waitcnt lgkmcnt(0)
v_cvt_pk_bf16_f32 v253,v142,v143
M a[8:11],v[48:51],v[192:195],a[8:11]
ds_read_b128 v[32:35],v8 offset:40960
v_cvt_pk_bf16_f32 v230,v144,v145
M a[8:11],v[52:55],v[196:199],a[8:11]
v_exp_f32 v65,v65
M a[40:43],v[48:51],v[200:203],a[40:43]
ds_read_b128 v[36:39],v8 offset:41216
v_cvt_pk_bf16_f32 v231,v146,v147
M a[40:43],v[52:55],v[204:207],a[40:43]
v_exp_f32 v66,v66
M a[72:75],v[48:51],v[208:211],a[72:75]
ds_read_b128 v[40:43],v8 offset:41472
v_cvt_pk_bf16_f32 v238,v148,v149
M a[72:75],v[52:55],v[212:215],a[72:75]
v_exp_f32 v67,v67
M a[104:107],v[48:51],v[216:219],a[104:107]
ds_read_b128 v[44:47],v8 offset:41728
v_cvt_pk_bf16_f32 v239,v150,v151
M a[104:107],v[52:55],v[220:223],a[104:107]
v_exp_f32 v68,v68
M a[12:15],v[56:59],v[192:195],a[12:15]
v_exp_f32 v69,v69
M a[12:15],v[60:63],v[196:199],a[12:15]
v_exp_f32 v70,v70
M a[44:47],v[56:59],v[200:203],a[44:47]
v_exp_f32 v71,v71
M a[44:47],v[60:63],v[204:207],a[44:47]
v_exp_f32 v72,v72
M a[76:79],v[56:59],v[208:211],a[76:79]
v_exp_f32 v73,v73
M a[76:79],v[60:63],v[212:215],a[76:79]
v_exp_f32 v74,v74
M a[108:111],v[56:59],v[216:219],a[108:111]
v_exp_f32 v75,v75
M a[108:111],v[60:63],v[220:223],a[108:111]
v_exp_f32 v76,v76
M v[164:167],v[176:179],v[200:203],v[164:167]
v_exp_f32 v77,v77
M v[164:167],v[176:179],v[204:207],v[164:167]
s_waitcnt lgkmcnt(0)
v_cvt_pk_bf16_f32 v246,v152,v153
M v[96:99],v[32:35],a[128:131],0
ds_read_b64_tr_b16 v[48:49],v9 offset:512
v_cvt_pk_bf16_f32 v247,v154,v155
M v[96:99],v[36:39],a[132:135],v[96:99]
ds_read_b64_tr_b16 v[50:51],v9 offset:4608
v_cvt_pk_bf16_f32 v254,v156,v157
M v[96:99],v[40:43],a[136:139],v[96:99]
ds_read_b64_tr_b16 v[52:53],v9 offset:8704
v_cvt_pk_bf16_f32 v255,v158,v159
M v[96:99],v[44:47],a[140:143],v[96:99]
ds_read_b64_tr_b16 v[54:55],v9 offset:12800
M v[100:103],v[32:35],a[144:147],0
ds_read_b64_tr_b16 v[56:57],v10 offset:512
M v[100:103],v[36:39],a[148:151],v[100:103]
ds_read_b64_tr_b16 v[58:59],v10 offset:4608
M v[100:103],v[40:43],a[152:155],v[100:103]
ds_read_b64_tr_b16 v[60:61],v10 offset:8704
M v[100:103],v[44:47],a[156:159],v[100:103]
ds_read_b64_tr_b16 v[62:63],v10 offset:12800
M v[104:107],v[32:35],a[160:163],0
v_exp_f32 v78,v78
M v[104:107],v[36:39],a[164:167],v[104:107]
v_exp_f32 v79,v79
M v[104:107],v[40:43],a[168:171],v[104:107]
v_exp_f32 v80,v80
M v[104:107],v[44:47],a[172:175],v[104:107]
v_exp_f32 v81,v81
M v[108:111],v[32:35],a[176:179],0
v_exp_f32 v82,v82
M v[108:111],v[36:39],a[180:183],v[108:111]
v_exp_f32 v83,v83
M v[108:111],v[40:43],a[184:187],v[108:111]
v_exp_f32 v84,v84
M v[108:111],v[44:47],a[188:191],v[108:111]
s_waitcnt lgkmcnt(0)
M a[16:19],v[48:51],v[192:195],a[16:19]
ds_read_b128 v[32:35],v8 offset:45056
M a[16:19],v[52:55],v[196:199],a[16:19]
v_exp_f32 v85,v85
M a[48:51],v[48:51],v[200:203],a[48:51]
ds_read_b128 v[36:39],v8 offset:45312
M a[48:51],v[52:55],v[204:207],a[48:51]
v_exp_f32 v86,v86
M a[80:83],v[48:51],v[208:211],a[80:83]
ds_read_b128 v[40:43],v8 offset:45568
M a[80:83],v[52:55],v[212:215],a[80:83]
v_exp_f32 v87,v87
M a[112:115],v[48:51],v[216:219],a[112:115]
ds_read_b128 v[44:47],v8 offset:45824
M a[112:115],v[52:55],v[220:223],a[112:115]
v_exp_f32 v88,v88
M a[20:23],v[56:59],v[192:195],a[20:23]
v_exp_f32 v89,v89
M a[20:23],v[60:63],v[196:199],a[20:23]
v_exp_f32 v90,v90
M a[52:55],v[56:59],v[200:203],a[52:55]
v_exp_f32 v91,v91
M a[52:55],v[60:63],v[204:207],a[52:55]
v_exp_f32 v92,v92
M a[84:87],v[56:59],v[208:211],a[84:87]
v_exp_f32 v93,v93
M a[84:87],v[60:63],v[212:215],a[84:87]
v_exp_f32 v94,v94
M a[116:119],v[56:59],v[216:219],a[116:119]
v_exp_f32 v95,v95
M a[116:119],v[60:63],v[220:223],a[116:119]
v_exp_f32 v96,v96
M v[168:171],v[176:179],v[208:211],v[168:171]
v_exp_f32 v97,v97
M v[168:171],v[176:179],v[212:215],v[168:171]
s_waitcnt lgkmcnt(0)
M v[112:115],v[32:35],a[128:131],0
ds_read_b64_tr_b16 v[48:49],v9 offset:768
M v[112:115],v[36:39],a[132:135],v[112:115]
ds_read_b64_tr_b16 v[50:51],v9 offset:4864
M v[112:115],v[40:43],a[136:139],v[112:115]
ds_read_b64_tr_b16 v[52:53],v9 offset:8960
M v[112:115],v[44:47],a[140:143],v[112:115]
ds_read_b64_tr_b16 v[54:55],v9 offset:13056
M v[116:119],v[32:35],a[144:147],0
ds_read_b64_tr_b16 v[56:57],v10 offset:768
M v[116:119],v[36:39],a[148:151],v[116:119]
ds_read_b64_tr_b16 v[58:59],v10 offset:4864
M v[116:119],v[40:43],a[152:155],v[116:119]
ds_read_b64_tr_b16 v[60:61],v10 offset:8960
M v[116:119],v[44:47],a[156:159],v[116:119]
ds_read_b64_tr_b16 v[62:63],v10 offset:13056
M v[120:123],v[32:35],a[160:163],0
v_exp_f32 v98,v98
M v[120:123],v[36:39],a[164:167],v[120:123]
v_exp_f32 v99,v99
M v[120:123],v[40:43],a[168:171],v[120:123]
v_exp_f32 v100,v100
M v[120:123],v[44:47],a[172:175],v[120:123]
v_exp_f32 v101,v101
M v[124:127],v[32:35],a[176:179],0
v_exp_f32 v102,v102
M v[124:127],v[36:39],a[180:183],v[124:127]
v_exp_f32 v103,v103
M v[124:127],v[40:43],a[184:187],v[124:127]
v_exp_f32 v104,v104
M v[124:127],v[44:47],a[188:191],v[124:127]
s_waitcnt lgkmcnt(0)
s_barrier
M a[24:27],v[48:51],v[192:195],a[24:27]
ds_read_b128 v[32:35],v8 offset:49152
M a[24:27],v[52:55],v[196:199],a[24:27]
v_exp_f32 v105,v105
M a[56:59],v[48:51],v[200:203],a[56:59]
ds_read_b128 v[36:39],v8 offset:49408
M a[56:59],v[52:55],v[204:207],a[56:59]
v_exp_f32 v106,v106
M a[88:91],v[48:51],v[208:211],a[88:91]
ds_read_b128 v[40:43],v8 offset:49664
M a[88:91],v[52:55],v[212:215],a[88:91]
v_exp_f32 v107,v107
M a[120:123],v[48:51],v[216:219],a[120:123]
ds_read_b128 v[44:47],v8 offset:49920
M a[120:123],v[52:55],v[220:223],a[120:123]
v_exp_f32 v108,v108
M a[28:31],v[56:59],v[192:195],a[28:31]
v_exp_f32 v109,v109
M a[28:31],v[60:63],v[196:199],a[28:31]
v_exp_f32 v110,v110
M a[60:63],v[56:59],v[200:203],a[60:63]
v_exp_f32 v111,v111
M a[60:63],v[60:63],v[204:207],a[60:63]
v_exp_f32 v112,v112
M a[92:95],v[56:59],v[208:211],a[92:95]
v_exp_f32 v113,v113
M a[92:95],v[60:63],v[212:215],a[92:95]
v_exp_f32 v114,v114
M a[124:127],v[56:59],v[216:219],a[124:127]
v_exp_f32 v115,v115
M a[124:127],v[60:63],v[220:223],a[124:127]
v_exp_f32 v116,v116
M v[172:175],v[176:179],v[216:219],v[172:175]
v_exp_f32 v117,v117
M v[172:175],v[176:179],v[220:223],v[172:175]
s_waitcnt lgkmcnt(0)
v_cvt_pk_bf16_f32 v192,v64,v65
M v[128:131],v[32:35],a[128:131],0
ds_read_b64_tr_b16 v[48:49],v9 offset:16384
v_cvt_pk_bf16_f32 v193,v66,v67
M v[128:131],v[36:39],a[132:135],v[128:131]
ds_read_b64_tr_b16 v[50:51],v9 offset:20480
v_cvt_pk_bf16_f32 v200,v68,v69
M v[128:131],v[40:43],a[136:139],v[128:131]
ds_read_b64_tr_b16 v[52:53],v9 offset:24576
v_cvt_pk_bf16_f32 v201,v70,v71
M v[128:131],v[44:47],a[140:143],v[128:131]
ds_read_b64_tr_b16 v[54:55],v9 offset:28672
v_cvt_pk_bf16_f32 v208,v72,v73
M v[132:135],v[32:35],a[144:147],0
ds_read_b64_tr_b16 v[56:57],v10 offset:16384
v_cvt_pk_bf16_f32 v209,v74,v75
M v[132:135],v[36:39],a[148:151],v[132:135]
ds_read_b64_tr_b16 v[58:59],v10 offset:20480
v_cvt_pk_bf16_f32 v216,v76,v77
M v[132:135],v[40:43],a[152:155],v[132:135]
ds_read_b64_tr_b16 v[60:61],v10 offset:24576
v_cvt_pk_bf16_f32 v217,v78,v79
M v[132:135],v[44:47],a[156:159],v[132:135]
ds_read_b64_tr_b16 v[62:63],v10 offset:28672
v_cvt_pk_bf16_f32 v194,v80,v81
M v[136:139],v[32:35],a[160:163],0
v_exp_f32 v118,v118
M v[136:139],v[36:39],a[164:167],v[136:139]
v_exp_f32 v119,v119
M v[136:139],v[40:43],a[168:171],v[136:139]
v_exp_f32 v120,v120
M v[136:139],v[44:47],a[172:175],v[136:139]
v_exp_f32 v121,v121
M v[140:143],v[32:35],a[176:179],0
v_exp_f32 v122,v122
M v[140:143],v[36:39],a[180:183],v[140:143]
v_exp_f32 v123,v123
M v[140:143],v[40:43],a[184:187],v[140:143]
v_exp_f32 v124,v124
M v[140:143],v[44:47],a[188:191],v[140:143]
s_waitcnt lgkmcnt(0)
v_cvt_pk_bf16_f32 v195,v82,v83
M a[0:3],v[48:51],v[224:227],a[0:3]
ds_read_b128 v[32:35],v8 offset:53248
v_cvt_pk_bf16_f32 v202,v84,v85
M a[0:3],v[52:55],v[228:231],a[0:3]
v_exp_f32 v125,v125
M a[32:35],v[48:51],v[232:235],a[32:35]
ds_read_b128 v[36:39],v8 offset:53504
v_cvt_pk_bf16_f32 v203,v86,v87
M a[32:35],v[52:55],v[236:239],a[32:35]
v_exp_f32 v126,v126
M a[64:67],v[48:51],v[240:243],a[64:67]
ds_read_b128 v[40:43],v8 offset:53760
v_cvt_pk_bf16_f32 v210,v88,v89
M a[64:67],v[52:55],v[244:247],a[64:67]
v_exp_f32 v127,v127
M a[96:99],v[48:51],v[248:251],a[96:99]
ds_read_b128 v[44:47],v8 offset:54016
v_cvt_pk_bf16_f32 v211,v90,v91
M a[96:99],v[52:55],v[252:255],a[96:99]
v_exp_f32 v128,v128
M a[4:7],v[56:59],v[224:227],a[4:7]
v_exp_f32 v129,v129
M a[4:7],v[60:63],v[228:231],a[4:7]
v_exp_f32 v130,v130
M a[36:39],v[56:59],v[232:235],a[36:39]
v_exp_f32 v131,v131
M a[36:39],v[60:63],v[236:239],a[36:39]
v_exp_f32 v132,v132
M a[68:71],v[56:59],v[240:243],a[68:71]
v_exp_f32 v133,v133
M a[68:71],v[60:63],v[244:247],a[68:71]
v_exp_f32 v134,v134
M a[100:103],v[56:59],v[248:251],a[100:103]
v_exp_f32 v135,v135
M a[100:103],v[60:63],v[252:255],a[100:103]
v_exp_f32 v136,v136
M v[160:163],v[176:179],v[224:227],v[160:163]
v_exp_f32 v137,v137
M v[160:163],v[176:179],v[228:231],v[160:163]
s_waitcnt lgkmcnt(0)
v_cvt_pk_bf16_f32 v218,v92,v93
M v[144:147],v[32:35],a[128:131],0
ds_read_b64_tr_b16 v[48:49],v9 offset:16640
v_cvt_pk_bf16_f32 v219,v94,v95
M v[144:147],v[36:39],a[132:135],v[144:147]
ds_read_b64_tr_b16 v[50:51],v9 offset:20736
v_cvt_pk_bf16_f32 v196,v96,v97
M v[144:147],v[40:43],a[136:139],v[144:147]
ds_read_b64_tr_b16 v[52:53],v9 offset:24832
v_cvt_pk_bf16_f32 v197,v98,v99
M v[144:147],v[44:47],a[140:143],v[144:147]
ds_read_b64_tr_b16 v[54:55],v9 offset:28928
v_cvt_pk_bf16_f32 v204,v100,v101
M v[148:151],v[32:35],a[144:147],0
ds_read_b64_tr_b16 v[56:57],v10 offset:16640
v_cvt_pk_bf16_f32 v205,v102,v103
M v[148:151],v[36:39],a[148:151],v[148:151]
ds_read_b64_tr_b16 v[58:59],v10 offset:20736
v_cvt_pk_bf16_f32 v212,v104,v105
M v[148:151],v[40:43],a[152:155],v[148:151]
ds_read_b64_tr_b16 v[60:61],v10 offset:24832
v_cvt_pk_bf16_f32 v213,v106,v107
M v[148:151],v[44:47],a[156:159],v[148:151]
ds_read_b64_tr_b16 v[62:63],v10 offset:28928
v_cvt_pk_bf16_f32 v220,v108,v109
M v[152:155],v[32:35],a[160:163],0
v_exp_f32 v138,v138
M v[152:155],v[36:39],a[164:167],v[152:155]
v_exp_f32 v139,v139
M v[152:155],v[40:43],a[168:171],v[152:155]
v_exp_f32 v140,v140
M v[152:155],v[44:47],a[172:175],v[152:155]
v_exp_f32 v141,v141
M v[156:159],v[32:35],a[176:179],0
v_exp_f32 v142,v142
M v[156:159],v[36:39],a[180:183],v[156:159]
v_exp_f32 v143,v143
M v[156:159],v[40:43],a[184:187],v[156:159]
v_exp_f32 v144,v144
M v[156:159],v[44:47],a[188:191],v[156:159]
s_waitcnt lgkmcnt(0)
v_cvt_pk_bf16_f32 v221,v110,v111
M a[8:11],v[48:51],v[224:227],a[8:11]
ds_read_b128 v[32:35],v8 offset:57344
v_cvt_pk_bf16_f32 v198,v112,v113
M a[8:11],v[52:55],v[228:231],a[8:11]
v_exp_f32 v145,v145
M a[40:43],v[48:51],v[232:235],a[40:43]
ds_read_b128 v[36:39],v8 offset:57600
v_cvt_pk_bf16_f32 v199,v114,v115
M a[40:43],v[52:55],v[236:239],a[40:43]
v_exp_f32 v146,v146
M a[72:75],v[48:51],v[240:243],a[72:75]
ds_read_b128 v[40:43],v8 offset:57856
v_cvt_pk_bf16_f32 v206,v116,v117
M a[72:75],v[52:55],v[244:247],a[72:75]
v_exp_f32 v147,v147
M a[104:107],v[48:51],v[248:251],a[104:107]
ds_read_b128 v[44:47],v8 offset:58112
v_cvt_pk_bf16_f32 v207,v118,v119
M a[104:107],v[52:55],v[252:255],a[104:107]
v_exp_f32 v148,v148
M a[12:15],v[56:59],v[224:227],a[12:15]
v_exp_f32 v149,v149
M a[12:15],v[60:63],v[228:231],a[12:15]
v_exp_f32 v150,v150
M a[44:47],v[56:59],v[232:235],a[44:47]
v_exp_f32 v151,v151
M a[44:47],v[60:63],v[236:239],a[44:47]
v_exp_f32 v152,v152
M a[76:79],v[56:59],v[240:243],a[76:79]
v_exp_f32 v153,v153
M a[76:79],v[60:63],v[244:247],a[76:79]
v_exp_f32 v154,v154
M a[108:111],v[56:59],v[248:251],a[108:111]
v_exp_f32 v155,v155
M a[108:111],v[60:63],v[252:255],a[108:111]
v_exp_f32 v156,v156
M v[164:167],v[176:179],v[232:235],v[164:167]
v_exp_f32 v157,v157
M v[164:167],v[176:179],v[236:239],v[164:167]
s_waitcnt lgkmcnt(0)
v_cvt_pk_bf16_f32 v214,v120,v121
M v[64:67],v[32:35],a[128:131],0
ds_read_b64_tr_b16 v[48:49],v9 offset:16896
v_cvt_pk_bf16_f32 v215,v122,v123
M v[64:67],v[36:39],a[132:135],v[64:67]
ds_read_b64_tr_b16 v[50:51],v9 offset:20992
v_cvt_pk_bf16_f32 v222,v124,v125
M v[64:67],v[40:43],a[136:139],v[64:67]
ds_read_b64_tr_b16 v[52:53],v9 offset:25088
v_cvt_pk_bf16_f32 v223,v126,v127
M v[64:67],v[44:47],a[140:143],v[64:67]
ds_read_b64_tr_b16 v[54:55],v9 offset:29184
M v[68:71],v[32:35],a[144:147],0
ds_read_b64_tr_b16 v[56:57],v10 offset:16896
M v[68:71],v[36:39],a[148:151],v[68:71]
ds_read_b64_tr_b16 v[58:59],v10 offset:20992
M v[68:71],v[40:43],a[152:155],v[68:71]
ds_read_b64_tr_b16 v[60:61],v10 offset:25088
M v[68:71],v[44:47],a[156:159],v[68:71]
ds_read_b64_tr_b16 v[62:63],v10 offset:29184
M v[72:75],v[32:35],a[160:163],0
v_exp_f32 v158,v158
M v[72:75],v[36:39],a[164:167],v[72:75]
v_exp_f32 v159,v159
M v[72:75],v[40:43],a[168:171],v[72:75]
v_exp_f32 v64,v64
M v[72:75],v[44:47],a[172:175],v[72:75]
v_exp_f32 v65,v65
M v[76:79],v[32:35],a[176:179],0
v_exp_f32 v66,v66
M v[76:79],v[36:39],a[180:183],v[76:79]
v_exp_f32 v67,v67
M v[76:79],v[40:43],a[184:187],v[76:79]
v_exp_f32 v68,v68
M v[76:79],v[44:47],a[188:191],v[76:79]
s_waitcnt lgkmcnt(0)
M a[16:19],v[48:51],v[224:227],a[16:19]
ds_read_b128 v[32:35],v8 offset:61440
M a[16:19],v[52:55],v[228:231],a[16:19]
v_exp_f32 v69,v69
M a[48:51],v[48:51],v[232:235],a[48:51]
ds_read_b128 v[36:39],v8 offset:61696
M a[48:51],v[52:55],v[236:239],a[48:51]
v_exp_f32 v70,v70
M a[80:83],v[48:51],v[240:243],a[80:83]
ds_read_b128 v[40:43],v8 offset:61952
M a[80:83],v[52:55],v[244:247],a[80:83]
v_exp_f32 v71,v71
M a[112:115],v[48:51],v[248:251],a[112:115]
ds_read_b128 v[44:47],v8 offset:62208
M a[112:115],v[52:55],v[252:255],a[112:115]
v_exp_f32 v72,v72
M a[20:23],v[56:59],v[224:227],a[20:23]
v_exp_f32 v73,v73
M a[20:23],v[60:63],v[228:231],a[20:23]
v_exp_f32 v74,v74
M a[52:55],v[56:59],v[232:235],a[52:55]
v_exp_f32 v75,v75
M a[52:55],v[60:63],v[236:239],a[52:55]
v_exp_f32 v76,v76
M a[84:87],v[56:59],v[240:243],a[84:87]
v_exp_f32 v77,v77
M a[84:87],v[60:63],v[244:247],a[84:87]
v_exp_f32 v78,v78
M a[116:119],v[56:59],v[248:251],a[116:119]
v_exp_f32 v79,v79
M a[116:119],v[60:63],v[252:255],a[116:119]
M v[168:171],v[176:179],v[240:243],v[168:171]
M v[168:171],v[176:179],v[244:247],v[168:171]
s_waitcnt lgkmcnt(0)
M v[80:83],v[32:35],a[128:131],0
ds_read_b64_tr_b16 v[48:49],v9 offset:17152
M v[80:83],v[36:39],a[132:135],v[80:83]
ds_read_b64_tr_b16 v[50:51],v9 offset:21248
M v[80:83],v[40:43],a[136:139],v[80:83]
ds_read_b64_tr_b16 v[52:53],v9 offset:25344
M v[80:83],v[44:47],a[140:143],v[80:83]
ds_read_b64_tr_b16 v[54:55],v9 offset:29440
M v[84:87],v[32:35],a[144:147],0
ds_read_b64_tr_b16 v[56:57],v10 offset:17152
M v[84:87],v[36:39],a[148:151],v[84:87]
ds_read_b64_tr_b16 v[58:59],v10 offset:21248
M v[84:87],v[40:43],a[152:155],v[84:87]
ds_read_b64_tr_b16 v[60:61],v10 offset:25344
M v[84:87],v[44:47],a[156:159],v[84:87]
ds_read_b64_tr_b16 v[62:63],v10 offset:29440
M v[88:91],v[32:35],a[160:163],0
v_exp_f32 v80,v80
M v[88:91],v[36:39],a[164:167],v[88:91]
v_exp_f32 v81,v81
M v[88:91],v[40:43],a[168:171],v[88:91]
v_exp_f32 v82,v82
M v[88:91],v[44:47],a[172:175],v[88:91]
v_exp_f32 v83,v83
M v[92:95],v[32:35],a[176:179],0
v_exp_f32 v84,v84
M v[92:95],v[36:39],a[180:183],v[92:95]
v_exp_f32 v85,v85
M v[92:95],v[40:43],a[184:187],v[92:95]
v_exp_f32 v86,v86
M v[92:95],v[44:47],a[188:191],v[92:95]
s_waitcnt lgkmcnt(0)
s_barrier
M a[24:27],v[48:51],v[224:227],a[24:27]
ds_read_b128 v[32:35],v8
M a[24:27],v[52:55],v[228:231],a[24:27]
v_exp_f32 v87,v87
M a[56:59],v[48:51],v[232:235],a[56:59]
ds_read_b128 v[36:39],v8 offset:256
M a[56:59],v[52:55],v[236:239],a[56:59]
v_exp_f32 v88,v88
M a[88:91],v[48:51],v[240:243],a[88:91]
ds_read_b128 v[40:43],v8 offset:512
M a[88:91],v[52:55],v[244:247],a[88:91]
v_exp_f32 v89,v89
M a[120:123],v[48:51],v[248:251],a[120:123]
ds_read_b128 v[44:47],v8 offset:768
M a[120:123],v[52:55],v[252:255],a[120:123]
v_exp_f32 v90,v90
M a[28:31],v[56:59],v[224:227],a[28:31]
v_exp_f32 v91,v91
M a[28:31],v[60:63],v[228:231],a[28:31]
v_exp_f32 v92,v92
M a[60:63],v[56:59],v[232:235],a[60:63]
v_exp_f32 v93,v93
M a[60:63],v[60:63],v[236:239],a[60:63]
v_exp_f32 v94,v94
M a[92:95],v[56:59],v[240:243],a[92:95]
v_exp_f32 v95,v95
M a[92:95],v[60:63],v[244:247],a[92:95]
v_cvt_pk_bf16_f32 v224,v128,v129
v_cvt_pk_bf16_f32 v225,v130,v131
M a[124:127],v[56:59],v[248:251],a[124:127]
v_cvt_pk_bf16_f32 v232,v132,v133
v_cvt_pk_bf16_f32 v233,v134,v135
M a[124:127],v[60:63],v[252:255],a[124:127]
v_cvt_pk_bf16_f32 v240,v136,v137
v_cvt_pk_bf16_f32 v241,v138,v139
M v[172:175],v[176:179],v[248:251],v[172:175]
v_cvt_pk_bf16_f32 v248,v140,v141
v_cvt_pk_bf16_f32 v249,v142,v143
M v[172:175],v[176:179],v[252:255],v[172:175]
s_waitcnt lgkmcnt(0)
v_cvt_pk_bf16_f32 v226,v144,v145
M v[96:99],v[32:35],a[192:195],0
ds_read_b64_tr_b16 v[48:49],v9 offset:32768
v_cvt_pk_bf16_f32 v227,v146,v147
M v[96:99],v[36:39],a[196:199],v[96:99]
ds_read_b64_tr_b16 v[50:51],v9 offset:36864
v_cvt_pk_bf16_f32 v234,v148,v149
M v[96:99],v[40:43],a[200:203],v[96:99]
ds_read_b64_tr_b16 v[52:53],v9 offset:40960
v_cvt_pk_bf16_f32 v235,v150,v151
M v[96:99],v[44:47],a[204:207],v[96:99]
ds_read_b64_tr_b16 v[54:55],v9 offset:45056
v_cvt_pk_bf16_f32 v242,v152,v153
M v[100:103],v[32:35],a[208:211],0
ds_read_b64_tr_b16 v[56:57],v10 offset:32768
v_cvt_pk_bf16_f32 v243,v154,v155
M v[100:103],v[36:39],a[212:215],v[100:103]
ds_read_b64_tr_b16 v[58:59],v10 offset:36864
v_cvt_pk_bf16_f32 v250,v156,v157
M v[100:103],v[40:43],a[216:219],v[100:103]
ds_read_b64_tr_b16 v[60:61],v10 offset:40960
v_cvt_pk_bf16_f32 v251,v158,v159
M v[100:103],v[44:47],a[220:223],v[100:103]
ds_read_b64_tr_b16 v[62:63],v10 offset:45056
v_cvt_pk_bf16_f32 v228,v64,v65
M v[104:107],v[32:35],a[224:227],0
v_exp_f32 v96,v96
M v[104:107],v[36:39],a[228:231],v[104:107]
v_exp_f32 v97,v97
M v[104:107],v[40:43],a[232:235],v[104:107]
v_exp_f32 v98,v98
M v[104:107],v[44:47],a[236:239],v[104:107]
v_exp_f32 v99,v99
M v[108:111],v[32:35],a[240:243],0
v_exp_f32 v100,v100
M v[108:111],v[36:39],a[244:247],v[108:111]
v_exp_f32 v101,v101
M v[108:111],v[40:43],a[248:251],v[108:111]
v_exp_f32 v102,v102
M v[108:111],v[44:47],a[252:255],v[108:111]
s_waitcnt lgkmcnt(0)
v_cvt_pk_bf16_f32 v229,v66,v67
M a[0:3],v[48:51],v[192:195],a[0:3]
ds_read_b128 v[32:35],v8 offset:4096
v_cvt_pk_bf16_f32 v236,v68,v69
M a[0:3],v[52:55],v[196:199],a[0:3]
v_exp_f32 v103,v103
M a[32:35],v[48:51],v[200:203],a[32:35]
ds_read_b128 v[36:39],v8 offset:4352
v_cvt_pk_bf16_f32 v237,v70,v71
M a[32:35],v[52:55],v[204:207],a[32:35]
v_exp_f32 v104,v104
M a[64:67],v[48:51],v[208:211],a[64:67]
ds_read_b128 v[40:43],v8 offset:4608
v_cvt_pk_bf16_f32 v244,v72,v73
M a[64:67],v[52:55],v[212:215],a[64:67]
v_exp_f32 v105,v105
M a[96:99],v[48:51],v[216:219],a[96:99]
ds_read_b128 v[44:47],v8 offset:4864
v_cvt_pk_bf16_f32 v245,v74,v75
M a[96:99],v[52:55],v[220:223],a[96:99]
v_exp_f32 v106,v106
M a[4:7],v[56:59],v[192:195],a[4:7]
v_exp_f32 v107,v107
M a[4:7],v[60:63],v[196:199],a[4:7]
v_exp_f32 v108,v108
M a[36:39],v[56:59],v[200:203],a[36:39]
v_exp_f32 v109,v109
M a[36:39],v[60:63],v[204:207],a[36:39]
v_exp_f32 v110,v110
M a[68:71],v[56:59],v[208:211],a[68:71]
v_exp_f32 v111,v111
M a[68:71],v[60:63],v[212:215],a[68:71]
v_cvt_pk_bf16_f32 v252,v76,v77
v_cvt_pk_bf16_f32 v253,v78,v79
M a[100:103],v[56:59],v[216:219],a[100:103]
v_cvt_pk_bf16_f32 v230,v80,v81
v_cvt_pk_bf16_f32 v231,v82,v83
M a[100:103],v[60:63],v[220:223],a[100:103]
v_cvt_pk_bf16_f32 v238,v84,v85
v_cvt_pk_bf16_f32 v239,v86,v87
M v[160:163],v[176:179],v[192:195],v[160:163]
v_cvt_pk_bf16_f32 v246,v88,v89
v_cvt_pk_bf16_f32 v247,v90,v91
M v[160:163],v[176:179],v[196:199],v[160:163]
s_waitcnt lgkmcnt(0)
v_cvt_pk_bf16_f32 v254,v92,v93
M v[112:115],v[32:35],a[192:195],0
ds_read_b64_tr_b16 v[48:49],v9 offset:33024
v_cvt_pk_bf16_f32 v255,v94,v95
M v[112:115],v[36:39],a[196:199],v[112:115]
ds_read_b64_tr_b16 v[50:51],v9 offset:37120
M v[112:115],v[40:43],a[200:203],v[112:115]
ds_read_b64_tr_b16 v[52:53],v9 offset:41216
M v[112:115],v[44:47],a[204:207],v[112:115]
ds_read_b64_tr_b16 v[54:55],v9 offset:45312
M v[116:119],v[32:35],a[208:211],0
ds_read_b64_tr_b16 v[56:57],v10 offset:33024
M v[116:119],v[36:39],a[212:215],v[116:119]
ds_read_b64_tr_b16 v[58:59],v10 offset:37120
M v[116:119],v[40:43],a[216:219],v[116:119]
ds_read_b64_tr_b16 v[60:61],v10 offset:41216
M v[116:119],v[44:47],a[220:223],v[116:119]
ds_read_b64_tr_b16 v[62:63],v10 offset:45312
M v[120:123],v[32:35],a[224:227],0
v_exp_f32 v112,v112
M v[120:123],v[36:39],a[228:231],v[120:123]
v_exp_f32 v113,v113
M v[120:123],v[40:43],a[232:235],v[120:123]
v_exp_f32 v114,v114
M v[120:123],v[44:47],a[236:239],v[120:123]
v_exp_f32 v115,v115
M v[124:127],v[32:35],a[240:243],0
v_exp_f32 v116,v116
M v[124:127],v[36:39],a[244:247],v[124:127]
v_exp_f32 v117,v117
M v[124:127],v[40:43],a[248:251],v[124:127]
v_exp_f32 v118,v118
M v[124:127],v[44:47],a[252:255],v[124:127]
s_waitcnt lgkmcnt(0)
M a[8:11],v[48:51],v[192:195],a[8:11]
ds_read_b128 v[32:35],v8 offset:8192
M a[8:11],v[52:55],v[196:199],a[8:11]
v_exp_f32 v119,v119
M a[40:43],v[48:51],v[200:203],a[40:43]
ds_read_b128 v[36:39],v8 offset:8448
M a[40:43],v[52:55],v[204:207],a[40:43]
v_exp_f32 v120,v120
M a[72:75],v[48:51],v[208:211],a[72:75]
ds_read_b128 v[40:43],v8 offset:8704
M a[72:75],v[52:55],v[212:215],a[72:75]
v_exp_f32 v121,v121
M a[104:107],v[48:51],v[216:219],a[104:107]
ds_read_b128 v[44:47],v8 offset:8960
M a[104:107],v[52:55],v[220:223],a[104:107]
v_exp_f32 v122,v122
M a[12:15],v[56:59],v[192:195],a[12:15]
v_exp_f32 v123,v123
M a[12:15],v[60:63],v[196:199],a[12:15]
v_exp_f32 v124,v124
M a[44:47],v[56:59],v[200:203],a[44:47]
v_exp_f32 v125,v125
M a[44:47],v[60:63],v[204:207],a[44:47]
v_exp_f32 v126,v126
M a[76:79],v[56:59],v[208:211],a[76:79]
v_exp_f32 v127,v127
M a[76:79],v[60:63],v[212:215],a[76:79]
M a[108:111],v[56:59],v[216:219],a[108:111]
M a[108:111],v[60:63],v[220:223],a[108:111]
M v[164:167],v[176:179],v[200:203],v[164:167]
M v[164:167],v[176:179],v[204:207],v[164:167]
s_waitcnt lgkmcnt(0)
M v[128:131],v[32:35],a[192:195],0
ds_read_b64_tr_b16 v[48:49],v9 offset:33280
M v[128:131],v[36:39],a[196:199],v[128:131]
ds_read_b64_tr_b16 v[50:51],v9 offset:37376
M v[128:131],v[40:43],a[200:203],v[128:131]
ds_read_b64_tr_b16 v[52:53],v9 offset:41472
M v[128:131],v[44:47],a[204:207],v[128:131]
ds_read_b64_tr_b16 v[54:55],v9 offset:45568
M v[132:135],v[32:35],a[208:211],0
ds_read_b64_tr_b16 v[56:57],v10 offset:33280
M v[132:135],v[36:39],a[212:215],v[132:135]
ds_read_b64_tr_b16 v[58:59],v10 offset:37376
M v[132:135],v[40:43],a[216:219],v[132:135]
ds_read_b64_tr_b16 v[60:61],v10 offset:41472
M v[132:135],v[44:47],a[220:223],v[132:135]
ds_read_b64_tr_b16 v[62:63],v10 offset:45568
M v[136:139],v[32:35],a[224:227],0
v_exp_f32 v128,v128
M v[136:139],v[36:39],a[228:231],v[136:139]
v_exp_f32 v129,v129
M v[136:139],v[40:43],a[232:235],v[136:139]
v_exp_f32 v130,v130
M v[136:139],v[44:47],a[236:239],v[136:139]
v_exp_f32 v131,v131
M v[140:143],v[32:35],a[240:243],0
v_exp_f32 v132,v132
M v[140:143],v[36:39],a[244:247],v[140:143]
v_exp_f32 v133,v133
M v[140:143],v[40:43],a[248:251],v[140:143]
v_exp_f32 v134,v134
M v[140:143],v[44:47],a[252:255],v[140:143]
s_waitcnt lgkmcnt(0)
M a[16:19],v[48:51],v[192:195],a[16:19]
ds_read_b128 v[32:35],v8 offset:12288
M a[16:19],v[52:55],v[196:199],a[16:19]
v_exp_f32 v135,v135
M a[48:51],v[48:51],v[200:203],a[48:51]
ds_read_b128 v[36:39],v8 offset:12544
M a[48:51],v[52:55],v[204:207],a[48:51]
v_exp_f32 v136,v136
M a[80:83],v[48:51],v[208:211],a[80:83]
ds_read_b128 v[40:43],v8 offset:12800
M a[80:83],v[52:55],v[212:215],a[80:83]
v_exp_f32 v137,v137
M a[112:115],v[48:51],v[216:219],a[112:115]
ds_read_b128 v[44:47],v8 offset:13056
M a[112:115],v[52:55],v[220:223],a[112:115]
v_exp_f32 v138,v138
M a[20:23],v[56:59],v[192:195],a[20:23]
v_exp_f32 v139,v139
M a[20:23],v[60:63],v[196:199],a[20:23]
v_exp_f32 v140,v140
M a[52:55],v[56:59],v[200:203],a[52:55]
v_exp_f32 v141,v141
M a[52:55],v[60:63],v[204:207],a[52:55]
v_exp_f32 v142,v142
M a[84:87],v[56:59],v[208:211],a[84:87]
v_exp_f32 v143,v143
M a[84:87],v[60:63],v[212:215],a[84:87]
M a[116:119],v[56:59],v[216:219],a[116:119]
M a[116:119],v[60:63],v[220:223],a[116:119]
M v[168:171],v[176:179],v[208:211],v[168:171]
M v[168:171],v[176:179],v[212:215],v[168:171]
s_waitcnt lgkmcnt(0)
M v[144:147],v[32:35],a[192:195],0
ds_read_b64_tr_b16 v[48:49],v9 offset:33536
M v[144:147],v[36:39],a[196:199],v[144:147]
ds_read_b64_tr_b16 v[50:51],v9 offset:37632
M v[144:147],v[40:43],a[200:203],v[144:147]
ds_read_b64_tr_b16 v[52:53],v9 offset:41728
M v[144:147],v[44:47],a[204:207],v[144:147]
ds_read_b64_tr_b16 v[54:55],v9 offset:45824
M v[148:151],v[32:35],a[208:211],0
ds_read_b64_tr_b16 v[56:57],v10 offset:33536
M v[148:151],v[36:39],a[212:215],v[148:151]
ds_read_b64_tr_b16 v[58:59],v10 offset:37632
M v[148:151],v[40:43],a[216:219],v[148:151]
ds_read_b64_tr_b16 v[60:61],v10 offset:41728
M v[148:151],v[44:47],a[220:223],v[148:151]
ds_read_b64_tr_b16 v[62:63],v10 offset:45824
M v[152:155],v[32:35],a[224:227],0
v_exp_f32 v144,v144
M v[152:155],v[36:39],a[228:231],v[152:155]
v_exp_f32 v145,v145
M v[152:155],v[40:43],a[232:235],v[152:155]
v_exp_f32 v146,v146
M v[152:155],v[44:47],a[236:239],v[152:155]
v_exp_f32 v147,v147
M v[156:159],v[32:35],a[240:243],0
v_exp_f32 v148,v148
M v[156:159],v[36:39],a[244:247],v[156:159]
v_exp_f32 v149,v149
M v[156:159],v[40:43],a[248:251],v[156:159]
v_exp_f32 v150,v150
M v[156:159],v[44:47],a[252:255],v[156:159]
s_waitcnt lgkmcnt(0)
s_barrier
M a[24:27],v[48:51],v[192:195],a[24:27]
ds_read_b128 v[32:35],v8 offset:16384
M a[24:27],v[52:55],v[196:199],a[24:27]
v_exp_f32 v151,v151
M a[56:59],v[48:51],v[200:203],a[56:59]
ds_read_b128 v[36:39],v8 offset:16640
M a[56:59],v[52:55],v[204:207],a[56:59]
v_exp_f32 v152,v152
M a[88:91],v[48:51],v[208:211],a[88:91]
ds_read_b128 v[40:43],v8 offset:16896
M a[88:91],v[52:55],v[212:215],a[88:91]
v_exp_f32 v153,v153
M a[120:123],v[48:51],v[216:219],a[120:123]
ds_read_b128 v[44:47],v8 offset:17152
M a[120:123],v[52:55],v[220:223],a[120:123]
v_exp_f32 v154,v154
M a[28:31],v[56:59],v[192:195],a[28:31]
v_exp_f32 v155,v155
M a[28:31],v[60:63],v[196:199],a[28:31]
v_exp_f32 v156,v156
M a[60:63],v[56:59],v[200:203],a[60:63]
v_exp_f32 v157,v157
M a[60:63],v[60:63],v[204:207],a[60:63]
v_exp_f32 v158,v158
M a[92:95],v[56:59],v[208:211],a[92:95]
v_exp_f32 v159,v159
M a[92:95],v[60:63],v[212:215],a[92:95]
v_cvt_pk_bf16_f32 v192,v96,v97
v_cvt_pk_bf16_f32 v193,v98,v99
M a[124:127],v[56:59],v[216:219],a[124:127]
v_cvt_pk_bf16_f32 v200,v100,v101
v_cvt_pk_bf16_f32 v201,v102,v103
M a[124:127],v[60:63],v[220:223],a[124:127]
v_cvt_pk_bf16_f32 v208,v104,v105
v_cvt_pk_bf16_f32 v209,v106,v107
M v[172:175],v[176:179],v[216:219],v[172:175]
v_cvt_pk_bf16_f32 v216,v108,v109
v_cvt_pk_bf16_f32 v217,v110,v111
M v[172:175],v[176:179],v[220:223],v[172:175]
s_waitcnt lgkmcnt(0)
v_cvt_pk_bf16_f32 v194,v112,v113
M v[64:67],v[32:35],a[192:195],0
ds_read_b64_tr_b16 v[48:49],v9 offset:49152
v_cvt_pk_bf16_f32 v195,v114,v115
M v[64:67],v[36:39],a[196:199],v[64:67]
ds_read_b64_tr_b16 v[50:51],v9 offset:53248
v_cvt_pk_bf16_f32 v202,v116,v117
M v[64:67],v[40:43],a[200:203],v[64:67]
ds_read_b64_tr_b16 v[52:53],v9 offset:57344
v_cvt_pk_bf16_f32 v203,v118,v119
M v[64:67],v[44:47],a[204:207],v[64:67]
ds_read_b64_tr_b16 v[54:55],v9 offset:61440
v_cvt_pk_bf16_f32 v210,v120,v121
M v[68:71],v[32:35],a[208:211],0
ds_read_b64_tr_b16 v[56:57],v10 offset:49152
v_cvt_pk_bf16_f32 v211,v122,v123
M v[68:71],v[36:39],a[212:215],v[68:71]
ds_read_b64_tr_b16 v[58:59],v10 offset:53248
v_cvt_pk_bf16_f32 v218,v124,v125
M v[68:71],v[40:43],a[216:219],v[68:71]
ds_read_b64_tr_b16 v[60:61],v10 offset:57344
v_cvt_pk_bf16_f32 v219,v126,v127
M v[68:71],v[44:47],a[220:223],v[68:71]
ds_read_b64_tr_b16 v[62:63],v10 offset:61440
v_cvt_pk_bf16_f32 v196,v128,v129
M v[72:75],v[32:35],a[224:227],0
v_cvt_pk_bf16_f32 v197,v130,v131
v_cvt_pk_bf16_f32 v204,v132,v133
M v[72:75],v[36:39],a[228:231],v[72:75]
v_cvt_pk_bf16_f32 v205,v134,v135
v_cvt_pk_bf16_f32 v212,v136,v137
M v[72:75],v[40:43],a[232:235],v[72:75]
v_cvt_pk_bf16_f32 v213,v138,v139
v_cvt_pk_bf16_f32 v220,v140,v141
M v[72:75],v[44:47],a[236:239],v[72:75]
v_cvt_pk_bf16_f32 v221,v142,v143
v_cvt_pk_bf16_f32 v198,v144,v145
M v[76:79],v[32:35],a[240:243],0
v_cvt_pk_bf16_f32 v199,v146,v147
v_cvt_pk_bf16_f32 v206,v148,v149
M v[76:79],v[36:39],a[244:247],v[76:79]
v_cvt_pk_bf16_f32 v207,v150,v151
v_cvt_pk_bf16_f32 v214,v152,v153
M v[76:79],v[40:43],a[248:251],v[76:79]
v_cvt_pk_bf16_f32 v215,v154,v155
v_cvt_pk_bf16_f32 v222,v156,v157
M v[76:79],v[44:47],a[252:255],v[76:79]
s_waitcnt lgkmcnt(0)
v_cvt_pk_bf16_f32 v223,v158,v159
M v[160:163],v[176:179],v[224:227],v[160:163]
ds_read_b128 v[32:35],v8 offset:20480
M v[160:163],v[176:179],v[228:231],v[160:163]
M v[164:167],v[176:179],v[232:235],v[164:167]
ds_read_b128 v[36:39],v8 offset:20736
M v[164:167],v[176:179],v[236:239],v[164:167]
M v[168:171],v[176:179],v[240:243],v[168:171]
ds_read_b128 v[40:43],v8 offset:20992
M v[168:171],v[176:179],v[244:247],v[168:171]
M v[172:175],v[176:179],v[248:251],v[172:175]
ds_read_b128 v[44:47],v8 offset:21248
M v[172:175],v[176:179],v[252:255],v[172:175]
v_rcp_f32 v4,v160
M a[0:3],v[48:51],v[224:227],a[0:3]
v_rcp_f32 v5,v164
M a[0:3],v[52:55],v[228:231],a[0:3]
v_add_f32 v22,v160,v4
v_add_f32 v22,v22,v164
M a[32:35],v[48:51],v[232:235],a[32:35]
v_rcp_f32 v6,v168
M a[32:35],v[52:55],v[236:239],a[32:35]
v_rcp_f32 v7,v172
M a[64:67],v[48:51],v[240:243],a[64:67]
v_add_f32 v22,v22,v5
v_add_f32 v22,v22,v168
M a[64:67],v[52:55],v[244:247],a[64:67]
v_add_f32 v22,v22,v6
v_add_f32 v22,v22,v172
M a[96:99],v[48:51],v[248:251],a[96:99]
v_add_f32 v22,v22,v7
v_cmp_nge_f32 vcc,0x53800000,v22
M a[96:99],v[52:55],v[252:255],a[96:99]
v_accvgpr_read_b32 v11,a0
v_accvgpr_read_b32 v21,a1
M a[4:7],v[56:59],v[224:227],a[4:7]
v_accvgpr_read_b32 v22,a2
v_accvgpr_read_b32 v23,a3
M a[4:7],v[60:63],v[228:231],a[4:7]
v_mul_f32 v11,v4,v11
v_mul_f32 v21,v4,v21
M a[36:39],v[56:59],v[232:235],a[36:39]
v_mul_f32 v22,v4,v22
v_mul_f32 v23,v4,v23
M a[36:39],v[60:63],v[236:239],a[36:39]
v_cvt_pk_bf16_f32 v12,v11,v21
v_cvt_pk_bf16_f32 v13,v22,v23
M a[68:71],v[56:59],v[240:243],a[68:71]
v_accvgpr_read_b32 v24,a4
v_accvgpr_read_b32 v25,a5
M a[68:71],v[60:63],v[244:247],a[68:71]
v_accvgpr_read_b32 v26,a6
v_accvgpr_read_b32 v27,a7
M a[100:103],v[56:59],v[248:251],a[100:103]
v_mul_f32 v24,v4,v24
v_mul_f32 v25,v4,v25
M a[100:103],v[60:63],v[252:255],a[100:103]
s_waitcnt lgkmcnt(0)
v_mul_f32 v26,v4,v26
M v[80:83],v[32:35],a[192:195],0
ds_read_b64_tr_b16 v[48:49],v9 offset:49408
v_mul_f32 v27,v4,v27
M v[80:83],v[36:39],a[196:199],v[80:83]
ds_read_b64_tr_b16 v[50:51],v9 offset:53504
v_cvt_pk_bf16_f32 v14,v24,v25
M v[80:83],v[40:43],a[200:203],v[80:83]
ds_read_b64_tr_b16 v[52:53],v9 offset:57600
v_cvt_pk_bf16_f32 v15,v26,v27
M v[80:83],v[44:47],a[204:207],v[80:83]
ds_read_b64_tr_b16 v[54:55],v9 offset:61696
v_accvgpr_write_b32 a128,v12
M v[84:87],v[32:35],a[208:211],0
ds_read_b64_tr_b16 v[56:57],v10 offset:49408
v_accvgpr_write_b32 a129,v13
M v[84:87],v[36:39],a[212:215],v[84:87]
ds_read_b64_tr_b16 v[58:59],v10 offset:53504
v_accvgpr_write_b32 a130,v14
M v[84:87],v[40:43],a[216:219],v[84:87]
ds_read_b64_tr_b16 v[60:61],v10 offset:57600
v_accvgpr_write_b32 a131,v15
M v[84:87],v[44:47],a[220:223],v[84:87]
ds_read_b64_tr_b16 v[62:63],v10 offset:61696
v_accvgpr_read_b32 v11,a32
M v[88:91],v[32:35],a[224:227],0
v_accvgpr_read_b32 v21,a33
v_accvgpr_read_b32 v22,a34
M v[88:91],v[36:39],a[228:231],v[88:91]
v_accvgpr_read_b32 v23,a35
v_accvgpr_read_b32 v24,a36
M v[88:91],v[40:43],a[232:235],v[88:91]
v_accvgpr_read_b32 v25,a37
v_accvgpr_read_b32 v26,a38
M v[88:91],v[44:47],a[236:239],v[88:91]
v_accvgpr_read_b32 v27,a39
v_mul_f32 v11,v5,v11
M v[92:95],v[32:35],a[240:243],0
v_mul_f32 v21,v5,v21
v_mul_f32 v22,v5,v22
M v[92:95],v[36:39],a[244:247],v[92:95]
v_mul_f32 v23,v5,v23
v_mul_f32 v24,v5,v24
M v[92:95],v[40:43],a[248:251],v[92:95]
v_mul_f32 v25,v5,v25
v_mul_f32 v26,v5,v26
M v[92:95],v[44:47],a[252:255],v[92:95]
s_waitcnt lgkmcnt(0)
v_mul_f32 v27,v5,v27
M a[8:11],v[48:51],v[224:227],a[8:11]
ds_read_b128 v[32:35],v8 offset:24576
v_cvt_pk_bf16_f32 v28,v11,v21
M a[8:11],v[52:55],v[228:231],a[8:11]
v_cvt_pk_bf16_f32 v29,v22,v23
v_cvt_pk_bf16_f32 v30,v24,v25
M a[40:43],v[48:51],v[232:235],a[40:43]
ds_read_b128 v[36:39],v8 offset:24832
v_cvt_pk_bf16_f32 v31,v26,v27
M a[40:43],v[52:55],v[236:239],a[40:43]
v_accvgpr_write_b32 a144,v28
v_accvgpr_write_b32 a145,v29
M a[72:75],v[48:51],v[240:243],a[72:75]
ds_read_b128 v[40:43],v8 offset:25088
v_accvgpr_write_b32 a146,v30
M a[72:75],v[52:55],v[244:247],a[72:75]
v_accvgpr_write_b32 a147,v31
v_accvgpr_read_b32 v11,a64
M a[104:107],v[48:51],v[248:251],a[104:107]
ds_read_b128 v[44:47],v8 offset:25344
v_accvgpr_read_b32 v21,a65
M a[104:107],v[52:55],v[252:255],a[104:107]
v_accvgpr_read_b32 v22,a66
v_accvgpr_read_b32 v23,a67
M a[12:15],v[56:59],v[224:227],a[12:15]
v_accvgpr_read_b32 v24,a68
v_accvgpr_read_b32 v25,a69
M a[12:15],v[60:63],v[228:231],a[12:15]
v_accvgpr_read_b32 v26,a70
v_accvgpr_read_b32 v27,a71
M a[44:47],v[56:59],v[232:235],a[44:47]
v_mul_f32 v11,v6,v11
v_mul_f32 v21,v6,v21
M a[44:47],v[60:63],v[236:239],a[44:47]
v_mul_f32 v22,v6,v22
v_mul_f32 v23,v6,v23
M a[76:79],v[56:59],v[240:243],a[76:79]
v_mul_f32 v24,v6,v24
v_mul_f32 v25,v6,v25
M a[76:79],v[60:63],v[244:247],a[76:79]
v_mul_f32 v26,v6,v26
v_mul_f32 v27,v6,v27
M a[108:111],v[56:59],v[248:251],a[108:111]
v_cvt_pk_bf16_f32 v12,v11,v21
v_cvt_pk_bf16_f32 v13,v22,v23
M a[108:111],v[60:63],v[252:255],a[108:111]
s_waitcnt lgkmcnt(0)
v_cvt_pk_bf16_f32 v14,v24,v25
M v[96:99],v[32:35],a[192:195],0
ds_read_b64_tr_b16 v[48:49],v9 offset:49664
v_cvt_pk_bf16_f32 v15,v26,v27
M v[96:99],v[36:39],a[196:199],v[96:99]
ds_read_b64_tr_b16 v[50:51],v9 offset:53760
v_accvgpr_write_b32 a160,v12
M v[96:99],v[40:43],a[200:203],v[96:99]
ds_read_b64_tr_b16 v[52:53],v9 offset:57856
v_accvgpr_write_b32 a161,v13
M v[96:99],v[44:47],a[204:207],v[96:99]
ds_read_b64_tr_b16 v[54:55],v9 offset:61952
v_accvgpr_write_b32 a162,v14
M v[100:103],v[32:35],a[208:211],0
ds_read_b64_tr_b16 v[56:57],v10 offset:49664
v_accvgpr_write_b32 a163,v15
M v[100:103],v[36:39],a[212:215],v[100:103]
ds_read_b64_tr_b16 v[58:59],v10 offset:53760
v_accvgpr_read_b32 v11,a96
M v[100:103],v[40:43],a[216:219],v[100:103]
ds_read_b64_tr_b16 v[60:61],v10 offset:57856
v_accvgpr_read_b32 v21,a97
M v[100:103],v[44:47],a[220:223],v[100:103]
ds_read_b64_tr_b16 v[62:63],v10 offset:61952
v_accvgpr_read_b32 v22,a98
M v[104:107],v[32:35],a[224:227],0
v_accvgpr_read_b32 v23,a99
v_accvgpr_read_b32 v24,a100
M v[104:107],v[36:39],a[228:231],v[104:107]
v_accvgpr_read_b32 v25,a101
v_accvgpr_read_b32 v26,a102
M v[104:107],v[40:43],a[232:235],v[104:107]
v_accvgpr_read_b32 v27,a103
v_mul_f32 v11,v7,v11
M v[104:107],v[44:47],a[236:239],v[104:107]
v_mul_f32 v21,v7,v21
v_mul_f32 v22,v7,v22
M v[108:111],v[32:35],a[240:243],0
v_mul_f32 v23,v7,v23
v_mul_f32 v24,v7,v24
M v[108:111],v[36:39],a[244:247],v[108:111]
v_mul_f32 v25,v7,v25
v_mul_f32 v26,v7,v26
M v[108:111],v[40:43],a[248:251],v[108:111]
v_mul_f32 v27,v7,v27
v_cvt_pk_bf16_f32 v28,v11,v21
M v[108:111],v[44:47],a[252:255],v[108:111]
s_waitcnt lgkmcnt(0)
v_cvt_pk_bf16_f32 v29,v22,v23
M a[16:19],v[48:51],v[224:227],a[16:19]
ds_read_b128 v[32:35],v8 offset:28672
v_cvt_pk_bf16_f32 v30,v24,v25
M a[16:19],v[52:55],v[228:231],a[16:19]
v_cvt_pk_bf16_f32 v31,v26,v27
v_accvgpr_write_b32 a176,v28
M a[48:51],v[48:51],v[232:235],a[48:51]
ds_read_b128 v[36:39],v8 offset:28928
v_accvgpr_write_b32 a177,v29
M a[48:51],v[52:55],v[236:239],a[48:51]
v_accvgpr_write_b32 a178,v30
v_accvgpr_write_b32 a179,v31
M a[80:83],v[48:51],v[240:243],a[80:83]
ds_read_b128 v[40:43],v8 offset:29184
v_accvgpr_read_b32 v11,a8
M a[80:83],v[52:55],v[244:247],a[80:83]
v_accvgpr_read_b32 v21,a9
v_accvgpr_read_b32 v22,a10
M a[112:115],v[48:51],v[248:251],a[112:115]
ds_read_b128 v[44:47],v8 offset:29440
v_accvgpr_read_b32 v23,a11
M a[112:115],v[52:55],v[252:255],a[112:115]
v_accvgpr_read_b32 v24,a12
v_accvgpr_read_b32 v25,a13
M a[20:23],v[56:59],v[224:227],a[20:23]
v_accvgpr_read_b32 v26,a14
v_accvgpr_read_b32 v27,a15
M a[20:23],v[60:63],v[228:231],a[20:23]
v_mul_f32 v11,v4,v11
v_mul_f32 v21,v4,v21
M a[52:55],v[56:59],v[232:235],a[52:55]
v_mul_f32 v22,v4,v22
v_mul_f32 v23,v4,v23
M a[52:55],v[60:63],v[236:239],a[52:55]
v_mul_f32 v24,v4,v24
v_mul_f32 v25,v4,v25
M a[84:87],v[56:59],v[240:243],a[84:87]
v_mul_f32 v26,v4,v26
v_mul_f32 v27,v4,v27
M a[84:87],v[60:63],v[244:247],a[84:87]
v_cvt_pk_bf16_f32 v12,v11,v21
v_cvt_pk_bf16_f32 v13,v22,v23
M a[116:119],v[56:59],v[248:251],a[116:119]
v_cvt_pk_bf16_f32 v14,v24,v25
v_cvt_pk_bf16_f32 v15,v26,v27
M a[116:119],v[60:63],v[252:255],a[116:119]
s_waitcnt lgkmcnt(0)
v_accvgpr_write_b32 a132,v12
M v[112:115],v[32:35],a[192:195],0
ds_read_b64_tr_b16 v[48:49],v9 offset:49920
v_accvgpr_write_b32 a133,v13
M v[112:115],v[36:39],a[196:199],v[112:115]
ds_read_b64_tr_b16 v[50:51],v9 offset:54016
v_accvgpr_write_b32 a134,v14
M v[112:115],v[40:43],a[200:203],v[112:115]
ds_read_b64_tr_b16 v[52:53],v9 offset:58112
v_accvgpr_write_b32 a135,v15
M v[112:115],v[44:47],a[204:207],v[112:115]
ds_read_b64_tr_b16 v[54:55],v9 offset:62208
v_accvgpr_read_b32 v11,a40
M v[116:119],v[32:35],a[208:211],0
ds_read_b64_tr_b16 v[56:57],v10 offset:49920
v_accvgpr_read_b32 v21,a41
M v[116:119],v[36:39],a[212:215],v[116:119]
ds_read_b64_tr_b16 v[58:59],v10 offset:54016
v_accvgpr_read_b32 v22,a42
M v[116:119],v[40:43],a[216:219],v[116:119]
ds_read_b64_tr_b16 v[60:61],v10 offset:58112
v_accvgpr_read_b32 v23,a43
M v[116:119],v[44:47],a[220:223],v[116:119]
ds_read_b64_tr_b16 v[62:63],v10 offset:62208
v_accvgpr_read_b32 v24,a44
M v[120:123],v[32:35],a[224:227],0
v_accvgpr_read_b32 v25,a45
v_accvgpr_read_b32 v26,a46
M v[120:123],v[36:39],a[228:231],v[120:123]
v_accvgpr_read_b32 v27,a47
v_mul_f32 v11,v5,v11
M v[120:123],v[40:43],a[232:235],v[120:123]
v_mul_f32 v21,v5,v21
v_mul_f32 v22,v5,v22
M v[120:123],v[44:47],a[236:239],v[120:123]
v_mul_f32 v23,v5,v23
v_mul_f32 v24,v5,v24
M v[124:127],v[32:35],a[240:243],0
v_mul_f32 v25,v5,v25
v_mul_f32 v26,v5,v26
M v[124:127],v[36:39],a[244:247],v[124:127]
v_mul_f32 v27,v5,v27
v_cvt_pk_bf16_f32 v28,v11,v21
M v[124:127],v[40:43],a[248:251],v[124:127]
v_cvt_pk_bf16_f32 v29,v22,v23
v_cvt_pk_bf16_f32 v30,v24,v25
M v[124:127],v[44:47],a[252:255],v[124:127]
s_waitcnt lgkmcnt(0)
s_barrier
M a[24:27],v[48:51],v[224:227],a[24:27]
ds_read_b128 v[32:35],v8 offset:32768
v_cvt_pk_bf16_f32 v31,v26,v27
M a[24:27],v[52:55],v[228:231],a[24:27]
v_accvgpr_write_b32 a148,v28
v_accvgpr_write_b32 a149,v29
M a[56:59],v[48:51],v[232:235],a[56:59]
ds_read_b128 v[36:39],v8 offset:33024
v_accvgpr_write_b32 a150,v30
M a[56:59],v[52:55],v[236:239],a[56:59]
v_accvgpr_write_b32 a151,v31
v_accvgpr_read_b32 v11,a72
M a[88:91],v[48:51],v[240:243],a[88:91]
ds_read_b128 v[40:43],v8 offset:33280
v_accvgpr_read_b32 v21,a73
M a[88:91],v[52:55],v[244:247],a[88:91]
v_accvgpr_read_b32 v22,a74
v_accvgpr_read_b32 v23,a75
M a[120:123],v[48:51],v[248:251],a[120:123]
ds_read_b128 v[44:47],v8 offset:33536
v_accvgpr_read_b32 v24,a76
M a[120:123],v[52:55],v[252:255],a[120:123]
v_accvgpr_read_b32 v25,a77
v_accvgpr_read_b32 v26,a78
M a[28:31],v[56:59],v[224:227],a[28:31]
v_accvgpr_read_b32 v27,a79
v_mul_f32 v11,v6,v11
M a[28:31],v[60:63],v[228:231],a[28:31]
v_mul_f32 v21,v6,v21
v_mul_f32 v22,v6,v22
M a[60:63],v[56:59],v[232:235],a[60:63]
v_mul_f32 v23,v6,v23
v_mul_f32 v24,v6,v24
M a[60:63],v[60:63],v[236:239],a[60:63]
v_mul_f32 v25,v6,v25
v_mul_f32 v26,v6,v26
M a[92:95],v[56:59],v[240:243],a[92:95]
v_mul_f32 v27,v6,v27
v_cvt_pk_bf16_f32 v12,v11,v21
M a[92:95],v[60:63],v[244:247],a[92:95]
v_cvt_pk_bf16_f32 v13,v22,v23
v_cvt_pk_bf16_f32 v14,v24,v25
M a[124:127],v[56:59],v[248:251],a[124:127]
v_cvt_pk_bf16_f32 v15,v26,v27
v_accvgpr_write_b32 a164,v12
M a[124:127],v[60:63],v[252:255],a[124:127]
s_waitcnt lgkmcnt(0)
v_accvgpr_write_b32 a165,v13
M v[128:131],v[32:35],a[192:195],0
ds_read_b64_tr_b16 v[48:49],v9
v_accvgpr_write_b32 a166,v14
M v[128:131],v[36:39],a[196:199],v[128:131]
ds_read_b64_tr_b16 v[50:51],v9 offset:4096
buffer_store_dwordx4 a[128:131],v20,s[20:23],s44 offen sc1
M v[128:131],v[40:43],a[200:203],v[128:131]
ds_read_b64_tr_b16 v[52:53],v9 offset:8192
v_accvgpr_write_b32 a167,v15
M v[128:131],v[44:47],a[204:207],v[128:131]
ds_read_b64_tr_b16 v[54:55],v9 offset:12288
v_accvgpr_read_b32 v11,a104
M v[132:135],v[32:35],a[208:211],0
ds_read_b64_tr_b16 v[56:57],v10
v_accvgpr_read_b32 v21,a105
M v[132:135],v[36:39],a[212:215],v[132:135]
ds_read_b64_tr_b16 v[58:59],v10 offset:4096
v_accvgpr_read_b32 v22,a106
M v[132:135],v[40:43],a[216:219],v[132:135]
ds_read_b64_tr_b16 v[60:61],v10 offset:8192
v_accvgpr_read_b32 v23,a107
M v[132:135],v[44:47],a[220:223],v[132:135]
ds_read_b64_tr_b16 v[62:63],v10 offset:12288
v_accvgpr_read_b32 v24,a108
M v[136:139],v[32:35],a[224:227],0
v_accvgpr_read_b32 v25,a109
v_accvgpr_read_b32 v26,a110
M v[136:139],v[36:39],a[228:231],v[136:139]
v_accvgpr_read_b32 v27,a111
v_mul_f32 v11,v7,v11
M v[136:139],v[40:43],a[232:235],v[136:139]
v_mul_f32 v21,v7,v21
v_mul_f32 v22,v7,v22
M v[136:139],v[44:47],a[236:239],v[136:139]
v_mul_f32 v23,v7,v23
v_mul_f32 v24,v7,v24
M v[140:143],v[32:35],a[240:243],0
v_mul_f32 v25,v7,v25
v_mul_f32 v26,v7,v26
M v[140:143],v[36:39],a[244:247],v[140:143]
v_mul_f32 v27,v7,v27
v_cvt_pk_bf16_f32 v28,v11,v21
M v[140:143],v[40:43],a[248:251],v[140:143]
v_cvt_pk_bf16_f32 v29,v22,v23
v_cvt_pk_bf16_f32 v30,v24,v25
M v[140:143],v[44:47],a[252:255],v[140:143]
s_waitcnt lgkmcnt(0)
v_cvt_pk_bf16_f32 v31,v26,v27
M a[0:3],v[48:51],v[192:195],0
ds_read_b128 v[32:35],v8 offset:36864
v_accvgpr_write_b32 a180,v28
M a[0:3],v[52:55],v[196:199],a[0:3]
v_accvgpr_write_b32 a181,v29
v_accvgpr_write_b32 a182,v30
M a[32:35],v[48:51],v[200:203],0
ds_read_b128 v[36:39],v8 offset:37120
v_accvgpr_write_b32 a183,v31
M a[32:35],v[52:55],v[204:207],a[32:35]
v_accvgpr_read_b32 v11,a16
v_accvgpr_read_b32 v21,a17
M a[64:67],v[48:51],v[208:211],0
ds_read_b128 v[40:43],v8 offset:37376
buffer_store_dwordx4 a[144:147],v20,s[20:23],s45 offen sc1
M a[64:67],v[52:55],v[212:215],a[64:67]
v_accvgpr_read_b32 v22,a18
v_accvgpr_read_b32 v23,a19
M a[96:99],v[48:51],v[216:219],0
ds_read_b128 v[44:47],v8 offset:37632
v_accvgpr_read_b32 v24,a20
M a[96:99],v[52:55],v[220:223],a[96:99]
v_accvgpr_read_b32 v25,a21
v_accvgpr_read_b32 v26,a22
M a[4:7],v[56:59],v[192:195],0
v_accvgpr_read_b32 v27,a23
v_mul_f32 v11,v4,v11
M a[4:7],v[60:63],v[196:199],a[4:7]
v_mul_f32 v21,v4,v21
v_mul_f32 v22,v4,v22
M a[36:39],v[56:59],v[200:203],0
v_mul_f32 v23,v4,v23
v_mul_f32 v24,v4,v24
M a[36:39],v[60:63],v[204:207],a[36:39]
v_mul_f32 v25,v4,v25
v_mul_f32 v26,v4,v26
M a[68:71],v[56:59],v[208:211],0
v_mul_f32 v27,v4,v27
v_cvt_pk_bf16_f32 v12,v11,v21
M a[68:71],v[60:63],v[212:215],a[68:71]
v_cvt_pk_bf16_f32 v13,v22,v23
v_cvt_pk_bf16_f32 v14,v24,v25
M a[100:103],v[56:59],v[216:219],0
v_cvt_pk_bf16_f32 v15,v26,v27
v_accvgpr_write_b32 a136,v12
M a[100:103],v[60:63],v[220:223],a[100:103]
v_accvgpr_write_b32 a137,v13
v_accvgpr_write_b32 a138,v14
M v[160:163],v[176:179],v[192:195],0
v_accvgpr_write_b32 a139,v15
v_accvgpr_read_b32 v11,a48
M v[160:163],v[176:179],v[196:199],v[160:163]
s_waitcnt lgkmcnt(0)
v_accvgpr_read_b32 v21,a49
M v[144:147],v[32:35],a[192:195],0
ds_read_b64_tr_b16 v[48:49],v9 offset:256
v_accvgpr_read_b32 v22,a50
M v[144:147],v[36:39],a[196:199],v[144:147]
ds_read_b64_tr_b16 v[50:51],v9 offset:4352
v_accvgpr_read_b32 v23,a51
M v[144:147],v[40:43],a[200:203],v[144:147]
ds_read_b64_tr_b16 v[52:53],v9 offset:8448
v_accvgpr_read_b32 v24,a52
M v[144:147],v[44:47],a[204:207],v[144:147]
ds_read_b64_tr_b16 v[54:55],v9 offset:12544
v_accvgpr_read_b32 v25,a53
M v[148:151],v[32:35],a[208:211],0
ds_read_b64_tr_b16 v[56:57],v10 offset:256
v_accvgpr_read_b32 v26,a54
M v[148:151],v[36:39],a[212:215],v[148:151]
ds_read_b64_tr_b16 v[58:59],v10 offset:4352
v_accvgpr_read_b32 v27,a55
M v[148:151],v[40:43],a[216:219],v[148:151]
ds_read_b64_tr_b16 v[60:61],v10 offset:8448
buffer_store_dwordx4 a[160:163],v20,s[20:23],s46 offen sc1
M v[148:151],v[44:47],a[220:223],v[148:151]
ds_read_b64_tr_b16 v[62:63],v10 offset:12544
v_mul_f32 v11,v5,v11
M v[152:155],v[32:35],a[224:227],0
v_mul_f32 v21,v5,v21
v_mul_f32 v22,v5,v22
M v[152:155],v[36:39],a[228:231],v[152:155]
v_mul_f32 v23,v5,v23
v_mul_f32 v24,v5,v24
M v[152:155],v[40:43],a[232:235],v[152:155]
v_mul_f32 v25,v5,v25
v_mul_f32 v26,v5,v26
M v[152:155],v[44:47],a[236:239],v[152:155]
v_mul_f32 v27,v5,v27
v_cvt_pk_bf16_f32 v28,v11,v21
M v[156:159],v[32:35],a[240:243],0
v_cvt_pk_bf16_f32 v29,v22,v23
v_cvt_pk_bf16_f32 v30,v24,v25
M v[156:159],v[36:39],a[244:247],v[156:159]
v_cvt_pk_bf16_f32 v31,v26,v27
v_accvgpr_write_b32 a152,v28
M v[156:159],v[40:43],a[248:251],v[156:159]
v_accvgpr_write_b32 a153,v29
v_accvgpr_write_b32 a154,v30
M v[156:159],v[44:47],a[252:255],v[156:159]
s_waitcnt lgkmcnt(0)
v_accvgpr_write_b32 a155,v31
M a[8:11],v[48:51],v[192:195],0
ds_read_b128 v[32:35],v8 offset:40960
v_accvgpr_read_b32 v11,a80
M a[8:11],v[52:55],v[196:199],a[8:11]
v_accvgpr_read_b32 v21,a81
v_accvgpr_read_b32 v22,a82
M a[40:43],v[48:51],v[200:203],0
ds_read_b128 v[36:39],v8 offset:41216
v_accvgpr_read_b32 v23,a83
M a[40:43],v[52:55],v[204:207],a[40:43]
v_accvgpr_read_b32 v24,a84
v_accvgpr_read_b32 v25,a85
M a[72:75],v[48:51],v[208:211],0
ds_read_b128 v[40:43],v8 offset:41472
v_accvgpr_read_b32 v26,a86
M a[72:75],v[52:55],v[212:215],a[72:75]
v_accvgpr_read_b32 v27,a87
v_mul_f32 v11,v6,v11
M a[104:107],v[48:51],v[216:219],0
ds_read_b128 v[44:47],v8 offset:41728
v_mul_f32 v21,v6,v21
M a[104:107],v[52:55],v[220:223],a[104:107]
v_mul_f32 v22,v6,v22
v_mul_f32 v23,v6,v23
M a[12:15],v[56:59],v[192:195],0
v_mul_f32 v24,v6,v24
v_mul_f32 v25,v6,v25
M a[12:15],v[60:63],v[196:199],a[12:15]
v_mul_f32 v26,v6,v26
v_mul_f32 v27,v6,v27
M a[44:47],v[56:59],v[200:203],0
buffer_store_dwordx4 a[176:179],v20,s[20:23],s47 offen sc1
v_cvt_pk_bf16_f32 v12,v11,v21
M a[44:47],v[60:63],v[204:207],a[44:47]
v_cvt_pk_bf16_f32 v13,v22,v23
v_cvt_pk_bf16_f32 v14,v24,v25
M a[76:79],v[56:59],v[208:211],0
v_cvt_pk_bf16_f32 v15,v26,v27
v_accvgpr_write_b32 a168,v12
M a[76:79],v[60:63],v[212:215],a[76:79]
v_accvgpr_write_b32 a169,v13
v_accvgpr_write_b32 a170,v14
M a[108:111],v[56:59],v[216:219],0
v_accvgpr_write_b32 a171,v15
v_accvgpr_read_b32 v11,a112
M a[108:111],v[60:63],v[220:223],a[108:111]
v_accvgpr_read_b32 v21,a113
v_accvgpr_read_b32 v22,a114
M v[164:167],v[176:179],v[200:203],0
v_accvgpr_read_b32 v23,a115
v_accvgpr_read_b32 v24,a116
M v[164:167],v[176:179],v[204:207],v[164:167]
s_waitcnt lgkmcnt(0)
v_accvgpr_read_b32 v25,a117
v_exp_f32 v64,v64
v_exp_f32 v65,v65
v_exp_f32 v66,v66
v_exp_f32 v67,v67
v_cvt_pk_bf16_f32 v224,v64,v65
v_cvt_pk_bf16_f32 v225,v66,v67
M v[64:67],v[32:35],a[192:195],0
ds_read_b64_tr_b16 v[48:49],v9 offset:512
v_accvgpr_read_b32 v26,a118
M v[64:67],v[36:39],a[196:199],v[64:67]
ds_read_b64_tr_b16 v[50:51],v9 offset:4608
v_accvgpr_read_b32 v27,a119
M v[64:67],v[40:43],a[200:203],v[64:67]
ds_read_b64_tr_b16 v[52:53],v9 offset:8704
v_mul_f32 v11,v7,v11
M v[64:67],v[44:47],a[204:207],v[64:67]
ds_read_b64_tr_b16 v[54:55],v9 offset:12800
v_mul_f32 v21,v7,v21
v_exp_f32 v68,v68
v_exp_f32 v69,v69
v_exp_f32 v70,v70
v_exp_f32 v71,v71
v_cvt_pk_bf16_f32 v232,v68,v69
v_cvt_pk_bf16_f32 v233,v70,v71
M v[68:71],v[32:35],a[208:211],0
ds_read_b64_tr_b16 v[56:57],v10 offset:512
v_mul_f32 v22,v7,v22
M v[68:71],v[36:39],a[212:215],v[68:71]
ds_read_b64_tr_b16 v[58:59],v10 offset:4608
v_mul_f32 v23,v7,v23
M v[68:71],v[40:43],a[216:219],v[68:71]
ds_read_b64_tr_b16 v[60:61],v10 offset:8704
v_mul_f32 v24,v7,v24
M v[68:71],v[44:47],a[220:223],v[68:71]
ds_read_b64_tr_b16 v[62:63],v10 offset:12800
v_mul_f32 v25,v7,v25
v_exp_f32 v72,v72
v_exp_f32 v73,v73
v_exp_f32 v74,v74
v_exp_f32 v75,v75
v_cvt_pk_bf16_f32 v240,v72,v73
v_cvt_pk_bf16_f32 v241,v74,v75
M v[72:75],v[32:35],a[224:227],0
v_mul_f32 v26,v7,v26
v_mul_f32 v27,v7,v27
M v[72:75],v[36:39],a[228:231],v[72:75]
v_cvt_pk_bf16_f32 v28,v11,v21
v_cvt_pk_bf16_f32 v29,v22,v23
M v[72:75],v[40:43],a[232:235],v[72:75]
v_cvt_pk_bf16_f32 v30,v24,v25
v_cvt_pk_bf16_f32 v31,v26,v27
M v[72:75],v[44:47],a[236:239],v[72:75]
v_accvgpr_write_b32 a184,v28
v_accvgpr_write_b32 a185,v29
v_exp_f32 v76,v76
v_exp_f32 v77,v77
v_exp_f32 v78,v78
v_exp_f32 v79,v79
v_cvt_pk_bf16_f32 v248,v76,v77
v_cvt_pk_bf16_f32 v249,v78,v79
M v[76:79],v[32:35],a[240:243],0
buffer_store_dwordx4 a[132:135],v20,s[20:23],s44 offen offset:1024 sc1
v_accvgpr_write_b32 a186,v30
M v[76:79],v[36:39],a[244:247],v[76:79]
v_accvgpr_write_b32 a187,v31
v_accvgpr_read_b32 v11,a24
M v[76:79],v[40:43],a[248:251],v[76:79]
v_accvgpr_read_b32 v21,a25
v_accvgpr_read_b32 v22,a26
M v[76:79],v[44:47],a[252:255],v[76:79]
s_waitcnt lgkmcnt(0)
v_accvgpr_read_b32 v23,a27
M a[16:19],v[48:51],v[192:195],0
ds_read_b128 v[32:35],v8 offset:45056
v_accvgpr_read_b32 v24,a28
M a[16:19],v[52:55],v[196:199],a[16:19]
v_accvgpr_read_b32 v25,a29
v_accvgpr_read_b32 v26,a30
M a[48:51],v[48:51],v[200:203],0
ds_read_b128 v[36:39],v8 offset:45312
v_accvgpr_read_b32 v27,a31
M a[48:51],v[52:55],v[204:207],a[48:51]
v_mul_f32 v11,v4,v11
v_mul_f32 v21,v4,v21
M a[80:83],v[48:51],v[208:211],0
ds_read_b128 v[40:43],v8 offset:45568
v_mul_f32 v22,v4,v22
M a[80:83],v[52:55],v[212:215],a[80:83]
v_mul_f32 v23,v4,v23
v_mul_f32 v24,v4,v24
M a[112:115],v[48:51],v[216:219],0
ds_read_b128 v[44:47],v8 offset:45824
v_mul_f32 v25,v4,v25
M a[112:115],v[52:55],v[220:223],a[112:115]
v_mul_f32 v26,v4,v26
v_mul_f32 v27,v4,v27
M a[20:23],v[56:59],v[192:195],0
v_cvt_pk_bf16_f32 v12,v11,v21
v_cvt_pk_bf16_f32 v13,v22,v23
M a[20:23],v[60:63],v[196:199],a[20:23]
v_cvt_pk_bf16_f32 v14,v24,v25
v_cvt_pk_bf16_f32 v15,v26,v27
M a[52:55],v[56:59],v[200:203],0
v_accvgpr_write_b32 a140,v12
v_accvgpr_write_b32 a141,v13
M a[52:55],v[60:63],v[204:207],a[52:55]
v_accvgpr_write_b32 a142,v14
v_accvgpr_write_b32 a143,v15
M a[84:87],v[56:59],v[208:211],0
v_accvgpr_read_b32 v11,a56
v_accvgpr_read_b32 v21,a57
M a[84:87],v[60:63],v[212:215],a[84:87]
v_accvgpr_read_b32 v22,a58
v_accvgpr_read_b32 v23,a59
M a[116:119],v[56:59],v[216:219],0
v_accvgpr_read_b32 v24,a60
v_accvgpr_read_b32 v25,a61
M a[116:119],v[60:63],v[220:223],a[116:119]
v_accvgpr_read_b32 v26,a62
v_accvgpr_read_b32 v27,a63
M v[168:171],v[176:179],v[208:211],0
buffer_store_dwordx4 a[148:151],v20,s[20:23],s45 offen offset:1024 sc1
v_mul_f32 v11,v5,v11
M v[168:171],v[176:179],v[212:215],v[168:171]
s_waitcnt lgkmcnt(0)
v_mul_f32 v21,v5,v21
v_exp_f32 v80,v80
v_exp_f32 v81,v81
v_exp_f32 v82,v82
v_exp_f32 v83,v83
v_cvt_pk_bf16_f32 v226,v80,v81
v_cvt_pk_bf16_f32 v227,v82,v83
M v[80:83],v[32:35],a[192:195],0
ds_read_b64_tr_b16 v[48:49],v9 offset:768
v_mul_f32 v22,v5,v22
M v[80:83],v[36:39],a[196:199],v[80:83]
ds_read_b64_tr_b16 v[50:51],v9 offset:4864
v_mul_f32 v23,v5,v23
M v[80:83],v[40:43],a[200:203],v[80:83]
ds_read_b64_tr_b16 v[52:53],v9 offset:8960
v_mul_f32 v24,v5,v24
M v[80:83],v[44:47],a[204:207],v[80:83]
ds_read_b64_tr_b16 v[54:55],v9 offset:13056
v_mul_f32 v25,v5,v25
v_exp_f32 v84,v84
v_exp_f32 v85,v85
v_exp_f32 v86,v86
v_exp_f32 v87,v87
v_cvt_pk_bf16_f32 v234,v84,v85
v_cvt_pk_bf16_f32 v235,v86,v87
M v[84:87],v[32:35],a[208:211],0
ds_read_b64_tr_b16 v[56:57],v10 offset:768
v_mul_f32 v26,v5,v26
M v[84:87],v[36:39],a[212:215],v[84:87]
ds_read_b64_tr_b16 v[58:59],v10 offset:4864
v_mul_f32 v27,v5,v27
M v[84:87],v[40:43],a[216:219],v[84:87]
ds_read_b64_tr_b16 v[60:61],v10 offset:8960
v_cvt_pk_bf16_f32 v28,v11,v21
M v[84:87],v[44:47],a[220:223],v[84:87]
ds_read_b64_tr_b16 v[62:63],v10 offset:13056
v_cvt_pk_bf16_f32 v29,v22,v23
v_exp_f32 v88,v88
v_exp_f32 v89,v89
v_exp_f32 v90,v90
v_exp_f32 v91,v91
v_cvt_pk_bf16_f32 v242,v88,v89
v_cvt_pk_bf16_f32 v243,v90,v91
M v[88:91],v[32:35],a[224:227],0
v_cvt_pk_bf16_f32 v30,v24,v25
v_cvt_pk_bf16_f32 v31,v26,v27
M v[88:91],v[36:39],a[228:231],v[88:91]
v_accvgpr_write_b32 a156,v28
v_accvgpr_write_b32 a157,v29
M v[88:91],v[40:43],a[232:235],v[88:91]
v_accvgpr_write_b32 a158,v30
v_accvgpr_write_b32 a159,v31
M v[88:91],v[44:47],a[236:239],v[88:91]
v_accvgpr_read_b32 v11,a88
v_accvgpr_read_b32 v21,a89
v_exp_f32 v92,v92
v_exp_f32 v93,v93
v_exp_f32 v94,v94
v_exp_f32 v95,v95
v_cvt_pk_bf16_f32 v250,v92,v93
v_cvt_pk_bf16_f32 v251,v94,v95
M v[92:95],v[32:35],a[240:243],0
v_exp_f32 v96,v96
M v[92:95],v[36:39],a[244:247],v[92:95]
v_exp_f32 v97,v97
M v[92:95],v[40:43],a[248:251],v[92:95]
v_exp_f32 v98,v98
M v[92:95],v[44:47],a[252:255],v[92:95]
s_waitcnt lgkmcnt(0)
s_barrier
M a[24:27],v[48:51],v[192:195],0
ds_read_b128 v[32:35],v8 offset:49152
v_accvgpr_read_b32 v22,a90
M a[24:27],v[52:55],v[196:199],a[24:27]
buffer_store_dwordx4 a[164:167],v20,s[20:23],s46 offen offset:1024 sc1
v_accvgpr_read_b32 v23,a91
M a[56:59],v[48:51],v[200:203],0
ds_read_b128 v[36:39],v8 offset:49408
v_accvgpr_read_b32 v24,a92
M a[56:59],v[52:55],v[204:207],a[56:59]
v_exp_f32 v99,v99
M a[88:91],v[48:51],v[208:211],0
ds_read_b128 v[40:43],v8 offset:49664
v_accvgpr_read_b32 v25,a93
M a[88:91],v[52:55],v[212:215],a[88:91]
v_exp_f32 v100,v100
v_mul_f32 v11,v6,v11
v_mul_f32 v21,v6,v21
v_cvt_pk_bf16_f32 v12,v11,v21
v_accvgpr_read_b32 v11,a120
v_accvgpr_read_b32 v21,a121
v_mul_f32 v22,v6,v22
v_mul_f32 v23,v6,v23
v_cvt_pk_bf16_f32 v13,v22,v23
v_accvgpr_read_b32 v22,a122
v_accvgpr_read_b32 v23,a123
M a[120:123],v[48:51],v[216:219],0
ds_read_b128 v[44:47],v8 offset:49920
v_accvgpr_read_b32 v26,a94
M a[120:123],v[52:55],v[220:223],a[120:123]
v_exp_f32 v101,v101
M a[28:31],v[56:59],v[192:195],0
v_exp_f32 v102,v102
M a[28:31],v[60:63],v[196:199],a[28:31]
v_exp_f32 v103,v103
M a[60:63],v[56:59],v[200:203],0
v_exp_f32 v104,v104
M a[60:63],v[60:63],v[204:207],a[60:63]
v_exp_f32 v105,v105
v_accvgpr_read_b32 v27,a95
M a[92:95],v[56:59],v[208:211],0
v_exp_f32 v106,v106
M a[92:95],v[60:63],v[212:215],a[92:95]
v_exp_f32 v107,v107
v_mul_f32 v24,v6,v24
v_mul_f32 v25,v6,v25
v_cvt_pk_bf16_f32 v14,v24,v25
v_accvgpr_read_b32 v24,a124
v_accvgpr_read_b32 v25,a125
v_mul_f32 v26,v6,v26
v_mul_f32 v27,v6,v27
v_cvt_pk_bf16_f32 v15,v26,v27
v_accvgpr_read_b32 v26,a126
v_accvgpr_read_b32 v27,a127
M a[124:127],v[56:59],v[216:219],0
v_exp_f32 v108,v108
M a[124:127],v[60:63],v[220:223],a[124:127]
v_exp_f32 v109,v109
M v[172:175],v[176:179],v[216:219],0
v_exp_f32 v110,v110
M v[172:175],v[176:179],v[220:223],v[172:175]
s_waitcnt lgkmcnt(0)
v_accvgpr_write_b32 a172,v12
v_cvt_pk_bf16_f32 v228,v96,v97
v_cvt_pk_bf16_f32 v229,v98,v99
M v[96:99],v[32:35],a[192:195],0
ds_read_b64_tr_b16 v[48:49],v9 offset:16384
v_accvgpr_write_b32 a173,v13
M v[96:99],v[36:39],a[196:199],v[96:99]
ds_read_b64_tr_b16 v[50:51],v9 offset:20480
v_accvgpr_write_b32 a174,v14
M v[96:99],v[40:43],a[200:203],v[96:99]
ds_read_b64_tr_b16 v[52:53],v9 offset:24576
v_accvgpr_write_b32 a175,v15
M v[96:99],v[44:47],a[204:207],v[96:99]
ds_read_b64_tr_b16 v[54:55],v9 offset:28672
buffer_store_dwordx4 a[180:183],v20,s[20:23],s47 offen offset:1024 sc1
v_cvt_pk_bf16_f32 v236,v100,v101
v_cvt_pk_bf16_f32 v237,v102,v103
M v[100:103],v[32:35],a[208:211],0
ds_read_b64_tr_b16 v[56:57],v10 offset:16384
v_mul_f32 v11,v7,v11
M v[100:103],v[36:39],a[212:215],v[100:103]
ds_read_b64_tr_b16 v[58:59],v10 offset:20480
v_mul_f32 v21,v7,v21
M v[100:103],v[40:43],a[216:219],v[100:103]
ds_read_b64_tr_b16 v[60:61],v10 offset:24576
v_mul_f32 v22,v7,v22
M v[100:103],v[44:47],a[220:223],v[100:103]
ds_read_b64_tr_b16 v[62:63],v10 offset:28672
v_mul_f32 v23,v7,v23
v_cvt_pk_bf16_f32 v244,v104,v105
v_cvt_pk_bf16_f32 v245,v106,v107
M v[104:107],v[32:35],a[224:227],0
v_exp_f32 v111,v111
M v[104:107],v[36:39],a[228:231],v[104:107]
v_exp_f32 v112,v112
M v[104:107],v[40:43],a[232:235],v[104:107]
v_exp_f32 v113,v113
M v[104:107],v[44:47],a[236:239],v[104:107]
v_exp_f32 v114,v114
v_cvt_pk_bf16_f32 v252,v108,v109
v_cvt_pk_bf16_f32 v253,v110,v111
M v[108:111],v[32:35],a[240:243],0
v_exp_f32 v115,v115
M v[108:111],v[36:39],a[244:247],v[108:111]
v_exp_f32 v116,v116
M v[108:111],v[40:43],a[248:251],v[108:111]
v_exp_f32 v117,v117
M v[108:111],v[44:47],a[252:255],v[108:111]
s_waitcnt lgkmcnt(0)
v_mul_f32 v24,v7,v24
M a[0:3],v[48:51],v[224:227],a[0:3]
ds_read_b128 v[32:35],v8 offset:53248
v_mul_f32 v25,v7,v25
v_cvt_pk_bf16_f32 v230,v112,v113
v_cvt_pk_bf16_f32 v231,v114,v115
s_nop 1
M a[0:3],v[52:55],v[228:231],a[0:3]
v_exp_f32 v118,v118
M a[32:35],v[48:51],v[232:235],a[32:35]
ds_read_b128 v[36:39],v8 offset:53504
v_mul_f32 v26,v7,v26
v_cvt_pk_bf16_f32 v238,v116,v117
v_exp_f32 v119,v119
s_nop 0
v_cvt_pk_bf16_f32 v239,v118,v119
s_nop 1
M a[32:35],v[52:55],v[236:239],a[32:35]
v_cvt_pk_bf16_f32 v28,v11,v21
v_accvgpr_write_b32 a188,v28
v_mov_b32 v28,0
buffer_load_dword v15,v28,s[92:95],0 offen sc1
v_mul_f32 v27,v7,v27
M a[64:67],v[48:51],v[240:243],a[64:67]
ds_read_b128 v[40:43],v8 offset:53760
v_cvt_pk_bf16_f32 v29,v22,v23
v_exp_f32 v120,v120
v_exp_f32 v121,v121
s_nop 0
v_cvt_pk_bf16_f32 v246,v120,v121
v_exp_f32 v122,v122
v_exp_f32 v123,v123
s_nop 0
v_cvt_pk_bf16_f32 v247,v122,v123
s_nop 1
M a[64:67],v[52:55],v[244:247],a[64:67]
v_exp_f32 v124,v124
M a[96:99],v[48:51],v[248:251],a[96:99]
ds_read_b128 v[44:47],v8 offset:54016
v_cvt_pk_bf16_f32 v30,v24,v25
v_exp_f32 v125,v125
s_nop 0
v_cvt_pk_bf16_f32 v254,v124,v125
v_exp_f32 v126,v126
v_exp_f32 v127,v127
s_nop 0
v_cvt_pk_bf16_f32 v255,v126,v127
s_nop 1
M a[96:99],v[52:55],v[252:255],a[96:99]
buffer_store_dwordx4 a[136:139],v20,s[20:23],s44 offen offset:2048 sc1
v_cvt_pk_bf16_f32 v31,v26,v27
M a[4:7],v[56:59],v[224:227],a[4:7]
v_exp_f32 v128,v128
M a[4:7],v[60:63],v[228:231],a[4:7]
v_exp_f32 v129,v129
M a[36:39],v[56:59],v[232:235],a[36:39]
v_exp_f32 v130,v130
M a[36:39],v[60:63],v[236:239],a[36:39]
v_exp_f32 v131,v131
M a[68:71],v[56:59],v[240:243],a[68:71]
v_exp_f32 v132,v132
M a[68:71],v[60:63],v[244:247],a[68:71]
v_exp_f32 v133,v133
M a[100:103],v[56:59],v[248:251],a[100:103]
v_exp_f32 v134,v134
M a[100:103],v[60:63],v[252:255],a[100:103]
v_exp_f32 v135,v135
M v[160:163],v[176:179],v[224:227],v[160:163]
v_accvgpr_write_b32 a189,v29
v_accvgpr_write_b32 a190,v30
M v[160:163],v[176:179],v[228:231],v[160:163]
s_waitcnt lgkmcnt(0)
v_accvgpr_write_b32 a191,v31
M v[112:115],v[32:35],a[192:195],0
ds_read_b64_tr_b16 v[48:49],v9 offset:16640
s_lshl_b32 s80,s28,2
M v[112:115],v[36:39],a[196:199],v[112:115]
ds_read_b64_tr_b16 v[50:51],v9 offset:20736
s_add_u32 s80,s80,161808
M v[112:115],v[40:43],a[200:203],v[112:115]
ds_read_b64_tr_b16 v[52:53],v9 offset:24832
v_mov_b32 v0,s80
M v[112:115],v[44:47],a[204:207],v[112:115]
ds_read_b64_tr_b16 v[54:55],v9 offset:28928
v_mbcnt_lo_u32_b32 v2,-1,0
M v[116:119],v[32:35],a[208:211],0
ds_read_b64_tr_b16 v[56:57],v10 offset:16640
v_mbcnt_hi_u32_b32 v2,-1,v2
M v[116:119],v[36:39],a[212:215],v[116:119]
ds_read_b64_tr_b16 v[58:59],v10 offset:20736
v_lshlrev_b32 v11,4,v2
M v[116:119],v[40:43],a[216:219],v[116:119]
ds_read_b64_tr_b16 v[60:61],v10 offset:24832
v_lshrrev_b32 v3,4,v2
M v[116:119],v[44:47],a[220:223],v[116:119]
ds_read_b64_tr_b16 v[62:63],v10 offset:28928
v_and_b32 v23,15,v2
M v[120:123],v[32:35],a[224:227],0
v_exp_f32 v136,v136
M v[120:123],v[36:39],a[228:231],v[120:123]
buffer_store_dwordx4 a[152:155],v20,s[20:23],s45 offen offset:2048 sc1
s_lshr_b32 s80,s72,13
M v[120:123],v[40:43],a[232:235],v[120:123]
v_exp_f32 v137,v137
M v[120:123],v[44:47],a[236:239],v[120:123]
v_exp_f32 v138,v138
M v[124:127],v[32:35],a[240:243],0
v_exp_f32 v139,v139
M v[124:127],v[36:39],a[244:247],v[124:127]
v_exp_f32 v140,v140
M v[124:127],v[40:43],a[248:251],v[124:127]
v_exp_f32 v141,v141
M v[124:127],v[44:47],a[252:255],v[124:127]
s_waitcnt lgkmcnt(0)
s_and_b32 s80,8,s80
M a[8:11],v[48:51],v[224:227],a[8:11]
ds_read_b128 v[32:35],v8 offset:57344
v_lshlrev_b32 v29,1,v3
M a[8:11],v[52:55],v[228:231],a[8:11]
v_exp_f32 v142,v142
M a[40:43],v[48:51],v[232:235],a[40:43]
ds_read_b128 v[36:39],v8 offset:57600
v_xor_b32 v29,v29,v23
M a[40:43],v[52:55],v[236:239],a[40:43]
v_exp_f32 v143,v143
M a[72:75],v[48:51],v[240:243],a[72:75]
ds_read_b128 v[40:43],v8 offset:57856
v_xor_b32 v29,s80,v29
M a[72:75],v[52:55],v[244:247],a[72:75]
v_exp_f32 v144,v144
M a[104:107],v[48:51],v[248:251],a[104:107]
ds_read_b128 v[44:47],v8 offset:58112
v_lshlrev_b32 v29,4,v29
M a[104:107],v[52:55],v[252:255],a[104:107]
v_exp_f32 v145,v145
M a[12:15],v[56:59],v[224:227],a[12:15]
v_exp_f32 v146,v146
M a[12:15],v[60:63],v[228:231],a[12:15]
v_exp_f32 v147,v147
M a[44:47],v[56:59],v[232:235],a[44:47]
v_exp_f32 v148,v148
M a[44:47],v[60:63],v[236:239],a[44:47]
v_exp_f32 v149,v149
M a[76:79],v[56:59],v[240:243],a[76:79]
v_exp_f32 v150,v150
M a[76:79],v[60:63],v[244:247],a[76:79]
buffer_store_dwordx4 a[168:171],v20,s[20:23],s46 offen offset:2048 sc1
s_lshr_b32 s81,s74,3
M a[108:111],v[56:59],v[248:251],a[108:111]
v_exp_f32 v151,v151
M a[108:111],v[60:63],v[252:255],a[108:111]
v_exp_f32 v152,v152
M v[164:167],v[176:179],v[232:235],v[164:167]
v_exp_f32 v153,v153
M v[164:167],v[176:179],v[236:239],v[164:167]
s_waitcnt lgkmcnt(0)
s_and_b32 s81,128,s81
v_cvt_pk_bf16_f32 v192,v128,v129
v_cvt_pk_bf16_f32 v193,v130,v131
M v[128:131],v[32:35],a[192:195],0
ds_read_b64_tr_b16 v[48:49],v9 offset:16896
v_xor_b32 v29,s81,v29
M v[128:131],v[36:39],a[196:199],v[128:131]
ds_read_b64_tr_b16 v[50:51],v9 offset:20992
v_lshlrev_b32 v12,10,v3
M v[128:131],v[40:43],a[200:203],v[128:131]
ds_read_b64_tr_b16 v[52:53],v9 offset:25088
v_add_u32 v29,v29,v12
M v[128:131],v[44:47],a[204:207],v[128:131]
ds_read_b64_tr_b16 v[54:55],v9 offset:29184
s_lshr_b32 s80,s72,10
v_cvt_pk_bf16_f32 v200,v132,v133
v_cvt_pk_bf16_f32 v201,v134,v135
M v[132:135],v[32:35],a[208:211],0
ds_read_b64_tr_b16 v[56:57],v10 offset:16896
s_and_b32 s80,3,s80
M v[132:135],v[36:39],a[212:215],v[132:135]
ds_read_b64_tr_b16 v[58:59],v10 offset:20992
s_xor_b32 s80,s80,s28
M v[132:135],v[40:43],a[216:219],v[132:135]
ds_read_b64_tr_b16 v[60:61],v10 offset:25088
s_lshl_b32 s80,s80,15
M v[132:135],v[44:47],a[220:223],v[132:135]
ds_read_b64_tr_b16 v[62:63],v10 offset:29184
v_add_u32 v12,s80,v29
v_cvt_pk_bf16_f32 v208,v136,v137
v_cvt_pk_bf16_f32 v209,v138,v139
M v[136:139],v[32:35],a[224:227],0
v_exp_f32 v154,v154
M v[136:139],v[36:39],a[228:231],v[136:139]
v_exp_f32 v155,v155
M v[136:139],v[40:43],a[232:235],v[136:139]
v_exp_f32 v156,v156
M v[136:139],v[44:47],a[236:239],v[136:139]
v_exp_f32 v157,v157
v_cvt_pk_bf16_f32 v216,v140,v141
v_cvt_pk_bf16_f32 v217,v142,v143
M v[140:143],v[32:35],a[240:243],0
v_exp_f32 v158,v158
M v[140:143],v[36:39],a[244:247],v[140:143]
v_exp_f32 v159,v159
M v[140:143],v[40:43],a[248:251],v[140:143]
buffer_store_dwordx4 a[184:187],v20,s[20:23],s47 offen offset:2048 sc1
v_xor_b32 v13,128,v12
M v[140:143],v[44:47],a[252:255],v[140:143]
s_waitcnt lgkmcnt(0)
s_and_b32 s80,1,s83
M a[16:19],v[48:51],v[224:227],a[16:19]
ds_read_b128 v[32:35],v8 offset:61440
s_lshl_b32 s80,s80,7
M a[16:19],v[52:55],v[228:231],a[16:19]
v_exp_f32 v64,v64
M a[48:51],v[48:51],v[232:235],a[48:51]
ds_read_b128 v[36:39],v8 offset:61696
v_and_b32 v3,1,v3
M a[48:51],v[52:55],v[236:239],a[48:51]
v_exp_f32 v65,v65
M a[80:83],v[48:51],v[240:243],a[80:83]
ds_read_b128 v[40:43],v8 offset:61952
v_mul_u32_u24 v3,s80,v3
M a[80:83],v[52:55],v[244:247],a[80:83]
v_exp_f32 v66,v66
M a[112:115],v[48:51],v[248:251],a[112:115]
ds_read_b128 v[44:47],v8 offset:62208
v_and_b32 v23,7,v23
M a[112:115],v[52:55],v[252:255],a[112:115]
v_exp_f32 v67,v67
M a[20:23],v[56:59],v[224:227],a[20:23]
v_exp_f32 v68,v68
M a[20:23],v[60:63],v[228:231],a[20:23]
v_exp_f32 v69,v69
M a[52:55],v[56:59],v[232:235],a[52:55]
v_exp_f32 v70,v70
M a[52:55],v[60:63],v[236:239],a[52:55]
v_exp_f32 v71,v71
M a[84:87],v[56:59],v[240:243],a[84:87]
v_exp_f32 v72,v72
M a[84:87],v[60:63],v[244:247],a[84:87]
v_exp_f32 v73,v73
M a[116:119],v[56:59],v[248:251],a[116:119]
v_exp_f32 v74,v74
M a[116:119],v[60:63],v[252:255],a[116:119]
v_exp_f32 v75,v75
M v[168:171],v[176:179],v[240:243],v[168:171]
v_exp_f32 v76,v76
M v[168:171],v[176:179],v[244:247],v[168:171]
s_waitcnt lgkmcnt(0)
s_lshr_b32 s80,s72,13
v_cvt_pk_bf16_f32 v194,v144,v145
v_cvt_pk_bf16_f32 v195,v146,v147
M v[144:147],v[32:35],a[192:195],0
ds_read_b64_tr_b16 v[48:49],v9 offset:17152
buffer_store_dwordx4 a[140:143],v20,s[20:23],s44 offen offset:3072 sc1
M v[144:147],v[36:39],a[196:199],v[144:147]
ds_read_b64_tr_b16 v[50:51],v9 offset:21248
s_and_b32 s80,8,s80
M v[144:147],v[40:43],a[200:203],v[144:147]
ds_read_b64_tr_b16 v[52:53],v9 offset:25344
v_or_b32 v23,s80,v23
M v[144:147],v[44:47],a[204:207],v[144:147]
ds_read_b64_tr_b16 v[54:55],v9 offset:29440
v_lshlrev_b32 v23,2,v23
v_cvt_pk_bf16_f32 v202,v148,v149
v_cvt_pk_bf16_f32 v203,v150,v151
M v[148:151],v[32:35],a[208:211],0
ds_read_b64_tr_b16 v[56:57],v10 offset:17152
v_add_u32 v3,v3,v23
M v[148:151],v[36:39],a[212:215],v[148:151]
ds_read_b64_tr_b16 v[58:59],v10 offset:21248
s_and_b32 s81,0xfffffffe,s83
M v[148:151],v[40:43],a[216:219],v[148:151]
ds_read_b64_tr_b16 v[60:61],v10 offset:25344
v_add_u32 v27,s81,v3
M v[148:151],v[44:47],a[220:223],v[148:151]
ds_read_b64_tr_b16 v[62:63],v10 offset:29440
v_bfrev_b32 v14,2
v_cvt_pk_bf16_f32 v210,v152,v153
v_cvt_pk_bf16_f32 v211,v154,v155
M v[152:155],v[32:35],a[224:227],0
v_exp_f32 v77,v77
M v[152:155],v[36:39],a[228:231],v[152:155]
v_exp_f32 v78,v78
M v[152:155],v[40:43],a[232:235],v[152:155]
v_exp_f32 v79,v79
M v[152:155],v[44:47],a[236:239],v[152:155]
v_exp_f32 v80,v80
v_cvt_pk_bf16_f32 v218,v156,v157
v_cvt_pk_bf16_f32 v219,v158,v159
M v[156:159],v[32:35],a[240:243],0
v_exp_f32 v81,v81
M v[156:159],v[36:39],a[244:247],v[156:159]
v_exp_f32 v82,v82
M v[156:159],v[40:43],a[248:251],v[156:159]
v_exp_f32 v83,v83
M v[156:159],v[44:47],a[252:255],v[156:159]
s_cmp_lg_u64 vcc,0
s_cselect_b32 s55,1,0
s_or_b32 s43,s43,s55
v_mov_b32 v1,s43
ds_write_b32 v0,v1
s_waitcnt lgkmcnt(0)
s_barrier
M a[24:27],v[48:51],v[224:227],a[24:27]
ds_read_b128 v[32:35],v8
v_cvt_pk_bf16_f32 v196,v64,v65
M a[24:27],v[52:55],v[228:231],a[24:27]
v_exp_f32 v84,v84
M a[56:59],v[48:51],v[232:235],a[56:59]
ds_read_b128 v[36:39],v8 offset:256
v_cvt_pk_bf16_f32 v197,v66,v67
M a[56:59],v[52:55],v[236:239],a[56:59]
v_exp_f32 v85,v85
M a[88:91],v[48:51],v[240:243],a[88:91]
ds_read_b128 v[40:43],v8 offset:512
buffer_store_dwordx4 a[156:159],v20,s[20:23],s45 offen offset:3072 sc1
M a[88:91],v[52:55],v[244:247],a[88:91]
v_exp_f32 v86,v86
M a[120:123],v[48:51],v[248:251],a[120:123]
ds_read_b128 v[44:47],v8 offset:768
v_cvt_pk_bf16_f32 v204,v68,v69
M a[120:123],v[52:55],v[252:255],a[120:123]
v_exp_f32 v87,v87
M a[28:31],v[56:59],v[224:227],a[28:31]
v_exp_f32 v88,v88
M a[28:31],v[60:63],v[228:231],a[28:31]
v_exp_f32 v89,v89
M a[60:63],v[56:59],v[232:235],a[60:63]
v_exp_f32 v90,v90
M a[60:63],v[60:63],v[236:239],a[60:63]
v_exp_f32 v91,v91
M a[92:95],v[56:59],v[240:243],a[92:95]
v_exp_f32 v92,v92
M a[92:95],v[60:63],v[244:247],a[92:95]
v_exp_f32 v93,v93
M a[124:127],v[56:59],v[248:251],a[124:127]
v_exp_f32 v94,v94
M a[124:127],v[60:63],v[252:255],a[124:127]
v_exp_f32 v95,v95
M v[172:175],v[176:179],v[248:251],v[172:175]
v_exp_f32 v96,v96
M v[172:175],v[176:179],v[252:255],v[172:175]
s_waitcnt lgkmcnt(0)
v_cvt_pk_bf16_f32 v205,v70,v71
M v[64:67],v[32:35],a[192:195],0
ds_read_b64_tr_b16 v[48:49],v9 offset:32768
v_cvt_pk_bf16_f32 v212,v72,v73
M v[64:67],v[36:39],a[196:199],v[64:67]
ds_read_b64_tr_b16 v[50:51],v9 offset:36864
v_cvt_pk_bf16_f32 v213,v74,v75
M v[64:67],v[40:43],a[200:203],v[64:67]
ds_read_b64_tr_b16 v[52:53],v9 offset:40960
v_cvt_pk_bf16_f32 v220,v76,v77
M v[64:67],v[44:47],a[204:207],v[64:67]
ds_read_b64_tr_b16 v[54:55],v9 offset:45056
v_cvt_pk_bf16_f32 v221,v78,v79
M v[68:71],v[32:35],a[208:211],0
ds_read_b64_tr_b16 v[56:57],v10 offset:32768
v_cvt_pk_bf16_f32 v198,v80,v81
M v[68:71],v[36:39],a[212:215],v[68:71]
ds_read_b64_tr_b16 v[58:59],v10 offset:36864
v_cvt_pk_bf16_f32 v199,v82,v83
M v[68:71],v[40:43],a[216:219],v[68:71]
ds_read_b64_tr_b16 v[60:61],v10 offset:40960
buffer_store_dwordx4 a[172:175],v20,s[20:23],s46 offen offset:3072 sc1
M v[68:71],v[44:47],a[220:223],v[68:71]
ds_read_b64_tr_b16 v[62:63],v10 offset:45056
v_cvt_pk_bf16_f32 v206,v84,v85
M v[72:75],v[32:35],a[224:227],0
v_exp_f32 v97,v97
M v[72:75],v[36:39],a[228:231],v[72:75]
v_exp_f32 v98,v98
M v[72:75],v[40:43],a[232:235],v[72:75]
v_exp_f32 v99,v99
M v[72:75],v[44:47],a[236:239],v[72:75]
v_exp_f32 v100,v100
M v[76:79],v[32:35],a[240:243],0
v_exp_f32 v101,v101
M v[76:79],v[36:39],a[244:247],v[76:79]
v_exp_f32 v102,v102
M v[76:79],v[40:43],a[248:251],v[76:79]
v_exp_f32 v103,v103
M v[76:79],v[44:47],a[252:255],v[76:79]
s_waitcnt lgkmcnt(0)
v_cvt_pk_bf16_f32 v207,v86,v87
M a[0:3],v[48:51],v[192:195],a[0:3]
ds_read_b128 v[32:35],v8 offset:4096
s_mov_b32 s8,s37
M a[0:3],v[52:55],v[196:199],a[0:3]
s_mov_b32 s9,s53
v_cvt_pk_bf16_f32 v214,v88,v89
M a[32:35],v[48:51],v[200:203],a[32:35]
ds_read_b128 v[36:39],v8 offset:4352
s_mov_b32 s10,4194304
M a[32:35],v[52:55],v[204:207],a[32:35]
s_lshl_b32 s54,s28,13
v_cvt_pk_bf16_f32 v215,v90,v91
M a[64:67],v[48:51],v[208:211],a[64:67]
ds_read_b128 v[40:43],v8 offset:4608
s_add_u32 s54,s54,s89
M a[64:67],v[52:55],v[212:215],a[64:67]
s_cmp_lt_u32 s28,2
s_cselect_b32 s50,s54,0x40000000
M a[96:99],v[48:51],v[216:219],a[96:99]
ds_read_b128 v[44:47],v8 offset:4864
v_mbcnt_lo_u32_b32 v21,-1,0
v_cvt_pk_bf16_f32 v222,v92,v93
v_cvt_pk_bf16_f32 v223,v94,v95
s_nop 1
M a[96:99],v[52:55],v[220:223],a[96:99]
v_mbcnt_hi_u32_b32 v21,-1,v21
v_mov_b32 v29,161808
M a[4:7],v[56:59],v[192:195],a[4:7]
v_lshlrev_b32 v21,7,v21
ds_read_b128 v[4:7],v29
M a[4:7],v[60:63],v[196:199],a[4:7]
v_exp_f32 v104,v104
M a[36:39],v[56:59],v[200:203],a[36:39]
buffer_store_dwordx4 a[188:191],v20,s[20:23],s47 offen offset:3072 sc1
s_waitcnt lgkmcnt(0)
v_or_b32 v4,v4,v5
M a[36:39],v[60:63],v[204:207],a[36:39]
v_exp_f32 v105,v105
M a[68:71],v[56:59],v[208:211],a[68:71]
v_exp_f32 v106,v106
M a[68:71],v[60:63],v[212:215],a[68:71]
v_exp_f32 v107,v107
M a[100:103],v[56:59],v[216:219],a[100:103]
v_exp_f32 v108,v108
M a[100:103],v[60:63],v[220:223],a[100:103]
v_exp_f32 v109,v109
M v[160:163],v[176:179],v[192:195],v[160:163]
v_exp_f32 v110,v110
M v[160:163],v[176:179],v[196:199],v[160:163]
v_or_b32 v6,v6,v7
M v[80:83],v[32:35],a[192:195],0
ds_read_b64_tr_b16 v[48:49],v9 offset:33024
v_or_b32 v4,v4,v6
M v[80:83],v[36:39],a[196:199],v[80:83]
ds_read_b64_tr_b16 v[50:51],v9 offset:37120
v_readfirstlane_b32 s3,v4
M v[80:83],v[40:43],a[200:203],v[80:83]
ds_read_b64_tr_b16 v[52:53],v9 offset:41216
v_cvt_pk_bf16_f32 v224,v96,v97
M v[80:83],v[44:47],a[204:207],v[80:83]
ds_read_b64_tr_b16 v[54:55],v9 offset:45312
v_cvt_pk_bf16_f32 v225,v98,v99
M v[84:87],v[32:35],a[208:211],0
ds_read_b64_tr_b16 v[56:57],v10 offset:33024
v_cvt_pk_bf16_f32 v232,v100,v101
M v[84:87],v[36:39],a[212:215],v[84:87]
ds_read_b64_tr_b16 v[58:59],v10 offset:37120
v_cvt_pk_bf16_f32 v233,v102,v103
M v[84:87],v[40:43],a[216:219],v[84:87]
ds_read_b64_tr_b16 v[60:61],v10 offset:41216
v_cvt_pk_bf16_f32 v240,v104,v105
M v[84:87],v[44:47],a[220:223],v[84:87]
ds_read_b64_tr_b16 v[62:63],v10 offset:45312
v_cvt_pk_bf16_f32 v241,v106,v107
M v[88:91],v[32:35],a[224:227],0
s_cmp_lt_u32 s2,240
s_cselect_b32 s29,s3,1
M v[88:91],v[36:39],a[228:231],v[88:91]
v_exp_f32 v111,v111
M v[88:91],v[40:43],a[232:235],v[88:91]
v_exp_f32 v112,v112
M v[88:91],v[44:47],a[236:239],v[88:91]
v_exp_f32 v113,v113
M v[92:95],v[32:35],a[240:243],0
v_exp_f32 v114,v114
M v[92:95],v[36:39],a[244:247],v[92:95]
v_exp_f32 v115,v115
M v[92:95],v[40:43],a[248:251],v[92:95]
v_exp_f32 v116,v116
M v[92:95],v[44:47],a[252:255],v[92:95]
s_waitcnt lgkmcnt(0)
v_cvt_pk_bf16_f32 v248,v108,v109
M a[8:11],v[48:51],v[192:195],a[8:11]
ds_read_b128 v[32:35],v8 offset:8192
v_cvt_pk_bf16_f32 v249,v110,v111
M a[8:11],v[52:55],v[196:199],a[8:11]
v_exp_f32 v117,v117
M a[40:43],v[48:51],v[200:203],a[40:43]
ds_read_b128 v[36:39],v8 offset:8448
v_cvt_pk_bf16_f32 v226,v112,v113
M a[40:43],v[52:55],v[204:207],a[40:43]
v_exp_f32 v118,v118
M a[72:75],v[48:51],v[208:211],a[72:75]
ds_read_b128 v[40:43],v8 offset:8704
v_cvt_pk_bf16_f32 v227,v114,v115
M a[72:75],v[52:55],v[212:215],a[72:75]
v_exp_f32 v119,v119
M a[104:107],v[48:51],v[216:219],a[104:107]
ds_read_b128 v[44:47],v8 offset:8960
v_cvt_pk_bf16_f32 v234,v116,v117
M a[104:107],v[52:55],v[220:223],a[104:107]
v_exp_f32 v120,v120
M a[12:15],v[56:59],v[192:195],a[12:15]
v_exp_f32 v121,v121
M a[12:15],v[60:63],v[196:199],a[12:15]
v_exp_f32 v122,v122
M a[44:47],v[56:59],v[200:203],a[44:47]
v_exp_f32 v123,v123
M a[44:47],v[60:63],v[204:207],a[44:47]
v_exp_f32 v124,v124
M a[76:79],v[56:59],v[208:211],a[76:79]
v_exp_f32 v125,v125
M a[76:79],v[60:63],v[212:215],a[76:79]
v_exp_f32 v126,v126
M a[108:111],v[56:59],v[216:219],a[108:111]
v_exp_f32 v127,v127
M a[108:111],v[60:63],v[220:223],a[108:111]
v_exp_f32 v128,v128
M v[164:167],v[176:179],v[200:203],v[164:167]
v_exp_f32 v129,v129
M v[164:167],v[176:179],v[204:207],v[164:167]
s_waitcnt lgkmcnt(0)
v_cvt_pk_bf16_f32 v235,v118,v119
M v[96:99],v[32:35],a[192:195],0
ds_read_b64_tr_b16 v[48:49],v9 offset:33280
v_cvt_pk_bf16_f32 v242,v120,v121
M v[96:99],v[36:39],a[196:199],v[96:99]
ds_read_b64_tr_b16 v[50:51],v9 offset:37376
v_cvt_pk_bf16_f32 v243,v122,v123
M v[96:99],v[40:43],a[200:203],v[96:99]
ds_read_b64_tr_b16 v[52:53],v9 offset:41472
v_cvt_pk_bf16_f32 v250,v124,v125
M v[96:99],v[44:47],a[204:207],v[96:99]
ds_read_b64_tr_b16 v[54:55],v9 offset:45568
v_cvt_pk_bf16_f32 v251,v126,v127
M v[100:103],v[32:35],a[208:211],0
ds_read_b64_tr_b16 v[56:57],v10 offset:33280
v_cvt_pk_bf16_f32 v228,v128,v129
M v[100:103],v[36:39],a[212:215],v[100:103]
ds_read_b64_tr_b16 v[58:59],v10 offset:37376
M v[100:103],v[40:43],a[216:219],v[100:103]
ds_read_b64_tr_b16 v[60:61],v10 offset:41472
M v[100:103],v[44:47],a[220:223],v[100:103]
ds_read_b64_tr_b16 v[62:63],v10 offset:45568
M v[104:107],v[32:35],a[224:227],0
v_exp_f32 v130,v130
M v[104:107],v[36:39],a[228:231],v[104:107]
v_exp_f32 v131,v131
M v[104:107],v[40:43],a[232:235],v[104:107]
v_exp_f32 v132,v132
M v[104:107],v[44:47],a[236:239],v[104:107]
v_exp_f32 v133,v133
M v[108:111],v[32:35],a[240:243],0
v_exp_f32 v134,v134
M v[108:111],v[36:39],a[244:247],v[108:111]
v_exp_f32 v135,v135
M v[108:111],v[40:43],a[248:251],v[108:111]
v_exp_f32 v136,v136
M v[108:111],v[44:47],a[252:255],v[108:111]
s_waitcnt lgkmcnt(0)
v_cvt_pk_bf16_f32 v229,v130,v131
M a[16:19],v[48:51],v[192:195],a[16:19]
ds_read_b128 v[32:35],v8 offset:12288
v_cvt_pk_bf16_f32 v236,v132,v133
M a[16:19],v[52:55],v[196:199],a[16:19]
v_exp_f32 v137,v137
M a[48:51],v[48:51],v[200:203],a[48:51]
ds_read_b128 v[36:39],v8 offset:12544
v_cvt_pk_bf16_f32 v237,v134,v135
M a[48:51],v[52:55],v[204:207],a[48:51]
v_exp_f32 v138,v138
M a[80:83],v[48:51],v[208:211],a[80:83]
ds_read_b128 v[40:43],v8 offset:12800
v_cvt_pk_bf16_f32 v244,v136,v137
M a[80:83],v[52:55],v[212:215],a[80:83]
v_exp_f32 v139,v139
M a[112:115],v[48:51],v[216:219],a[112:115]
ds_read_b128 v[44:47],v8 offset:13056
v_cvt_pk_bf16_f32 v245,v138,v139
M a[112:115],v[52:55],v[220:223],a[112:115]
v_exp_f32 v140,v140
M a[20:23],v[56:59],v[192:195],a[20:23]
v_exp_f32 v141,v141
M a[20:23],v[60:63],v[196:199],a[20:23]
v_exp_f32 v142,v142
M a[52:55],v[56:59],v[200:203],a[52:55]
v_exp_f32 v143,v143
M a[52:55],v[60:63],v[204:207],a[52:55]
v_exp_f32 v144,v144
M a[84:87],v[56:59],v[208:211],a[84:87]
v_exp_f32 v145,v145
M a[84:87],v[60:63],v[212:215],a[84:87]
v_exp_f32 v146,v146
M a[116:119],v[56:59],v[216:219],a[116:119]
v_exp_f32 v147,v147
M a[116:119],v[60:63],v[220:223],a[116:119]
v_exp_f32 v148,v148
M v[168:171],v[176:179],v[208:211],v[168:171]
v_exp_f32 v149,v149
M v[168:171],v[176:179],v[212:215],v[168:171]
s_waitcnt lgkmcnt(0)
v_cvt_pk_bf16_f32 v252,v140,v141
M v[112:115],v[32:35],a[192:195],0
ds_read_b64_tr_b16 v[48:49],v9 offset:33536
v_cvt_pk_bf16_f32 v253,v142,v143
M v[112:115],v[36:39],a[196:199],v[112:115]
ds_read_b64_tr_b16 v[50:51],v9 offset:37632
v_cvt_pk_bf16_f32 v230,v144,v145
M v[112:115],v[40:43],a[200:203],v[112:115]
ds_read_b64_tr_b16 v[52:53],v9 offset:41728
v_cvt_pk_bf16_f32 v231,v146,v147
M v[112:115],v[44:47],a[204:207],v[112:115]
ds_read_b64_tr_b16 v[54:55],v9 offset:45824
v_cvt_pk_bf16_f32 v238,v148,v149
M v[116:119],v[32:35],a[208:211],0
ds_read_b64_tr_b16 v[56:57],v10 offset:33536
M v[116:119],v[36:39],a[212:215],v[116:119]
ds_read_b64_tr_b16 v[58:59],v10 offset:37632
M v[116:119],v[40:43],a[216:219],v[116:119]
ds_read_b64_tr_b16 v[60:61],v10 offset:41728
M v[116:119],v[44:47],a[220:223],v[116:119]
ds_read_b64_tr_b16 v[62:63],v10 offset:45824
M v[120:123],v[32:35],a[224:227],0
v_exp_f32 v150,v150
M v[120:123],v[36:39],a[228:231],v[120:123]
v_exp_f32 v151,v151
M v[120:123],v[40:43],a[232:235],v[120:123]
v_exp_f32 v152,v152
M v[120:123],v[44:47],a[236:239],v[120:123]
v_exp_f32 v153,v153
M v[124:127],v[32:35],a[240:243],0
v_exp_f32 v154,v154
M v[124:127],v[36:39],a[244:247],v[124:127]
v_exp_f32 v155,v155
M v[124:127],v[40:43],a[248:251],v[124:127]
s_waitcnt vmcnt(8)
v_readfirstlane_b32 s80,v15
s_nop 0
s_cmp_ge_u32 s80,256
s_cbranch_scc0 A_CNT_SPIN
A_CNT_BACK:
M v[124:127],v[44:47],a[252:255],v[124:127]
s_waitcnt vmcnt(0) lgkmcnt(0)
s_barrier
M a[24:27],v[48:51],v[192:195],a[24:27]
ds_read_b128 v[32:35],v8 offset:16384
v_cvt_pk_bf16_f32 v239,v150,v151
M a[24:27],v[52:55],v[196:199],a[24:27]
v_exp_f32 v156,v156
M a[56:59],v[48:51],v[200:203],a[56:59]
ds_read_b128 v[36:39],v8 offset:16640
v_cvt_pk_bf16_f32 v246,v152,v153
M a[56:59],v[52:55],v[204:207],a[56:59]
v_exp_f32 v157,v157
M a[88:91],v[48:51],v[208:211],a[88:91]
ds_read_b128 v[40:43],v8 offset:16896
v_cvt_pk_bf16_f32 v247,v154,v155
M a[88:91],v[52:55],v[212:215],a[88:91]
v_exp_f32 v158,v158
M a[120:123],v[48:51],v[216:219],a[120:123]
ds_read_b128 v[44:47],v8 offset:17152
v_cvt_pk_bf16_f32 v254,v156,v157
M a[120:123],v[52:55],v[220:223],a[120:123]
v_exp_f32 v159,v159
M a[28:31],v[56:59],v[192:195],a[28:31]
v_exp_f32 v64,v64
M a[28:31],v[60:63],v[196:199],a[28:31]
v_exp_f32 v65,v65
M a[60:63],v[56:59],v[200:203],a[60:63]
v_exp_f32 v66,v66
M a[60:63],v[60:63],v[204:207],a[60:63]
v_exp_f32 v67,v67
M a[92:95],v[56:59],v[208:211],a[92:95]
v_exp_f32 v68,v68
M a[92:95],v[60:63],v[212:215],a[92:95]
v_exp_f32 v69,v69
M a[124:127],v[56:59],v[216:219],a[124:127]
v_exp_f32 v70,v70
M a[124:127],v[60:63],v[220:223],a[124:127]
v_exp_f32 v71,v71
M v[172:175],v[176:179],v[216:219],v[172:175]
v_exp_f32 v72,v72
M v[172:175],v[176:179],v[220:223],v[172:175]
s_waitcnt lgkmcnt(0)
v_cvt_pk_bf16_f32 v255,v158,v159
M v[128:131],v[32:35],a[192:195],0
ds_read_b64_tr_b16 v[48:49],v9 offset:49152
v_cvt_pk_bf16_f32 v192,v64,v65
M v[128:131],v[36:39],a[196:199],v[128:131]
ds_read_b64_tr_b16 v[50:51],v9 offset:53248
v_cvt_pk_bf16_f32 v193,v66,v67
M v[128:131],v[40:43],a[200:203],v[128:131]
ds_read_b64_tr_b16 v[52:53],v9 offset:57344
v_cvt_pk_bf16_f32 v200,v68,v69
M v[128:131],v[44:47],a[204:207],v[128:131]
ds_read_b64_tr_b16 v[54:55],v9 offset:61440
v_cvt_pk_bf16_f32 v201,v70,v71
M v[132:135],v[32:35],a[208:211],0
ds_read_b64_tr_b16 v[56:57],v10 offset:49152
M v[132:135],v[36:39],a[212:215],v[132:135]
ds_read_b64_tr_b16 v[58:59],v10 offset:53248
M v[132:135],v[40:43],a[216:219],v[132:135]
ds_read_b64_tr_b16 v[60:61],v10 offset:57344
M v[132:135],v[44:47],a[220:223],v[132:135]
ds_read_b64_tr_b16 v[62:63],v10 offset:61440
M v[136:139],v[32:35],a[224:227],0
v_exp_f32 v73,v73
M v[136:139],v[36:39],a[228:231],v[136:139]
v_exp_f32 v74,v74
M v[136:139],v[40:43],a[232:235],v[136:139]
v_exp_f32 v75,v75
M v[136:139],v[44:47],a[236:239],v[136:139]
v_exp_f32 v76,v76
M v[140:143],v[32:35],a[240:243],0
v_exp_f32 v77,v77
M v[140:143],v[36:39],a[244:247],v[140:143]
v_exp_f32 v78,v78
M v[140:143],v[40:43],a[248:251],v[140:143]
v_exp_f32 v79,v79
M v[140:143],v[44:47],a[252:255],v[140:143]
s_waitcnt lgkmcnt(0)
v_cvt_pk_bf16_f32 v208,v72,v73
M a[0:3],v[48:51],v[224:227],a[0:3]
ds_read_b128 v[32:35],v8 offset:20480
v_cvt_pk_bf16_f32 v209,v74,v75
M a[0:3],v[52:55],v[228:231],a[0:3]
v_exp_f32 v80,v80
M a[32:35],v[48:51],v[232:235],a[32:35]
ds_read_b128 v[36:39],v8 offset:20736
v_cvt_pk_bf16_f32 v216,v76,v77
M a[32:35],v[52:55],v[236:239],a[32:35]
v_exp_f32 v81,v81
M a[64:67],v[48:51],v[240:243],a[64:67]
ds_read_b128 v[40:43],v8 offset:20992
v_cvt_pk_bf16_f32 v217,v78,v79
M a[64:67],v[52:55],v[244:247],a[64:67]
v_exp_f32 v82,v82
M a[96:99],v[48:51],v[248:251],a[96:99]
ds_read_b128 v[44:47],v8 offset:21248
v_cvt_pk_bf16_f32 v194,v80,v81
M a[96:99],v[52:55],v[252:255],a[96:99]
v_exp_f32 v83,v83
M a[4:7],v[56:59],v[224:227],a[4:7]
v_exp_f32 v84,v84
M a[4:7],v[60:63],v[228:231],a[4:7]
buffer_load_dword v22,v21,s[8:11],s50 offen
v_cvt_pk_bf16_f32 v195,v82,v83
M a[36:39],v[56:59],v[232:235],a[36:39]
s_add_u32 s50,s50,16384
M a[36:39],v[60:63],v[236:239],a[36:39]
v_exp_f32 v85,v85
M a[68:71],v[56:59],v[240:243],a[68:71]
v_exp_f32 v86,v86
M a[68:71],v[60:63],v[244:247],a[68:71]
v_exp_f32 v87,v87
M a[100:103],v[56:59],v[248:251],a[100:103]
v_exp_f32 v88,v88
M a[100:103],v[60:63],v[252:255],a[100:103]
v_exp_f32 v89,v89
M v[160:163],v[176:179],v[224:227],v[160:163]
v_exp_f32 v90,v90
M v[160:163],v[176:179],v[228:231],v[160:163]
s_waitcnt lgkmcnt(0)
v_cvt_pk_bf16_f32 v202,v84,v85
M v[144:147],v[32:35],a[192:195],0
ds_read_b64_tr_b16 v[48:49],v9 offset:49408
v_cvt_pk_bf16_f32 v203,v86,v87
M v[144:147],v[36:39],a[196:199],v[144:147]
ds_read_b64_tr_b16 v[50:51],v9 offset:53504
v_cvt_pk_bf16_f32 v210,v88,v89
M v[144:147],v[40:43],a[200:203],v[144:147]
ds_read_b64_tr_b16 v[52:53],v9 offset:57600
M v[144:147],v[44:47],a[204:207],v[144:147]
ds_read_b64_tr_b16 v[54:55],v9 offset:61696
M v[148:151],v[32:35],a[208:211],0
ds_read_b64_tr_b16 v[56:57],v10 offset:49408
M v[148:151],v[36:39],a[212:215],v[148:151]
ds_read_b64_tr_b16 v[58:59],v10 offset:53504
M v[148:151],v[40:43],a[216:219],v[148:151]
ds_read_b64_tr_b16 v[60:61],v10 offset:57600
M v[148:151],v[44:47],a[220:223],v[148:151]
ds_read_b64_tr_b16 v[62:63],v10 offset:61696
M v[152:155],v[32:35],a[224:227],0
v_exp_f32 v91,v91
M v[152:155],v[36:39],a[228:231],v[152:155]
v_exp_f32 v92,v92
M v[152:155],v[40:43],a[232:235],v[152:155]
v_exp_f32 v93,v93
M v[152:155],v[44:47],a[236:239],v[152:155]
v_exp_f32 v94,v94
M v[156:159],v[32:35],a[240:243],0
v_exp_f32 v95,v95
M v[156:159],v[36:39],a[244:247],v[156:159]
v_exp_f32 v96,v96
M v[156:159],v[40:43],a[248:251],v[156:159]
v_exp_f32 v97,v97
M v[156:159],v[44:47],a[252:255],v[156:159]
s_waitcnt lgkmcnt(0)
v_cvt_pk_bf16_f32 v211,v90,v91
M a[8:11],v[48:51],v[224:227],a[8:11]
ds_read_b128 v[32:35],v8 offset:24576
v_cvt_pk_bf16_f32 v218,v92,v93
M a[8:11],v[52:55],v[228:231],a[8:11]
v_exp_f32 v98,v98
M a[40:43],v[48:51],v[232:235],a[40:43]
ds_read_b128 v[36:39],v8 offset:24832
v_cvt_pk_bf16_f32 v219,v94,v95
M a[40:43],v[52:55],v[236:239],a[40:43]
v_exp_f32 v99,v99
M a[72:75],v[48:51],v[240:243],a[72:75]
ds_read_b128 v[40:43],v8 offset:25088
v_cvt_pk_bf16_f32 v196,v96,v97
M a[72:75],v[52:55],v[244:247],a[72:75]
v_exp_f32 v100,v100
M a[104:107],v[48:51],v[248:251],a[104:107]
ds_read_b128 v[44:47],v8 offset:25344
v_cvt_pk_bf16_f32 v197,v98,v99
M a[104:107],v[52:55],v[252:255],a[104:107]
v_exp_f32 v101,v101
M a[12:15],v[56:59],v[224:227],a[12:15]
v_exp_f32 v102,v102
M a[12:15],v[60:63],v[228:231],a[12:15]
v_exp_f32 v103,v103
M a[44:47],v[56:59],v[232:235],a[44:47]
v_exp_f32 v104,v104
M a[44:47],v[60:63],v[236:239],a[44:47]
v_exp_f32 v105,v105
M a[76:79],v[56:59],v[240:243],a[76:79]
v_exp_f32 v106,v106
M a[76:79],v[60:63],v[244:247],a[76:79]
v_exp_f32 v107,v107
M a[108:111],v[56:59],v[248:251],a[108:111]
v_exp_f32 v108,v108
M a[108:111],v[60:63],v[252:255],a[108:111]
v_exp_f32 v109,v109
M v[164:167],v[176:179],v[232:235],v[164:167]
v_exp_f32 v110,v110
M v[164:167],v[176:179],v[236:239],v[164:167]
s_waitcnt lgkmcnt(0)
v_cvt_pk_bf16_f32 v204,v100,v101
M v[64:67],v[32:35],a[192:195],0
ds_read_b64_tr_b16 v[48:49],v9 offset:49664
v_cvt_pk_bf16_f32 v205,v102,v103
M v[64:67],v[36:39],a[196:199],v[64:67]
ds_read_b64_tr_b16 v[50:51],v9 offset:53760
v_cvt_pk_bf16_f32 v212,v104,v105
M v[64:67],v[40:43],a[200:203],v[64:67]
ds_read_b64_tr_b16 v[52:53],v9 offset:57856
v_cvt_pk_bf16_f32 v213,v106,v107
M v[64:67],v[44:47],a[204:207],v[64:67]
ds_read_b64_tr_b16 v[54:55],v9 offset:61952
v_cvt_pk_bf16_f32 v220,v108,v109
M v[68:71],v[32:35],a[208:211],0
ds_read_b64_tr_b16 v[56:57],v10 offset:49664
M v[68:71],v[36:39],a[212:215],v[68:71]
ds_read_b64_tr_b16 v[58:59],v10 offset:53760
M v[68:71],v[40:43],a[216:219],v[68:71]
ds_read_b64_tr_b16 v[60:61],v10 offset:57856
M v[68:71],v[44:47],a[220:223],v[68:71]
ds_read_b64_tr_b16 v[62:63],v10 offset:61952
M v[72:75],v[32:35],a[224:227],0
v_exp_f32 v111,v111
M v[72:75],v[36:39],a[228:231],v[72:75]
v_exp_f32 v112,v112
M v[72:75],v[40:43],a[232:235],v[72:75]
v_exp_f32 v113,v113
M v[72:75],v[44:47],a[236:239],v[72:75]
v_exp_f32 v114,v114
M v[76:79],v[32:35],a[240:243],0
v_exp_f32 v115,v115
M v[76:79],v[36:39],a[244:247],v[76:79]
v_exp_f32 v116,v116
M v[76:79],v[40:43],a[248:251],v[76:79]
v_exp_f32 v117,v117
M v[76:79],v[44:47],a[252:255],v[76:79]
s_waitcnt lgkmcnt(0)
v_cvt_pk_bf16_f32 v221,v110,v111
M a[16:19],v[48:51],v[224:227],a[16:19]
ds_read_b128 v[32:35],v8 offset:28672
v_cvt_pk_bf16_f32 v198,v112,v113
M a[16:19],v[52:55],v[228:231],a[16:19]
v_exp_f32 v118,v118
M a[48:51],v[48:51],v[232:235],a[48:51]
ds_read_b128 v[36:39],v8 offset:28928
v_cvt_pk_bf16_f32 v199,v114,v115
M a[48:51],v[52:55],v[236:239],a[48:51]
v_exp_f32 v119,v119
M a[80:83],v[48:51],v[240:243],a[80:83]
ds_read_b128 v[40:43],v8 offset:29184
v_cvt_pk_bf16_f32 v206,v116,v117
M a[80:83],v[52:55],v[244:247],a[80:83]
v_exp_f32 v120,v120
M a[112:115],v[48:51],v[248:251],a[112:115]
ds_read_b128 v[44:47],v8 offset:29440
v_cvt_pk_bf16_f32 v207,v118,v119
M a[112:115],v[52:55],v[252:255],a[112:115]
v_exp_f32 v121,v121
M a[20:23],v[56:59],v[224:227],a[20:23]
v_exp_f32 v122,v122
M a[20:23],v[60:63],v[228:231],a[20:23]
v_exp_f32 v123,v123
M a[52:55],v[56:59],v[232:235],a[52:55]
v_exp_f32 v124,v124
M a[52:55],v[60:63],v[236:239],a[52:55]
v_exp_f32 v125,v125
M a[84:87],v[56:59],v[240:243],a[84:87]
v_exp_f32 v126,v126
M a[84:87],v[60:63],v[244:247],a[84:87]
v_exp_f32 v127,v127
M a[116:119],v[56:59],v[248:251],a[116:119]
v_exp_f32 v128,v128
M a[116:119],v[60:63],v[252:255],a[116:119]
v_exp_f32 v129,v129
M v[168:171],v[176:179],v[240:243],v[168:171]
v_exp_f32 v130,v130
M v[168:171],v[176:179],v[244:247],v[168:171]
s_waitcnt lgkmcnt(0)
v_cvt_pk_bf16_f32 v214,v120,v121
M v[80:83],v[32:35],a[192:195],0
ds_read_b64_tr_b16 v[48:49],v9 offset:49920
v_cvt_pk_bf16_f32 v215,v122,v123
M v[80:83],v[36:39],a[196:199],v[80:83]
ds_read_b64_tr_b16 v[50:51],v9 offset:54016
v_cvt_pk_bf16_f32 v222,v124,v125
M v[80:83],v[40:43],a[200:203],v[80:83]
ds_read_b64_tr_b16 v[52:53],v9 offset:58112
v_cvt_pk_bf16_f32 v223,v126,v127
M v[80:83],v[44:47],a[204:207],v[80:83]
ds_read_b64_tr_b16 v[54:55],v9 offset:62208
M v[84:87],v[32:35],a[208:211],0
ds_read_b64_tr_b16 v[56:57],v10 offset:49920
M v[84:87],v[36:39],a[212:215],v[84:87]
ds_read_b64_tr_b16 v[58:59],v10 offset:54016
M v[84:87],v[40:43],a[216:219],v[84:87]
ds_read_b64_tr_b16 v[60:61],v10 offset:58112
M v[84:87],v[44:47],a[220:223],v[84:87]
ds_read_b64_tr_b16 v[62:63],v10 offset:62208
M v[88:91],v[32:35],a[224:227],0
v_exp_f32 v131,v131
M v[88:91],v[36:39],a[228:231],v[88:91]
v_exp_f32 v132,v132
M v[88:91],v[40:43],a[232:235],v[88:91]
v_exp_f32 v133,v133
M v[88:91],v[44:47],a[236:239],v[88:91]
v_exp_f32 v134,v134
M v[92:95],v[32:35],a[240:243],0
v_exp_f32 v135,v135
M v[92:95],v[36:39],a[244:247],v[92:95]
v_exp_f32 v136,v136
M v[92:95],v[40:43],a[248:251],v[92:95]
v_exp_f32 v137,v137
M v[92:95],v[44:47],a[252:255],v[92:95]
s_waitcnt lgkmcnt(0)
s_barrier
M a[24:27],v[48:51],v[224:227],a[24:27]
ds_read_b128 v[32:35],v8 offset:32768
M a[24:27],v[52:55],v[228:231],a[24:27]
v_exp_f32 v138,v138
M a[56:59],v[48:51],v[232:235],a[56:59]
ds_read_b128 v[36:39],v8 offset:33024
M a[56:59],v[52:55],v[236:239],a[56:59]
v_exp_f32 v139,v139
M a[88:91],v[48:51],v[240:243],a[88:91]
ds_read_b128 v[40:43],v8 offset:33280
M a[88:91],v[52:55],v[244:247],a[88:91]
v_exp_f32 v140,v140
M a[120:123],v[48:51],v[248:251],a[120:123]
ds_read_b128 v[44:47],v8 offset:33536
M a[120:123],v[52:55],v[252:255],a[120:123]
v_exp_f32 v141,v141
M a[28:31],v[56:59],v[224:227],a[28:31]
v_exp_f32 v142,v142
M a[28:31],v[60:63],v[228:231],a[28:31]
v_exp_f32 v143,v143
M a[60:63],v[56:59],v[232:235],a[60:63]
v_exp_f32 v144,v144
M a[60:63],v[60:63],v[236:239],a[60:63]
v_exp_f32 v145,v145
M a[92:95],v[56:59],v[240:243],a[92:95]
v_exp_f32 v146,v146
M a[92:95],v[60:63],v[244:247],a[92:95]
v_exp_f32 v147,v147
M a[124:127],v[56:59],v[248:251],a[124:127]
v_exp_f32 v148,v148
M a[124:127],v[60:63],v[252:255],a[124:127]
v_exp_f32 v149,v149
M v[172:175],v[176:179],v[248:251],v[172:175]
v_exp_f32 v150,v150
M v[172:175],v[176:179],v[252:255],v[172:175]
s_waitcnt lgkmcnt(0)
v_cvt_pk_bf16_f32 v224,v128,v129
M v[96:99],v[32:35],a[192:195],0
ds_read_b64_tr_b16 v[48:49],v9
v_cvt_pk_bf16_f32 v225,v130,v131
M v[96:99],v[36:39],a[196:199],v[96:99]
ds_read_b64_tr_b16 v[50:51],v9 offset:4096
v_cvt_pk_bf16_f32 v232,v132,v133
M v[96:99],v[40:43],a[200:203],v[96:99]
ds_read_b64_tr_b16 v[52:53],v9 offset:8192
v_cvt_pk_bf16_f32 v233,v134,v135
M v[96:99],v[44:47],a[204:207],v[96:99]
ds_read_b64_tr_b16 v[54:55],v9 offset:12288
buffer_load_dword v15,v27,s[64:67],0 offen sc1
M v[100:103],v[32:35],a[208:211],0
ds_read_b64_tr_b16 v[56:57],v10
v_cvt_pk_bf16_f32 v240,v136,v137
M v[100:103],v[36:39],a[212:215],v[100:103]
ds_read_b64_tr_b16 v[58:59],v10 offset:4096
v_cvt_pk_bf16_f32 v241,v138,v139
M v[100:103],v[40:43],a[216:219],v[100:103]
ds_read_b64_tr_b16 v[60:61],v10 offset:8192
v_cvt_pk_bf16_f32 v248,v140,v141
M v[100:103],v[44:47],a[220:223],v[100:103]
ds_read_b64_tr_b16 v[62:63],v10 offset:12288
v_cvt_pk_bf16_f32 v249,v142,v143
M v[104:107],v[32:35],a[224:227],0
v_exp_f32 v151,v151
M v[104:107],v[36:39],a[228:231],v[104:107]
v_exp_f32 v152,v152
M v[104:107],v[40:43],a[232:235],v[104:107]
v_exp_f32 v153,v153
M v[104:107],v[44:47],a[236:239],v[104:107]
v_exp_f32 v154,v154
M v[108:111],v[32:35],a[240:243],0
v_exp_f32 v155,v155
M v[108:111],v[36:39],a[244:247],v[108:111]
v_exp_f32 v156,v156
M v[108:111],v[40:43],a[248:251],v[108:111]
v_exp_f32 v157,v157
M v[108:111],v[44:47],a[252:255],v[108:111]
s_waitcnt lgkmcnt(0)
v_cvt_pk_bf16_f32 v226,v144,v145
M a[0:3],v[48:51],v[192:195],a[0:3]
ds_read_b128 v[32:35],v8 offset:36864
v_cvt_pk_bf16_f32 v227,v146,v147
M a[0:3],v[52:55],v[196:199],a[0:3]
v_exp_f32 v158,v158
M a[32:35],v[48:51],v[200:203],a[32:35]
ds_read_b128 v[36:39],v8 offset:37120
v_cvt_pk_bf16_f32 v234,v148,v149
M a[32:35],v[52:55],v[204:207],a[32:35]
v_exp_f32 v159,v159
M a[64:67],v[48:51],v[208:211],a[64:67]
ds_read_b128 v[40:43],v8 offset:37376
v_cvt_pk_bf16_f32 v235,v150,v151
M a[64:67],v[52:55],v[212:215],a[64:67]
v_exp_f32 v64,v64
M a[96:99],v[48:51],v[216:219],a[96:99]
ds_read_b128 v[44:47],v8 offset:37632
v_cvt_pk_bf16_f32 v242,v152,v153
M a[96:99],v[52:55],v[220:223],a[96:99]
v_exp_f32 v65,v65
M a[4:7],v[56:59],v[192:195],a[4:7]
v_exp_f32 v66,v66
M a[4:7],v[60:63],v[196:199],a[4:7]
buffer_load_dword v22,v21,s[8:11],s50 offen
v_cvt_pk_bf16_f32 v243,v154,v155
M a[36:39],v[56:59],v[200:203],a[36:39]
s_add_u32 s50,s50,16384
v_cvt_pk_bf16_f32 v250,v156,v157
M a[36:39],v[60:63],v[204:207],a[36:39]
v_exp_f32 v67,v67
M a[68:71],v[56:59],v[208:211],a[68:71]
v_exp_f32 v68,v68
M a[68:71],v[60:63],v[212:215],a[68:71]
v_exp_f32 v69,v69
M a[100:103],v[56:59],v[216:219],a[100:103]
v_exp_f32 v70,v70
M a[100:103],v[60:63],v[220:223],a[100:103]
v_exp_f32 v71,v71
M v[160:163],v[176:179],v[192:195],v[160:163]
v_exp_f32 v72,v72
M v[160:163],v[176:179],v[196:199],v[160:163]
s_waitcnt lgkmcnt(0)
v_cvt_pk_bf16_f32 v251,v158,v159
M v[112:115],v[32:35],a[192:195],0
ds_read_b64_tr_b16 v[48:49],v9 offset:256
v_cvt_pk_bf16_f32 v228,v64,v65
M v[112:115],v[36:39],a[196:199],v[112:115]
ds_read_b64_tr_b16 v[50:51],v9 offset:4352
v_cvt_pk_bf16_f32 v229,v66,v67
M v[112:115],v[40:43],a[200:203],v[112:115]
ds_read_b64_tr_b16 v[52:53],v9 offset:8448
v_cvt_pk_bf16_f32 v236,v68,v69
M v[112:115],v[44:47],a[204:207],v[112:115]
ds_read_b64_tr_b16 v[54:55],v9 offset:12544
v_cvt_pk_bf16_f32 v237,v70,v71
M v[116:119],v[32:35],a[208:211],0
ds_read_b64_tr_b16 v[56:57],v10 offset:256
M v[116:119],v[36:39],a[212:215],v[116:119]
ds_read_b64_tr_b16 v[58:59],v10 offset:4352
M v[116:119],v[40:43],a[216:219],v[116:119]
ds_read_b64_tr_b16 v[60:61],v10 offset:8448
M v[116:119],v[44:47],a[220:223],v[116:119]
ds_read_b64_tr_b16 v[62:63],v10 offset:12544
M v[120:123],v[32:35],a[224:227],0
v_exp_f32 v73,v73
M v[120:123],v[36:39],a[228:231],v[120:123]
v_exp_f32 v74,v74
M v[120:123],v[40:43],a[232:235],v[120:123]
v_exp_f32 v75,v75
M v[120:123],v[44:47],a[236:239],v[120:123]
v_exp_f32 v76,v76
M v[124:127],v[32:35],a[240:243],0
v_exp_f32 v77,v77
M v[124:127],v[36:39],a[244:247],v[124:127]
v_exp_f32 v78,v78
M v[124:127],v[40:43],a[248:251],v[124:127]
v_exp_f32 v79,v79
M v[124:127],v[44:47],a[252:255],v[124:127]
s_waitcnt lgkmcnt(0)
v_cvt_pk_bf16_f32 v244,v72,v73
M a[8:11],v[48:51],v[192:195],a[8:11]
ds_read_b128 v[32:35],v8 offset:40960
v_cvt_pk_bf16_f32 v245,v74,v75
M a[8:11],v[52:55],v[196:199],a[8:11]
v_exp_f32 v80,v80
M a[40:43],v[48:51],v[200:203],a[40:43]
ds_read_b128 v[36:39],v8 offset:41216
v_cvt_pk_bf16_f32 v252,v76,v77
M a[40:43],v[52:55],v[204:207],a[40:43]
v_exp_f32 v81,v81
M a[72:75],v[48:51],v[208:211],a[72:75]
ds_read_b128 v[40:43],v8 offset:41472
v_cvt_pk_bf16_f32 v253,v78,v79
M a[72:75],v[52:55],v[212:215],a[72:75]
v_exp_f32 v82,v82
M a[104:107],v[48:51],v[216:219],a[104:107]
ds_read_b128 v[44:47],v8 offset:41728
v_cvt_pk_bf16_f32 v230,v80,v81
M a[104:107],v[52:55],v[220:223],a[104:107]
v_exp_f32 v83,v83
M a[12:15],v[56:59],v[192:195],a[12:15]
v_exp_f32 v84,v84
M a[12:15],v[60:63],v[196:199],a[12:15]
v_exp_f32 v85,v85
M a[44:47],v[56:59],v[200:203],a[44:47]
v_exp_f32 v86,v86
M a[44:47],v[60:63],v[204:207],a[44:47]
v_exp_f32 v87,v87
M a[76:79],v[56:59],v[208:211],a[76:79]
v_exp_f32 v88,v88
M a[76:79],v[60:63],v[212:215],a[76:79]
v_exp_f32 v89,v89
M a[108:111],v[56:59],v[216:219],a[108:111]
v_exp_f32 v90,v90
M a[108:111],v[60:63],v[220:223],a[108:111]
v_exp_f32 v91,v91
M v[164:167],v[176:179],v[200:203],v[164:167]
v_exp_f32 v92,v92
M v[164:167],v[176:179],v[204:207],v[164:167]
s_waitcnt lgkmcnt(0)
v_cvt_pk_bf16_f32 v231,v82,v83
M v[128:131],v[32:35],a[192:195],0
ds_read_b64_tr_b16 v[48:49],v9 offset:512
s_xor_b32 m0,s74,0
M v[128:131],v[36:39],a[196:199],v[128:131]
ds_read_b64_tr_b16 v[50:51],v9 offset:4608
buffer_load_dwordx4 v12,s[56:59],s73 offen lds
M v[128:131],v[40:43],a[200:203],v[128:131]
ds_read_b64_tr_b16 v[52:53],v9 offset:8704
v_cvt_pk_bf16_f32 v238,v84,v85
M v[128:131],v[44:47],a[204:207],v[128:131]
ds_read_b64_tr_b16 v[54:55],v9 offset:12800
v_cvt_pk_bf16_f32 v239,v86,v87
M v[132:135],v[32:35],a[208:211],0
ds_read_b64_tr_b16 v[56:57],v10 offset:512
v_cvt_pk_bf16_f32 v246,v88,v89
M v[132:135],v[36:39],a[212:215],v[132:135]
ds_read_b64_tr_b16 v[58:59],v10 offset:4608
v_cvt_pk_bf16_f32 v247,v90,v91
M v[132:135],v[40:43],a[216:219],v[132:135]
ds_read_b64_tr_b16 v[60:61],v10 offset:8704
M v[132:135],v[44:47],a[220:223],v[132:135]
ds_read_b64_tr_b16 v[62:63],v10 offset:12800
s_xor_b32 s81,s73,0x1000
s_xor_b32 m0,s74,0x400
M v[136:139],v[32:35],a[224:227],0
buffer_load_dwordx4 v13,s[56:59],s81 offen lds
M v[136:139],v[36:39],a[228:231],v[136:139]
v_exp_f32 v93,v93
M v[136:139],v[40:43],a[232:235],v[136:139]
v_exp_f32 v94,v94
M v[136:139],v[44:47],a[236:239],v[136:139]
v_exp_f32 v95,v95
M v[140:143],v[32:35],a[240:243],0
v_exp_f32 v96,v96
M v[140:143],v[36:39],a[244:247],v[140:143]
v_exp_f32 v97,v97
M v[140:143],v[40:43],a[248:251],v[140:143]
v_exp_f32 v98,v98
M v[140:143],v[44:47],a[252:255],v[140:143]
s_xor_b32 s80,s73,0x2000
s_xor_b32 m0,s74,0x800
s_waitcnt lgkmcnt(0)
M a[16:19],v[48:51],v[192:195],a[16:19]
ds_read_b128 v[32:35],v8 offset:45056
buffer_load_dwordx4 v12,s[56:59],s80 offen lds
M a[16:19],v[52:55],v[196:199],a[16:19]
v_exp_f32 v99,v99
M a[48:51],v[48:51],v[200:203],a[48:51]
ds_read_b128 v[36:39],v8 offset:45312
v_cvt_pk_bf16_f32 v254,v92,v93
M a[48:51],v[52:55],v[204:207],a[48:51]
v_exp_f32 v100,v100
M a[80:83],v[48:51],v[208:211],a[80:83]
ds_read_b128 v[40:43],v8 offset:45568
v_cvt_pk_bf16_f32 v255,v94,v95
M a[80:83],v[52:55],v[212:215],a[80:83]
v_exp_f32 v101,v101
M a[112:115],v[48:51],v[216:219],a[112:115]
ds_read_b128 v[44:47],v8 offset:45824
s_xor_b32 s81,s73,0x3000
s_xor_b32 m0,s74,0xc00
M a[112:115],v[52:55],v[220:223],a[112:115]
buffer_load_dwordx4 v13,s[56:59],s81 offen lds
M a[20:23],v[56:59],v[192:195],a[20:23]
v_exp_f32 v102,v102
M a[20:23],v[60:63],v[196:199],a[20:23]
v_exp_f32 v103,v103
M a[52:55],v[56:59],v[200:203],a[52:55]
v_exp_f32 v104,v104
M a[52:55],v[60:63],v[204:207],a[52:55]
v_exp_f32 v105,v105
M a[84:87],v[56:59],v[208:211],a[84:87]
v_exp_f32 v106,v106
M a[84:87],v[60:63],v[212:215],a[84:87]
v_exp_f32 v107,v107
M a[116:119],v[56:59],v[216:219],a[116:119]
s_xor_b32 s80,s73,0x4000
s_xor_b32 m0,s74,0x1000
M a[116:119],v[60:63],v[220:223],a[116:119]
buffer_load_dwordx4 v12,s[56:59],s80 offen lds
M v[168:171],v[176:179],v[208:211],v[168:171]
v_exp_f32 v108,v108
M v[168:171],v[176:179],v[212:215],v[168:171]
s_waitcnt lgkmcnt(0)
M v[144:147],v[32:35],a[192:195],0
ds_read_b64_tr_b16 v[48:49],v9 offset:768
M v[144:147],v[36:39],a[196:199],v[144:147]
ds_read_b64_tr_b16 v[50:51],v9 offset:4864
M v[144:147],v[40:43],a[200:203],v[144:147]
ds_read_b64_tr_b16 v[52:53],v9 offset:8960
M v[144:147],v[44:47],a[204:207],v[144:147]
ds_read_b64_tr_b16 v[54:55],v9 offset:13056
M v[148:151],v[32:35],a[208:211],0
ds_read_b64_tr_b16 v[56:57],v10 offset:768
s_xor_b32 s81,s73,0x5000
s_xor_b32 m0,s74,0x1400
M v[148:151],v[36:39],a[212:215],v[148:151]
ds_read_b64_tr_b16 v[58:59],v10 offset:4864
buffer_load_dwordx4 v13,s[56:59],s81 offen lds
M v[148:151],v[40:43],a[216:219],v[148:151]
ds_read_b64_tr_b16 v[60:61],v10 offset:8960
M v[148:151],v[44:47],a[220:223],v[148:151]
ds_read_b64_tr_b16 v[62:63],v10 offset:13056
M v[152:155],v[32:35],a[224:227],0
v_exp_f32 v109,v109
M v[152:155],v[36:39],a[228:231],v[152:155]
v_exp_f32 v110,v110
M v[152:155],v[40:43],a[232:235],v[152:155]
v_exp_f32 v111,v111
M v[152:155],v[44:47],a[236:239],v[152:155]
s_xor_b32 s80,s73,0x6000
s_xor_b32 m0,s74,0x1800
M v[156:159],v[32:35],a[240:243],0
buffer_load_dwordx4 v12,s[56:59],s80 offen lds
M v[156:159],v[36:39],a[244:247],v[156:159]
v_exp_f32 v112,v112
M v[156:159],v[40:43],a[248:251],v[156:159]
s_xor_b32 s81,s73,0x7000
s_xor_b32 m0,s74,0x1c00
s_nop 0
buffer_load_dwordx4 v13,s[56:59],s81 offen lds
s_waitcnt vmcnt(9)
v_cmp_eq_u32 s[80:81],1,v15
s_nop 0
s_cmp_eq_u64 s[80:81],-1
s_cbranch_scc1 A_H0_BACK
s_cmp_eq_u32 s29,0
s_cbranch_scc1 A_H0_SPIN
A_H0_BACK:
M v[156:159],v[44:47],a[252:255],v[156:159]
s_waitcnt lgkmcnt(0)
s_barrier
M a[24:27],v[48:51],v[192:195],a[24:27]
ds_read_b128 v[32:35],v8 offset:49152
M a[24:27],v[52:55],v[196:199],a[24:27]
v_exp_f32 v113,v113
M a[56:59],v[48:51],v[200:203],a[56:59]
ds_read_b128 v[36:39],v8 offset:49408
M a[56:59],v[52:55],v[204:207],a[56:59]
v_exp_f32 v114,v114
M a[88:91],v[48:51],v[208:211],a[88:91]
ds_read_b128 v[40:43],v8 offset:49664
M a[88:91],v[52:55],v[212:215],a[88:91]
v_exp_f32 v115,v115
M a[120:123],v[48:51],v[216:219],a[120:123]
ds_read_b128 v[44:47],v8 offset:49920
M a[120:123],v[52:55],v[220:223],a[120:123]
v_exp_f32 v116,v116
M a[28:31],v[56:59],v[192:195],a[28:31]
v_exp_f32 v117,v117
M a[28:31],v[60:63],v[196:199],a[28:31]
v_exp_f32 v118,v118
M a[60:63],v[56:59],v[200:203],a[60:63]
v_exp_f32 v119,v119
M a[60:63],v[60:63],v[204:207],a[60:63]
v_exp_f32 v120,v120
M a[92:95],v[56:59],v[208:211],a[92:95]
v_exp_f32 v121,v121
M a[92:95],v[60:63],v[212:215],a[92:95]
v_exp_f32 v122,v122
M a[124:127],v[56:59],v[216:219],a[124:127]
v_exp_f32 v123,v123
M a[124:127],v[60:63],v[220:223],a[124:127]
v_exp_f32 v124,v124
M v[172:175],v[176:179],v[216:219],v[172:175]
v_exp_f32 v125,v125
M v[172:175],v[176:179],v[220:223],v[172:175]
s_waitcnt lgkmcnt(0)
v_cvt_pk_bf16_f32 v192,v96,v97
M v[64:67],v[32:35],a[192:195],0
ds_read_b64_tr_b16 v[48:49],v9 offset:16384
v_cvt_pk_bf16_f32 v193,v98,v99
M v[64:67],v[36:39],a[196:199],v[64:67]
ds_read_b64_tr_b16 v[50:51],v9 offset:20480
buffer_load_dwordx4 a[128:131],v11,s[60:63],s72 offen sc1
M v[64:67],v[40:43],a[200:203],v[64:67]
ds_read_b64_tr_b16 v[52:53],v9 offset:24576
v_cvt_pk_bf16_f32 v200,v100,v101
M v[64:67],v[44:47],a[204:207],v[64:67]
ds_read_b64_tr_b16 v[54:55],v9 offset:28672
v_cvt_pk_bf16_f32 v201,v102,v103
M v[68:71],v[32:35],a[208:211],0
ds_read_b64_tr_b16 v[56:57],v10 offset:16384
v_cvt_pk_bf16_f32 v208,v104,v105
M v[68:71],v[36:39],a[212:215],v[68:71]
ds_read_b64_tr_b16 v[58:59],v10 offset:20480
v_cvt_pk_bf16_f32 v209,v106,v107
M v[68:71],v[40:43],a[216:219],v[68:71]
ds_read_b64_tr_b16 v[60:61],v10 offset:24576
v_cvt_pk_bf16_f32 v216,v108,v109
M v[68:71],v[44:47],a[220:223],v[68:71]
ds_read_b64_tr_b16 v[62:63],v10 offset:28672
s_xor_b32 s80,s72,0x20000
M v[72:75],v[32:35],a[224:227],0
buffer_load_dwordx4 a[144:147],v11,s[60:63],s80 offen sc1
v_cvt_pk_bf16_f32 v217,v110,v111
M v[72:75],v[36:39],a[228:231],v[72:75]
v_exp_f32 v126,v126
M v[72:75],v[40:43],a[232:235],v[72:75]
v_exp_f32 v127,v127
M v[72:75],v[44:47],a[236:239],v[72:75]
v_exp_f32 v128,v128
M v[76:79],v[32:35],a[240:243],0
v_exp_f32 v129,v129
M v[76:79],v[36:39],a[244:247],v[76:79]
v_exp_f32 v130,v130
M v[76:79],v[40:43],a[248:251],v[76:79]
v_exp_f32 v131,v131
M v[76:79],v[44:47],a[252:255],v[76:79]
s_xor_b32 s81,s72,0x400
s_waitcnt lgkmcnt(0)
M a[0:3],v[48:51],v[224:227],a[0:3]
ds_read_b128 v[32:35],v8 offset:53248
buffer_load_dwordx4 a[132:135],v11,s[60:63],s81 offen sc1
M a[0:3],v[52:55],v[228:231],a[0:3]
v_exp_f32 v132,v132
M a[32:35],v[48:51],v[232:235],a[32:35]
ds_read_b128 v[36:39],v8 offset:53504
v_cvt_pk_bf16_f32 v194,v112,v113
M a[32:35],v[52:55],v[236:239],a[32:35]
v_exp_f32 v133,v133
M a[64:67],v[48:51],v[240:243],a[64:67]
ds_read_b128 v[40:43],v8 offset:53760
v_cvt_pk_bf16_f32 v195,v114,v115
M a[64:67],v[52:55],v[244:247],a[64:67]
v_exp_f32 v134,v134
M a[96:99],v[48:51],v[248:251],a[96:99]
ds_read_b128 v[44:47],v8 offset:54016
v_cvt_pk_bf16_f32 v202,v116,v117
M a[96:99],v[52:55],v[252:255],a[96:99]
s_xor_b32 s80,s72,0x20400
v_cvt_pk_bf16_f32 v203,v118,v119
M a[4:7],v[56:59],v[224:227],a[4:7]
buffer_load_dwordx4 a[148:151],v11,s[60:63],s80 offen sc1
v_cvt_pk_bf16_f32 v210,v120,v121
M a[4:7],v[60:63],v[228:231],a[4:7]
v_exp_f32 v135,v135
M a[36:39],v[56:59],v[232:235],a[36:39]
v_exp_f32 v136,v136
M a[36:39],v[60:63],v[236:239],a[36:39]
v_exp_f32 v137,v137
M a[68:71],v[56:59],v[240:243],a[68:71]
v_exp_f32 v138,v138
M a[68:71],v[60:63],v[244:247],a[68:71]
v_exp_f32 v139,v139
M a[100:103],v[56:59],v[248:251],a[100:103]
v_exp_f32 v140,v140
M a[100:103],v[60:63],v[252:255],a[100:103]
s_xor_b32 s81,s72,0x800
v_cvt_pk_bf16_f32 v211,v122,v123
M v[160:163],v[176:179],v[224:227],v[160:163]
buffer_load_dwordx4 a[136:139],v11,s[60:63],s81 offen sc1
v_cvt_pk_bf16_f32 v218,v124,v125
M v[160:163],v[176:179],v[228:231],v[160:163]
s_waitcnt lgkmcnt(0)
v_cvt_pk_bf16_f32 v219,v126,v127
M v[80:83],v[32:35],a[192:195],0
ds_read_b64_tr_b16 v[48:49],v9 offset:16640
v_cvt_pk_bf16_f32 v196,v128,v129
M v[80:83],v[36:39],a[196:199],v[80:83]
ds_read_b64_tr_b16 v[50:51],v9 offset:20736
v_cvt_pk_bf16_f32 v197,v130,v131
M v[80:83],v[40:43],a[200:203],v[80:83]
ds_read_b64_tr_b16 v[52:53],v9 offset:24832
v_cvt_pk_bf16_f32 v204,v132,v133
M v[80:83],v[44:47],a[204:207],v[80:83]
ds_read_b64_tr_b16 v[54:55],v9 offset:28928
v_cvt_pk_bf16_f32 v205,v134,v135
M v[84:87],v[32:35],a[208:211],0
ds_read_b64_tr_b16 v[56:57],v10 offset:16640
v_cvt_pk_bf16_f32 v212,v136,v137
M v[84:87],v[36:39],a[212:215],v[84:87]
ds_read_b64_tr_b16 v[58:59],v10 offset:20736
s_xor_b32 s80,s72,0x20800
M v[84:87],v[40:43],a[216:219],v[84:87]
ds_read_b64_tr_b16 v[60:61],v10 offset:24832
buffer_load_dwordx4 a[152:155],v11,s[60:63],s80 offen sc1
M v[84:87],v[44:47],a[220:223],v[84:87]
ds_read_b64_tr_b16 v[62:63],v10 offset:28928
v_cvt_pk_bf16_f32 v213,v138,v139
M v[88:91],v[32:35],a[224:227],0
v_exp_f32 v141,v141
M v[88:91],v[36:39],a[228:231],v[88:91]
v_exp_f32 v142,v142
M v[88:91],v[40:43],a[232:235],v[88:91]
v_exp_f32 v143,v143
M v[88:91],v[44:47],a[236:239],v[88:91]
v_exp_f32 v144,v144
M v[92:95],v[32:35],a[240:243],0
s_xor_b32 s81,s72,0xc00
v_cvt_pk_bf16_f32 v220,v140,v141
M v[92:95],v[36:39],a[244:247],v[92:95]
buffer_load_dwordx4 a[140:143],v11,s[60:63],s81 offen sc1
v_cvt_pk_bf16_f32 v221,v142,v143
M v[92:95],v[40:43],a[248:251],v[92:95]
v_exp_f32 v145,v145
M v[92:95],v[44:47],a[252:255],v[92:95]
s_waitcnt lgkmcnt(0)
v_cvt_pk_bf16_f32 v198,v144,v145
M a[8:11],v[48:51],v[224:227],a[8:11]
ds_read_b128 v[32:35],v8 offset:57344
s_add_u32 s44,s44,4096
M a[8:11],v[52:55],v[228:231],a[8:11]
v_exp_f32 v146,v146
M a[40:43],v[48:51],v[232:235],a[40:43]
ds_read_b128 v[36:39],v8 offset:57600
s_add_u32 s45,s45,4096
M a[40:43],v[52:55],v[236:239],a[40:43]
v_exp_f32 v147,v147
M a[72:75],v[48:51],v[240:243],a[72:75]
ds_read_b128 v[40:43],v8 offset:57856
s_xor_b32 s80,s72,0x20c00
M a[72:75],v[52:55],v[244:247],a[72:75]
buffer_load_dwordx4 a[156:159],v11,s[60:63],s80 offen sc1
v_cvt_pk_bf16_f32 v199,v146,v147
M a[104:107],v[48:51],v[248:251],a[104:107]
ds_read_b128 v[44:47],v8 offset:58112
s_add_u32 s46,s46,4096
M a[104:107],v[52:55],v[252:255],a[104:107]
v_exp_f32 v148,v148
M a[12:15],v[56:59],v[224:227],a[12:15]
v_exp_f32 v149,v149
M a[12:15],v[60:63],v[228:231],a[12:15]
v_exp_f32 v150,v150
M a[44:47],v[56:59],v[232:235],a[44:47]
v_exp_f32 v151,v151
M a[44:47],v[60:63],v[236:239],a[44:47]
v_exp_f32 v152,v152
M a[76:79],v[56:59],v[240:243],a[76:79]
s_xor_b32 s81,s72,0x2000
v_cvt_pk_bf16_f32 v206,v148,v149
M a[76:79],v[60:63],v[244:247],a[76:79]
buffer_load_dwordx4 a[160:163],v11,s[60:63],s81 offen sc1
v_cvt_pk_bf16_f32 v207,v150,v151
M a[108:111],v[56:59],v[248:251],a[108:111]
v_exp_f32 v153,v153
M a[108:111],v[60:63],v[252:255],a[108:111]
v_exp_f32 v154,v154
M v[164:167],v[176:179],v[232:235],v[164:167]
v_exp_f32 v155,v155
M v[164:167],v[176:179],v[236:239],v[164:167]
s_waitcnt lgkmcnt(0)
v_cvt_pk_bf16_f32 v214,v152,v153
M v[96:99],v[32:35],a[192:195],0
ds_read_b64_tr_b16 v[48:49],v9 offset:16896
v_cvt_pk_bf16_f32 v215,v154,v155
M v[96:99],v[36:39],a[196:199],v[96:99]
ds_read_b64_tr_b16 v[50:51],v9 offset:20992
s_add_u32 s47,s47,4096
M v[96:99],v[40:43],a[200:203],v[96:99]
ds_read_b64_tr_b16 v[52:53],v9 offset:25088
s_xor_b32 s80,s72,0x22000
M v[96:99],v[44:47],a[204:207],v[96:99]
ds_read_b64_tr_b16 v[54:55],v9 offset:29184
buffer_load_dwordx4 a[176:179],v11,s[60:63],s80 offen sc1
M v[100:103],v[32:35],a[208:211],0
ds_read_b64_tr_b16 v[56:57],v10 offset:16896
M v[100:103],v[36:39],a[212:215],v[100:103]
ds_read_b64_tr_b16 v[58:59],v10 offset:20992
M v[100:103],v[40:43],a[216:219],v[100:103]
ds_read_b64_tr_b16 v[60:61],v10 offset:25088
M v[100:103],v[44:47],a[220:223],v[100:103]
ds_read_b64_tr_b16 v[62:63],v10 offset:29184
M v[104:107],v[32:35],a[224:227],0
v_exp_f32 v156,v156
M v[104:107],v[36:39],a[228:231],v[104:107]
v_exp_f32 v157,v157
M v[104:107],v[40:43],a[232:235],v[104:107]
s_xor_b32 s81,s72,0x2400
v_cvt_pk_bf16_f32 v222,v156,v157
M v[104:107],v[44:47],a[236:239],v[104:107]
buffer_load_dwordx4 a[164:167],v11,s[60:63],s81 offen sc1
M v[108:111],v[32:35],a[240:243],0
v_exp_f32 v158,v158
M v[108:111],v[36:39],a[244:247],v[108:111]
v_exp_f32 v159,v159
M v[108:111],v[40:43],a[248:251],v[108:111]
v_cvt_pk_bf16_f32 v223,v158,v159
M v[108:111],v[44:47],a[252:255],v[108:111]
s_waitcnt lgkmcnt(0)
M a[16:19],v[48:51],v[224:227],a[16:19]
ds_read_b128 v[32:35],v8 offset:61440
M a[16:19],v[52:55],v[228:231],a[16:19]
s_xor_b32 s80,s72,0x22400
M a[48:51],v[48:51],v[232:235],a[48:51]
ds_read_b128 v[36:39],v8 offset:61696
buffer_load_dwordx4 a[180:183],v11,s[60:63],s80 offen sc1
M a[48:51],v[52:55],v[236:239],a[48:51]
M a[80:83],v[48:51],v[240:243],a[80:83]
ds_read_b128 v[40:43],v8 offset:61952
M a[80:83],v[52:55],v[244:247],a[80:83]
M a[112:115],v[48:51],v[248:251],a[112:115]
ds_read_b128 v[44:47],v8 offset:62208
M a[112:115],v[52:55],v[252:255],a[112:115]
M a[20:23],v[56:59],v[224:227],a[20:23]
M a[20:23],v[60:63],v[228:231],a[20:23]
s_xor_b32 s81,s72,0x2800
M a[52:55],v[56:59],v[232:235],a[52:55]
buffer_load_dwordx4 a[168:171],v11,s[60:63],s81 offen sc1
M a[52:55],v[60:63],v[236:239],a[52:55]
M a[84:87],v[56:59],v[240:243],a[84:87]
M a[84:87],v[60:63],v[244:247],a[84:87]
M a[116:119],v[56:59],v[248:251],a[116:119]
M a[116:119],v[60:63],v[252:255],a[116:119]
M v[168:171],v[176:179],v[240:243],v[168:171]
M v[168:171],v[176:179],v[244:247],v[168:171]
s_xor_b32 s80,s72,0x22800
s_waitcnt lgkmcnt(0)
M v[112:115],v[32:35],a[192:195],0
ds_read_b64_tr_b16 v[48:49],v9 offset:17152
buffer_load_dwordx4 a[184:187],v11,s[60:63],s80 offen sc1
M v[112:115],v[36:39],a[196:199],v[112:115]
ds_read_b64_tr_b16 v[50:51],v9 offset:21248
M v[112:115],v[40:43],a[200:203],v[112:115]
ds_read_b64_tr_b16 v[52:53],v9 offset:25344
M v[112:115],v[44:47],a[204:207],v[112:115]
ds_read_b64_tr_b16 v[54:55],v9 offset:29440
M v[116:119],v[32:35],a[208:211],0
ds_read_b64_tr_b16 v[56:57],v10 offset:17152
M v[116:119],v[36:39],a[212:215],v[116:119]
ds_read_b64_tr_b16 v[58:59],v10 offset:21248
M v[116:119],v[40:43],a[216:219],v[116:119]
ds_read_b64_tr_b16 v[60:61],v10 offset:25344
M v[116:119],v[44:47],a[220:223],v[116:119]
ds_read_b64_tr_b16 v[62:63],v10 offset:29440
s_xor_b32 s81,s72,0x2c00
M v[120:123],v[32:35],a[224:227],0
buffer_load_dwordx4 a[172:175],v11,s[60:63],s81 offen sc1
M v[120:123],v[36:39],a[228:231],v[120:123]
M v[120:123],v[40:43],a[232:235],v[120:123]
M v[120:123],v[44:47],a[236:239],v[120:123]
M v[124:127],v[32:35],a[240:243],0
M v[124:127],v[36:39],a[244:247],v[124:127]
M v[124:127],v[40:43],a[248:251],v[124:127]
M v[124:127],v[44:47],a[252:255],v[124:127]
s_xor_b32 s80,s72,0x22c00
s_waitcnt lgkmcnt(0)
s_barrier
M a[24:27],v[48:51],v[224:227],a[24:27]
ds_read_b64_tr_b16 v[32:33],v9 offset:32768
buffer_load_dwordx4 a[188:191],v11,s[60:63],s80 offen sc1
M a[24:27],v[52:55],v[228:231],a[24:27]
ds_read_b64_tr_b16 v[34:35],v9 offset:36864
M a[56:59],v[48:51],v[232:235],a[56:59]
ds_read_b64_tr_b16 v[36:37],v9 offset:40960
M a[56:59],v[52:55],v[236:239],a[56:59]
ds_read_b64_tr_b16 v[38:39],v9 offset:45056
M a[88:91],v[48:51],v[240:243],a[88:91]
ds_read_b64_tr_b16 v[40:41],v10 offset:32768
M a[88:91],v[52:55],v[244:247],a[88:91]
ds_read_b64_tr_b16 v[42:43],v10 offset:36864
M a[120:123],v[48:51],v[248:251],a[120:123]
ds_read_b64_tr_b16 v[44:45],v10 offset:40960
M a[120:123],v[52:55],v[252:255],a[120:123]
ds_read_b64_tr_b16 v[46:47],v10 offset:45056
M a[28:31],v[56:59],v[224:227],a[28:31]
M a[28:31],v[60:63],v[228:231],a[28:31]
M a[60:63],v[56:59],v[232:235],a[60:63]
M a[60:63],v[60:63],v[236:239],a[60:63]
M a[92:95],v[56:59],v[240:243],a[92:95]
M a[92:95],v[60:63],v[244:247],a[92:95]
M a[124:127],v[56:59],v[248:251],a[124:127]
M a[124:127],v[60:63],v[252:255],a[124:127]
M v[172:175],v[176:179],v[248:251],v[172:175]
M v[172:175],v[176:179],v[252:255],v[172:175]
A_TAIL:
s_waitcnt lgkmcnt(0)
M a[0:3],v[32:35],v[192:195],a[0:3]
ds_read_b64_tr_b16 v[48:49],v9 offset:33024
M a[0:3],v[36:39],v[196:199],a[0:3]
ds_read_b64_tr_b16 v[50:51],v9 offset:37120
M a[32:35],v[32:35],v[200:203],a[32:35]
v_exp_f32 v64,v64
M a[32:35],v[36:39],v[204:207],a[32:35]
ds_read_b64_tr_b16 v[52:53],v9 offset:41216
M a[64:67],v[32:35],v[208:211],a[64:67]
ds_read_b64_tr_b16 v[54:55],v9 offset:45312
M a[64:67],v[36:39],v[212:215],a[64:67]
v_exp_f32 v65,v65
M a[96:99],v[32:35],v[216:219],a[96:99]
ds_read_b64_tr_b16 v[56:57],v10 offset:33024
v_cvt_pk_bf16_f32 v224,v64,v65
M a[96:99],v[36:39],v[220:223],a[96:99]
v_exp_f32 v66,v66
M a[4:7],v[40:43],v[192:195],a[4:7]
ds_read_b64_tr_b16 v[58:59],v10 offset:37120
M a[4:7],v[44:47],v[196:199],a[4:7]
ds_read_b64_tr_b16 v[60:61],v10 offset:41216
M a[36:39],v[40:43],v[200:203],a[36:39]
v_exp_f32 v67,v67
M a[36:39],v[44:47],v[204:207],a[36:39]
ds_read_b64_tr_b16 v[62:63],v10 offset:45312
v_cvt_pk_bf16_f32 v225,v66,v67
M a[68:71],v[40:43],v[208:211],a[68:71]
v_exp_f32 v80,v80
M a[68:71],v[44:47],v[212:215],a[68:71]
v_exp_f32 v81,v81
M a[100:103],v[40:43],v[216:219],a[100:103]
v_exp_f32 v82,v82
M a[100:103],v[44:47],v[220:223],a[100:103]
v_exp_f32 v83,v83
M v[160:163],v[176:179],v[192:195],v[160:163]
v_exp_f32 v96,v96
M v[160:163],v[176:179],v[196:199],v[160:163]
s_waitcnt lgkmcnt(0)
s_barrier
M a[8:11],v[48:51],v[192:195],a[8:11]
ds_read_b64_tr_b16 v[32:33],v9 offset:33280
v_cvt_pk_bf16_f32 v226,v80,v81
M a[8:11],v[52:55],v[196:199],a[8:11]
ds_read_b64_tr_b16 v[34:35],v9 offset:37376
v_cvt_pk_bf16_f32 v227,v82,v83
M a[40:43],v[48:51],v[200:203],a[40:43]
v_exp_f32 v97,v97
M a[40:43],v[52:55],v[204:207],a[40:43]
ds_read_b64_tr_b16 v[36:37],v9 offset:41472
v_cvt_pk_bf16_f32 v228,v96,v97
M a[72:75],v[48:51],v[208:211],a[72:75]
ds_read_b64_tr_b16 v[38:39],v9 offset:45568
M a[72:75],v[52:55],v[212:215],a[72:75]
v_exp_f32 v98,v98
M a[104:107],v[48:51],v[216:219],a[104:107]
ds_read_b64_tr_b16 v[40:41],v10 offset:33280
M a[104:107],v[52:55],v[220:223],a[104:107]
v_exp_f32 v99,v99
M a[12:15],v[56:59],v[192:195],a[12:15]
ds_read_b64_tr_b16 v[42:43],v10 offset:37376
v_cvt_pk_bf16_f32 v229,v98,v99
M a[12:15],v[60:63],v[196:199],a[12:15]
ds_read_b64_tr_b16 v[44:45],v10 offset:41472
M a[44:47],v[56:59],v[200:203],a[44:47]
v_exp_f32 v112,v112
M a[44:47],v[60:63],v[204:207],a[44:47]
ds_read_b64_tr_b16 v[46:47],v10 offset:45568
M a[76:79],v[56:59],v[208:211],a[76:79]
v_exp_f32 v113,v113
M a[76:79],v[60:63],v[212:215],a[76:79]
v_exp_f32 v114,v114
M a[108:111],v[56:59],v[216:219],a[108:111]
v_exp_f32 v115,v115
M a[108:111],v[60:63],v[220:223],a[108:111]
v_exp_f32 v68,v68
M v[164:167],v[176:179],v[200:203],v[164:167]
v_exp_f32 v69,v69
M v[164:167],v[176:179],v[204:207],v[164:167]
s_waitcnt lgkmcnt(0)
v_cvt_pk_bf16_f32 v230,v112,v113
M a[16:19],v[32:35],v[192:195],a[16:19]
ds_read_b64_tr_b16 v[48:49],v9 offset:33536
v_cvt_pk_bf16_f32 v231,v114,v115
M a[16:19],v[36:39],v[196:199],a[16:19]
ds_read_b64_tr_b16 v[50:51],v9 offset:37632
v_cvt_pk_bf16_f32 v232,v68,v69
M a[48:51],v[32:35],v[200:203],a[48:51]
v_exp_f32 v70,v70
M a[48:51],v[36:39],v[204:207],a[48:51]
ds_read_b64_tr_b16 v[52:53],v9 offset:41728
M a[80:83],v[32:35],v[208:211],a[80:83]
ds_read_b64_tr_b16 v[54:55],v9 offset:45824
M a[80:83],v[36:39],v[212:215],a[80:83]
v_exp_f32 v71,v71
M a[112:115],v[32:35],v[216:219],a[112:115]
ds_read_b64_tr_b16 v[56:57],v10 offset:33536
v_cvt_pk_bf16_f32 v233,v70,v71
M a[112:115],v[36:39],v[220:223],a[112:115]
v_exp_f32 v84,v84
M a[20:23],v[40:43],v[192:195],a[20:23]
ds_read_b64_tr_b16 v[58:59],v10 offset:37632
M a[20:23],v[44:47],v[196:199],a[20:23]
ds_read_b64_tr_b16 v[60:61],v10 offset:41728
M a[52:55],v[40:43],v[200:203],a[52:55]
v_exp_f32 v85,v85
M a[52:55],v[44:47],v[204:207],a[52:55]
ds_read_b64_tr_b16 v[62:63],v10 offset:45824
v_cvt_pk_bf16_f32 v234,v84,v85
M a[84:87],v[40:43],v[208:211],a[84:87]
v_exp_f32 v86,v86
M a[84:87],v[44:47],v[212:215],a[84:87]
v_exp_f32 v87,v87
M a[116:119],v[40:43],v[216:219],a[116:119]
v_exp_f32 v100,v100
M a[116:119],v[44:47],v[220:223],a[116:119]
v_exp_f32 v101,v101
M v[168:171],v[176:179],v[208:211],v[168:171]
v_exp_f32 v102,v102
M v[168:171],v[176:179],v[212:215],v[168:171]
s_waitcnt lgkmcnt(0)
v_cvt_pk_bf16_f32 v235,v86,v87
M a[24:27],v[48:51],v[192:195],a[24:27]
ds_read_b64_tr_b16 v[32:33],v9 offset:49152
s_xor_b32 s81,s73,0x40000
s_xor_b32 m0,s74,0x8000
M a[24:27],v[52:55],v[196:199],a[24:27]
ds_read_b64_tr_b16 v[34:35],v9 offset:53248
buffer_load_dwordx4 v12,s[56:59],s81 offen lds
M a[56:59],v[48:51],v[200:203],a[56:59]
s_xor_b32 s80,s73,0x41000
s_xor_b32 m0,s74,0x8400
M a[56:59],v[52:55],v[204:207],a[56:59]
ds_read_b64_tr_b16 v[36:37],v9 offset:57344
buffer_load_dwordx4 v13,s[56:59],s80 offen lds
M a[88:91],v[48:51],v[208:211],a[88:91]
ds_read_b64_tr_b16 v[38:39],v9 offset:61440
v_cvt_pk_bf16_f32 v236,v100,v101
M a[88:91],v[52:55],v[212:215],a[88:91]
s_xor_b32 s81,s73,0x42000
s_xor_b32 m0,s74,0x8800
M a[120:123],v[48:51],v[216:219],a[120:123]
ds_read_b64_tr_b16 v[40:41],v10 offset:49152
buffer_load_dwordx4 v12,s[56:59],s81 offen lds
M a[120:123],v[52:55],v[220:223],a[120:123]
v_exp_f32 v103,v103
M a[28:31],v[56:59],v[192:195],a[28:31]
ds_read_b64_tr_b16 v[42:43],v10 offset:53248
s_xor_b32 s80,s73,0x43000
s_xor_b32 m0,s74,0x8c00
M a[28:31],v[60:63],v[196:199],a[28:31]
ds_read_b64_tr_b16 v[44:45],v10 offset:57344
buffer_load_dwordx4 v13,s[56:59],s80 offen lds
M a[60:63],v[56:59],v[200:203],a[60:63]
v_exp_f32 v116,v116
M a[60:63],v[60:63],v[204:207],a[60:63]
ds_read_b64_tr_b16 v[46:47],v10 offset:61440
s_xor_b32 s81,s73,0x44000
s_xor_b32 m0,s74,0x9000
M a[92:95],v[56:59],v[208:211],a[92:95]
buffer_load_dwordx4 v12,s[56:59],s81 offen lds
v_cvt_pk_bf16_f32 v237,v102,v103
M a[92:95],v[60:63],v[212:215],a[92:95]
v_exp_f32 v117,v117
M a[124:127],v[56:59],v[216:219],a[124:127]
s_xor_b32 s80,s73,0x45000
s_xor_b32 m0,s74,0x9400
M a[124:127],v[60:63],v[220:223],a[124:127]
buffer_load_dwordx4 v13,s[56:59],s80 offen lds
v_cvt_pk_bf16_f32 v238,v116,v117
M v[172:175],v[176:179],v[216:219],v[172:175]
v_exp_f32 v118,v118
M v[172:175],v[176:179],v[220:223],v[172:175]
s_xor_b32 s81,s73,0x46000
s_xor_b32 m0,s74,0x9800
s_waitcnt lgkmcnt(0)
M v[160:163],v[176:179],v[224:227],v[160:163]
ds_read_b64_tr_b16 v[48:49],v9 offset:49408
buffer_load_dwordx4 v12,s[56:59],s81 offen lds
M v[160:163],v[176:179],v[228:231],v[160:163]
ds_read_b64_tr_b16 v[50:51],v9 offset:53504
M v[164:167],v[176:179],v[232:235],v[164:167]
s_xor_b32 s80,s73,0x47000
s_xor_b32 m0,s74,0x9c00
v_exp_f32 v119,v119
s_nop 0
v_cvt_pk_bf16_f32 v239,v118,v119
s_nop 1
M v[164:167],v[176:179],v[236:239],v[164:167]
ds_read_b64_tr_b16 v[52:53],v9 offset:57600
buffer_load_dwordx4 v13,s[56:59],s80 offen lds
v_exp_f32 v72,v72
v_exp_f32 v73,v73
s_nop 0
v_cvt_pk_bf16_f32 v240,v72,v73
v_exp_f32 v74,v74
v_exp_f32 v75,v75
s_nop 0
v_cvt_pk_bf16_f32 v241,v74,v75
v_exp_f32 v88,v88
v_exp_f32 v89,v89
s_nop 0
v_cvt_pk_bf16_f32 v242,v88,v89
v_exp_f32 v90,v90
v_exp_f32 v91,v91
s_nop 0
v_cvt_pk_bf16_f32 v243,v90,v91
s_nop 1
M v[168:171],v[176:179],v[240:243],v[168:171]
ds_read_b64_tr_b16 v[54:55],v9 offset:61696
v_exp_f32 v104,v104
v_exp_f32 v105,v105
s_nop 0
v_cvt_pk_bf16_f32 v244,v104,v105
v_exp_f32 v106,v106
v_exp_f32 v107,v107
s_nop 0
v_cvt_pk_bf16_f32 v245,v106,v107
v_exp_f32 v120,v120
v_exp_f32 v121,v121
s_nop 0
v_cvt_pk_bf16_f32 v246,v120,v121
v_exp_f32 v122,v122
v_exp_f32 v123,v123
s_nop 0
v_cvt_pk_bf16_f32 v247,v122,v123
s_nop 1
M v[168:171],v[176:179],v[244:247],v[168:171]
s_xor_b32 s81,s72,0x4000
v_exp_f32 v76,v76
v_exp_f32 v77,v77
s_nop 0
v_cvt_pk_bf16_f32 v248,v76,v77
v_exp_f32 v78,v78
v_exp_f32 v79,v79
s_nop 0
v_cvt_pk_bf16_f32 v249,v78,v79
v_exp_f32 v92,v92
v_exp_f32 v93,v93
s_nop 0
v_cvt_pk_bf16_f32 v250,v92,v93
v_exp_f32 v94,v94
v_exp_f32 v95,v95
s_nop 0
v_cvt_pk_bf16_f32 v251,v94,v95
s_nop 1
M v[172:175],v[176:179],v[248:251],v[172:175]
ds_read_b64_tr_b16 v[56:57],v10 offset:49408
buffer_load_dwordx4 a[192:195],v11,s[60:63],s81 offen sc1
v_exp_f32 v108,v108
v_exp_f32 v109,v109
s_nop 0
v_cvt_pk_bf16_f32 v252,v108,v109
v_exp_f32 v110,v110
v_exp_f32 v111,v111
s_nop 0
v_cvt_pk_bf16_f32 v253,v110,v111
v_exp_f32 v124,v124
v_exp_f32 v125,v125
s_nop 0
v_cvt_pk_bf16_f32 v254,v124,v125
v_exp_f32 v126,v126
v_exp_f32 v127,v127
s_nop 0
v_cvt_pk_bf16_f32 v255,v126,v127
s_nop 1
M v[172:175],v[176:179],v[252:255],v[172:175]
s_xor_b32 s80,s72,0x24000
M a[0:3],v[32:35],v[224:227],a[0:3]
ds_read_b64_tr_b16 v[58:59],v10 offset:53504
buffer_load_dwordx4 a[208:211],v11,s[60:63],s80 offen sc1
M a[0:3],v[36:39],v[228:231],a[0:3]
ds_read_b64_tr_b16 v[60:61],v10 offset:57600
M a[32:35],v[32:35],v[232:235],a[32:35]
s_xor_b32 s81,s72,0x4400
M a[32:35],v[36:39],v[236:239],a[32:35]
ds_read_b64_tr_b16 v[62:63],v10 offset:61696
buffer_load_dwordx4 a[196:199],v11,s[60:63],s81 offen sc1
M a[64:67],v[32:35],v[240:243],a[64:67]
v_rcp_f32 v4,v160
M a[64:67],v[36:39],v[244:247],a[64:67]
s_xor_b32 s80,s72,0x24400
v_add_f32 v130,v160,v4
M a[96:99],v[32:35],v[248:251],a[96:99]
buffer_load_dwordx4 a[212:215],v11,s[60:63],s80 offen sc1
v_add_f32 v130,v130,v164
M a[96:99],v[36:39],v[252:255],a[96:99]
v_rcp_f32 v5,v164
M a[4:7],v[40:43],v[224:227],a[4:7]
s_xor_b32 s81,s72,0x4800
v_add_f32 v130,v130,v5
M a[4:7],v[44:47],v[228:231],a[4:7]
buffer_load_dwordx4 a[200:203],v11,s[60:63],s81 offen sc1
v_add_f32 v130,v130,v168
M a[36:39],v[40:43],v[232:235],a[36:39]
v_rcp_f32 v6,v168
M a[36:39],v[44:47],v[236:239],a[36:39]
s_xor_b32 s80,s72,0x24800
v_add_f32 v130,v130,v6
M a[68:71],v[40:43],v[240:243],a[68:71]
buffer_load_dwordx4 a[216:219],v11,s[60:63],s80 offen sc1
v_add_f32 v130,v130,v172
M a[68:71],v[44:47],v[244:247],a[68:71]
v_rcp_f32 v7,v172
M a[100:103],v[40:43],v[248:251],a[100:103]
s_xor_b32 s81,s72,0x4c00
v_add_f32 v130,v130,v7
M a[100:103],v[44:47],v[252:255],a[100:103]
buffer_load_dwordx4 a[204:207],v11,s[60:63],s81 offen sc1
s_waitcnt lgkmcnt(0)
M a[8:11],v[48:51],v[224:227],a[8:11]
ds_read_b64_tr_b16 v[32:33],v9 offset:49664
v_cmp_nge_f32 vcc,0x53800000,v130
M a[8:11],v[52:55],v[228:231],a[8:11]
ds_read_b64_tr_b16 v[34:35],v9 offset:53760
s_xor_b32 s80,s72,0x24c00
M a[40:43],v[48:51],v[232:235],a[40:43]
buffer_load_dwordx4 a[220:223],v11,s[60:63],s80 offen sc1
M a[40:43],v[52:55],v[236:239],a[40:43]
ds_read_b64_tr_b16 v[36:37],v9 offset:57856
M a[72:75],v[48:51],v[240:243],a[72:75]
ds_read_b64_tr_b16 v[38:39],v9 offset:61952
s_xor_b32 s81,s73,0x80000
s_xor_b32 m0,s74,0x10000
M a[72:75],v[52:55],v[244:247],a[72:75]
buffer_load_dwordx4 v12,s[56:59],s81 offen lds
M a[104:107],v[48:51],v[248:251],a[104:107]
ds_read_b64_tr_b16 v[40:41],v10 offset:49664
s_xor_b32 s80,s73,0x81000
s_xor_b32 m0,s74,0x10400
M a[104:107],v[52:55],v[252:255],a[104:107]
buffer_load_dwordx4 v13,s[56:59],s80 offen lds
M a[12:15],v[56:59],v[224:227],a[12:15]
ds_read_b64_tr_b16 v[42:43],v10 offset:53760
M a[12:15],v[60:63],v[228:231],a[12:15]
ds_read_b64_tr_b16 v[44:45],v10 offset:57856
s_xor_b32 s81,s73,0x82000
s_xor_b32 m0,s74,0x10800
M a[44:47],v[56:59],v[232:235],a[44:47]
buffer_load_dwordx4 v12,s[56:59],s81 offen lds
M a[44:47],v[60:63],v[236:239],a[44:47]
ds_read_b64_tr_b16 v[46:47],v10 offset:61952
M a[76:79],v[56:59],v[240:243],a[76:79]
s_xor_b32 s80,s73,0x83000
s_xor_b32 m0,s74,0x10c00
M a[76:79],v[60:63],v[244:247],a[76:79]
buffer_load_dwordx4 v13,s[56:59],s80 offen lds
M a[108:111],v[56:59],v[248:251],a[108:111]
M a[108:111],v[60:63],v[252:255],a[108:111]
s_xor_b32 s81,s73,0x84000
s_xor_b32 m0,s74,0x11000
s_waitcnt lgkmcnt(0)
M a[16:19],v[32:35],v[224:227],a[16:19]
ds_read_b64_tr_b16 v[48:49],v9 offset:49920
buffer_load_dwordx4 v12,s[56:59],s81 offen lds
M a[16:19],v[36:39],v[228:231],a[16:19]
ds_read_b64_tr_b16 v[50:51],v9 offset:54016
M a[48:51],v[32:35],v[232:235],a[48:51]
s_xor_b32 s80,s73,0x85000
s_xor_b32 m0,s74,0x11400
M a[48:51],v[36:39],v[236:239],a[48:51]
ds_read_b64_tr_b16 v[52:53],v9 offset:58112
buffer_load_dwordx4 v13,s[56:59],s80 offen lds
M a[80:83],v[32:35],v[240:243],a[80:83]
ds_read_b64_tr_b16 v[54:55],v9 offset:62208
M a[80:83],v[36:39],v[244:247],a[80:83]
s_xor_b32 s81,s73,0x86000
s_xor_b32 m0,s74,0x11800
M a[112:115],v[32:35],v[248:251],a[112:115]
ds_read_b64_tr_b16 v[56:57],v10 offset:49920
buffer_load_dwordx4 v12,s[56:59],s81 offen lds
M a[112:115],v[36:39],v[252:255],a[112:115]
M a[20:23],v[40:43],v[224:227],a[20:23]
ds_read_b64_tr_b16 v[58:59],v10 offset:54016
s_xor_b32 s80,s73,0x87000
s_xor_b32 m0,s74,0x11c00
M a[20:23],v[44:47],v[228:231],a[20:23]
ds_read_b64_tr_b16 v[60:61],v10 offset:58112
buffer_load_dwordx4 v13,s[56:59],s80 offen lds
M a[52:55],v[40:43],v[232:235],a[52:55]
M a[52:55],v[44:47],v[236:239],a[52:55]
ds_read_b64_tr_b16 v[62:63],v10 offset:62208
M a[84:87],v[40:43],v[240:243],a[84:87]
M a[84:87],v[44:47],v[244:247],a[84:87]
M a[116:119],v[40:43],v[248:251],a[116:119]
M a[116:119],v[44:47],v[252:255],a[116:119]
s_waitcnt lgkmcnt(0)
M a[24:27],v[48:51],v[224:227],a[24:27]
M a[24:27],v[52:55],v[228:231],a[24:27]
M a[56:59],v[48:51],v[232:235],a[56:59]
M a[56:59],v[52:55],v[236:239],a[56:59]
M a[88:91],v[48:51],v[240:243],a[88:91]
M a[88:91],v[52:55],v[244:247],a[88:91]
M a[120:123],v[48:51],v[248:251],a[120:123]
M a[120:123],v[52:55],v[252:255],a[120:123]
M a[28:31],v[56:59],v[224:227],a[28:31]
M a[28:31],v[60:63],v[228:231],a[28:31]
M a[60:63],v[56:59],v[232:235],a[60:63]
M a[60:63],v[60:63],v[236:239],a[60:63]
M a[92:95],v[56:59],v[240:243],a[92:95]
M a[92:95],v[60:63],v[244:247],a[92:95]
M a[124:127],v[56:59],v[248:251],a[124:127]
M a[124:127],v[60:63],v[252:255],a[124:127]
s_cmp_lg_u64 vcc,0
s_cselect_b32 s55,1,0
s_or_b32 s43,s43,s55
s_lshl_b32 s54,s28,2
s_add_u32 s54,s54,161792
v_mov_b32 v128,s54
v_mov_b32 v129,s43
ds_write_b32 v128,v129
v_lshrrev_b32 v192,4,v11
v_lshrrev_b32 v193,4,v192
v_lshrrev_b32 v194,2,v192
v_and_b32 v194,3,v194
v_and_b32 v195,3,v192
v_and_b32 v196,1,v193
v_lshlrev_b32 v196,2,v196
v_add_u32 v196,v196,v194
v_lshlrev_b32 v196,1,v196
v_lshrrev_b32 v198,1,v195
v_xor_b32 v196,v196,v198
v_lshlrev_b32 v196,4,v196
v_and_b32 v197,1,v195
v_lshlrev_b32 v199,3,v197
v_add_u32 v196,v196,v199
v_lshlrev_b32 v197,10,v193
v_add_u32 v196,v196,v197
v_lshlrev_b32 v197,8,v194
v_add_u32 v160,v196,v197
v_xor_b32 v161,32,v160
v_xor_b32 v162,64,v160
v_xor_b32 v163,96,v160
v_xor_b32 v164,128,v160
v_xor_b32 v165,160,v160
v_xor_b32 v166,192,v160
v_xor_b32 v167,224,v160
v_add_u32 v168,65536,v160
v_add_u32 v169,65536,v161
v_add_u32 v170,65536,v162
v_add_u32 v171,65536,v163
v_add_u32 v172,65536,v164
v_add_u32 v173,65536,v165
v_add_u32 v174,65536,v166
v_add_u32 v175,65536,v167
s_waitcnt vmcnt(40) lgkmcnt(0)
s_barrier
s_branch K2F
A_CNT_SPIN:
s_mov_b32 s87,0
A_CNT_LOOP:
buffer_load_dword v15,v28,s[92:95],0 offen sc1
s_waitcnt vmcnt(0)
v_readfirstlane_b32 s80,v15
s_nop 0
s_cmp_ge_u32 s80,256
s_cbranch_scc1 A_CNT_BACK
s_add_u32 s87,s87,1
s_cmp_lt_u32 s87,131072
s_cbranch_scc1 A_CNT_LOOP
s_branch A_CNT_BACK
A_H0_SPIN:
s_mov_b32 s87,0
A_H0_LOOP:
buffer_load_dword v15,v27,s[64:67],0 offen sc1
s_waitcnt vmcnt(0)
v_cmp_eq_u32 s[80:81],1,v15
s_nop 0
s_cmp_eq_u64 s[80:81],-1
s_cbranch_scc1 A_H0_BACK
s_add_u32 s87,s87,1
s_cmp_lt_u32 s87,131072
s_cbranch_scc1 A_H0_LOOP
s_branch A_H0_BACK
K1_B:
v_and_b32 v201,31,v193
v_min_u32 v201,29,v201
s_lshr_b32 s80,s75,2
s_mul_i32 s80,s80,30
v_add_u32 v201,s80,v201
v_lshlrev_b32 v201,10,v201
v_lshrrev_b32 v202,5,v193
v_lshlrev_b32 v3,7,v202
v_add_u32 v3,v3,v201
v_lshlrev_b32 v7,18,v202
v_lshrrev_b32 v201,2,v193
v_and_b32 v201,7,v201
s_and_b32 s80,s75,3
s_lshl_b32 s80,s80,3
v_add_u32 v201,s80,v201
v_lshlrev_b32 v201,13,v201
v_add_u32 v7,v7,v201
v_and_b32 v201,3,v193
v_lshlrev_b32 v201,7,v201
v_add_u32 v7,v7,v201
s_mov_b32 s87,0
buffer_load_dword v30,v7,s[8:11],s87 offen
buffer_load_dword v30,v3,s[4:7],0 offen
s_getpc_b64 s[24:25]
K1_PC:
s_sub_u32 s24,s24,K1_PC-concat_heads__mha_block_cached__mha_block_cached__near_ridge_kernel
s_subb_u32 s25,s25,0
s_mov_b32 s26,CODE_END-concat_heads__mha_block_cached__mha_block_cached__near_ridge_kernel
s_mov_b32 s27,0x20000
s_lshr_b32 s3,s2,3
s_mul_i32 s3,s3,40
v_add_u32 v31,s3,v193
v_lshlrev_b32 v31,7,v31
v_cmp_gt_u32 vcc,40,v193
v_bfrev_b32 v29,2
s_nop 0
v_cndmask_b32 v31,v29,v31
buffer_load_dword v30,v31,s[24:27],0 offen
s_mov_b32 s87,524288
buffer_load_dword v30,v7,s[8:11],s87 offen
s_cmp_eq_u32 s76,0
s_waitcnt lgkmcnt(0)
s_cselect_b32 s12,s58,s66
s_cselect_b32 s13,s59,s67
s_cselect_b32 s16,s60,s68
s_cselect_b32 s17,s61,s69
s_cselect_b32 s37,s82,s100
s_cselect_b32 s53,s83,s101
s_lshl_b32 s80,s78,5
s_lshl_b32 s81,s79,1
s_add_u32 s80,s80,s81
s_lshl_b32 s80,s80,17
s_add_u32 s12,s12,s80
s_addc_u32 s13,s13,0
s_mov_b32 s14,262144
s_mov_b32 s15,0x20000
s_add_u32 s16,s16,s80
s_addc_u32 s17,s17,0
s_mov_b32 s18,262144
s_mov_b32 s19,0x20000
s_mul_i32 s80,s76,120
s_mul_i32 s81,s78,15
s_add_u32 s80,s80,s81
s_mul_i32 s80,s80,131072
s_lshl_b32 s81,s79,13
s_add_u32 s80,s80,s81
s_add_u32 s20,s72,s80
s_addc_u32 s21,s73,0
s_sub_u32 s86,1966080,s81
s_mov_b32 s22,s86
s_mov_b32 s23,0x20000
s_lshl_b32 s80,s77,5
s_add_u32 s80,s80,s75
s_lshl_b32 s89,s80,15
s_mov_b32 s52,0x3e0293ee
s_mov_b32 s84,0xffff0000
s_mov_b32 s85,0xffff0000
s_mov_b32 s43,0
v_sub_u32 v200,0,v197
v_and_b32 v200,3,v200
v_xor_b32 v200,v200,v196
v_lshlrev_b32 v200,4,v200
v_lshlrev_b32 v201,10,v197
v_lshlrev_b32 v202,6,v198
v_add_u32 v201,v201,v202
v_add_u32 v8,v201,v200
v_lshrrev_b32 v201,3,v195
v_lshlrev_b32 v201,10,v201
v_and_b32 v202,7,v195
v_lshlrev_b32 v202,6,v202
v_add_u32 v201,v201,v202
v_add_u32 v201,v201,v200
s_lshl_b32 s80,s28,13
s_add_u32 s80,s80,98304
v_add_u32 v11,s80,v201
v_lshlrev_b32 v201,10,v196
v_lshlrev_b32 v202,6,v197
v_add_u32 v201,v201,v202
v_and_b32 v202,1,v198
v_lshlrev_b32 v202,3,v202
v_add_u32 v201,v201,v202
v_and_b32 v199,1,v196
v_lshlrev_b32 v199,1,v199
v_lshrrev_b32 v202,1,v198
v_xor_b32 v202,v202,v199
v_lshlrev_b32 v202,4,v202
v_add_u32 v201,v201,v202
v_add_u32 v9,65536,v201
v_xor_b32 v10,32,v9
v_lshrrev_b32 v201,1,v197
v_lshlrev_b32 v201,2,v201
v_and_b32 v202,1,v196
v_add_u32 v201,v201,v202
v_xor_b32 v201,v201,v198
v_lshlrev_b32 v201,4,v201
v_lshlrev_b32 v202,10,v196
v_add_u32 v201,v201,v202
v_lshlrev_b32 v202,7,v197
v_add_u32 v201,v201,v202
v_add_u32 v12,49152,v201
v_xor_b32 v13,8,v12
v_xor_b32 v14,64,v12
v_xor_b32 v15,72,v12
v_lshlrev_b32 v201,8,v197
v_lshlrev_b32 v202,6,v196
v_add_u32 v201,v201,v202
v_xor_b32 v202,0,v198
v_lshlrev_b32 v202,4,v202
v_add_u32 v21,v201,v202
v_xor_b32 v202,3,v198
v_lshlrev_b32 v202,4,v202
v_add_u32 v22,v201,v202
v_xor_b32 v202,2,v198
v_lshlrev_b32 v202,4,v202
v_add_u32 v23,v201,v202
v_xor_b32 v202,1,v198
v_lshlrev_b32 v202,4,v202
v_add_u32 v24,v201,v202
v_xor_b32 v202,0,v198
v_lshlrev_b32 v202,4,v202
v_add_u32 v25,v201,v202
v_xor_b32 v202,2,v198
v_lshlrev_b32 v202,4,v202
v_add_u32 v26,v201,v202
s_mul_i32 s80,s28,524288
v_lshlrev_b32 v201,4,v193
v_add_u32 v20,s80,v201
s_mov_b32 s48,0
s_mov_b32 s49,0
s_lshl_b32 s80,s76,3
s_add_u32 s80,s80,s78
s_lshl_b32 s80,s80,7
s_lshl_b32 s81,s79,2
s_add_u32 s80,s80,s81
s_add_u32 s82,s80,8454144
s_lshr_b32 s54,s74,1
s_and_b32 s54,1,s54
s_and_b32 s55,1,s74
s_mul_i32 s55,s55,30
s_add_u32 s55,s55,s75
s_lshr_b32 s87,s55,2
s_and_b32 s55,3,s55
s_lshl_b32 s80,s76,3
s_lshr_b32 s81,s87,1
s_add_u32 s80,s80,s81
s_lshl_b32 s80,s80,7
s_and_b32 s81,1,s87
s_add_u32 s80,s80,s81
s_add_u32 s83,s80,8454144
s_mul_i32 s80,s76,120
s_lshl_b32 s81,s87,3
s_add_u32 s80,s80,s81
s_lshl_b32 s81,s28,1
s_add_u32 s80,s80,s81
s_mul_i32 s80,s80,131072
s_add_u32 s60,s72,s80
s_addc_u32 s61,s73,0
s_cmp_lt_u32 s2,240
s_cselect_b32 s62,262144,0
s_mov_b32 s63,0x20000
s_add_u32 s64,s72,33554432
s_addc_u32 s65,s73,0
s_mov_b32 s66,8458240
s_mov_b32 s67,0x20000
s_lshl_b32 s80,s55,8
s_add_u32 s56,s37,s80
s_addc_u32 s57,s53,0
s_sub_u32 s80,4194304,s80
s_cmp_lt_u32 s2,240
s_cselect_b32 s58,s80,0
s_mov_b32 s59,0x20000
s_lshl_b32 s80,s76,10
s_lshl_b32 s81,s55,8
s_add_u32 s80,s80,s81
s_lshl_b32 s81,s54,7
s_add_u32 s80,s80,s81
s_lshl_b32 s81,s87,18
s_add_u32 s80,s80,s81
s_add_u32 s68,s94,s80
s_addc_u32 s69,s95,0
s_sub_u32 s80,3932160,s80
s_cmp_lt_u32 s2,240
s_cselect_b32 s70,s80,0
s_mov_b32 s71,0x20000
s_mov_b32 s94,256
s_mov_b32 s95,0x20000
s_lshl_b32 s80,s54,16
s_lshl_b32 s81,s55,10
s_or_b32 s72,s80,s81
s_and_b32 s81,7,s87
s_lshl_b32 s80,s54,21
s_lshl_b32 s54,s81,12
s_or_b32 s73,s80,s54
s_lshl_b32 s81,s81,10
s_lshl_b32 s80,s28,13
s_or_b32 s74,s80,s81
s_and_b32 s81,0xc00,s81
s_lshl_b32 s55,s28,12
s_or_b32 s75,s55,s81
s_lshl_b32 s81,s2,15
s_add_u32 s76,s81,s80
s_xor_b32 s77,s76,65536
s_lshl_b32 s81,s2,8
s_add_u32 s78,s81,8388608
s_xor_b32 s79,s78,512
s_mov_b32 s3,0
v_bfrev_b32 v27,2
v_writelane_b32 v27,s78,0
v_writelane_b32 v27,s82,1
s_add_u32 s80,s82,2048
v_writelane_b32 v27,s80,2
v_mov_b32 v28,0
buffer_store_dword v28,v27,s[64:67],0 offen sc1
v_bfrev_b32 v4,2
v_writelane_b32 v4,0,0
v_mov_b32 v5,1
s_lshr_b32 s29,s2,3
s_and_b32 s29,15,s29
s_mov_b32 s44,0
s_mov_b32 s45,131072
s_mov_b32 s46,262144
s_mov_b32 s47,0x40000000
s_barrier
ds_read_b128 a[192:195],v11 offset:32768
ds_read_b128 a[196:199],v11 offset:34816
ds_read_b128 a[200:203],v11 offset:36864
ds_read_b64_tr_b16 v[192:193],v12
ds_read_b64_tr_b16 v[194:195],v12 offset:512
ds_read_b64_tr_b16 v[196:197],v13
ds_read_b64_tr_b16 v[198:199],v13 offset:512
ds_read_b64_tr_b16 v[200:201],v14
ds_read_b64_tr_b16 v[202:203],v14 offset:512
ds_read_b64_tr_b16 v[204:205],v15
ds_read_b64_tr_b16 v[206:207],v15 offset:512
B_MAIN:
s_waitcnt lgkmcnt(4)
M v[64:67],v[192:195],a[192:195],0
ds_read_b64_tr_b16 v[208:209],v12 offset:4096
s_mov_b32 m0,90112
M v[96:99],v[192:195],a[196:199],0
ds_read_b64_tr_b16 v[210:211],v12 offset:4608
buffer_load_dwordx4 v16,s[8:11],s34 offen nt lds
M v[128:131],v[192:195],a[200:203],0
ds_read_b64_tr_b16 v[212:213],v13 offset:4096
buffer_load_dwordx4 v17,s[8:11],s34 offen offset:1024 nt lds
M v[68:71],v[196:199],a[192:195],0
ds_read_b64_tr_b16 v[214:215],v13 offset:4608
buffer_load_dwordx4 v18,s[8:11],s34 offen offset:2048 nt lds
M v[100:103],v[196:199],a[196:199],0
buffer_load_dwordx4 v19,s[8:11],s34 offen offset:3072 nt lds
M v[132:135],v[196:199],a[200:203],0
s_waitcnt lgkmcnt(4)
s_add_u32 s34,s34,262144
M v[72:75],v[200:203],a[192:195],0
ds_read_b64_tr_b16 v[192:193],v14 offset:4096
s_mov_b32 m0,94208
M v[104:107],v[200:203],a[196:199],0
ds_read_b64_tr_b16 v[194:195],v14 offset:4608
buffer_load_dwordx4 v16,s[8:11],s35 offen nt lds
M v[136:139],v[200:203],a[200:203],0
ds_read_b64_tr_b16 v[196:197],v15 offset:4096
buffer_load_dwordx4 v17,s[8:11],s35 offen offset:1024 nt lds
M v[76:79],v[204:207],a[192:195],0
ds_read_b64_tr_b16 v[198:199],v15 offset:4608
buffer_load_dwordx4 v18,s[8:11],s35 offen offset:2048 nt lds
M v[108:111],v[204:207],a[196:199],0
buffer_load_dwordx4 v19,s[8:11],s35 offen offset:3072 nt lds
M v[140:143],v[204:207],a[200:203],0
s_waitcnt vmcnt(13) lgkmcnt(0)
s_barrier
s_add_u32 s35,s35,262144
M v[80:83],v[208:211],a[192:195],0
ds_read_b64_tr_b16 v[200:201],v12 offset:8192
M v[112:115],v[208:211],a[196:199],0
ds_read_b64_tr_b16 v[202:203],v12 offset:8704
M v[144:147],v[208:211],a[200:203],0
ds_read_b64_tr_b16 v[204:205],v13 offset:8192
M v[84:87],v[212:215],a[192:195],0
ds_read_b64_tr_b16 v[206:207],v13 offset:8704
M v[116:119],v[212:215],a[196:199],0
M v[148:151],v[212:215],a[200:203],0
M v[88:91],v[192:195],a[192:195],0
ds_read_b64_tr_b16 v[208:209],v14 offset:8192
M v[120:123],v[192:195],a[196:199],0
ds_read_b64_tr_b16 v[210:211],v14 offset:8704
M v[152:155],v[192:195],a[200:203],0
ds_read_b64_tr_b16 v[212:213],v15 offset:8192
M v[92:95],v[196:199],a[192:195],0
ds_read_b64_tr_b16 v[214:215],v15 offset:8704
M v[124:127],v[196:199],a[196:199],0
M v[156:159],v[196:199],a[200:203],0
s_waitcnt lgkmcnt(4)
M a[0:3],v[200:203],a[192:195],0
ds_read_b64_tr_b16 v[192:193],v12 offset:12288
s_mov_b32 s87,1048576
buffer_load_dword v30,v7,s[8:11],s87 offen
M a[32:35],v[200:203],a[196:199],0
ds_read_b64_tr_b16 v[194:195],v12 offset:12800
s_mov_b32 s87,1572864
buffer_load_dword v30,v7,s[8:11],s87 offen
M a[64:67],v[200:203],a[200:203],0
ds_read_b64_tr_b16 v[196:197],v13 offset:12288
buffer_load_dword v30,v3,s[4:7],0 offen offset:256
M a[4:7],v[204:207],a[192:195],0
ds_read_b64_tr_b16 v[198:199],v13 offset:12800
M a[36:39],v[204:207],a[196:199],0
M a[68:71],v[204:207],a[200:203],0
s_waitcnt lgkmcnt(4)
M a[8:11],v[208:211],a[192:195],0
ds_read_b64_tr_b16 v[200:201],v14 offset:12288
M a[40:43],v[208:211],a[196:199],0
ds_read_b64_tr_b16 v[202:203],v14 offset:12800
M a[72:75],v[208:211],a[200:203],0
ds_read_b64_tr_b16 v[204:205],v15 offset:12288
M a[12:15],v[212:215],a[192:195],0
ds_read_b64_tr_b16 v[206:207],v15 offset:12800
M a[44:47],v[212:215],a[196:199],0
M a[76:79],v[212:215],a[200:203],0
s_waitcnt lgkmcnt(0)
s_barrier
M a[16:19],v[192:195],a[192:195],0
ds_read_b64_tr_b16 v[208:209],v12 offset:32768
s_mov_b32 m0,57344
M a[48:51],v[192:195],a[196:199],0
ds_read_b64_tr_b16 v[210:211],v12 offset:33280
buffer_load_dwordx4 v16,s[8:11],s34 offen lds
M a[80:83],v[192:195],a[200:203],0
ds_read_b64_tr_b16 v[212:213],v13 offset:32768
buffer_load_dwordx4 v17,s[8:11],s34 offen offset:1024 lds
M a[20:23],v[196:199],a[192:195],0
ds_read_b64_tr_b16 v[214:215],v13 offset:33280
buffer_load_dwordx4 v18,s[8:11],s34 offen offset:2048 lds
M a[52:55],v[196:199],a[196:199],0
ds_read_b128 a[208:211],v11 offset:33280
buffer_load_dwordx4 v19,s[8:11],s34 offen offset:3072 lds
M a[84:87],v[196:199],a[200:203],0
ds_read_b128 a[212:215],v11 offset:35328
s_add_u32 s34,s34,262144
M a[24:27],v[200:203],a[192:195],0
ds_read_b128 a[216:219],v11 offset:37376
ds_read_b64_tr_b16 v[192:193],v14 offset:32768
M a[56:59],v[200:203],a[196:199],0
ds_read_b64_tr_b16 v[194:195],v14 offset:33280
M a[88:91],v[200:203],a[200:203],0
ds_read_b64_tr_b16 v[196:197],v15 offset:32768
M a[28:31],v[204:207],a[192:195],0
ds_read_b64_tr_b16 v[198:199],v15 offset:33280
s_mov_b32 m0,61440
M a[60:63],v[204:207],a[196:199],0
buffer_load_dwordx4 v16,s[8:11],s35 offen lds
M a[92:95],v[204:207],a[200:203],0
s_waitcnt lgkmcnt(4)
buffer_load_dwordx4 v17,s[8:11],s35 offen offset:1024 lds
M v[64:67],v[208:211],a[208:211],v[64:67]
ds_read_b64_tr_b16 v[200:201],v12 offset:36864
buffer_load_dwordx4 v18,s[8:11],s35 offen offset:2048 lds
M v[96:99],v[208:211],a[212:215],v[96:99]
ds_read_b64_tr_b16 v[202:203],v12 offset:37376
buffer_load_dwordx4 v19,s[8:11],s35 offen offset:3072 lds
M v[128:131],v[208:211],a[216:219],v[128:131]
ds_read_b64_tr_b16 v[204:205],v13 offset:36864
s_add_u32 s35,s35,262144
M v[68:71],v[212:215],a[208:211],v[68:71]
ds_read_b64_tr_b16 v[206:207],v13 offset:37376
M v[100:103],v[212:215],a[212:215],v[100:103]
M v[132:135],v[212:215],a[216:219],v[132:135]
s_waitcnt lgkmcnt(4)
M v[72:75],v[192:195],a[208:211],v[72:75]
ds_read_b64_tr_b16 v[208:209],v14 offset:36864
M v[104:107],v[192:195],a[212:215],v[104:107]
ds_read_b64_tr_b16 v[210:211],v14 offset:37376
M v[136:139],v[192:195],a[216:219],v[136:139]
ds_read_b64_tr_b16 v[212:213],v15 offset:36864
M v[76:79],v[196:199],a[208:211],v[76:79]
ds_read_b64_tr_b16 v[214:215],v15 offset:37376
M v[108:111],v[196:199],a[212:215],v[108:111]
M v[140:143],v[196:199],a[216:219],v[140:143]
s_waitcnt vmcnt(11) lgkmcnt(0)
s_barrier
M v[80:83],v[200:203],a[208:211],v[80:83]
ds_read_b64_tr_b16 v[192:193],v12 offset:40960
M v[112:115],v[200:203],a[212:215],v[112:115]
ds_read_b64_tr_b16 v[194:195],v12 offset:41472
s_cmp_eq_u32 s29,0
s_cbranch_scc0 L_cg3
buffer_atomic_add v5,v4,s[92:95],0 offen
L_cg3:
M v[144:147],v[200:203],a[216:219],v[144:147]
ds_read_b64_tr_b16 v[196:197],v13 offset:40960
M v[84:87],v[204:207],a[208:211],v[84:87]
ds_read_b64_tr_b16 v[198:199],v13 offset:41472
M v[116:119],v[204:207],a[212:215],v[116:119]
M v[148:151],v[204:207],a[216:219],v[148:151]
M v[88:91],v[208:211],a[208:211],v[88:91]
ds_read_b64_tr_b16 v[200:201],v14 offset:40960
M v[120:123],v[208:211],a[212:215],v[120:123]
ds_read_b64_tr_b16 v[202:203],v14 offset:41472
M v[152:155],v[208:211],a[216:219],v[152:155]
ds_read_b64_tr_b16 v[204:205],v15 offset:40960
M v[92:95],v[212:215],a[208:211],v[92:95]
ds_read_b64_tr_b16 v[206:207],v15 offset:41472
M v[124:127],v[212:215],a[212:215],v[124:127]
M v[156:159],v[212:215],a[216:219],v[156:159]
s_waitcnt lgkmcnt(4)
M a[0:3],v[192:195],a[208:211],a[0:3]
ds_read_b64_tr_b16 v[208:209],v12 offset:45056
M a[32:35],v[192:195],a[212:215],a[32:35]
ds_read_b64_tr_b16 v[210:211],v12 offset:45568
M a[64:67],v[192:195],a[216:219],a[64:67]
ds_read_b64_tr_b16 v[212:213],v13 offset:45056
M a[4:7],v[196:199],a[208:211],a[4:7]
ds_read_b64_tr_b16 v[214:215],v13 offset:45568
M a[36:39],v[196:199],a[212:215],a[36:39]
M a[68:71],v[196:199],a[216:219],a[68:71]
s_waitcnt lgkmcnt(4)
M a[8:11],v[200:203],a[208:211],a[8:11]
ds_read_b64_tr_b16 v[192:193],v14 offset:45056
M a[40:43],v[200:203],a[212:215],a[40:43]
ds_read_b64_tr_b16 v[194:195],v14 offset:45568
M a[72:75],v[200:203],a[216:219],a[72:75]
ds_read_b64_tr_b16 v[196:197],v15 offset:45056
M a[12:15],v[204:207],a[208:211],a[12:15]
ds_read_b64_tr_b16 v[198:199],v15 offset:45568
M a[44:47],v[204:207],a[212:215],a[44:47]
M a[76:79],v[204:207],a[216:219],a[76:79]
s_waitcnt lgkmcnt(0)
s_barrier
M a[16:19],v[208:211],a[208:211],a[16:19]
ds_read_b64_tr_b16 v[200:201],v12
s_mov_b32 m0,90112
M a[48:51],v[208:211],a[212:215],a[48:51]
ds_read_b64_tr_b16 v[202:203],v12 offset:512
buffer_load_dwordx4 v16,s[8:11],s34 offen lds
M a[80:83],v[208:211],a[216:219],a[80:83]
ds_read_b64_tr_b16 v[204:205],v13
buffer_load_dwordx4 v17,s[8:11],s34 offen offset:1024 lds
M a[20:23],v[212:215],a[208:211],a[20:23]
ds_read_b64_tr_b16 v[206:207],v13 offset:512
buffer_load_dwordx4 v18,s[8:11],s34 offen offset:2048 lds
M a[52:55],v[212:215],a[212:215],a[52:55]
ds_read_b128 a[192:195],v11
buffer_load_dwordx4 v19,s[8:11],s34 offen offset:3072 lds
M a[84:87],v[212:215],a[216:219],a[84:87]
ds_read_b128 a[196:199],v11 offset:2048
s_add_u32 s34,s34,262144
M a[24:27],v[192:195],a[208:211],a[24:27]
ds_read_b128 a[200:203],v11 offset:4096
ds_read_b64_tr_b16 v[208:209],v14
M a[56:59],v[192:195],a[212:215],a[56:59]
ds_read_b64_tr_b16 v[210:211],v14 offset:512
M a[88:91],v[192:195],a[216:219],a[88:91]
ds_read_b64_tr_b16 v[212:213],v15
M a[28:31],v[196:199],a[208:211],a[28:31]
ds_read_b64_tr_b16 v[214:215],v15 offset:512
s_mov_b32 m0,94208
M a[60:63],v[196:199],a[212:215],a[60:63]
buffer_load_dwordx4 v16,s[8:11],s35 offen lds
M a[92:95],v[196:199],a[216:219],a[92:95]
s_waitcnt lgkmcnt(4)
buffer_load_dwordx4 v17,s[8:11],s35 offen offset:1024 lds
M v[64:67],v[200:203],a[192:195],v[64:67]
ds_read_b64_tr_b16 v[192:193],v12 offset:4096
buffer_load_dwordx4 v18,s[8:11],s35 offen offset:2048 lds
M v[96:99],v[200:203],a[196:199],v[96:99]
ds_read_b64_tr_b16 v[194:195],v12 offset:4608
buffer_load_dwordx4 v19,s[8:11],s35 offen offset:3072 lds
M v[128:131],v[200:203],a[200:203],v[128:131]
ds_read_b64_tr_b16 v[196:197],v13 offset:4096
s_add_u32 s35,s35,262144
M v[68:71],v[204:207],a[192:195],v[68:71]
ds_read_b64_tr_b16 v[198:199],v13 offset:4608
M v[100:103],v[204:207],a[196:199],v[100:103]
M v[132:135],v[204:207],a[200:203],v[132:135]
s_waitcnt lgkmcnt(4)
M v[72:75],v[208:211],a[192:195],v[72:75]
ds_read_b64_tr_b16 v[200:201],v14 offset:4096
s_cmp_eq_u32 s29,1
s_cbranch_scc0 L_cg4
buffer_atomic_add v5,v4,s[92:95],0 offen
L_cg4:
M v[104:107],v[208:211],a[196:199],v[104:107]
ds_read_b64_tr_b16 v[202:203],v14 offset:4608
M v[136:139],v[208:211],a[200:203],v[136:139]
ds_read_b64_tr_b16 v[204:205],v15 offset:4096
M v[76:79],v[212:215],a[192:195],v[76:79]
ds_read_b64_tr_b16 v[206:207],v15 offset:4608
M v[108:111],v[212:215],a[196:199],v[108:111]
M v[140:143],v[212:215],a[200:203],v[140:143]
s_waitcnt vmcnt(8) lgkmcnt(0)
s_barrier
M v[80:83],v[192:195],a[192:195],v[80:83]
ds_read_b64_tr_b16 v[208:209],v12 offset:8192
M v[112:115],v[192:195],a[196:199],v[112:115]
ds_read_b64_tr_b16 v[210:211],v12 offset:8704
M v[144:147],v[192:195],a[200:203],v[144:147]
ds_read_b64_tr_b16 v[212:213],v13 offset:8192
M v[84:87],v[196:199],a[192:195],v[84:87]
ds_read_b64_tr_b16 v[214:215],v13 offset:8704
M v[116:119],v[196:199],a[196:199],v[116:119]
M v[148:151],v[196:199],a[200:203],v[148:151]
M v[88:91],v[200:203],a[192:195],v[88:91]
ds_read_b64_tr_b16 v[192:193],v14 offset:8192
M v[120:123],v[200:203],a[196:199],v[120:123]
ds_read_b64_tr_b16 v[194:195],v14 offset:8704
M v[152:155],v[200:203],a[200:203],v[152:155]
ds_read_b64_tr_b16 v[196:197],v15 offset:8192
M v[92:95],v[204:207],a[192:195],v[92:95]
ds_read_b64_tr_b16 v[198:199],v15 offset:8704
M v[124:127],v[204:207],a[196:199],v[124:127]
M v[156:159],v[204:207],a[200:203],v[156:159]
s_waitcnt lgkmcnt(4)
M a[0:3],v[208:211],a[192:195],a[0:3]
ds_read_b64_tr_b16 v[200:201],v12 offset:12288
M a[32:35],v[208:211],a[196:199],a[32:35]
ds_read_b64_tr_b16 v[202:203],v12 offset:12800
M a[64:67],v[208:211],a[200:203],a[64:67]
ds_read_b64_tr_b16 v[204:205],v13 offset:12288
M a[4:7],v[212:215],a[192:195],a[4:7]
ds_read_b64_tr_b16 v[206:207],v13 offset:12800
M a[36:39],v[212:215],a[196:199],a[36:39]
M a[68:71],v[212:215],a[200:203],a[68:71]
s_waitcnt lgkmcnt(4)
M a[8:11],v[192:195],a[192:195],a[8:11]
ds_read_b64_tr_b16 v[208:209],v14 offset:12288
M a[40:43],v[192:195],a[196:199],a[40:43]
ds_read_b64_tr_b16 v[210:211],v14 offset:12800
M a[72:75],v[192:195],a[200:203],a[72:75]
ds_read_b64_tr_b16 v[212:213],v15 offset:12288
M a[12:15],v[196:199],a[192:195],a[12:15]
ds_read_b64_tr_b16 v[214:215],v15 offset:12800
M a[44:47],v[196:199],a[196:199],a[44:47]
M a[76:79],v[196:199],a[200:203],a[76:79]
s_waitcnt lgkmcnt(0)
s_barrier
M a[16:19],v[200:203],a[192:195],a[16:19]
ds_read_b64_tr_b16 v[192:193],v12 offset:32768
s_mov_b32 m0,57344
M a[48:51],v[200:203],a[196:199],a[48:51]
ds_read_b64_tr_b16 v[194:195],v12 offset:33280
buffer_load_dwordx4 v16,s[8:11],s34 offen lds
M a[80:83],v[200:203],a[200:203],a[80:83]
ds_read_b64_tr_b16 v[196:197],v13 offset:32768
buffer_load_dwordx4 v17,s[8:11],s34 offen offset:1024 lds
M a[20:23],v[204:207],a[192:195],a[20:23]
ds_read_b64_tr_b16 v[198:199],v13 offset:33280
buffer_load_dwordx4 v18,s[8:11],s34 offen offset:2048 lds
M a[52:55],v[204:207],a[196:199],a[52:55]
ds_read_b128 a[208:211],v11 offset:512
buffer_load_dwordx4 v19,s[8:11],s34 offen offset:3072 lds
M a[84:87],v[204:207],a[200:203],a[84:87]
ds_read_b128 a[212:215],v11 offset:2560
s_add_u32 s34,s34,262144
M a[24:27],v[208:211],a[192:195],a[24:27]
ds_read_b128 a[216:219],v11 offset:4608
ds_read_b64_tr_b16 v[200:201],v14 offset:32768
M a[56:59],v[208:211],a[196:199],a[56:59]
ds_read_b64_tr_b16 v[202:203],v14 offset:33280
M a[88:91],v[208:211],a[200:203],a[88:91]
ds_read_b64_tr_b16 v[204:205],v15 offset:32768
M a[28:31],v[212:215],a[192:195],a[28:31]
ds_read_b64_tr_b16 v[206:207],v15 offset:33280
s_mov_b32 m0,61440
M a[60:63],v[212:215],a[196:199],a[60:63]
buffer_load_dwordx4 v16,s[8:11],s35 offen lds
M a[92:95],v[212:215],a[200:203],a[92:95]
s_waitcnt lgkmcnt(4)
s_cmp_eq_u32 s29,2
s_cbranch_scc0 L_cg5
buffer_atomic_add v5,v4,s[92:95],0 offen
L_cg5:
buffer_load_dwordx4 v17,s[8:11],s35 offen offset:1024 lds
M v[64:67],v[192:195],a[208:211],v[64:67]
ds_read_b64_tr_b16 v[208:209],v12 offset:36864
buffer_load_dwordx4 v18,s[8:11],s35 offen offset:2048 lds
M v[96:99],v[192:195],a[212:215],v[96:99]
ds_read_b64_tr_b16 v[210:211],v12 offset:37376
buffer_load_dwordx4 v19,s[8:11],s35 offen offset:3072 lds
M v[128:131],v[192:195],a[216:219],v[128:131]
ds_read_b64_tr_b16 v[212:213],v13 offset:36864
s_add_u32 s35,s35,262144
M v[68:71],v[196:199],a[208:211],v[68:71]
ds_read_b64_tr_b16 v[214:215],v13 offset:37376
M v[100:103],v[196:199],a[212:215],v[100:103]
M v[132:135],v[196:199],a[216:219],v[132:135]
s_waitcnt lgkmcnt(4)
M v[72:75],v[200:203],a[208:211],v[72:75]
ds_read_b64_tr_b16 v[192:193],v14 offset:36864
M v[104:107],v[200:203],a[212:215],v[104:107]
ds_read_b64_tr_b16 v[194:195],v14 offset:37376
M v[136:139],v[200:203],a[216:219],v[136:139]
ds_read_b64_tr_b16 v[196:197],v15 offset:36864
M v[76:79],v[204:207],a[208:211],v[76:79]
ds_read_b64_tr_b16 v[198:199],v15 offset:37376
M v[108:111],v[204:207],a[212:215],v[108:111]
M v[140:143],v[204:207],a[216:219],v[140:143]
s_waitcnt vmcnt(8) lgkmcnt(0)
s_barrier
M v[80:83],v[208:211],a[208:211],v[80:83]
ds_read_b64_tr_b16 v[200:201],v12 offset:40960
M v[112:115],v[208:211],a[212:215],v[112:115]
ds_read_b64_tr_b16 v[202:203],v12 offset:41472
M v[144:147],v[208:211],a[216:219],v[144:147]
ds_read_b64_tr_b16 v[204:205],v13 offset:40960
M v[84:87],v[212:215],a[208:211],v[84:87]
ds_read_b64_tr_b16 v[206:207],v13 offset:41472
M v[116:119],v[212:215],a[212:215],v[116:119]
M v[148:151],v[212:215],a[216:219],v[148:151]
M v[88:91],v[192:195],a[208:211],v[88:91]
ds_read_b64_tr_b16 v[208:209],v14 offset:40960
M v[120:123],v[192:195],a[212:215],v[120:123]
ds_read_b64_tr_b16 v[210:211],v14 offset:41472
M v[152:155],v[192:195],a[216:219],v[152:155]
ds_read_b64_tr_b16 v[212:213],v15 offset:40960
M v[92:95],v[196:199],a[208:211],v[92:95]
ds_read_b64_tr_b16 v[214:215],v15 offset:41472
M v[124:127],v[196:199],a[212:215],v[124:127]
M v[156:159],v[196:199],a[216:219],v[156:159]
s_waitcnt lgkmcnt(4)
M a[0:3],v[200:203],a[208:211],a[0:3]
ds_read_b64_tr_b16 v[192:193],v12 offset:45056
s_mov_b32 s87,2097152
buffer_load_dword v30,v7,s[8:11],s87 offen
M a[32:35],v[200:203],a[212:215],a[32:35]
ds_read_b64_tr_b16 v[194:195],v12 offset:45568
s_mov_b32 s87,2621440
buffer_load_dword v30,v7,s[8:11],s87 offen
M a[64:67],v[200:203],a[216:219],a[64:67]
ds_read_b64_tr_b16 v[196:197],v13 offset:45056
buffer_load_dword v30,v3,s[4:7],0 offen offset:512
M a[4:7],v[204:207],a[208:211],a[4:7]
ds_read_b64_tr_b16 v[198:199],v13 offset:45568
M a[36:39],v[204:207],a[212:215],a[36:39]
M a[68:71],v[204:207],a[216:219],a[68:71]
s_waitcnt lgkmcnt(4)
M a[8:11],v[208:211],a[208:211],a[8:11]
ds_read_b64_tr_b16 v[200:201],v14 offset:45056
M a[40:43],v[208:211],a[212:215],a[40:43]
ds_read_b64_tr_b16 v[202:203],v14 offset:45568
M a[72:75],v[208:211],a[216:219],a[72:75]
ds_read_b64_tr_b16 v[204:205],v15 offset:45056
M a[12:15],v[212:215],a[208:211],a[12:15]
ds_read_b64_tr_b16 v[206:207],v15 offset:45568
M a[44:47],v[212:215],a[212:215],a[44:47]
M a[76:79],v[212:215],a[216:219],a[76:79]
s_waitcnt lgkmcnt(0)
s_barrier
M a[16:19],v[192:195],a[208:211],a[16:19]
ds_read_b64_tr_b16 v[208:209],v12
s_mov_b32 m0,90112
M a[48:51],v[192:195],a[212:215],a[48:51]
ds_read_b64_tr_b16 v[210:211],v12 offset:512
buffer_load_dwordx4 v16,s[8:11],s34 offen lds
M a[80:83],v[192:195],a[216:219],a[80:83]
ds_read_b64_tr_b16 v[212:213],v13
buffer_load_dwordx4 v17,s[8:11],s34 offen offset:1024 lds
M a[20:23],v[196:199],a[208:211],a[20:23]
ds_read_b64_tr_b16 v[214:215],v13 offset:512
buffer_load_dwordx4 v18,s[8:11],s34 offen offset:2048 lds
M a[52:55],v[196:199],a[212:215],a[52:55]
ds_read_b128 a[192:195],v11 offset:32768
buffer_load_dwordx4 v19,s[8:11],s34 offen offset:3072 lds
M a[84:87],v[196:199],a[216:219],a[84:87]
ds_read_b128 a[196:199],v11 offset:34816
s_cmp_eq_u32 s29,3
s_cbranch_scc0 L_cg6
buffer_atomic_add v5,v4,s[92:95],0 offen
L_cg6:
s_add_u32 s34,s34,262144
M a[24:27],v[200:203],a[208:211],a[24:27]
ds_read_b128 a[200:203],v11 offset:36864
ds_read_b64_tr_b16 v[192:193],v14
M a[56:59],v[200:203],a[212:215],a[56:59]
ds_read_b64_tr_b16 v[194:195],v14 offset:512
M a[88:91],v[200:203],a[216:219],a[88:91]
ds_read_b64_tr_b16 v[196:197],v15
M a[28:31],v[204:207],a[208:211],a[28:31]
ds_read_b64_tr_b16 v[198:199],v15 offset:512
s_mov_b32 m0,94208
M a[60:63],v[204:207],a[212:215],a[60:63]
buffer_load_dwordx4 v16,s[8:11],s35 offen lds
M a[92:95],v[204:207],a[216:219],a[92:95]
s_waitcnt lgkmcnt(4)
buffer_load_dwordx4 v17,s[8:11],s35 offen offset:1024 lds
M v[64:67],v[208:211],a[192:195],v[64:67]
ds_read_b64_tr_b16 v[200:201],v12 offset:4096
buffer_load_dwordx4 v18,s[8:11],s35 offen offset:2048 lds
M v[96:99],v[208:211],a[196:199],v[96:99]
ds_read_b64_tr_b16 v[202:203],v12 offset:4608
buffer_load_dwordx4 v19,s[8:11],s35 offen offset:3072 lds
M v[128:131],v[208:211],a[200:203],v[128:131]
ds_read_b64_tr_b16 v[204:205],v13 offset:4096
s_add_u32 s35,s35,262144
M v[68:71],v[212:215],a[192:195],v[68:71]
ds_read_b64_tr_b16 v[206:207],v13 offset:4608
M v[100:103],v[212:215],a[196:199],v[100:103]
M v[132:135],v[212:215],a[200:203],v[132:135]
s_waitcnt lgkmcnt(4)
M v[72:75],v[192:195],a[192:195],v[72:75]
ds_read_b64_tr_b16 v[208:209],v14 offset:4096
M v[104:107],v[192:195],a[196:199],v[104:107]
ds_read_b64_tr_b16 v[210:211],v14 offset:4608
M v[136:139],v[192:195],a[200:203],v[136:139]
ds_read_b64_tr_b16 v[212:213],v15 offset:4096
M v[76:79],v[196:199],a[192:195],v[76:79]
ds_read_b64_tr_b16 v[214:215],v15 offset:4608
M v[108:111],v[196:199],a[196:199],v[108:111]
M v[140:143],v[196:199],a[200:203],v[140:143]
s_waitcnt vmcnt(11) lgkmcnt(0)
s_barrier
M v[80:83],v[200:203],a[192:195],v[80:83]
ds_read_b64_tr_b16 v[192:193],v12 offset:8192
M v[112:115],v[200:203],a[196:199],v[112:115]
ds_read_b64_tr_b16 v[194:195],v12 offset:8704
M v[144:147],v[200:203],a[200:203],v[144:147]
ds_read_b64_tr_b16 v[196:197],v13 offset:8192
M v[84:87],v[204:207],a[192:195],v[84:87]
ds_read_b64_tr_b16 v[198:199],v13 offset:8704
M v[116:119],v[204:207],a[196:199],v[116:119]
M v[148:151],v[204:207],a[200:203],v[148:151]
M v[88:91],v[208:211],a[192:195],v[88:91]
ds_read_b64_tr_b16 v[200:201],v14 offset:8192
M v[120:123],v[208:211],a[196:199],v[120:123]
ds_read_b64_tr_b16 v[202:203],v14 offset:8704
M v[152:155],v[208:211],a[200:203],v[152:155]
ds_read_b64_tr_b16 v[204:205],v15 offset:8192
M v[92:95],v[212:215],a[192:195],v[92:95]
ds_read_b64_tr_b16 v[206:207],v15 offset:8704
M v[124:127],v[212:215],a[196:199],v[124:127]
M v[156:159],v[212:215],a[200:203],v[156:159]
s_waitcnt lgkmcnt(4)
M a[0:3],v[192:195],a[192:195],a[0:3]
ds_read_b64_tr_b16 v[208:209],v12 offset:12288
M a[32:35],v[192:195],a[196:199],a[32:35]
ds_read_b64_tr_b16 v[210:211],v12 offset:12800
M a[64:67],v[192:195],a[200:203],a[64:67]
ds_read_b64_tr_b16 v[212:213],v13 offset:12288
M a[4:7],v[196:199],a[192:195],a[4:7]
ds_read_b64_tr_b16 v[214:215],v13 offset:12800
M a[36:39],v[196:199],a[196:199],a[36:39]
M a[68:71],v[196:199],a[200:203],a[68:71]
s_waitcnt lgkmcnt(4)
M a[8:11],v[200:203],a[192:195],a[8:11]
ds_read_b64_tr_b16 v[192:193],v14 offset:12288
M a[40:43],v[200:203],a[196:199],a[40:43]
ds_read_b64_tr_b16 v[194:195],v14 offset:12800
M a[72:75],v[200:203],a[200:203],a[72:75]
ds_read_b64_tr_b16 v[196:197],v15 offset:12288
M a[12:15],v[204:207],a[192:195],a[12:15]
ds_read_b64_tr_b16 v[198:199],v15 offset:12800
M a[44:47],v[204:207],a[196:199],a[44:47]
s_cmp_eq_u32 s29,4
s_cbranch_scc0 L_cg7
buffer_atomic_add v5,v4,s[92:95],0 offen
L_cg7:
M a[76:79],v[204:207],a[200:203],a[76:79]
s_waitcnt lgkmcnt(0)
s_barrier
M a[16:19],v[208:211],a[192:195],a[16:19]
ds_read_b64_tr_b16 v[200:201],v12 offset:32768
s_mov_b32 m0,57344
M a[48:51],v[208:211],a[196:199],a[48:51]
ds_read_b64_tr_b16 v[202:203],v12 offset:33280
buffer_load_dwordx4 v16,s[8:11],s34 offen lds
M a[80:83],v[208:211],a[200:203],a[80:83]
ds_read_b64_tr_b16 v[204:205],v13 offset:32768
buffer_load_dwordx4 v17,s[8:11],s34 offen offset:1024 lds
M a[20:23],v[212:215],a[192:195],a[20:23]
ds_read_b64_tr_b16 v[206:207],v13 offset:33280
buffer_load_dwordx4 v18,s[8:11],s34 offen offset:2048 lds
M a[52:55],v[212:215],a[196:199],a[52:55]
ds_read_b128 a[208:211],v11 offset:33280
buffer_load_dwordx4 v19,s[8:11],s34 offen offset:3072 lds
M a[84:87],v[212:215],a[200:203],a[84:87]
ds_read_b128 a[212:215],v11 offset:35328
s_add_u32 s34,s34,262144
M a[24:27],v[192:195],a[192:195],a[24:27]
ds_read_b128 a[216:219],v11 offset:37376
ds_read_b64_tr_b16 v[208:209],v14 offset:32768
M a[56:59],v[192:195],a[196:199],a[56:59]
ds_read_b64_tr_b16 v[210:211],v14 offset:33280
M a[88:91],v[192:195],a[200:203],a[88:91]
ds_read_b64_tr_b16 v[212:213],v15 offset:32768
M a[28:31],v[196:199],a[192:195],a[28:31]
ds_read_b64_tr_b16 v[214:215],v15 offset:33280
s_mov_b32 m0,61440
M a[60:63],v[196:199],a[196:199],a[60:63]
buffer_load_dwordx4 v16,s[8:11],s35 offen lds
M a[92:95],v[196:199],a[200:203],a[92:95]
s_waitcnt lgkmcnt(4)
buffer_load_dwordx4 v17,s[8:11],s35 offen offset:1024 lds
M v[64:67],v[200:203],a[208:211],v[64:67]
ds_read_b64_tr_b16 v[192:193],v12 offset:36864
buffer_load_dwordx4 v18,s[8:11],s35 offen offset:2048 lds
M v[96:99],v[200:203],a[212:215],v[96:99]
ds_read_b64_tr_b16 v[194:195],v12 offset:37376
buffer_load_dwordx4 v19,s[8:11],s35 offen offset:3072 lds
M v[128:131],v[200:203],a[216:219],v[128:131]
ds_read_b64_tr_b16 v[196:197],v13 offset:36864
s_add_u32 s35,s35,262144
M v[68:71],v[204:207],a[208:211],v[68:71]
ds_read_b64_tr_b16 v[198:199],v13 offset:37376
M v[100:103],v[204:207],a[212:215],v[100:103]
M v[132:135],v[204:207],a[216:219],v[132:135]
s_waitcnt lgkmcnt(4)
M v[72:75],v[208:211],a[208:211],v[72:75]
ds_read_b64_tr_b16 v[200:201],v14 offset:36864
M v[104:107],v[208:211],a[212:215],v[104:107]
ds_read_b64_tr_b16 v[202:203],v14 offset:37376
M v[136:139],v[208:211],a[216:219],v[136:139]
ds_read_b64_tr_b16 v[204:205],v15 offset:36864
M v[76:79],v[212:215],a[208:211],v[76:79]
ds_read_b64_tr_b16 v[206:207],v15 offset:37376
M v[108:111],v[212:215],a[212:215],v[108:111]
M v[140:143],v[212:215],a[216:219],v[140:143]
s_waitcnt vmcnt(8) lgkmcnt(0)
s_barrier
M v[80:83],v[192:195],a[208:211],v[80:83]
ds_read_b64_tr_b16 v[208:209],v12 offset:40960
M v[112:115],v[192:195],a[212:215],v[112:115]
ds_read_b64_tr_b16 v[210:211],v12 offset:41472
M v[144:147],v[192:195],a[216:219],v[144:147]
ds_read_b64_tr_b16 v[212:213],v13 offset:40960
M v[84:87],v[196:199],a[208:211],v[84:87]
ds_read_b64_tr_b16 v[214:215],v13 offset:41472
M v[116:119],v[196:199],a[212:215],v[116:119]
M v[148:151],v[196:199],a[216:219],v[148:151]
M v[88:91],v[200:203],a[208:211],v[88:91]
ds_read_b64_tr_b16 v[192:193],v14 offset:40960
M v[120:123],v[200:203],a[212:215],v[120:123]
ds_read_b64_tr_b16 v[194:195],v14 offset:41472
M v[152:155],v[200:203],a[216:219],v[152:155]
ds_read_b64_tr_b16 v[196:197],v15 offset:40960
M v[92:95],v[204:207],a[208:211],v[92:95]
ds_read_b64_tr_b16 v[198:199],v15 offset:41472
M v[124:127],v[204:207],a[212:215],v[124:127]
M v[156:159],v[204:207],a[216:219],v[156:159]
s_waitcnt lgkmcnt(4)
M a[0:3],v[208:211],a[208:211],a[0:3]
ds_read_b64_tr_b16 v[200:201],v12 offset:45056
M a[32:35],v[208:211],a[212:215],a[32:35]
ds_read_b64_tr_b16 v[202:203],v12 offset:45568
M a[64:67],v[208:211],a[216:219],a[64:67]
ds_read_b64_tr_b16 v[204:205],v13 offset:45056
M a[4:7],v[212:215],a[208:211],a[4:7]
ds_read_b64_tr_b16 v[206:207],v13 offset:45568
M a[36:39],v[212:215],a[212:215],a[36:39]
s_cmp_eq_u32 s29,5
s_cbranch_scc0 L_cg8
buffer_atomic_add v5,v4,s[92:95],0 offen
L_cg8:
M a[68:71],v[212:215],a[216:219],a[68:71]
s_waitcnt lgkmcnt(4)
M a[8:11],v[192:195],a[208:211],a[8:11]
ds_read_b64_tr_b16 v[208:209],v14 offset:45056
M a[40:43],v[192:195],a[212:215],a[40:43]
ds_read_b64_tr_b16 v[210:211],v14 offset:45568
M a[72:75],v[192:195],a[216:219],a[72:75]
ds_read_b64_tr_b16 v[212:213],v15 offset:45056
M a[12:15],v[196:199],a[208:211],a[12:15]
ds_read_b64_tr_b16 v[214:215],v15 offset:45568
M a[44:47],v[196:199],a[212:215],a[44:47]
M a[76:79],v[196:199],a[216:219],a[76:79]
s_waitcnt lgkmcnt(0)
s_barrier
M a[16:19],v[200:203],a[208:211],a[16:19]
ds_read_b64_tr_b16 v[192:193],v12
s_mov_b32 m0,90112
M a[48:51],v[200:203],a[212:215],a[48:51]
ds_read_b64_tr_b16 v[194:195],v12 offset:512
buffer_load_dwordx4 v16,s[8:11],s34 offen lds
M a[80:83],v[200:203],a[216:219],a[80:83]
ds_read_b64_tr_b16 v[196:197],v13
buffer_load_dwordx4 v17,s[8:11],s34 offen offset:1024 lds
M a[20:23],v[204:207],a[208:211],a[20:23]
ds_read_b64_tr_b16 v[198:199],v13 offset:512
buffer_load_dwordx4 v18,s[8:11],s34 offen offset:2048 lds
M a[52:55],v[204:207],a[212:215],a[52:55]
ds_read_b128 a[192:195],v11
buffer_load_dwordx4 v19,s[8:11],s34 offen offset:3072 lds
M a[84:87],v[204:207],a[216:219],a[84:87]
ds_read_b128 a[196:199],v11 offset:2048
s_add_u32 s34,s34,262144
M a[24:27],v[208:211],a[208:211],a[24:27]
ds_read_b128 a[200:203],v11 offset:4096
ds_read_b64_tr_b16 v[200:201],v14
M a[56:59],v[208:211],a[212:215],a[56:59]
ds_read_b64_tr_b16 v[202:203],v14 offset:512
M a[88:91],v[208:211],a[216:219],a[88:91]
ds_read_b64_tr_b16 v[204:205],v15
M a[28:31],v[212:215],a[208:211],a[28:31]
ds_read_b64_tr_b16 v[206:207],v15 offset:512
s_mov_b32 m0,94208
M a[60:63],v[212:215],a[212:215],a[60:63]
buffer_load_dwordx4 v16,s[8:11],s35 offen lds
M a[92:95],v[212:215],a[216:219],a[92:95]
s_waitcnt lgkmcnt(4)
buffer_load_dwordx4 v17,s[8:11],s35 offen offset:1024 lds
M v[64:67],v[192:195],a[192:195],v[64:67]
ds_read_b64_tr_b16 v[208:209],v12 offset:4096
buffer_load_dwordx4 v18,s[8:11],s35 offen offset:2048 lds
M v[96:99],v[192:195],a[196:199],v[96:99]
ds_read_b64_tr_b16 v[210:211],v12 offset:4608
buffer_load_dwordx4 v19,s[8:11],s35 offen offset:3072 lds
M v[128:131],v[192:195],a[200:203],v[128:131]
ds_read_b64_tr_b16 v[212:213],v13 offset:4096
s_add_u32 s35,s35,262144
M v[68:71],v[196:199],a[192:195],v[68:71]
ds_read_b64_tr_b16 v[214:215],v13 offset:4608
M v[100:103],v[196:199],a[196:199],v[100:103]
M v[132:135],v[196:199],a[200:203],v[132:135]
s_waitcnt lgkmcnt(4)
M v[72:75],v[200:203],a[192:195],v[72:75]
ds_read_b64_tr_b16 v[192:193],v14 offset:4096
M v[104:107],v[200:203],a[196:199],v[104:107]
ds_read_b64_tr_b16 v[194:195],v14 offset:4608
M v[136:139],v[200:203],a[200:203],v[136:139]
ds_read_b64_tr_b16 v[196:197],v15 offset:4096
M v[76:79],v[204:207],a[192:195],v[76:79]
ds_read_b64_tr_b16 v[198:199],v15 offset:4608
M v[108:111],v[204:207],a[196:199],v[108:111]
M v[140:143],v[204:207],a[200:203],v[140:143]
s_waitcnt vmcnt(8) lgkmcnt(0)
s_barrier
M v[80:83],v[208:211],a[192:195],v[80:83]
ds_read_b64_tr_b16 v[200:201],v12 offset:8192
M v[112:115],v[208:211],a[196:199],v[112:115]
ds_read_b64_tr_b16 v[202:203],v12 offset:8704
M v[144:147],v[208:211],a[200:203],v[144:147]
ds_read_b64_tr_b16 v[204:205],v13 offset:8192
M v[84:87],v[212:215],a[192:195],v[84:87]
ds_read_b64_tr_b16 v[206:207],v13 offset:8704
M v[116:119],v[212:215],a[196:199],v[116:119]
M v[148:151],v[212:215],a[200:203],v[148:151]
M v[88:91],v[192:195],a[192:195],v[88:91]
ds_read_b64_tr_b16 v[208:209],v14 offset:8192
M v[120:123],v[192:195],a[196:199],v[120:123]
ds_read_b64_tr_b16 v[210:211],v14 offset:8704
M v[152:155],v[192:195],a[200:203],v[152:155]
ds_read_b64_tr_b16 v[212:213],v15 offset:8192
M v[92:95],v[196:199],a[192:195],v[92:95]
ds_read_b64_tr_b16 v[214:215],v15 offset:8704
s_cmp_eq_u32 s29,6
s_cbranch_scc0 L_cg9
buffer_atomic_add v5,v4,s[92:95],0 offen
L_cg9:
M v[124:127],v[196:199],a[196:199],v[124:127]
M v[156:159],v[196:199],a[200:203],v[156:159]
s_waitcnt lgkmcnt(4)
M a[0:3],v[200:203],a[192:195],a[0:3]
ds_read_b64_tr_b16 v[192:193],v12 offset:12288
s_mov_b32 s87,3145728
buffer_load_dword v30,v7,s[8:11],s87 offen
M a[32:35],v[200:203],a[196:199],a[32:35]
ds_read_b64_tr_b16 v[194:195],v12 offset:12800
s_mov_b32 s87,3670016
buffer_load_dword v30,v7,s[8:11],s87 offen
M a[64:67],v[200:203],a[200:203],a[64:67]
ds_read_b64_tr_b16 v[196:197],v13 offset:12288
buffer_load_dword v30,v3,s[4:7],0 offen offset:768
M a[4:7],v[204:207],a[192:195],a[4:7]
ds_read_b64_tr_b16 v[198:199],v13 offset:12800
M a[36:39],v[204:207],a[196:199],a[36:39]
M a[68:71],v[204:207],a[200:203],a[68:71]
s_waitcnt lgkmcnt(4)
M a[8:11],v[208:211],a[192:195],a[8:11]
ds_read_b64_tr_b16 v[200:201],v14 offset:12288
M a[40:43],v[208:211],a[196:199],a[40:43]
ds_read_b64_tr_b16 v[202:203],v14 offset:12800
M a[72:75],v[208:211],a[200:203],a[72:75]
ds_read_b64_tr_b16 v[204:205],v15 offset:12288
M a[12:15],v[212:215],a[192:195],a[12:15]
ds_read_b64_tr_b16 v[206:207],v15 offset:12800
M a[44:47],v[212:215],a[196:199],a[44:47]
M a[76:79],v[212:215],a[200:203],a[76:79]
s_waitcnt lgkmcnt(0)
s_barrier
M a[16:19],v[192:195],a[192:195],a[16:19]
ds_read_b64_tr_b16 v[208:209],v12 offset:32768
s_mov_b32 m0,57344
M a[48:51],v[192:195],a[196:199],a[48:51]
ds_read_b64_tr_b16 v[210:211],v12 offset:33280
buffer_load_dwordx4 v16,s[8:11],s34 offen lds
M a[80:83],v[192:195],a[200:203],a[80:83]
ds_read_b64_tr_b16 v[212:213],v13 offset:32768
buffer_load_dwordx4 v17,s[8:11],s34 offen offset:1024 lds
M a[20:23],v[196:199],a[192:195],a[20:23]
ds_read_b64_tr_b16 v[214:215],v13 offset:33280
buffer_load_dwordx4 v18,s[8:11],s34 offen offset:2048 lds
M a[52:55],v[196:199],a[196:199],a[52:55]
ds_read_b128 a[208:211],v11 offset:512
buffer_load_dwordx4 v19,s[8:11],s34 offen offset:3072 lds
M a[84:87],v[196:199],a[200:203],a[84:87]
ds_read_b128 a[212:215],v11 offset:2560
s_add_u32 s34,s34,262144
M a[24:27],v[200:203],a[192:195],a[24:27]
ds_read_b128 a[216:219],v11 offset:4608
ds_read_b64_tr_b16 v[192:193],v14 offset:32768
M a[56:59],v[200:203],a[196:199],a[56:59]
ds_read_b64_tr_b16 v[194:195],v14 offset:33280
M a[88:91],v[200:203],a[200:203],a[88:91]
ds_read_b64_tr_b16 v[196:197],v15 offset:32768
M a[28:31],v[204:207],a[192:195],a[28:31]
ds_read_b64_tr_b16 v[198:199],v15 offset:33280
s_mov_b32 m0,61440
M a[60:63],v[204:207],a[196:199],a[60:63]
buffer_load_dwordx4 v16,s[8:11],s35 offen lds
M a[92:95],v[204:207],a[200:203],a[92:95]
s_waitcnt lgkmcnt(4)
buffer_load_dwordx4 v17,s[8:11],s35 offen offset:1024 lds
M v[64:67],v[208:211],a[208:211],v[64:67]
ds_read_b64_tr_b16 v[200:201],v12 offset:36864
buffer_load_dwordx4 v18,s[8:11],s35 offen offset:2048 lds
M v[96:99],v[208:211],a[212:215],v[96:99]
ds_read_b64_tr_b16 v[202:203],v12 offset:37376
buffer_load_dwordx4 v19,s[8:11],s35 offen offset:3072 lds
M v[128:131],v[208:211],a[216:219],v[128:131]
ds_read_b64_tr_b16 v[204:205],v13 offset:36864
s_add_u32 s35,s35,262144
M v[68:71],v[212:215],a[208:211],v[68:71]
ds_read_b64_tr_b16 v[206:207],v13 offset:37376
M v[100:103],v[212:215],a[212:215],v[100:103]
M v[132:135],v[212:215],a[216:219],v[132:135]
s_waitcnt lgkmcnt(4)
M v[72:75],v[192:195],a[208:211],v[72:75]
ds_read_b64_tr_b16 v[208:209],v14 offset:36864
M v[104:107],v[192:195],a[212:215],v[104:107]
ds_read_b64_tr_b16 v[210:211],v14 offset:37376
M v[136:139],v[192:195],a[216:219],v[136:139]
ds_read_b64_tr_b16 v[212:213],v15 offset:36864
M v[76:79],v[196:199],a[208:211],v[76:79]
ds_read_b64_tr_b16 v[214:215],v15 offset:37376
M v[108:111],v[196:199],a[212:215],v[108:111]
M v[140:143],v[196:199],a[216:219],v[140:143]
s_waitcnt vmcnt(11) lgkmcnt(0)
s_barrier
M v[80:83],v[200:203],a[208:211],v[80:83]
ds_read_b64_tr_b16 v[192:193],v12 offset:40960
M v[112:115],v[200:203],a[212:215],v[112:115]
ds_read_b64_tr_b16 v[194:195],v12 offset:41472
M v[144:147],v[200:203],a[216:219],v[144:147]
ds_read_b64_tr_b16 v[196:197],v13 offset:40960
M v[84:87],v[204:207],a[208:211],v[84:87]
ds_read_b64_tr_b16 v[198:199],v13 offset:41472
s_cmp_eq_u32 s29,7
s_cbranch_scc0 L_cg10
buffer_atomic_add v5,v4,s[92:95],0 offen
L_cg10:
M v[116:119],v[204:207],a[212:215],v[116:119]
M v[148:151],v[204:207],a[216:219],v[148:151]
M v[88:91],v[208:211],a[208:211],v[88:91]
ds_read_b64_tr_b16 v[200:201],v14 offset:40960
M v[120:123],v[208:211],a[212:215],v[120:123]
ds_read_b64_tr_b16 v[202:203],v14 offset:41472
M v[152:155],v[208:211],a[216:219],v[152:155]
ds_read_b64_tr_b16 v[204:205],v15 offset:40960
M v[92:95],v[212:215],a[208:211],v[92:95]
ds_read_b64_tr_b16 v[206:207],v15 offset:41472
M v[124:127],v[212:215],a[212:215],v[124:127]
M v[156:159],v[212:215],a[216:219],v[156:159]
s_waitcnt lgkmcnt(4)
M a[0:3],v[192:195],a[208:211],a[0:3]
ds_read_b64_tr_b16 v[208:209],v12 offset:45056
M a[32:35],v[192:195],a[212:215],a[32:35]
ds_read_b64_tr_b16 v[210:211],v12 offset:45568
M a[64:67],v[192:195],a[216:219],a[64:67]
ds_read_b64_tr_b16 v[212:213],v13 offset:45056
M a[4:7],v[196:199],a[208:211],a[4:7]
ds_read_b64_tr_b16 v[214:215],v13 offset:45568
M a[36:39],v[196:199],a[212:215],a[36:39]
M a[68:71],v[196:199],a[216:219],a[68:71]
s_waitcnt lgkmcnt(4)
M a[8:11],v[200:203],a[208:211],a[8:11]
ds_read_b64_tr_b16 v[192:193],v14 offset:45056
M a[40:43],v[200:203],a[212:215],a[40:43]
ds_read_b64_tr_b16 v[194:195],v14 offset:45568
M a[72:75],v[200:203],a[216:219],a[72:75]
ds_read_b64_tr_b16 v[196:197],v15 offset:45056
M a[12:15],v[204:207],a[208:211],a[12:15]
ds_read_b64_tr_b16 v[198:199],v15 offset:45568
M a[44:47],v[204:207],a[212:215],a[44:47]
M a[76:79],v[204:207],a[216:219],a[76:79]
s_waitcnt lgkmcnt(0)
s_barrier
M a[16:19],v[208:211],a[208:211],a[16:19]
ds_read_b64_tr_b16 v[200:201],v12
s_mov_b32 m0,90112
M a[48:51],v[208:211],a[212:215],a[48:51]
ds_read_b64_tr_b16 v[202:203],v12 offset:512
buffer_load_dwordx4 v16,s[8:11],s34 offen lds
M a[80:83],v[208:211],a[216:219],a[80:83]
ds_read_b64_tr_b16 v[204:205],v13
buffer_load_dwordx4 v17,s[8:11],s34 offen offset:1024 lds
M a[20:23],v[212:215],a[208:211],a[20:23]
ds_read_b64_tr_b16 v[206:207],v13 offset:512
buffer_load_dwordx4 v18,s[8:11],s34 offen offset:2048 lds
M a[52:55],v[212:215],a[212:215],a[52:55]
ds_read_b128 a[192:195],v11 offset:32768
buffer_load_dwordx4 v19,s[8:11],s34 offen offset:3072 lds
M a[84:87],v[212:215],a[216:219],a[84:87]
ds_read_b128 a[196:199],v11 offset:34816
s_add_u32 s34,s34,262144
M a[24:27],v[192:195],a[208:211],a[24:27]
ds_read_b128 a[200:203],v11 offset:36864
ds_read_b64_tr_b16 v[208:209],v14
M a[56:59],v[192:195],a[212:215],a[56:59]
ds_read_b64_tr_b16 v[210:211],v14 offset:512
M a[88:91],v[192:195],a[216:219],a[88:91]
ds_read_b64_tr_b16 v[212:213],v15
M a[28:31],v[196:199],a[208:211],a[28:31]
ds_read_b64_tr_b16 v[214:215],v15 offset:512
s_mov_b32 m0,94208
M a[60:63],v[196:199],a[212:215],a[60:63]
buffer_load_dwordx4 v16,s[8:11],s35 offen lds
M a[92:95],v[196:199],a[216:219],a[92:95]
s_waitcnt lgkmcnt(4)
buffer_load_dwordx4 v17,s[8:11],s35 offen offset:1024 lds
M v[64:67],v[200:203],a[192:195],v[64:67]
ds_read_b64_tr_b16 v[192:193],v12 offset:4096
buffer_load_dwordx4 v18,s[8:11],s35 offen offset:2048 lds
M v[96:99],v[200:203],a[196:199],v[96:99]
ds_read_b64_tr_b16 v[194:195],v12 offset:4608
buffer_load_dwordx4 v19,s[8:11],s35 offen offset:3072 lds
M v[128:131],v[200:203],a[200:203],v[128:131]
ds_read_b64_tr_b16 v[196:197],v13 offset:4096
s_add_u32 s35,s35,262144
M v[68:71],v[204:207],a[192:195],v[68:71]
ds_read_b64_tr_b16 v[198:199],v13 offset:4608
M v[100:103],v[204:207],a[196:199],v[100:103]
M v[132:135],v[204:207],a[200:203],v[132:135]
s_waitcnt lgkmcnt(4)
M v[72:75],v[208:211],a[192:195],v[72:75]
ds_read_b64_tr_b16 v[200:201],v14 offset:4096
s_mov_b32 m0,0
M v[104:107],v[208:211],a[196:199],v[104:107]
ds_read_b64_tr_b16 v[202:203],v14 offset:4608
buffer_load_dwordx4 v21,s[12:15],s48 offen nt lds
M v[136:139],v[208:211],a[200:203],v[136:139]
ds_read_b64_tr_b16 v[204:205],v15 offset:4096
s_cmp_eq_u32 s29,8
s_cbranch_scc0 L_cg11
buffer_atomic_add v5,v4,s[92:95],0 offen
L_cg11:
buffer_load_dwordx4 v22,s[12:15],s48 offen offset:1024 nt lds
M v[76:79],v[212:215],a[192:195],v[76:79]
ds_read_b64_tr_b16 v[206:207],v15 offset:4608
buffer_load_dwordx4 v23,s[12:15],s48 offen offset:2048 nt lds
M v[108:111],v[212:215],a[196:199],v[108:111]
buffer_load_dwordx4 v24,s[12:15],s48 offen offset:3072 nt lds
M v[140:143],v[212:215],a[200:203],v[140:143]
s_waitcnt vmcnt(12) lgkmcnt(0)
s_barrier
s_add_u32 s48,s48,4096
s_mov_b32 m0,4096
M v[80:83],v[192:195],a[192:195],v[80:83]
ds_read_b64_tr_b16 v[208:209],v12 offset:8192
buffer_load_dwordx4 v21,s[12:15],s48 offen nt lds
M v[112:115],v[192:195],a[196:199],v[112:115]
ds_read_b64_tr_b16 v[210:211],v12 offset:8704
buffer_load_dwordx4 v22,s[12:15],s48 offen offset:1024 nt lds
M v[144:147],v[192:195],a[200:203],v[144:147]
ds_read_b64_tr_b16 v[212:213],v13 offset:8192
buffer_load_dwordx4 v23,s[12:15],s48 offen offset:2048 nt lds
M v[84:87],v[196:199],a[192:195],v[84:87]
ds_read_b64_tr_b16 v[214:215],v13 offset:8704
buffer_load_dwordx4 v24,s[12:15],s48 offen offset:3072 nt lds
M v[116:119],v[196:199],a[196:199],v[116:119]
s_add_u32 s48,s48,4096
s_mov_b32 m0,8192
M v[148:151],v[196:199],a[200:203],v[148:151]
buffer_load_dwordx4 v21,s[12:15],s48 offen nt lds
M v[88:91],v[200:203],a[192:195],v[88:91]
ds_read_b64_tr_b16 v[192:193],v14 offset:8192
buffer_load_dwordx4 v22,s[12:15],s48 offen offset:1024 nt lds
M v[120:123],v[200:203],a[196:199],v[120:123]
ds_read_b64_tr_b16 v[194:195],v14 offset:8704
buffer_load_dwordx4 v23,s[12:15],s48 offen offset:2048 nt lds
M v[152:155],v[200:203],a[200:203],v[152:155]
ds_read_b64_tr_b16 v[196:197],v15 offset:8192
buffer_load_dwordx4 v24,s[12:15],s48 offen offset:3072 nt lds
M v[92:95],v[204:207],a[192:195],v[92:95]
ds_read_b64_tr_b16 v[198:199],v15 offset:8704
s_add_u32 s48,s48,4096
s_mov_b32 m0,12288
M v[124:127],v[204:207],a[196:199],v[124:127]
buffer_load_dwordx4 v21,s[12:15],s48 offen nt lds
M v[156:159],v[204:207],a[200:203],v[156:159]
s_waitcnt lgkmcnt(4)
buffer_load_dwordx4 v22,s[12:15],s48 offen offset:1024 nt lds
M a[0:3],v[208:211],a[192:195],a[0:3]
ds_read_b64_tr_b16 v[200:201],v12 offset:12288
buffer_load_dwordx4 v23,s[12:15],s48 offen offset:2048 nt lds
M a[32:35],v[208:211],a[196:199],a[32:35]
ds_read_b64_tr_b16 v[202:203],v12 offset:12800
buffer_load_dwordx4 v24,s[12:15],s48 offen offset:3072 nt lds
M a[64:67],v[208:211],a[200:203],a[64:67]
ds_read_b64_tr_b16 v[204:205],v13 offset:12288
s_add_u32 s48,s48,4096
M a[4:7],v[212:215],a[192:195],a[4:7]
ds_read_b64_tr_b16 v[206:207],v13 offset:12800
M a[36:39],v[212:215],a[196:199],a[36:39]
M a[68:71],v[212:215],a[200:203],a[68:71]
s_waitcnt lgkmcnt(4)
M a[8:11],v[192:195],a[192:195],a[8:11]
ds_read_b64_tr_b16 v[208:209],v14 offset:12288
M a[40:43],v[192:195],a[196:199],a[40:43]
ds_read_b64_tr_b16 v[210:211],v14 offset:12800
M a[72:75],v[192:195],a[200:203],a[72:75]
ds_read_b64_tr_b16 v[212:213],v15 offset:12288
M a[12:15],v[196:199],a[192:195],a[12:15]
ds_read_b64_tr_b16 v[214:215],v15 offset:12800
M a[44:47],v[196:199],a[196:199],a[44:47]
M a[76:79],v[196:199],a[200:203],a[76:79]
s_waitcnt lgkmcnt(0)
s_barrier
M a[16:19],v[200:203],a[192:195],a[16:19]
ds_read_b64_tr_b16 v[192:193],v12 offset:32768
s_mov_b32 m0,57344
M a[48:51],v[200:203],a[196:199],a[48:51]
ds_read_b64_tr_b16 v[194:195],v12 offset:33280
buffer_load_dwordx4 v16,s[8:11],s34 offen lds
M a[80:83],v[200:203],a[200:203],a[80:83]
ds_read_b64_tr_b16 v[196:197],v13 offset:32768
buffer_load_dwordx4 v17,s[8:11],s34 offen offset:1024 lds
M a[20:23],v[204:207],a[192:195],a[20:23]
ds_read_b64_tr_b16 v[198:199],v13 offset:33280
buffer_load_dwordx4 v18,s[8:11],s34 offen offset:2048 lds
M a[52:55],v[204:207],a[196:199],a[52:55]
ds_read_b128 a[208:211],v11 offset:33280
buffer_load_dwordx4 v19,s[8:11],s34 offen offset:3072 lds
M a[84:87],v[204:207],a[200:203],a[84:87]
ds_read_b128 a[212:215],v11 offset:35328
s_add_u32 s34,s34,262144
M a[24:27],v[208:211],a[192:195],a[24:27]
ds_read_b128 a[216:219],v11 offset:37376
ds_read_b64_tr_b16 v[200:201],v14 offset:32768
M a[56:59],v[208:211],a[196:199],a[56:59]
ds_read_b64_tr_b16 v[202:203],v14 offset:33280
M a[88:91],v[208:211],a[200:203],a[88:91]
ds_read_b64_tr_b16 v[204:205],v15 offset:32768
M a[28:31],v[212:215],a[192:195],a[28:31]
ds_read_b64_tr_b16 v[206:207],v15 offset:33280
s_mov_b32 m0,61440
M a[60:63],v[212:215],a[196:199],a[60:63]
buffer_load_dwordx4 v16,s[8:11],s35 offen lds
M a[92:95],v[212:215],a[200:203],a[92:95]
s_waitcnt lgkmcnt(4)
buffer_load_dwordx4 v17,s[8:11],s35 offen offset:1024 lds
M v[64:67],v[192:195],a[208:211],v[64:67]
ds_read_b64_tr_b16 v[208:209],v12 offset:36864
buffer_load_dwordx4 v18,s[8:11],s35 offen offset:2048 lds
M v[96:99],v[192:195],a[212:215],v[96:99]
ds_read_b64_tr_b16 v[210:211],v12 offset:37376
buffer_load_dwordx4 v19,s[8:11],s35 offen offset:3072 lds
M v[128:131],v[192:195],a[216:219],v[128:131]
ds_read_b64_tr_b16 v[212:213],v13 offset:36864
s_cmp_eq_u32 s29,9
s_cbranch_scc0 L_cg12
buffer_atomic_add v5,v4,s[92:95],0 offen
L_cg12:
s_add_u32 s35,s35,262144
M v[68:71],v[196:199],a[208:211],v[68:71]
ds_read_b64_tr_b16 v[214:215],v13 offset:37376
M v[100:103],v[196:199],a[212:215],v[100:103]
M v[132:135],v[196:199],a[216:219],v[132:135]
s_waitcnt lgkmcnt(4)
M v[72:75],v[200:203],a[208:211],v[72:75]
ds_read_b64_tr_b16 v[192:193],v14 offset:36864
M v[104:107],v[200:203],a[212:215],v[104:107]
ds_read_b64_tr_b16 v[194:195],v14 offset:37376
M v[136:139],v[200:203],a[216:219],v[136:139]
ds_read_b64_tr_b16 v[196:197],v15 offset:36864
M v[76:79],v[204:207],a[208:211],v[76:79]
ds_read_b64_tr_b16 v[198:199],v15 offset:37376
M v[108:111],v[204:207],a[212:215],v[108:111]
M v[140:143],v[204:207],a[216:219],v[140:143]
s_waitcnt vmcnt(24) lgkmcnt(0)
s_barrier
M v[80:83],v[208:211],a[208:211],v[80:83]
ds_read_b64_tr_b16 v[200:201],v12 offset:40960
M v[112:115],v[208:211],a[212:215],v[112:115]
ds_read_b64_tr_b16 v[202:203],v12 offset:41472
M v[144:147],v[208:211],a[216:219],v[144:147]
ds_read_b64_tr_b16 v[204:205],v13 offset:40960
M v[84:87],v[212:215],a[208:211],v[84:87]
ds_read_b64_tr_b16 v[206:207],v13 offset:41472
M v[116:119],v[212:215],a[212:215],v[116:119]
M v[148:151],v[212:215],a[216:219],v[148:151]
M v[88:91],v[192:195],a[208:211],v[88:91]
ds_read_b64_tr_b16 v[208:209],v14 offset:40960
M v[120:123],v[192:195],a[212:215],v[120:123]
ds_read_b64_tr_b16 v[210:211],v14 offset:41472
M v[152:155],v[192:195],a[216:219],v[152:155]
ds_read_b64_tr_b16 v[212:213],v15 offset:40960
M v[92:95],v[196:199],a[208:211],v[92:95]
ds_read_b64_tr_b16 v[214:215],v15 offset:41472
M v[124:127],v[196:199],a[212:215],v[124:127]
M v[156:159],v[196:199],a[216:219],v[156:159]
s_waitcnt lgkmcnt(4)
M a[0:3],v[200:203],a[208:211],a[0:3]
ds_read_b64_tr_b16 v[192:193],v12 offset:45056
M a[32:35],v[200:203],a[212:215],a[32:35]
ds_read_b64_tr_b16 v[194:195],v12 offset:45568
M a[64:67],v[200:203],a[216:219],a[64:67]
ds_read_b64_tr_b16 v[196:197],v13 offset:45056
M a[4:7],v[204:207],a[208:211],a[4:7]
ds_read_b64_tr_b16 v[198:199],v13 offset:45568
M a[36:39],v[204:207],a[212:215],a[36:39]
M a[68:71],v[204:207],a[216:219],a[68:71]
s_waitcnt lgkmcnt(4)
M a[8:11],v[208:211],a[208:211],a[8:11]
ds_read_b64_tr_b16 v[200:201],v14 offset:45056
M a[40:43],v[208:211],a[212:215],a[40:43]
ds_read_b64_tr_b16 v[202:203],v14 offset:45568
M a[72:75],v[208:211],a[216:219],a[72:75]
ds_read_b64_tr_b16 v[204:205],v15 offset:45056
M a[12:15],v[212:215],a[208:211],a[12:15]
ds_read_b64_tr_b16 v[206:207],v15 offset:45568
M a[44:47],v[212:215],a[212:215],a[44:47]
M a[76:79],v[212:215],a[216:219],a[76:79]
s_waitcnt lgkmcnt(0)
s_barrier
M a[16:19],v[192:195],a[208:211],a[16:19]
ds_read_b64_tr_b16 v[208:209],v12
s_mov_b32 m0,90112
M a[48:51],v[192:195],a[212:215],a[48:51]
ds_read_b64_tr_b16 v[210:211],v12 offset:512
buffer_load_dwordx4 v16,s[8:11],s34 offen lds
M a[80:83],v[192:195],a[216:219],a[80:83]
ds_read_b64_tr_b16 v[212:213],v13
buffer_load_dwordx4 v17,s[8:11],s34 offen offset:1024 lds
M a[20:23],v[196:199],a[208:211],a[20:23]
ds_read_b64_tr_b16 v[214:215],v13 offset:512
buffer_load_dwordx4 v18,s[8:11],s34 offen offset:2048 lds
M a[52:55],v[196:199],a[212:215],a[52:55]
ds_read_b128 a[192:195],v11
buffer_load_dwordx4 v19,s[8:11],s34 offen offset:3072 lds
M a[84:87],v[196:199],a[216:219],a[84:87]
ds_read_b128 a[196:199],v11 offset:2048
s_add_u32 s34,s34,262144
M a[24:27],v[200:203],a[208:211],a[24:27]
ds_read_b128 a[200:203],v11 offset:4096
ds_read_b64_tr_b16 v[192:193],v14
M a[56:59],v[200:203],a[212:215],a[56:59]
ds_read_b64_tr_b16 v[194:195],v14 offset:512
s_cmp_eq_u32 s29,10
s_cbranch_scc0 L_cg13
buffer_atomic_add v5,v4,s[92:95],0 offen
L_cg13:
M a[88:91],v[200:203],a[216:219],a[88:91]
ds_read_b64_tr_b16 v[196:197],v15
M a[28:31],v[204:207],a[208:211],a[28:31]
ds_read_b64_tr_b16 v[198:199],v15 offset:512
s_mov_b32 m0,94208
M a[60:63],v[204:207],a[212:215],a[60:63]
buffer_load_dwordx4 v16,s[8:11],s35 offen lds
M a[92:95],v[204:207],a[216:219],a[92:95]
s_waitcnt lgkmcnt(4)
buffer_load_dwordx4 v17,s[8:11],s35 offen offset:1024 lds
M v[64:67],v[208:211],a[192:195],v[64:67]
ds_read_b64_tr_b16 v[200:201],v12 offset:4096
buffer_load_dwordx4 v18,s[8:11],s35 offen offset:2048 lds
M v[96:99],v[208:211],a[196:199],v[96:99]
ds_read_b64_tr_b16 v[202:203],v12 offset:4608
buffer_load_dwordx4 v19,s[8:11],s35 offen offset:3072 lds
M v[128:131],v[208:211],a[200:203],v[128:131]
ds_read_b64_tr_b16 v[204:205],v13 offset:4096
s_add_u32 s35,s35,262144
M v[68:71],v[212:215],a[192:195],v[68:71]
ds_read_b64_tr_b16 v[206:207],v13 offset:4608
M v[100:103],v[212:215],a[196:199],v[100:103]
M v[132:135],v[212:215],a[200:203],v[132:135]
s_waitcnt lgkmcnt(4)
M v[72:75],v[192:195],a[192:195],v[72:75]
ds_read_b64_tr_b16 v[208:209],v14 offset:4096
M v[104:107],v[192:195],a[196:199],v[104:107]
ds_read_b64_tr_b16 v[210:211],v14 offset:4608
M v[136:139],v[192:195],a[200:203],v[136:139]
ds_read_b64_tr_b16 v[212:213],v15 offset:4096
M v[76:79],v[196:199],a[192:195],v[76:79]
ds_read_b64_tr_b16 v[214:215],v15 offset:4608
M v[108:111],v[196:199],a[196:199],v[108:111]
M v[140:143],v[196:199],a[200:203],v[140:143]
s_waitcnt vmcnt(8) lgkmcnt(0)
s_barrier
M v[80:83],v[200:203],a[192:195],v[80:83]
ds_read_b64_tr_b16 v[192:193],v12 offset:8192
M v[112:115],v[200:203],a[196:199],v[112:115]
ds_read_b64_tr_b16 v[194:195],v12 offset:8704
M v[144:147],v[200:203],a[200:203],v[144:147]
ds_read_b64_tr_b16 v[196:197],v13 offset:8192
M v[84:87],v[204:207],a[192:195],v[84:87]
ds_read_b64_tr_b16 v[198:199],v13 offset:8704
M v[116:119],v[204:207],a[196:199],v[116:119]
M v[148:151],v[204:207],a[200:203],v[148:151]
M v[88:91],v[208:211],a[192:195],v[88:91]
ds_read_b64_tr_b16 v[200:201],v14 offset:8192
M v[120:123],v[208:211],a[196:199],v[120:123]
ds_read_b64_tr_b16 v[202:203],v14 offset:8704
M v[152:155],v[208:211],a[200:203],v[152:155]
ds_read_b64_tr_b16 v[204:205],v15 offset:8192
M v[92:95],v[212:215],a[192:195],v[92:95]
ds_read_b64_tr_b16 v[206:207],v15 offset:8704
M v[124:127],v[212:215],a[196:199],v[124:127]
M v[156:159],v[212:215],a[200:203],v[156:159]
s_waitcnt lgkmcnt(4)
M a[0:3],v[192:195],a[192:195],a[0:3]
ds_read_b64_tr_b16 v[208:209],v12 offset:12288
M a[32:35],v[192:195],a[196:199],a[32:35]
ds_read_b64_tr_b16 v[210:211],v12 offset:12800
M a[64:67],v[192:195],a[200:203],a[64:67]
ds_read_b64_tr_b16 v[212:213],v13 offset:12288
M a[4:7],v[196:199],a[192:195],a[4:7]
ds_read_b64_tr_b16 v[214:215],v13 offset:12800
M a[36:39],v[196:199],a[196:199],a[36:39]
M a[68:71],v[196:199],a[200:203],a[68:71]
s_waitcnt lgkmcnt(4)
M a[8:11],v[200:203],a[192:195],a[8:11]
ds_read_b64_tr_b16 v[192:193],v14 offset:12288
M a[40:43],v[200:203],a[196:199],a[40:43]
ds_read_b64_tr_b16 v[194:195],v14 offset:12800
M a[72:75],v[200:203],a[200:203],a[72:75]
ds_read_b64_tr_b16 v[196:197],v15 offset:12288
M a[12:15],v[204:207],a[192:195],a[12:15]
ds_read_b64_tr_b16 v[198:199],v15 offset:12800
M a[44:47],v[204:207],a[196:199],a[44:47]
M a[76:79],v[204:207],a[200:203],a[76:79]
s_waitcnt lgkmcnt(0)
s_barrier
M a[16:19],v[208:211],a[192:195],a[16:19]
ds_read_b64_tr_b16 v[200:201],v12 offset:32768
s_mov_b32 m0,57344
M a[48:51],v[208:211],a[196:199],a[48:51]
ds_read_b64_tr_b16 v[202:203],v12 offset:33280
s_cmp_eq_u32 s29,11
s_cbranch_scc0 L_cg14
buffer_atomic_add v5,v4,s[92:95],0 offen
L_cg14:
buffer_load_dwordx4 v16,s[8:11],s34 offen lds
M a[80:83],v[208:211],a[200:203],a[80:83]
ds_read_b64_tr_b16 v[204:205],v13 offset:32768
buffer_load_dwordx4 v17,s[8:11],s34 offen offset:1024 lds
M a[20:23],v[212:215],a[192:195],a[20:23]
ds_read_b64_tr_b16 v[206:207],v13 offset:33280
buffer_load_dwordx4 v18,s[8:11],s34 offen offset:2048 lds
M a[52:55],v[212:215],a[196:199],a[52:55]
ds_read_b128 a[208:211],v11 offset:512
buffer_load_dwordx4 v19,s[8:11],s34 offen offset:3072 lds
M a[84:87],v[212:215],a[200:203],a[84:87]
ds_read_b128 a[212:215],v11 offset:2560
s_add_u32 s34,s34,262144
M a[24:27],v[192:195],a[192:195],a[24:27]
ds_read_b128 a[216:219],v11 offset:4608
ds_read_b64_tr_b16 v[208:209],v14 offset:32768
M a[56:59],v[192:195],a[196:199],a[56:59]
ds_read_b64_tr_b16 v[210:211],v14 offset:33280
M a[88:91],v[192:195],a[200:203],a[88:91]
ds_read_b64_tr_b16 v[212:213],v15 offset:32768
M a[28:31],v[196:199],a[192:195],a[28:31]
ds_read_b64_tr_b16 v[214:215],v15 offset:33280
s_mov_b32 m0,61440
M a[60:63],v[196:199],a[196:199],a[60:63]
buffer_load_dwordx4 v16,s[8:11],s35 offen lds
M a[92:95],v[196:199],a[200:203],a[92:95]
s_waitcnt lgkmcnt(4)
buffer_load_dwordx4 v17,s[8:11],s35 offen offset:1024 lds
M v[64:67],v[200:203],a[208:211],v[64:67]
ds_read_b64_tr_b16 v[192:193],v12 offset:36864
buffer_load_dwordx4 v18,s[8:11],s35 offen offset:2048 lds
M v[96:99],v[200:203],a[212:215],v[96:99]
ds_read_b64_tr_b16 v[194:195],v12 offset:37376
buffer_load_dwordx4 v19,s[8:11],s35 offen offset:3072 lds
M v[128:131],v[200:203],a[216:219],v[128:131]
ds_read_b64_tr_b16 v[196:197],v13 offset:36864
s_add_u32 s35,s35,262144
M v[68:71],v[204:207],a[208:211],v[68:71]
ds_read_b64_tr_b16 v[198:199],v13 offset:37376
M v[100:103],v[204:207],a[212:215],v[100:103]
M v[132:135],v[204:207],a[216:219],v[132:135]
s_waitcnt lgkmcnt(4)
M v[72:75],v[208:211],a[208:211],v[72:75]
ds_read_b64_tr_b16 v[200:201],v14 offset:36864
s_mov_b32 m0,16384
M v[104:107],v[208:211],a[212:215],v[104:107]
ds_read_b64_tr_b16 v[202:203],v14 offset:37376
buffer_load_dwordx4 v21,s[12:15],s48 offen nt lds
M v[136:139],v[208:211],a[216:219],v[136:139]
ds_read_b64_tr_b16 v[204:205],v15 offset:36864
buffer_load_dwordx4 v22,s[12:15],s48 offen offset:1024 nt lds
M v[76:79],v[212:215],a[208:211],v[76:79]
ds_read_b64_tr_b16 v[206:207],v15 offset:37376
buffer_load_dwordx4 v23,s[12:15],s48 offen offset:2048 nt lds
M v[108:111],v[212:215],a[212:215],v[108:111]
buffer_load_dwordx4 v24,s[12:15],s48 offen offset:3072 nt lds
M v[140:143],v[212:215],a[216:219],v[140:143]
s_waitcnt vmcnt(12) lgkmcnt(0)
s_barrier
s_add_u32 s48,s48,4096
s_mov_b32 m0,20480
M v[80:83],v[192:195],a[208:211],v[80:83]
ds_read_b64_tr_b16 v[208:209],v12 offset:40960
buffer_load_dwordx4 v21,s[12:15],s48 offen nt lds
M v[112:115],v[192:195],a[212:215],v[112:115]
ds_read_b64_tr_b16 v[210:211],v12 offset:41472
buffer_load_dwordx4 v22,s[12:15],s48 offen offset:1024 nt lds
M v[144:147],v[192:195],a[216:219],v[144:147]
ds_read_b64_tr_b16 v[212:213],v13 offset:40960
buffer_load_dwordx4 v23,s[12:15],s48 offen offset:2048 nt lds
M v[84:87],v[196:199],a[208:211],v[84:87]
ds_read_b64_tr_b16 v[214:215],v13 offset:41472
buffer_load_dwordx4 v24,s[12:15],s48 offen offset:3072 nt lds
M v[116:119],v[196:199],a[212:215],v[116:119]
s_add_u32 s48,s48,4096
s_mov_b32 m0,24576
M v[148:151],v[196:199],a[216:219],v[148:151]
buffer_load_dwordx4 v21,s[12:15],s48 offen nt lds
M v[88:91],v[200:203],a[208:211],v[88:91]
ds_read_b64_tr_b16 v[192:193],v14 offset:40960
buffer_load_dwordx4 v22,s[12:15],s48 offen offset:1024 nt lds
M v[120:123],v[200:203],a[212:215],v[120:123]
ds_read_b64_tr_b16 v[194:195],v14 offset:41472
buffer_load_dwordx4 v23,s[12:15],s48 offen offset:2048 nt lds
M v[152:155],v[200:203],a[216:219],v[152:155]
ds_read_b64_tr_b16 v[196:197],v15 offset:40960
buffer_load_dwordx4 v24,s[12:15],s48 offen offset:3072 nt lds
M v[92:95],v[204:207],a[208:211],v[92:95]
ds_read_b64_tr_b16 v[198:199],v15 offset:41472
s_add_u32 s48,s48,4096
s_mov_b32 m0,28672
M v[124:127],v[204:207],a[212:215],v[124:127]
buffer_load_dwordx4 v21,s[12:15],s48 offen nt lds
M v[156:159],v[204:207],a[216:219],v[156:159]
s_waitcnt lgkmcnt(4)
buffer_load_dwordx4 v22,s[12:15],s48 offen offset:1024 nt lds
M a[0:3],v[208:211],a[208:211],a[0:3]
ds_read_b64_tr_b16 v[200:201],v12 offset:45056
buffer_load_dwordx4 v23,s[12:15],s48 offen offset:2048 nt lds
M a[32:35],v[208:211],a[212:215],a[32:35]
ds_read_b64_tr_b16 v[202:203],v12 offset:45568
buffer_load_dwordx4 v24,s[12:15],s48 offen offset:3072 nt lds
M a[64:67],v[208:211],a[216:219],a[64:67]
ds_read_b64_tr_b16 v[204:205],v13 offset:45056
s_add_u32 s48,s48,4096
M a[4:7],v[212:215],a[208:211],a[4:7]
ds_read_b64_tr_b16 v[206:207],v13 offset:45568
M a[36:39],v[212:215],a[212:215],a[36:39]
M a[68:71],v[212:215],a[216:219],a[68:71]
s_waitcnt lgkmcnt(4)
M a[8:11],v[192:195],a[208:211],a[8:11]
ds_read_b64_tr_b16 v[208:209],v14 offset:45056
s_cmp_eq_u32 s29,12
s_cbranch_scc0 L_cg15
buffer_atomic_add v5,v4,s[92:95],0 offen
L_cg15:
M a[40:43],v[192:195],a[212:215],a[40:43]
ds_read_b64_tr_b16 v[210:211],v14 offset:45568
M a[72:75],v[192:195],a[216:219],a[72:75]
ds_read_b64_tr_b16 v[212:213],v15 offset:45056
M a[12:15],v[196:199],a[208:211],a[12:15]
ds_read_b64_tr_b16 v[214:215],v15 offset:45568
M a[44:47],v[196:199],a[212:215],a[44:47]
M a[76:79],v[196:199],a[216:219],a[76:79]
s_waitcnt lgkmcnt(0)
s_barrier
M a[16:19],v[200:203],a[208:211],a[16:19]
ds_read_b64_tr_b16 v[192:193],v12
s_mov_b32 m0,90112
M a[48:51],v[200:203],a[212:215],a[48:51]
ds_read_b64_tr_b16 v[194:195],v12 offset:512
buffer_load_dwordx4 v16,s[8:11],s34 offen lds
M a[80:83],v[200:203],a[216:219],a[80:83]
ds_read_b64_tr_b16 v[196:197],v13
buffer_load_dwordx4 v17,s[8:11],s34 offen offset:1024 lds
M a[20:23],v[204:207],a[208:211],a[20:23]
ds_read_b64_tr_b16 v[198:199],v13 offset:512
buffer_load_dwordx4 v18,s[8:11],s34 offen offset:2048 lds
M a[52:55],v[204:207],a[212:215],a[52:55]
ds_read_b128 a[192:195],v11 offset:32768
buffer_load_dwordx4 v19,s[8:11],s34 offen offset:3072 lds
M a[84:87],v[204:207],a[216:219],a[84:87]
ds_read_b128 a[196:199],v11 offset:34816
s_add_u32 s34,s34,262144
M a[24:27],v[208:211],a[208:211],a[24:27]
ds_read_b128 a[200:203],v11 offset:36864
ds_read_b64_tr_b16 v[200:201],v14
M a[56:59],v[208:211],a[212:215],a[56:59]
ds_read_b64_tr_b16 v[202:203],v14 offset:512
M a[88:91],v[208:211],a[216:219],a[88:91]
ds_read_b64_tr_b16 v[204:205],v15
M a[28:31],v[212:215],a[208:211],a[28:31]
ds_read_b64_tr_b16 v[206:207],v15 offset:512
s_mov_b32 m0,94208
M a[60:63],v[212:215],a[212:215],a[60:63]
buffer_load_dwordx4 v16,s[8:11],s35 offen lds
M a[92:95],v[212:215],a[216:219],a[92:95]
s_waitcnt lgkmcnt(4)
buffer_load_dwordx4 v17,s[8:11],s35 offen offset:1024 lds
M v[64:67],v[192:195],a[192:195],v[64:67]
ds_read_b64_tr_b16 v[208:209],v12 offset:4096
buffer_load_dwordx4 v18,s[8:11],s35 offen offset:2048 lds
M v[96:99],v[192:195],a[196:199],v[96:99]
ds_read_b64_tr_b16 v[210:211],v12 offset:4608
buffer_load_dwordx4 v19,s[8:11],s35 offen offset:3072 lds
M v[128:131],v[192:195],a[200:203],v[128:131]
ds_read_b64_tr_b16 v[212:213],v13 offset:4096
s_add_u32 s35,s35,262144
M v[68:71],v[196:199],a[192:195],v[68:71]
ds_read_b64_tr_b16 v[214:215],v13 offset:4608
M v[100:103],v[196:199],a[196:199],v[100:103]
M v[132:135],v[196:199],a[200:203],v[132:135]
s_waitcnt lgkmcnt(4)
M v[72:75],v[200:203],a[192:195],v[72:75]
ds_read_b64_tr_b16 v[192:193],v14 offset:4096
M v[104:107],v[200:203],a[196:199],v[104:107]
ds_read_b64_tr_b16 v[194:195],v14 offset:4608
M v[136:139],v[200:203],a[200:203],v[136:139]
ds_read_b64_tr_b16 v[196:197],v15 offset:4096
M v[76:79],v[204:207],a[192:195],v[76:79]
ds_read_b64_tr_b16 v[198:199],v15 offset:4608
M v[108:111],v[204:207],a[196:199],v[108:111]
M v[140:143],v[204:207],a[200:203],v[140:143]
s_waitcnt vmcnt(24) lgkmcnt(0)
s_barrier
M v[80:83],v[208:211],a[192:195],v[80:83]
ds_read_b64_tr_b16 v[200:201],v12 offset:8192
M v[112:115],v[208:211],a[196:199],v[112:115]
ds_read_b64_tr_b16 v[202:203],v12 offset:8704
M v[144:147],v[208:211],a[200:203],v[144:147]
ds_read_b64_tr_b16 v[204:205],v13 offset:8192
M v[84:87],v[212:215],a[192:195],v[84:87]
ds_read_b64_tr_b16 v[206:207],v13 offset:8704
M v[116:119],v[212:215],a[196:199],v[116:119]
M v[148:151],v[212:215],a[200:203],v[148:151]
M v[88:91],v[192:195],a[192:195],v[88:91]
ds_read_b64_tr_b16 v[208:209],v14 offset:8192
M v[120:123],v[192:195],a[196:199],v[120:123]
ds_read_b64_tr_b16 v[210:211],v14 offset:8704
M v[152:155],v[192:195],a[200:203],v[152:155]
ds_read_b64_tr_b16 v[212:213],v15 offset:8192
M v[92:95],v[196:199],a[192:195],v[92:95]
ds_read_b64_tr_b16 v[214:215],v15 offset:8704
M v[124:127],v[196:199],a[196:199],v[124:127]
M v[156:159],v[196:199],a[200:203],v[156:159]
s_waitcnt lgkmcnt(4)
M a[0:3],v[200:203],a[192:195],a[0:3]
ds_read_b64_tr_b16 v[192:193],v12 offset:12288
s_cmp_eq_u32 s29,13
s_cbranch_scc0 L_cg16
buffer_atomic_add v5,v4,s[92:95],0 offen
L_cg16:
buffer_load_dword v30,v31,s[24:27],0 offen
M a[32:35],v[200:203],a[196:199],a[32:35]
ds_read_b64_tr_b16 v[194:195],v12 offset:12800
M a[64:67],v[200:203],a[200:203],a[64:67]
ds_read_b64_tr_b16 v[196:197],v13 offset:12288
M a[4:7],v[204:207],a[192:195],a[4:7]
ds_read_b64_tr_b16 v[198:199],v13 offset:12800
M a[36:39],v[204:207],a[196:199],a[36:39]
M a[68:71],v[204:207],a[200:203],a[68:71]
s_waitcnt lgkmcnt(4)
M a[8:11],v[208:211],a[192:195],a[8:11]
ds_read_b64_tr_b16 v[200:201],v14 offset:12288
M a[40:43],v[208:211],a[196:199],a[40:43]
ds_read_b64_tr_b16 v[202:203],v14 offset:12800
M a[72:75],v[208:211],a[200:203],a[72:75]
ds_read_b64_tr_b16 v[204:205],v15 offset:12288
M a[12:15],v[212:215],a[192:195],a[12:15]
ds_read_b64_tr_b16 v[206:207],v15 offset:12800
M a[44:47],v[212:215],a[196:199],a[44:47]
M a[76:79],v[212:215],a[200:203],a[76:79]
s_waitcnt lgkmcnt(0)
s_barrier
M a[16:19],v[192:195],a[192:195],a[16:19]
ds_read_b64_tr_b16 v[208:209],v12 offset:32768
s_mov_b32 m0,57344
M a[48:51],v[192:195],a[196:199],a[48:51]
ds_read_b64_tr_b16 v[210:211],v12 offset:33280
buffer_load_dwordx4 v16,s[8:11],s34 offen lds
M a[80:83],v[192:195],a[200:203],a[80:83]
ds_read_b64_tr_b16 v[212:213],v13 offset:32768
buffer_load_dwordx4 v17,s[8:11],s34 offen offset:1024 lds
M a[20:23],v[196:199],a[192:195],a[20:23]
ds_read_b64_tr_b16 v[214:215],v13 offset:33280
buffer_load_dwordx4 v18,s[8:11],s34 offen offset:2048 lds
M a[52:55],v[196:199],a[196:199],a[52:55]
ds_read_b128 a[208:211],v11 offset:33280
buffer_load_dwordx4 v19,s[8:11],s34 offen offset:3072 lds
M a[84:87],v[196:199],a[200:203],a[84:87]
ds_read_b128 a[212:215],v11 offset:35328
s_add_u32 s34,s34,262144
M a[24:27],v[200:203],a[192:195],a[24:27]
ds_read_b128 a[216:219],v11 offset:37376
ds_read_b64_tr_b16 v[192:193],v14 offset:32768
M a[56:59],v[200:203],a[196:199],a[56:59]
ds_read_b64_tr_b16 v[194:195],v14 offset:33280
M a[88:91],v[200:203],a[200:203],a[88:91]
ds_read_b64_tr_b16 v[196:197],v15 offset:32768
M a[28:31],v[204:207],a[192:195],a[28:31]
ds_read_b64_tr_b16 v[198:199],v15 offset:33280
s_mov_b32 m0,61440
M a[60:63],v[204:207],a[196:199],a[60:63]
buffer_load_dwordx4 v16,s[8:11],s35 offen lds
M a[92:95],v[204:207],a[200:203],a[92:95]
s_waitcnt lgkmcnt(4)
buffer_load_dwordx4 v17,s[8:11],s35 offen offset:1024 lds
M v[64:67],v[208:211],a[208:211],v[64:67]
ds_read_b64_tr_b16 v[200:201],v12 offset:36864
buffer_load_dwordx4 v18,s[8:11],s35 offen offset:2048 lds
M v[96:99],v[208:211],a[212:215],v[96:99]
ds_read_b64_tr_b16 v[202:203],v12 offset:37376
buffer_load_dwordx4 v19,s[8:11],s35 offen offset:3072 lds
M v[128:131],v[208:211],a[216:219],v[128:131]
ds_read_b64_tr_b16 v[204:205],v13 offset:36864
s_add_u32 s35,s35,262144
M v[68:71],v[212:215],a[208:211],v[68:71]
ds_read_b64_tr_b16 v[206:207],v13 offset:37376
M v[100:103],v[212:215],a[212:215],v[100:103]
M v[132:135],v[212:215],a[216:219],v[132:135]
s_waitcnt lgkmcnt(4)
M v[72:75],v[192:195],a[208:211],v[72:75]
ds_read_b64_tr_b16 v[208:209],v14 offset:36864
M v[104:107],v[192:195],a[212:215],v[104:107]
ds_read_b64_tr_b16 v[210:211],v14 offset:37376
M v[136:139],v[192:195],a[216:219],v[136:139]
ds_read_b64_tr_b16 v[212:213],v15 offset:36864
M v[76:79],v[196:199],a[208:211],v[76:79]
ds_read_b64_tr_b16 v[214:215],v15 offset:37376
M v[108:111],v[196:199],a[212:215],v[108:111]
M v[140:143],v[196:199],a[216:219],v[140:143]
s_waitcnt vmcnt(9) lgkmcnt(0)
s_barrier
M v[80:83],v[200:203],a[208:211],v[80:83]
ds_read_b64_tr_b16 v[192:193],v12 offset:40960
M v[112:115],v[200:203],a[212:215],v[112:115]
ds_read_b64_tr_b16 v[194:195],v12 offset:41472
M v[144:147],v[200:203],a[216:219],v[144:147]
ds_read_b64_tr_b16 v[196:197],v13 offset:40960
M v[84:87],v[204:207],a[208:211],v[84:87]
ds_read_b64_tr_b16 v[198:199],v13 offset:41472
M v[116:119],v[204:207],a[212:215],v[116:119]
M v[148:151],v[204:207],a[216:219],v[148:151]
s_cmp_eq_u32 s29,14
s_cbranch_scc0 L_cg17
buffer_atomic_add v5,v4,s[92:95],0 offen
L_cg17:
M v[88:91],v[208:211],a[208:211],v[88:91]
ds_read_b64_tr_b16 v[200:201],v14 offset:40960
M v[120:123],v[208:211],a[212:215],v[120:123]
ds_read_b64_tr_b16 v[202:203],v14 offset:41472
M v[152:155],v[208:211],a[216:219],v[152:155]
ds_read_b64_tr_b16 v[204:205],v15 offset:40960
M v[92:95],v[212:215],a[208:211],v[92:95]
ds_read_b64_tr_b16 v[206:207],v15 offset:41472
M v[124:127],v[212:215],a[212:215],v[124:127]
M v[156:159],v[212:215],a[216:219],v[156:159]
s_waitcnt lgkmcnt(4)
M a[0:3],v[192:195],a[208:211],a[0:3]
ds_read_b64_tr_b16 v[208:209],v12 offset:45056
M a[32:35],v[192:195],a[212:215],a[32:35]
ds_read_b64_tr_b16 v[210:211],v12 offset:45568
M a[64:67],v[192:195],a[216:219],a[64:67]
ds_read_b64_tr_b16 v[212:213],v13 offset:45056
M a[4:7],v[196:199],a[208:211],a[4:7]
ds_read_b64_tr_b16 v[214:215],v13 offset:45568
M a[36:39],v[196:199],a[212:215],a[36:39]
M a[68:71],v[196:199],a[216:219],a[68:71]
s_waitcnt lgkmcnt(4)
M a[8:11],v[200:203],a[208:211],a[8:11]
ds_read_b64_tr_b16 v[192:193],v14 offset:45056
M a[40:43],v[200:203],a[212:215],a[40:43]
ds_read_b64_tr_b16 v[194:195],v14 offset:45568
M a[72:75],v[200:203],a[216:219],a[72:75]
ds_read_b64_tr_b16 v[196:197],v15 offset:45056
M a[12:15],v[204:207],a[208:211],a[12:15]
ds_read_b64_tr_b16 v[198:199],v15 offset:45568
M a[44:47],v[204:207],a[212:215],a[44:47]
M a[76:79],v[204:207],a[216:219],a[76:79]
s_waitcnt lgkmcnt(0)
s_barrier
M a[16:19],v[208:211],a[208:211],a[16:19]
ds_read_b64_tr_b16 v[200:201],v12
s_mov_b32 m0,90112
M a[48:51],v[208:211],a[212:215],a[48:51]
ds_read_b64_tr_b16 v[202:203],v12 offset:512
buffer_load_dwordx4 v16,s[8:11],s34 offen lds
M a[80:83],v[208:211],a[216:219],a[80:83]
ds_read_b64_tr_b16 v[204:205],v13
buffer_load_dwordx4 v17,s[8:11],s34 offen offset:1024 lds
M a[20:23],v[212:215],a[208:211],a[20:23]
ds_read_b64_tr_b16 v[206:207],v13 offset:512
buffer_load_dwordx4 v18,s[8:11],s34 offen offset:2048 lds
M a[52:55],v[212:215],a[212:215],a[52:55]
ds_read_b128 a[192:195],v11
buffer_load_dwordx4 v19,s[8:11],s34 offen offset:3072 lds
M a[84:87],v[212:215],a[216:219],a[84:87]
ds_read_b128 a[196:199],v11 offset:2048
s_add_u32 s34,s34,262144
s_mov_b32 m0,32768
M a[24:27],v[192:195],a[208:211],a[24:27]
ds_read_b128 a[200:203],v11 offset:4096
ds_read_b64_tr_b16 v[208:209],v14
buffer_load_dwordx4 v21,s[12:15],s48 offen nt lds
M a[56:59],v[192:195],a[212:215],a[56:59]
ds_read_b64_tr_b16 v[210:211],v14 offset:512
buffer_load_dwordx4 v22,s[12:15],s48 offen offset:1024 nt lds
M a[88:91],v[192:195],a[216:219],a[88:91]
ds_read_b64_tr_b16 v[212:213],v15
buffer_load_dwordx4 v23,s[12:15],s48 offen offset:2048 nt lds
M a[28:31],v[196:199],a[208:211],a[28:31]
ds_read_b64_tr_b16 v[214:215],v15 offset:512
buffer_load_dwordx4 v24,s[12:15],s48 offen offset:3072 nt lds
M a[60:63],v[196:199],a[212:215],a[60:63]
s_add_u32 s48,s48,4096
s_mov_b32 m0,36864
M a[92:95],v[196:199],a[216:219],a[92:95]
s_waitcnt lgkmcnt(4)
buffer_load_dwordx4 v21,s[12:15],s48 offen nt lds
M v[64:67],v[200:203],a[192:195],v[64:67]
ds_read_b64_tr_b16 v[192:193],v12 offset:4096
buffer_load_dwordx4 v22,s[12:15],s48 offen offset:1024 nt lds
M v[96:99],v[200:203],a[196:199],v[96:99]
ds_read_b64_tr_b16 v[194:195],v12 offset:4608
buffer_load_dwordx4 v23,s[12:15],s48 offen offset:2048 nt lds
M v[128:131],v[200:203],a[200:203],v[128:131]
ds_read_b64_tr_b16 v[196:197],v13 offset:4096
buffer_load_dwordx4 v24,s[12:15],s48 offen offset:3072 nt lds
M v[68:71],v[204:207],a[192:195],v[68:71]
ds_read_b64_tr_b16 v[198:199],v13 offset:4608
s_add_u32 s48,s48,4096
s_mov_b32 m0,94208
M v[100:103],v[204:207],a[196:199],v[100:103]
buffer_load_dwordx4 v16,s[8:11],s35 offen lds
M v[132:135],v[204:207],a[200:203],v[132:135]
s_waitcnt lgkmcnt(4)
buffer_load_dwordx4 v17,s[8:11],s35 offen offset:1024 lds
M v[72:75],v[208:211],a[192:195],v[72:75]
ds_read_b64_tr_b16 v[200:201],v14 offset:4096
buffer_load_dwordx4 v18,s[8:11],s35 offen offset:2048 lds
M v[104:107],v[208:211],a[196:199],v[104:107]
ds_read_b64_tr_b16 v[202:203],v14 offset:4608
buffer_load_dwordx4 v19,s[8:11],s35 offen offset:3072 lds
M v[136:139],v[208:211],a[200:203],v[136:139]
ds_read_b64_tr_b16 v[204:205],v15 offset:4096
s_add_u32 s35,s35,262144
s_mov_b32 m0,40960
M v[76:79],v[212:215],a[192:195],v[76:79]
ds_read_b64_tr_b16 v[206:207],v15 offset:4608
buffer_load_dwordx4 v21,s[12:15],s48 offen nt lds
M v[108:111],v[212:215],a[196:199],v[108:111]
buffer_load_dwordx4 v22,s[12:15],s48 offen offset:1024 nt lds
M v[140:143],v[212:215],a[200:203],v[140:143]
s_waitcnt vmcnt(18) lgkmcnt(0)
s_barrier
s_cmp_eq_u32 s29,15
s_cbranch_scc0 L_cg18
buffer_atomic_add v5,v4,s[92:95],0 offen
L_cg18:
buffer_load_dwordx4 v23,s[12:15],s48 offen offset:2048 nt lds
M v[80:83],v[192:195],a[192:195],v[80:83]
ds_read_b64_tr_b16 v[208:209],v12 offset:8192
buffer_load_dwordx4 v24,s[12:15],s48 offen offset:3072 nt lds
M v[112:115],v[192:195],a[196:199],v[112:115]
ds_read_b64_tr_b16 v[210:211],v12 offset:8704
s_add_u32 s48,s48,4096
s_mov_b32 m0,45056
M v[144:147],v[192:195],a[200:203],v[144:147]
ds_read_b64_tr_b16 v[212:213],v13 offset:8192
buffer_load_dwordx4 v21,s[12:15],s48 offen nt lds
M v[84:87],v[196:199],a[192:195],v[84:87]
ds_read_b64_tr_b16 v[214:215],v13 offset:8704
buffer_load_dwordx4 v22,s[12:15],s48 offen offset:1024 nt lds
M v[116:119],v[196:199],a[196:199],v[116:119]
buffer_load_dwordx4 v23,s[12:15],s48 offen offset:2048 nt lds
M v[148:151],v[196:199],a[200:203],v[148:151]
buffer_load_dwordx4 v24,s[12:15],s48 offen offset:3072 nt lds
M v[88:91],v[200:203],a[192:195],v[88:91]
ds_read_b64_tr_b16 v[192:193],v14 offset:8192
s_add_u32 s48,s48,4096
M v[120:123],v[200:203],a[196:199],v[120:123]
ds_read_b64_tr_b16 v[194:195],v14 offset:8704
M v[152:155],v[200:203],a[200:203],v[152:155]
ds_read_b64_tr_b16 v[196:197],v15 offset:8192
M v[92:95],v[204:207],a[192:195],v[92:95]
ds_read_b64_tr_b16 v[198:199],v15 offset:8704
M v[124:127],v[204:207],a[196:199],v[124:127]
M v[156:159],v[204:207],a[200:203],v[156:159]
s_waitcnt lgkmcnt(4)
M a[0:3],v[208:211],a[192:195],a[0:3]
ds_read_b64_tr_b16 v[200:201],v12 offset:12288
M a[32:35],v[208:211],a[196:199],a[32:35]
ds_read_b64_tr_b16 v[202:203],v12 offset:12800
M a[64:67],v[208:211],a[200:203],a[64:67]
ds_read_b64_tr_b16 v[204:205],v13 offset:12288
M a[4:7],v[212:215],a[192:195],a[4:7]
ds_read_b64_tr_b16 v[206:207],v13 offset:12800
M a[36:39],v[212:215],a[196:199],a[36:39]
M a[68:71],v[212:215],a[200:203],a[68:71]
s_waitcnt lgkmcnt(4)
M a[8:11],v[192:195],a[192:195],a[8:11]
ds_read_b64_tr_b16 v[208:209],v14 offset:12288
M a[40:43],v[192:195],a[196:199],a[40:43]
ds_read_b64_tr_b16 v[210:211],v14 offset:12800
M a[72:75],v[192:195],a[200:203],a[72:75]
ds_read_b64_tr_b16 v[212:213],v15 offset:12288
M a[12:15],v[196:199],a[192:195],a[12:15]
ds_read_b64_tr_b16 v[214:215],v15 offset:12800
M a[44:47],v[196:199],a[196:199],a[44:47]
M a[76:79],v[196:199],a[200:203],a[76:79]
s_waitcnt lgkmcnt(0)
s_barrier
M a[16:19],v[200:203],a[192:195],a[16:19]
ds_read_b64_tr_b16 v[192:193],v12 offset:32768
M a[48:51],v[200:203],a[196:199],a[48:51]
ds_read_b64_tr_b16 v[194:195],v12 offset:33280
M a[80:83],v[200:203],a[200:203],a[80:83]
ds_read_b64_tr_b16 v[196:197],v13 offset:32768
M a[20:23],v[204:207],a[192:195],a[20:23]
ds_read_b64_tr_b16 v[198:199],v13 offset:33280
M a[52:55],v[204:207],a[196:199],a[52:55]
ds_read_b128 a[208:211],v11 offset:512
M a[84:87],v[204:207],a[200:203],a[84:87]
ds_read_b128 a[212:215],v11 offset:2560
M a[24:27],v[208:211],a[192:195],a[24:27]
ds_read_b128 a[216:219],v11 offset:4608
ds_read_b64_tr_b16 v[200:201],v14 offset:32768
M a[56:59],v[208:211],a[196:199],a[56:59]
ds_read_b64_tr_b16 v[202:203],v14 offset:33280
M a[88:91],v[208:211],a[200:203],a[88:91]
ds_read_b64_tr_b16 v[204:205],v15 offset:32768
M a[28:31],v[212:215],a[192:195],a[28:31]
ds_read_b64_tr_b16 v[206:207],v15 offset:33280
M a[60:63],v[212:215],a[196:199],a[60:63]
M a[92:95],v[212:215],a[200:203],a[92:95]
s_waitcnt lgkmcnt(4)
M v[64:67],v[192:195],a[208:211],v[64:67]
ds_read_b64_tr_b16 v[208:209],v12 offset:36864
s_mov_b32 m0,65536
M v[96:99],v[192:195],a[212:215],v[96:99]
ds_read_b64_tr_b16 v[210:211],v12 offset:37376
buffer_load_dwordx4 v25,s[16:19],s49 offen nt lds
M v[128:131],v[192:195],a[216:219],v[128:131]
ds_read_b64_tr_b16 v[212:213],v13 offset:36864
buffer_load_dwordx4 v26,s[16:19],s49 offen offset:1024 nt lds
M v[68:71],v[196:199],a[208:211],v[68:71]
ds_read_b64_tr_b16 v[214:215],v13 offset:37376
buffer_load_dwordx4 v25,s[16:19],s49 offen offset:2048 nt lds
M v[100:103],v[196:199],a[212:215],v[100:103]
buffer_load_dwordx4 v26,s[16:19],s49 offen offset:3072 nt lds
v_mul_f32 v64,s52,v64
M v[132:135],v[196:199],a[216:219],v[132:135]
s_waitcnt lgkmcnt(4)
s_add_u32 s49,s49,4096
s_mov_b32 m0,69632
M v[72:75],v[200:203],a[208:211],v[72:75]
ds_read_b64_tr_b16 v[192:193],v14 offset:36864
buffer_load_dwordx4 v25,s[16:19],s49 offen nt lds
M v[104:107],v[200:203],a[212:215],v[104:107]
ds_read_b64_tr_b16 v[194:195],v14 offset:37376
buffer_load_dwordx4 v26,s[16:19],s49 offen offset:1024 nt lds
M v[136:139],v[200:203],a[216:219],v[136:139]
ds_read_b64_tr_b16 v[196:197],v15 offset:36864
buffer_load_dwordx4 v25,s[16:19],s49 offen offset:2048 nt lds
M v[76:79],v[204:207],a[208:211],v[76:79]
ds_read_b64_tr_b16 v[198:199],v15 offset:37376
buffer_load_dwordx4 v26,s[16:19],s49 offen offset:3072 nt lds
M v[108:111],v[204:207],a[212:215],v[108:111]
s_add_u32 s49,s49,4096
s_mov_b32 m0,73728
M v[140:143],v[204:207],a[216:219],v[140:143]
s_waitcnt vmcnt(16) lgkmcnt(0)
s_barrier
buffer_load_dwordx4 v25,s[16:19],s49 offen nt lds
M v[80:83],v[208:211],a[208:211],v[80:83]
ds_read_b64_tr_b16 v[200:201],v12 offset:40960
buffer_load_dwordx4 v26,s[16:19],s49 offen offset:1024 nt lds
M v[112:115],v[208:211],a[212:215],v[112:115]
ds_read_b64_tr_b16 v[202:203],v12 offset:41472
buffer_load_dwordx4 v25,s[16:19],s49 offen offset:2048 nt lds
M v[144:147],v[208:211],a[216:219],v[144:147]
ds_read_b64_tr_b16 v[204:205],v13 offset:40960
buffer_load_dwordx4 v26,s[16:19],s49 offen offset:3072 nt lds
M v[84:87],v[212:215],a[208:211],v[84:87]
ds_read_b64_tr_b16 v[206:207],v13 offset:41472
s_add_u32 s49,s49,4096
s_mov_b32 m0,77824
M v[116:119],v[212:215],a[212:215],v[116:119]
buffer_load_dwordx4 v25,s[16:19],s49 offen nt lds
v_mul_f32 v65,s52,v65
M v[148:151],v[212:215],a[216:219],v[148:151]
buffer_load_dwordx4 v26,s[16:19],s49 offen offset:1024 nt lds
M v[88:91],v[192:195],a[208:211],v[88:91]
ds_read_b64_tr_b16 v[208:209],v14 offset:40960
buffer_load_dwordx4 v25,s[16:19],s49 offen offset:2048 nt lds
M v[120:123],v[192:195],a[212:215],v[120:123]
ds_read_b64_tr_b16 v[210:211],v14 offset:41472
buffer_load_dwordx4 v26,s[16:19],s49 offen offset:3072 nt lds
M v[152:155],v[192:195],a[216:219],v[152:155]
ds_read_b64_tr_b16 v[212:213],v15 offset:40960
s_add_u32 s49,s49,4096
M v[92:95],v[196:199],a[208:211],v[92:95]
ds_read_b64_tr_b16 v[214:215],v15 offset:41472
v_mul_f32 v66,s52,v66
M v[124:127],v[196:199],a[212:215],v[124:127]
v_mul_f32 v67,s52,v67
v_mul_f32 v68,s52,v68
M v[156:159],v[196:199],a[216:219],v[156:159]
s_waitcnt lgkmcnt(4)
v_mul_f32 v69,s52,v69
M a[0:3],v[200:203],a[208:211],a[0:3]
ds_read_b64_tr_b16 v[192:193],v12 offset:45056
v_mul_f32 v70,s52,v70
M a[32:35],v[200:203],a[212:215],a[32:35]
ds_read_b64_tr_b16 v[194:195],v12 offset:45568
v_mul_f32 v71,s52,v71
M a[64:67],v[200:203],a[216:219],a[64:67]
ds_read_b64_tr_b16 v[196:197],v13 offset:45056
v_cvt_pk_bf16_f32 v244,v64,v65
M a[4:7],v[204:207],a[208:211],a[4:7]
ds_read_b64_tr_b16 v[198:199],v13 offset:45568
v_cvt_pk_bf16_f32 v245,v66,v67
M a[36:39],v[204:207],a[212:215],a[36:39]
v_cvt_pk_bf16_f32 v246,v68,v69
v_cvt_pk_bf16_f32 v247,v70,v71
M a[68:71],v[204:207],a[216:219],a[68:71]
s_waitcnt lgkmcnt(4)
v_accvgpr_write_b32 a128,v244
M a[8:11],v[208:211],a[208:211],a[8:11]
ds_read_b64_tr_b16 v[200:201],v14 offset:45056
v_accvgpr_write_b32 a129,v245
M a[40:43],v[208:211],a[212:215],a[40:43]
ds_read_b64_tr_b16 v[202:203],v14 offset:45568
v_accvgpr_write_b32 a130,v246
M a[72:75],v[208:211],a[216:219],a[72:75]
ds_read_b64_tr_b16 v[204:205],v15 offset:45056
v_accvgpr_write_b32 a131,v247
M a[12:15],v[212:215],a[208:211],a[12:15]
ds_read_b64_tr_b16 v[206:207],v15 offset:45568
v_mul_f32 v96,s52,v96
M a[44:47],v[212:215],a[212:215],a[44:47]
v_mul_f32 v97,s52,v97
v_mul_f32 v98,s52,v98
M a[76:79],v[212:215],a[216:219],a[76:79]
s_waitcnt lgkmcnt(0)
s_barrier
M a[16:19],v[192:195],a[208:211],a[16:19]
ds_read_b128 v[32:35],v8
s_mov_b32 m0,49152
M a[48:51],v[192:195],a[212:215],a[48:51]
ds_read_b128 v[36:39],v8 offset:256
buffer_load_dwordx4 v21,s[12:15],s48 offen nt lds
M a[80:83],v[192:195],a[216:219],a[80:83]
ds_read_b128 v[40:43],v8 offset:512
buffer_load_dwordx4 v22,s[12:15],s48 offen offset:1024 nt lds
M a[20:23],v[196:199],a[208:211],a[20:23]
ds_read_b128 v[44:47],v8 offset:768
v_mul_f32 v99,s52,v99
M a[52:55],v[196:199],a[212:215],a[52:55]
buffer_load_dwordx4 v23,s[12:15],s48 offen offset:2048 nt lds
v_mul_f32 v100,s52,v100
M a[84:87],v[196:199],a[216:219],a[84:87]
v_mul_f32 v101,s52,v101
M a[24:27],v[200:203],a[208:211],a[24:27]
buffer_load_dwordx4 v24,s[12:15],s48 offen offset:3072 nt lds
s_add_u32 s48,s48,4096
M a[56:59],v[200:203],a[212:215],a[56:59]
s_mov_b32 m0,53248
v_mul_f32 v102,s52,v102
M a[88:91],v[200:203],a[216:219],a[88:91]
buffer_load_dwordx4 v21,s[12:15],s48 offen nt lds
v_mul_f32 v103,s52,v103
M a[28:31],v[204:207],a[208:211],a[28:31]
v_cvt_pk_bf16_f32 v248,v96,v97
v_cvt_pk_bf16_f32 v249,v98,v99
M a[60:63],v[204:207],a[212:215],a[60:63]
buffer_load_dwordx4 v22,s[12:15],s48 offen offset:1024 nt lds
v_cvt_pk_bf16_f32 v250,v100,v101
M a[92:95],v[204:207],a[216:219],a[92:95]
s_waitcnt lgkmcnt(0)
v_cvt_pk_bf16_f32 v251,v102,v103
M v[64:67],v[32:35],a[128:131],0
ds_read_b128 v[48:51],v8 offset:4096
buffer_load_dwordx4 v23,s[12:15],s48 offen offset:2048 nt lds
v_accvgpr_write_b32 a144,v248
v_mul_f32 v72,s52,v72
v_mul_f32 v73,s52,v73
v_cvt_pk_bf16_f32 v248,v72,v73
v_accvgpr_write_b32 a132,v248
v_accvgpr_write_b32 a145,v249
v_mul_f32 v74,s52,v74
v_mul_f32 v75,s52,v75
v_cvt_pk_bf16_f32 v249,v74,v75
v_accvgpr_write_b32 a133,v249
v_accvgpr_write_b32 a146,v250
v_mul_f32 v76,s52,v76
v_mul_f32 v77,s52,v77
v_cvt_pk_bf16_f32 v250,v76,v77
v_accvgpr_write_b32 a134,v250
v_accvgpr_write_b32 a147,v251
v_mul_f32 v78,s52,v78
v_mul_f32 v79,s52,v79
v_cvt_pk_bf16_f32 v251,v78,v79
v_accvgpr_write_b32 a135,v251
s_nop 1
M v[64:67],v[36:39],a[132:135],v[64:67]
buffer_load_dwordx4 v24,s[12:15],s48 offen offset:3072 nt lds
s_add_u32 s48,s48,4096
v_mul_f32 v128,s52,v128
v_mul_f32 v129,s52,v129
v_cvt_pk_bf16_f32 v244,v128,v129
v_accvgpr_write_b32 a160,v244
v_mul_f32 v104,s52,v104
v_mul_f32 v105,s52,v105
v_cvt_pk_bf16_f32 v244,v104,v105
v_accvgpr_write_b32 a148,v244
v_mul_f32 v80,s52,v80
v_mul_f32 v81,s52,v81
v_cvt_pk_bf16_f32 v244,v80,v81
v_accvgpr_write_b32 a136,v244
v_mul_f32 v130,s52,v130
v_mul_f32 v131,s52,v131
v_cvt_pk_bf16_f32 v245,v130,v131
v_accvgpr_write_b32 a161,v245
v_mul_f32 v106,s52,v106
v_mul_f32 v107,s52,v107
v_cvt_pk_bf16_f32 v245,v106,v107
v_accvgpr_write_b32 a149,v245
v_mul_f32 v82,s52,v82
v_mul_f32 v83,s52,v83
v_cvt_pk_bf16_f32 v245,v82,v83
v_accvgpr_write_b32 a137,v245
v_mul_f32 v132,s52,v132
v_mul_f32 v133,s52,v133
v_cvt_pk_bf16_f32 v246,v132,v133
v_accvgpr_write_b32 a162,v246
v_mul_f32 v108,s52,v108
v_mul_f32 v109,s52,v109
v_cvt_pk_bf16_f32 v246,v108,v109
v_accvgpr_write_b32 a150,v246
v_mul_f32 v84,s52,v84
v_mul_f32 v85,s52,v85
v_cvt_pk_bf16_f32 v246,v84,v85
v_accvgpr_write_b32 a138,v246
v_mul_f32 v134,s52,v134
v_mul_f32 v135,s52,v135
v_cvt_pk_bf16_f32 v247,v134,v135
v_accvgpr_write_b32 a163,v247
v_mul_f32 v110,s52,v110
v_mul_f32 v111,s52,v111
v_cvt_pk_bf16_f32 v247,v110,v111
v_accvgpr_write_b32 a151,v247
v_mul_f32 v86,s52,v86
v_mul_f32 v87,s52,v87
v_cvt_pk_bf16_f32 v247,v86,v87
v_accvgpr_write_b32 a139,v247
s_nop 1
M v[64:67],v[40:43],a[136:139],v[64:67]
ds_read_b128 v[52:55],v8 offset:4352
s_mov_b32 m0,57344
v_mul_f32 v136,s52,v136
v_mul_f32 v137,s52,v137
v_cvt_pk_bf16_f32 v248,v136,v137
v_accvgpr_write_b32 a164,v248
v_mul_f32 v112,s52,v112
v_mul_f32 v113,s52,v113
v_cvt_pk_bf16_f32 v248,v112,v113
v_accvgpr_write_b32 a152,v248
v_mul_f32 v88,s52,v88
v_mul_f32 v89,s52,v89
v_cvt_pk_bf16_f32 v248,v88,v89
v_accvgpr_write_b32 a140,v248
v_mul_f32 v138,s52,v138
v_mul_f32 v139,s52,v139
v_cvt_pk_bf16_f32 v249,v138,v139
v_accvgpr_write_b32 a165,v249
v_mul_f32 v114,s52,v114
v_mul_f32 v115,s52,v115
v_cvt_pk_bf16_f32 v249,v114,v115
v_accvgpr_write_b32 a153,v249
v_mul_f32 v90,s52,v90
v_mul_f32 v91,s52,v91
v_cvt_pk_bf16_f32 v249,v90,v91
v_accvgpr_write_b32 a141,v249
v_mul_f32 v140,s52,v140
v_mul_f32 v141,s52,v141
v_cvt_pk_bf16_f32 v250,v140,v141
v_accvgpr_write_b32 a166,v250
v_mul_f32 v116,s52,v116
v_mul_f32 v117,s52,v117
v_cvt_pk_bf16_f32 v250,v116,v117
v_accvgpr_write_b32 a154,v250
v_mul_f32 v92,s52,v92
v_mul_f32 v93,s52,v93
v_cvt_pk_bf16_f32 v250,v92,v93
v_accvgpr_write_b32 a142,v250
v_mul_f32 v142,s52,v142
v_mul_f32 v143,s52,v143
v_cvt_pk_bf16_f32 v251,v142,v143
v_accvgpr_write_b32 a167,v251
v_mul_f32 v118,s52,v118
v_mul_f32 v119,s52,v119
v_cvt_pk_bf16_f32 v251,v118,v119
v_accvgpr_write_b32 a155,v251
v_mul_f32 v94,s52,v94
v_mul_f32 v95,s52,v95
v_cvt_pk_bf16_f32 v251,v94,v95
v_accvgpr_write_b32 a143,v251
s_nop 1
M v[64:67],v[44:47],a[140:143],v[64:67]
buffer_load_dwordx4 v21,s[12:15],s48 offen nt lds
v_mul_f32 v144,s52,v144
M v[68:71],v[32:35],a[144:147],0
ds_read_b128 v[56:59],v8 offset:4608
v_mul_f32 v145,s52,v145
M v[68:71],v[36:39],a[148:151],v[68:71]
buffer_load_dwordx4 v22,s[12:15],s48 offen offset:1024 nt lds
v_mul_f32 v146,s52,v146
M v[68:71],v[40:43],a[152:155],v[68:71]
ds_read_b128 v[60:63],v8 offset:4864
v_mul_f32 v147,s52,v147
v_cvt_pk_bf16_f32 v244,v144,v145
v_accvgpr_write_b32 a168,v244
v_mul_f32 v120,s52,v120
v_mul_f32 v121,s52,v121
v_cvt_pk_bf16_f32 v244,v120,v121
v_accvgpr_write_b32 a156,v244
v_cvt_pk_bf16_f32 v245,v146,v147
v_accvgpr_write_b32 a169,v245
v_mul_f32 v122,s52,v122
v_mul_f32 v123,s52,v123
v_cvt_pk_bf16_f32 v245,v122,v123
v_accvgpr_write_b32 a157,v245
v_mul_f32 v148,s52,v148
v_mul_f32 v149,s52,v149
v_cvt_pk_bf16_f32 v246,v148,v149
v_accvgpr_write_b32 a170,v246
v_mul_f32 v124,s52,v124
v_mul_f32 v125,s52,v125
v_cvt_pk_bf16_f32 v246,v124,v125
v_accvgpr_write_b32 a158,v246
v_mul_f32 v150,s52,v150
v_mul_f32 v151,s52,v151
v_cvt_pk_bf16_f32 v247,v150,v151
v_accvgpr_write_b32 a171,v247
v_mul_f32 v126,s52,v126
v_mul_f32 v127,s52,v127
v_cvt_pk_bf16_f32 v247,v126,v127
v_accvgpr_write_b32 a159,v247
s_nop 1
M v[68:71],v[44:47],a[156:159],v[68:71]
buffer_load_dwordx4 v23,s[12:15],s48 offen offset:2048 nt lds
v_mul_f32 v152,s52,v152
M v[72:75],v[32:35],a[160:163],0
v_exp_f32 v64,v64
M v[72:75],v[36:39],a[164:167],v[72:75]
buffer_load_dwordx4 v24,s[12:15],s48 offen offset:3072 nt lds
s_add_u32 s48,s48,4096
M v[72:75],v[40:43],a[168:171],v[72:75]
s_mov_b32 m0,61440
v_mul_f32 v153,s52,v153
v_cvt_pk_bf16_f32 v248,v152,v153
v_accvgpr_write_b32 a172,v248
v_mul_f32 v154,s52,v154
v_mul_f32 v155,s52,v155
v_cvt_pk_bf16_f32 v249,v154,v155
v_accvgpr_write_b32 a173,v249
v_mul_f32 v156,s52,v156
v_mul_f32 v157,s52,v157
v_cvt_pk_bf16_f32 v250,v156,v157
v_accvgpr_write_b32 a174,v250
v_mul_f32 v158,s52,v158
v_mul_f32 v159,s52,v159
v_cvt_pk_bf16_f32 v251,v158,v159
v_accvgpr_write_b32 a175,v251
s_nop 1
M v[72:75],v[44:47],a[172:175],v[72:75]
buffer_load_dwordx4 v21,s[12:15],s48 offen nt lds
s_waitcnt lgkmcnt(0)
M v[80:83],v[48:51],a[128:131],0
ds_read_b128 v[32:35],v8 offset:8192
buffer_load_dwordx4 v22,s[12:15],s48 offen offset:1024 nt lds
M v[80:83],v[52:55],a[132:135],v[80:83]
v_exp_f32 v65,v65
M v[80:83],v[56:59],a[136:139],v[80:83]
ds_read_b128 v[36:39],v8 offset:8448
buffer_load_dwordx4 v23,s[12:15],s48 offen offset:2048 nt lds
M v[80:83],v[60:63],a[140:143],v[80:83]
v_exp_f32 v66,v66
M v[84:87],v[48:51],a[144:147],0
ds_read_b128 v[40:43],v8 offset:8704
buffer_load_dwordx4 v24,s[12:15],s48 offen offset:3072 nt lds
s_add_u32 s48,s48,4096
M v[84:87],v[52:55],a[148:151],v[84:87]
s_mov_b32 m0,81920
v_mov_b32 v176,0x3f803f80
M v[84:87],v[56:59],a[152:155],v[84:87]
ds_read_b128 v[44:47],v8 offset:8960
buffer_load_dwordx4 v25,s[16:19],s49 offen nt lds
M v[84:87],v[60:63],a[156:159],v[84:87]
v_exp_f32 v67,v67
M v[88:91],v[48:51],a[160:163],0
buffer_load_dwordx4 v26,s[16:19],s49 offen offset:1024 nt lds
v_mov_b32 v177,0x3f803f80
M v[88:91],v[52:55],a[164:167],v[88:91]
v_exp_f32 v68,v68
M v[88:91],v[56:59],a[168:171],v[88:91]
buffer_load_dwordx4 v25,s[16:19],s49 offen offset:2048 nt lds
v_mov_b32 v178,0x3f803f80
M v[88:91],v[60:63],a[172:175],v[88:91]
s_waitcnt lgkmcnt(0)
v_mov_b32 v179,0x3f803f80
M v[96:99],v[32:35],a[128:131],0
ds_read_b128 v[48:51],v8 offset:12288
buffer_load_dwordx4 v26,s[16:19],s49 offen offset:3072 nt lds
s_add_u32 s49,s49,4096
s_mov_b32 m0,86016
M v[96:99],v[36:39],a[132:135],v[96:99]
buffer_load_dwordx4 v25,s[16:19],s49 offen nt lds
v_cvt_pk_bf16_f32 v192,v64,v65
M v[96:99],v[40:43],a[136:139],v[96:99]
ds_read_b128 v[52:55],v8 offset:12544
v_cvt_pk_bf16_f32 v193,v66,v67
M v[96:99],v[44:47],a[140:143],v[96:99]
buffer_load_dwordx4 v26,s[16:19],s49 offen offset:1024 nt lds
M v[100:103],v[32:35],a[144:147],0
ds_read_b128 v[56:59],v8 offset:12800
M v[100:103],v[36:39],a[148:151],v[100:103]
buffer_load_dwordx4 v25,s[16:19],s49 offen offset:2048 nt lds
M v[100:103],v[40:43],a[152:155],v[100:103]
ds_read_b128 v[60:63],v8 offset:13056
M v[100:103],v[44:47],a[156:159],v[100:103]
buffer_load_dwordx4 v26,s[16:19],s49 offen offset:3072 nt lds
s_add_u32 s49,s49,4096
M v[104:107],v[32:35],a[160:163],0
s_mov_b32 m0,90112
M v[104:107],v[36:39],a[164:167],v[104:107]
buffer_load_dwordx4 v25,s[16:19],s49 offen nt lds
M v[104:107],v[40:43],a[168:171],v[104:107]
v_exp_f32 v69,v69
M v[104:107],v[44:47],a[172:175],v[104:107]
buffer_load_dwordx4 v26,s[16:19],s49 offen offset:1024 nt lds
s_waitcnt lgkmcnt(0)
M v[112:115],v[48:51],a[128:131],0
ds_read_b128 v[32:35],v8 offset:16384
buffer_load_dwordx4 v25,s[16:19],s49 offen offset:2048 nt lds
M v[112:115],v[52:55],a[132:135],v[112:115]
v_exp_f32 v70,v70
M v[112:115],v[56:59],a[136:139],v[112:115]
ds_read_b128 v[36:39],v8 offset:16640
buffer_load_dwordx4 v26,s[16:19],s49 offen offset:3072 nt lds
s_add_u32 s49,s49,4096
M v[112:115],v[60:63],a[140:143],v[112:115]
s_mov_b32 m0,94208
v_cvt_pk_bf16_f32 v200,v68,v69
M v[116:119],v[48:51],a[144:147],0
ds_read_b128 v[40:43],v8 offset:16896
buffer_load_dwordx4 v25,s[16:19],s49 offen nt lds
M v[116:119],v[52:55],a[148:151],v[116:119]
v_exp_f32 v71,v71
M v[116:119],v[56:59],a[152:155],v[116:119]
ds_read_b128 v[44:47],v8 offset:17152
buffer_load_dwordx4 v26,s[16:19],s49 offen offset:1024 nt lds
M v[116:119],v[60:63],a[156:159],v[116:119]
v_exp_f32 v72,v72
M v[120:123],v[48:51],a[160:163],0
buffer_load_dwordx4 v25,s[16:19],s49 offen offset:2048 nt lds
v_cvt_pk_bf16_f32 v201,v70,v71
M v[120:123],v[52:55],a[164:167],v[120:123]
v_exp_f32 v73,v73
M v[120:123],v[56:59],a[168:171],v[120:123]
buffer_load_dwordx4 v26,s[16:19],s49 offen offset:3072 nt lds
s_add_u32 s49,s49,4096
M v[120:123],v[60:63],a[172:175],v[120:123]
s_waitcnt lgkmcnt(0)
v_cvt_pk_bf16_f32 v208,v72,v73
M v[128:131],v[32:35],a[128:131],0
ds_read_b128 v[48:51],v8 offset:20480
M v[128:131],v[36:39],a[132:135],v[128:131]
v_exp_f32 v74,v74
M v[128:131],v[40:43],a[136:139],v[128:131]
ds_read_b128 v[52:55],v8 offset:20736
M v[128:131],v[44:47],a[140:143],v[128:131]
v_exp_f32 v75,v75
M v[132:135],v[32:35],a[144:147],0
ds_read_b128 v[56:59],v8 offset:20992
v_cvt_pk_bf16_f32 v209,v74,v75
M v[132:135],v[36:39],a[148:151],v[132:135]
v_exp_f32 v80,v80
M v[132:135],v[40:43],a[152:155],v[132:135]
ds_read_b128 v[60:63],v8 offset:21248
M v[132:135],v[44:47],a[156:159],v[132:135]
v_exp_f32 v81,v81
M v[136:139],v[32:35],a[160:163],0
v_exp_f32 v82,v82
M v[136:139],v[36:39],a[164:167],v[136:139]
v_exp_f32 v83,v83
M v[136:139],v[40:43],a[168:171],v[136:139]
v_exp_f32 v84,v84
M v[136:139],v[44:47],a[172:175],v[136:139]
s_waitcnt lgkmcnt(0)
v_cvt_pk_bf16_f32 v194,v80,v81
M v[144:147],v[48:51],a[128:131],0
ds_read_b128 v[32:35],v8 offset:24576
v_cvt_pk_bf16_f32 v195,v82,v83
M v[144:147],v[52:55],a[132:135],v[144:147]
v_exp_f32 v85,v85
M v[144:147],v[56:59],a[136:139],v[144:147]
ds_read_b128 v[36:39],v8 offset:24832
v_cvt_pk_bf16_f32 v202,v84,v85
M v[144:147],v[60:63],a[140:143],v[144:147]
v_exp_f32 v86,v86
M v[148:151],v[48:51],a[144:147],0
ds_read_b128 v[40:43],v8 offset:25088
v_accvgpr_read_b32 v180,a0
M v[148:151],v[52:55],a[148:151],v[148:151]
v_exp_f32 v87,v87
M v[148:151],v[56:59],a[152:155],v[148:151]
ds_read_b128 v[44:47],v8 offset:25344
v_cvt_pk_bf16_f32 v203,v86,v87
M v[148:151],v[60:63],a[156:159],v[148:151]
v_exp_f32 v88,v88
M v[152:155],v[48:51],a[160:163],0
v_exp_f32 v89,v89
M v[152:155],v[52:55],a[164:167],v[152:155]
v_exp_f32 v90,v90
M v[152:155],v[56:59],a[168:171],v[152:155]
v_exp_f32 v91,v91
M v[152:155],v[60:63],a[172:175],v[152:155]
s_waitcnt lgkmcnt(0)
v_cvt_pk_bf16_f32 v210,v88,v89
M v[64:67],v[32:35],a[128:131],0
ds_read_b128 v[48:51],v8 offset:28672
v_cvt_pk_bf16_f32 v211,v90,v91
M v[64:67],v[36:39],a[132:135],v[64:67]
v_exp_f32 v96,v96
M v[64:67],v[40:43],a[136:139],v[64:67]
ds_read_b128 v[52:55],v8 offset:28928
v_accvgpr_read_b32 v181,a1
M v[64:67],v[44:47],a[140:143],v[64:67]
v_exp_f32 v97,v97
M v[68:71],v[32:35],a[144:147],0
ds_read_b128 v[56:59],v8 offset:29184
v_cvt_pk_bf16_f32 v196,v96,v97
M v[68:71],v[36:39],a[148:151],v[68:71]
v_exp_f32 v98,v98
M v[68:71],v[40:43],a[152:155],v[68:71]
ds_read_b128 v[60:63],v8 offset:29440
v_accvgpr_read_b32 v182,a2
M v[68:71],v[44:47],a[156:159],v[68:71]
v_exp_f32 v99,v99
M v[72:75],v[32:35],a[160:163],0
v_exp_f32 v100,v100
M v[72:75],v[36:39],a[164:167],v[72:75]
v_exp_f32 v101,v101
M v[72:75],v[40:43],a[168:171],v[72:75]
v_exp_f32 v102,v102
M v[72:75],v[44:47],a[172:175],v[72:75]
s_waitcnt vmcnt(32) lgkmcnt(0)
s_barrier
M v[80:83],v[48:51],a[128:131],0
ds_read_b128 v[32:35],v8 offset:32768
s_mov_b32 m0,0
M v[80:83],v[52:55],a[132:135],v[80:83]
buffer_load_dwordx4 v21,s[12:15],s48 offen nt lds
v_cvt_pk_bf16_f32 v197,v98,v99
M v[80:83],v[56:59],a[136:139],v[80:83]
ds_read_b128 v[36:39],v8 offset:33024
buffer_load_dwordx4 v22,s[12:15],s48 offen offset:1024 nt lds
M v[80:83],v[60:63],a[140:143],v[80:83]
v_exp_f32 v103,v103
M v[84:87],v[48:51],a[144:147],0
ds_read_b128 v[40:43],v8 offset:33280
buffer_load_dwordx4 v23,s[12:15],s48 offen offset:2048 nt lds
M v[84:87],v[52:55],a[148:151],v[84:87]
v_exp_f32 v104,v104
M v[84:87],v[56:59],a[152:155],v[84:87]
ds_read_b128 v[44:47],v8 offset:33536
buffer_load_dwordx4 v24,s[12:15],s48 offen offset:3072 nt lds
s_add_u32 s48,s48,4096
M v[84:87],v[60:63],a[156:159],v[84:87]
s_mov_b32 m0,4096
v_cvt_pk_bf16_f32 v204,v100,v101
M v[88:91],v[48:51],a[160:163],0
buffer_load_dwordx4 v21,s[12:15],s48 offen nt lds
v_cvt_pk_bf16_f32 v205,v102,v103
M v[88:91],v[52:55],a[164:167],v[88:91]
v_exp_f32 v105,v105
M v[88:91],v[56:59],a[168:171],v[88:91]
buffer_load_dwordx4 v22,s[12:15],s48 offen offset:1024 nt lds
v_cvt_pk_bf16_f32 v212,v104,v105
M v[88:91],v[60:63],a[172:175],v[88:91]
s_waitcnt lgkmcnt(0)
v_accvgpr_read_b32 v183,a3
M v[96:99],v[32:35],a[128:131],0
ds_read_b64_tr_b16 v[48:49],v9
ds_read_b64_tr_b16 v[50:51],v9 offset:4096
buffer_load_dwordx4 v23,s[12:15],s48 offen offset:2048 nt lds
M v[96:99],v[36:39],a[132:135],v[96:99]
ds_read_b64_tr_b16 v[52:53],v9 offset:8192
ds_read_b64_tr_b16 v[54:55],v9 offset:12288
M v[96:99],v[40:43],a[136:139],v[96:99]
ds_read_b64_tr_b16 v[56:57],v10
buffer_load_dwordx4 v24,s[12:15],s48 offen offset:3072 nt lds
s_add_u32 s48,s48,4096
M v[96:99],v[44:47],a[140:143],v[96:99]
ds_read_b64_tr_b16 v[58:59],v10 offset:4096
ds_read_b64_tr_b16 v[60:61],v10 offset:8192
s_mov_b32 m0,8192
M v[100:103],v[32:35],a[144:147],0
ds_read_b64_tr_b16 v[62:63],v10 offset:12288
buffer_load_dwordx4 v21,s[12:15],s48 offen nt lds
M v[100:103],v[36:39],a[148:151],v[100:103]
v_exp_f32 v106,v106
M v[100:103],v[40:43],a[152:155],v[100:103]
buffer_load_dwordx4 v22,s[12:15],s48 offen offset:1024 nt lds
v_accvgpr_read_b32 v184,a4
M v[100:103],v[44:47],a[156:159],v[100:103]
buffer_load_dwordx4 v23,s[12:15],s48 offen offset:2048 nt lds
v_accvgpr_read_b32 v185,a5
v_exp_f32 v107,v107
s_nop 0
v_cvt_pk_bf16_f32 v213,v106,v107
M v[104:107],v[32:35],a[160:163],0
v_exp_f32 v112,v112
M v[104:107],v[36:39],a[164:167],v[104:107]
buffer_load_dwordx4 v24,s[12:15],s48 offen offset:3072 nt lds
s_add_u32 s48,s48,4096
M v[104:107],v[40:43],a[168:171],v[104:107]
s_mov_b32 m0,12288
v_accvgpr_read_b32 v186,a6
M v[104:107],v[44:47],a[172:175],v[104:107]
buffer_load_dwordx4 v21,s[12:15],s48 offen nt lds
s_waitcnt lgkmcnt(0)
M a[0:3],v[48:51],v[192:195],0
ds_read_b128 v[32:35],v8 offset:36864
v_accvgpr_read_b32 v187,a7
v_exp_f32 v113,v113
s_nop 0
v_cvt_pk_bf16_f32 v198,v112,v113
v_exp_f32 v114,v114
v_exp_f32 v115,v115
s_nop 0
v_cvt_pk_bf16_f32 v199,v114,v115
s_nop 1
M a[0:3],v[52:55],v[196:199],a[0:3]
buffer_load_dwordx4 v22,s[12:15],s48 offen offset:1024 nt lds
v_mul_f32 v180,s52,v180
v_mul_f32 v181,s52,v181
v_cvt_pk_bf16_f32 v188,v180,v181
v_accvgpr_read_b32 v180,a32
v_accvgpr_read_b32 v181,a33
v_mul_f32 v182,s52,v182
v_mul_f32 v183,s52,v183
v_cvt_pk_bf16_f32 v189,v182,v183
v_accvgpr_read_b32 v182,a34
v_accvgpr_read_b32 v183,a35
M a[32:35],v[48:51],v[200:203],0
ds_read_b128 v[36:39],v8 offset:37120
v_mul_f32 v184,s52,v184
v_exp_f32 v116,v116
v_exp_f32 v117,v117
s_nop 0
v_cvt_pk_bf16_f32 v206,v116,v117
v_exp_f32 v118,v118
v_exp_f32 v119,v119
s_nop 0
v_cvt_pk_bf16_f32 v207,v118,v119
s_nop 1
M a[32:35],v[52:55],v[204:207],a[32:35]
buffer_load_dwordx4 v23,s[12:15],s48 offen offset:2048 nt lds
v_mul_f32 v185,s52,v185
v_mul_f32 v180,s52,v180
v_accvgpr_write_b32 a192,v188
v_mul_f32 v181,s52,v181
v_cvt_pk_bf16_f32 v188,v180,v181
v_accvgpr_read_b32 v180,a64
v_accvgpr_read_b32 v181,a65
v_mul_f32 v182,s52,v182
v_accvgpr_write_b32 a193,v189
v_mul_f32 v183,s52,v183
v_cvt_pk_bf16_f32 v189,v182,v183
v_accvgpr_read_b32 v182,a66
v_accvgpr_read_b32 v183,a67
M a[64:67],v[48:51],v[208:211],0
ds_read_b128 v[40:43],v8 offset:37376
v_mul_f32 v186,s52,v186
v_exp_f32 v120,v120
v_exp_f32 v121,v121
s_nop 0
v_cvt_pk_bf16_f32 v214,v120,v121
v_exp_f32 v122,v122
v_exp_f32 v123,v123
s_nop 0
v_cvt_pk_bf16_f32 v215,v122,v123
s_nop 1
M a[64:67],v[52:55],v[212:215],a[64:67]
buffer_load_dwordx4 v24,s[12:15],s48 offen offset:3072 nt lds
s_add_u32 s48,s48,4096
M a[4:7],v[56:59],v[192:195],0
ds_read_b128 v[44:47],v8 offset:37632
s_mov_b32 m0,98304
M a[4:7],v[60:63],v[196:199],a[4:7]
buffer_load_dwordx4 v25,s[16:19],s49 offen nt lds
v_mul_f32 v187,s52,v187
v_cvt_pk_bf16_f32 v190,v184,v185
v_accvgpr_read_b32 v184,a36
v_accvgpr_read_b32 v185,a37
v_cvt_pk_bf16_f32 v191,v186,v187
v_accvgpr_read_b32 v186,a38
v_accvgpr_read_b32 v187,a39
M a[36:39],v[56:59],v[200:203],0
v_accvgpr_write_b32 a194,v190
v_accvgpr_write_b32 a195,v191
M a[36:39],v[60:63],v[204:207],a[36:39]
buffer_load_dwordx4 v26,s[16:19],s49 offen offset:1024 nt lds
v_mul_f32 v184,s52,v184
v_mul_f32 v185,s52,v185
v_cvt_pk_bf16_f32 v190,v184,v185
v_accvgpr_read_b32 v184,a68
v_accvgpr_read_b32 v185,a69
v_mul_f32 v186,s52,v186
v_mul_f32 v187,s52,v187
v_cvt_pk_bf16_f32 v191,v186,v187
v_accvgpr_read_b32 v186,a70
v_accvgpr_read_b32 v187,a71
M a[68:71],v[56:59],v[208:211],0
v_accvgpr_write_b32 a208,v188
v_accvgpr_write_b32 a209,v189
M a[68:71],v[60:63],v[212:215],a[68:71]
buffer_load_dwordx4 v25,s[16:19],s49 offen offset:2048 nt lds
v_accvgpr_write_b32 a210,v190
M v[160:163],v[176:179],v[192:195],0
v_accvgpr_write_b32 a211,v191
v_mul_f32 v180,s52,v180
M v[160:163],v[176:179],v[196:199],v[160:163]
buffer_load_dwordx4 v26,s[16:19],s49 offen offset:3072 nt lds
s_add_u32 s49,s49,4096
s_mov_b32 m0,102400
s_waitcnt lgkmcnt(0)
M v[112:115],v[32:35],a[128:131],0
ds_read_b64_tr_b16 v[48:49],v9 offset:256
ds_read_b64_tr_b16 v[50:51],v9 offset:4352
buffer_load_dwordx4 v25,s[16:19],s49 offen nt lds
M v[112:115],v[36:39],a[132:135],v[112:115]
ds_read_b64_tr_b16 v[52:53],v9 offset:8448
ds_read_b64_tr_b16 v[54:55],v9 offset:12544
M v[112:115],v[40:43],a[136:139],v[112:115]
ds_read_b64_tr_b16 v[56:57],v10 offset:256
buffer_load_dwordx4 v26,s[16:19],s49 offen offset:1024 nt lds
M v[112:115],v[44:47],a[140:143],v[112:115]
ds_read_b64_tr_b16 v[58:59],v10 offset:4352
ds_read_b64_tr_b16 v[60:61],v10 offset:8448
M v[116:119],v[32:35],a[144:147],0
ds_read_b64_tr_b16 v[62:63],v10 offset:12544
buffer_load_dwordx4 v25,s[16:19],s49 offen offset:2048 nt lds
M v[116:119],v[36:39],a[148:151],v[116:119]
v_mul_f32 v181,s52,v181
v_mul_f32 v182,s52,v182
M v[116:119],v[40:43],a[152:155],v[116:119]
buffer_load_dwordx4 v26,s[16:19],s49 offen offset:3072 nt lds
s_add_u32 s49,s49,4096
M v[116:119],v[44:47],a[156:159],v[116:119]
s_mov_b32 m0,106496
v_mul_f32 v183,s52,v183
M v[120:123],v[32:35],a[160:163],0
buffer_load_dwordx4 v25,s[16:19],s49 offen nt lds
v_mul_f32 v184,s52,v184
M v[120:123],v[36:39],a[164:167],v[120:123]
v_mul_f32 v185,s52,v185
v_mul_f32 v186,s52,v186
M v[120:123],v[40:43],a[168:171],v[120:123]
buffer_load_dwordx4 v26,s[16:19],s49 offen offset:1024 nt lds
v_mul_f32 v187,s52,v187
M v[120:123],v[44:47],a[172:175],v[120:123]
s_waitcnt lgkmcnt(0)
v_cvt_pk_bf16_f32 v188,v180,v181
v_accvgpr_read_b32 v180,a8
v_accvgpr_read_b32 v181,a9
v_cvt_pk_bf16_f32 v189,v182,v183
v_accvgpr_read_b32 v182,a10
v_accvgpr_read_b32 v183,a11
M a[8:11],v[48:51],v[192:195],0
ds_read_b128 v[32:35],v8 offset:40960
buffer_load_dwordx4 v25,s[16:19],s49 offen offset:2048 nt lds
M a[8:11],v[52:55],v[196:199],a[8:11]
v_cvt_pk_bf16_f32 v190,v184,v185
v_cvt_pk_bf16_f32 v191,v186,v187
v_mul_f32 v180,s52,v180
v_accvgpr_write_b32 a224,v188
v_mul_f32 v181,s52,v181
v_cvt_pk_bf16_f32 v188,v180,v181
v_accvgpr_read_b32 v180,a40
v_accvgpr_read_b32 v181,a41
v_mul_f32 v182,s52,v182
v_accvgpr_write_b32 a225,v189
v_mul_f32 v183,s52,v183
v_cvt_pk_bf16_f32 v189,v182,v183
v_accvgpr_read_b32 v182,a42
v_accvgpr_read_b32 v183,a43
M a[40:43],v[48:51],v[200:203],0
ds_read_b128 v[36:39],v8 offset:41216
buffer_load_dwordx4 v26,s[16:19],s49 offen offset:3072 nt lds
s_add_u32 s49,s49,4096
M a[40:43],v[52:55],v[204:207],a[40:43]
s_mov_b32 m0,110592
v_accvgpr_write_b32 a226,v190
v_mul_f32 v180,s52,v180
v_accvgpr_write_b32 a196,v188
v_mul_f32 v181,s52,v181
v_cvt_pk_bf16_f32 v188,v180,v181
v_accvgpr_read_b32 v180,a72
v_accvgpr_read_b32 v181,a73
v_mul_f32 v182,s52,v182
v_accvgpr_write_b32 a197,v189
v_mul_f32 v183,s52,v183
v_cvt_pk_bf16_f32 v189,v182,v183
v_accvgpr_read_b32 v182,a74
v_accvgpr_read_b32 v183,a75
M a[72:75],v[48:51],v[208:211],0
ds_read_b128 v[40:43],v8 offset:41472
buffer_load_dwordx4 v25,s[16:19],s49 offen nt lds
M a[72:75],v[52:55],v[212:215],a[72:75]
buffer_load_dwordx4 v26,s[16:19],s49 offen offset:1024 nt lds
v_accvgpr_write_b32 a227,v191
v_accvgpr_read_b32 v184,a12
v_accvgpr_read_b32 v185,a13
v_accvgpr_read_b32 v186,a14
v_accvgpr_read_b32 v187,a15
M a[12:15],v[56:59],v[192:195],0
ds_read_b128 v[44:47],v8 offset:41728
v_mul_f32 v184,s52,v184
M a[12:15],v[60:63],v[196:199],a[12:15]
buffer_load_dwordx4 v25,s[16:19],s49 offen offset:2048 nt lds
v_mul_f32 v185,s52,v185
v_cvt_pk_bf16_f32 v190,v184,v185
v_accvgpr_read_b32 v184,a44
v_accvgpr_read_b32 v185,a45
v_mul_f32 v186,s52,v186
v_mul_f32 v187,s52,v187
v_cvt_pk_bf16_f32 v191,v186,v187
v_accvgpr_read_b32 v186,a46
v_accvgpr_read_b32 v187,a47
M a[44:47],v[56:59],v[200:203],0
v_accvgpr_write_b32 a198,v190
v_accvgpr_write_b32 a199,v191
M a[44:47],v[60:63],v[204:207],a[44:47]
buffer_load_dwordx4 v26,s[16:19],s49 offen offset:3072 nt lds
s_add_u32 s49,s49,4096
v_mul_f32 v184,s52,v184
v_mul_f32 v185,s52,v185
v_cvt_pk_bf16_f32 v190,v184,v185
v_accvgpr_read_b32 v184,a76
v_accvgpr_read_b32 v185,a77
v_mul_f32 v186,s52,v186
v_mul_f32 v187,s52,v187
v_cvt_pk_bf16_f32 v191,v186,v187
v_accvgpr_read_b32 v186,a78
v_accvgpr_read_b32 v187,a79
M a[76:79],v[56:59],v[208:211],0
s_mov_b32 m0,114688
v_accvgpr_write_b32 a212,v188
M a[76:79],v[60:63],v[212:215],a[76:79]
buffer_load_dwordx4 v25,s[16:19],s49 offen nt lds
v_accvgpr_write_b32 a213,v189
M v[164:167],v[176:179],v[200:203],0
v_accvgpr_write_b32 a214,v190
v_accvgpr_write_b32 a215,v191
M v[164:167],v[176:179],v[204:207],v[164:167]
buffer_load_dwordx4 v26,s[16:19],s49 offen offset:1024 nt lds
s_waitcnt lgkmcnt(0)
v_exp_f32 v128,v128
v_exp_f32 v129,v129
v_exp_f32 v130,v130
v_exp_f32 v131,v131
v_cvt_pk_bf16_f32 v224,v128,v129
v_cvt_pk_bf16_f32 v225,v130,v131
M v[128:131],v[32:35],a[128:131],0
ds_read_b64_tr_b16 v[48:49],v9 offset:512
ds_read_b64_tr_b16 v[50:51],v9 offset:4608
M v[128:131],v[36:39],a[132:135],v[128:131]
ds_read_b64_tr_b16 v[52:53],v9 offset:8704
ds_read_b64_tr_b16 v[54:55],v9 offset:12800
buffer_load_dwordx4 v25,s[16:19],s49 offen offset:2048 nt lds
M v[128:131],v[40:43],a[136:139],v[128:131]
ds_read_b64_tr_b16 v[56:57],v10 offset:512
v_mul_f32 v180,s52,v180
M v[128:131],v[44:47],a[140:143],v[128:131]
ds_read_b64_tr_b16 v[58:59],v10 offset:4608
ds_read_b64_tr_b16 v[60:61],v10 offset:8704
buffer_load_dwordx4 v26,s[16:19],s49 offen offset:3072 nt lds
s_add_u32 s49,s49,4096
v_exp_f32 v132,v132
v_exp_f32 v133,v133
v_exp_f32 v134,v134
v_exp_f32 v135,v135
v_cvt_pk_bf16_f32 v232,v132,v133
v_cvt_pk_bf16_f32 v233,v134,v135
M v[132:135],v[32:35],a[144:147],0
ds_read_b64_tr_b16 v[62:63],v10 offset:12800
s_mov_b32 m0,118784
M v[132:135],v[36:39],a[148:151],v[132:135]
buffer_load_dwordx4 v25,s[16:19],s49 offen nt lds
v_mul_f32 v181,s52,v181
M v[132:135],v[40:43],a[152:155],v[132:135]
v_mul_f32 v182,s52,v182
v_mul_f32 v183,s52,v183
M v[132:135],v[44:47],a[156:159],v[132:135]
buffer_load_dwordx4 v26,s[16:19],s49 offen offset:1024 nt lds
v_mul_f32 v184,s52,v184
v_exp_f32 v136,v136
v_exp_f32 v137,v137
v_exp_f32 v138,v138
v_exp_f32 v139,v139
v_cvt_pk_bf16_f32 v240,v136,v137
v_cvt_pk_bf16_f32 v241,v138,v139
M v[136:139],v[32:35],a[160:163],0
v_mul_f32 v185,s52,v185
v_mul_f32 v186,s52,v186
M v[136:139],v[36:39],a[164:167],v[136:139]
buffer_load_dwordx4 v25,s[16:19],s49 offen offset:2048 nt lds
v_mul_f32 v187,s52,v187
M v[136:139],v[40:43],a[168:171],v[136:139]
buffer_load_dwordx4 v26,s[16:19],s49 offen offset:3072 nt lds
s_add_u32 s49,s49,4096
M v[136:139],v[44:47],a[172:175],v[136:139]
s_mov_b32 m0,122880
s_waitcnt lgkmcnt(0)
v_cvt_pk_bf16_f32 v188,v180,v181
v_accvgpr_read_b32 v180,a16
v_accvgpr_read_b32 v181,a17
v_cvt_pk_bf16_f32 v189,v182,v183
v_accvgpr_read_b32 v182,a18
v_accvgpr_read_b32 v183,a19
M a[16:19],v[48:51],v[192:195],0
ds_read_b128 v[32:35],v8 offset:45056
buffer_load_dwordx4 v25,s[16:19],s49 offen nt lds
M a[16:19],v[52:55],v[196:199],a[16:19]
v_cvt_pk_bf16_f32 v190,v184,v185
v_cvt_pk_bf16_f32 v191,v186,v187
v_mul_f32 v180,s52,v180
v_accvgpr_write_b32 a228,v188
v_mul_f32 v181,s52,v181
v_cvt_pk_bf16_f32 v188,v180,v181
v_accvgpr_read_b32 v180,a48
v_accvgpr_read_b32 v181,a49
v_mul_f32 v182,s52,v182
v_accvgpr_write_b32 a229,v189
v_mul_f32 v183,s52,v183
v_cvt_pk_bf16_f32 v189,v182,v183
v_accvgpr_read_b32 v182,a50
v_accvgpr_read_b32 v183,a51
M a[48:51],v[48:51],v[200:203],0
ds_read_b128 v[36:39],v8 offset:45312
buffer_load_dwordx4 v26,s[16:19],s49 offen offset:1024 nt lds
M a[48:51],v[52:55],v[204:207],a[48:51]
v_accvgpr_write_b32 a230,v190
v_accvgpr_write_b32 a231,v191
v_mul_f32 v180,s52,v180
v_accvgpr_write_b32 a200,v188
v_mul_f32 v181,s52,v181
v_cvt_pk_bf16_f32 v188,v180,v181
v_accvgpr_read_b32 v180,a80
v_accvgpr_read_b32 v181,a81
v_mul_f32 v182,s52,v182
v_accvgpr_write_b32 a201,v189
v_mul_f32 v183,s52,v183
v_cvt_pk_bf16_f32 v189,v182,v183
v_accvgpr_read_b32 v182,a82
v_accvgpr_read_b32 v183,a83
M a[80:83],v[48:51],v[208:211],0
ds_read_b128 v[40:43],v8 offset:45568
buffer_load_dwordx4 v25,s[16:19],s49 offen offset:2048 nt lds
M a[80:83],v[52:55],v[212:215],a[80:83]
v_accvgpr_read_b32 v184,a20
v_accvgpr_read_b32 v185,a21
v_accvgpr_read_b32 v186,a22
v_accvgpr_read_b32 v187,a23
M a[20:23],v[56:59],v[192:195],0
ds_read_b128 v[44:47],v8 offset:45824
buffer_load_dwordx4 v26,s[16:19],s49 offen offset:3072 nt lds
s_add_u32 s49,s49,4096
M a[20:23],v[60:63],v[196:199],a[20:23]
s_mov_b32 m0,126976
v_mul_f32 v184,s52,v184
v_mul_f32 v185,s52,v185
v_cvt_pk_bf16_f32 v190,v184,v185
v_accvgpr_read_b32 v184,a52
v_accvgpr_read_b32 v185,a53
v_mul_f32 v186,s52,v186
v_mul_f32 v187,s52,v187
v_cvt_pk_bf16_f32 v191,v186,v187
v_accvgpr_read_b32 v186,a54
v_accvgpr_read_b32 v187,a55
M a[52:55],v[56:59],v[200:203],0
buffer_load_dwordx4 v25,s[16:19],s49 offen nt lds
v_accvgpr_write_b32 a202,v190
M a[52:55],v[60:63],v[204:207],a[52:55]
v_accvgpr_write_b32 a203,v191
v_mul_f32 v184,s52,v184
v_mul_f32 v185,s52,v185
v_cvt_pk_bf16_f32 v190,v184,v185
v_accvgpr_read_b32 v184,a84
v_accvgpr_read_b32 v185,a85
v_mul_f32 v186,s52,v186
v_mul_f32 v187,s52,v187
v_cvt_pk_bf16_f32 v191,v186,v187
v_accvgpr_read_b32 v186,a86
v_accvgpr_read_b32 v187,a87
M a[84:87],v[56:59],v[208:211],0
buffer_load_dwordx4 v26,s[16:19],s49 offen offset:1024 nt lds
v_accvgpr_write_b32 a216,v188
M a[84:87],v[60:63],v[212:215],a[84:87]
v_accvgpr_write_b32 a217,v189
v_accvgpr_write_b32 a218,v190
M v[168:171],v[176:179],v[208:211],0
buffer_load_dwordx4 v25,s[16:19],s49 offen offset:2048 nt lds
v_accvgpr_write_b32 a219,v191
M v[168:171],v[176:179],v[212:215],v[168:171]
s_waitcnt lgkmcnt(0)
v_mul_f32 v180,s52,v180
v_exp_f32 v144,v144
v_exp_f32 v145,v145
v_exp_f32 v146,v146
v_exp_f32 v147,v147
v_cvt_pk_bf16_f32 v226,v144,v145
v_cvt_pk_bf16_f32 v227,v146,v147
M v[144:147],v[32:35],a[128:131],0
ds_read_b64_tr_b16 v[48:49],v9 offset:768
ds_read_b64_tr_b16 v[50:51],v9 offset:4864
buffer_load_dwordx4 v26,s[16:19],s49 offen offset:3072 nt lds
s_add_u32 s49,s49,4096
M v[144:147],v[36:39],a[132:135],v[144:147]
ds_read_b64_tr_b16 v[52:53],v9 offset:8960
ds_read_b64_tr_b16 v[54:55],v9 offset:13056
M v[144:147],v[40:43],a[136:139],v[144:147]
ds_read_b64_tr_b16 v[56:57],v10 offset:768
v_mul_f32 v181,s52,v181
M v[144:147],v[44:47],a[140:143],v[144:147]
ds_read_b64_tr_b16 v[58:59],v10 offset:4864
ds_read_b64_tr_b16 v[60:61],v10 offset:8960
v_exp_f32 v148,v148
v_exp_f32 v149,v149
v_exp_f32 v150,v150
v_exp_f32 v151,v151
v_cvt_pk_bf16_f32 v234,v148,v149
v_cvt_pk_bf16_f32 v235,v150,v151
M v[148:151],v[32:35],a[144:147],0
ds_read_b64_tr_b16 v[62:63],v10 offset:13056
v_mul_f32 v182,s52,v182
M v[148:151],v[36:39],a[148:151],v[148:151]
v_mul_f32 v183,s52,v183
v_mul_f32 v184,s52,v184
M v[148:151],v[40:43],a[152:155],v[148:151]
v_mul_f32 v185,s52,v185
v_mul_f32 v186,s52,v186
M v[148:151],v[44:47],a[156:159],v[148:151]
v_mul_f32 v187,s52,v187
v_cvt_pk_bf16_f32 v188,v180,v181
v_exp_f32 v152,v152
v_exp_f32 v153,v153
v_exp_f32 v154,v154
v_exp_f32 v155,v155
v_cvt_pk_bf16_f32 v242,v152,v153
v_cvt_pk_bf16_f32 v243,v154,v155
M v[152:155],v[32:35],a[160:163],0
v_cvt_pk_bf16_f32 v189,v182,v183
v_cvt_pk_bf16_f32 v190,v184,v185
M v[152:155],v[36:39],a[164:167],v[152:155]
v_cvt_pk_bf16_f32 v191,v186,v187
v_accvgpr_write_b32 a232,v188
M v[152:155],v[40:43],a[168:171],v[152:155]
v_accvgpr_write_b32 a233,v189
v_accvgpr_write_b32 a234,v190
M v[152:155],v[44:47],a[172:175],v[152:155]
s_waitcnt vmcnt(48) lgkmcnt(0)
s_barrier
v_accvgpr_read_b32 v180,a24
v_accvgpr_read_b32 v181,a25
v_accvgpr_read_b32 v182,a26
v_accvgpr_read_b32 v183,a27
M a[24:27],v[48:51],v[192:195],0
ds_read_b128 v[32:35],v8 offset:49152
s_mov_b32 m0,16384
M a[24:27],v[52:55],v[196:199],a[24:27]
buffer_load_dwordx4 v21,s[12:15],s48 offen nt lds
v_accvgpr_write_b32 a235,v191
v_mul_f32 v180,s52,v180
v_mul_f32 v181,s52,v181
v_cvt_pk_bf16_f32 v188,v180,v181
v_accvgpr_read_b32 v180,a56
v_accvgpr_read_b32 v181,a57
v_mul_f32 v182,s52,v182
v_mul_f32 v183,s52,v183
v_cvt_pk_bf16_f32 v189,v182,v183
v_accvgpr_read_b32 v182,a58
v_accvgpr_read_b32 v183,a59
M a[56:59],v[48:51],v[200:203],0
ds_read_b128 v[36:39],v8 offset:49408
v_accvgpr_read_b32 v184,a28
M a[56:59],v[52:55],v[204:207],a[56:59]
buffer_load_dwordx4 v22,s[12:15],s48 offen offset:1024 nt lds
v_accvgpr_read_b32 v185,a29
v_mul_f32 v180,s52,v180
v_accvgpr_write_b32 a204,v188
v_mul_f32 v181,s52,v181
v_cvt_pk_bf16_f32 v188,v180,v181
v_accvgpr_read_b32 v180,a88
v_accvgpr_read_b32 v181,a89
v_mul_f32 v182,s52,v182
v_accvgpr_write_b32 a205,v189
v_mul_f32 v183,s52,v183
v_cvt_pk_bf16_f32 v189,v182,v183
v_accvgpr_read_b32 v182,a90
v_accvgpr_read_b32 v183,a91
M a[88:91],v[48:51],v[208:211],0
ds_read_b128 v[40:43],v8 offset:49664
v_accvgpr_read_b32 v186,a30
M a[88:91],v[52:55],v[212:215],a[88:91]
v_exp_f32 v64,v64
v_accvgpr_read_b32 v187,a31
M a[28:31],v[56:59],v[192:195],0
ds_read_b128 v[44:47],v8 offset:49920
buffer_load_dwordx4 v23,s[12:15],s48 offen offset:2048 nt lds
M a[28:31],v[60:63],v[196:199],a[28:31]
v_exp_f32 v65,v65
v_mul_f32 v184,s52,v184
v_mul_f32 v185,s52,v185
v_cvt_pk_bf16_f32 v190,v184,v185
v_accvgpr_read_b32 v184,a60
v_accvgpr_read_b32 v185,a61
v_mul_f32 v186,s52,v186
v_mul_f32 v187,s52,v187
v_cvt_pk_bf16_f32 v191,v186,v187
v_accvgpr_read_b32 v186,a62
v_accvgpr_read_b32 v187,a63
M a[60:63],v[56:59],v[200:203],0
v_exp_f32 v66,v66
M a[60:63],v[60:63],v[204:207],a[60:63]
buffer_load_dwordx4 v24,s[12:15],s48 offen offset:3072 nt lds
s_add_u32 s48,s48,4096
v_mul_f32 v184,s52,v184
v_accvgpr_write_b32 a206,v190
v_mul_f32 v185,s52,v185
v_cvt_pk_bf16_f32 v190,v184,v185
v_accvgpr_read_b32 v184,a92
v_accvgpr_read_b32 v185,a93
v_mul_f32 v186,s52,v186
v_accvgpr_write_b32 a207,v191
v_mul_f32 v187,s52,v187
v_cvt_pk_bf16_f32 v191,v186,v187
v_accvgpr_read_b32 v186,a94
v_accvgpr_read_b32 v187,a95
M a[92:95],v[56:59],v[208:211],0
v_exp_f32 v67,v67
M a[92:95],v[60:63],v[212:215],a[92:95]
s_mov_b32 m0,20480
s_waitcnt lgkmcnt(0)
v_cvt_pk_bf16_f32 v228,v64,v65
v_cvt_pk_bf16_f32 v229,v66,v67
M v[64:67],v[32:35],a[128:131],0
ds_read_b64_tr_b16 v[48:49],v9 offset:16384
ds_read_b64_tr_b16 v[50:51],v9 offset:20480
buffer_load_dwordx4 v21,s[12:15],s48 offen nt lds
M v[64:67],v[36:39],a[132:135],v[64:67]
ds_read_b64_tr_b16 v[52:53],v9 offset:24576
ds_read_b64_tr_b16 v[54:55],v9 offset:28672
M v[64:67],v[40:43],a[136:139],v[64:67]
ds_read_b64_tr_b16 v[56:57],v10 offset:16384
v_accvgpr_write_b32 a220,v188
M v[64:67],v[44:47],a[140:143],v[64:67]
ds_read_b64_tr_b16 v[58:59],v10 offset:20480
ds_read_b64_tr_b16 v[60:61],v10 offset:24576
buffer_load_dwordx4 v22,s[12:15],s48 offen offset:1024 nt lds
v_exp_f32 v68,v68
v_exp_f32 v69,v69
v_exp_f32 v70,v70
v_exp_f32 v71,v71
v_cvt_pk_bf16_f32 v236,v68,v69
v_cvt_pk_bf16_f32 v237,v70,v71
M v[68:71],v[32:35],a[144:147],0
ds_read_b64_tr_b16 v[62:63],v10 offset:28672
v_accvgpr_write_b32 a221,v189
M v[68:71],v[36:39],a[148:151],v[68:71]
v_exp_f32 v72,v72
M v[68:71],v[40:43],a[152:155],v[68:71]
buffer_load_dwordx4 v23,s[12:15],s48 offen offset:2048 nt lds
v_accvgpr_write_b32 a222,v190
M v[68:71],v[44:47],a[156:159],v[68:71]
v_exp_f32 v73,v73
v_exp_f32 v74,v74
v_exp_f32 v75,v75
v_cvt_pk_bf16_f32 v244,v72,v73
v_cvt_pk_bf16_f32 v245,v74,v75
M v[72:75],v[32:35],a[160:163],0
buffer_load_dwordx4 v24,s[12:15],s48 offen offset:3072 nt lds
s_add_u32 s48,s48,4096
M v[72:75],v[36:39],a[164:167],v[72:75]
v_exp_f32 v80,v80
M v[72:75],v[40:43],a[168:171],v[72:75]
s_mov_b32 m0,24576
v_accvgpr_write_b32 a223,v191
M v[72:75],v[44:47],a[172:175],v[72:75]
buffer_load_dwordx4 v21,s[12:15],s48 offen nt lds
s_waitcnt lgkmcnt(0)
M a[0:3],v[48:51],v[224:227],a[0:3]
ds_read_b128 v[32:35],v8 offset:53248
v_mul_f32 v180,s52,v180
v_exp_f32 v81,v81
s_nop 0
v_cvt_pk_bf16_f32 v230,v80,v81
v_exp_f32 v82,v82
v_exp_f32 v83,v83
s_nop 0
v_cvt_pk_bf16_f32 v231,v82,v83
s_nop 1
M a[0:3],v[52:55],v[228:231],a[0:3]
v_exp_f32 v84,v84
M a[32:35],v[48:51],v[232:235],a[32:35]
ds_read_b128 v[36:39],v8 offset:53504
buffer_load_dwordx4 v22,s[12:15],s48 offen offset:1024 nt lds
v_exp_f32 v85,v85
s_nop 0
v_cvt_pk_bf16_f32 v238,v84,v85
v_exp_f32 v86,v86
v_exp_f32 v87,v87
s_nop 0
v_cvt_pk_bf16_f32 v239,v86,v87
s_nop 1
M a[32:35],v[52:55],v[236:239],a[32:35]
v_exp_f32 v88,v88
M a[64:67],v[48:51],v[240:243],a[64:67]
ds_read_b128 v[40:43],v8 offset:53760
v_mul_f32 v181,s52,v181
v_exp_f32 v89,v89
s_nop 0
v_cvt_pk_bf16_f32 v246,v88,v89
v_exp_f32 v90,v90
v_exp_f32 v91,v91
s_nop 0
v_cvt_pk_bf16_f32 v247,v90,v91
s_nop 1
M a[64:67],v[52:55],v[244:247],a[64:67]
buffer_load_dwordx4 v23,s[12:15],s48 offen offset:2048 nt lds
v_mul_f32 v182,s52,v182
M a[4:7],v[56:59],v[224:227],a[4:7]
ds_read_b128 v[44:47],v8 offset:54016
buffer_load_dword v30,v31,s[24:27],0 offen
M a[4:7],v[60:63],v[228:231],a[4:7]
v_exp_f32 v96,v96
M a[36:39],v[56:59],v[232:235],a[36:39]
buffer_load_dwordx4 v24,s[12:15],s48 offen offset:3072 nt lds
s_add_u32 s48,s48,4096
M a[36:39],v[60:63],v[236:239],a[36:39]
v_exp_f32 v97,v97
M a[68:71],v[56:59],v[240:243],a[68:71]
s_mov_b32 m0,28672
v_mul_f32 v183,s52,v183
M a[68:71],v[60:63],v[244:247],a[68:71]
buffer_load_dwordx4 v21,s[12:15],s48 offen nt lds
v_mul_f32 v184,s52,v184
M v[160:163],v[176:179],v[224:227],v[160:163]
v_exp_f32 v98,v98
M v[160:163],v[176:179],v[228:231],v[160:163]
buffer_load_dwordx4 v22,s[12:15],s48 offen offset:1024 nt lds
s_waitcnt lgkmcnt(0)
M v[80:83],v[32:35],a[128:131],0
ds_read_b64_tr_b16 v[48:49],v9 offset:16640
ds_read_b64_tr_b16 v[50:51],v9 offset:20736
M v[80:83],v[36:39],a[132:135],v[80:83]
ds_read_b64_tr_b16 v[52:53],v9 offset:24832
ds_read_b64_tr_b16 v[54:55],v9 offset:28928
M v[80:83],v[40:43],a[136:139],v[80:83]
ds_read_b64_tr_b16 v[56:57],v10 offset:16640
buffer_load_dwordx4 v23,s[12:15],s48 offen offset:2048 nt lds
M v[80:83],v[44:47],a[140:143],v[80:83]
ds_read_b64_tr_b16 v[58:59],v10 offset:20736
ds_read_b64_tr_b16 v[60:61],v10 offset:24832
M v[84:87],v[32:35],a[144:147],0
ds_read_b64_tr_b16 v[62:63],v10 offset:28928
v_mul_f32 v185,s52,v185
M v[84:87],v[36:39],a[148:151],v[84:87]
buffer_load_dwordx4 v24,s[12:15],s48 offen offset:3072 nt lds
s_add_u32 s48,s48,4096
M v[84:87],v[40:43],a[152:155],v[84:87]
v_exp_f32 v99,v99
M v[84:87],v[44:47],a[156:159],v[84:87]
s_mov_b32 m0,65536
v_mul_f32 v186,s52,v186
M v[88:91],v[32:35],a[160:163],0
buffer_load_dwordx4 v25,s[16:19],s49 offen nt lds
v_mul_f32 v187,s52,v187
M v[88:91],v[36:39],a[164:167],v[88:91]
v_exp_f32 v100,v100
M v[88:91],v[40:43],a[168:171],v[88:91]
v_exp_f32 v101,v101
M v[88:91],v[44:47],a[172:175],v[88:91]
buffer_load_dwordx4 v26,s[16:19],s49 offen offset:1024 nt lds
s_waitcnt lgkmcnt(0)
M a[8:11],v[48:51],v[224:227],a[8:11]
ds_read_b128 v[32:35],v8 offset:57344
v_cvt_pk_bf16_f32 v188,v180,v181
M a[8:11],v[52:55],v[228:231],a[8:11]
v_exp_f32 v102,v102
M a[40:43],v[48:51],v[232:235],a[40:43]
ds_read_b128 v[36:39],v8 offset:57600
buffer_load_dwordx4 v25,s[16:19],s49 offen offset:2048 nt lds
M a[40:43],v[52:55],v[236:239],a[40:43]
v_exp_f32 v103,v103
M a[72:75],v[48:51],v[240:243],a[72:75]
ds_read_b128 v[40:43],v8 offset:57856
v_cvt_pk_bf16_f32 v189,v182,v183
M a[72:75],v[52:55],v[244:247],a[72:75]
buffer_load_dwordx4 v26,s[16:19],s49 offen offset:3072 nt lds
s_add_u32 s49,s49,4096
M a[12:15],v[56:59],v[224:227],a[12:15]
ds_read_b128 v[44:47],v8 offset:58112
s_mov_b32 m0,69632
M a[12:15],v[60:63],v[228:231],a[12:15]
buffer_load_dwordx4 v25,s[16:19],s49 offen nt lds
v_cvt_pk_bf16_f32 v190,v184,v185
M a[44:47],v[56:59],v[232:235],a[44:47]
v_exp_f32 v104,v104
M a[44:47],v[60:63],v[236:239],a[44:47]
v_exp_f32 v105,v105
M a[76:79],v[56:59],v[240:243],a[76:79]
buffer_load_dwordx4 v26,s[16:19],s49 offen offset:1024 nt lds
v_cvt_pk_bf16_f32 v191,v186,v187
M a[76:79],v[60:63],v[244:247],a[76:79]
v_exp_f32 v106,v106
M v[164:167],v[176:179],v[232:235],v[164:167]
v_exp_f32 v107,v107
M v[164:167],v[176:179],v[236:239],v[164:167]
buffer_load_dwordx4 v25,s[16:19],s49 offen offset:2048 nt lds
s_waitcnt lgkmcnt(0)
v_cvt_pk_bf16_f32 v192,v96,v97
v_cvt_pk_bf16_f32 v193,v98,v99
M v[96:99],v[32:35],a[128:131],0
ds_read_b64_tr_b16 v[48:49],v9 offset:16896
ds_read_b64_tr_b16 v[50:51],v9 offset:20992
M v[96:99],v[36:39],a[132:135],v[96:99]
ds_read_b64_tr_b16 v[52:53],v9 offset:25088
ds_read_b64_tr_b16 v[54:55],v9 offset:29184
M v[96:99],v[40:43],a[136:139],v[96:99]
ds_read_b64_tr_b16 v[56:57],v10 offset:16896
buffer_load_dwordx4 v26,s[16:19],s49 offen offset:3072 nt lds
s_add_u32 s49,s49,4096
M v[96:99],v[44:47],a[140:143],v[96:99]
ds_read_b64_tr_b16 v[58:59],v10 offset:20992
ds_read_b64_tr_b16 v[60:61],v10 offset:25088
v_cvt_pk_bf16_f32 v200,v100,v101
v_cvt_pk_bf16_f32 v201,v102,v103
M v[100:103],v[32:35],a[144:147],0
ds_read_b64_tr_b16 v[62:63],v10 offset:29184
s_mov_b32 m0,73728
M v[100:103],v[36:39],a[148:151],v[100:103]
buffer_load_dwordx4 v25,s[16:19],s49 offen nt lds
v_accvgpr_write_b32 a236,v188
M v[100:103],v[40:43],a[152:155],v[100:103]
v_exp_f32 v112,v112
M v[100:103],v[44:47],a[156:159],v[100:103]
v_exp_f32 v113,v113
v_cvt_pk_bf16_f32 v208,v104,v105
v_cvt_pk_bf16_f32 v209,v106,v107
M v[104:107],v[32:35],a[160:163],0
buffer_load_dwordx4 v26,s[16:19],s49 offen offset:1024 nt lds
v_accvgpr_write_b32 a237,v189
M v[104:107],v[36:39],a[164:167],v[104:107]
v_exp_f32 v114,v114
M v[104:107],v[40:43],a[168:171],v[104:107]
buffer_load_dwordx4 v25,s[16:19],s49 offen offset:2048 nt lds
v_accvgpr_write_b32 a238,v190
M v[104:107],v[44:47],a[172:175],v[104:107]
s_waitcnt lgkmcnt(0)
v_accvgpr_write_b32 a239,v191
M a[16:19],v[48:51],v[224:227],a[16:19]
ds_read_b128 v[32:35],v8 offset:61440
v_cvt_pk_bf16_f32 v194,v112,v113
M a[16:19],v[52:55],v[228:231],a[16:19]
buffer_load_dwordx4 v26,s[16:19],s49 offen offset:3072 nt lds
s_add_u32 s49,s49,4096
M a[48:51],v[48:51],v[232:235],a[48:51]
ds_read_b128 v[36:39],v8 offset:61696
M a[48:51],v[52:55],v[236:239],a[48:51]
s_mov_b32 m0,77824
M a[80:83],v[48:51],v[240:243],a[80:83]
ds_read_b128 v[40:43],v8 offset:61952
buffer_load_dwordx4 v25,s[16:19],s49 offen nt lds
M a[80:83],v[52:55],v[244:247],a[80:83]
v_exp_f32 v115,v115
M a[20:23],v[56:59],v[224:227],a[20:23]
ds_read_b128 v[44:47],v8 offset:62208
v_cvt_pk_bf16_f32 v195,v114,v115
M a[20:23],v[60:63],v[228:231],a[20:23]
buffer_load_dwordx4 v26,s[16:19],s49 offen offset:1024 nt lds
M a[52:55],v[56:59],v[232:235],a[52:55]
v_exp_f32 v116,v116
M a[52:55],v[60:63],v[236:239],a[52:55]
v_exp_f32 v117,v117
M a[84:87],v[56:59],v[240:243],a[84:87]
buffer_load_dwordx4 v25,s[16:19],s49 offen offset:2048 nt lds
v_cvt_pk_bf16_f32 v202,v116,v117
M a[84:87],v[60:63],v[244:247],a[84:87]
v_exp_f32 v118,v118
M v[168:171],v[176:179],v[240:243],v[168:171]
v_exp_f32 v119,v119
M v[168:171],v[176:179],v[244:247],v[168:171]
buffer_load_dwordx4 v26,s[16:19],s49 offen offset:3072 nt lds
s_add_u32 s49,s49,4096
s_waitcnt lgkmcnt(0)
M v[112:115],v[32:35],a[128:131],0
ds_read_b64_tr_b16 v[48:49],v9 offset:17152
ds_read_b64_tr_b16 v[50:51],v9 offset:21248
M v[112:115],v[36:39],a[132:135],v[112:115]
ds_read_b64_tr_b16 v[52:53],v9 offset:25344
ds_read_b64_tr_b16 v[54:55],v9 offset:29440
M v[112:115],v[40:43],a[136:139],v[112:115]
ds_read_b64_tr_b16 v[56:57],v10 offset:17152
v_cvt_pk_bf16_f32 v203,v118,v119
M v[112:115],v[44:47],a[140:143],v[112:115]
ds_read_b64_tr_b16 v[58:59],v10 offset:21248
ds_read_b64_tr_b16 v[60:61],v10 offset:25344
M v[116:119],v[32:35],a[144:147],0
ds_read_b64_tr_b16 v[62:63],v10 offset:29440
M v[116:119],v[36:39],a[148:151],v[116:119]
v_exp_f32 v120,v120
M v[116:119],v[40:43],a[152:155],v[116:119]
v_exp_f32 v121,v121
M v[116:119],v[44:47],a[156:159],v[116:119]
v_exp_f32 v122,v122
v_exp_f32 v123,v123
v_cvt_pk_bf16_f32 v210,v120,v121
v_cvt_pk_bf16_f32 v211,v122,v123
M v[120:123],v[32:35],a[160:163],0
v_exp_f32 v128,v128
M v[120:123],v[36:39],a[164:167],v[120:123]
v_exp_f32 v129,v129
M v[120:123],v[40:43],a[168:171],v[120:123]
v_exp_f32 v130,v130
M v[120:123],v[44:47],a[172:175],v[120:123]
s_waitcnt vmcnt(49) lgkmcnt(0)
s_barrier
M a[24:27],v[48:51],v[224:227],a[24:27]
ds_read_b128 v[32:35],v8
s_mov_b32 m0,32768
M a[24:27],v[52:55],v[228:231],a[24:27]
buffer_load_dwordx4 v21,s[12:15],s48 offen nt lds
v_cvt_pk_bf16_f32 v196,v128,v129
M a[56:59],v[48:51],v[232:235],a[56:59]
ds_read_b128 v[36:39],v8 offset:256
M a[56:59],v[52:55],v[236:239],a[56:59]
buffer_load_dwordx4 v22,s[12:15],s48 offen offset:1024 nt lds
M a[88:91],v[48:51],v[240:243],a[88:91]
ds_read_b128 v[40:43],v8 offset:512
M a[88:91],v[52:55],v[244:247],a[88:91]
v_exp_f32 v131,v131
M a[28:31],v[56:59],v[224:227],a[28:31]
ds_read_b128 v[44:47],v8 offset:768
buffer_load_dwordx4 v23,s[12:15],s48 offen offset:2048 nt lds
M a[28:31],v[60:63],v[228:231],a[28:31]
v_exp_f32 v132,v132
M a[60:63],v[56:59],v[232:235],a[60:63]
v_exp_f32 v133,v133
M a[60:63],v[60:63],v[236:239],a[60:63]
buffer_load_dwordx4 v24,s[12:15],s48 offen offset:3072 nt lds
s_add_u32 s48,s48,4096
M a[92:95],v[56:59],v[240:243],a[92:95]
v_exp_f32 v134,v134
M a[92:95],v[60:63],v[244:247],a[92:95]
s_mov_b32 m0,36864
s_waitcnt lgkmcnt(0)
v_cvt_pk_bf16_f32 v197,v130,v131
M v[128:131],v[32:35],a[128:131],0
ds_read_b64_tr_b16 v[48:49],v9 offset:32768
ds_read_b64_tr_b16 v[50:51],v9 offset:36864
buffer_load_dwordx4 v21,s[12:15],s48 offen nt lds
M v[128:131],v[36:39],a[132:135],v[128:131]
ds_read_b64_tr_b16 v[52:53],v9 offset:40960
ds_read_b64_tr_b16 v[54:55],v9 offset:45056
M v[128:131],v[40:43],a[136:139],v[128:131]
ds_read_b64_tr_b16 v[56:57],v10 offset:32768
v_cvt_pk_bf16_f32 v204,v132,v133
M v[128:131],v[44:47],a[140:143],v[128:131]
ds_read_b64_tr_b16 v[58:59],v10 offset:36864
ds_read_b64_tr_b16 v[60:61],v10 offset:40960
buffer_load_dwordx4 v22,s[12:15],s48 offen offset:1024 nt lds
v_exp_f32 v135,v135
s_nop 0
v_cvt_pk_bf16_f32 v205,v134,v135
M v[132:135],v[32:35],a[144:147],0
ds_read_b64_tr_b16 v[62:63],v10 offset:45056
M v[132:135],v[36:39],a[148:151],v[132:135]
v_exp_f32 v136,v136
M v[132:135],v[40:43],a[152:155],v[132:135]
buffer_load_dwordx4 v23,s[12:15],s48 offen offset:2048 nt lds
M v[132:135],v[44:47],a[156:159],v[132:135]
v_exp_f32 v137,v137
v_exp_f32 v138,v138
v_exp_f32 v139,v139
v_cvt_pk_bf16_f32 v212,v136,v137
v_cvt_pk_bf16_f32 v213,v138,v139
M v[136:139],v[32:35],a[160:163],0
buffer_load_dwordx4 v24,s[12:15],s48 offen offset:3072 nt lds
s_add_u32 s48,s48,4096
M v[136:139],v[36:39],a[164:167],v[136:139]
v_exp_f32 v144,v144
M v[136:139],v[40:43],a[168:171],v[136:139]
s_mov_b32 m0,40960
M v[136:139],v[44:47],a[172:175],v[136:139]
buffer_load_dwordx4 v21,s[12:15],s48 offen nt lds
s_waitcnt lgkmcnt(0)
M a[0:3],v[48:51],v[192:195],a[0:3]
ds_read_b128 v[32:35],v8 offset:4096
v_exp_f32 v145,v145
s_nop 0
v_cvt_pk_bf16_f32 v198,v144,v145
v_exp_f32 v146,v146
v_exp_f32 v147,v147
s_nop 0
v_cvt_pk_bf16_f32 v199,v146,v147
s_nop 1
M a[0:3],v[52:55],v[196:199],a[0:3]
v_exp_f32 v148,v148
M a[32:35],v[48:51],v[200:203],a[32:35]
ds_read_b128 v[36:39],v8 offset:4352
buffer_load_dwordx4 v22,s[12:15],s48 offen offset:1024 nt lds
v_exp_f32 v149,v149
s_nop 0
v_cvt_pk_bf16_f32 v206,v148,v149
v_exp_f32 v150,v150
v_exp_f32 v151,v151
s_nop 0
v_cvt_pk_bf16_f32 v207,v150,v151
s_nop 1
M a[32:35],v[52:55],v[204:207],a[32:35]
v_exp_f32 v152,v152
M a[64:67],v[48:51],v[208:211],a[64:67]
ds_read_b128 v[40:43],v8 offset:4608
v_exp_f32 v153,v153
s_nop 0
v_cvt_pk_bf16_f32 v214,v152,v153
v_exp_f32 v154,v154
v_exp_f32 v155,v155
s_nop 0
v_cvt_pk_bf16_f32 v215,v154,v155
s_nop 1
M a[64:67],v[52:55],v[212:215],a[64:67]
buffer_load_dwordx4 v23,s[12:15],s48 offen offset:2048 nt lds
M a[4:7],v[56:59],v[192:195],a[4:7]
ds_read_b128 v[44:47],v8 offset:4864
M a[4:7],v[60:63],v[196:199],a[4:7]
v_exp_f32 v64,v64
M a[36:39],v[56:59],v[200:203],a[36:39]
buffer_load_dwordx4 v24,s[12:15],s48 offen offset:3072 nt lds
s_add_u32 s48,s48,4096
M a[36:39],v[60:63],v[204:207],a[36:39]
v_exp_f32 v65,v65
M a[68:71],v[56:59],v[208:211],a[68:71]
s_mov_b32 m0,45056
v_cvt_pk_bf16_f32 v224,v64,v65
M a[68:71],v[60:63],v[212:215],a[68:71]
buffer_load_dwordx4 v21,s[12:15],s48 offen nt lds
M v[160:163],v[176:179],v[192:195],v[160:163]
v_exp_f32 v66,v66
M v[160:163],v[176:179],v[196:199],v[160:163]
buffer_load_dwordx4 v22,s[12:15],s48 offen offset:1024 nt lds
s_waitcnt lgkmcnt(0)
M v[144:147],v[32:35],a[128:131],0
ds_read_b64_tr_b16 v[48:49],v9 offset:33024
ds_read_b64_tr_b16 v[50:51],v9 offset:37120
M v[144:147],v[36:39],a[132:135],v[144:147]
ds_read_b64_tr_b16 v[52:53],v9 offset:41216
ds_read_b64_tr_b16 v[54:55],v9 offset:45312
M v[144:147],v[40:43],a[136:139],v[144:147]
ds_read_b64_tr_b16 v[56:57],v10 offset:33024
buffer_load_dwordx4 v23,s[12:15],s48 offen offset:2048 nt lds
M v[144:147],v[44:47],a[140:143],v[144:147]
ds_read_b64_tr_b16 v[58:59],v10 offset:37120
ds_read_b64_tr_b16 v[60:61],v10 offset:41216
M v[148:151],v[32:35],a[144:147],0
ds_read_b64_tr_b16 v[62:63],v10 offset:45312
M v[148:151],v[36:39],a[148:151],v[148:151]
buffer_load_dwordx4 v24,s[12:15],s48 offen offset:3072 nt lds
s_add_u32 s48,s48,4096
M v[148:151],v[40:43],a[152:155],v[148:151]
v_exp_f32 v67,v67
M v[148:151],v[44:47],a[156:159],v[148:151]
s_mov_b32 m0,81920
v_cvt_pk_bf16_f32 v225,v66,v67
M v[152:155],v[32:35],a[160:163],0
buffer_load_dwordx4 v25,s[16:19],s49 offen nt lds
M v[152:155],v[36:39],a[164:167],v[152:155]
v_exp_f32 v68,v68
M v[152:155],v[40:43],a[168:171],v[152:155]
v_exp_f32 v69,v69
M v[152:155],v[44:47],a[172:175],v[152:155]
buffer_load_dwordx4 v26,s[16:19],s49 offen offset:1024 nt lds
s_waitcnt lgkmcnt(0)
M a[8:11],v[48:51],v[192:195],a[8:11]
ds_read_b128 v[32:35],v8 offset:8192
v_cvt_pk_bf16_f32 v232,v68,v69
M a[8:11],v[52:55],v[196:199],a[8:11]
v_exp_f32 v70,v70
M a[40:43],v[48:51],v[200:203],a[40:43]
ds_read_b128 v[36:39],v8 offset:8448
buffer_load_dwordx4 v25,s[16:19],s49 offen offset:2048 nt lds
M a[40:43],v[52:55],v[204:207],a[40:43]
v_exp_f32 v71,v71
M a[72:75],v[48:51],v[208:211],a[72:75]
ds_read_b128 v[40:43],v8 offset:8704
v_cvt_pk_bf16_f32 v233,v70,v71
M a[72:75],v[52:55],v[212:215],a[72:75]
buffer_load_dwordx4 v26,s[16:19],s49 offen offset:3072 nt lds
s_add_u32 s49,s49,4096
M a[12:15],v[56:59],v[192:195],a[12:15]
ds_read_b128 v[44:47],v8 offset:8960
s_mov_b32 m0,86016
M a[12:15],v[60:63],v[196:199],a[12:15]
buffer_load_dwordx4 v25,s[16:19],s49 offen nt lds
M a[44:47],v[56:59],v[200:203],a[44:47]
v_exp_f32 v72,v72
M a[44:47],v[60:63],v[204:207],a[44:47]
v_exp_f32 v73,v73
M a[76:79],v[56:59],v[208:211],a[76:79]
buffer_load_dwordx4 v26,s[16:19],s49 offen offset:1024 nt lds
v_cvt_pk_bf16_f32 v240,v72,v73
M a[76:79],v[60:63],v[212:215],a[76:79]
v_exp_f32 v74,v74
M v[164:167],v[176:179],v[200:203],v[164:167]
v_exp_f32 v75,v75
M v[164:167],v[176:179],v[204:207],v[164:167]
buffer_load_dwordx4 v25,s[16:19],s49 offen offset:2048 nt lds
s_waitcnt lgkmcnt(0)
M v[64:67],v[32:35],a[128:131],0
ds_read_b64_tr_b16 v[48:49],v9 offset:33280
ds_read_b64_tr_b16 v[50:51],v9 offset:37376
M v[64:67],v[36:39],a[132:135],v[64:67]
ds_read_b64_tr_b16 v[52:53],v9 offset:41472
ds_read_b64_tr_b16 v[54:55],v9 offset:45568
M v[64:67],v[40:43],a[136:139],v[64:67]
ds_read_b64_tr_b16 v[56:57],v10 offset:33280
buffer_load_dwordx4 v26,s[16:19],s49 offen offset:3072 nt lds
s_add_u32 s49,s49,4096
M v[64:67],v[44:47],a[140:143],v[64:67]
ds_read_b64_tr_b16 v[58:59],v10 offset:37376
ds_read_b64_tr_b16 v[60:61],v10 offset:41472
M v[68:71],v[32:35],a[144:147],0
ds_read_b64_tr_b16 v[62:63],v10 offset:45568
s_mov_b32 m0,90112
M v[68:71],v[36:39],a[148:151],v[68:71]
buffer_load_dwordx4 v25,s[16:19],s49 offen nt lds
v_cvt_pk_bf16_f32 v241,v74,v75
M v[68:71],v[40:43],a[152:155],v[68:71]
v_exp_f32 v80,v80
M v[68:71],v[44:47],a[156:159],v[68:71]
v_exp_f32 v81,v81
M v[72:75],v[32:35],a[160:163],0
buffer_load_dwordx4 v26,s[16:19],s49 offen offset:1024 nt lds
v_cvt_pk_bf16_f32 v226,v80,v81
M v[72:75],v[36:39],a[164:167],v[72:75]
v_exp_f32 v82,v82
M v[72:75],v[40:43],a[168:171],v[72:75]
buffer_load_dwordx4 v25,s[16:19],s49 offen offset:2048 nt lds
M v[72:75],v[44:47],a[172:175],v[72:75]
s_waitcnt lgkmcnt(0)
M a[16:19],v[48:51],v[192:195],a[16:19]
ds_read_b128 v[32:35],v8 offset:12288
M a[16:19],v[52:55],v[196:199],a[16:19]
buffer_load_dwordx4 v26,s[16:19],s49 offen offset:3072 nt lds
s_add_u32 s49,s49,4096
M a[48:51],v[48:51],v[200:203],a[48:51]
ds_read_b128 v[36:39],v8 offset:12544
M a[48:51],v[52:55],v[204:207],a[48:51]
s_mov_b32 m0,94208
M a[80:83],v[48:51],v[208:211],a[80:83]
ds_read_b128 v[40:43],v8 offset:12800
buffer_load_dwordx4 v25,s[16:19],s49 offen nt lds
M a[80:83],v[52:55],v[212:215],a[80:83]
v_exp_f32 v83,v83
M a[20:23],v[56:59],v[192:195],a[20:23]
ds_read_b128 v[44:47],v8 offset:13056
v_cvt_pk_bf16_f32 v227,v82,v83
M a[20:23],v[60:63],v[196:199],a[20:23]
buffer_load_dwordx4 v26,s[16:19],s49 offen offset:1024 nt lds
M a[52:55],v[56:59],v[200:203],a[52:55]
v_exp_f32 v84,v84
M a[52:55],v[60:63],v[204:207],a[52:55]
v_exp_f32 v85,v85
M a[84:87],v[56:59],v[208:211],a[84:87]
buffer_load_dwordx4 v25,s[16:19],s49 offen offset:2048 nt lds
v_cvt_pk_bf16_f32 v234,v84,v85
M a[84:87],v[60:63],v[212:215],a[84:87]
v_exp_f32 v86,v86
M v[168:171],v[176:179],v[208:211],v[168:171]
v_exp_f32 v87,v87
M v[168:171],v[176:179],v[212:215],v[168:171]
buffer_load_dwordx4 v26,s[16:19],s49 offen offset:3072 nt lds
s_add_u32 s49,s49,4096
s_waitcnt lgkmcnt(0)
M v[80:83],v[32:35],a[128:131],0
ds_read_b64_tr_b16 v[48:49],v9 offset:33536
ds_read_b64_tr_b16 v[50:51],v9 offset:37632
M v[80:83],v[36:39],a[132:135],v[80:83]
ds_read_b64_tr_b16 v[52:53],v9 offset:41728
ds_read_b64_tr_b16 v[54:55],v9 offset:45824
M v[80:83],v[40:43],a[136:139],v[80:83]
ds_read_b64_tr_b16 v[56:57],v10 offset:33536
v_cvt_pk_bf16_f32 v235,v86,v87
M v[80:83],v[44:47],a[140:143],v[80:83]
ds_read_b64_tr_b16 v[58:59],v10 offset:37632
ds_read_b64_tr_b16 v[60:61],v10 offset:41728
M v[84:87],v[32:35],a[144:147],0
ds_read_b64_tr_b16 v[62:63],v10 offset:45824
M v[84:87],v[36:39],a[148:151],v[84:87]
v_exp_f32 v88,v88
M v[84:87],v[40:43],a[152:155],v[84:87]
v_exp_f32 v89,v89
M v[84:87],v[44:47],a[156:159],v[84:87]
v_exp_f32 v90,v90
v_exp_f32 v91,v91
v_cvt_pk_bf16_f32 v242,v88,v89
v_cvt_pk_bf16_f32 v243,v90,v91
M v[88:91],v[32:35],a[160:163],0
v_exp_f32 v96,v96
M v[88:91],v[36:39],a[164:167],v[88:91]
v_exp_f32 v97,v97
M v[88:91],v[40:43],a[168:171],v[88:91]
v_exp_f32 v98,v98
M v[88:91],v[44:47],a[172:175],v[88:91]
s_waitcnt vmcnt(48) lgkmcnt(0)
s_barrier
M a[24:27],v[48:51],v[192:195],a[24:27]
ds_read_b128 v[32:35],v8 offset:16384
s_mov_b32 m0,49152
M a[24:27],v[52:55],v[196:199],a[24:27]
buffer_load_dwordx4 v21,s[12:15],s48 offen nt lds
v_cvt_pk_bf16_f32 v228,v96,v97
M a[56:59],v[48:51],v[200:203],a[56:59]
ds_read_b128 v[36:39],v8 offset:16640
M a[56:59],v[52:55],v[204:207],a[56:59]
buffer_load_dwordx4 v22,s[12:15],s48 offen offset:1024 nt lds
M a[88:91],v[48:51],v[208:211],a[88:91]
ds_read_b128 v[40:43],v8 offset:16896
M a[88:91],v[52:55],v[212:215],a[88:91]
v_exp_f32 v99,v99
M a[28:31],v[56:59],v[192:195],a[28:31]
ds_read_b128 v[44:47],v8 offset:17152
buffer_load_dwordx4 v23,s[12:15],s48 offen offset:2048 nt lds
M a[28:31],v[60:63],v[196:199],a[28:31]
v_exp_f32 v100,v100
M a[60:63],v[56:59],v[200:203],a[60:63]
v_exp_f32 v101,v101
M a[60:63],v[60:63],v[204:207],a[60:63]
buffer_load_dwordx4 v24,s[12:15],s48 offen offset:3072 nt lds
s_add_u32 s48,s48,4096
M a[92:95],v[56:59],v[208:211],a[92:95]
v_exp_f32 v102,v102
M a[92:95],v[60:63],v[212:215],a[92:95]
s_mov_b32 m0,53248
s_waitcnt lgkmcnt(0)
v_cvt_pk_bf16_f32 v229,v98,v99
M v[96:99],v[32:35],a[128:131],0
ds_read_b64_tr_b16 v[48:49],v9 offset:49152
ds_read_b64_tr_b16 v[50:51],v9 offset:53248
buffer_load_dwordx4 v21,s[12:15],s48 offen nt lds
M v[96:99],v[36:39],a[132:135],v[96:99]
ds_read_b64_tr_b16 v[52:53],v9 offset:57344
ds_read_b64_tr_b16 v[54:55],v9 offset:61440
M v[96:99],v[40:43],a[136:139],v[96:99]
ds_read_b64_tr_b16 v[56:57],v10 offset:49152
v_cvt_pk_bf16_f32 v236,v100,v101
M v[96:99],v[44:47],a[140:143],v[96:99]
ds_read_b64_tr_b16 v[58:59],v10 offset:53248
ds_read_b64_tr_b16 v[60:61],v10 offset:57344
buffer_load_dwordx4 v22,s[12:15],s48 offen offset:1024 nt lds
v_exp_f32 v103,v103
s_nop 0
v_cvt_pk_bf16_f32 v237,v102,v103
M v[100:103],v[32:35],a[144:147],0
ds_read_b64_tr_b16 v[62:63],v10 offset:61440
M v[100:103],v[36:39],a[148:151],v[100:103]
v_exp_f32 v104,v104
M v[100:103],v[40:43],a[152:155],v[100:103]
buffer_load_dwordx4 v23,s[12:15],s48 offen offset:2048 nt lds
M v[100:103],v[44:47],a[156:159],v[100:103]
v_exp_f32 v105,v105
v_exp_f32 v106,v106
v_exp_f32 v107,v107
v_cvt_pk_bf16_f32 v244,v104,v105
v_cvt_pk_bf16_f32 v245,v106,v107
M v[104:107],v[32:35],a[160:163],0
buffer_load_dwordx4 v24,s[12:15],s48 offen offset:3072 nt lds
s_add_u32 s48,s48,4096
M v[104:107],v[36:39],a[164:167],v[104:107]
v_exp_f32 v112,v112
M v[104:107],v[40:43],a[168:171],v[104:107]
s_mov_b32 m0,57344
M v[104:107],v[44:47],a[172:175],v[104:107]
buffer_load_dwordx4 v21,s[12:15],s48 offen nt lds
s_waitcnt lgkmcnt(0)
M a[0:3],v[48:51],v[224:227],a[0:3]
ds_read_b128 v[32:35],v8 offset:20480
v_exp_f32 v113,v113
s_nop 0
v_cvt_pk_bf16_f32 v230,v112,v113
v_exp_f32 v114,v114
v_exp_f32 v115,v115
s_nop 0
v_cvt_pk_bf16_f32 v231,v114,v115
s_nop 1
M a[0:3],v[52:55],v[228:231],a[0:3]
v_exp_f32 v116,v116
M a[32:35],v[48:51],v[232:235],a[32:35]
ds_read_b128 v[36:39],v8 offset:20736
buffer_load_dwordx4 v22,s[12:15],s48 offen offset:1024 nt lds
v_exp_f32 v117,v117
s_nop 0
v_cvt_pk_bf16_f32 v238,v116,v117
v_exp_f32 v118,v118
v_exp_f32 v119,v119
s_nop 0
v_cvt_pk_bf16_f32 v239,v118,v119
s_nop 1
M a[32:35],v[52:55],v[236:239],a[32:35]
v_exp_f32 v120,v120
M a[64:67],v[48:51],v[240:243],a[64:67]
ds_read_b128 v[40:43],v8 offset:20992
v_exp_f32 v121,v121
s_nop 0
v_cvt_pk_bf16_f32 v246,v120,v121
v_exp_f32 v122,v122
v_exp_f32 v123,v123
s_nop 0
v_cvt_pk_bf16_f32 v247,v122,v123
s_nop 1
M a[64:67],v[52:55],v[244:247],a[64:67]
buffer_load_dwordx4 v23,s[12:15],s48 offen offset:2048 nt lds
M a[4:7],v[56:59],v[224:227],a[4:7]
ds_read_b128 v[44:47],v8 offset:21248
M a[4:7],v[60:63],v[228:231],a[4:7]
v_exp_f32 v128,v128
M a[36:39],v[56:59],v[232:235],a[36:39]
buffer_load_dwordx4 v24,s[12:15],s48 offen offset:3072 nt lds
s_add_u32 s48,s48,4096
M a[36:39],v[60:63],v[236:239],a[36:39]
v_exp_f32 v129,v129
M a[68:71],v[56:59],v[240:243],a[68:71]
s_mov_b32 m0,61440
v_cvt_pk_bf16_f32 v192,v128,v129
M a[68:71],v[60:63],v[244:247],a[68:71]
buffer_load_dwordx4 v21,s[12:15],s48 offen nt lds
M v[160:163],v[176:179],v[224:227],v[160:163]
v_exp_f32 v130,v130
M v[160:163],v[176:179],v[228:231],v[160:163]
buffer_load_dwordx4 v22,s[12:15],s48 offen offset:1024 nt lds
s_waitcnt lgkmcnt(0)
M v[112:115],v[32:35],a[128:131],0
ds_read_b64_tr_b16 v[48:49],v9 offset:49408
ds_read_b64_tr_b16 v[50:51],v9 offset:53504
M v[112:115],v[36:39],a[132:135],v[112:115]
ds_read_b64_tr_b16 v[52:53],v9 offset:57600
ds_read_b64_tr_b16 v[54:55],v9 offset:61696
M v[112:115],v[40:43],a[136:139],v[112:115]
ds_read_b64_tr_b16 v[56:57],v10 offset:49408
buffer_load_dwordx4 v23,s[12:15],s48 offen offset:2048 nt lds
M v[112:115],v[44:47],a[140:143],v[112:115]
ds_read_b64_tr_b16 v[58:59],v10 offset:53504
ds_read_b64_tr_b16 v[60:61],v10 offset:57600
M v[116:119],v[32:35],a[144:147],0
ds_read_b64_tr_b16 v[62:63],v10 offset:61696
M v[116:119],v[36:39],a[148:151],v[116:119]
buffer_load_dwordx4 v24,s[12:15],s48 offen offset:3072 nt lds
s_add_u32 s48,s48,4096
M v[116:119],v[40:43],a[152:155],v[116:119]
v_exp_f32 v131,v131
M v[116:119],v[44:47],a[156:159],v[116:119]
s_mov_b32 m0,98304
v_cvt_pk_bf16_f32 v193,v130,v131
M v[120:123],v[32:35],a[160:163],0
buffer_load_dwordx4 v25,s[16:19],s49 offen nt lds
M v[120:123],v[36:39],a[164:167],v[120:123]
v_exp_f32 v132,v132
M v[120:123],v[40:43],a[168:171],v[120:123]
v_exp_f32 v133,v133
M v[120:123],v[44:47],a[172:175],v[120:123]
buffer_load_dwordx4 v26,s[16:19],s49 offen offset:1024 nt lds
s_waitcnt lgkmcnt(0)
M a[8:11],v[48:51],v[224:227],a[8:11]
ds_read_b128 v[32:35],v8 offset:24576
v_cvt_pk_bf16_f32 v200,v132,v133
M a[8:11],v[52:55],v[228:231],a[8:11]
v_exp_f32 v134,v134
M a[40:43],v[48:51],v[232:235],a[40:43]
ds_read_b128 v[36:39],v8 offset:24832
buffer_load_dwordx4 v25,s[16:19],s49 offen offset:2048 nt lds
M a[40:43],v[52:55],v[236:239],a[40:43]
v_exp_f32 v135,v135
M a[72:75],v[48:51],v[240:243],a[72:75]
ds_read_b128 v[40:43],v8 offset:25088
v_cvt_pk_bf16_f32 v201,v134,v135
M a[72:75],v[52:55],v[244:247],a[72:75]
buffer_load_dwordx4 v26,s[16:19],s49 offen offset:3072 nt lds
s_add_u32 s49,s49,4096
M a[12:15],v[56:59],v[224:227],a[12:15]
ds_read_b128 v[44:47],v8 offset:25344
s_mov_b32 m0,102400
M a[12:15],v[60:63],v[228:231],a[12:15]
buffer_load_dwordx4 v25,s[16:19],s49 offen nt lds
M a[44:47],v[56:59],v[232:235],a[44:47]
v_exp_f32 v136,v136
M a[44:47],v[60:63],v[236:239],a[44:47]
v_exp_f32 v137,v137
M a[76:79],v[56:59],v[240:243],a[76:79]
buffer_load_dwordx4 v26,s[16:19],s49 offen offset:1024 nt lds
v_cvt_pk_bf16_f32 v208,v136,v137
M a[76:79],v[60:63],v[244:247],a[76:79]
v_exp_f32 v138,v138
M v[164:167],v[176:179],v[232:235],v[164:167]
v_exp_f32 v139,v139
M v[164:167],v[176:179],v[236:239],v[164:167]
buffer_load_dwordx4 v25,s[16:19],s49 offen offset:2048 nt lds
s_waitcnt lgkmcnt(0)
M v[128:131],v[32:35],a[128:131],0
ds_read_b64_tr_b16 v[48:49],v9 offset:49664
ds_read_b64_tr_b16 v[50:51],v9 offset:53760
M v[128:131],v[36:39],a[132:135],v[128:131]
ds_read_b64_tr_b16 v[52:53],v9 offset:57856
ds_read_b64_tr_b16 v[54:55],v9 offset:61952
M v[128:131],v[40:43],a[136:139],v[128:131]
ds_read_b64_tr_b16 v[56:57],v10 offset:49664
buffer_load_dwordx4 v26,s[16:19],s49 offen offset:3072 nt lds
s_add_u32 s49,s49,4096
M v[128:131],v[44:47],a[140:143],v[128:131]
ds_read_b64_tr_b16 v[58:59],v10 offset:53760
ds_read_b64_tr_b16 v[60:61],v10 offset:57856
M v[132:135],v[32:35],a[144:147],0
ds_read_b64_tr_b16 v[62:63],v10 offset:61952
s_mov_b32 m0,106496
M v[132:135],v[36:39],a[148:151],v[132:135]
buffer_load_dwordx4 v25,s[16:19],s49 offen nt lds
v_cvt_pk_bf16_f32 v209,v138,v139
M v[132:135],v[40:43],a[152:155],v[132:135]
v_exp_f32 v144,v144
M v[132:135],v[44:47],a[156:159],v[132:135]
v_exp_f32 v145,v145
M v[136:139],v[32:35],a[160:163],0
buffer_load_dwordx4 v26,s[16:19],s49 offen offset:1024 nt lds
v_cvt_pk_bf16_f32 v194,v144,v145
M v[136:139],v[36:39],a[164:167],v[136:139]
v_exp_f32 v146,v146
M v[136:139],v[40:43],a[168:171],v[136:139]
buffer_load_dwordx4 v25,s[16:19],s49 offen offset:2048 nt lds
M v[136:139],v[44:47],a[172:175],v[136:139]
s_waitcnt lgkmcnt(0)
M a[16:19],v[48:51],v[224:227],a[16:19]
ds_read_b128 v[32:35],v8 offset:28672
M a[16:19],v[52:55],v[228:231],a[16:19]
buffer_load_dwordx4 v26,s[16:19],s49 offen offset:3072 nt lds
s_add_u32 s49,s49,4096
M a[48:51],v[48:51],v[232:235],a[48:51]
ds_read_b128 v[36:39],v8 offset:28928
M a[48:51],v[52:55],v[236:239],a[48:51]
s_mov_b32 m0,110592
M a[80:83],v[48:51],v[240:243],a[80:83]
ds_read_b128 v[40:43],v8 offset:29184
buffer_load_dwordx4 v25,s[16:19],s49 offen nt lds
M a[80:83],v[52:55],v[244:247],a[80:83]
v_exp_f32 v147,v147
M a[20:23],v[56:59],v[224:227],a[20:23]
ds_read_b128 v[44:47],v8 offset:29440
v_cvt_pk_bf16_f32 v195,v146,v147
M a[20:23],v[60:63],v[228:231],a[20:23]
buffer_load_dwordx4 v26,s[16:19],s49 offen offset:1024 nt lds
M a[52:55],v[56:59],v[232:235],a[52:55]
v_exp_f32 v148,v148
M a[52:55],v[60:63],v[236:239],a[52:55]
v_exp_f32 v149,v149
M a[84:87],v[56:59],v[240:243],a[84:87]
buffer_load_dwordx4 v25,s[16:19],s49 offen offset:2048 nt lds
v_cvt_pk_bf16_f32 v202,v148,v149
M a[84:87],v[60:63],v[244:247],a[84:87]
v_exp_f32 v150,v150
M v[168:171],v[176:179],v[240:243],v[168:171]
v_exp_f32 v151,v151
M v[168:171],v[176:179],v[244:247],v[168:171]
buffer_load_dwordx4 v26,s[16:19],s49 offen offset:3072 nt lds
s_add_u32 s49,s49,4096
s_waitcnt lgkmcnt(0)
M v[144:147],v[32:35],a[128:131],0
ds_read_b64_tr_b16 v[48:49],v9 offset:49920
ds_read_b64_tr_b16 v[50:51],v9 offset:54016
M v[144:147],v[36:39],a[132:135],v[144:147]
ds_read_b64_tr_b16 v[52:53],v9 offset:58112
ds_read_b64_tr_b16 v[54:55],v9 offset:62208
M v[144:147],v[40:43],a[136:139],v[144:147]
ds_read_b64_tr_b16 v[56:57],v10 offset:49920
v_cvt_pk_bf16_f32 v203,v150,v151
M v[144:147],v[44:47],a[140:143],v[144:147]
ds_read_b64_tr_b16 v[58:59],v10 offset:54016
ds_read_b64_tr_b16 v[60:61],v10 offset:58112
M v[148:151],v[32:35],a[144:147],0
ds_read_b64_tr_b16 v[62:63],v10 offset:62208
M v[148:151],v[36:39],a[148:151],v[148:151]
v_exp_f32 v152,v152
M v[148:151],v[40:43],a[152:155],v[148:151]
v_exp_f32 v153,v153
M v[148:151],v[44:47],a[156:159],v[148:151]
v_exp_f32 v154,v154
v_exp_f32 v155,v155
v_cvt_pk_bf16_f32 v210,v152,v153
v_cvt_pk_bf16_f32 v211,v154,v155
M v[152:155],v[32:35],a[160:163],0
v_exp_f32 v64,v64
M v[152:155],v[36:39],a[164:167],v[152:155]
v_exp_f32 v65,v65
M v[152:155],v[40:43],a[168:171],v[152:155]
v_exp_f32 v66,v66
M v[152:155],v[44:47],a[172:175],v[152:155]
s_waitcnt vmcnt(48) lgkmcnt(0)
s_barrier
M a[24:27],v[48:51],v[224:227],a[24:27]
ds_read_b128 v[32:35],v8 offset:32768
s_mov_b32 m0,0
M a[24:27],v[52:55],v[228:231],a[24:27]
buffer_load_dwordx4 v21,s[12:15],s48 offen nt lds
v_cvt_pk_bf16_f32 v196,v64,v65
M a[56:59],v[48:51],v[232:235],a[56:59]
ds_read_b128 v[36:39],v8 offset:33024
M a[56:59],v[52:55],v[236:239],a[56:59]
buffer_load_dwordx4 v22,s[12:15],s48 offen offset:1024 nt lds
M a[88:91],v[48:51],v[240:243],a[88:91]
ds_read_b128 v[40:43],v8 offset:33280
M a[88:91],v[52:55],v[244:247],a[88:91]
v_exp_f32 v67,v67
M a[28:31],v[56:59],v[224:227],a[28:31]
ds_read_b128 v[44:47],v8 offset:33536
buffer_load_dwordx4 v23,s[12:15],s48 offen offset:2048 nt lds
M a[28:31],v[60:63],v[228:231],a[28:31]
v_exp_f32 v68,v68
M a[60:63],v[56:59],v[232:235],a[60:63]
v_exp_f32 v69,v69
M a[60:63],v[60:63],v[236:239],a[60:63]
buffer_load_dwordx4 v24,s[12:15],s48 offen offset:3072 nt lds
s_add_u32 s48,s48,4096
M a[92:95],v[56:59],v[240:243],a[92:95]
v_exp_f32 v70,v70
M a[92:95],v[60:63],v[244:247],a[92:95]
s_mov_b32 m0,4096
s_waitcnt lgkmcnt(0)
v_cvt_pk_bf16_f32 v197,v66,v67
M v[64:67],v[32:35],a[128:131],0
ds_read_b64_tr_b16 v[48:49],v9
ds_read_b64_tr_b16 v[50:51],v9 offset:4096
buffer_load_dwordx4 v21,s[12:15],s48 offen nt lds
M v[64:67],v[36:39],a[132:135],v[64:67]
ds_read_b64_tr_b16 v[52:53],v9 offset:8192
ds_read_b64_tr_b16 v[54:55],v9 offset:12288
M v[64:67],v[40:43],a[136:139],v[64:67]
ds_read_b64_tr_b16 v[56:57],v10
v_cvt_pk_bf16_f32 v204,v68,v69
M v[64:67],v[44:47],a[140:143],v[64:67]
ds_read_b64_tr_b16 v[58:59],v10 offset:4096
ds_read_b64_tr_b16 v[60:61],v10 offset:8192
buffer_load_dwordx4 v22,s[12:15],s48 offen offset:1024 nt lds
v_exp_f32 v71,v71
s_nop 0
v_cvt_pk_bf16_f32 v205,v70,v71
M v[68:71],v[32:35],a[144:147],0
ds_read_b64_tr_b16 v[62:63],v10 offset:12288
M v[68:71],v[36:39],a[148:151],v[68:71]
v_exp_f32 v72,v72
M v[68:71],v[40:43],a[152:155],v[68:71]
buffer_load_dwordx4 v23,s[12:15],s48 offen offset:2048 nt lds
M v[68:71],v[44:47],a[156:159],v[68:71]
v_exp_f32 v73,v73
v_exp_f32 v74,v74
v_exp_f32 v75,v75
v_cvt_pk_bf16_f32 v212,v72,v73
v_cvt_pk_bf16_f32 v213,v74,v75
M v[72:75],v[32:35],a[160:163],0
buffer_load_dwordx4 v24,s[12:15],s48 offen offset:3072 nt lds
s_add_u32 s48,s48,4096
M v[72:75],v[36:39],a[164:167],v[72:75]
v_exp_f32 v80,v80
M v[72:75],v[40:43],a[168:171],v[72:75]
s_mov_b32 m0,8192
M v[72:75],v[44:47],a[172:175],v[72:75]
buffer_load_dwordx4 v21,s[12:15],s48 offen nt lds
s_waitcnt lgkmcnt(0)
M a[0:3],v[48:51],v[192:195],a[0:3]
ds_read_b128 v[32:35],v8 offset:36864
v_exp_f32 v81,v81
s_nop 0
v_cvt_pk_bf16_f32 v198,v80,v81
v_exp_f32 v82,v82
v_exp_f32 v83,v83
s_nop 0
v_cvt_pk_bf16_f32 v199,v82,v83
s_nop 1
M a[0:3],v[52:55],v[196:199],a[0:3]
v_exp_f32 v84,v84
M a[32:35],v[48:51],v[200:203],a[32:35]
ds_read_b128 v[36:39],v8 offset:37120
buffer_load_dwordx4 v22,s[12:15],s48 offen offset:1024 nt lds
v_exp_f32 v85,v85
s_nop 0
v_cvt_pk_bf16_f32 v206,v84,v85
v_exp_f32 v86,v86
v_exp_f32 v87,v87
s_nop 0
v_cvt_pk_bf16_f32 v207,v86,v87
s_nop 1
M a[32:35],v[52:55],v[204:207],a[32:35]
v_exp_f32 v88,v88
M a[64:67],v[48:51],v[208:211],a[64:67]
ds_read_b128 v[40:43],v8 offset:37376
v_exp_f32 v89,v89
s_nop 0
v_cvt_pk_bf16_f32 v214,v88,v89
v_exp_f32 v90,v90
v_exp_f32 v91,v91
s_nop 0
v_cvt_pk_bf16_f32 v215,v90,v91
s_nop 1
M a[64:67],v[52:55],v[212:215],a[64:67]
buffer_load_dwordx4 v23,s[12:15],s48 offen offset:2048 nt lds
M a[4:7],v[56:59],v[192:195],a[4:7]
ds_read_b128 v[44:47],v8 offset:37632
buffer_load_dword v30,v31,s[24:27],0 offen
M a[4:7],v[60:63],v[196:199],a[4:7]
v_exp_f32 v96,v96
M a[36:39],v[56:59],v[200:203],a[36:39]
buffer_load_dwordx4 v24,s[12:15],s48 offen offset:3072 nt lds
s_add_u32 s48,s48,4096
M a[36:39],v[60:63],v[204:207],a[36:39]
v_exp_f32 v97,v97
M a[68:71],v[56:59],v[208:211],a[68:71]
s_mov_b32 m0,12288
v_cvt_pk_bf16_f32 v224,v96,v97
M a[68:71],v[60:63],v[212:215],a[68:71]
buffer_load_dwordx4 v21,s[12:15],s48 offen nt lds
M v[160:163],v[176:179],v[192:195],v[160:163]
v_exp_f32 v98,v98
M v[160:163],v[176:179],v[196:199],v[160:163]
buffer_load_dwordx4 v22,s[12:15],s48 offen offset:1024 nt lds
s_waitcnt lgkmcnt(0)
M v[80:83],v[32:35],a[128:131],0
ds_read_b64_tr_b16 v[48:49],v9 offset:256
ds_read_b64_tr_b16 v[50:51],v9 offset:4352
M v[80:83],v[36:39],a[132:135],v[80:83]
ds_read_b64_tr_b16 v[52:53],v9 offset:8448
ds_read_b64_tr_b16 v[54:55],v9 offset:12544
M v[80:83],v[40:43],a[136:139],v[80:83]
ds_read_b64_tr_b16 v[56:57],v10 offset:256
buffer_load_dwordx4 v23,s[12:15],s48 offen offset:2048 nt lds
M v[80:83],v[44:47],a[140:143],v[80:83]
ds_read_b64_tr_b16 v[58:59],v10 offset:4352
ds_read_b64_tr_b16 v[60:61],v10 offset:8448
M v[84:87],v[32:35],a[144:147],0
ds_read_b64_tr_b16 v[62:63],v10 offset:12544
M v[84:87],v[36:39],a[148:151],v[84:87]
buffer_load_dwordx4 v24,s[12:15],s48 offen offset:3072 nt lds
s_add_u32 s48,s48,4096
M v[84:87],v[40:43],a[152:155],v[84:87]
v_exp_f32 v99,v99
M v[84:87],v[44:47],a[156:159],v[84:87]
s_mov_b32 m0,114688
v_cvt_pk_bf16_f32 v225,v98,v99
M v[88:91],v[32:35],a[160:163],0
buffer_load_dwordx4 v25,s[16:19],s49 offen nt lds
M v[88:91],v[36:39],a[164:167],v[88:91]
v_exp_f32 v100,v100
M v[88:91],v[40:43],a[168:171],v[88:91]
v_exp_f32 v101,v101
M v[88:91],v[44:47],a[172:175],v[88:91]
buffer_load_dwordx4 v26,s[16:19],s49 offen offset:1024 nt lds
s_waitcnt lgkmcnt(0)
M a[8:11],v[48:51],v[192:195],a[8:11]
ds_read_b128 v[32:35],v8 offset:40960
v_cvt_pk_bf16_f32 v232,v100,v101
M a[8:11],v[52:55],v[196:199],a[8:11]
v_exp_f32 v102,v102
M a[40:43],v[48:51],v[200:203],a[40:43]
ds_read_b128 v[36:39],v8 offset:41216
buffer_load_dwordx4 v25,s[16:19],s49 offen offset:2048 nt lds
M a[40:43],v[52:55],v[204:207],a[40:43]
v_exp_f32 v103,v103
M a[72:75],v[48:51],v[208:211],a[72:75]
ds_read_b128 v[40:43],v8 offset:41472
v_cvt_pk_bf16_f32 v233,v102,v103
M a[72:75],v[52:55],v[212:215],a[72:75]
buffer_load_dwordx4 v26,s[16:19],s49 offen offset:3072 nt lds
s_add_u32 s49,s49,4096
M a[12:15],v[56:59],v[192:195],a[12:15]
ds_read_b128 v[44:47],v8 offset:41728
s_mov_b32 m0,118784
M a[12:15],v[60:63],v[196:199],a[12:15]
buffer_load_dwordx4 v25,s[16:19],s49 offen nt lds
M a[44:47],v[56:59],v[200:203],a[44:47]
v_exp_f32 v104,v104
M a[44:47],v[60:63],v[204:207],a[44:47]
v_exp_f32 v105,v105
M a[76:79],v[56:59],v[208:211],a[76:79]
buffer_load_dwordx4 v26,s[16:19],s49 offen offset:1024 nt lds
v_cvt_pk_bf16_f32 v240,v104,v105
M a[76:79],v[60:63],v[212:215],a[76:79]
v_exp_f32 v106,v106
M v[164:167],v[176:179],v[200:203],v[164:167]
v_exp_f32 v107,v107
M v[164:167],v[176:179],v[204:207],v[164:167]
buffer_load_dwordx4 v25,s[16:19],s49 offen offset:2048 nt lds
s_waitcnt lgkmcnt(0)
M v[96:99],v[32:35],a[128:131],0
ds_read_b64_tr_b16 v[48:49],v9 offset:512
ds_read_b64_tr_b16 v[50:51],v9 offset:4608
M v[96:99],v[36:39],a[132:135],v[96:99]
ds_read_b64_tr_b16 v[52:53],v9 offset:8704
ds_read_b64_tr_b16 v[54:55],v9 offset:12800
M v[96:99],v[40:43],a[136:139],v[96:99]
ds_read_b64_tr_b16 v[56:57],v10 offset:512
buffer_load_dwordx4 v26,s[16:19],s49 offen offset:3072 nt lds
s_add_u32 s49,s49,4096
M v[96:99],v[44:47],a[140:143],v[96:99]
ds_read_b64_tr_b16 v[58:59],v10 offset:4608
ds_read_b64_tr_b16 v[60:61],v10 offset:8704
M v[100:103],v[32:35],a[144:147],0
ds_read_b64_tr_b16 v[62:63],v10 offset:12800
s_mov_b32 m0,122880
M v[100:103],v[36:39],a[148:151],v[100:103]
buffer_load_dwordx4 v25,s[16:19],s49 offen nt lds
v_cvt_pk_bf16_f32 v241,v106,v107
M v[100:103],v[40:43],a[152:155],v[100:103]
v_exp_f32 v112,v112
M v[100:103],v[44:47],a[156:159],v[100:103]
v_exp_f32 v113,v113
M v[104:107],v[32:35],a[160:163],0
buffer_load_dwordx4 v26,s[16:19],s49 offen offset:1024 nt lds
v_cvt_pk_bf16_f32 v226,v112,v113
M v[104:107],v[36:39],a[164:167],v[104:107]
v_exp_f32 v114,v114
M v[104:107],v[40:43],a[168:171],v[104:107]
buffer_load_dwordx4 v25,s[16:19],s49 offen offset:2048 nt lds
M v[104:107],v[44:47],a[172:175],v[104:107]
s_waitcnt lgkmcnt(0)
M a[16:19],v[48:51],v[192:195],a[16:19]
ds_read_b128 v[32:35],v8 offset:45056
M a[16:19],v[52:55],v[196:199],a[16:19]
buffer_load_dwordx4 v26,s[16:19],s49 offen offset:3072 nt lds
s_add_u32 s49,s49,4096
M a[48:51],v[48:51],v[200:203],a[48:51]
ds_read_b128 v[36:39],v8 offset:45312
M a[48:51],v[52:55],v[204:207],a[48:51]
s_mov_b32 m0,126976
M a[80:83],v[48:51],v[208:211],a[80:83]
ds_read_b128 v[40:43],v8 offset:45568
buffer_load_dwordx4 v25,s[16:19],s49 offen nt lds
M a[80:83],v[52:55],v[212:215],a[80:83]
v_exp_f32 v115,v115
M a[20:23],v[56:59],v[192:195],a[20:23]
ds_read_b128 v[44:47],v8 offset:45824
v_cvt_pk_bf16_f32 v227,v114,v115
M a[20:23],v[60:63],v[196:199],a[20:23]
buffer_load_dwordx4 v26,s[16:19],s49 offen offset:1024 nt lds
M a[52:55],v[56:59],v[200:203],a[52:55]
v_exp_f32 v116,v116
M a[52:55],v[60:63],v[204:207],a[52:55]
v_exp_f32 v117,v117
M a[84:87],v[56:59],v[208:211],a[84:87]
buffer_load_dwordx4 v25,s[16:19],s49 offen offset:2048 nt lds
v_cvt_pk_bf16_f32 v234,v116,v117
M a[84:87],v[60:63],v[212:215],a[84:87]
v_exp_f32 v118,v118
M v[168:171],v[176:179],v[208:211],v[168:171]
v_exp_f32 v119,v119
M v[168:171],v[176:179],v[212:215],v[168:171]
buffer_load_dwordx4 v26,s[16:19],s49 offen offset:3072 nt lds
s_add_u32 s49,s49,4096
s_waitcnt lgkmcnt(0)
M v[112:115],v[32:35],a[128:131],0
ds_read_b64_tr_b16 v[48:49],v9 offset:768
ds_read_b64_tr_b16 v[50:51],v9 offset:4864
M v[112:115],v[36:39],a[132:135],v[112:115]
ds_read_b64_tr_b16 v[52:53],v9 offset:8960
ds_read_b64_tr_b16 v[54:55],v9 offset:13056
M v[112:115],v[40:43],a[136:139],v[112:115]
ds_read_b64_tr_b16 v[56:57],v10 offset:768
v_cvt_pk_bf16_f32 v235,v118,v119
M v[112:115],v[44:47],a[140:143],v[112:115]
ds_read_b64_tr_b16 v[58:59],v10 offset:4864
ds_read_b64_tr_b16 v[60:61],v10 offset:8960
M v[116:119],v[32:35],a[144:147],0
ds_read_b64_tr_b16 v[62:63],v10 offset:13056
M v[116:119],v[36:39],a[148:151],v[116:119]
v_exp_f32 v120,v120
M v[116:119],v[40:43],a[152:155],v[116:119]
v_exp_f32 v121,v121
M v[116:119],v[44:47],a[156:159],v[116:119]
v_exp_f32 v122,v122
v_exp_f32 v123,v123
v_cvt_pk_bf16_f32 v242,v120,v121
v_cvt_pk_bf16_f32 v243,v122,v123
M v[120:123],v[32:35],a[160:163],0
v_exp_f32 v128,v128
M v[120:123],v[36:39],a[164:167],v[120:123]
v_exp_f32 v129,v129
M v[120:123],v[40:43],a[168:171],v[120:123]
v_exp_f32 v130,v130
M v[120:123],v[44:47],a[172:175],v[120:123]
s_waitcnt vmcnt(49) lgkmcnt(0)
s_barrier
M a[24:27],v[48:51],v[192:195],a[24:27]
ds_read_b128 v[32:35],v8 offset:49152
s_mov_b32 m0,16384
M a[24:27],v[52:55],v[196:199],a[24:27]
buffer_load_dwordx4 v21,s[12:15],s48 offen nt lds
v_cvt_pk_bf16_f32 v228,v128,v129
M a[56:59],v[48:51],v[200:203],a[56:59]
ds_read_b128 v[36:39],v8 offset:49408
M a[56:59],v[52:55],v[204:207],a[56:59]
buffer_load_dwordx4 v22,s[12:15],s48 offen offset:1024 nt lds
M a[88:91],v[48:51],v[208:211],a[88:91]
ds_read_b128 v[40:43],v8 offset:49664
M a[88:91],v[52:55],v[212:215],a[88:91]
v_exp_f32 v131,v131
M a[28:31],v[56:59],v[192:195],a[28:31]
ds_read_b128 v[44:47],v8 offset:49920
buffer_load_dwordx4 v23,s[12:15],s48 offen offset:2048 nt lds
M a[28:31],v[60:63],v[196:199],a[28:31]
v_exp_f32 v132,v132
M a[60:63],v[56:59],v[200:203],a[60:63]
v_exp_f32 v133,v133
M a[60:63],v[60:63],v[204:207],a[60:63]
buffer_load_dwordx4 v24,s[12:15],s48 offen offset:3072 nt lds
s_add_u32 s48,s48,4096
M a[92:95],v[56:59],v[208:211],a[92:95]
v_exp_f32 v134,v134
M a[92:95],v[60:63],v[212:215],a[92:95]
s_mov_b32 m0,20480
s_waitcnt lgkmcnt(0)
v_cvt_pk_bf16_f32 v229,v130,v131
M v[128:131],v[32:35],a[128:131],0
ds_read_b64_tr_b16 v[48:49],v9 offset:16384
ds_read_b64_tr_b16 v[50:51],v9 offset:20480
buffer_load_dwordx4 v21,s[12:15],s48 offen nt lds
M v[128:131],v[36:39],a[132:135],v[128:131]
ds_read_b64_tr_b16 v[52:53],v9 offset:24576
ds_read_b64_tr_b16 v[54:55],v9 offset:28672
M v[128:131],v[40:43],a[136:139],v[128:131]
ds_read_b64_tr_b16 v[56:57],v10 offset:16384
v_cvt_pk_bf16_f32 v236,v132,v133
M v[128:131],v[44:47],a[140:143],v[128:131]
ds_read_b64_tr_b16 v[58:59],v10 offset:20480
ds_read_b64_tr_b16 v[60:61],v10 offset:24576
buffer_load_dwordx4 v22,s[12:15],s48 offen offset:1024 nt lds
v_exp_f32 v135,v135
s_nop 0
v_cvt_pk_bf16_f32 v237,v134,v135
M v[132:135],v[32:35],a[144:147],0
ds_read_b64_tr_b16 v[62:63],v10 offset:28672
M v[132:135],v[36:39],a[148:151],v[132:135]
v_exp_f32 v136,v136
M v[132:135],v[40:43],a[152:155],v[132:135]
buffer_load_dwordx4 v23,s[12:15],s48 offen offset:2048 nt lds
M v[132:135],v[44:47],a[156:159],v[132:135]
v_exp_f32 v137,v137
v_exp_f32 v138,v138
v_exp_f32 v139,v139
v_cvt_pk_bf16_f32 v244,v136,v137
v_cvt_pk_bf16_f32 v245,v138,v139
M v[136:139],v[32:35],a[160:163],0
buffer_load_dwordx4 v24,s[12:15],s48 offen offset:3072 nt lds
s_add_u32 s48,s48,4096
M v[136:139],v[36:39],a[164:167],v[136:139]
v_exp_f32 v144,v144
M v[136:139],v[40:43],a[168:171],v[136:139]
s_mov_b32 m0,24576
M v[136:139],v[44:47],a[172:175],v[136:139]
buffer_load_dwordx4 v21,s[12:15],s48 offen nt lds
s_waitcnt lgkmcnt(0)
M a[0:3],v[48:51],v[224:227],a[0:3]
ds_read_b128 v[32:35],v8 offset:53248
v_exp_f32 v145,v145
s_nop 0
v_cvt_pk_bf16_f32 v230,v144,v145
v_exp_f32 v146,v146
v_exp_f32 v147,v147
s_nop 0
v_cvt_pk_bf16_f32 v231,v146,v147
s_nop 1
M a[0:3],v[52:55],v[228:231],a[0:3]
v_exp_f32 v148,v148
M a[32:35],v[48:51],v[232:235],a[32:35]
ds_read_b128 v[36:39],v8 offset:53504
buffer_load_dwordx4 v22,s[12:15],s48 offen offset:1024 nt lds
v_exp_f32 v149,v149
s_nop 0
v_cvt_pk_bf16_f32 v238,v148,v149
v_exp_f32 v150,v150
v_exp_f32 v151,v151
s_nop 0
v_cvt_pk_bf16_f32 v239,v150,v151
s_nop 1
M a[32:35],v[52:55],v[236:239],a[32:35]
v_exp_f32 v152,v152
M a[64:67],v[48:51],v[240:243],a[64:67]
ds_read_b128 v[40:43],v8 offset:53760
v_exp_f32 v153,v153
s_nop 0
v_cvt_pk_bf16_f32 v246,v152,v153
v_exp_f32 v154,v154
v_exp_f32 v155,v155
s_nop 0
v_cvt_pk_bf16_f32 v247,v154,v155
s_nop 1
M a[64:67],v[52:55],v[244:247],a[64:67]
buffer_load_dwordx4 v23,s[12:15],s48 offen offset:2048 nt lds
M a[4:7],v[56:59],v[224:227],a[4:7]
ds_read_b128 v[44:47],v8 offset:54016
M a[4:7],v[60:63],v[228:231],a[4:7]
v_exp_f32 v64,v64
M a[36:39],v[56:59],v[232:235],a[36:39]
buffer_load_dwordx4 v24,s[12:15],s48 offen offset:3072 nt lds
s_add_u32 s48,s48,4096
M a[36:39],v[60:63],v[236:239],a[36:39]
v_exp_f32 v65,v65
M a[68:71],v[56:59],v[240:243],a[68:71]
s_mov_b32 m0,28672
v_cvt_pk_bf16_f32 v192,v64,v65
M a[68:71],v[60:63],v[244:247],a[68:71]
buffer_load_dwordx4 v21,s[12:15],s48 offen nt lds
M v[160:163],v[176:179],v[224:227],v[160:163]
v_exp_f32 v66,v66
M v[160:163],v[176:179],v[228:231],v[160:163]
buffer_load_dwordx4 v22,s[12:15],s48 offen offset:1024 nt lds
s_waitcnt lgkmcnt(0)
M v[144:147],v[32:35],a[128:131],0
ds_read_b64_tr_b16 v[48:49],v9 offset:16640
ds_read_b64_tr_b16 v[50:51],v9 offset:20736
M v[144:147],v[36:39],a[132:135],v[144:147]
ds_read_b64_tr_b16 v[52:53],v9 offset:24832
ds_read_b64_tr_b16 v[54:55],v9 offset:28928
M v[144:147],v[40:43],a[136:139],v[144:147]
ds_read_b64_tr_b16 v[56:57],v10 offset:16640
buffer_load_dwordx4 v23,s[12:15],s48 offen offset:2048 nt lds
M v[144:147],v[44:47],a[140:143],v[144:147]
ds_read_b64_tr_b16 v[58:59],v10 offset:20736
ds_read_b64_tr_b16 v[60:61],v10 offset:24832
M v[148:151],v[32:35],a[144:147],0
ds_read_b64_tr_b16 v[62:63],v10 offset:28928
M v[148:151],v[36:39],a[148:151],v[148:151]
buffer_load_dwordx4 v24,s[12:15],s48 offen offset:3072 nt lds
s_add_u32 s48,s48,4096
M v[148:151],v[40:43],a[152:155],v[148:151]
v_exp_f32 v67,v67
M v[148:151],v[44:47],a[156:159],v[148:151]
s_mov_b32 m0,65536
v_cvt_pk_bf16_f32 v193,v66,v67
M v[152:155],v[32:35],a[160:163],0
buffer_load_dwordx4 v25,s[16:19],s49 offen nt lds
M v[152:155],v[36:39],a[164:167],v[152:155]
v_exp_f32 v68,v68
M v[152:155],v[40:43],a[168:171],v[152:155]
v_exp_f32 v69,v69
M v[152:155],v[44:47],a[172:175],v[152:155]
buffer_load_dwordx4 v26,s[16:19],s49 offen offset:1024 nt lds
s_waitcnt lgkmcnt(0)
M a[8:11],v[48:51],v[224:227],a[8:11]
ds_read_b128 v[32:35],v8 offset:57344
v_cvt_pk_bf16_f32 v200,v68,v69
M a[8:11],v[52:55],v[228:231],a[8:11]
v_exp_f32 v70,v70
M a[40:43],v[48:51],v[232:235],a[40:43]
ds_read_b128 v[36:39],v8 offset:57600
buffer_load_dwordx4 v25,s[16:19],s49 offen offset:2048 nt lds
M a[40:43],v[52:55],v[236:239],a[40:43]
v_exp_f32 v71,v71
M a[72:75],v[48:51],v[240:243],a[72:75]
ds_read_b128 v[40:43],v8 offset:57856
v_cvt_pk_bf16_f32 v201,v70,v71
M a[72:75],v[52:55],v[244:247],a[72:75]
buffer_load_dwordx4 v26,s[16:19],s49 offen offset:3072 nt lds
s_add_u32 s49,s49,4096
M a[12:15],v[56:59],v[224:227],a[12:15]
ds_read_b128 v[44:47],v8 offset:58112
s_mov_b32 m0,69632
M a[12:15],v[60:63],v[228:231],a[12:15]
buffer_load_dwordx4 v25,s[16:19],s49 offen nt lds
M a[44:47],v[56:59],v[232:235],a[44:47]
v_exp_f32 v72,v72
M a[44:47],v[60:63],v[236:239],a[44:47]
v_exp_f32 v73,v73
M a[76:79],v[56:59],v[240:243],a[76:79]
buffer_load_dwordx4 v26,s[16:19],s49 offen offset:1024 nt lds
v_cvt_pk_bf16_f32 v208,v72,v73
M a[76:79],v[60:63],v[244:247],a[76:79]
v_exp_f32 v74,v74
M v[164:167],v[176:179],v[232:235],v[164:167]
v_exp_f32 v75,v75
M v[164:167],v[176:179],v[236:239],v[164:167]
buffer_load_dwordx4 v25,s[16:19],s49 offen offset:2048 nt lds
s_waitcnt lgkmcnt(0)
M v[64:67],v[32:35],a[128:131],0
ds_read_b64_tr_b16 v[48:49],v9 offset:16896
ds_read_b64_tr_b16 v[50:51],v9 offset:20992
M v[64:67],v[36:39],a[132:135],v[64:67]
ds_read_b64_tr_b16 v[52:53],v9 offset:25088
ds_read_b64_tr_b16 v[54:55],v9 offset:29184
M v[64:67],v[40:43],a[136:139],v[64:67]
ds_read_b64_tr_b16 v[56:57],v10 offset:16896
buffer_load_dwordx4 v26,s[16:19],s49 offen offset:3072 nt lds
s_add_u32 s49,s49,4096
M v[64:67],v[44:47],a[140:143],v[64:67]
ds_read_b64_tr_b16 v[58:59],v10 offset:20992
ds_read_b64_tr_b16 v[60:61],v10 offset:25088
M v[68:71],v[32:35],a[144:147],0
ds_read_b64_tr_b16 v[62:63],v10 offset:29184
s_mov_b32 m0,73728
M v[68:71],v[36:39],a[148:151],v[68:71]
buffer_load_dwordx4 v25,s[16:19],s49 offen nt lds
v_cvt_pk_bf16_f32 v209,v74,v75
M v[68:71],v[40:43],a[152:155],v[68:71]
v_exp_f32 v80,v80
M v[68:71],v[44:47],a[156:159],v[68:71]
v_exp_f32 v81,v81
M v[72:75],v[32:35],a[160:163],0
buffer_load_dwordx4 v26,s[16:19],s49 offen offset:1024 nt lds
v_cvt_pk_bf16_f32 v194,v80,v81
M v[72:75],v[36:39],a[164:167],v[72:75]
v_exp_f32 v82,v82
M v[72:75],v[40:43],a[168:171],v[72:75]
buffer_load_dwordx4 v25,s[16:19],s49 offen offset:2048 nt lds
M v[72:75],v[44:47],a[172:175],v[72:75]
s_waitcnt lgkmcnt(0)
M a[16:19],v[48:51],v[224:227],a[16:19]
ds_read_b128 v[32:35],v8 offset:61440
M a[16:19],v[52:55],v[228:231],a[16:19]
buffer_load_dwordx4 v26,s[16:19],s49 offen offset:3072 nt lds
s_add_u32 s49,s49,4096
M a[48:51],v[48:51],v[232:235],a[48:51]
ds_read_b128 v[36:39],v8 offset:61696
M a[48:51],v[52:55],v[236:239],a[48:51]
s_mov_b32 m0,77824
M a[80:83],v[48:51],v[240:243],a[80:83]
ds_read_b128 v[40:43],v8 offset:61952
buffer_load_dwordx4 v25,s[16:19],s49 offen nt lds
M a[80:83],v[52:55],v[244:247],a[80:83]
v_exp_f32 v83,v83
M a[20:23],v[56:59],v[224:227],a[20:23]
ds_read_b128 v[44:47],v8 offset:62208
v_cvt_pk_bf16_f32 v195,v82,v83
M a[20:23],v[60:63],v[228:231],a[20:23]
buffer_load_dwordx4 v26,s[16:19],s49 offen offset:1024 nt lds
M a[52:55],v[56:59],v[232:235],a[52:55]
v_exp_f32 v84,v84
M a[52:55],v[60:63],v[236:239],a[52:55]
v_exp_f32 v85,v85
M a[84:87],v[56:59],v[240:243],a[84:87]
buffer_load_dwordx4 v25,s[16:19],s49 offen offset:2048 nt lds
v_cvt_pk_bf16_f32 v202,v84,v85
M a[84:87],v[60:63],v[244:247],a[84:87]
v_exp_f32 v86,v86
M v[168:171],v[176:179],v[240:243],v[168:171]
v_exp_f32 v87,v87
M v[168:171],v[176:179],v[244:247],v[168:171]
buffer_load_dwordx4 v26,s[16:19],s49 offen offset:3072 nt lds
s_add_u32 s49,s49,4096
s_waitcnt lgkmcnt(0)
M v[80:83],v[32:35],a[128:131],0
ds_read_b64_tr_b16 v[48:49],v9 offset:17152
ds_read_b64_tr_b16 v[50:51],v9 offset:21248
M v[80:83],v[36:39],a[132:135],v[80:83]
ds_read_b64_tr_b16 v[52:53],v9 offset:25344
ds_read_b64_tr_b16 v[54:55],v9 offset:29440
M v[80:83],v[40:43],a[136:139],v[80:83]
ds_read_b64_tr_b16 v[56:57],v10 offset:17152
v_cvt_pk_bf16_f32 v203,v86,v87
M v[80:83],v[44:47],a[140:143],v[80:83]
ds_read_b64_tr_b16 v[58:59],v10 offset:21248
ds_read_b64_tr_b16 v[60:61],v10 offset:25344
M v[84:87],v[32:35],a[144:147],0
ds_read_b64_tr_b16 v[62:63],v10 offset:29440
M v[84:87],v[36:39],a[148:151],v[84:87]
v_exp_f32 v88,v88
M v[84:87],v[40:43],a[152:155],v[84:87]
v_exp_f32 v89,v89
M v[84:87],v[44:47],a[156:159],v[84:87]
v_exp_f32 v90,v90
v_exp_f32 v91,v91
v_cvt_pk_bf16_f32 v210,v88,v89
v_cvt_pk_bf16_f32 v211,v90,v91
M v[88:91],v[32:35],a[160:163],0
v_exp_f32 v96,v96
M v[88:91],v[36:39],a[164:167],v[88:91]
v_exp_f32 v97,v97
M v[88:91],v[40:43],a[168:171],v[88:91]
v_exp_f32 v98,v98
M v[88:91],v[44:47],a[172:175],v[88:91]
s_waitcnt vmcnt(48) lgkmcnt(0)
s_barrier
M a[24:27],v[48:51],v[224:227],a[24:27]
ds_read_b128 v[32:35],v8
s_mov_b32 m0,32768
M a[24:27],v[52:55],v[228:231],a[24:27]
buffer_load_dwordx4 v21,s[12:15],s48 offen nt lds
v_cvt_pk_bf16_f32 v196,v96,v97
M a[56:59],v[48:51],v[232:235],a[56:59]
ds_read_b128 v[36:39],v8 offset:256
M a[56:59],v[52:55],v[236:239],a[56:59]
buffer_load_dwordx4 v22,s[12:15],s48 offen offset:1024 nt lds
M a[88:91],v[48:51],v[240:243],a[88:91]
ds_read_b128 v[40:43],v8 offset:512
M a[88:91],v[52:55],v[244:247],a[88:91]
v_exp_f32 v99,v99
M a[28:31],v[56:59],v[224:227],a[28:31]
ds_read_b128 v[44:47],v8 offset:768
buffer_load_dwordx4 v23,s[12:15],s48 offen offset:2048 nt lds
M a[28:31],v[60:63],v[228:231],a[28:31]
v_exp_f32 v100,v100
M a[60:63],v[56:59],v[232:235],a[60:63]
v_exp_f32 v101,v101
M a[60:63],v[60:63],v[236:239],a[60:63]
buffer_load_dwordx4 v24,s[12:15],s48 offen offset:3072 nt lds
s_add_u32 s48,s48,4096
M a[92:95],v[56:59],v[240:243],a[92:95]
v_exp_f32 v102,v102
M a[92:95],v[60:63],v[244:247],a[92:95]
s_mov_b32 m0,36864
s_waitcnt lgkmcnt(0)
v_cvt_pk_bf16_f32 v197,v98,v99
M v[96:99],v[32:35],a[192:195],0
ds_read_b64_tr_b16 v[48:49],v9 offset:32768
ds_read_b64_tr_b16 v[50:51],v9 offset:36864
buffer_load_dwordx4 v21,s[12:15],s48 offen nt lds
M v[96:99],v[36:39],a[196:199],v[96:99]
ds_read_b64_tr_b16 v[52:53],v9 offset:40960
ds_read_b64_tr_b16 v[54:55],v9 offset:45056
M v[96:99],v[40:43],a[200:203],v[96:99]
ds_read_b64_tr_b16 v[56:57],v10 offset:32768
v_cvt_pk_bf16_f32 v204,v100,v101
M v[96:99],v[44:47],a[204:207],v[96:99]
ds_read_b64_tr_b16 v[58:59],v10 offset:36864
ds_read_b64_tr_b16 v[60:61],v10 offset:40960
buffer_load_dwordx4 v22,s[12:15],s48 offen offset:1024 nt lds
v_exp_f32 v103,v103
s_nop 0
v_cvt_pk_bf16_f32 v205,v102,v103
M v[100:103],v[32:35],a[208:211],0
ds_read_b64_tr_b16 v[62:63],v10 offset:45056
M v[100:103],v[36:39],a[212:215],v[100:103]
v_exp_f32 v104,v104
M v[100:103],v[40:43],a[216:219],v[100:103]
buffer_load_dwordx4 v23,s[12:15],s48 offen offset:2048 nt lds
M v[100:103],v[44:47],a[220:223],v[100:103]
v_exp_f32 v105,v105
v_exp_f32 v106,v106
v_exp_f32 v107,v107
v_cvt_pk_bf16_f32 v212,v104,v105
v_cvt_pk_bf16_f32 v213,v106,v107
M v[104:107],v[32:35],a[224:227],0
buffer_load_dwordx4 v24,s[12:15],s48 offen offset:3072 nt lds
s_add_u32 s48,s48,4096
M v[104:107],v[36:39],a[228:231],v[104:107]
v_exp_f32 v112,v112
M v[104:107],v[40:43],a[232:235],v[104:107]
s_mov_b32 m0,40960
M v[104:107],v[44:47],a[236:239],v[104:107]
buffer_load_dwordx4 v21,s[12:15],s48 offen nt lds
s_waitcnt lgkmcnt(0)
M a[0:3],v[48:51],v[192:195],a[0:3]
ds_read_b128 v[32:35],v8 offset:4096
v_exp_f32 v113,v113
s_nop 0
v_cvt_pk_bf16_f32 v198,v112,v113
v_exp_f32 v114,v114
v_exp_f32 v115,v115
s_nop 0
v_cvt_pk_bf16_f32 v199,v114,v115
s_nop 1
M a[0:3],v[52:55],v[196:199],a[0:3]
v_exp_f32 v116,v116
M a[32:35],v[48:51],v[200:203],a[32:35]
ds_read_b128 v[36:39],v8 offset:4352
buffer_load_dwordx4 v22,s[12:15],s48 offen offset:1024 nt lds
v_exp_f32 v117,v117
s_nop 0
v_cvt_pk_bf16_f32 v206,v116,v117
v_exp_f32 v118,v118
v_exp_f32 v119,v119
s_nop 0
v_cvt_pk_bf16_f32 v207,v118,v119
s_nop 1
M a[32:35],v[52:55],v[204:207],a[32:35]
v_exp_f32 v120,v120
M a[64:67],v[48:51],v[208:211],a[64:67]
ds_read_b128 v[40:43],v8 offset:4608
v_exp_f32 v121,v121
s_nop 0
v_cvt_pk_bf16_f32 v214,v120,v121
v_exp_f32 v122,v122
v_exp_f32 v123,v123
s_nop 0
v_cvt_pk_bf16_f32 v215,v122,v123
s_nop 1
M a[64:67],v[52:55],v[212:215],a[64:67]
buffer_load_dwordx4 v23,s[12:15],s48 offen offset:2048 nt lds
M a[4:7],v[56:59],v[192:195],a[4:7]
ds_read_b128 v[44:47],v8 offset:4864
M a[4:7],v[60:63],v[196:199],a[4:7]
v_exp_f32 v128,v128
M a[36:39],v[56:59],v[200:203],a[36:39]
buffer_load_dwordx4 v24,s[12:15],s48 offen offset:3072 nt lds
s_add_u32 s48,s48,4096
M a[36:39],v[60:63],v[204:207],a[36:39]
v_exp_f32 v129,v129
M a[68:71],v[56:59],v[208:211],a[68:71]
s_mov_b32 m0,45056
v_cvt_pk_bf16_f32 v224,v128,v129
M a[68:71],v[60:63],v[212:215],a[68:71]
buffer_load_dwordx4 v21,s[12:15],s48 offen nt lds
M v[160:163],v[176:179],v[192:195],v[160:163]
v_exp_f32 v130,v130
M v[160:163],v[176:179],v[196:199],v[160:163]
buffer_load_dwordx4 v22,s[12:15],s48 offen offset:1024 nt lds
s_waitcnt lgkmcnt(0)
M v[112:115],v[32:35],a[192:195],0
ds_read_b64_tr_b16 v[48:49],v9 offset:33024
ds_read_b64_tr_b16 v[50:51],v9 offset:37120
M v[112:115],v[36:39],a[196:199],v[112:115]
ds_read_b64_tr_b16 v[52:53],v9 offset:41216
ds_read_b64_tr_b16 v[54:55],v9 offset:45312
M v[112:115],v[40:43],a[200:203],v[112:115]
ds_read_b64_tr_b16 v[56:57],v10 offset:33024
buffer_load_dwordx4 v23,s[12:15],s48 offen offset:2048 nt lds
M v[112:115],v[44:47],a[204:207],v[112:115]
ds_read_b64_tr_b16 v[58:59],v10 offset:37120
ds_read_b64_tr_b16 v[60:61],v10 offset:41216
M v[116:119],v[32:35],a[208:211],0
ds_read_b64_tr_b16 v[62:63],v10 offset:45312
M v[116:119],v[36:39],a[212:215],v[116:119]
buffer_load_dwordx4 v24,s[12:15],s48 offen offset:3072 nt lds
s_add_u32 s48,s48,4096
M v[116:119],v[40:43],a[216:219],v[116:119]
v_exp_f32 v131,v131
M v[116:119],v[44:47],a[220:223],v[116:119]
s_mov_b32 m0,81920
v_cvt_pk_bf16_f32 v225,v130,v131
M v[120:123],v[32:35],a[224:227],0
buffer_load_dwordx4 v25,s[16:19],s49 offen nt lds
M v[120:123],v[36:39],a[228:231],v[120:123]
v_exp_f32 v132,v132
M v[120:123],v[40:43],a[232:235],v[120:123]
v_exp_f32 v133,v133
M v[120:123],v[44:47],a[236:239],v[120:123]
buffer_load_dwordx4 v26,s[16:19],s49 offen offset:1024 nt lds
s_waitcnt lgkmcnt(0)
M a[8:11],v[48:51],v[192:195],a[8:11]
ds_read_b128 v[32:35],v8 offset:8192
v_cvt_pk_bf16_f32 v232,v132,v133
M a[8:11],v[52:55],v[196:199],a[8:11]
v_exp_f32 v134,v134
M a[40:43],v[48:51],v[200:203],a[40:43]
ds_read_b128 v[36:39],v8 offset:8448
buffer_load_dwordx4 v25,s[16:19],s49 offen offset:2048 nt lds
M a[40:43],v[52:55],v[204:207],a[40:43]
v_exp_f32 v135,v135
M a[72:75],v[48:51],v[208:211],a[72:75]
ds_read_b128 v[40:43],v8 offset:8704
v_cvt_pk_bf16_f32 v233,v134,v135
M a[72:75],v[52:55],v[212:215],a[72:75]
buffer_load_dwordx4 v26,s[16:19],s49 offen offset:3072 nt lds
s_add_u32 s49,s49,4096
M a[12:15],v[56:59],v[192:195],a[12:15]
ds_read_b128 v[44:47],v8 offset:8960
s_mov_b32 m0,86016
M a[12:15],v[60:63],v[196:199],a[12:15]
buffer_load_dwordx4 v25,s[16:19],s49 offen nt lds
M a[44:47],v[56:59],v[200:203],a[44:47]
v_exp_f32 v136,v136
M a[44:47],v[60:63],v[204:207],a[44:47]
v_exp_f32 v137,v137
M a[76:79],v[56:59],v[208:211],a[76:79]
buffer_load_dwordx4 v26,s[16:19],s49 offen offset:1024 nt lds
v_cvt_pk_bf16_f32 v240,v136,v137
M a[76:79],v[60:63],v[212:215],a[76:79]
v_exp_f32 v138,v138
M v[164:167],v[176:179],v[200:203],v[164:167]
v_exp_f32 v139,v139
M v[164:167],v[176:179],v[204:207],v[164:167]
buffer_load_dwordx4 v25,s[16:19],s49 offen offset:2048 nt lds
s_waitcnt lgkmcnt(0)
M v[128:131],v[32:35],a[192:195],0
ds_read_b64_tr_b16 v[48:49],v9 offset:33280
ds_read_b64_tr_b16 v[50:51],v9 offset:37376
M v[128:131],v[36:39],a[196:199],v[128:131]
ds_read_b64_tr_b16 v[52:53],v9 offset:41472
ds_read_b64_tr_b16 v[54:55],v9 offset:45568
M v[128:131],v[40:43],a[200:203],v[128:131]
ds_read_b64_tr_b16 v[56:57],v10 offset:33280
buffer_load_dwordx4 v26,s[16:19],s49 offen offset:3072 nt lds
s_add_u32 s49,s49,4096
M v[128:131],v[44:47],a[204:207],v[128:131]
ds_read_b64_tr_b16 v[58:59],v10 offset:37376
ds_read_b64_tr_b16 v[60:61],v10 offset:41472
M v[132:135],v[32:35],a[208:211],0
ds_read_b64_tr_b16 v[62:63],v10 offset:45568
s_mov_b32 m0,90112
M v[132:135],v[36:39],a[212:215],v[132:135]
buffer_load_dwordx4 v25,s[16:19],s49 offen nt lds
v_cvt_pk_bf16_f32 v241,v138,v139
M v[132:135],v[40:43],a[216:219],v[132:135]
v_exp_f32 v144,v144
M v[132:135],v[44:47],a[220:223],v[132:135]
v_exp_f32 v145,v145
M v[136:139],v[32:35],a[224:227],0
buffer_load_dwordx4 v26,s[16:19],s49 offen offset:1024 nt lds
v_cvt_pk_bf16_f32 v226,v144,v145
M v[136:139],v[36:39],a[228:231],v[136:139]
v_exp_f32 v146,v146
M v[136:139],v[40:43],a[232:235],v[136:139]
buffer_load_dwordx4 v25,s[16:19],s49 offen offset:2048 nt lds
M v[136:139],v[44:47],a[236:239],v[136:139]
s_waitcnt lgkmcnt(0)
M a[16:19],v[48:51],v[192:195],a[16:19]
ds_read_b128 v[32:35],v8 offset:12288
M a[16:19],v[52:55],v[196:199],a[16:19]
buffer_load_dwordx4 v26,s[16:19],s49 offen offset:3072 nt lds
s_add_u32 s49,s49,4096
M a[48:51],v[48:51],v[200:203],a[48:51]
ds_read_b128 v[36:39],v8 offset:12544
M a[48:51],v[52:55],v[204:207],a[48:51]
s_mov_b32 m0,94208
M a[80:83],v[48:51],v[208:211],a[80:83]
ds_read_b128 v[40:43],v8 offset:12800
buffer_load_dwordx4 v25,s[16:19],s49 offen nt lds
M a[80:83],v[52:55],v[212:215],a[80:83]
v_exp_f32 v147,v147
M a[20:23],v[56:59],v[192:195],a[20:23]
ds_read_b128 v[44:47],v8 offset:13056
v_cvt_pk_bf16_f32 v227,v146,v147
M a[20:23],v[60:63],v[196:199],a[20:23]
buffer_load_dwordx4 v26,s[16:19],s49 offen offset:1024 nt lds
M a[52:55],v[56:59],v[200:203],a[52:55]
v_exp_f32 v148,v148
M a[52:55],v[60:63],v[204:207],a[52:55]
v_exp_f32 v149,v149
M a[84:87],v[56:59],v[208:211],a[84:87]
buffer_load_dwordx4 v25,s[16:19],s49 offen offset:2048 nt lds
v_cvt_pk_bf16_f32 v234,v148,v149
M a[84:87],v[60:63],v[212:215],a[84:87]
v_exp_f32 v150,v150
M v[168:171],v[176:179],v[208:211],v[168:171]
v_exp_f32 v151,v151
M v[168:171],v[176:179],v[212:215],v[168:171]
buffer_load_dwordx4 v26,s[16:19],s49 offen offset:3072 nt lds
s_add_u32 s49,s49,4096
s_waitcnt lgkmcnt(0)
M v[144:147],v[32:35],a[192:195],0
ds_read_b64_tr_b16 v[48:49],v9 offset:33536
ds_read_b64_tr_b16 v[50:51],v9 offset:37632
M v[144:147],v[36:39],a[196:199],v[144:147]
ds_read_b64_tr_b16 v[52:53],v9 offset:41728
ds_read_b64_tr_b16 v[54:55],v9 offset:45824
M v[144:147],v[40:43],a[200:203],v[144:147]
ds_read_b64_tr_b16 v[56:57],v10 offset:33536
v_cvt_pk_bf16_f32 v235,v150,v151
M v[144:147],v[44:47],a[204:207],v[144:147]
ds_read_b64_tr_b16 v[58:59],v10 offset:37632
ds_read_b64_tr_b16 v[60:61],v10 offset:41728
M v[148:151],v[32:35],a[208:211],0
ds_read_b64_tr_b16 v[62:63],v10 offset:45824
M v[148:151],v[36:39],a[212:215],v[148:151]
v_exp_f32 v152,v152
M v[148:151],v[40:43],a[216:219],v[148:151]
v_exp_f32 v153,v153
M v[148:151],v[44:47],a[220:223],v[148:151]
v_exp_f32 v154,v154
v_exp_f32 v155,v155
v_cvt_pk_bf16_f32 v242,v152,v153
v_cvt_pk_bf16_f32 v243,v154,v155
M v[152:155],v[32:35],a[224:227],0
v_exp_f32 v64,v64
M v[152:155],v[36:39],a[228:231],v[152:155]
v_exp_f32 v65,v65
M v[152:155],v[40:43],a[232:235],v[152:155]
v_exp_f32 v66,v66
M v[152:155],v[44:47],a[236:239],v[152:155]
s_waitcnt vmcnt(48) lgkmcnt(0)
s_barrier
M a[24:27],v[48:51],v[192:195],a[24:27]
ds_read_b128 v[32:35],v8 offset:16384
s_mov_b32 m0,49152
M a[24:27],v[52:55],v[196:199],a[24:27]
buffer_load_dwordx4 v21,s[12:15],s48 offen nt lds
v_cvt_pk_bf16_f32 v228,v64,v65
M a[56:59],v[48:51],v[200:203],a[56:59]
ds_read_b128 v[36:39],v8 offset:16640
M a[56:59],v[52:55],v[204:207],a[56:59]
buffer_load_dwordx4 v22,s[12:15],s48 offen offset:1024 nt lds
M a[88:91],v[48:51],v[208:211],a[88:91]
ds_read_b128 v[40:43],v8 offset:16896
M a[88:91],v[52:55],v[212:215],a[88:91]
v_exp_f32 v67,v67
M a[28:31],v[56:59],v[192:195],a[28:31]
ds_read_b128 v[44:47],v8 offset:17152
buffer_load_dwordx4 v23,s[12:15],s48 offen offset:2048 nt lds
M a[28:31],v[60:63],v[196:199],a[28:31]
v_exp_f32 v68,v68
M a[60:63],v[56:59],v[200:203],a[60:63]
v_exp_f32 v69,v69
M a[60:63],v[60:63],v[204:207],a[60:63]
buffer_load_dwordx4 v24,s[12:15],s48 offen offset:3072 nt lds
s_add_u32 s48,s48,4096
M a[92:95],v[56:59],v[208:211],a[92:95]
v_exp_f32 v70,v70
M a[92:95],v[60:63],v[212:215],a[92:95]
s_mov_b32 m0,53248
s_waitcnt lgkmcnt(0)
v_cvt_pk_bf16_f32 v229,v66,v67
M v[64:67],v[32:35],a[192:195],0
ds_read_b64_tr_b16 v[48:49],v9 offset:49152
ds_read_b64_tr_b16 v[50:51],v9 offset:53248
buffer_load_dwordx4 v21,s[12:15],s48 offen nt lds
M v[64:67],v[36:39],a[196:199],v[64:67]
ds_read_b64_tr_b16 v[52:53],v9 offset:57344
ds_read_b64_tr_b16 v[54:55],v9 offset:61440
M v[64:67],v[40:43],a[200:203],v[64:67]
ds_read_b64_tr_b16 v[56:57],v10 offset:49152
v_cvt_pk_bf16_f32 v236,v68,v69
M v[64:67],v[44:47],a[204:207],v[64:67]
ds_read_b64_tr_b16 v[58:59],v10 offset:53248
ds_read_b64_tr_b16 v[60:61],v10 offset:57344
buffer_load_dwordx4 v22,s[12:15],s48 offen offset:1024 nt lds
v_exp_f32 v71,v71
s_nop 0
v_cvt_pk_bf16_f32 v237,v70,v71
M v[68:71],v[32:35],a[208:211],0
ds_read_b64_tr_b16 v[62:63],v10 offset:61440
M v[68:71],v[36:39],a[212:215],v[68:71]
v_exp_f32 v72,v72
M v[68:71],v[40:43],a[216:219],v[68:71]
buffer_load_dwordx4 v23,s[12:15],s48 offen offset:2048 nt lds
M v[68:71],v[44:47],a[220:223],v[68:71]
v_exp_f32 v73,v73
v_exp_f32 v74,v74
v_exp_f32 v75,v75
v_cvt_pk_bf16_f32 v244,v72,v73
v_cvt_pk_bf16_f32 v245,v74,v75
M v[72:75],v[32:35],a[224:227],0
buffer_load_dwordx4 v24,s[12:15],s48 offen offset:3072 nt lds
s_add_u32 s48,s48,4096
M v[72:75],v[36:39],a[228:231],v[72:75]
v_exp_f32 v80,v80
M v[72:75],v[40:43],a[232:235],v[72:75]
s_mov_b32 m0,57344
M v[72:75],v[44:47],a[236:239],v[72:75]
buffer_load_dwordx4 v21,s[12:15],s48 offen nt lds
s_waitcnt lgkmcnt(0)
M v[160:163],v[176:179],v[224:227],v[160:163]
ds_read_b128 v[32:35],v8 offset:20480
v_exp_f32 v81,v81
s_nop 0
v_cvt_pk_bf16_f32 v230,v80,v81
v_exp_f32 v82,v82
v_exp_f32 v83,v83
s_nop 0
v_cvt_pk_bf16_f32 v231,v82,v83
s_nop 1
M v[160:163],v[176:179],v[228:231],v[160:163]
v_exp_f32 v84,v84
M v[164:167],v[176:179],v[232:235],v[164:167]
ds_read_b128 v[36:39],v8 offset:20736
buffer_load_dwordx4 v22,s[12:15],s48 offen offset:1024 nt lds
v_exp_f32 v85,v85
s_nop 0
v_cvt_pk_bf16_f32 v238,v84,v85
v_exp_f32 v86,v86
v_exp_f32 v87,v87
s_nop 0
v_cvt_pk_bf16_f32 v239,v86,v87
s_nop 1
M v[164:167],v[176:179],v[236:239],v[164:167]
v_exp_f32 v88,v88
M v[168:171],v[176:179],v[240:243],v[168:171]
ds_read_b128 v[40:43],v8 offset:20992
v_exp_f32 v89,v89
s_nop 0
v_cvt_pk_bf16_f32 v246,v88,v89
v_exp_f32 v90,v90
v_exp_f32 v91,v91
s_nop 0
v_cvt_pk_bf16_f32 v247,v90,v91
s_nop 1
M v[168:171],v[176:179],v[244:247],v[168:171]
buffer_load_dwordx4 v23,s[12:15],s48 offen offset:2048 nt lds
M a[0:3],v[48:51],v[224:227],a[0:3]
ds_read_b128 v[44:47],v8 offset:21248
buffer_load_dword v30,v31,s[24:27],0 offen
M a[0:3],v[52:55],v[228:231],a[0:3]
v_exp_f32 v96,v96
M a[32:35],v[48:51],v[232:235],a[32:35]
buffer_load_dwordx4 v24,s[12:15],s48 offen offset:3072 nt lds
s_add_u32 s48,s48,4096
M a[32:35],v[52:55],v[236:239],a[32:35]
v_exp_f32 v97,v97
M a[64:67],v[48:51],v[240:243],a[64:67]
s_mov_b32 m0,61440
v_cvt_pk_bf16_f32 v192,v96,v97
M a[64:67],v[52:55],v[244:247],a[64:67]
buffer_load_dwordx4 v21,s[12:15],s48 offen nt lds
M a[4:7],v[56:59],v[224:227],a[4:7]
v_exp_f32 v98,v98
M a[4:7],v[60:63],v[228:231],a[4:7]
buffer_load_dwordx4 v22,s[12:15],s48 offen offset:1024 nt lds
M a[36:39],v[56:59],v[232:235],a[36:39]
v_exp_f32 v99,v99
M a[36:39],v[60:63],v[236:239],a[36:39]
v_exp_f32 v100,v100
M a[68:71],v[56:59],v[240:243],a[68:71]
buffer_load_dwordx4 v23,s[12:15],s48 offen offset:2048 nt lds
v_cvt_pk_bf16_f32 v193,v98,v99
M a[68:71],v[60:63],v[244:247],a[68:71]
s_waitcnt lgkmcnt(0)
M v[80:83],v[32:35],a[192:195],0
ds_read_b64_tr_b16 v[48:49],v9 offset:49408
ds_read_b64_tr_b16 v[50:51],v9 offset:53504
M v[80:83],v[36:39],a[196:199],v[80:83]
ds_read_b64_tr_b16 v[52:53],v9 offset:57600
ds_read_b64_tr_b16 v[54:55],v9 offset:61696
buffer_load_dwordx4 v24,s[12:15],s48 offen offset:3072 nt lds
s_add_u32 s48,s48,4096
M v[80:83],v[40:43],a[200:203],v[80:83]
ds_read_b64_tr_b16 v[56:57],v10 offset:49408
M v[80:83],v[44:47],a[204:207],v[80:83]
ds_read_b64_tr_b16 v[58:59],v10 offset:53504
ds_read_b64_tr_b16 v[60:61],v10 offset:57600
s_mov_b32 m0,98304
M v[84:87],v[32:35],a[208:211],0
ds_read_b64_tr_b16 v[62:63],v10 offset:61696
buffer_load_dwordx4 v25,s[16:19],s49 offen nt lds
M v[84:87],v[36:39],a[212:215],v[84:87]
v_exp_f32 v101,v101
M v[84:87],v[40:43],a[216:219],v[84:87]
v_exp_f32 v102,v102
M v[84:87],v[44:47],a[220:223],v[84:87]
buffer_load_dwordx4 v26,s[16:19],s49 offen offset:1024 nt lds
v_cvt_pk_bf16_f32 v200,v100,v101
M v[88:91],v[32:35],a[224:227],0
v_exp_f32 v103,v103
M v[88:91],v[36:39],a[228:231],v[88:91]
v_exp_f32 v104,v104
M v[88:91],v[40:43],a[232:235],v[88:91]
buffer_load_dwordx4 v25,s[16:19],s49 offen offset:2048 nt lds
v_cvt_pk_bf16_f32 v201,v102,v103
M v[88:91],v[44:47],a[236:239],v[88:91]
s_waitcnt lgkmcnt(0)
M a[8:11],v[48:51],v[224:227],a[8:11]
ds_read_b128 v[32:35],v8 offset:24576
M a[8:11],v[52:55],v[228:231],a[8:11]
buffer_load_dwordx4 v26,s[16:19],s49 offen offset:3072 nt lds
s_add_u32 s49,s49,4096
M a[40:43],v[48:51],v[232:235],a[40:43]
ds_read_b128 v[36:39],v8 offset:24832
s_mov_b32 m0,102400
M a[40:43],v[52:55],v[236:239],a[40:43]
buffer_load_dwordx4 v25,s[16:19],s49 offen nt lds
M a[72:75],v[48:51],v[240:243],a[72:75]
ds_read_b128 v[40:43],v8 offset:25088
M a[72:75],v[52:55],v[244:247],a[72:75]
v_exp_f32 v105,v105
M a[12:15],v[56:59],v[224:227],a[12:15]
ds_read_b128 v[44:47],v8 offset:25344
buffer_load_dwordx4 v26,s[16:19],s49 offen offset:1024 nt lds
M a[12:15],v[60:63],v[228:231],a[12:15]
v_exp_f32 v106,v106
M a[44:47],v[56:59],v[232:235],a[44:47]
v_exp_f32 v107,v107
M a[44:47],v[60:63],v[236:239],a[44:47]
buffer_load_dwordx4 v25,s[16:19],s49 offen offset:2048 nt lds
v_cvt_pk_bf16_f32 v208,v104,v105
M a[76:79],v[56:59],v[240:243],a[76:79]
v_exp_f32 v112,v112
M a[76:79],v[60:63],v[244:247],a[76:79]
s_waitcnt lgkmcnt(0)
v_cvt_pk_bf16_f32 v209,v106,v107
M v[96:99],v[32:35],a[192:195],0
ds_read_b64_tr_b16 v[48:49],v9 offset:49664
ds_read_b64_tr_b16 v[50:51],v9 offset:53760
buffer_load_dwordx4 v26,s[16:19],s49 offen offset:3072 nt lds
s_add_u32 s49,s49,4096
M v[96:99],v[36:39],a[196:199],v[96:99]
ds_read_b64_tr_b16 v[52:53],v9 offset:57856
ds_read_b64_tr_b16 v[54:55],v9 offset:61952
M v[96:99],v[40:43],a[200:203],v[96:99]
ds_read_b64_tr_b16 v[56:57],v10 offset:49664
s_mov_b32 m0,106496
M v[96:99],v[44:47],a[204:207],v[96:99]
ds_read_b64_tr_b16 v[58:59],v10 offset:53760
ds_read_b64_tr_b16 v[60:61],v10 offset:57856
buffer_load_dwordx4 v25,s[16:19],s49 offen nt lds
M v[100:103],v[32:35],a[208:211],0
ds_read_b64_tr_b16 v[62:63],v10 offset:61952
M v[100:103],v[36:39],a[212:215],v[100:103]
v_exp_f32 v113,v113
M v[100:103],v[40:43],a[216:219],v[100:103]
buffer_load_dwordx4 v26,s[16:19],s49 offen offset:1024 nt lds
v_cvt_pk_bf16_f32 v194,v112,v113
M v[100:103],v[44:47],a[220:223],v[100:103]
v_exp_f32 v114,v114
M v[104:107],v[32:35],a[224:227],0
buffer_load_dwordx4 v25,s[16:19],s49 offen offset:2048 nt lds
M v[104:107],v[36:39],a[228:231],v[104:107]
v_exp_f32 v115,v115
M v[104:107],v[40:43],a[232:235],v[104:107]
v_exp_f32 v116,v116
M v[104:107],v[44:47],a[236:239],v[104:107]
buffer_load_dwordx4 v26,s[16:19],s49 offen offset:3072 nt lds
s_add_u32 s49,s49,4096
s_waitcnt lgkmcnt(0)
M a[16:19],v[48:51],v[224:227],a[16:19]
ds_read_b128 v[32:35],v8 offset:28672
v_cvt_pk_bf16_f32 v195,v114,v115
M a[16:19],v[52:55],v[228:231],a[16:19]
s_mov_b32 m0,110592
M a[48:51],v[48:51],v[232:235],a[48:51]
ds_read_b128 v[36:39],v8 offset:28928
buffer_load_dwordx4 v25,s[16:19],s49 offen nt lds
M a[48:51],v[52:55],v[236:239],a[48:51]
v_exp_f32 v117,v117
M a[80:83],v[48:51],v[240:243],a[80:83]
ds_read_b128 v[40:43],v8 offset:29184
v_cvt_pk_bf16_f32 v202,v116,v117
M a[80:83],v[52:55],v[244:247],a[80:83]
buffer_load_dwordx4 v26,s[16:19],s49 offen offset:1024 nt lds
M a[20:23],v[56:59],v[224:227],a[20:23]
ds_read_b128 v[44:47],v8 offset:29440
M a[20:23],v[60:63],v[228:231],a[20:23]
v_exp_f32 v118,v118
M a[52:55],v[56:59],v[232:235],a[52:55]
buffer_load_dwordx4 v25,s[16:19],s49 offen offset:2048 nt lds
M a[52:55],v[60:63],v[236:239],a[52:55]
v_exp_f32 v119,v119
M a[84:87],v[56:59],v[240:243],a[84:87]
v_exp_f32 v120,v120
M a[84:87],v[60:63],v[244:247],a[84:87]
buffer_load_dwordx4 v26,s[16:19],s49 offen offset:3072 nt lds
s_add_u32 s49,s49,4096
s_waitcnt lgkmcnt(0)
M v[112:115],v[32:35],a[192:195],0
ds_read_b64_tr_b16 v[48:49],v9 offset:49920
ds_read_b64_tr_b16 v[50:51],v9 offset:54016
M v[112:115],v[36:39],a[196:199],v[112:115]
ds_read_b64_tr_b16 v[52:53],v9 offset:58112
ds_read_b64_tr_b16 v[54:55],v9 offset:62208
M v[112:115],v[40:43],a[200:203],v[112:115]
ds_read_b64_tr_b16 v[56:57],v10 offset:49920
v_cvt_pk_bf16_f32 v203,v118,v119
M v[112:115],v[44:47],a[204:207],v[112:115]
ds_read_b64_tr_b16 v[58:59],v10 offset:54016
ds_read_b64_tr_b16 v[60:61],v10 offset:58112
M v[116:119],v[32:35],a[208:211],0
ds_read_b64_tr_b16 v[62:63],v10 offset:62208
M v[116:119],v[36:39],a[212:215],v[116:119]
v_exp_f32 v121,v121
M v[116:119],v[40:43],a[216:219],v[116:119]
v_exp_f32 v122,v122
M v[116:119],v[44:47],a[220:223],v[116:119]
v_exp_f32 v123,v123
v_cvt_pk_bf16_f32 v210,v120,v121
v_cvt_pk_bf16_f32 v211,v122,v123
M v[120:123],v[32:35],a[224:227],0
v_exp_f32 v128,v128
M v[120:123],v[36:39],a[228:231],v[120:123]
v_exp_f32 v129,v129
M v[120:123],v[40:43],a[232:235],v[120:123]
v_exp_f32 v130,v130
M v[120:123],v[44:47],a[236:239],v[120:123]
s_waitcnt vmcnt(49) lgkmcnt(0)
s_barrier
M a[24:27],v[48:51],v[224:227],a[24:27]
ds_read_b128 v[32:35],v8 offset:32768
s_mov_b32 m0,0
M a[24:27],v[52:55],v[228:231],a[24:27]
buffer_load_dwordx4 v21,s[12:15],s48 offen nt lds
v_cvt_pk_bf16_f32 v196,v128,v129
M a[56:59],v[48:51],v[232:235],a[56:59]
ds_read_b128 v[36:39],v8 offset:33024
v_accvgpr_read_b32 v180,a0
M a[56:59],v[52:55],v[236:239],a[56:59]
buffer_load_dwordx4 v22,s[12:15],s48 offen offset:1024 nt lds
v_accvgpr_read_b32 v181,a1
M a[88:91],v[48:51],v[240:243],a[88:91]
ds_read_b128 v[40:43],v8 offset:33280
v_accvgpr_read_b32 v183,a3
M a[88:91],v[52:55],v[244:247],a[88:91]
v_exp_f32 v131,v131
M a[28:31],v[56:59],v[224:227],a[28:31]
ds_read_b128 v[44:47],v8 offset:33536
buffer_load_dwordx4 v23,s[12:15],s48 offen offset:2048 nt lds
M a[28:31],v[60:63],v[228:231],a[28:31]
v_exp_f32 v132,v132
M a[60:63],v[56:59],v[232:235],a[60:63]
v_exp_f32 v133,v133
M a[60:63],v[60:63],v[236:239],a[60:63]
buffer_load_dwordx4 v24,s[12:15],s48 offen offset:3072 nt lds
s_add_u32 s48,s48,4096
M a[92:95],v[56:59],v[240:243],a[92:95]
v_exp_f32 v134,v134
M a[92:95],v[60:63],v[244:247],a[92:95]
s_mov_b32 m0,4096
s_waitcnt lgkmcnt(0)
v_cvt_pk_bf16_f32 v197,v130,v131
M v[128:131],v[32:35],a[192:195],0
ds_read_b64_tr_b16 v[48:49],v9
ds_read_b64_tr_b16 v[50:51],v9 offset:4096
buffer_load_dwordx4 v21,s[12:15],s48 offen nt lds
M v[128:131],v[36:39],a[196:199],v[128:131]
ds_read_b64_tr_b16 v[52:53],v9 offset:8192
ds_read_b64_tr_b16 v[54:55],v9 offset:12288
v_rcp_f32 v4,v160
s_nop 0
v_mul_f32 v180,v4,v180
v_mul_f32 v181,v4,v181
v_cvt_pk_bf16_f32 v188,v180,v181
v_accvgpr_write_b32 a128,v188
v_rcp_f32 v6,v168
v_rcp_f32 v5,v164
v_add_f32 v182,v160,v4
v_add_f32 v182,v182,v164
v_add_f32 v182,v182,v5
v_add_f32 v182,v182,v168
v_add_f32 v182,v182,v6
v_cmp_nge_f32 vcc,0x53800000,v182
v_accvgpr_read_b32 v182,a2
v_mul_f32 v182,v4,v182
v_mul_f32 v183,v4,v183
v_cvt_pk_bf16_f32 v189,v182,v183
v_accvgpr_write_b32 a129,v189
v_accvgpr_read_b32 v184,a4
v_mul_f32 v184,v4,v184
v_accvgpr_read_b32 v185,a5
v_mul_f32 v185,v4,v185
v_cvt_pk_bf16_f32 v190,v184,v185
v_accvgpr_write_b32 a130,v190
v_accvgpr_read_b32 v186,a6
v_mul_f32 v186,v4,v186
v_accvgpr_read_b32 v187,a7
v_mul_f32 v187,v4,v187
v_cvt_pk_bf16_f32 v191,v186,v187
v_accvgpr_write_b32 a131,v191
buffer_store_dwordx4 a[128:131],v20,s[20:23],s44 offen sc1
M v[128:131],v[40:43],a[200:203],v[128:131]
ds_read_b64_tr_b16 v[56:57],v10
v_cvt_pk_bf16_f32 v204,v132,v133
M v[128:131],v[44:47],a[204:207],v[128:131]
ds_read_b64_tr_b16 v[58:59],v10 offset:4096
ds_read_b64_tr_b16 v[60:61],v10 offset:8192
buffer_load_dwordx4 v22,s[12:15],s48 offen offset:1024 nt lds
v_exp_f32 v135,v135
s_nop 0
v_cvt_pk_bf16_f32 v205,v134,v135
M v[132:135],v[32:35],a[208:211],0
ds_read_b64_tr_b16 v[62:63],v10 offset:12288
v_accvgpr_read_b32 v180,a32
M v[132:135],v[36:39],a[212:215],v[132:135]
v_exp_f32 v136,v136
M v[132:135],v[40:43],a[216:219],v[132:135]
buffer_load_dwordx4 v23,s[12:15],s48 offen offset:2048 nt lds
v_accvgpr_read_b32 v181,a33
M v[132:135],v[44:47],a[220:223],v[132:135]
v_exp_f32 v137,v137
v_exp_f32 v138,v138
v_exp_f32 v139,v139
v_cvt_pk_bf16_f32 v212,v136,v137
v_cvt_pk_bf16_f32 v213,v138,v139
M v[136:139],v[32:35],a[224:227],0
buffer_load_dwordx4 v24,s[12:15],s48 offen offset:3072 nt lds
s_add_u32 s48,s48,4096
M v[136:139],v[36:39],a[228:231],v[136:139]
v_exp_f32 v144,v144
M v[136:139],v[40:43],a[232:235],v[136:139]
s_mov_b32 m0,8192
v_accvgpr_read_b32 v182,a34
M v[136:139],v[44:47],a[236:239],v[136:139]
buffer_load_dwordx4 v21,s[12:15],s48 offen nt lds
s_waitcnt lgkmcnt(0)
M a[0:3],v[48:51],v[192:195],0
ds_read_b128 v[32:35],v8 offset:36864
v_accvgpr_read_b32 v183,a35
v_exp_f32 v145,v145
s_nop 0
v_cvt_pk_bf16_f32 v198,v144,v145
v_exp_f32 v146,v146
v_exp_f32 v147,v147
s_nop 0
v_cvt_pk_bf16_f32 v199,v146,v147
s_nop 1
M a[0:3],v[52:55],v[196:199],a[0:3]
v_exp_f32 v148,v148
M a[32:35],v[48:51],v[200:203],0
ds_read_b128 v[36:39],v8 offset:37120
buffer_load_dwordx4 v22,s[12:15],s48 offen offset:1024 nt lds
v_exp_f32 v149,v149
s_nop 0
v_cvt_pk_bf16_f32 v206,v148,v149
v_exp_f32 v150,v150
v_exp_f32 v151,v151
s_nop 0
v_cvt_pk_bf16_f32 v207,v150,v151
s_nop 1
M a[32:35],v[52:55],v[204:207],a[32:35]
v_exp_f32 v152,v152
v_mul_f32 v180,v5,v180
v_mul_f32 v181,v5,v181
v_cvt_pk_bf16_f32 v172,v180,v181
v_accvgpr_read_b32 v180,a64
v_accvgpr_read_b32 v181,a65
v_mul_f32 v182,v5,v182
v_mul_f32 v183,v5,v183
v_cvt_pk_bf16_f32 v173,v182,v183
v_accvgpr_read_b32 v182,a66
v_accvgpr_read_b32 v183,a67
M a[64:67],v[48:51],v[208:211],0
ds_read_b128 v[40:43],v8 offset:37376
v_accvgpr_read_b32 v184,a36
v_exp_f32 v153,v153
s_nop 0
v_cvt_pk_bf16_f32 v214,v152,v153
v_exp_f32 v154,v154
v_exp_f32 v155,v155
s_nop 0
v_cvt_pk_bf16_f32 v215,v154,v155
s_nop 1
M a[64:67],v[52:55],v[212:215],a[64:67]
buffer_load_dwordx4 v23,s[12:15],s48 offen offset:2048 nt lds
v_accvgpr_read_b32 v185,a37
M a[4:7],v[56:59],v[192:195],0
ds_read_b128 v[44:47],v8 offset:37632
v_accvgpr_read_b32 v186,a38
M a[4:7],v[60:63],v[196:199],a[4:7]
v_accvgpr_read_b32 v187,a39
v_mul_f32 v184,v5,v184
M a[36:39],v[56:59],v[200:203],0
buffer_load_dwordx4 v24,s[12:15],s48 offen offset:3072 nt lds
s_add_u32 s48,s48,4096
v_accvgpr_write_b32 a144,v172
v_accvgpr_write_b32 a145,v173
v_mul_f32 v185,v5,v185
v_cvt_pk_bf16_f32 v174,v184,v185
v_accvgpr_write_b32 a146,v174
v_mul_f32 v186,v5,v186
v_mul_f32 v187,v5,v187
v_cvt_pk_bf16_f32 v175,v186,v187
v_accvgpr_write_b32 a147,v175
buffer_store_dwordx4 a[144:147],v20,s[20:23],s45 offen sc1
M a[36:39],v[60:63],v[204:207],a[36:39]
v_accvgpr_read_b32 v184,a68
v_accvgpr_read_b32 v185,a69
v_accvgpr_read_b32 v186,a70
v_accvgpr_read_b32 v187,a71
M a[68:71],v[56:59],v[208:211],0
s_mov_b32 m0,12288
v_mul_f32 v180,v6,v180
M a[68:71],v[60:63],v[212:215],a[68:71]
buffer_load_dwordx4 v21,s[12:15],s48 offen nt lds
v_mul_f32 v181,v6,v181
M v[160:163],v[176:179],v[192:195],0
v_mul_f32 v182,v6,v182
v_mul_f32 v183,v6,v183
M v[160:163],v[176:179],v[196:199],v[160:163]
buffer_load_dwordx4 v22,s[12:15],s48 offen offset:1024 nt lds
s_waitcnt lgkmcnt(0)
M v[144:147],v[32:35],a[192:195],0
ds_read_b64_tr_b16 v[48:49],v9 offset:256
ds_read_b64_tr_b16 v[50:51],v9 offset:4352
M v[144:147],v[36:39],a[196:199],v[144:147]
ds_read_b64_tr_b16 v[52:53],v9 offset:8448
ds_read_b64_tr_b16 v[54:55],v9 offset:12544
M v[144:147],v[40:43],a[200:203],v[144:147]
ds_read_b64_tr_b16 v[56:57],v10 offset:256
buffer_load_dwordx4 v23,s[12:15],s48 offen offset:2048 nt lds
M v[144:147],v[44:47],a[204:207],v[144:147]
ds_read_b64_tr_b16 v[58:59],v10 offset:4352
ds_read_b64_tr_b16 v[60:61],v10 offset:8448
M v[148:151],v[32:35],a[208:211],0
ds_read_b64_tr_b16 v[62:63],v10 offset:12544
v_mul_f32 v184,v6,v184
M v[148:151],v[36:39],a[212:215],v[148:151]
buffer_load_dwordx4 v24,s[12:15],s48 offen offset:3072 nt lds
s_add_u32 s48,s48,4096
M v[148:151],v[40:43],a[216:219],v[148:151]
v_mul_f32 v185,v6,v185
v_mul_f32 v186,v6,v186
M v[148:151],v[44:47],a[220:223],v[148:151]
s_mov_b32 m0,114688
v_mul_f32 v187,v6,v187
M v[152:155],v[32:35],a[224:227],0
buffer_load_dwordx4 v25,s[16:19],s49 offen nt lds
v_cvt_pk_bf16_f32 v188,v180,v181
M v[152:155],v[36:39],a[228:231],v[152:155]
v_cvt_pk_bf16_f32 v189,v182,v183
v_cvt_pk_bf16_f32 v190,v184,v185
M v[152:155],v[40:43],a[232:235],v[152:155]
v_cvt_pk_bf16_f32 v191,v186,v187
v_accvgpr_write_b32 a160,v188
M v[152:155],v[44:47],a[236:239],v[152:155]
buffer_load_dwordx4 v26,s[16:19],s49 offen offset:1024 nt lds
s_waitcnt lgkmcnt(0)
v_accvgpr_read_b32 v180,a8
v_accvgpr_read_b32 v181,a9
v_accvgpr_read_b32 v182,a10
v_accvgpr_read_b32 v183,a11
M a[8:11],v[48:51],v[192:195],0
ds_read_b128 v[32:35],v8 offset:40960
v_accvgpr_write_b32 a161,v189
M a[8:11],v[52:55],v[196:199],a[8:11]
v_accvgpr_write_b32 a162,v190
v_accvgpr_write_b32 a163,v191
v_mul_f32 v180,v4,v180
v_mul_f32 v181,v4,v181
v_cvt_pk_bf16_f32 v188,v180,v181
v_accvgpr_read_b32 v180,a40
v_accvgpr_read_b32 v181,a41
v_mul_f32 v182,v4,v182
v_mul_f32 v183,v4,v183
v_cvt_pk_bf16_f32 v189,v182,v183
v_accvgpr_read_b32 v182,a42
v_accvgpr_read_b32 v183,a43
M a[40:43],v[48:51],v[200:203],0
ds_read_b128 v[36:39],v8 offset:41216
buffer_load_dwordx4 v25,s[16:19],s49 offen offset:2048 nt lds
buffer_store_dwordx4 a[160:163],v20,s[20:23],s46 offen sc1
M a[40:43],v[52:55],v[204:207],a[40:43]
v_accvgpr_read_b32 v184,a12
v_accvgpr_read_b32 v185,a13
v_mul_f32 v180,v5,v180
v_mul_f32 v181,v5,v181
v_cvt_pk_bf16_f32 v172,v180,v181
v_accvgpr_read_b32 v180,a72
v_accvgpr_read_b32 v181,a73
v_mul_f32 v182,v5,v182
v_mul_f32 v183,v5,v183
v_cvt_pk_bf16_f32 v173,v182,v183
v_accvgpr_read_b32 v182,a74
v_accvgpr_read_b32 v183,a75
M a[72:75],v[48:51],v[208:211],0
ds_read_b128 v[40:43],v8 offset:41472
v_accvgpr_read_b32 v186,a14
M a[72:75],v[52:55],v[212:215],a[72:75]
buffer_load_dwordx4 v26,s[16:19],s49 offen offset:3072 nt lds
s_add_u32 s49,s49,4096
v_accvgpr_read_b32 v187,a15
M a[12:15],v[56:59],v[192:195],0
ds_read_b128 v[44:47],v8 offset:41728
s_mov_b32 m0,118784
M a[12:15],v[60:63],v[196:199],a[12:15]
buffer_load_dwordx4 v25,s[16:19],s49 offen nt lds
v_mul_f32 v184,v4,v184
v_mul_f32 v185,v4,v185
v_cvt_pk_bf16_f32 v190,v184,v185
v_accvgpr_read_b32 v184,a44
v_accvgpr_read_b32 v185,a45
v_mul_f32 v186,v4,v186
v_mul_f32 v187,v4,v187
v_cvt_pk_bf16_f32 v191,v186,v187
v_accvgpr_read_b32 v186,a46
v_accvgpr_read_b32 v187,a47
M a[44:47],v[56:59],v[200:203],0
v_accvgpr_write_b32 a132,v188
v_accvgpr_write_b32 a133,v189
M a[44:47],v[60:63],v[204:207],a[44:47]
v_accvgpr_write_b32 a134,v190
v_accvgpr_write_b32 a135,v191
v_mul_f32 v184,v5,v184
v_mul_f32 v185,v5,v185
v_cvt_pk_bf16_f32 v174,v184,v185
v_accvgpr_read_b32 v184,a76
v_accvgpr_read_b32 v185,a77
v_mul_f32 v186,v5,v186
v_mul_f32 v187,v5,v187
v_cvt_pk_bf16_f32 v175,v186,v187
v_accvgpr_read_b32 v186,a78
v_accvgpr_read_b32 v187,a79
M a[76:79],v[56:59],v[208:211],0
buffer_load_dwordx4 v26,s[16:19],s49 offen offset:1024 nt lds
v_accvgpr_write_b32 a148,v172
M a[76:79],v[60:63],v[212:215],a[76:79]
v_accvgpr_write_b32 a149,v173
v_accvgpr_write_b32 a150,v174
M v[164:167],v[176:179],v[200:203],0
v_accvgpr_write_b32 a151,v175
v_mul_f32 v180,v6,v180
M v[164:167],v[176:179],v[204:207],v[164:167]
buffer_load_dwordx4 v25,s[16:19],s49 offen offset:2048 nt lds
s_waitcnt lgkmcnt(0)
v_exp_f32 v64,v64
v_exp_f32 v65,v65
v_exp_f32 v66,v66
v_exp_f32 v67,v67
v_cvt_pk_bf16_f32 v224,v64,v65
v_cvt_pk_bf16_f32 v225,v66,v67
M v[64:67],v[32:35],a[192:195],0
ds_read_b64_tr_b16 v[48:49],v9 offset:512
ds_read_b64_tr_b16 v[50:51],v9 offset:4608
M v[64:67],v[36:39],a[196:199],v[64:67]
ds_read_b64_tr_b16 v[52:53],v9 offset:8704
ds_read_b64_tr_b16 v[54:55],v9 offset:12800
M v[64:67],v[40:43],a[200:203],v[64:67]
ds_read_b64_tr_b16 v[56:57],v10 offset:512
buffer_load_dwordx4 v26,s[16:19],s49 offen offset:3072 nt lds
s_add_u32 s49,s49,4096
M v[64:67],v[44:47],a[204:207],v[64:67]
ds_read_b64_tr_b16 v[58:59],v10 offset:4608
ds_read_b64_tr_b16 v[60:61],v10 offset:8704
v_exp_f32 v68,v68
v_exp_f32 v69,v69
v_exp_f32 v70,v70
v_exp_f32 v71,v71
v_cvt_pk_bf16_f32 v232,v68,v69
v_cvt_pk_bf16_f32 v233,v70,v71
M v[68:71],v[32:35],a[208:211],0
ds_read_b64_tr_b16 v[62:63],v10 offset:12800
s_mov_b32 m0,122880
M v[68:71],v[36:39],a[212:215],v[68:71]
buffer_load_dwordx4 v25,s[16:19],s49 offen nt lds
v_mul_f32 v181,v6,v181
M v[68:71],v[40:43],a[216:219],v[68:71]
v_mul_f32 v182,v6,v182
v_mul_f32 v183,v6,v183
M v[68:71],v[44:47],a[220:223],v[68:71]
v_mul_f32 v184,v6,v184
v_mul_f32 v185,v6,v185
v_exp_f32 v72,v72
v_exp_f32 v73,v73
v_exp_f32 v74,v74
v_exp_f32 v75,v75
v_cvt_pk_bf16_f32 v240,v72,v73
v_cvt_pk_bf16_f32 v241,v74,v75
M v[72:75],v[32:35],a[224:227],0
buffer_load_dwordx4 v26,s[16:19],s49 offen offset:1024 nt lds
buffer_store_dwordx4 a[132:135],v20,s[20:23],s44 offen offset:1024 sc1
M v[72:75],v[36:39],a[228:231],v[72:75]
v_mul_f32 v186,v6,v186
v_mul_f32 v187,v6,v187
M v[72:75],v[40:43],a[232:235],v[72:75]
buffer_load_dwordx4 v25,s[16:19],s49 offen offset:2048 nt lds
v_cvt_pk_bf16_f32 v188,v180,v181
M v[72:75],v[44:47],a[236:239],v[72:75]
s_waitcnt lgkmcnt(0)
v_cvt_pk_bf16_f32 v189,v182,v183
v_accvgpr_read_b32 v180,a16
v_accvgpr_read_b32 v181,a17
v_accvgpr_read_b32 v182,a18
v_accvgpr_read_b32 v183,a19
M a[16:19],v[48:51],v[192:195],0
ds_read_b128 v[32:35],v8 offset:45056
v_cvt_pk_bf16_f32 v190,v184,v185
M a[16:19],v[52:55],v[196:199],a[16:19]
buffer_load_dwordx4 v26,s[16:19],s49 offen offset:3072 nt lds
s_add_u32 s49,s49,4096
v_mul_f32 v180,v4,v180
v_accvgpr_write_b32 a164,v188
v_mul_f32 v181,v4,v181
v_cvt_pk_bf16_f32 v188,v180,v181
v_accvgpr_read_b32 v180,a48
v_accvgpr_read_b32 v181,a49
v_mul_f32 v182,v4,v182
v_accvgpr_write_b32 a165,v189
v_mul_f32 v183,v4,v183
v_cvt_pk_bf16_f32 v189,v182,v183
v_accvgpr_read_b32 v182,a50
v_accvgpr_read_b32 v183,a51
M a[48:51],v[48:51],v[200:203],0
ds_read_b128 v[36:39],v8 offset:45312
v_cvt_pk_bf16_f32 v191,v186,v187
M a[48:51],v[52:55],v[204:207],a[48:51]
s_mov_b32 m0,126976
v_accvgpr_write_b32 a166,v190
v_mul_f32 v180,v5,v180
v_mul_f32 v181,v5,v181
v_cvt_pk_bf16_f32 v172,v180,v181
v_accvgpr_read_b32 v180,a80
v_accvgpr_read_b32 v181,a81
v_mul_f32 v182,v5,v182
v_mul_f32 v183,v5,v183
v_cvt_pk_bf16_f32 v173,v182,v183
v_accvgpr_read_b32 v182,a82
v_accvgpr_read_b32 v183,a83
M a[80:83],v[48:51],v[208:211],0
ds_read_b128 v[40:43],v8 offset:45568
buffer_load_dwordx4 v25,s[16:19],s49 offen nt lds
M a[80:83],v[52:55],v[212:215],a[80:83]
v_accvgpr_write_b32 a167,v191
v_accvgpr_read_b32 v184,a20
v_accvgpr_read_b32 v185,a21
v_accvgpr_read_b32 v186,a22
v_accvgpr_read_b32 v187,a23
M a[20:23],v[56:59],v[192:195],0
ds_read_b128 v[44:47],v8 offset:45824
v_mul_f32 v184,v4,v184
M a[20:23],v[60:63],v[196:199],a[20:23]
buffer_load_dwordx4 v26,s[16:19],s49 offen offset:1024 nt lds
v_mul_f32 v185,v4,v185
v_cvt_pk_bf16_f32 v190,v184,v185
v_accvgpr_read_b32 v184,a52
v_accvgpr_read_b32 v185,a53
v_mul_f32 v186,v4,v186
v_mul_f32 v187,v4,v187
v_cvt_pk_bf16_f32 v191,v186,v187
v_accvgpr_read_b32 v186,a54
v_accvgpr_read_b32 v187,a55
M a[52:55],v[56:59],v[200:203],0
v_accvgpr_write_b32 a136,v188
v_accvgpr_write_b32 a137,v189
M a[52:55],v[60:63],v[204:207],a[52:55]
v_accvgpr_write_b32 a138,v190
v_accvgpr_write_b32 a139,v191
v_mul_f32 v184,v5,v184
v_mul_f32 v185,v5,v185
v_cvt_pk_bf16_f32 v174,v184,v185
v_accvgpr_read_b32 v184,a84
v_accvgpr_read_b32 v185,a85
v_mul_f32 v186,v5,v186
v_mul_f32 v187,v5,v187
v_cvt_pk_bf16_f32 v175,v186,v187
v_accvgpr_read_b32 v186,a86
v_accvgpr_read_b32 v187,a87
M a[84:87],v[56:59],v[208:211],0
buffer_load_dwordx4 v25,s[16:19],s49 offen offset:2048 nt lds
v_accvgpr_write_b32 a152,v172
M a[84:87],v[60:63],v[212:215],a[84:87]
v_accvgpr_write_b32 a153,v173
v_accvgpr_write_b32 a154,v174
M v[168:171],v[176:179],v[208:211],0
v_accvgpr_write_b32 a155,v175
v_mul_f32 v180,v6,v180
M v[168:171],v[176:179],v[212:215],v[168:171]
buffer_load_dwordx4 v26,s[16:19],s49 offen offset:3072 nt lds
s_add_u32 s49,s49,4096
s_waitcnt lgkmcnt(0)
v_exp_f32 v80,v80
v_exp_f32 v81,v81
v_exp_f32 v82,v82
v_exp_f32 v83,v83
v_cvt_pk_bf16_f32 v226,v80,v81
v_cvt_pk_bf16_f32 v227,v82,v83
M v[80:83],v[32:35],a[192:195],0
ds_read_b64_tr_b16 v[48:49],v9 offset:768
ds_read_b64_tr_b16 v[50:51],v9 offset:4864
M v[80:83],v[36:39],a[196:199],v[80:83]
ds_read_b64_tr_b16 v[52:53],v9 offset:8960
ds_read_b64_tr_b16 v[54:55],v9 offset:13056
M v[80:83],v[40:43],a[200:203],v[80:83]
ds_read_b64_tr_b16 v[56:57],v10 offset:768
buffer_store_dwordx4 a[148:151],v20,s[20:23],s45 offen offset:1024 sc1
M v[80:83],v[44:47],a[204:207],v[80:83]
ds_read_b64_tr_b16 v[58:59],v10 offset:4864
ds_read_b64_tr_b16 v[60:61],v10 offset:8960
v_exp_f32 v84,v84
v_exp_f32 v85,v85
v_exp_f32 v86,v86
v_exp_f32 v87,v87
v_cvt_pk_bf16_f32 v234,v84,v85
v_cvt_pk_bf16_f32 v235,v86,v87
M v[84:87],v[32:35],a[208:211],0
ds_read_b64_tr_b16 v[62:63],v10 offset:13056
v_mul_f32 v181,v6,v181
M v[84:87],v[36:39],a[212:215],v[84:87]
v_mul_f32 v182,v6,v182
v_mul_f32 v183,v6,v183
M v[84:87],v[40:43],a[216:219],v[84:87]
v_mul_f32 v184,v6,v184
v_mul_f32 v185,v6,v185
M v[84:87],v[44:47],a[220:223],v[84:87]
v_mul_f32 v186,v6,v186
v_mul_f32 v187,v6,v187
v_exp_f32 v88,v88
v_exp_f32 v89,v89
v_exp_f32 v90,v90
v_exp_f32 v91,v91
v_cvt_pk_bf16_f32 v242,v88,v89
v_cvt_pk_bf16_f32 v243,v90,v91
M v[88:91],v[32:35],a[224:227],0
v_cvt_pk_bf16_f32 v188,v180,v181
v_cvt_pk_bf16_f32 v189,v182,v183
M v[88:91],v[36:39],a[228:231],v[88:91]
v_cvt_pk_bf16_f32 v190,v184,v185
v_cvt_pk_bf16_f32 v191,v186,v187
M v[88:91],v[40:43],a[232:235],v[88:91]
v_accvgpr_write_b32 a168,v188
v_accvgpr_write_b32 a169,v189
M v[88:91],v[44:47],a[236:239],v[88:91]
s_waitcnt vmcnt(53) lgkmcnt(0)
s_barrier
v_accvgpr_read_b32 v180,a24
v_accvgpr_read_b32 v181,a25
v_accvgpr_read_b32 v182,a26
v_accvgpr_read_b32 v183,a27
M a[24:27],v[48:51],v[192:195],0
ds_read_b128 v[32:35],v8 offset:49152
s_mov_b32 m0,16384
M a[24:27],v[52:55],v[196:199],a[24:27]
buffer_load_dwordx4 v21,s[12:15],s48 offen nt lds
v_accvgpr_write_b32 a170,v190
v_mul_f32 v180,v4,v180
v_mul_f32 v181,v4,v181
v_cvt_pk_bf16_f32 v188,v180,v181
v_accvgpr_read_b32 v180,a56
v_accvgpr_read_b32 v181,a57
v_mul_f32 v182,v4,v182
v_mul_f32 v183,v4,v183
v_cvt_pk_bf16_f32 v189,v182,v183
v_accvgpr_read_b32 v182,a58
v_accvgpr_read_b32 v183,a59
M a[56:59],v[48:51],v[200:203],0
ds_read_b128 v[36:39],v8 offset:49408
v_accvgpr_write_b32 a171,v191
M a[56:59],v[52:55],v[204:207],a[56:59]
buffer_load_dwordx4 v22,s[12:15],s48 offen offset:1024 nt lds
v_accvgpr_read_b32 v184,a28
v_mul_f32 v180,v5,v180
v_mul_f32 v181,v5,v181
v_cvt_pk_bf16_f32 v172,v180,v181
v_accvgpr_read_b32 v180,a88
v_accvgpr_read_b32 v181,a89
v_mul_f32 v182,v5,v182
v_mul_f32 v183,v5,v183
v_cvt_pk_bf16_f32 v173,v182,v183
v_accvgpr_read_b32 v182,a90
v_accvgpr_read_b32 v183,a91
M a[88:91],v[48:51],v[208:211],0
ds_read_b128 v[40:43],v8 offset:49664
v_accvgpr_read_b32 v185,a29
M a[88:91],v[52:55],v[212:215],a[88:91]
v_exp_f32 v96,v96
v_accvgpr_read_b32 v186,a30
v_accvgpr_read_b32 v187,a31
M a[28:31],v[56:59],v[192:195],0
ds_read_b128 v[44:47],v8 offset:49920
buffer_load_dwordx4 v23,s[12:15],s48 offen offset:2048 nt lds
M a[28:31],v[60:63],v[196:199],a[28:31]
v_exp_f32 v97,v97
v_mul_f32 v184,v4,v184
v_mul_f32 v185,v4,v185
v_cvt_pk_bf16_f32 v190,v184,v185
v_accvgpr_read_b32 v184,a60
v_accvgpr_read_b32 v185,a61
v_mul_f32 v186,v4,v186
v_mul_f32 v187,v4,v187
v_cvt_pk_bf16_f32 v191,v186,v187
v_accvgpr_read_b32 v186,a62
v_accvgpr_read_b32 v187,a63
M a[60:63],v[56:59],v[200:203],0
v_exp_f32 v98,v98
M a[60:63],v[60:63],v[204:207],a[60:63]
buffer_store_dwordx4 a[164:167],v20,s[20:23],s46 offen offset:1024 sc1
buffer_load_dwordx4 v24,s[12:15],s48 offen offset:3072 nt lds
s_add_u32 s48,s48,4096
v_mul_f32 v184,v5,v184
v_mul_f32 v185,v5,v185
v_cvt_pk_bf16_f32 v174,v184,v185
v_accvgpr_read_b32 v184,a92
v_accvgpr_read_b32 v185,a93
v_mul_f32 v186,v5,v186
v_mul_f32 v187,v5,v187
v_cvt_pk_bf16_f32 v175,v186,v187
v_accvgpr_read_b32 v186,a94
v_accvgpr_read_b32 v187,a95
M a[92:95],v[56:59],v[208:211],0
v_exp_f32 v99,v99
M a[92:95],v[60:63],v[212:215],a[92:95]
s_mov_b32 m0,20480
s_waitcnt lgkmcnt(0)
v_cvt_pk_bf16_f32 v228,v96,v97
v_cvt_pk_bf16_f32 v229,v98,v99
M v[96:99],v[32:35],a[192:195],0
ds_read_b64_tr_b16 v[48:49],v9 offset:16384
ds_read_b64_tr_b16 v[50:51],v9 offset:20480
buffer_load_dwordx4 v21,s[12:15],s48 offen nt lds
M v[96:99],v[36:39],a[196:199],v[96:99]
ds_read_b64_tr_b16 v[52:53],v9 offset:24576
ds_read_b64_tr_b16 v[54:55],v9 offset:28672
M v[96:99],v[40:43],a[200:203],v[96:99]
ds_read_b64_tr_b16 v[56:57],v10 offset:16384
v_accvgpr_write_b32 a140,v188
M v[96:99],v[44:47],a[204:207],v[96:99]
ds_read_b64_tr_b16 v[58:59],v10 offset:20480
ds_read_b64_tr_b16 v[60:61],v10 offset:24576
buffer_load_dwordx4 v22,s[12:15],s48 offen offset:1024 nt lds
v_exp_f32 v100,v100
v_exp_f32 v101,v101
v_exp_f32 v102,v102
v_exp_f32 v103,v103
v_cvt_pk_bf16_f32 v236,v100,v101
v_cvt_pk_bf16_f32 v237,v102,v103
M v[100:103],v[32:35],a[208:211],0
ds_read_b64_tr_b16 v[62:63],v10 offset:28672
v_accvgpr_write_b32 a141,v189
M v[100:103],v[36:39],a[212:215],v[100:103]
v_exp_f32 v104,v104
M v[100:103],v[40:43],a[216:219],v[100:103]
buffer_load_dwordx4 v23,s[12:15],s48 offen offset:2048 nt lds
v_accvgpr_write_b32 a142,v190
M v[100:103],v[44:47],a[220:223],v[100:103]
v_exp_f32 v105,v105
v_exp_f32 v106,v106
v_exp_f32 v107,v107
v_cvt_pk_bf16_f32 v244,v104,v105
v_cvt_pk_bf16_f32 v245,v106,v107
M v[104:107],v[32:35],a[224:227],0
buffer_load_dwordx4 v24,s[12:15],s48 offen offset:3072 nt lds
s_add_u32 s48,s48,4096
M v[104:107],v[36:39],a[228:231],v[104:107]
v_exp_f32 v112,v112
M v[104:107],v[40:43],a[232:235],v[104:107]
s_mov_b32 m0,24576
v_accvgpr_write_b32 a143,v191
M v[104:107],v[44:47],a[236:239],v[104:107]
buffer_load_dwordx4 v21,s[12:15],s48 offen nt lds
s_waitcnt lgkmcnt(0)
M a[0:3],v[48:51],v[224:227],a[0:3]
ds_read_b128 v[32:35],v8 offset:53248
v_accvgpr_write_b32 a156,v172
v_exp_f32 v113,v113
s_nop 0
v_cvt_pk_bf16_f32 v230,v112,v113
v_exp_f32 v114,v114
v_exp_f32 v115,v115
s_nop 0
v_cvt_pk_bf16_f32 v231,v114,v115
s_nop 1
M a[0:3],v[52:55],v[228:231],a[0:3]
v_exp_f32 v116,v116
M a[32:35],v[48:51],v[232:235],a[32:35]
ds_read_b128 v[36:39],v8 offset:53504
buffer_load_dwordx4 v22,s[12:15],s48 offen offset:1024 nt lds
v_exp_f32 v117,v117
s_nop 0
v_cvt_pk_bf16_f32 v238,v116,v117
v_exp_f32 v118,v118
v_exp_f32 v119,v119
s_nop 0
v_cvt_pk_bf16_f32 v239,v118,v119
s_nop 1
M a[32:35],v[52:55],v[236:239],a[32:35]
v_exp_f32 v120,v120
M a[64:67],v[48:51],v[240:243],a[64:67]
ds_read_b128 v[40:43],v8 offset:53760
v_accvgpr_write_b32 a157,v173
v_exp_f32 v121,v121
s_nop 0
v_cvt_pk_bf16_f32 v246,v120,v121
v_exp_f32 v122,v122
v_exp_f32 v123,v123
s_nop 0
v_cvt_pk_bf16_f32 v247,v122,v123
s_nop 1
M a[64:67],v[52:55],v[244:247],a[64:67]
buffer_store_dwordx4 a[136:139],v20,s[20:23],s44 offen offset:2048 sc1
buffer_load_dwordx4 v23,s[12:15],s48 offen offset:2048 nt lds
M a[4:7],v[56:59],v[224:227],a[4:7]
ds_read_b128 v[44:47],v8 offset:54016
v_accvgpr_write_b32 a158,v174
M a[4:7],v[60:63],v[228:231],a[4:7]
v_accvgpr_write_b32 a159,v175
v_mul_f32 v180,v6,v180
M a[36:39],v[56:59],v[232:235],a[36:39]
buffer_load_dwordx4 v24,s[12:15],s48 offen offset:3072 nt lds
s_add_u32 s48,s48,4096
M a[36:39],v[60:63],v[236:239],a[36:39]
v_mul_f32 v181,v6,v181
v_mul_f32 v182,v6,v182
M a[68:71],v[56:59],v[240:243],a[68:71]
s_mov_b32 m0,28672
v_mul_f32 v183,v6,v183
M a[68:71],v[60:63],v[244:247],a[68:71]
buffer_load_dwordx4 v21,s[12:15],s48 offen nt lds
v_mul_f32 v184,v6,v184
M v[160:163],v[176:179],v[224:227],v[160:163]
v_mul_f32 v185,v6,v185
v_mul_f32 v186,v6,v186
M v[160:163],v[176:179],v[228:231],v[160:163]
buffer_load_dwordx4 v22,s[12:15],s48 offen offset:1024 nt lds
s_waitcnt lgkmcnt(0)
M v[112:115],v[32:35],a[192:195],0
ds_read_b64_tr_b16 v[48:49],v9 offset:16640
ds_read_b64_tr_b16 v[50:51],v9 offset:20736
M v[112:115],v[36:39],a[196:199],v[112:115]
ds_read_b64_tr_b16 v[52:53],v9 offset:24832
ds_read_b64_tr_b16 v[54:55],v9 offset:28928
M v[112:115],v[40:43],a[200:203],v[112:115]
ds_read_b64_tr_b16 v[56:57],v10 offset:16640
buffer_load_dwordx4 v23,s[12:15],s48 offen offset:2048 nt lds
M v[112:115],v[44:47],a[204:207],v[112:115]
ds_read_b64_tr_b16 v[58:59],v10 offset:20736
ds_read_b64_tr_b16 v[60:61],v10 offset:24832
M v[116:119],v[32:35],a[208:211],0
ds_read_b64_tr_b16 v[62:63],v10 offset:28928
v_mul_f32 v187,v6,v187
M v[116:119],v[36:39],a[212:215],v[116:119]
buffer_load_dwordx4 v24,s[12:15],s48 offen offset:3072 nt lds
s_add_u32 s48,s48,4096
M v[116:119],v[40:43],a[216:219],v[116:119]
v_cvt_pk_bf16_f32 v188,v180,v181
v_cvt_pk_bf16_f32 v189,v182,v183
M v[116:119],v[44:47],a[220:223],v[116:119]
s_mov_b32 m0,65536
v_cvt_pk_bf16_f32 v190,v184,v185
M v[120:123],v[32:35],a[224:227],0
buffer_load_dwordx4 v25,s[16:19],s49 offen nt lds
v_cvt_pk_bf16_f32 v191,v186,v187
M v[120:123],v[36:39],a[228:231],v[120:123]
v_exp_f32 v128,v128
M v[120:123],v[40:43],a[232:235],v[120:123]
v_exp_f32 v129,v129
M v[120:123],v[44:47],a[236:239],v[120:123]
buffer_store_dwordx4 a[152:155],v20,s[20:23],s45 offen offset:2048 sc1
buffer_load_dwordx4 v26,s[16:19],s49 offen offset:1024 nt lds
s_waitcnt lgkmcnt(0)
M a[8:11],v[48:51],v[224:227],a[8:11]
ds_read_b128 v[32:35],v8 offset:57344
v_accvgpr_write_b32 a172,v188
M a[8:11],v[52:55],v[228:231],a[8:11]
v_exp_f32 v130,v130
M a[40:43],v[48:51],v[232:235],a[40:43]
ds_read_b128 v[36:39],v8 offset:57600
buffer_load_dwordx4 v25,s[16:19],s49 offen offset:2048 nt lds
M a[40:43],v[52:55],v[236:239],a[40:43]
v_exp_f32 v131,v131
M a[72:75],v[48:51],v[240:243],a[72:75]
ds_read_b128 v[40:43],v8 offset:57856
v_accvgpr_write_b32 a173,v189
M a[72:75],v[52:55],v[244:247],a[72:75]
buffer_load_dwordx4 v26,s[16:19],s49 offen offset:3072 nt lds
s_add_u32 s49,s49,4096
M a[12:15],v[56:59],v[224:227],a[12:15]
ds_read_b128 v[44:47],v8 offset:58112
s_mov_b32 m0,69632
M a[12:15],v[60:63],v[228:231],a[12:15]
buffer_load_dwordx4 v25,s[16:19],s49 offen nt lds
v_accvgpr_write_b32 a174,v190
M a[44:47],v[56:59],v[232:235],a[44:47]
v_exp_f32 v132,v132
M a[44:47],v[60:63],v[236:239],a[44:47]
v_exp_f32 v133,v133
M a[76:79],v[56:59],v[240:243],a[76:79]
buffer_load_dwordx4 v26,s[16:19],s49 offen offset:1024 nt lds
v_accvgpr_write_b32 a175,v191
M a[76:79],v[60:63],v[244:247],a[76:79]
v_exp_f32 v134,v134
M v[164:167],v[176:179],v[232:235],v[164:167]
v_exp_f32 v135,v135
M v[164:167],v[176:179],v[236:239],v[164:167]
buffer_load_dwordx4 v25,s[16:19],s49 offen offset:2048 nt lds
s_waitcnt lgkmcnt(0)
v_cvt_pk_bf16_f32 v192,v128,v129
v_cvt_pk_bf16_f32 v193,v130,v131
M v[128:131],v[32:35],a[192:195],0
ds_read_b64_tr_b16 v[48:49],v9 offset:16896
ds_read_b64_tr_b16 v[50:51],v9 offset:20992
M v[128:131],v[36:39],a[196:199],v[128:131]
ds_read_b64_tr_b16 v[52:53],v9 offset:25088
ds_read_b64_tr_b16 v[54:55],v9 offset:29184
M v[128:131],v[40:43],a[200:203],v[128:131]
ds_read_b64_tr_b16 v[56:57],v10 offset:16896
buffer_load_dwordx4 v26,s[16:19],s49 offen offset:3072 nt lds
s_add_u32 s49,s49,4096
M v[128:131],v[44:47],a[204:207],v[128:131]
ds_read_b64_tr_b16 v[58:59],v10 offset:20992
ds_read_b64_tr_b16 v[60:61],v10 offset:25088
v_cvt_pk_bf16_f32 v200,v132,v133
v_cvt_pk_bf16_f32 v201,v134,v135
M v[132:135],v[32:35],a[208:211],0
ds_read_b64_tr_b16 v[62:63],v10 offset:29184
s_mov_b32 m0,73728
M v[132:135],v[36:39],a[212:215],v[132:135]
buffer_store_dwordx4 a[168:171],v20,s[20:23],s46 offen offset:2048 sc1
buffer_load_dwordx4 v25,s[16:19],s49 offen nt lds
M v[132:135],v[40:43],a[216:219],v[132:135]
v_exp_f32 v136,v136
M v[132:135],v[44:47],a[220:223],v[132:135]
v_exp_f32 v137,v137
v_exp_f32 v138,v138
v_exp_f32 v139,v139
v_cvt_pk_bf16_f32 v208,v136,v137
v_cvt_pk_bf16_f32 v209,v138,v139
M v[136:139],v[32:35],a[224:227],0
buffer_load_dwordx4 v26,s[16:19],s49 offen offset:1024 nt lds
s_lshl_b32 s80,s28,2
M v[136:139],v[36:39],a[228:231],v[136:139]
v_exp_f32 v144,v144
M v[136:139],v[40:43],a[232:235],v[136:139]
buffer_load_dwordx4 v25,s[16:19],s49 offen offset:2048 nt lds
s_add_u32 s80,s80,161808
M v[136:139],v[44:47],a[236:239],v[136:139]
s_waitcnt lgkmcnt(0)
v_mov_b32 v0,s80
M a[16:19],v[48:51],v[224:227],a[16:19]
ds_read_b128 v[32:35],v8 offset:61440
v_mbcnt_lo_u32_b32 v2,-1,0
M a[16:19],v[52:55],v[228:231],a[16:19]
buffer_load_dwordx4 v26,s[16:19],s49 offen offset:3072 nt lds
s_add_u32 s49,s49,4096
M a[48:51],v[48:51],v[232:235],a[48:51]
ds_read_b128 v[36:39],v8 offset:61696
v_mbcnt_hi_u32_b32 v2,-1,v2
M a[48:51],v[52:55],v[236:239],a[48:51]
s_mov_b32 m0,77824
v_lshlrev_b32 v11,4,v2
M a[80:83],v[48:51],v[240:243],a[80:83]
ds_read_b128 v[40:43],v8 offset:61952
buffer_load_dwordx4 v25,s[16:19],s49 offen nt lds
M a[80:83],v[52:55],v[244:247],a[80:83]
v_exp_f32 v145,v145
M a[20:23],v[56:59],v[224:227],a[20:23]
ds_read_b128 v[44:47],v8 offset:62208
v_lshrrev_b32 v3,4,v2
M a[20:23],v[60:63],v[228:231],a[20:23]
buffer_load_dwordx4 v26,s[16:19],s49 offen offset:1024 nt lds
v_and_b32 v19,15,v2
M a[52:55],v[56:59],v[232:235],a[52:55]
v_exp_f32 v146,v146
M a[52:55],v[60:63],v[236:239],a[52:55]
v_exp_f32 v147,v147
M a[84:87],v[56:59],v[240:243],a[84:87]
buffer_load_dwordx4 v25,s[16:19],s49 offen offset:2048 nt lds
s_lshr_b32 s80,s72,13
M a[84:87],v[60:63],v[244:247],a[84:87]
v_exp_f32 v148,v148
M v[168:171],v[176:179],v[240:243],v[168:171]
buffer_store_dwordx4 a[140:143],v20,s[20:23],s44 offen offset:3072 sc1
s_and_b32 s80,8,s80
M v[168:171],v[176:179],v[244:247],v[168:171]
buffer_load_dwordx4 v26,s[16:19],s49 offen offset:3072 nt lds
s_add_u32 s49,s49,4096
s_waitcnt lgkmcnt(0)
v_cvt_pk_bf16_f32 v194,v144,v145
v_cvt_pk_bf16_f32 v195,v146,v147
M v[144:147],v[32:35],a[192:195],0
ds_read_b64_tr_b16 v[48:49],v9 offset:17152
ds_read_b64_tr_b16 v[50:51],v9 offset:21248
M v[144:147],v[36:39],a[196:199],v[144:147]
ds_read_b64_tr_b16 v[52:53],v9 offset:25344
ds_read_b64_tr_b16 v[54:55],v9 offset:29440
M v[144:147],v[40:43],a[200:203],v[144:147]
ds_read_b64_tr_b16 v[56:57],v10 offset:17152
v_lshlrev_b32 v29,1,v3
M v[144:147],v[44:47],a[204:207],v[144:147]
ds_read_b64_tr_b16 v[58:59],v10 offset:21248
ds_read_b64_tr_b16 v[60:61],v10 offset:25344
v_exp_f32 v149,v149
v_exp_f32 v150,v150
v_exp_f32 v151,v151
v_cvt_pk_bf16_f32 v202,v148,v149
v_cvt_pk_bf16_f32 v203,v150,v151
M v[148:151],v[32:35],a[208:211],0
ds_read_b64_tr_b16 v[62:63],v10 offset:29440
v_xor_b32 v29,v29,v19
M v[148:151],v[36:39],a[212:215],v[148:151]
v_exp_f32 v152,v152
M v[148:151],v[40:43],a[216:219],v[148:151]
v_exp_f32 v153,v153
M v[148:151],v[44:47],a[220:223],v[148:151]
v_exp_f32 v154,v154
v_exp_f32 v155,v155
v_cvt_pk_bf16_f32 v210,v152,v153
v_cvt_pk_bf16_f32 v211,v154,v155
M v[152:155],v[32:35],a[224:227],0
v_exp_f32 v64,v64
M v[152:155],v[36:39],a[228:231],v[152:155]
v_exp_f32 v65,v65
M v[152:155],v[40:43],a[232:235],v[152:155]
v_exp_f32 v66,v66
M v[152:155],v[44:47],a[236:239],v[152:155]
s_cmp_lg_u64 vcc,0
s_cselect_b32 s55,1,0
s_or_b32 s43,s43,s55
v_mov_b32 v1,s43
ds_write_b32 v0,v1
s_waitcnt vmcnt(56) lgkmcnt(0)
s_barrier
M a[24:27],v[48:51],v[224:227],a[24:27]
ds_read_b128 v[32:35],v8
s_mov_b32 m0,32768
M a[24:27],v[52:55],v[228:231],a[24:27]
buffer_load_dwordx4 v21,s[12:15],s48 offen nt lds
v_xor_b32 v29,s80,v29
M a[56:59],v[48:51],v[232:235],a[56:59]
ds_read_b128 v[36:39],v8 offset:256
v_lshlrev_b32 v29,4,v29
M a[56:59],v[52:55],v[236:239],a[56:59]
buffer_load_dwordx4 v22,s[12:15],s48 offen offset:1024 nt lds
s_lshr_b32 s81,s74,3
M a[88:91],v[48:51],v[240:243],a[88:91]
ds_read_b128 v[40:43],v8 offset:512
s_and_b32 s81,128,s81
M a[88:91],v[52:55],v[244:247],a[88:91]
v_exp_f32 v67,v67
M a[28:31],v[56:59],v[224:227],a[28:31]
ds_read_b128 v[44:47],v8 offset:768
buffer_store_dwordx4 a[156:159],v20,s[20:23],s45 offen offset:3072 sc1
buffer_load_dwordx4 v23,s[12:15],s48 offen offset:2048 nt lds
M a[28:31],v[60:63],v[228:231],a[28:31]
v_exp_f32 v68,v68
M a[60:63],v[56:59],v[232:235],a[60:63]
v_exp_f32 v69,v69
M a[60:63],v[60:63],v[236:239],a[60:63]
buffer_load_dwordx4 v24,s[12:15],s48 offen offset:3072 nt lds
s_add_u32 s48,s48,4096
M a[92:95],v[56:59],v[240:243],a[92:95]
v_exp_f32 v70,v70
M a[92:95],v[60:63],v[244:247],a[92:95]
s_mov_b32 m0,36864
s_waitcnt lgkmcnt(0)
v_cvt_pk_bf16_f32 v196,v64,v65
v_cvt_pk_bf16_f32 v197,v66,v67
M v[64:67],v[32:35],a[192:195],0
ds_read_b64_tr_b16 v[48:49],v9 offset:32768
ds_read_b64_tr_b16 v[50:51],v9 offset:36864
buffer_load_dwordx4 v21,s[12:15],s48 offen nt lds
M v[64:67],v[36:39],a[196:199],v[64:67]
ds_read_b64_tr_b16 v[52:53],v9 offset:40960
ds_read_b64_tr_b16 v[54:55],v9 offset:45056
M v[64:67],v[40:43],a[200:203],v[64:67]
ds_read_b64_tr_b16 v[56:57],v10 offset:32768
v_xor_b32 v29,s81,v29
M v[64:67],v[44:47],a[204:207],v[64:67]
ds_read_b64_tr_b16 v[58:59],v10 offset:36864
ds_read_b64_tr_b16 v[60:61],v10 offset:40960
buffer_load_dwordx4 v22,s[12:15],s48 offen offset:1024 nt lds
v_exp_f32 v71,v71
v_cvt_pk_bf16_f32 v204,v68,v69
v_cvt_pk_bf16_f32 v205,v70,v71
M v[68:71],v[32:35],a[208:211],0
ds_read_b64_tr_b16 v[62:63],v10 offset:45056
v_lshlrev_b32 v12,10,v3
M v[68:71],v[36:39],a[212:215],v[68:71]
v_exp_f32 v72,v72
M v[68:71],v[40:43],a[216:219],v[68:71]
buffer_load_dwordx4 v23,s[12:15],s48 offen offset:2048 nt lds
v_add_u32 v29,v29,v12
M v[68:71],v[44:47],a[220:223],v[68:71]
v_exp_f32 v73,v73
v_exp_f32 v74,v74
v_exp_f32 v75,v75
v_cvt_pk_bf16_f32 v212,v72,v73
v_cvt_pk_bf16_f32 v213,v74,v75
M v[72:75],v[32:35],a[224:227],0
buffer_load_dwordx4 v24,s[12:15],s48 offen offset:3072 nt lds
s_add_u32 s48,s48,4096
M v[72:75],v[36:39],a[228:231],v[72:75]
v_exp_f32 v80,v80
M v[72:75],v[40:43],a[232:235],v[72:75]
s_mov_b32 m0,40960
s_lshr_b32 s80,s72,10
M v[72:75],v[44:47],a[236:239],v[72:75]
buffer_load_dwordx4 v21,s[12:15],s48 offen nt lds
s_waitcnt lgkmcnt(0)
M a[0:3],v[48:51],v[192:195],a[0:3]
ds_read_b128 v[32:35],v8 offset:4096
s_and_b32 s80,3,s80
v_exp_f32 v81,v81
s_nop 0
v_cvt_pk_bf16_f32 v198,v80,v81
v_exp_f32 v82,v82
v_exp_f32 v83,v83
s_nop 0
v_cvt_pk_bf16_f32 v199,v82,v83
s_nop 1
M a[0:3],v[52:55],v[196:199],a[0:3]
v_exp_f32 v84,v84
M a[32:35],v[48:51],v[200:203],a[32:35]
ds_read_b128 v[36:39],v8 offset:4352
buffer_store_dwordx4 a[172:175],v20,s[20:23],s46 offen offset:3072 sc1
buffer_load_dwordx4 v22,s[12:15],s48 offen offset:1024 nt lds
v_exp_f32 v85,v85
s_nop 0
v_cvt_pk_bf16_f32 v206,v84,v85
v_exp_f32 v86,v86
v_exp_f32 v87,v87
s_nop 0
v_cvt_pk_bf16_f32 v207,v86,v87
s_nop 1
M a[32:35],v[52:55],v[204:207],a[32:35]
v_exp_f32 v88,v88
M a[64:67],v[48:51],v[208:211],a[64:67]
ds_read_b128 v[40:43],v8 offset:4608
s_xor_b32 s80,s80,s28
v_exp_f32 v89,v89
s_nop 0
v_cvt_pk_bf16_f32 v214,v88,v89
v_exp_f32 v90,v90
v_exp_f32 v91,v91
s_nop 0
v_cvt_pk_bf16_f32 v215,v90,v91
s_nop 1
M a[64:67],v[52:55],v[212:215],a[64:67]
buffer_load_dwordx4 v23,s[12:15],s48 offen offset:2048 nt lds
s_lshl_b32 s80,s80,15
M a[4:7],v[56:59],v[192:195],a[4:7]
ds_read_b128 v[44:47],v8 offset:4864
buffer_load_dword v30,v31,s[24:27],0 offen
M a[4:7],v[60:63],v[196:199],a[4:7]
v_exp_f32 v96,v96
M a[36:39],v[56:59],v[200:203],a[36:39]
buffer_load_dwordx4 v24,s[12:15],s48 offen offset:3072 nt lds
s_add_u32 s48,s48,4096
M a[36:39],v[60:63],v[204:207],a[36:39]
v_exp_f32 v97,v97
M a[68:71],v[56:59],v[208:211],a[68:71]
s_mov_b32 m0,45056
v_add_u32 v12,s80,v29
M a[68:71],v[60:63],v[212:215],a[68:71]
buffer_load_dwordx4 v21,s[12:15],s48 offen nt lds
v_xor_b32 v13,128,v12
M v[160:163],v[176:179],v[192:195],v[160:163]
v_exp_f32 v98,v98
M v[160:163],v[176:179],v[196:199],v[160:163]
buffer_load_dwordx4 v22,s[12:15],s48 offen offset:1024 nt lds
s_waitcnt lgkmcnt(0)
M v[80:83],v[32:35],a[192:195],0
ds_read_b64_tr_b16 v[48:49],v9 offset:33024
ds_read_b64_tr_b16 v[50:51],v9 offset:37120
M v[80:83],v[36:39],a[196:199],v[80:83]
ds_read_b64_tr_b16 v[52:53],v9 offset:41216
ds_read_b64_tr_b16 v[54:55],v9 offset:45312
M v[80:83],v[40:43],a[200:203],v[80:83]
ds_read_b64_tr_b16 v[56:57],v10 offset:33024
buffer_load_dwordx4 v23,s[12:15],s48 offen offset:2048 nt lds
M v[80:83],v[44:47],a[204:207],v[80:83]
ds_read_b64_tr_b16 v[58:59],v10 offset:37120
ds_read_b64_tr_b16 v[60:61],v10 offset:41216
M v[84:87],v[32:35],a[208:211],0
ds_read_b64_tr_b16 v[62:63],v10 offset:45312
s_and_b32 s80,1,s83
M v[84:87],v[36:39],a[212:215],v[84:87]
buffer_load_dwordx4 v24,s[12:15],s48 offen offset:3072 nt lds
s_add_u32 s48,s48,4096
M v[84:87],v[40:43],a[216:219],v[84:87]
v_exp_f32 v99,v99
M v[84:87],v[44:47],a[220:223],v[84:87]
s_mov_b32 m0,81920
s_lshl_b32 s80,s80,7
M v[88:91],v[32:35],a[224:227],0
buffer_load_dwordx4 v25,s[16:19],s49 offen nt lds
v_and_b32 v3,1,v3
M v[88:91],v[36:39],a[228:231],v[88:91]
v_exp_f32 v100,v100
M v[88:91],v[40:43],a[232:235],v[88:91]
v_exp_f32 v101,v101
M v[88:91],v[44:47],a[236:239],v[88:91]
buffer_load_dwordx4 v26,s[16:19],s49 offen offset:1024 nt lds
s_waitcnt lgkmcnt(0)
M a[8:11],v[48:51],v[192:195],a[8:11]
ds_read_b128 v[32:35],v8 offset:8192
v_mul_u32_u24 v3,s80,v3
M a[8:11],v[52:55],v[196:199],a[8:11]
v_exp_f32 v102,v102
M a[40:43],v[48:51],v[200:203],a[40:43]
ds_read_b128 v[36:39],v8 offset:8448
buffer_load_dwordx4 v25,s[16:19],s49 offen offset:2048 nt lds
M a[40:43],v[52:55],v[204:207],a[40:43]
v_exp_f32 v103,v103
M a[72:75],v[48:51],v[208:211],a[72:75]
ds_read_b128 v[40:43],v8 offset:8704
v_and_b32 v19,7,v19
M a[72:75],v[52:55],v[212:215],a[72:75]
buffer_load_dwordx4 v26,s[16:19],s49 offen offset:3072 nt lds
s_add_u32 s49,s49,4096
M a[12:15],v[56:59],v[192:195],a[12:15]
ds_read_b128 v[44:47],v8 offset:8960
s_mov_b32 m0,86016
M a[12:15],v[60:63],v[196:199],a[12:15]
buffer_load_dwordx4 v25,s[16:19],s49 offen nt lds
s_lshr_b32 s80,s72,13
M a[44:47],v[56:59],v[200:203],a[44:47]
v_exp_f32 v104,v104
M a[44:47],v[60:63],v[204:207],a[44:47]
v_exp_f32 v105,v105
M a[76:79],v[56:59],v[208:211],a[76:79]
buffer_load_dwordx4 v26,s[16:19],s49 offen offset:1024 nt lds
s_and_b32 s80,8,s80
M a[76:79],v[60:63],v[212:215],a[76:79]
v_exp_f32 v106,v106
M v[164:167],v[176:179],v[200:203],v[164:167]
v_exp_f32 v107,v107
M v[164:167],v[176:179],v[204:207],v[164:167]
buffer_load_dwordx4 v25,s[16:19],s49 offen offset:2048 nt lds
s_waitcnt lgkmcnt(0)
v_cvt_pk_bf16_f32 v224,v96,v97
v_cvt_pk_bf16_f32 v225,v98,v99
M v[96:99],v[32:35],a[192:195],0
ds_read_b64_tr_b16 v[48:49],v9 offset:33280
ds_read_b64_tr_b16 v[50:51],v9 offset:37376
M v[96:99],v[36:39],a[196:199],v[96:99]
ds_read_b64_tr_b16 v[52:53],v9 offset:41472
ds_read_b64_tr_b16 v[54:55],v9 offset:45568
M v[96:99],v[40:43],a[200:203],v[96:99]
ds_read_b64_tr_b16 v[56:57],v10 offset:33280
buffer_load_dwordx4 v26,s[16:19],s49 offen offset:3072 nt lds
s_add_u32 s49,s49,4096
M v[96:99],v[44:47],a[204:207],v[96:99]
ds_read_b64_tr_b16 v[58:59],v10 offset:37376
ds_read_b64_tr_b16 v[60:61],v10 offset:41472
v_cvt_pk_bf16_f32 v232,v100,v101
v_cvt_pk_bf16_f32 v233,v102,v103
M v[100:103],v[32:35],a[208:211],0
ds_read_b64_tr_b16 v[62:63],v10 offset:45568
s_mov_b32 m0,90112
M v[100:103],v[36:39],a[212:215],v[100:103]
buffer_load_dwordx4 v25,s[16:19],s49 offen nt lds
v_or_b32 v19,s80,v19
M v[100:103],v[40:43],a[216:219],v[100:103]
v_exp_f32 v112,v112
M v[100:103],v[44:47],a[220:223],v[100:103]
v_exp_f32 v113,v113
v_cvt_pk_bf16_f32 v240,v104,v105
v_cvt_pk_bf16_f32 v241,v106,v107
M v[104:107],v[32:35],a[224:227],0
buffer_load_dwordx4 v26,s[16:19],s49 offen offset:1024 nt lds
v_lshlrev_b32 v19,2,v19
M v[104:107],v[36:39],a[228:231],v[104:107]
v_exp_f32 v114,v114
M v[104:107],v[40:43],a[232:235],v[104:107]
buffer_load_dwordx4 v25,s[16:19],s49 offen offset:2048 nt lds
v_add_u32 v3,v3,v19
M v[104:107],v[44:47],a[236:239],v[104:107]
s_waitcnt lgkmcnt(0)
s_and_b32 s81,0xfffffffe,s83
M a[16:19],v[48:51],v[192:195],a[16:19]
ds_read_b128 v[32:35],v8 offset:12288
v_add_u32 v27,s81,v3
M a[16:19],v[52:55],v[196:199],a[16:19]
buffer_load_dwordx4 v26,s[16:19],s49 offen offset:3072 nt lds
s_add_u32 s49,s49,4096
M a[48:51],v[48:51],v[200:203],a[48:51]
ds_read_b128 v[36:39],v8 offset:12544
v_mov_b32 v28,0
M a[48:51],v[52:55],v[204:207],a[48:51]
s_mov_b32 m0,94208
v_bfrev_b32 v14,2
M a[80:83],v[48:51],v[208:211],a[80:83]
ds_read_b128 v[40:43],v8 offset:12800
buffer_load_dwordx4 v25,s[16:19],s49 offen nt lds
M a[80:83],v[52:55],v[212:215],a[80:83]
v_exp_f32 v115,v115
M a[20:23],v[56:59],v[192:195],a[20:23]
ds_read_b128 v[44:47],v8 offset:13056
v_writelane_b32 v14,0,0
M a[20:23],v[60:63],v[196:199],a[20:23]
buffer_load_dwordx4 v26,s[16:19],s49 offen offset:1024 nt lds
v_mov_b32 v29,161808
M a[52:55],v[56:59],v[200:203],a[52:55]
v_exp_f32 v116,v116
M a[52:55],v[60:63],v[204:207],a[52:55]
v_exp_f32 v117,v117
M a[84:87],v[56:59],v[208:211],a[84:87]
buffer_load_dwordx4 v25,s[16:19],s49 offen offset:2048 nt lds
ds_read_b128 v[4:7],v29
M a[84:87],v[60:63],v[212:215],a[84:87]
v_exp_f32 v118,v118
M v[168:171],v[176:179],v[208:211],v[168:171]
v_exp_f32 v119,v119
M v[168:171],v[176:179],v[212:215],v[168:171]
buffer_load_dwordx4 v26,s[16:19],s49 offen offset:3072 nt lds
s_add_u32 s49,s49,4096
s_waitcnt lgkmcnt(1)
v_cvt_pk_bf16_f32 v226,v112,v113
v_cvt_pk_bf16_f32 v227,v114,v115
M v[112:115],v[32:35],a[192:195],0
ds_read_b64_tr_b16 v[48:49],v9 offset:33536
ds_read_b64_tr_b16 v[50:51],v9 offset:37632
M v[112:115],v[36:39],a[196:199],v[112:115]
ds_read_b64_tr_b16 v[52:53],v9 offset:41728
ds_read_b64_tr_b16 v[54:55],v9 offset:45824
M v[112:115],v[40:43],a[200:203],v[112:115]
ds_read_b64_tr_b16 v[56:57],v10 offset:33536
s_waitcnt lgkmcnt(5)
v_or_b32 v4,v4,v5
M v[112:115],v[44:47],a[204:207],v[112:115]
ds_read_b64_tr_b16 v[58:59],v10 offset:37632
ds_read_b64_tr_b16 v[60:61],v10 offset:41728
v_cvt_pk_bf16_f32 v234,v116,v117
v_cvt_pk_bf16_f32 v235,v118,v119
M v[116:119],v[32:35],a[208:211],0
ds_read_b64_tr_b16 v[62:63],v10 offset:45824
v_or_b32 v6,v6,v7
M v[116:119],v[36:39],a[212:215],v[116:119]
v_exp_f32 v120,v120
M v[116:119],v[40:43],a[216:219],v[116:119]
v_exp_f32 v121,v121
M v[116:119],v[44:47],a[220:223],v[116:119]
v_exp_f32 v122,v122
v_exp_f32 v123,v123
v_cvt_pk_bf16_f32 v242,v120,v121
v_cvt_pk_bf16_f32 v243,v122,v123
M v[120:123],v[32:35],a[224:227],0
v_exp_f32 v128,v128
M v[120:123],v[36:39],a[228:231],v[120:123]
v_exp_f32 v129,v129
M v[120:123],v[40:43],a[232:235],v[120:123]
v_exp_f32 v130,v130
M v[120:123],v[44:47],a[236:239],v[120:123]
s_waitcnt vmcnt(24) lgkmcnt(0)
s_barrier
M a[24:27],v[48:51],v[192:195],a[24:27]
ds_read_b128 v[32:35],v8 offset:16384
s_mov_b32 m0,49152
v_mov_b32 v19,1
v_or_b32 v4,v4,v6
s_nop 0
v_readfirstlane_b32 s3,v4
s_nop 0
s_cmp_eq_u32 s3,0
s_cselect_b32 s80,0,0x40000000
v_or_b32 v29,s80,v14
buffer_store_dword v19,v29,s[64:67],s82 offen sc1
M a[24:27],v[52:55],v[196:199],a[24:27]
buffer_load_dwordx4 v21,s[12:15],s48 offen nt lds
v_cvt_pk_bf16_f32 v228,v128,v129
M a[56:59],v[48:51],v[200:203],a[56:59]
ds_read_b128 v[36:39],v8 offset:16640
M a[56:59],v[52:55],v[204:207],a[56:59]
buffer_load_dwordx4 v22,s[12:15],s48 offen offset:1024 nt lds
M a[88:91],v[48:51],v[208:211],a[88:91]
ds_read_b128 v[40:43],v8 offset:16896
M a[88:91],v[52:55],v[212:215],a[88:91]
s_cmp_lt_u32 s2,240
s_cselect_b32 s29,s3,1
M a[28:31],v[56:59],v[192:195],a[28:31]
ds_read_b128 v[44:47],v8 offset:17152
buffer_load_dwordx4 v23,s[12:15],s48 offen offset:2048 nt lds
M a[28:31],v[60:63],v[196:199],a[28:31]
v_exp_f32 v131,v131
M a[60:63],v[56:59],v[200:203],a[60:63]
v_exp_f32 v132,v132
M a[60:63],v[60:63],v[204:207],a[60:63]
buffer_load_dwordx4 v24,s[12:15],s48 offen offset:3072 nt lds
s_add_u32 s48,s48,4096
M a[92:95],v[56:59],v[208:211],a[92:95]
v_exp_f32 v133,v133
M a[92:95],v[60:63],v[212:215],a[92:95]
s_mov_b32 m0,53248
s_waitcnt lgkmcnt(0)
v_cvt_pk_bf16_f32 v229,v130,v131
M v[128:131],v[32:35],a[192:195],0
ds_read_b64_tr_b16 v[48:49],v9 offset:49152
ds_read_b64_tr_b16 v[50:51],v9 offset:53248
buffer_load_dwordx4 v21,s[12:15],s48 offen nt lds
M v[128:131],v[36:39],a[196:199],v[128:131]
ds_read_b64_tr_b16 v[52:53],v9 offset:57344
ds_read_b64_tr_b16 v[54:55],v9 offset:61440
M v[128:131],v[40:43],a[200:203],v[128:131]
ds_read_b64_tr_b16 v[56:57],v10 offset:49152
v_cvt_pk_bf16_f32 v236,v132,v133
M v[128:131],v[44:47],a[204:207],v[128:131]
ds_read_b64_tr_b16 v[58:59],v10 offset:53248
ds_read_b64_tr_b16 v[60:61],v10 offset:57344
buffer_load_dwordx4 v22,s[12:15],s48 offen offset:1024 nt lds
v_exp_f32 v134,v134
v_exp_f32 v135,v135
s_nop 0
v_cvt_pk_bf16_f32 v237,v134,v135
M v[132:135],v[32:35],a[208:211],0
ds_read_b64_tr_b16 v[62:63],v10 offset:61440
M v[132:135],v[36:39],a[212:215],v[132:135]
v_exp_f32 v136,v136
M v[132:135],v[40:43],a[216:219],v[132:135]
buffer_load_dwordx4 v23,s[12:15],s48 offen offset:2048 nt lds
M v[132:135],v[44:47],a[220:223],v[132:135]
v_exp_f32 v137,v137
v_exp_f32 v138,v138
v_exp_f32 v139,v139
v_cvt_pk_bf16_f32 v244,v136,v137
v_cvt_pk_bf16_f32 v245,v138,v139
M v[136:139],v[32:35],a[224:227],0
buffer_load_dwordx4 v24,s[12:15],s48 offen offset:3072 nt lds
s_add_u32 s48,s48,4096
M v[136:139],v[36:39],a[228:231],v[136:139]
v_exp_f32 v144,v144
M v[136:139],v[40:43],a[232:235],v[136:139]
s_mov_b32 m0,57344
M v[136:139],v[44:47],a[236:239],v[136:139]
buffer_load_dwordx4 v21,s[12:15],s48 offen nt lds
s_waitcnt lgkmcnt(0)
M a[0:3],v[48:51],v[224:227],a[0:3]
ds_read_b128 v[32:35],v8 offset:20480
v_exp_f32 v145,v145
s_nop 0
v_cvt_pk_bf16_f32 v230,v144,v145
v_exp_f32 v146,v146
v_exp_f32 v147,v147
s_nop 0
v_cvt_pk_bf16_f32 v231,v146,v147
s_nop 1
M a[0:3],v[52:55],v[228:231],a[0:3]
v_exp_f32 v148,v148
M a[32:35],v[48:51],v[232:235],a[32:35]
ds_read_b128 v[36:39],v8 offset:20736
buffer_load_dwordx4 v22,s[12:15],s48 offen offset:1024 nt lds
v_exp_f32 v149,v149
s_nop 0
v_cvt_pk_bf16_f32 v238,v148,v149
v_exp_f32 v150,v150
v_exp_f32 v151,v151
s_nop 0
v_cvt_pk_bf16_f32 v239,v150,v151
s_nop 1
M a[32:35],v[52:55],v[236:239],a[32:35]
v_exp_f32 v152,v152
M a[64:67],v[48:51],v[240:243],a[64:67]
ds_read_b128 v[40:43],v8 offset:20992
v_exp_f32 v153,v153
s_nop 0
v_cvt_pk_bf16_f32 v246,v152,v153
v_exp_f32 v154,v154
v_exp_f32 v155,v155
s_nop 0
v_cvt_pk_bf16_f32 v247,v154,v155
s_nop 1
M a[64:67],v[52:55],v[244:247],a[64:67]
buffer_load_dwordx4 v23,s[12:15],s48 offen offset:2048 nt lds
M a[4:7],v[56:59],v[224:227],a[4:7]
ds_read_b128 v[44:47],v8 offset:21248
M a[4:7],v[60:63],v[228:231],a[4:7]
v_exp_f32 v64,v64
M a[36:39],v[56:59],v[232:235],a[36:39]
buffer_load_dwordx4 v24,s[12:15],s48 offen offset:3072 nt lds
s_add_u32 s48,s48,4096
M a[36:39],v[60:63],v[236:239],a[36:39]
v_exp_f32 v65,v65
M a[68:71],v[56:59],v[240:243],a[68:71]
s_mov_b32 m0,61440
v_cvt_pk_bf16_f32 v192,v64,v65
M a[68:71],v[60:63],v[244:247],a[68:71]
buffer_load_dwordx4 v21,s[12:15],s48 offen nt lds
M v[160:163],v[176:179],v[224:227],v[160:163]
v_exp_f32 v66,v66
M v[160:163],v[176:179],v[228:231],v[160:163]
buffer_load_dwordx4 v22,s[12:15],s48 offen offset:1024 nt lds
s_waitcnt lgkmcnt(0)
M v[144:147],v[32:35],a[192:195],0
ds_read_b64_tr_b16 v[48:49],v9 offset:49408
ds_read_b64_tr_b16 v[50:51],v9 offset:53504
M v[144:147],v[36:39],a[196:199],v[144:147]
ds_read_b64_tr_b16 v[52:53],v9 offset:57600
ds_read_b64_tr_b16 v[54:55],v9 offset:61696
M v[144:147],v[40:43],a[200:203],v[144:147]
ds_read_b64_tr_b16 v[56:57],v10 offset:49408
buffer_load_dwordx4 v23,s[12:15],s48 offen offset:2048 nt lds
M v[144:147],v[44:47],a[204:207],v[144:147]
ds_read_b64_tr_b16 v[58:59],v10 offset:53504
ds_read_b64_tr_b16 v[60:61],v10 offset:57600
M v[148:151],v[32:35],a[208:211],0
ds_read_b64_tr_b16 v[62:63],v10 offset:61696
M v[148:151],v[36:39],a[212:215],v[148:151]
buffer_load_dwordx4 v24,s[12:15],s48 offen offset:3072 nt lds
s_add_u32 s48,s48,4096
M v[148:151],v[40:43],a[216:219],v[148:151]
v_exp_f32 v67,v67
M v[148:151],v[44:47],a[220:223],v[148:151]
s_mov_b32 m0,98304
v_cvt_pk_bf16_f32 v193,v66,v67
M v[152:155],v[32:35],a[224:227],0
buffer_load_dwordx4 v25,s[16:19],s49 offen nt lds
M v[152:155],v[36:39],a[228:231],v[152:155]
v_exp_f32 v68,v68
M v[152:155],v[40:43],a[232:235],v[152:155]
v_exp_f32 v69,v69
M v[152:155],v[44:47],a[236:239],v[152:155]
buffer_load_dwordx4 v26,s[16:19],s49 offen offset:1024 nt lds
s_waitcnt lgkmcnt(0)
M a[8:11],v[48:51],v[224:227],a[8:11]
ds_read_b128 v[32:35],v8 offset:24576
v_cvt_pk_bf16_f32 v200,v68,v69
M a[8:11],v[52:55],v[228:231],a[8:11]
v_exp_f32 v70,v70
M a[40:43],v[48:51],v[232:235],a[40:43]
ds_read_b128 v[36:39],v8 offset:24832
buffer_load_dwordx4 v25,s[16:19],s49 offen offset:2048 nt lds
M a[40:43],v[52:55],v[236:239],a[40:43]
v_exp_f32 v71,v71
M a[72:75],v[48:51],v[240:243],a[72:75]
ds_read_b128 v[40:43],v8 offset:25088
v_cvt_pk_bf16_f32 v201,v70,v71
M a[72:75],v[52:55],v[244:247],a[72:75]
buffer_load_dwordx4 v26,s[16:19],s49 offen offset:3072 nt lds
s_add_u32 s49,s49,4096
M a[12:15],v[56:59],v[224:227],a[12:15]
ds_read_b128 v[44:47],v8 offset:25344
s_mov_b32 m0,102400
M a[12:15],v[60:63],v[228:231],a[12:15]
buffer_load_dwordx4 v25,s[16:19],s49 offen nt lds
M a[44:47],v[56:59],v[232:235],a[44:47]
v_exp_f32 v72,v72
M a[44:47],v[60:63],v[236:239],a[44:47]
v_exp_f32 v73,v73
M a[76:79],v[56:59],v[240:243],a[76:79]
buffer_load_dwordx4 v26,s[16:19],s49 offen offset:1024 nt lds
v_cvt_pk_bf16_f32 v208,v72,v73
M a[76:79],v[60:63],v[244:247],a[76:79]
v_exp_f32 v74,v74
M v[164:167],v[176:179],v[232:235],v[164:167]
v_exp_f32 v75,v75
M v[164:167],v[176:179],v[236:239],v[164:167]
buffer_load_dwordx4 v25,s[16:19],s49 offen offset:2048 nt lds
s_waitcnt lgkmcnt(0)
M v[64:67],v[32:35],a[192:195],0
ds_read_b64_tr_b16 v[48:49],v9 offset:49664
ds_read_b64_tr_b16 v[50:51],v9 offset:53760
M v[64:67],v[36:39],a[196:199],v[64:67]
ds_read_b64_tr_b16 v[52:53],v9 offset:57856
ds_read_b64_tr_b16 v[54:55],v9 offset:61952
M v[64:67],v[40:43],a[200:203],v[64:67]
ds_read_b64_tr_b16 v[56:57],v10 offset:49664
buffer_load_dwordx4 v26,s[16:19],s49 offen offset:3072 nt lds
s_add_u32 s49,s49,4096
M v[64:67],v[44:47],a[204:207],v[64:67]
ds_read_b64_tr_b16 v[58:59],v10 offset:53760
ds_read_b64_tr_b16 v[60:61],v10 offset:57856
M v[68:71],v[32:35],a[208:211],0
ds_read_b64_tr_b16 v[62:63],v10 offset:61952
s_mov_b32 m0,106496
M v[68:71],v[36:39],a[212:215],v[68:71]
buffer_load_dwordx4 v25,s[16:19],s49 offen nt lds
v_cvt_pk_bf16_f32 v209,v74,v75
M v[68:71],v[40:43],a[216:219],v[68:71]
v_exp_f32 v80,v80
M v[68:71],v[44:47],a[220:223],v[68:71]
v_exp_f32 v81,v81
M v[72:75],v[32:35],a[224:227],0
buffer_load_dwordx4 v26,s[16:19],s49 offen offset:1024 nt lds
v_cvt_pk_bf16_f32 v194,v80,v81
M v[72:75],v[36:39],a[228:231],v[72:75]
v_exp_f32 v82,v82
M v[72:75],v[40:43],a[232:235],v[72:75]
buffer_load_dwordx4 v25,s[16:19],s49 offen offset:2048 nt lds
M v[72:75],v[44:47],a[236:239],v[72:75]
s_waitcnt lgkmcnt(0)
M a[16:19],v[48:51],v[224:227],a[16:19]
ds_read_b128 v[32:35],v8 offset:28672
M a[16:19],v[52:55],v[228:231],a[16:19]
buffer_load_dwordx4 v26,s[16:19],s49 offen offset:3072 nt lds
s_add_u32 s49,s49,4096
M a[48:51],v[48:51],v[232:235],a[48:51]
ds_read_b128 v[36:39],v8 offset:28928
M a[48:51],v[52:55],v[236:239],a[48:51]
s_mov_b32 m0,110592
M a[80:83],v[48:51],v[240:243],a[80:83]
ds_read_b128 v[40:43],v8 offset:29184
buffer_load_dwordx4 v25,s[16:19],s49 offen nt lds
M a[80:83],v[52:55],v[244:247],a[80:83]
v_exp_f32 v83,v83
M a[20:23],v[56:59],v[224:227],a[20:23]
ds_read_b128 v[44:47],v8 offset:29440
v_cvt_pk_bf16_f32 v195,v82,v83
M a[20:23],v[60:63],v[228:231],a[20:23]
buffer_load_dwordx4 v26,s[16:19],s49 offen offset:1024 nt lds
M a[52:55],v[56:59],v[232:235],a[52:55]
v_exp_f32 v84,v84
M a[52:55],v[60:63],v[236:239],a[52:55]
v_exp_f32 v85,v85
M a[84:87],v[56:59],v[240:243],a[84:87]
buffer_load_dwordx4 v25,s[16:19],s49 offen offset:2048 nt lds
v_cvt_pk_bf16_f32 v202,v84,v85
M a[84:87],v[60:63],v[244:247],a[84:87]
v_exp_f32 v86,v86
M v[168:171],v[176:179],v[240:243],v[168:171]
v_exp_f32 v87,v87
M v[168:171],v[176:179],v[244:247],v[168:171]
buffer_load_dwordx4 v26,s[16:19],s49 offen offset:3072 nt lds
s_add_u32 s49,s49,4096
s_waitcnt lgkmcnt(0)
M v[80:83],v[32:35],a[192:195],0
ds_read_b64_tr_b16 v[48:49],v9 offset:49920
ds_read_b64_tr_b16 v[50:51],v9 offset:54016
M v[80:83],v[36:39],a[196:199],v[80:83]
ds_read_b64_tr_b16 v[52:53],v9 offset:58112
ds_read_b64_tr_b16 v[54:55],v9 offset:62208
M v[80:83],v[40:43],a[200:203],v[80:83]
ds_read_b64_tr_b16 v[56:57],v10 offset:49920
v_cvt_pk_bf16_f32 v203,v86,v87
M v[80:83],v[44:47],a[204:207],v[80:83]
ds_read_b64_tr_b16 v[58:59],v10 offset:54016
ds_read_b64_tr_b16 v[60:61],v10 offset:58112
M v[84:87],v[32:35],a[208:211],0
ds_read_b64_tr_b16 v[62:63],v10 offset:62208
M v[84:87],v[36:39],a[212:215],v[84:87]
v_exp_f32 v88,v88
M v[84:87],v[40:43],a[216:219],v[84:87]
v_exp_f32 v89,v89
M v[84:87],v[44:47],a[220:223],v[84:87]
v_exp_f32 v90,v90
v_exp_f32 v91,v91
v_cvt_pk_bf16_f32 v210,v88,v89
v_cvt_pk_bf16_f32 v211,v90,v91
M v[88:91],v[32:35],a[224:227],0
v_exp_f32 v96,v96
M v[88:91],v[36:39],a[228:231],v[88:91]
v_exp_f32 v97,v97
M v[88:91],v[40:43],a[232:235],v[88:91]
v_exp_f32 v98,v98
M v[88:91],v[44:47],a[236:239],v[88:91]
s_waitcnt vmcnt(49) lgkmcnt(0)
s_barrier
M a[24:27],v[48:51],v[224:227],a[24:27]
ds_read_b128 v[32:35],v8 offset:32768
s_mov_b32 m0,114688
M a[24:27],v[52:55],v[228:231],a[24:27]
buffer_load_dwordx4 v25,s[16:19],s49 offen nt lds
v_cvt_pk_bf16_f32 v196,v96,v97
M a[56:59],v[48:51],v[232:235],a[56:59]
ds_read_b128 v[36:39],v8 offset:33024
M a[56:59],v[52:55],v[236:239],a[56:59]
buffer_load_dwordx4 v26,s[16:19],s49 offen offset:1024 nt lds
M a[88:91],v[48:51],v[240:243],a[88:91]
ds_read_b128 v[40:43],v8 offset:33280
M a[88:91],v[52:55],v[244:247],a[88:91]
v_exp_f32 v99,v99
M a[28:31],v[56:59],v[224:227],a[28:31]
ds_read_b128 v[44:47],v8 offset:33536
buffer_load_dwordx4 v25,s[16:19],s49 offen offset:2048 nt lds
M a[28:31],v[60:63],v[228:231],a[28:31]
v_exp_f32 v100,v100
M a[60:63],v[56:59],v[232:235],a[60:63]
v_exp_f32 v101,v101
M a[60:63],v[60:63],v[236:239],a[60:63]
buffer_load_dwordx4 v26,s[16:19],s49 offen offset:3072 nt lds
s_add_u32 s49,s49,4096
M a[92:95],v[56:59],v[240:243],a[92:95]
v_exp_f32 v102,v102
M a[92:95],v[60:63],v[244:247],a[92:95]
s_mov_b32 m0,118784
s_waitcnt lgkmcnt(0)
v_cvt_pk_bf16_f32 v197,v98,v99
M v[96:99],v[32:35],a[192:195],0
ds_read_b64_tr_b16 v[48:49],v9
ds_read_b64_tr_b16 v[50:51],v9 offset:4096
buffer_load_dwordx4 v25,s[16:19],s49 offen nt lds
M v[96:99],v[36:39],a[196:199],v[96:99]
ds_read_b64_tr_b16 v[52:53],v9 offset:8192
ds_read_b64_tr_b16 v[54:55],v9 offset:12288
M v[96:99],v[40:43],a[200:203],v[96:99]
ds_read_b64_tr_b16 v[56:57],v10
v_cvt_pk_bf16_f32 v204,v100,v101
M v[96:99],v[44:47],a[204:207],v[96:99]
ds_read_b64_tr_b16 v[58:59],v10 offset:4096
ds_read_b64_tr_b16 v[60:61],v10 offset:8192
buffer_load_dwordx4 v26,s[16:19],s49 offen offset:1024 nt lds
v_exp_f32 v103,v103
s_nop 0
v_cvt_pk_bf16_f32 v205,v102,v103
M v[100:103],v[32:35],a[208:211],0
ds_read_b64_tr_b16 v[62:63],v10 offset:12288
M v[100:103],v[36:39],a[212:215],v[100:103]
v_exp_f32 v104,v104
M v[100:103],v[40:43],a[216:219],v[100:103]
buffer_load_dwordx4 v25,s[16:19],s49 offen offset:2048 nt lds
M v[100:103],v[44:47],a[220:223],v[100:103]
v_exp_f32 v105,v105
v_exp_f32 v106,v106
v_exp_f32 v107,v107
v_cvt_pk_bf16_f32 v212,v104,v105
v_cvt_pk_bf16_f32 v213,v106,v107
M v[104:107],v[32:35],a[224:227],0
v_exp_f32 v112,v112
M v[104:107],v[36:39],a[228:231],v[104:107]
buffer_load_dwordx4 v26,s[16:19],s49 offen offset:3072 nt lds
s_add_u32 s49,s49,4096
M v[104:107],v[40:43],a[232:235],v[104:107]
v_exp_f32 v113,v113
M v[104:107],v[44:47],a[236:239],v[104:107]
s_mov_b32 m0,122880
s_waitcnt lgkmcnt(0)
M a[0:3],v[48:51],v[192:195],a[0:3]
ds_read_b128 v[32:35],v8 offset:36864
buffer_load_dwordx4 v25,s[16:19],s49 offen nt lds
v_cvt_pk_bf16_f32 v198,v112,v113
v_exp_f32 v114,v114
v_exp_f32 v115,v115
s_nop 0
v_cvt_pk_bf16_f32 v199,v114,v115
s_nop 1
M a[0:3],v[52:55],v[196:199],a[0:3]
v_exp_f32 v116,v116
M a[32:35],v[48:51],v[200:203],a[32:35]
ds_read_b128 v[36:39],v8 offset:37120
v_exp_f32 v117,v117
s_nop 0
v_cvt_pk_bf16_f32 v206,v116,v117
v_exp_f32 v118,v118
v_exp_f32 v119,v119
s_nop 0
v_cvt_pk_bf16_f32 v207,v118,v119
s_nop 1
M a[32:35],v[52:55],v[204:207],a[32:35]
buffer_load_dwordx4 v26,s[16:19],s49 offen offset:1024 nt lds
M a[64:67],v[48:51],v[208:211],a[64:67]
ds_read_b128 v[40:43],v8 offset:37376
v_exp_f32 v120,v120
v_exp_f32 v121,v121
s_nop 0
v_cvt_pk_bf16_f32 v214,v120,v121
v_exp_f32 v122,v122
v_exp_f32 v123,v123
s_nop 0
v_cvt_pk_bf16_f32 v215,v122,v123
s_nop 1
M a[64:67],v[52:55],v[212:215],a[64:67]
v_exp_f32 v128,v128
M a[4:7],v[56:59],v[192:195],a[4:7]
ds_read_b128 v[44:47],v8 offset:37632
buffer_load_dwordx4 v25,s[16:19],s49 offen offset:2048 nt lds
M a[4:7],v[60:63],v[196:199],a[4:7]
v_exp_f32 v129,v129
M a[36:39],v[56:59],v[200:203],a[36:39]
v_exp_f32 v130,v130
M a[36:39],v[60:63],v[204:207],a[36:39]
buffer_load_dwordx4 v26,s[16:19],s49 offen offset:3072 nt lds
s_add_u32 s49,s49,4096
M a[68:71],v[56:59],v[208:211],a[68:71]
v_exp_f32 v131,v131
M a[68:71],v[60:63],v[212:215],a[68:71]
s_mov_b32 m0,126976
v_cvt_pk_bf16_f32 v224,v128,v129
M v[160:163],v[176:179],v[192:195],v[160:163]
buffer_load_dwordx4 v25,s[16:19],s49 offen nt lds
v_cvt_pk_bf16_f32 v225,v130,v131
M v[160:163],v[176:179],v[196:199],v[160:163]
s_waitcnt lgkmcnt(0)
M v[112:115],v[32:35],a[192:195],0
ds_read_b64_tr_b16 v[48:49],v9 offset:256
ds_read_b64_tr_b16 v[50:51],v9 offset:4352
M v[112:115],v[36:39],a[196:199],v[112:115]
ds_read_b64_tr_b16 v[52:53],v9 offset:8448
ds_read_b64_tr_b16 v[54:55],v9 offset:12544
buffer_load_dwordx4 v26,s[16:19],s49 offen offset:1024 nt lds
M v[112:115],v[40:43],a[200:203],v[112:115]
ds_read_b64_tr_b16 v[56:57],v10 offset:256
M v[112:115],v[44:47],a[204:207],v[112:115]
ds_read_b64_tr_b16 v[58:59],v10 offset:4352
ds_read_b64_tr_b16 v[60:61],v10 offset:8448
M v[116:119],v[32:35],a[208:211],0
ds_read_b64_tr_b16 v[62:63],v10 offset:12544
buffer_load_dwordx4 v25,s[16:19],s49 offen offset:2048 nt lds
M v[116:119],v[36:39],a[212:215],v[116:119]
v_exp_f32 v132,v132
M v[116:119],v[40:43],a[216:219],v[116:119]
v_exp_f32 v133,v133
M v[116:119],v[44:47],a[220:223],v[116:119]
buffer_load_dwordx4 v26,s[16:19],s49 offen offset:3072 nt lds
s_add_u32 s49,s49,4096
M v[120:123],v[32:35],a[224:227],0
v_exp_f32 v134,v134
M v[120:123],v[36:39],a[228:231],v[120:123]
v_exp_f32 v135,v135
M v[120:123],v[40:43],a[232:235],v[120:123]
v_exp_f32 v136,v136
M v[120:123],v[44:47],a[236:239],v[120:123]
s_waitcnt lgkmcnt(0)
v_cvt_pk_bf16_f32 v232,v132,v133
M a[8:11],v[48:51],v[192:195],a[8:11]
ds_read_b128 v[32:35],v8 offset:40960
v_cvt_pk_bf16_f32 v233,v134,v135
M a[8:11],v[52:55],v[196:199],a[8:11]
v_exp_f32 v137,v137
M a[40:43],v[48:51],v[200:203],a[40:43]
ds_read_b128 v[36:39],v8 offset:41216
v_cvt_pk_bf16_f32 v240,v136,v137
M a[40:43],v[52:55],v[204:207],a[40:43]
v_exp_f32 v138,v138
M a[72:75],v[48:51],v[208:211],a[72:75]
ds_read_b128 v[40:43],v8 offset:41472
M a[72:75],v[52:55],v[212:215],a[72:75]
v_exp_f32 v139,v139
M a[12:15],v[56:59],v[192:195],a[12:15]
ds_read_b128 v[44:47],v8 offset:41728
v_cvt_pk_bf16_f32 v241,v138,v139
M a[12:15],v[60:63],v[196:199],a[12:15]
v_exp_f32 v144,v144
M a[44:47],v[56:59],v[200:203],a[44:47]
v_exp_f32 v145,v145
M a[44:47],v[60:63],v[204:207],a[44:47]
v_exp_f32 v146,v146
M a[76:79],v[56:59],v[208:211],a[76:79]
v_exp_f32 v147,v147
M a[76:79],v[60:63],v[212:215],a[76:79]
v_exp_f32 v148,v148
M v[164:167],v[176:179],v[200:203],v[164:167]
v_exp_f32 v149,v149
M v[164:167],v[176:179],v[204:207],v[164:167]
s_waitcnt lgkmcnt(0)
v_cvt_pk_bf16_f32 v226,v144,v145
M v[128:131],v[32:35],a[192:195],0
ds_read_b64_tr_b16 v[48:49],v9 offset:512
ds_read_b64_tr_b16 v[50:51],v9 offset:4608
s_xor_b32 m0,s74,0
M v[128:131],v[36:39],a[196:199],v[128:131]
ds_read_b64_tr_b16 v[52:53],v9 offset:8704
ds_read_b64_tr_b16 v[54:55],v9 offset:12800
buffer_load_dwordx4 v12,s[56:59],s73 offen lds
M v[128:131],v[40:43],a[200:203],v[128:131]
ds_read_b64_tr_b16 v[56:57],v10 offset:512
v_cvt_pk_bf16_f32 v227,v146,v147
M v[128:131],v[44:47],a[204:207],v[128:131]
ds_read_b64_tr_b16 v[58:59],v10 offset:4608
ds_read_b64_tr_b16 v[60:61],v10 offset:8704
M v[132:135],v[32:35],a[208:211],0
ds_read_b64_tr_b16 v[62:63],v10 offset:12800
v_cvt_pk_bf16_f32 v234,v148,v149
M v[132:135],v[36:39],a[212:215],v[132:135]
s_xor_b32 s81,s73,0x1000
s_xor_b32 m0,s74,0x400
M v[132:135],v[40:43],a[216:219],v[132:135]
buffer_load_dwordx4 v13,s[56:59],s81 offen lds
M v[132:135],v[44:47],a[220:223],v[132:135]
v_exp_f32 v150,v150
M v[136:139],v[32:35],a[224:227],0
v_exp_f32 v151,v151
M v[136:139],v[36:39],a[228:231],v[136:139]
v_exp_f32 v152,v152
M v[136:139],v[40:43],a[232:235],v[136:139]
v_exp_f32 v153,v153
M v[136:139],v[44:47],a[236:239],v[136:139]
s_xor_b32 s80,s73,0x2000
s_xor_b32 m0,s74,0x800
s_waitcnt lgkmcnt(0)
M a[16:19],v[48:51],v[192:195],a[16:19]
ds_read_b128 v[32:35],v8 offset:45056
buffer_load_dwordx4 v12,s[56:59],s80 offen lds
M a[16:19],v[52:55],v[196:199],a[16:19]
v_exp_f32 v154,v154
M a[48:51],v[48:51],v[200:203],a[48:51]
ds_read_b128 v[36:39],v8 offset:45312
v_cvt_pk_bf16_f32 v235,v150,v151
M a[48:51],v[52:55],v[204:207],a[48:51]
v_exp_f32 v155,v155
M a[80:83],v[48:51],v[208:211],a[80:83]
ds_read_b128 v[40:43],v8 offset:45568
s_xor_b32 s81,s73,0x3000
s_xor_b32 m0,s74,0xc00
M a[80:83],v[52:55],v[212:215],a[80:83]
buffer_load_dwordx4 v13,s[56:59],s81 offen lds
v_cvt_pk_bf16_f32 v242,v152,v153
M a[20:23],v[56:59],v[192:195],a[20:23]
ds_read_b128 v[44:47],v8 offset:45824
v_cvt_pk_bf16_f32 v243,v154,v155
M a[20:23],v[60:63],v[196:199],a[20:23]
v_exp_f32 v64,v64
M a[52:55],v[56:59],v[200:203],a[52:55]
v_exp_f32 v65,v65
M a[52:55],v[60:63],v[204:207],a[52:55]
v_exp_f32 v66,v66
M a[84:87],v[56:59],v[208:211],a[84:87]
s_xor_b32 s80,s73,0x4000
s_xor_b32 m0,s74,0x1000
M a[84:87],v[60:63],v[212:215],a[84:87]
buffer_load_dwordx4 v12,s[56:59],s80 offen lds
v_cvt_pk_bf16_f32 v228,v64,v65
M v[168:171],v[176:179],v[208:211],v[168:171]
v_exp_f32 v67,v67
M v[168:171],v[176:179],v[212:215],v[168:171]
s_waitcnt lgkmcnt(0)
v_cvt_pk_bf16_f32 v229,v66,v67
M v[144:147],v[32:35],a[192:195],0
ds_read_b64_tr_b16 v[48:49],v9 offset:768
ds_read_b64_tr_b16 v[50:51],v9 offset:4864
M v[144:147],v[36:39],a[196:199],v[144:147]
ds_read_b64_tr_b16 v[52:53],v9 offset:8960
ds_read_b64_tr_b16 v[54:55],v9 offset:13056
M v[144:147],v[40:43],a[200:203],v[144:147]
ds_read_b64_tr_b16 v[56:57],v10 offset:768
s_xor_b32 s81,s73,0x5000
s_xor_b32 m0,s74,0x1400
M v[144:147],v[44:47],a[204:207],v[144:147]
ds_read_b64_tr_b16 v[58:59],v10 offset:4864
ds_read_b64_tr_b16 v[60:61],v10 offset:8960
buffer_load_dwordx4 v13,s[56:59],s81 offen lds
M v[148:151],v[32:35],a[208:211],0
ds_read_b64_tr_b16 v[62:63],v10 offset:13056
M v[148:151],v[36:39],a[212:215],v[148:151]
v_exp_f32 v68,v68
M v[148:151],v[40:43],a[216:219],v[148:151]
v_exp_f32 v69,v69
M v[148:151],v[44:47],a[220:223],v[148:151]
s_xor_b32 s80,s73,0x6000
s_xor_b32 m0,s74,0x1800
M v[152:155],v[32:35],a[224:227],0
buffer_load_dwordx4 v12,s[56:59],s80 offen lds
v_cvt_pk_bf16_f32 v236,v68,v69
M v[152:155],v[36:39],a[228:231],v[152:155]
v_exp_f32 v70,v70
M v[152:155],v[40:43],a[232:235],v[152:155]
v_exp_f32 v71,v71
M v[152:155],v[44:47],a[236:239],v[152:155]
s_waitcnt vmcnt(39) lgkmcnt(0)
s_barrier
M a[24:27],v[48:51],v[192:195],a[24:27]
ds_read_b128 v[32:35],v8 offset:49152
v_cvt_pk_bf16_f32 v237,v70,v71
M a[24:27],v[52:55],v[196:199],a[24:27]
s_xor_b32 s81,s73,0x7000
s_xor_b32 m0,s74,0x1c00
M a[56:59],v[48:51],v[200:203],a[56:59]
ds_read_b128 v[36:39],v8 offset:49408
buffer_load_dwordx4 v13,s[56:59],s81 offen lds
M a[56:59],v[52:55],v[204:207],a[56:59]
v_exp_f32 v72,v72
M a[88:91],v[48:51],v[208:211],a[88:91]
ds_read_b128 v[40:43],v8 offset:49664
M a[88:91],v[52:55],v[212:215],a[88:91]
v_exp_f32 v73,v73
M a[28:31],v[56:59],v[192:195],a[28:31]
ds_read_b128 v[44:47],v8 offset:49920
v_cvt_pk_bf16_f32 v244,v72,v73
M a[28:31],v[60:63],v[196:199],a[28:31]
v_exp_f32 v74,v74
M a[60:63],v[56:59],v[200:203],a[60:63]
v_exp_f32 v75,v75
M a[60:63],v[60:63],v[204:207],a[60:63]
v_exp_f32 v80,v80
M a[92:95],v[56:59],v[208:211],a[92:95]
v_exp_f32 v81,v81
M a[92:95],v[60:63],v[212:215],a[92:95]
s_waitcnt lgkmcnt(0)
v_cvt_pk_bf16_f32 v245,v74,v75
M v[64:67],v[32:35],a[192:195],0
ds_read_b64_tr_b16 v[48:49],v9 offset:16384
ds_read_b64_tr_b16 v[50:51],v9 offset:20480
M v[64:67],v[36:39],a[196:199],v[64:67]
ds_read_b64_tr_b16 v[52:53],v9 offset:24576
ds_read_b64_tr_b16 v[54:55],v9 offset:28672
buffer_load_dwordx4 a[128:131],v11,s[60:63],s72 offen sc1
M v[64:67],v[40:43],a[200:203],v[64:67]
ds_read_b64_tr_b16 v[56:57],v10 offset:16384
v_cvt_pk_bf16_f32 v230,v80,v81
M v[64:67],v[44:47],a[204:207],v[64:67]
ds_read_b64_tr_b16 v[58:59],v10 offset:20480
ds_read_b64_tr_b16 v[60:61],v10 offset:24576
M v[68:71],v[32:35],a[208:211],0
ds_read_b64_tr_b16 v[62:63],v10 offset:28672
M v[68:71],v[36:39],a[212:215],v[68:71]
s_xor_b32 s80,s72,0x20000
M v[68:71],v[40:43],a[216:219],v[68:71]
buffer_load_dwordx4 a[144:147],v11,s[60:63],s80 offen sc1
M v[68:71],v[44:47],a[220:223],v[68:71]
v_exp_f32 v82,v82
M v[72:75],v[32:35],a[224:227],0
v_exp_f32 v83,v83
M v[72:75],v[36:39],a[228:231],v[72:75]
v_exp_f32 v84,v84
M v[72:75],v[40:43],a[232:235],v[72:75]
v_exp_f32 v85,v85
M v[72:75],v[44:47],a[236:239],v[72:75]
s_xor_b32 s81,s72,0x400
s_waitcnt lgkmcnt(0)
M a[0:3],v[48:51],v[224:227],a[0:3]
ds_read_b128 v[32:35],v8 offset:53248
buffer_load_dwordx4 a[132:135],v11,s[60:63],s81 offen sc1
v_cvt_pk_bf16_f32 v231,v82,v83
s_nop 1
M a[0:3],v[52:55],v[228:231],a[0:3]
v_exp_f32 v86,v86
M a[32:35],v[48:51],v[232:235],a[32:35]
ds_read_b128 v[36:39],v8 offset:53504
v_cvt_pk_bf16_f32 v238,v84,v85
v_exp_f32 v87,v87
s_nop 0
v_cvt_pk_bf16_f32 v239,v86,v87
s_nop 1
M a[32:35],v[52:55],v[236:239],a[32:35]
v_exp_f32 v88,v88
M a[64:67],v[48:51],v[240:243],a[64:67]
ds_read_b128 v[40:43],v8 offset:53760
v_exp_f32 v89,v89
s_nop 0
v_cvt_pk_bf16_f32 v246,v88,v89
v_exp_f32 v90,v90
v_exp_f32 v91,v91
s_nop 0
v_cvt_pk_bf16_f32 v247,v90,v91
s_nop 1
M a[64:67],v[52:55],v[244:247],a[64:67]
s_xor_b32 s80,s72,0x20400
M a[4:7],v[56:59],v[224:227],a[4:7]
ds_read_b128 v[44:47],v8 offset:54016
buffer_load_dwordx4 a[148:151],v11,s[60:63],s80 offen sc1
M a[4:7],v[60:63],v[228:231],a[4:7]
v_exp_f32 v96,v96
M a[36:39],v[56:59],v[232:235],a[36:39]
v_exp_f32 v97,v97
M a[36:39],v[60:63],v[236:239],a[36:39]
v_exp_f32 v98,v98
M a[68:71],v[56:59],v[240:243],a[68:71]
v_exp_f32 v99,v99
M a[68:71],v[60:63],v[244:247],a[68:71]
s_xor_b32 s81,s72,0x800
v_cvt_pk_bf16_f32 v192,v96,v97
M v[160:163],v[176:179],v[224:227],v[160:163]
buffer_load_dwordx4 a[136:139],v11,s[60:63],s81 offen sc1
v_cvt_pk_bf16_f32 v193,v98,v99
M v[160:163],v[176:179],v[228:231],v[160:163]
s_waitcnt lgkmcnt(0)
M v[80:83],v[32:35],a[192:195],0
ds_read_b64_tr_b16 v[48:49],v9 offset:16640
ds_read_b64_tr_b16 v[50:51],v9 offset:20736
M v[80:83],v[36:39],a[196:199],v[80:83]
ds_read_b64_tr_b16 v[52:53],v9 offset:24832
ds_read_b64_tr_b16 v[54:55],v9 offset:28928
M v[80:83],v[40:43],a[200:203],v[80:83]
ds_read_b64_tr_b16 v[56:57],v10 offset:16640
M v[80:83],v[44:47],a[204:207],v[80:83]
ds_read_b64_tr_b16 v[58:59],v10 offset:20736
ds_read_b64_tr_b16 v[60:61],v10 offset:24832
s_xor_b32 s80,s72,0x20800
M v[84:87],v[32:35],a[208:211],0
ds_read_b64_tr_b16 v[62:63],v10 offset:28928
buffer_load_dwordx4 a[152:155],v11,s[60:63],s80 offen sc1
M v[84:87],v[36:39],a[212:215],v[84:87]
v_exp_f32 v100,v100
M v[84:87],v[40:43],a[216:219],v[84:87]
v_exp_f32 v101,v101
M v[84:87],v[44:47],a[220:223],v[84:87]
v_exp_f32 v102,v102
M v[88:91],v[32:35],a[224:227],0
s_xor_b32 s81,s72,0xc00
v_cvt_pk_bf16_f32 v200,v100,v101
M v[88:91],v[36:39],a[228:231],v[88:91]
buffer_load_dwordx4 a[140:143],v11,s[60:63],s81 offen sc1
M v[88:91],v[40:43],a[232:235],v[88:91]
v_exp_f32 v103,v103
M v[88:91],v[44:47],a[236:239],v[88:91]
s_waitcnt lgkmcnt(0)
v_cvt_pk_bf16_f32 v201,v102,v103
M a[8:11],v[48:51],v[224:227],a[8:11]
ds_read_b128 v[32:35],v8 offset:57344
M a[8:11],v[52:55],v[228:231],a[8:11]
v_exp_f32 v104,v104
M a[40:43],v[48:51],v[232:235],a[40:43]
ds_read_b128 v[36:39],v8 offset:57600
s_xor_b32 s80,s72,0x20c00
M a[40:43],v[52:55],v[236:239],a[40:43]
buffer_load_dwordx4 a[156:159],v11,s[60:63],s80 offen sc1
M a[72:75],v[48:51],v[240:243],a[72:75]
ds_read_b128 v[40:43],v8 offset:57856
M a[72:75],v[52:55],v[244:247],a[72:75]
v_exp_f32 v105,v105
M a[12:15],v[56:59],v[224:227],a[12:15]
ds_read_b128 v[44:47],v8 offset:58112
v_cvt_pk_bf16_f32 v208,v104,v105
M a[12:15],v[60:63],v[228:231],a[12:15]
v_exp_f32 v106,v106
M a[44:47],v[56:59],v[232:235],a[44:47]
s_xor_b32 s81,s72,0x2000
M a[44:47],v[60:63],v[236:239],a[44:47]
buffer_load_dwordx4 a[160:163],v11,s[60:63],s81 offen sc1
M a[76:79],v[56:59],v[240:243],a[76:79]
v_exp_f32 v107,v107
M a[76:79],v[60:63],v[244:247],a[76:79]
v_exp_f32 v112,v112
M v[164:167],v[176:179],v[232:235],v[164:167]
v_exp_f32 v113,v113
M v[164:167],v[176:179],v[236:239],v[164:167]
s_waitcnt lgkmcnt(0)
v_cvt_pk_bf16_f32 v209,v106,v107
M v[96:99],v[32:35],a[192:195],0
ds_read_b64_tr_b16 v[48:49],v9 offset:16896
ds_read_b64_tr_b16 v[50:51],v9 offset:20992
s_xor_b32 s80,s72,0x22000
M v[96:99],v[36:39],a[196:199],v[96:99]
ds_read_b64_tr_b16 v[52:53],v9 offset:25088
ds_read_b64_tr_b16 v[54:55],v9 offset:29184
buffer_load_dwordx4 a[176:179],v11,s[60:63],s80 offen sc1
M v[96:99],v[40:43],a[200:203],v[96:99]
ds_read_b64_tr_b16 v[56:57],v10 offset:16896
v_cvt_pk_bf16_f32 v194,v112,v113
M v[96:99],v[44:47],a[204:207],v[96:99]
ds_read_b64_tr_b16 v[58:59],v10 offset:20992
ds_read_b64_tr_b16 v[60:61],v10 offset:25088
M v[100:103],v[32:35],a[208:211],0
ds_read_b64_tr_b16 v[62:63],v10 offset:29184
M v[100:103],v[36:39],a[212:215],v[100:103]
v_exp_f32 v114,v114
M v[100:103],v[40:43],a[216:219],v[100:103]
s_xor_b32 s81,s72,0x2400
M v[100:103],v[44:47],a[220:223],v[100:103]
buffer_load_dwordx4 a[164:167],v11,s[60:63],s81 offen sc1
M v[104:107],v[32:35],a[224:227],0
v_exp_f32 v115,v115
M v[104:107],v[36:39],a[228:231],v[104:107]
v_exp_f32 v116,v116
M v[104:107],v[40:43],a[232:235],v[104:107]
v_exp_f32 v117,v117
M v[104:107],v[44:47],a[236:239],v[104:107]
s_xor_b32 s80,s72,0x22400
s_waitcnt lgkmcnt(0)
M a[16:19],v[48:51],v[224:227],a[16:19]
ds_read_b128 v[32:35],v8 offset:61440
buffer_load_dwordx4 a[180:183],v11,s[60:63],s80 offen sc1
M a[16:19],v[52:55],v[228:231],a[16:19]
v_exp_f32 v118,v118
M a[48:51],v[48:51],v[232:235],a[48:51]
ds_read_b128 v[36:39],v8 offset:61696
v_cvt_pk_bf16_f32 v195,v114,v115
M a[48:51],v[52:55],v[236:239],a[48:51]
v_exp_f32 v119,v119
M a[80:83],v[48:51],v[240:243],a[80:83]
ds_read_b128 v[40:43],v8 offset:61952
v_cvt_pk_bf16_f32 v202,v116,v117
M a[80:83],v[52:55],v[244:247],a[80:83]
s_xor_b32 s81,s72,0x2800
v_cvt_pk_bf16_f32 v203,v118,v119
M a[20:23],v[56:59],v[224:227],a[20:23]
ds_read_b128 v[44:47],v8 offset:62208
buffer_load_dwordx4 a[168:171],v11,s[60:63],s81 offen sc1
M a[20:23],v[60:63],v[228:231],a[20:23]
v_exp_f32 v120,v120
M a[52:55],v[56:59],v[232:235],a[52:55]
v_exp_f32 v121,v121
M a[52:55],v[60:63],v[236:239],a[52:55]
v_exp_f32 v122,v122
M a[84:87],v[56:59],v[240:243],a[84:87]
v_exp_f32 v123,v123
M a[84:87],v[60:63],v[244:247],a[84:87]
s_xor_b32 s80,s72,0x22800
v_cvt_pk_bf16_f32 v210,v120,v121
M v[168:171],v[176:179],v[240:243],v[168:171]
buffer_load_dwordx4 a[184:187],v11,s[60:63],s80 offen sc1
v_cvt_pk_bf16_f32 v211,v122,v123
M v[168:171],v[176:179],v[244:247],v[168:171]
s_waitcnt lgkmcnt(0)
s_add_u32 s44,s44,4096
M v[112:115],v[32:35],a[192:195],0
ds_read_b64_tr_b16 v[48:49],v9 offset:17152
ds_read_b64_tr_b16 v[50:51],v9 offset:21248
M v[112:115],v[36:39],a[196:199],v[112:115]
ds_read_b64_tr_b16 v[52:53],v9 offset:25344
ds_read_b64_tr_b16 v[54:55],v9 offset:29440
M v[112:115],v[40:43],a[200:203],v[112:115]
ds_read_b64_tr_b16 v[56:57],v10 offset:17152
s_add_u32 s45,s45,4096
M v[112:115],v[44:47],a[204:207],v[112:115]
ds_read_b64_tr_b16 v[58:59],v10 offset:21248
ds_read_b64_tr_b16 v[60:61],v10 offset:25344
s_xor_b32 s81,s72,0x2c00
M v[116:119],v[32:35],a[208:211],0
ds_read_b64_tr_b16 v[62:63],v10 offset:29440
buffer_load_dwordx4 a[172:175],v11,s[60:63],s81 offen sc1
M v[116:119],v[36:39],a[212:215],v[116:119]
v_exp_f32 v128,v128
M v[116:119],v[40:43],a[216:219],v[116:119]
v_exp_f32 v129,v129
M v[116:119],v[44:47],a[220:223],v[116:119]
v_exp_f32 v130,v130
M v[120:123],v[32:35],a[224:227],0
v_exp_f32 v131,v131
M v[120:123],v[36:39],a[228:231],v[120:123]
s_xor_b32 s80,s72,0x22c00
v_cvt_pk_bf16_f32 v196,v128,v129
M v[120:123],v[40:43],a[232:235],v[120:123]
buffer_load_dwordx4 a[188:191],v11,s[60:63],s80 offen sc1
v_cvt_pk_bf16_f32 v197,v130,v131
M v[120:123],v[44:47],a[236:239],v[120:123]
s_waitcnt vmcnt(40) lgkmcnt(0)
s_barrier
M a[24:27],v[48:51],v[224:227],a[24:27]
ds_read_b64_tr_b16 v[32:33],v9 offset:32768
ds_read_b64_tr_b16 v[34:35],v9 offset:36864
M a[24:27],v[52:55],v[228:231],a[24:27]
ds_read_b64_tr_b16 v[36:37],v9 offset:40960
ds_read_b64_tr_b16 v[38:39],v9 offset:45056
M a[56:59],v[48:51],v[232:235],a[56:59]
ds_read_b64_tr_b16 v[40:41],v10 offset:32768
s_add_u32 s46,s46,4096
M a[56:59],v[52:55],v[236:239],a[56:59]
ds_read_b64_tr_b16 v[42:43],v10 offset:36864
ds_read_b64_tr_b16 v[44:45],v10 offset:40960
M a[88:91],v[48:51],v[240:243],a[88:91]
ds_read_b64_tr_b16 v[46:47],v10 offset:45056
M a[88:91],v[52:55],v[244:247],a[88:91]
v_exp_f32 v132,v132
M a[28:31],v[56:59],v[224:227],a[28:31]
v_exp_f32 v133,v133
M a[28:31],v[60:63],v[228:231],a[28:31]
v_exp_f32 v134,v134
M a[60:63],v[56:59],v[232:235],a[60:63]
v_exp_f32 v135,v135
M a[60:63],v[60:63],v[236:239],a[60:63]
v_exp_f32 v136,v136
M a[92:95],v[56:59],v[240:243],a[92:95]
v_exp_f32 v137,v137
M a[92:95],v[60:63],v[244:247],a[92:95]
v_exp_f32 v138,v138
v_cvt_pk_bf16_f32 v204,v132,v133
v_cvt_pk_bf16_f32 v205,v134,v135
v_exp_f32 v139,v139
v_cvt_pk_bf16_f32 v212,v136,v137
v_cvt_pk_bf16_f32 v213,v138,v139
v_exp_f32 v144,v144
v_exp_f32 v145,v145
v_exp_f32 v146,v146
v_exp_f32 v147,v147
v_cvt_pk_bf16_f32 v198,v144,v145
v_cvt_pk_bf16_f32 v199,v146,v147
v_exp_f32 v148,v148
v_exp_f32 v149,v149
v_exp_f32 v150,v150
v_exp_f32 v151,v151
v_cvt_pk_bf16_f32 v206,v148,v149
v_cvt_pk_bf16_f32 v207,v150,v151
v_exp_f32 v152,v152
v_exp_f32 v153,v153
v_exp_f32 v154,v154
v_exp_f32 v155,v155
v_cvt_pk_bf16_f32 v214,v152,v153
v_cvt_pk_bf16_f32 v215,v154,v155
B_TAIL:
s_waitcnt lgkmcnt(0)
M a[0:3],v[32:35],v[192:195],a[0:3]
ds_read_b64_tr_b16 v[48:49],v9 offset:33024
M a[0:3],v[36:39],v[196:199],a[0:3]
ds_read_b64_tr_b16 v[50:51],v9 offset:37120
M a[32:35],v[32:35],v[200:203],a[32:35]
ds_read_b64_tr_b16 v[52:53],v9 offset:41216
M a[32:35],v[36:39],v[204:207],a[32:35]
ds_read_b64_tr_b16 v[54:55],v9 offset:45312
M a[64:67],v[32:35],v[208:211],a[64:67]
ds_read_b64_tr_b16 v[56:57],v10 offset:33024
M a[64:67],v[36:39],v[212:215],a[64:67]
ds_read_b64_tr_b16 v[58:59],v10 offset:37120
M a[4:7],v[40:43],v[192:195],a[4:7]
ds_read_b64_tr_b16 v[60:61],v10 offset:41216
M a[4:7],v[44:47],v[196:199],a[4:7]
ds_read_b64_tr_b16 v[62:63],v10 offset:45312
M a[36:39],v[40:43],v[200:203],a[36:39]
v_exp_f32 v64,v64
M a[36:39],v[44:47],v[204:207],a[36:39]
v_exp_f32 v65,v65
M a[68:71],v[40:43],v[208:211],a[68:71]
v_exp_f32 v66,v66
M a[68:71],v[44:47],v[212:215],a[68:71]
v_exp_f32 v67,v67
M v[160:163],v[176:179],v[192:195],v[160:163]
v_exp_f32 v80,v80
M v[160:163],v[176:179],v[196:199],v[160:163]
s_waitcnt vmcnt(24) lgkmcnt(0)
s_barrier
M a[8:11],v[48:51],v[192:195],a[8:11]
ds_read_b64_tr_b16 v[32:33],v9 offset:33280
v_cvt_pk_bf16_f32 v224,v64,v65
M a[8:11],v[52:55],v[196:199],a[8:11]
ds_read_b64_tr_b16 v[34:35],v9 offset:37376
v_cvt_pk_bf16_f32 v225,v66,v67
M a[40:43],v[48:51],v[200:203],a[40:43]
ds_read_b64_tr_b16 v[36:37],v9 offset:41472
M a[40:43],v[52:55],v[204:207],a[40:43]
ds_read_b64_tr_b16 v[38:39],v9 offset:45568
M a[72:75],v[48:51],v[208:211],a[72:75]
ds_read_b64_tr_b16 v[40:41],v10 offset:33280
M a[72:75],v[52:55],v[212:215],a[72:75]
ds_read_b64_tr_b16 v[42:43],v10 offset:37376
M a[12:15],v[56:59],v[192:195],a[12:15]
ds_read_b64_tr_b16 v[44:45],v10 offset:41472
M a[12:15],v[60:63],v[196:199],a[12:15]
ds_read_b64_tr_b16 v[46:47],v10 offset:45568
M a[44:47],v[56:59],v[200:203],a[44:47]
v_exp_f32 v81,v81
M a[44:47],v[60:63],v[204:207],a[44:47]
v_exp_f32 v82,v82
M a[76:79],v[56:59],v[208:211],a[76:79]
v_exp_f32 v83,v83
M a[76:79],v[60:63],v[212:215],a[76:79]
v_exp_f32 v96,v96
M v[164:167],v[176:179],v[200:203],v[164:167]
v_exp_f32 v97,v97
M v[164:167],v[176:179],v[204:207],v[164:167]
s_waitcnt lgkmcnt(0)
v_cvt_pk_bf16_f32 v226,v80,v81
M a[16:19],v[32:35],v[192:195],a[16:19]
ds_read_b64_tr_b16 v[48:49],v9 offset:33536
v_cvt_pk_bf16_f32 v227,v82,v83
M a[16:19],v[36:39],v[196:199],a[16:19]
ds_read_b64_tr_b16 v[50:51],v9 offset:37632
v_cvt_pk_bf16_f32 v228,v96,v97
M a[48:51],v[32:35],v[200:203],a[48:51]
ds_read_b64_tr_b16 v[52:53],v9 offset:41728
M a[48:51],v[36:39],v[204:207],a[48:51]
ds_read_b64_tr_b16 v[54:55],v9 offset:45824
M a[80:83],v[32:35],v[208:211],a[80:83]
ds_read_b64_tr_b16 v[56:57],v10 offset:33536
M a[80:83],v[36:39],v[212:215],a[80:83]
ds_read_b64_tr_b16 v[58:59],v10 offset:37632
M a[20:23],v[40:43],v[192:195],a[20:23]
ds_read_b64_tr_b16 v[60:61],v10 offset:41728
M a[20:23],v[44:47],v[196:199],a[20:23]
ds_read_b64_tr_b16 v[62:63],v10 offset:45824
M a[52:55],v[40:43],v[200:203],a[52:55]
v_exp_f32 v98,v98
M a[52:55],v[44:47],v[204:207],a[52:55]
v_exp_f32 v99,v99
M a[84:87],v[40:43],v[208:211],a[84:87]
v_exp_f32 v112,v112
M a[84:87],v[44:47],v[212:215],a[84:87]
v_exp_f32 v113,v113
M v[168:171],v[176:179],v[208:211],v[168:171]
v_exp_f32 v114,v114
M v[168:171],v[176:179],v[212:215],v[168:171]
s_waitcnt lgkmcnt(0)
v_cvt_pk_bf16_f32 v229,v98,v99
M a[24:27],v[48:51],v[192:195],a[24:27]
ds_read_b64_tr_b16 v[32:33],v9 offset:49152
s_xor_b32 s81,s73,0x40000
s_xor_b32 m0,s74,0x8000
M a[24:27],v[52:55],v[196:199],a[24:27]
ds_read_b64_tr_b16 v[34:35],v9 offset:53248
buffer_load_dwordx4 v12,s[56:59],s81 offen lds
M a[56:59],v[48:51],v[200:203],a[56:59]
ds_read_b64_tr_b16 v[36:37],v9 offset:57344
s_xor_b32 s80,s73,0x41000
s_xor_b32 m0,s74,0x8400
M a[56:59],v[52:55],v[204:207],a[56:59]
ds_read_b64_tr_b16 v[38:39],v9 offset:61440
buffer_load_dwordx4 v13,s[56:59],s80 offen lds
M a[88:91],v[48:51],v[208:211],a[88:91]
ds_read_b64_tr_b16 v[40:41],v10 offset:49152
s_xor_b32 s81,s73,0x42000
s_xor_b32 m0,s74,0x8800
M a[88:91],v[52:55],v[212:215],a[88:91]
ds_read_b64_tr_b16 v[42:43],v10 offset:53248
buffer_load_dwordx4 v12,s[56:59],s81 offen lds
M a[28:31],v[56:59],v[192:195],a[28:31]
ds_read_b64_tr_b16 v[44:45],v10 offset:57344
s_xor_b32 s80,s73,0x43000
s_xor_b32 m0,s74,0x8c00
M a[28:31],v[60:63],v[196:199],a[28:31]
ds_read_b64_tr_b16 v[46:47],v10 offset:61440
buffer_load_dwordx4 v13,s[56:59],s80 offen lds
M a[60:63],v[56:59],v[200:203],a[60:63]
s_xor_b32 s81,s73,0x44000
s_xor_b32 m0,s74,0x9000
M a[60:63],v[60:63],v[204:207],a[60:63]
buffer_load_dwordx4 v12,s[56:59],s81 offen lds
v_cvt_pk_bf16_f32 v230,v112,v113
M a[92:95],v[56:59],v[208:211],a[92:95]
v_exp_f32 v115,v115
M a[92:95],v[60:63],v[212:215],a[92:95]
s_xor_b32 s80,s73,0x45000
s_xor_b32 m0,s74,0x9400
s_waitcnt lgkmcnt(0)
M v[160:163],v[176:179],v[224:227],v[160:163]
ds_read_b64_tr_b16 v[48:49],v9 offset:49408
buffer_load_dwordx4 v13,s[56:59],s80 offen lds
v_cvt_pk_bf16_f32 v231,v114,v115
s_nop 1
M v[160:163],v[176:179],v[228:231],v[160:163]
ds_read_b64_tr_b16 v[50:51],v9 offset:53504
s_xor_b32 s81,s73,0x46000
s_xor_b32 m0,s74,0x9800
v_exp_f32 v68,v68
v_exp_f32 v69,v69
s_nop 0
v_cvt_pk_bf16_f32 v232,v68,v69
v_exp_f32 v70,v70
v_exp_f32 v71,v71
s_nop 0
v_cvt_pk_bf16_f32 v233,v70,v71
v_exp_f32 v84,v84
v_exp_f32 v85,v85
s_nop 0
v_cvt_pk_bf16_f32 v234,v84,v85
v_exp_f32 v86,v86
v_exp_f32 v87,v87
s_nop 0
v_cvt_pk_bf16_f32 v235,v86,v87
s_nop 1
M v[164:167],v[176:179],v[232:235],v[164:167]
ds_read_b64_tr_b16 v[52:53],v9 offset:57600
buffer_load_dwordx4 v12,s[56:59],s81 offen lds
v_exp_f32 v100,v100
v_exp_f32 v101,v101
s_nop 0
v_cvt_pk_bf16_f32 v236,v100,v101
v_exp_f32 v102,v102
v_exp_f32 v103,v103
s_nop 0
v_cvt_pk_bf16_f32 v237,v102,v103
v_exp_f32 v116,v116
v_exp_f32 v117,v117
s_nop 0
v_cvt_pk_bf16_f32 v238,v116,v117
v_exp_f32 v118,v118
v_exp_f32 v119,v119
s_nop 0
v_cvt_pk_bf16_f32 v239,v118,v119
s_nop 1
M v[164:167],v[176:179],v[236:239],v[164:167]
ds_read_b64_tr_b16 v[54:55],v9 offset:61696
s_xor_b32 s80,s73,0x47000
s_xor_b32 m0,s74,0x9c00
v_exp_f32 v72,v72
v_exp_f32 v73,v73
s_nop 0
v_cvt_pk_bf16_f32 v240,v72,v73
v_exp_f32 v74,v74
v_exp_f32 v75,v75
s_nop 0
v_cvt_pk_bf16_f32 v241,v74,v75
v_exp_f32 v88,v88
v_exp_f32 v89,v89
s_nop 0
v_cvt_pk_bf16_f32 v242,v88,v89
v_exp_f32 v90,v90
v_exp_f32 v91,v91
s_nop 0
v_cvt_pk_bf16_f32 v243,v90,v91
s_nop 1
M v[168:171],v[176:179],v[240:243],v[168:171]
ds_read_b64_tr_b16 v[56:57],v10 offset:49408
buffer_load_dwordx4 v13,s[56:59],s80 offen lds
v_exp_f32 v104,v104
v_exp_f32 v105,v105
s_nop 0
v_cvt_pk_bf16_f32 v244,v104,v105
v_exp_f32 v106,v106
v_exp_f32 v107,v107
s_nop 0
v_cvt_pk_bf16_f32 v245,v106,v107
v_exp_f32 v120,v120
v_exp_f32 v121,v121
s_nop 0
v_cvt_pk_bf16_f32 v246,v120,v121
v_exp_f32 v122,v122
v_exp_f32 v123,v123
s_nop 0
v_cvt_pk_bf16_f32 v247,v122,v123
s_nop 1
M v[168:171],v[176:179],v[244:247],v[168:171]
ds_read_b64_tr_b16 v[58:59],v10 offset:53504
s_xor_b32 s81,s72,0x4000
M a[0:3],v[32:35],v[224:227],a[0:3]
ds_read_b64_tr_b16 v[60:61],v10 offset:57600
buffer_load_dwordx4 a[192:195],v11,s[60:63],s81 offen sc1
M a[0:3],v[36:39],v[228:231],a[0:3]
ds_read_b64_tr_b16 v[62:63],v10 offset:61696
s_xor_b32 s80,s72,0x24000
M a[32:35],v[32:35],v[232:235],a[32:35]
buffer_load_dwordx4 a[208:211],v11,s[60:63],s80 offen sc1
M a[32:35],v[36:39],v[236:239],a[32:35]
v_rcp_f32 v4,v160
M a[64:67],v[32:35],v[240:243],a[64:67]
s_xor_b32 s81,s72,0x4400
v_add_f32 v130,v160,v4
M a[64:67],v[36:39],v[244:247],a[64:67]
buffer_load_dwordx4 a[196:199],v11,s[60:63],s81 offen sc1
v_add_f32 v130,v130,v164
M a[4:7],v[40:43],v[224:227],a[4:7]
s_xor_b32 s80,s72,0x24400
M a[4:7],v[44:47],v[228:231],a[4:7]
buffer_load_dwordx4 a[212:215],v11,s[60:63],s80 offen sc1
M a[36:39],v[40:43],v[232:235],a[36:39]
s_xor_b32 s81,s72,0x4800
M a[36:39],v[44:47],v[236:239],a[36:39]
buffer_load_dwordx4 a[200:203],v11,s[60:63],s81 offen sc1
M a[68:71],v[40:43],v[240:243],a[68:71]
s_xor_b32 s80,s72,0x24800
M a[68:71],v[44:47],v[244:247],a[68:71]
buffer_load_dwordx4 a[216:219],v11,s[60:63],s80 offen sc1
s_waitcnt lgkmcnt(0)
M a[8:11],v[48:51],v[224:227],a[8:11]
ds_read_b64_tr_b16 v[32:33],v9 offset:49664
s_xor_b32 s81,s72,0x4c00
M a[8:11],v[52:55],v[228:231],a[8:11]
ds_read_b64_tr_b16 v[34:35],v9 offset:53760
buffer_load_dwordx4 a[204:207],v11,s[60:63],s81 offen sc1
M a[40:43],v[48:51],v[232:235],a[40:43]
ds_read_b64_tr_b16 v[36:37],v9 offset:57856
M a[40:43],v[52:55],v[236:239],a[40:43]
ds_read_b64_tr_b16 v[38:39],v9 offset:61952
s_xor_b32 s80,s72,0x24c00
M a[72:75],v[48:51],v[240:243],a[72:75]
ds_read_b64_tr_b16 v[40:41],v10 offset:49664
buffer_load_dwordx4 a[220:223],v11,s[60:63],s80 offen sc1
M a[72:75],v[52:55],v[244:247],a[72:75]
ds_read_b64_tr_b16 v[42:43],v10 offset:53760
s_xor_b32 s81,s73,0x80000
s_xor_b32 m0,s74,0x10000
M a[12:15],v[56:59],v[224:227],a[12:15]
ds_read_b64_tr_b16 v[44:45],v10 offset:57856
buffer_load_dwordx4 v12,s[56:59],s81 offen lds
M a[12:15],v[60:63],v[228:231],a[12:15]
ds_read_b64_tr_b16 v[46:47],v10 offset:61952
s_xor_b32 s80,s73,0x81000
s_xor_b32 m0,s74,0x10400
M a[44:47],v[56:59],v[232:235],a[44:47]
buffer_load_dwordx4 v13,s[56:59],s80 offen lds
M a[44:47],v[60:63],v[236:239],a[44:47]
s_xor_b32 s81,s73,0x82000
s_xor_b32 m0,s74,0x10800
M a[76:79],v[56:59],v[240:243],a[76:79]
buffer_load_dwordx4 v12,s[56:59],s81 offen lds
M a[76:79],v[60:63],v[244:247],a[76:79]
s_xor_b32 s80,s73,0x83000
s_xor_b32 m0,s74,0x10c00
s_waitcnt lgkmcnt(0)
M a[16:19],v[32:35],v[224:227],a[16:19]
ds_read_b64_tr_b16 v[48:49],v9 offset:49920
buffer_load_dwordx4 v13,s[56:59],s80 offen lds
M a[16:19],v[36:39],v[228:231],a[16:19]
ds_read_b64_tr_b16 v[50:51],v9 offset:54016
M a[48:51],v[32:35],v[232:235],a[48:51]
ds_read_b64_tr_b16 v[52:53],v9 offset:58112
s_xor_b32 s81,s73,0x84000
s_xor_b32 m0,s74,0x11000
M a[48:51],v[36:39],v[236:239],a[48:51]
ds_read_b64_tr_b16 v[54:55],v9 offset:62208
buffer_load_dwordx4 v12,s[56:59],s81 offen lds
M a[80:83],v[32:35],v[240:243],a[80:83]
ds_read_b64_tr_b16 v[56:57],v10 offset:49920
s_xor_b32 s80,s73,0x85000
s_xor_b32 m0,s74,0x11400
M a[80:83],v[36:39],v[244:247],a[80:83]
ds_read_b64_tr_b16 v[58:59],v10 offset:54016
buffer_load_dwordx4 v13,s[56:59],s80 offen lds
M a[20:23],v[40:43],v[224:227],a[20:23]
ds_read_b64_tr_b16 v[60:61],v10 offset:58112
s_xor_b32 s81,s73,0x86000
s_xor_b32 m0,s74,0x11800
M a[20:23],v[44:47],v[228:231],a[20:23]
ds_read_b64_tr_b16 v[62:63],v10 offset:62208
buffer_load_dwordx4 v12,s[56:59],s81 offen lds
M a[52:55],v[40:43],v[232:235],a[52:55]
s_xor_b32 s80,s73,0x87000
s_xor_b32 m0,s74,0x11c00
M a[52:55],v[44:47],v[236:239],a[52:55]
buffer_load_dwordx4 v13,s[56:59],s80 offen lds
M a[84:87],v[40:43],v[240:243],a[84:87]
v_rcp_f32 v5,v164
M a[84:87],v[44:47],v[244:247],a[84:87]
s_waitcnt lgkmcnt(0)
v_add_f32 v130,v130,v5
M a[24:27],v[48:51],v[224:227],a[24:27]
v_rcp_f32 v6,v168
M a[24:27],v[52:55],v[228:231],a[24:27]
v_add_f32 v130,v130,v168
v_add_f32 v130,v130,v6
M a[56:59],v[48:51],v[232:235],a[56:59]
v_cmp_nge_f32 vcc,0x53800000,v130
M a[56:59],v[52:55],v[236:239],a[56:59]
M a[88:91],v[48:51],v[240:243],a[88:91]
M a[88:91],v[52:55],v[244:247],a[88:91]
M a[28:31],v[56:59],v[224:227],a[28:31]
M a[28:31],v[60:63],v[228:231],a[28:31]
M a[60:63],v[56:59],v[232:235],a[60:63]
M a[60:63],v[60:63],v[236:239],a[60:63]
M a[92:95],v[56:59],v[240:243],a[92:95]
M a[92:95],v[60:63],v[244:247],a[92:95]
s_cmp_lg_u64 vcc,0
s_cselect_b32 s55,1,0
s_or_b32 s43,s43,s55
s_lshl_b32 s54,s28,2
s_add_u32 s54,s54,161792
v_mov_b32 v128,s54
v_mov_b32 v129,s43
ds_write_b32 v128,v129
v_lshrrev_b32 v192,4,v11
v_lshrrev_b32 v193,4,v192
v_lshrrev_b32 v194,2,v192
v_and_b32 v194,3,v194
v_and_b32 v195,3,v192
v_and_b32 v196,1,v193
v_lshlrev_b32 v196,2,v196
v_add_u32 v196,v196,v194
v_lshlrev_b32 v196,1,v196
v_lshrrev_b32 v198,1,v195
v_xor_b32 v196,v196,v198
v_lshlrev_b32 v196,4,v196
v_and_b32 v197,1,v195
v_lshlrev_b32 v199,3,v197
v_add_u32 v196,v196,v199
v_lshlrev_b32 v197,10,v193
v_add_u32 v196,v196,v197
v_lshlrev_b32 v197,8,v194
v_add_u32 v160,v196,v197
v_xor_b32 v161,32,v160
v_xor_b32 v162,64,v160
v_xor_b32 v163,96,v160
v_xor_b32 v164,128,v160
v_xor_b32 v165,160,v160
v_xor_b32 v166,192,v160
v_xor_b32 v167,224,v160
v_add_u32 v168,65536,v160
v_add_u32 v169,65536,v161
v_add_u32 v170,65536,v162
v_add_u32 v171,65536,v163
v_add_u32 v172,65536,v164
v_add_u32 v173,65536,v165
v_add_u32 v174,65536,v166
v_add_u32 v175,65536,v167
s_waitcnt vmcnt(40) lgkmcnt(0)
s_barrier
K2F:
v_mov_b32 v128,161792
ds_read_b128 v[132:135],v128
ds_read_b64_tr_b16 v[32:33],v160
ds_read_b64_tr_b16 v[34:35],v160 offset:4096
ds_read_b64_tr_b16 v[36:37],v160 offset:8192
ds_read_b64_tr_b16 v[38:39],v160 offset:12288
ds_read_b64_tr_b16 v[40:41],v160 offset:16384
ds_read_b64_tr_b16 v[42:43],v160 offset:20480
ds_read_b64_tr_b16 v[44:45],v160 offset:24576
ds_read_b64_tr_b16 v[46:47],v160 offset:28672
v_mov_b32 v186,1
s_waitcnt lgkmcnt(8)
v_or_b32 v132,v132,v133
v_or_b32 v134,v134,v135
v_or_b32 v132,v132,v134
s_nop 0
v_readfirstlane_b32 s80,v132
s_nop 0
s_cmp_lg_u32 s80,0
s_cbranch_scc1 K1_SLOW
s_cmp_lt_u32 s2,240
s_cbranch_scc0 K2F_EXIT
K2F_GO:
s_waitcnt vmcnt(32) lgkmcnt(0)
M v[64:67],v[32:35],a[128:131],0
ds_read_b64_tr_b16 v[48:49],v161
ds_read_b64_tr_b16 v[50:51],v161 offset:4096
s_xor_b32 s81,s72,0x6000
M v[64:67],v[36:39],a[132:135],v[64:67]
ds_read_b64_tr_b16 v[52:53],v161 offset:8192
ds_read_b64_tr_b16 v[54:55],v161 offset:12288
buffer_load_dwordx4 a[224:227],v11,s[60:63],s81 offen sc1
M v[64:67],v[40:43],a[136:139],v[64:67]
ds_read_b64_tr_b16 v[56:57],v161 offset:16384
ds_read_b64_tr_b16 v[58:59],v161 offset:20480
M v[64:67],v[44:47],a[140:143],v[64:67]
ds_read_b64_tr_b16 v[60:61],v161 offset:24576
ds_read_b64_tr_b16 v[62:63],v161 offset:28672
M v[80:83],v[32:35],a[144:147],0
v_xor_b32 v26,32,v27
v_and_b32 v196,1,v193
M v[80:83],v[36:39],a[148:151],v[80:83]
v_lshlrev_b32 v196,1,v196
v_lshrrev_b32 v197,1,v194
M v[80:83],v[40:43],a[152:155],v[80:83]
v_add_u32 v196,v196,v197
v_lshlrev_b32 v196,1,v196
M v[80:83],v[44:47],a[156:159],v[80:83]
s_waitcnt lgkmcnt(0)
v_xor_b32 v196,v196,v198
M v[68:71],v[48:51],a[128:131],0
ds_read_b64_tr_b16 v[32:33],v162
ds_read_b64_tr_b16 v[34:35],v162 offset:4096
M v[68:71],v[52:55],a[132:135],v[68:71]
ds_read_b64_tr_b16 v[36:37],v162 offset:8192
ds_read_b64_tr_b16 v[38:39],v162 offset:12288
M v[68:71],v[56:59],a[136:139],v[68:71]
ds_read_b64_tr_b16 v[40:41],v162 offset:16384
ds_read_b64_tr_b16 v[42:43],v162 offset:20480
M v[68:71],v[60:63],a[140:143],v[68:71]
ds_read_b64_tr_b16 v[44:45],v162 offset:24576
ds_read_b64_tr_b16 v[46:47],v162 offset:28672
M v[84:87],v[48:51],a[144:147],0
v_lshlrev_b32 v196,4,v196
v_add_u32 v196,v196,v199
M v[84:87],v[52:55],a[148:151],v[84:87]
v_lshlrev_b32 v197,9,v193
v_add_u32 v196,v196,v197
M v[84:87],v[56:59],a[152:155],v[84:87]
v_lshlrev_b32 v197,7,v194
v_add_u32 v176,v196,v197
M v[84:87],v[60:63],a[156:159],v[84:87]
s_waitcnt lgkmcnt(0)
v_xor_b32 v177,32,v176
M v[72:75],v[32:35],a[128:131],0
ds_read_b64_tr_b16 v[48:49],v163
ds_read_b64_tr_b16 v[50:51],v163 offset:4096
M v[72:75],v[36:39],a[132:135],v[72:75]
ds_read_b64_tr_b16 v[52:53],v163 offset:8192
ds_read_b64_tr_b16 v[54:55],v163 offset:12288
M v[72:75],v[40:43],a[136:139],v[72:75]
ds_read_b64_tr_b16 v[56:57],v163 offset:16384
ds_read_b64_tr_b16 v[58:59],v163 offset:20480
M v[72:75],v[44:47],a[140:143],v[72:75]
ds_read_b64_tr_b16 v[60:61],v163 offset:24576
ds_read_b64_tr_b16 v[62:63],v163 offset:28672
M v[88:91],v[32:35],a[144:147],0
s_xor_b32 s80,s72,0x26000
v_xor_b32 v178,64,v176
M v[88:91],v[36:39],a[148:151],v[88:91]
buffer_load_dwordx4 a[240:243],v11,s[60:63],s80 offen sc1
v_xor_b32 v179,96,v176
M v[88:91],v[40:43],a[152:155],v[88:91]
v_add_u32 v180,65536,v176
v_add_u32 v181,65536,v177
M v[88:91],v[44:47],a[156:159],v[88:91]
s_waitcnt lgkmcnt(0)
v_add_u32 v182,65536,v178
M v[76:79],v[48:51],a[128:131],0
ds_read_b64_tr_b16 v[32:33],v164
ds_read_b64_tr_b16 v[34:35],v164 offset:4096
M v[76:79],v[52:55],a[132:135],v[76:79]
ds_read_b64_tr_b16 v[36:37],v164 offset:8192
ds_read_b64_tr_b16 v[38:39],v164 offset:12288
M v[76:79],v[56:59],a[136:139],v[76:79]
ds_read_b64_tr_b16 v[40:41],v164 offset:16384
ds_read_b64_tr_b16 v[42:43],v164 offset:20480
M v[76:79],v[60:63],a[140:143],v[76:79]
ds_read_b64_tr_b16 v[44:45],v164 offset:24576
ds_read_b64_tr_b16 v[46:47],v164 offset:28672
M v[92:95],v[48:51],a[144:147],0
v_add_u32 v183,65536,v179
v_lshrrev_b32 v200,3,v192
M v[92:95],v[52:55],a[148:151],v[92:95]
v_and_b32 v197,7,v192
v_and_b32 v196,6,v200
v_accvgpr_read_b32 v128,a0
v_accvgpr_read_b32 v129,a1
v_accvgpr_read_b32 v130,a2
v_accvgpr_read_b32 v131,a3
v_accvgpr_read_b32 v132,a4
v_accvgpr_read_b32 v133,a5
v_accvgpr_read_b32 v134,a6
v_accvgpr_read_b32 v135,a7
v_mul_f32 v128,v4,v128
v_mul_f32 v129,v4,v129
v_mul_f32 v130,v4,v130
v_mul_f32 v131,v4,v131
v_mul_f32 v132,v4,v132
v_mul_f32 v133,v4,v133
v_mul_f32 v134,v4,v134
v_mul_f32 v135,v4,v135
v_cvt_pk_bf16_f32 v144,v128,v129
v_cvt_pk_bf16_f32 v145,v130,v131
v_cvt_pk_bf16_f32 v146,v132,v133
v_cvt_pk_bf16_f32 v147,v134,v135
buffer_store_dwordx4 v[144:147],v20,s[20:23],s44 offen sc1
v_accvgpr_read_b32 v136,a8
v_accvgpr_read_b32 v137,a9
v_accvgpr_read_b32 v138,a10
v_accvgpr_read_b32 v139,a11
v_accvgpr_read_b32 v140,a12
v_accvgpr_read_b32 v141,a13
v_accvgpr_read_b32 v142,a14
v_accvgpr_read_b32 v143,a15
v_mul_f32 v136,v4,v136
v_mul_f32 v137,v4,v137
v_mul_f32 v138,v4,v138
v_mul_f32 v139,v4,v139
v_mul_f32 v140,v4,v140
v_mul_f32 v141,v4,v141
v_mul_f32 v142,v4,v142
v_mul_f32 v143,v4,v143
v_cvt_pk_bf16_f32 v148,v136,v137
v_cvt_pk_bf16_f32 v149,v138,v139
v_cvt_pk_bf16_f32 v150,v140,v141
v_cvt_pk_bf16_f32 v151,v142,v143
buffer_store_dwordx4 v[148:151],v20,s[20:23],s44 offen offset:1024 sc1
v_accvgpr_read_b32 v128,a16
v_accvgpr_read_b32 v129,a17
v_accvgpr_read_b32 v130,a18
v_accvgpr_read_b32 v131,a19
v_accvgpr_read_b32 v132,a20
v_accvgpr_read_b32 v133,a21
v_accvgpr_read_b32 v134,a22
v_accvgpr_read_b32 v135,a23
v_mul_f32 v128,v4,v128
v_mul_f32 v129,v4,v129
v_mul_f32 v130,v4,v130
v_mul_f32 v131,v4,v131
v_mul_f32 v132,v4,v132
v_mul_f32 v133,v4,v133
v_mul_f32 v134,v4,v134
v_mul_f32 v135,v4,v135
v_cvt_pk_bf16_f32 v152,v128,v129
v_cvt_pk_bf16_f32 v153,v130,v131
v_cvt_pk_bf16_f32 v154,v132,v133
v_cvt_pk_bf16_f32 v155,v134,v135
buffer_store_dwordx4 v[152:155],v20,s[20:23],s44 offen offset:2048 sc1
v_accvgpr_read_b32 v136,a24
v_accvgpr_read_b32 v137,a25
v_accvgpr_read_b32 v138,a26
v_accvgpr_read_b32 v139,a27
v_accvgpr_read_b32 v140,a28
v_accvgpr_read_b32 v141,a29
v_accvgpr_read_b32 v142,a30
v_accvgpr_read_b32 v143,a31
v_mul_f32 v136,v4,v136
v_mul_f32 v137,v4,v137
v_mul_f32 v138,v4,v138
v_mul_f32 v139,v4,v139
v_mul_f32 v140,v4,v140
v_mul_f32 v141,v4,v141
v_mul_f32 v142,v4,v142
v_mul_f32 v143,v4,v143
v_cvt_pk_bf16_f32 v144,v136,v137
v_cvt_pk_bf16_f32 v145,v138,v139
v_cvt_pk_bf16_f32 v146,v140,v141
v_cvt_pk_bf16_f32 v147,v142,v143
buffer_store_dwordx4 v[144:147],v20,s[20:23],s44 offen offset:3072 sc1
v_accvgpr_read_b32 v128,a32
v_accvgpr_read_b32 v129,a33
v_accvgpr_read_b32 v130,a34
v_accvgpr_read_b32 v131,a35
v_accvgpr_read_b32 v132,a36
v_accvgpr_read_b32 v133,a37
v_accvgpr_read_b32 v134,a38
v_accvgpr_read_b32 v135,a39
v_mul_f32 v128,v5,v128
v_mul_f32 v129,v5,v129
v_mul_f32 v130,v5,v130
v_mul_f32 v131,v5,v131
v_mul_f32 v132,v5,v132
v_mul_f32 v133,v5,v133
v_mul_f32 v134,v5,v134
v_mul_f32 v135,v5,v135
v_cvt_pk_bf16_f32 v148,v128,v129
v_cvt_pk_bf16_f32 v149,v130,v131
v_cvt_pk_bf16_f32 v150,v132,v133
v_cvt_pk_bf16_f32 v151,v134,v135
buffer_store_dwordx4 v[148:151],v20,s[20:23],s45 offen sc1
v_accvgpr_read_b32 v136,a40
v_accvgpr_read_b32 v137,a41
v_accvgpr_read_b32 v138,a42
v_accvgpr_read_b32 v139,a43
v_accvgpr_read_b32 v140,a44
v_accvgpr_read_b32 v141,a45
v_accvgpr_read_b32 v142,a46
v_accvgpr_read_b32 v143,a47
v_mul_f32 v136,v5,v136
v_mul_f32 v137,v5,v137
v_mul_f32 v138,v5,v138
v_mul_f32 v139,v5,v139
v_mul_f32 v140,v5,v140
v_mul_f32 v141,v5,v141
v_mul_f32 v142,v5,v142
v_mul_f32 v143,v5,v143
v_cvt_pk_bf16_f32 v152,v136,v137
v_cvt_pk_bf16_f32 v153,v138,v139
v_cvt_pk_bf16_f32 v154,v140,v141
v_cvt_pk_bf16_f32 v155,v142,v143
buffer_store_dwordx4 v[152:155],v20,s[20:23],s45 offen offset:1024 sc1
v_accvgpr_read_b32 v128,a48
v_accvgpr_read_b32 v129,a49
v_accvgpr_read_b32 v130,a50
v_accvgpr_read_b32 v131,a51
v_accvgpr_read_b32 v132,a52
v_accvgpr_read_b32 v133,a53
v_accvgpr_read_b32 v134,a54
v_accvgpr_read_b32 v135,a55
v_mul_f32 v128,v5,v128
v_mul_f32 v129,v5,v129
v_mul_f32 v130,v5,v130
v_mul_f32 v131,v5,v131
v_mul_f32 v132,v5,v132
v_mul_f32 v133,v5,v133
v_mul_f32 v134,v5,v134
v_mul_f32 v135,v5,v135
v_cvt_pk_bf16_f32 v144,v128,v129
v_cvt_pk_bf16_f32 v145,v130,v131
v_cvt_pk_bf16_f32 v146,v132,v133
v_cvt_pk_bf16_f32 v147,v134,v135
buffer_store_dwordx4 v[144:147],v20,s[20:23],s45 offen offset:2048 sc1
v_accvgpr_read_b32 v136,a56
v_accvgpr_read_b32 v137,a57
v_accvgpr_read_b32 v138,a58
v_accvgpr_read_b32 v139,a59
v_accvgpr_read_b32 v140,a60
v_accvgpr_read_b32 v141,a61
v_accvgpr_read_b32 v142,a62
v_accvgpr_read_b32 v143,a63
M v[92:95],v[56:59],a[152:155],v[92:95]
v_xor_b32 v196,v196,v197
v_lshlrev_b32 v196,4,v196
v_mul_f32 v136,v5,v136
v_mul_f32 v137,v5,v137
v_mul_f32 v138,v5,v138
v_mul_f32 v139,v5,v139
v_mul_f32 v140,v5,v140
M v[92:95],v[60:63],a[156:159],v[92:95]
s_waitcnt lgkmcnt(0)
v_lshlrev_b32 v197,10,v200
v_mul_f32 v141,v5,v141
v_mul_f32 v142,v5,v142
v_mul_f32 v143,v5,v143
v_cvt_pk_bf16_f32 v148,v136,v137
v_cvt_pk_bf16_f32 v149,v138,v139
M v[96:99],v[32:35],a[128:131],0
ds_read_b64_tr_b16 v[48:49],v165
ds_read_b64_tr_b16 v[50:51],v165 offset:4096
v_cvt_pk_bf16_f32 v150,v140,v141
v_cvt_pk_bf16_f32 v151,v142,v143
buffer_store_dwordx4 v[148:151],v20,s[20:23],s45 offen offset:3072 sc1
v_accvgpr_read_b32 v128,a64
v_accvgpr_read_b32 v129,a65
v_accvgpr_read_b32 v130,a66
M v[96:99],v[36:39],a[132:135],v[96:99]
ds_read_b64_tr_b16 v[52:53],v165 offset:8192
ds_read_b64_tr_b16 v[54:55],v165 offset:12288
v_accvgpr_read_b32 v131,a67
v_accvgpr_read_b32 v132,a68
v_accvgpr_read_b32 v133,a69
v_accvgpr_read_b32 v134,a70
v_accvgpr_read_b32 v135,a71
M v[96:99],v[40:43],a[136:139],v[96:99]
ds_read_b64_tr_b16 v[56:57],v165 offset:16384
ds_read_b64_tr_b16 v[58:59],v165 offset:20480
v_mul_f32 v128,v6,v128
v_mul_f32 v129,v6,v129
v_mul_f32 v130,v6,v130
v_mul_f32 v131,v6,v131
v_mul_f32 v132,v6,v132
M v[96:99],v[44:47],a[140:143],v[96:99]
ds_read_b64_tr_b16 v[60:61],v165 offset:24576
ds_read_b64_tr_b16 v[62:63],v165 offset:28672
v_mul_f32 v133,v6,v133
v_mul_f32 v134,v6,v134
v_mul_f32 v135,v6,v135
v_cvt_pk_bf16_f32 v152,v128,v129
v_cvt_pk_bf16_f32 v153,v130,v131
M v[112:115],v[32:35],a[144:147],0
v_add_u32 v196,v196,v197
s_lshr_b32 s54,s72,10
v_cvt_pk_bf16_f32 v154,v132,v133
v_cvt_pk_bf16_f32 v155,v134,v135
buffer_store_dwordx4 v[152:155],v20,s[20:23],s46 offen sc1
v_accvgpr_read_b32 v136,a72
v_accvgpr_read_b32 v137,a73
M v[112:115],v[36:39],a[148:151],v[112:115]
s_and_b32 s54,3,s54
s_xor_b32 s54,s54,s28
v_accvgpr_read_b32 v138,a74
v_accvgpr_read_b32 v139,a75
v_accvgpr_read_b32 v140,a76
v_accvgpr_read_b32 v141,a77
v_accvgpr_read_b32 v142,a78
M v[112:115],v[40:43],a[152:155],v[112:115]
s_lshl_b32 s54,s54,15
s_lshr_b32 s55,s72,9
v_accvgpr_read_b32 v143,a79
v_mul_f32 v136,v6,v136
v_mul_f32 v137,v6,v137
v_mul_f32 v138,v6,v138
v_mul_f32 v139,v6,v139
v_mul_f32 v140,v6,v140
M v[112:115],v[44:47],a[156:159],v[112:115]
s_waitcnt lgkmcnt(0)
s_and_b32 s55,128,s55
v_mul_f32 v141,v6,v141
v_mul_f32 v142,v6,v142
v_mul_f32 v143,v6,v143
v_cvt_pk_bf16_f32 v144,v136,v137
v_cvt_pk_bf16_f32 v145,v138,v139
M v[100:103],v[48:51],a[128:131],0
ds_read_b64_tr_b16 v[32:33],v166
ds_read_b64_tr_b16 v[34:35],v166 offset:4096
s_xor_b32 s81,s73,0xc0000
s_xor_b32 m0,s74,0x18000
v_cvt_pk_bf16_f32 v146,v140,v141
v_cvt_pk_bf16_f32 v147,v142,v143
buffer_store_dwordx4 v[144:147],v20,s[20:23],s46 offen offset:1024 sc1
v_accvgpr_read_b32 v128,a80
v_accvgpr_read_b32 v129,a81
M v[100:103],v[52:55],a[132:135],v[100:103]
ds_read_b64_tr_b16 v[36:37],v166 offset:8192
ds_read_b64_tr_b16 v[38:39],v166 offset:12288
buffer_load_dwordx4 v12,s[56:59],s81 offen lds
v_accvgpr_read_b32 v130,a82
v_accvgpr_read_b32 v131,a83
v_accvgpr_read_b32 v132,a84
v_accvgpr_read_b32 v133,a85
v_accvgpr_read_b32 v134,a86
M v[100:103],v[56:59],a[136:139],v[100:103]
ds_read_b64_tr_b16 v[40:41],v166 offset:16384
ds_read_b64_tr_b16 v[42:43],v166 offset:20480
v_accvgpr_read_b32 v135,a87
v_mul_f32 v128,v6,v128
v_mul_f32 v129,v6,v129
v_mul_f32 v130,v6,v130
v_mul_f32 v131,v6,v131
M v[100:103],v[60:63],a[140:143],v[100:103]
ds_read_b64_tr_b16 v[44:45],v166 offset:24576
ds_read_b64_tr_b16 v[46:47],v166 offset:28672
v_mul_f32 v132,v6,v132
v_mul_f32 v133,v6,v133
v_mul_f32 v134,v6,v134
v_mul_f32 v135,v6,v135
v_cvt_pk_bf16_f32 v148,v128,v129
M v[116:119],v[48:51],a[144:147],0
s_add_u32 s54,s54,s55
v_add_u32 v184,s54,v196
v_cvt_pk_bf16_f32 v149,v130,v131
v_cvt_pk_bf16_f32 v150,v132,v133
v_cvt_pk_bf16_f32 v151,v134,v135
buffer_store_dwordx4 v[148:151],v20,s[20:23],s46 offen offset:2048 sc1
v_accvgpr_read_b32 v136,a88
v_accvgpr_read_b32 v137,a89
M v[116:119],v[52:55],a[148:151],v[116:119]
s_and_b32 s54,0xc00,s72
s_and_b32 s55,0xc00,s75
v_accvgpr_read_b32 v138,a90
v_accvgpr_read_b32 v139,a91
v_accvgpr_read_b32 v140,a92
v_accvgpr_read_b32 v141,a93
v_accvgpr_read_b32 v142,a94
M v[116:119],v[56:59],a[152:155],v[116:119]
s_lshl_b32 s55,s55,3
v_and_b32 v196,15,v192
v_accvgpr_read_b32 v143,a95
v_mul_f32 v136,v6,v136
v_mul_f32 v137,v6,v137
v_mul_f32 v138,v6,v138
v_mul_f32 v139,v6,v139
M v[116:119],v[60:63],a[156:159],v[116:119]
s_waitcnt lgkmcnt(0)
v_lshlrev_b32 v196,11,v196
v_mul_f32 v140,v6,v140
v_mul_f32 v141,v6,v141
v_mul_f32 v142,v6,v142
v_mul_f32 v143,v6,v143
v_cvt_pk_bf16_f32 v152,v136,v137
M v[104:107],v[32:35],a[128:131],0
ds_read_b64_tr_b16 v[48:49],v167
ds_read_b64_tr_b16 v[50:51],v167 offset:4096
v_cvt_pk_bf16_f32 v153,v138,v139
v_cvt_pk_bf16_f32 v154,v140,v141
v_cvt_pk_bf16_f32 v155,v142,v143
buffer_store_dwordx4 v[152:155],v20,s[20:23],s46 offen offset:3072 sc1
v_accvgpr_read_b32 v128,a96
M v[104:107],v[36:39],a[132:135],v[104:107]
ds_read_b64_tr_b16 v[52:53],v167 offset:8192
ds_read_b64_tr_b16 v[54:55],v167 offset:12288
v_accvgpr_read_b32 v129,a97
v_accvgpr_read_b32 v130,a98
v_accvgpr_read_b32 v131,a99
v_accvgpr_read_b32 v132,a100
v_accvgpr_read_b32 v133,a101
M v[104:107],v[40:43],a[136:139],v[104:107]
ds_read_b64_tr_b16 v[56:57],v167 offset:16384
ds_read_b64_tr_b16 v[58:59],v167 offset:20480
v_accvgpr_read_b32 v134,a102
v_accvgpr_read_b32 v135,a103
v_mul_f32 v128,v7,v128
v_mul_f32 v129,v7,v129
v_mul_f32 v130,v7,v130
v_mul_f32 v131,v7,v131
M v[104:107],v[44:47],a[140:143],v[104:107]
ds_read_b64_tr_b16 v[60:61],v167 offset:24576
ds_read_b64_tr_b16 v[62:63],v167 offset:28672
v_mul_f32 v132,v7,v132
v_mul_f32 v133,v7,v133
v_mul_f32 v134,v7,v134
v_mul_f32 v135,v7,v135
v_cvt_pk_bf16_f32 v144,v128,v129
M v[120:123],v[32:35],a[144:147],0
v_lshlrev_b32 v197,4,v193
v_add_u32 v196,v196,v197
v_cvt_pk_bf16_f32 v145,v130,v131
v_cvt_pk_bf16_f32 v146,v132,v133
v_cvt_pk_bf16_f32 v147,v134,v135
buffer_store_dwordx4 v[144:147],v20,s[20:23],s47 offen sc1
v_accvgpr_read_b32 v136,a104
M v[120:123],v[36:39],a[148:151],v[120:123]
v_mov_b32 v197,s28
v_lshlrev_b32 v197,16,v197
v_accvgpr_read_b32 v137,a105
v_accvgpr_read_b32 v138,a106
v_accvgpr_read_b32 v139,a107
v_accvgpr_read_b32 v140,a108
v_accvgpr_read_b32 v141,a109
M v[120:123],v[40:43],a[152:155],v[120:123]
v_add_u32 v185,v196,v197
v_xor_b32 v202,v193,v194
v_accvgpr_read_b32 v142,a110
v_accvgpr_read_b32 v143,a111
v_mul_f32 v136,v7,v136
v_mul_f32 v137,v7,v137
v_mul_f32 v138,v7,v138
M v[120:123],v[44:47],a[156:159],v[120:123]
s_waitcnt vmcnt(32) lgkmcnt(0)
s_barrier
v_mul_f32 v139,v7,v139
v_mul_f32 v140,v7,v140
v_mul_f32 v141,v7,v141
v_mul_f32 v142,v7,v142
v_mul_f32 v143,v7,v143
M v[108:111],v[48:51],a[128:131],0
ds_read_b64_tr_b16 v[32:33],v160 offset:32768
ds_read_b64_tr_b16 v[34:35],v160 offset:36864
v_cvt_pk_bf16_f32 v148,v136,v137
v_cvt_pk_bf16_f32 v149,v138,v139
v_cvt_pk_bf16_f32 v150,v140,v141
v_cvt_pk_bf16_f32 v151,v142,v143
buffer_store_dwordx4 v[148:151],v20,s[20:23],s47 offen offset:1024 sc1
v_accvgpr_read_b32 v128,a112
M v[108:111],v[52:55],a[132:135],v[108:111]
ds_read_b64_tr_b16 v[36:37],v160 offset:40960
ds_read_b64_tr_b16 v[38:39],v160 offset:45056
v_accvgpr_read_b32 v129,a113
v_accvgpr_read_b32 v130,a114
v_accvgpr_read_b32 v131,a115
v_accvgpr_read_b32 v132,a116
v_accvgpr_read_b32 v133,a117
M v[108:111],v[56:59],a[136:139],v[108:111]
ds_read_b64_tr_b16 v[40:41],v160 offset:49152
ds_read_b64_tr_b16 v[42:43],v160 offset:53248
v_accvgpr_read_b32 v134,a118
v_accvgpr_read_b32 v135,a119
v_mul_f32 v128,v7,v128
v_mul_f32 v129,v7,v129
v_mul_f32 v130,v7,v130
M v[108:111],v[60:63],a[140:143],v[108:111]
ds_read_b64_tr_b16 v[44:45],v160 offset:57344
ds_read_b64_tr_b16 v[46:47],v160 offset:61440
v_mul_f32 v131,v7,v131
v_mul_f32 v132,v7,v132
v_mul_f32 v133,v7,v133
v_mul_f32 v134,v7,v134
v_mul_f32 v135,v7,v135
M v[124:127],v[48:51],a[144:147],0
v_lshlrev_b32 v202,2,v202
v_or_b32 v202,v202,v195
v_cvt_pk_bf16_f32 v152,v128,v129
v_cvt_pk_bf16_f32 v153,v130,v131
v_cvt_pk_bf16_f32 v154,v132,v133
v_cvt_pk_bf16_f32 v155,v134,v135
buffer_store_dwordx4 v[152:155],v20,s[20:23],s47 offen offset:2048 sc1
M v[124:127],v[52:55],a[148:151],v[124:127]
v_lshrrev_b32 v202,1,v202
v_and_b32 v214,1,v195
v_accvgpr_read_b32 v136,a120
v_accvgpr_read_b32 v137,a121
v_accvgpr_read_b32 v138,a122
v_accvgpr_read_b32 v139,a123
v_accvgpr_read_b32 v140,a124
M v[124:127],v[56:59],a[152:155],v[124:127]
v_lshlrev_b32 v214,4,v214
v_mov_b32 v203,0x3f80
v_accvgpr_read_b32 v141,a125
v_accvgpr_read_b32 v142,a126
v_accvgpr_read_b32 v143,a127
v_mul_f32 v136,v7,v136
v_mul_f32 v137,v7,v137
v_mul_f32 v138,v7,v138
M v[124:127],v[60:63],a[156:159],v[124:127]
s_waitcnt vmcnt(34) lgkmcnt(0)
v_mul_f32 v139,v7,v139
v_mul_f32 v140,v7,v140
v_mul_f32 v141,v7,v141
v_mul_f32 v142,v7,v142
v_mul_f32 v143,v7,v143
M v[64:67],v[32:35],a[160:163],v[64:67]
ds_read_b64_tr_b16 v[48:49],v161 offset:32768
ds_read_b64_tr_b16 v[50:51],v161 offset:36864
s_xor_b32 s80,s72,0x8000
v_cvt_pk_bf16_f32 v144,v136,v137
v_cvt_pk_bf16_f32 v145,v138,v139
v_cvt_pk_bf16_f32 v146,v140,v141
v_cvt_pk_bf16_f32 v147,v142,v143
buffer_store_dwordx4 v[144:147],v20,s[20:23],s47 offen offset:3072 sc1
M v[64:67],v[36:39],a[164:167],v[64:67]
ds_read_b64_tr_b16 v[52:53],v161 offset:40960
ds_read_b64_tr_b16 v[54:55],v161 offset:45056
buffer_load_dwordx4 a[128:131],v11,s[60:63],s80 offen sc1
M v[64:67],v[40:43],a[168:171],v[64:67]
ds_read_b64_tr_b16 v[56:57],v161 offset:49152
ds_read_b64_tr_b16 v[58:59],v161 offset:53248
M v[64:67],v[44:47],a[172:175],v[64:67]
ds_read_b64_tr_b16 v[60:61],v161 offset:57344
ds_read_b64_tr_b16 v[62:63],v161 offset:61440
s_xor_b32 s81,s72,0x28000
M v[80:83],v[32:35],a[176:179],v[80:83]
buffer_load_dwordx4 a[144:147],v11,s[60:63],s81 offen sc1
v_lshlrev_b32 v203,v214,v203
M v[80:83],v[36:39],a[180:183],v[80:83]
v_mov_b32 v208,0
v_mov_b32 v209,0
M v[80:83],v[40:43],a[184:187],v[80:83]
v_mov_b32 v212,0
v_mov_b32 v213,0
M v[80:83],v[44:47],a[188:191],v[80:83]
s_xor_b32 s80,s73,0x100000
s_xor_b32 m0,s74,0
s_waitcnt lgkmcnt(0)
M v[68:71],v[48:51],a[160:163],v[68:71]
ds_read_b64_tr_b16 v[32:33],v162 offset:32768
ds_read_b64_tr_b16 v[34:35],v162 offset:36864
buffer_load_dwordx4 v12,s[56:59],s80 offen lds
M v[68:71],v[52:55],a[164:167],v[68:71]
ds_read_b64_tr_b16 v[36:37],v162 offset:40960
ds_read_b64_tr_b16 v[38:39],v162 offset:45056
M v[68:71],v[56:59],a[168:171],v[68:71]
ds_read_b64_tr_b16 v[40:41],v162 offset:49152
ds_read_b64_tr_b16 v[42:43],v162 offset:53248
M v[68:71],v[60:63],a[172:175],v[68:71]
ds_read_b64_tr_b16 v[44:45],v162 offset:57344
ds_read_b64_tr_b16 v[46:47],v162 offset:61440
s_xor_b32 s81,s73,0xc1000
s_xor_b32 m0,s74,0x18400
M v[84:87],v[48:51],a[176:179],v[84:87]
buffer_load_dwordx4 v13,s[56:59],s81 offen lds
v_cmp_eq_u32 vcc,0,v202
M v[84:87],v[52:55],a[180:183],v[84:87]
M v[84:87],v[56:59],a[184:187],v[84:87]
v_cndmask_b32 v210,v208,v203
v_cmp_eq_u32 vcc,1,v202
M v[84:87],v[60:63],a[188:191],v[84:87]
s_xor_b32 s80,s73,0xc2000
s_xor_b32 m0,s74,0x18800
s_waitcnt lgkmcnt(0)
M v[72:75],v[32:35],a[160:163],v[72:75]
ds_read_b64_tr_b16 v[48:49],v163 offset:32768
ds_read_b64_tr_b16 v[50:51],v163 offset:36864
buffer_load_dwordx4 v12,s[56:59],s80 offen lds
M v[72:75],v[36:39],a[164:167],v[72:75]
ds_read_b64_tr_b16 v[52:53],v163 offset:40960
ds_read_b64_tr_b16 v[54:55],v163 offset:45056
M v[72:75],v[40:43],a[168:171],v[72:75]
ds_read_b64_tr_b16 v[56:57],v163 offset:49152
ds_read_b64_tr_b16 v[58:59],v163 offset:53248
s_xor_b32 s81,s73,0xc3000
s_xor_b32 m0,s74,0x18c00
M v[72:75],v[44:47],a[172:175],v[72:75]
ds_read_b64_tr_b16 v[60:61],v163 offset:57344
ds_read_b64_tr_b16 v[62:63],v163 offset:61440
buffer_load_dwordx4 v13,s[56:59],s81 offen lds
M v[88:91],v[32:35],a[176:179],v[88:91]
v_cndmask_b32 v211,v208,v203
M v[88:91],v[36:39],a[180:183],v[88:91]
M v[88:91],v[40:43],a[184:187],v[88:91]
s_xor_b32 s80,s73,0xc4000
s_xor_b32 m0,s74,0x19000
M v[88:91],v[44:47],a[188:191],v[88:91]
buffer_load_dwordx4 v12,s[56:59],s80 offen lds
s_waitcnt lgkmcnt(0)
M v[76:79],v[48:51],a[160:163],v[76:79]
ds_read_b64_tr_b16 v[32:33],v164 offset:32768
ds_read_b64_tr_b16 v[34:35],v164 offset:36864
M v[76:79],v[52:55],a[164:167],v[76:79]
ds_read_b64_tr_b16 v[36:37],v164 offset:40960
ds_read_b64_tr_b16 v[38:39],v164 offset:45056
M v[76:79],v[56:59],a[168:171],v[76:79]
ds_read_b64_tr_b16 v[40:41],v164 offset:49152
ds_read_b64_tr_b16 v[42:43],v164 offset:53248
s_xor_b32 s81,s73,0xc5000
s_xor_b32 m0,s74,0x19400
M v[76:79],v[60:63],a[172:175],v[76:79]
ds_read_b64_tr_b16 v[44:45],v164 offset:57344
ds_read_b64_tr_b16 v[46:47],v164 offset:61440
buffer_load_dwordx4 v13,s[56:59],s81 offen lds
M v[92:95],v[48:51],a[176:179],v[92:95]
M v[92:95],v[52:55],a[180:183],v[92:95]
M v[92:95],v[56:59],a[184:187],v[92:95]
s_xor_b32 s80,s73,0xc6000
s_xor_b32 m0,s74,0x19800
M v[92:95],v[60:63],a[188:191],v[92:95]
buffer_load_dwordx4 v12,s[56:59],s80 offen lds
s_waitcnt lgkmcnt(0)
M v[96:99],v[32:35],a[160:163],v[96:99]
ds_read_b64_tr_b16 v[48:49],v165 offset:32768
ds_read_b64_tr_b16 v[50:51],v165 offset:36864
M v[96:99],v[36:39],a[164:167],v[96:99]
ds_read_b64_tr_b16 v[52:53],v165 offset:40960
ds_read_b64_tr_b16 v[54:55],v165 offset:45056
s_xor_b32 s81,s73,0xc7000
s_xor_b32 m0,s74,0x19c00
M v[96:99],v[40:43],a[168:171],v[96:99]
ds_read_b64_tr_b16 v[56:57],v165 offset:49152
ds_read_b64_tr_b16 v[58:59],v165 offset:53248
buffer_load_dwordx4 v13,s[56:59],s81 offen lds
M v[96:99],v[44:47],a[172:175],v[96:99]
ds_read_b64_tr_b16 v[60:61],v165 offset:57344
ds_read_b64_tr_b16 v[62:63],v165 offset:61440
M v[112:115],v[32:35],a[176:179],v[112:115]
M v[112:115],v[36:39],a[180:183],v[112:115]
s_xor_b32 s80,s72,0x6400
M v[112:115],v[40:43],a[184:187],v[112:115]
buffer_load_dwordx4 a[228:231],v11,s[60:63],s80 offen sc1
M v[112:115],v[44:47],a[188:191],v[112:115]
s_waitcnt lgkmcnt(0)
M v[100:103],v[48:51],a[160:163],v[100:103]
ds_read_b64_tr_b16 v[32:33],v166 offset:32768
ds_read_b64_tr_b16 v[34:35],v166 offset:36864
M v[100:103],v[52:55],a[164:167],v[100:103]
ds_read_b64_tr_b16 v[36:37],v166 offset:40960
ds_read_b64_tr_b16 v[38:39],v166 offset:45056
s_xor_b32 s81,s72,0x26400
M v[100:103],v[56:59],a[168:171],v[100:103]
ds_read_b64_tr_b16 v[40:41],v166 offset:49152
ds_read_b64_tr_b16 v[42:43],v166 offset:53248
buffer_load_dwordx4 a[244:247],v11,s[60:63],s81 offen sc1
M v[100:103],v[60:63],a[172:175],v[100:103]
ds_read_b64_tr_b16 v[44:45],v166 offset:57344
ds_read_b64_tr_b16 v[46:47],v166 offset:61440
M v[116:119],v[48:51],a[176:179],v[116:119]
M v[116:119],v[52:55],a[180:183],v[116:119]
s_xor_b32 s80,s72,0x6800
M v[116:119],v[56:59],a[184:187],v[116:119]
buffer_load_dwordx4 a[232:235],v11,s[60:63],s80 offen sc1
M v[116:119],v[60:63],a[188:191],v[116:119]
s_waitcnt lgkmcnt(0)
M v[104:107],v[32:35],a[160:163],v[104:107]
ds_read_b64_tr_b16 v[48:49],v167 offset:32768
ds_read_b64_tr_b16 v[50:51],v167 offset:36864
s_xor_b32 s81,s72,0x26800
M v[104:107],v[36:39],a[164:167],v[104:107]
ds_read_b64_tr_b16 v[52:53],v167 offset:40960
ds_read_b64_tr_b16 v[54:55],v167 offset:45056
buffer_load_dwordx4 a[248:251],v11,s[60:63],s81 offen sc1
M v[104:107],v[40:43],a[168:171],v[104:107]
ds_read_b64_tr_b16 v[56:57],v167 offset:49152
ds_read_b64_tr_b16 v[58:59],v167 offset:53248
M v[104:107],v[44:47],a[172:175],v[104:107]
ds_read_b64_tr_b16 v[60:61],v167 offset:57344
ds_read_b64_tr_b16 v[62:63],v167 offset:61440
M v[120:123],v[32:35],a[176:179],v[120:123]
s_xor_b32 s80,s72,0x6c00
M v[120:123],v[36:39],a[180:183],v[120:123]
buffer_load_dwordx4 a[236:239],v11,s[60:63],s80 offen sc1
M v[120:123],v[40:43],a[184:187],v[120:123]
M v[120:123],v[44:47],a[188:191],v[120:123]
s_waitcnt vmcnt(15) lgkmcnt(0)
s_barrier
M v[108:111],v[48:51],a[160:163],v[108:111]
ds_read_b64_tr_b16 v[32:33],v168
ds_read_b64_tr_b16 v[34:35],v168 offset:4096
s_xor_b32 s81,s72,0x26c00
M v[108:111],v[52:55],a[164:167],v[108:111]
ds_read_b64_tr_b16 v[36:37],v168 offset:8192
ds_read_b64_tr_b16 v[38:39],v168 offset:12288
buffer_load_dwordx4 a[252:255],v11,s[60:63],s81 offen sc1
M v[108:111],v[56:59],a[168:171],v[108:111]
ds_read_b64_tr_b16 v[40:41],v168 offset:16384
ds_read_b64_tr_b16 v[42:43],v168 offset:20480
M v[108:111],v[60:63],a[172:175],v[108:111]
ds_read_b64_tr_b16 v[44:45],v168 offset:24576
ds_read_b64_tr_b16 v[46:47],v168 offset:28672
M v[124:127],v[48:51],a[176:179],v[124:127]
buffer_store_dword v186,v14,s[64:67],s82 offen offset:2048 sc1
M v[124:127],v[52:55],a[180:183],v[124:127]
M v[124:127],v[56:59],a[184:187],v[124:127]
M v[124:127],v[60:63],a[188:191],v[124:127]
s_waitcnt lgkmcnt(0)
M v[64:67],v[32:35],a[192:195],v[64:67]
ds_read_b64_tr_b16 v[48:49],v169
ds_read_b64_tr_b16 v[50:51],v169 offset:4096
s_xor_b32 s80,s72,0xa000
M v[64:67],v[36:39],a[196:199],v[64:67]
ds_read_b64_tr_b16 v[52:53],v169 offset:8192
ds_read_b64_tr_b16 v[54:55],v169 offset:12288
buffer_load_dwordx4 a[160:163],v11,s[60:63],s80 offen sc1
M v[64:67],v[40:43],a[200:203],v[64:67]
ds_read_b64_tr_b16 v[56:57],v169 offset:16384
ds_read_b64_tr_b16 v[58:59],v169 offset:20480
M v[64:67],v[44:47],a[204:207],v[64:67]
ds_read_b64_tr_b16 v[60:61],v169 offset:24576
ds_read_b64_tr_b16 v[62:63],v169 offset:28672
s_xor_b32 s81,s72,0x2a000
M v[80:83],v[32:35],a[208:211],v[80:83]
buffer_load_dwordx4 a[176:179],v11,s[60:63],s81 offen sc1
M v[80:83],v[36:39],a[212:215],v[80:83]
M v[80:83],v[40:43],a[216:219],v[80:83]
M v[80:83],v[44:47],a[220:223],v[80:83]
s_xor_b32 s80,s73,0x140000
s_xor_b32 m0,s74,0x8000
s_waitcnt lgkmcnt(0)
M v[68:71],v[48:51],a[192:195],v[68:71]
ds_read_b64_tr_b16 v[32:33],v170
ds_read_b64_tr_b16 v[34:35],v170 offset:4096
buffer_load_dwordx4 v12,s[56:59],s80 offen lds
M v[68:71],v[52:55],a[196:199],v[68:71]
ds_read_b64_tr_b16 v[36:37],v170 offset:8192
ds_read_b64_tr_b16 v[38:39],v170 offset:12288
M v[68:71],v[56:59],a[200:203],v[68:71]
ds_read_b64_tr_b16 v[40:41],v170 offset:16384
ds_read_b64_tr_b16 v[42:43],v170 offset:20480
M v[68:71],v[60:63],a[204:207],v[68:71]
ds_read_b64_tr_b16 v[44:45],v170 offset:24576
ds_read_b64_tr_b16 v[46:47],v170 offset:28672
s_xor_b32 s81,s73,0x101000
s_xor_b32 m0,s74,0x400
M v[84:87],v[48:51],a[208:211],v[84:87]
buffer_load_dwordx4 v13,s[56:59],s81 offen lds
M v[84:87],v[52:55],a[212:215],v[84:87]
M v[84:87],v[56:59],a[216:219],v[84:87]
M v[84:87],v[60:63],a[220:223],v[84:87]
s_xor_b32 s80,s73,0x102000
s_xor_b32 m0,s74,0x800
s_waitcnt lgkmcnt(0)
M v[72:75],v[32:35],a[192:195],v[72:75]
ds_read_b64_tr_b16 v[48:49],v171
ds_read_b64_tr_b16 v[50:51],v171 offset:4096
buffer_load_dwordx4 v12,s[56:59],s80 offen lds
M v[72:75],v[36:39],a[196:199],v[72:75]
ds_read_b64_tr_b16 v[52:53],v171 offset:8192
ds_read_b64_tr_b16 v[54:55],v171 offset:12288
M v[72:75],v[40:43],a[200:203],v[72:75]
ds_read_b64_tr_b16 v[56:57],v171 offset:16384
ds_read_b64_tr_b16 v[58:59],v171 offset:20480
s_xor_b32 s81,s73,0x103000
s_xor_b32 m0,s74,0xc00
M v[72:75],v[44:47],a[204:207],v[72:75]
ds_read_b64_tr_b16 v[60:61],v171 offset:24576
ds_read_b64_tr_b16 v[62:63],v171 offset:28672
buffer_load_dwordx4 v13,s[56:59],s81 offen lds
M v[88:91],v[32:35],a[208:211],v[88:91]
M v[88:91],v[36:39],a[212:215],v[88:91]
M v[88:91],v[40:43],a[216:219],v[88:91]
s_xor_b32 s80,s73,0x104000
s_xor_b32 m0,s74,0x1000
M v[88:91],v[44:47],a[220:223],v[88:91]
buffer_load_dwordx4 v12,s[56:59],s80 offen lds
s_waitcnt lgkmcnt(0)
M v[76:79],v[48:51],a[192:195],v[76:79]
ds_read_b64_tr_b16 v[32:33],v172
ds_read_b64_tr_b16 v[34:35],v172 offset:4096
M v[76:79],v[52:55],a[196:199],v[76:79]
ds_read_b64_tr_b16 v[36:37],v172 offset:8192
ds_read_b64_tr_b16 v[38:39],v172 offset:12288
M v[76:79],v[56:59],a[200:203],v[76:79]
ds_read_b64_tr_b16 v[40:41],v172 offset:16384
ds_read_b64_tr_b16 v[42:43],v172 offset:20480
s_xor_b32 s81,s73,0x105000
s_xor_b32 m0,s74,0x1400
M v[76:79],v[60:63],a[204:207],v[76:79]
ds_read_b64_tr_b16 v[44:45],v172 offset:24576
ds_read_b64_tr_b16 v[46:47],v172 offset:28672
buffer_load_dwordx4 v13,s[56:59],s81 offen lds
M v[92:95],v[48:51],a[208:211],v[92:95]
M v[92:95],v[52:55],a[212:215],v[92:95]
M v[92:95],v[56:59],a[216:219],v[92:95]
s_xor_b32 s80,s73,0x106000
s_xor_b32 m0,s74,0x1800
M v[92:95],v[60:63],a[220:223],v[92:95]
buffer_load_dwordx4 v12,s[56:59],s80 offen lds
s_waitcnt lgkmcnt(0)
M v[96:99],v[32:35],a[192:195],v[96:99]
ds_read_b64_tr_b16 v[48:49],v173
ds_read_b64_tr_b16 v[50:51],v173 offset:4096
M v[96:99],v[36:39],a[196:199],v[96:99]
ds_read_b64_tr_b16 v[52:53],v173 offset:8192
ds_read_b64_tr_b16 v[54:55],v173 offset:12288
s_xor_b32 s81,s73,0x107000
s_xor_b32 m0,s74,0x1c00
M v[96:99],v[40:43],a[200:203],v[96:99]
ds_read_b64_tr_b16 v[56:57],v173 offset:16384
ds_read_b64_tr_b16 v[58:59],v173 offset:20480
buffer_load_dwordx4 v13,s[56:59],s81 offen lds
M v[96:99],v[44:47],a[204:207],v[96:99]
ds_read_b64_tr_b16 v[60:61],v173 offset:24576
ds_read_b64_tr_b16 v[62:63],v173 offset:28672
M v[112:115],v[32:35],a[208:211],v[112:115]
M v[112:115],v[36:39],a[212:215],v[112:115]
s_xor_b32 s80,s72,0x8400
M v[112:115],v[40:43],a[216:219],v[112:115]
buffer_load_dwordx4 a[132:135],v11,s[60:63],s80 offen sc1
M v[112:115],v[44:47],a[220:223],v[112:115]
s_waitcnt lgkmcnt(0)
M v[100:103],v[48:51],a[192:195],v[100:103]
ds_read_b64_tr_b16 v[32:33],v174
ds_read_b64_tr_b16 v[34:35],v174 offset:4096
M v[100:103],v[52:55],a[196:199],v[100:103]
ds_read_b64_tr_b16 v[36:37],v174 offset:8192
ds_read_b64_tr_b16 v[38:39],v174 offset:12288
s_xor_b32 s81,s72,0x28400
M v[100:103],v[56:59],a[200:203],v[100:103]
ds_read_b64_tr_b16 v[40:41],v174 offset:16384
ds_read_b64_tr_b16 v[42:43],v174 offset:20480
buffer_load_dwordx4 a[148:151],v11,s[60:63],s81 offen sc1
M v[100:103],v[60:63],a[204:207],v[100:103]
ds_read_b64_tr_b16 v[44:45],v174 offset:24576
ds_read_b64_tr_b16 v[46:47],v174 offset:28672
M v[116:119],v[48:51],a[208:211],v[116:119]
M v[116:119],v[52:55],a[212:215],v[116:119]
s_xor_b32 s80,s72,0x8800
M v[116:119],v[56:59],a[216:219],v[116:119]
buffer_load_dwordx4 a[136:139],v11,s[60:63],s80 offen sc1
M v[116:119],v[60:63],a[220:223],v[116:119]
s_waitcnt lgkmcnt(0)
M v[104:107],v[32:35],a[192:195],v[104:107]
ds_read_b64_tr_b16 v[48:49],v175
ds_read_b64_tr_b16 v[50:51],v175 offset:4096
s_xor_b32 s81,s72,0x28800
M v[104:107],v[36:39],a[196:199],v[104:107]
ds_read_b64_tr_b16 v[52:53],v175 offset:8192
ds_read_b64_tr_b16 v[54:55],v175 offset:12288
buffer_load_dwordx4 a[152:155],v11,s[60:63],s81 offen sc1
M v[104:107],v[40:43],a[200:203],v[104:107]
ds_read_b64_tr_b16 v[56:57],v175 offset:16384
ds_read_b64_tr_b16 v[58:59],v175 offset:20480
M v[104:107],v[44:47],a[204:207],v[104:107]
ds_read_b64_tr_b16 v[60:61],v175 offset:24576
ds_read_b64_tr_b16 v[62:63],v175 offset:28672
M v[120:123],v[32:35],a[208:211],v[120:123]
s_xor_b32 s80,s72,0x8c00
M v[120:123],v[36:39],a[212:215],v[120:123]
buffer_load_dwordx4 a[140:143],v11,s[60:63],s80 offen sc1
M v[120:123],v[40:43],a[216:219],v[120:123]
M v[120:123],v[44:47],a[220:223],v[120:123]
s_waitcnt vmcnt(22) lgkmcnt(0)
s_barrier
M v[108:111],v[48:51],a[192:195],v[108:111]
ds_read_b64_tr_b16 v[32:33],v168 offset:32768
ds_read_b64_tr_b16 v[34:35],v168 offset:36864
s_xor_b32 s81,s72,0x28c00
M v[108:111],v[52:55],a[196:199],v[108:111]
ds_read_b64_tr_b16 v[36:37],v168 offset:40960
ds_read_b64_tr_b16 v[38:39],v168 offset:45056
buffer_load_dwordx4 a[156:159],v11,s[60:63],s81 offen sc1
M v[108:111],v[56:59],a[200:203],v[108:111]
ds_read_b64_tr_b16 v[40:41],v168 offset:49152
ds_read_b64_tr_b16 v[42:43],v168 offset:53248
M v[108:111],v[60:63],a[204:207],v[108:111]
ds_read_b64_tr_b16 v[44:45],v168 offset:57344
ds_read_b64_tr_b16 v[46:47],v168 offset:61440
M v[124:127],v[48:51],a[208:211],v[124:127]
M v[124:127],v[52:55],a[212:215],v[124:127]
M v[124:127],v[56:59],a[216:219],v[124:127]
M v[124:127],v[60:63],a[220:223],v[124:127]
s_waitcnt vmcnt(17) lgkmcnt(0)
M v[64:67],v[32:35],a[224:227],v[64:67]
ds_read_b64_tr_b16 v[48:49],v169 offset:32768
ds_read_b64_tr_b16 v[50:51],v169 offset:36864
s_xor_b32 s80,s72,0xc000
M v[64:67],v[36:39],a[228:231],v[64:67]
ds_read_b64_tr_b16 v[52:53],v169 offset:40960
ds_read_b64_tr_b16 v[54:55],v169 offset:45056
buffer_load_dwordx4 a[192:195],v11,s[60:63],s80 offen sc1
M v[64:67],v[40:43],a[232:235],v[64:67]
ds_read_b64_tr_b16 v[56:57],v169 offset:49152
ds_read_b64_tr_b16 v[58:59],v169 offset:53248
M v[64:67],v[44:47],a[236:239],v[64:67]
ds_read_b64_tr_b16 v[60:61],v169 offset:57344
ds_read_b64_tr_b16 v[62:63],v169 offset:61440
s_xor_b32 s81,s72,0x2c000
M v[80:83],v[32:35],a[240:243],v[80:83]
buffer_load_dwordx4 a[208:211],v11,s[60:63],s81 offen sc1
M v[80:83],v[36:39],a[244:247],v[80:83]
M v[80:83],v[40:43],a[248:251],v[80:83]
M v[80:83],v[44:47],a[252:255],v[80:83]
s_xor_b32 s80,s73,0x180000
s_xor_b32 m0,s74,0x10000
s_waitcnt lgkmcnt(0)
M v[68:71],v[48:51],a[224:227],v[68:71]
ds_read_b64_tr_b16 v[32:33],v170 offset:32768
ds_read_b64_tr_b16 v[34:35],v170 offset:36864
buffer_load_dwordx4 v12,s[56:59],s80 offen lds
M v[68:71],v[52:55],a[228:231],v[68:71]
ds_read_b64_tr_b16 v[36:37],v170 offset:40960
ds_read_b64_tr_b16 v[38:39],v170 offset:45056
M v[68:71],v[56:59],a[232:235],v[68:71]
ds_read_b64_tr_b16 v[40:41],v170 offset:49152
ds_read_b64_tr_b16 v[42:43],v170 offset:53248
M v[68:71],v[60:63],a[236:239],v[68:71]
ds_read_b64_tr_b16 v[44:45],v170 offset:57344
ds_read_b64_tr_b16 v[46:47],v170 offset:61440
s_xor_b32 s81,s73,0x141000
s_xor_b32 m0,s74,0x8400
M v[84:87],v[48:51],a[240:243],v[84:87]
buffer_load_dwordx4 v13,s[56:59],s81 offen lds
M v[84:87],v[52:55],a[244:247],v[84:87]
M v[84:87],v[56:59],a[248:251],v[84:87]
M v[84:87],v[60:63],a[252:255],v[84:87]
s_xor_b32 s80,s73,0x142000
s_xor_b32 m0,s74,0x8800
s_waitcnt lgkmcnt(0)
M v[72:75],v[32:35],a[224:227],v[72:75]
ds_read_b64_tr_b16 v[48:49],v171 offset:32768
ds_read_b64_tr_b16 v[50:51],v171 offset:36864
buffer_load_dwordx4 v12,s[56:59],s80 offen lds
M v[72:75],v[36:39],a[228:231],v[72:75]
ds_read_b64_tr_b16 v[52:53],v171 offset:40960
ds_read_b64_tr_b16 v[54:55],v171 offset:45056
M v[72:75],v[40:43],a[232:235],v[72:75]
ds_read_b64_tr_b16 v[56:57],v171 offset:49152
ds_read_b64_tr_b16 v[58:59],v171 offset:53248
s_xor_b32 s81,s73,0x143000
s_xor_b32 m0,s74,0x8c00
M v[72:75],v[44:47],a[236:239],v[72:75]
ds_read_b64_tr_b16 v[60:61],v171 offset:57344
ds_read_b64_tr_b16 v[62:63],v171 offset:61440
buffer_load_dwordx4 v13,s[56:59],s81 offen lds
M v[88:91],v[32:35],a[240:243],v[88:91]
M v[88:91],v[36:39],a[244:247],v[88:91]
M v[88:91],v[40:43],a[248:251],v[88:91]
s_xor_b32 s80,s73,0x144000
s_xor_b32 m0,s74,0x9000
M v[88:91],v[44:47],a[252:255],v[88:91]
buffer_load_dwordx4 v12,s[56:59],s80 offen lds
s_waitcnt lgkmcnt(0)
M v[76:79],v[48:51],a[224:227],v[76:79]
ds_read_b64_tr_b16 v[32:33],v172 offset:32768
ds_read_b64_tr_b16 v[34:35],v172 offset:36864
M v[76:79],v[52:55],a[228:231],v[76:79]
ds_read_b64_tr_b16 v[36:37],v172 offset:40960
ds_read_b64_tr_b16 v[38:39],v172 offset:45056
M v[76:79],v[56:59],a[232:235],v[76:79]
ds_read_b64_tr_b16 v[40:41],v172 offset:49152
ds_read_b64_tr_b16 v[42:43],v172 offset:53248
s_xor_b32 s81,s73,0x145000
s_xor_b32 m0,s74,0x9400
M v[76:79],v[60:63],a[236:239],v[76:79]
ds_read_b64_tr_b16 v[44:45],v172 offset:57344
ds_read_b64_tr_b16 v[46:47],v172 offset:61440
buffer_load_dwordx4 v13,s[56:59],s81 offen lds
M v[92:95],v[48:51],a[240:243],v[92:95]
M v[92:95],v[52:55],a[244:247],v[92:95]
M v[92:95],v[56:59],a[248:251],v[92:95]
s_xor_b32 s80,s73,0x146000
s_xor_b32 m0,s74,0x9800
M v[92:95],v[60:63],a[252:255],v[92:95]
buffer_load_dwordx4 v12,s[56:59],s80 offen lds
s_waitcnt lgkmcnt(0)
M v[96:99],v[32:35],a[224:227],v[96:99]
ds_read_b64_tr_b16 v[48:49],v173 offset:32768
ds_read_b64_tr_b16 v[50:51],v173 offset:36864
M v[96:99],v[36:39],a[228:231],v[96:99]
ds_read_b64_tr_b16 v[52:53],v173 offset:40960
ds_read_b64_tr_b16 v[54:55],v173 offset:45056
s_xor_b32 s81,s73,0x147000
s_xor_b32 m0,s74,0x9c00
M v[96:99],v[40:43],a[232:235],v[96:99]
ds_read_b64_tr_b16 v[56:57],v173 offset:49152
ds_read_b64_tr_b16 v[58:59],v173 offset:53248
buffer_load_dwordx4 v13,s[56:59],s81 offen lds
M v[96:99],v[44:47],a[236:239],v[96:99]
ds_read_b64_tr_b16 v[60:61],v173 offset:57344
ds_read_b64_tr_b16 v[62:63],v173 offset:61440
M v[112:115],v[32:35],a[240:243],v[112:115]
M v[112:115],v[36:39],a[244:247],v[112:115]
s_xor_b32 s80,s72,0xa400
M v[112:115],v[40:43],a[248:251],v[112:115]
buffer_load_dwordx4 a[164:167],v11,s[60:63],s80 offen sc1
M v[112:115],v[44:47],a[252:255],v[112:115]
s_waitcnt lgkmcnt(0)
M v[100:103],v[48:51],a[224:227],v[100:103]
ds_read_b64_tr_b16 v[32:33],v174 offset:32768
ds_read_b64_tr_b16 v[34:35],v174 offset:36864
M v[100:103],v[52:55],a[228:231],v[100:103]
ds_read_b64_tr_b16 v[36:37],v174 offset:40960
ds_read_b64_tr_b16 v[38:39],v174 offset:45056
s_xor_b32 s81,s72,0x2a400
M v[100:103],v[56:59],a[232:235],v[100:103]
ds_read_b64_tr_b16 v[40:41],v174 offset:49152
ds_read_b64_tr_b16 v[42:43],v174 offset:53248
buffer_load_dwordx4 a[180:183],v11,s[60:63],s81 offen sc1
M v[100:103],v[60:63],a[236:239],v[100:103]
ds_read_b64_tr_b16 v[44:45],v174 offset:57344
ds_read_b64_tr_b16 v[46:47],v174 offset:61440
M v[116:119],v[48:51],a[240:243],v[116:119]
M v[116:119],v[52:55],a[244:247],v[116:119]
s_xor_b32 s80,s72,0xa800
M v[116:119],v[56:59],a[248:251],v[116:119]
buffer_load_dwordx4 a[168:171],v11,s[60:63],s80 offen sc1
M v[116:119],v[60:63],a[252:255],v[116:119]
s_waitcnt lgkmcnt(0)
M v[104:107],v[32:35],a[224:227],v[104:107]
ds_read_b64_tr_b16 v[48:49],v175 offset:32768
ds_read_b64_tr_b16 v[50:51],v175 offset:36864
s_xor_b32 s81,s72,0x2a800
M v[104:107],v[36:39],a[228:231],v[104:107]
ds_read_b64_tr_b16 v[52:53],v175 offset:40960
ds_read_b64_tr_b16 v[54:55],v175 offset:45056
buffer_load_dwordx4 a[184:187],v11,s[60:63],s81 offen sc1
M v[104:107],v[40:43],a[232:235],v[104:107]
ds_read_b64_tr_b16 v[56:57],v175 offset:49152
ds_read_b64_tr_b16 v[58:59],v175 offset:53248
M v[104:107],v[44:47],a[236:239],v[104:107]
ds_read_b64_tr_b16 v[60:61],v175 offset:57344
ds_read_b64_tr_b16 v[62:63],v175 offset:61440
M v[120:123],v[32:35],a[240:243],v[120:123]
s_xor_b32 s80,s72,0xac00
M v[120:123],v[36:39],a[244:247],v[120:123]
buffer_load_dwordx4 a[172:175],v11,s[60:63],s80 offen sc1
M v[120:123],v[40:43],a[248:251],v[120:123]
M v[120:123],v[44:47],a[252:255],v[120:123]
s_waitcnt vmcnt(21) lgkmcnt(0)
s_barrier
M v[108:111],v[48:51],a[224:227],v[108:111]
ds_read_b64_tr_b16 v[32:33],v160
ds_read_b64_tr_b16 v[34:35],v160 offset:4096
s_xor_b32 s81,s72,0x2ac00
M v[108:111],v[52:55],a[228:231],v[108:111]
ds_read_b64_tr_b16 v[36:37],v160 offset:8192
ds_read_b64_tr_b16 v[38:39],v160 offset:12288
buffer_load_dwordx4 a[188:191],v11,s[60:63],s81 offen sc1
M v[108:111],v[56:59],a[232:235],v[108:111]
ds_read_b64_tr_b16 v[40:41],v160 offset:16384
ds_read_b64_tr_b16 v[42:43],v160 offset:20480
M v[108:111],v[60:63],a[236:239],v[108:111]
ds_read_b64_tr_b16 v[44:45],v160 offset:24576
ds_read_b64_tr_b16 v[46:47],v160 offset:28672
M v[124:127],v[48:51],a[240:243],v[124:127]
M v[124:127],v[52:55],a[244:247],v[124:127]
M v[124:127],v[56:59],a[248:251],v[124:127]
M v[124:127],v[60:63],a[252:255],v[124:127]
s_waitcnt vmcnt(16) lgkmcnt(0)
M v[64:67],v[32:35],a[128:131],v[64:67]
ds_read_b64_tr_b16 v[48:49],v161
ds_read_b64_tr_b16 v[50:51],v161 offset:4096
s_xor_b32 s80,s72,0xe000
M v[64:67],v[36:39],a[132:135],v[64:67]
ds_read_b64_tr_b16 v[52:53],v161 offset:8192
ds_read_b64_tr_b16 v[54:55],v161 offset:12288
buffer_load_dwordx4 a[224:227],v11,s[60:63],s80 offen sc1
M v[64:67],v[40:43],a[136:139],v[64:67]
ds_read_b64_tr_b16 v[56:57],v161 offset:16384
ds_read_b64_tr_b16 v[58:59],v161 offset:20480
M v[64:67],v[44:47],a[140:143],v[64:67]
ds_read_b64_tr_b16 v[60:61],v161 offset:24576
ds_read_b64_tr_b16 v[62:63],v161 offset:28672
s_xor_b32 s81,s72,0x2e000
M v[80:83],v[32:35],a[144:147],v[80:83]
buffer_load_dwordx4 a[240:243],v11,s[60:63],s81 offen sc1
M v[80:83],v[36:39],a[148:151],v[80:83]
M v[80:83],v[40:43],a[152:155],v[80:83]
M v[80:83],v[44:47],a[156:159],v[80:83]
s_xor_b32 s80,s73,0x1c0000
s_xor_b32 m0,s74,0x18000
s_waitcnt lgkmcnt(0)
M v[68:71],v[48:51],a[128:131],v[68:71]
ds_read_b64_tr_b16 v[32:33],v162
ds_read_b64_tr_b16 v[34:35],v162 offset:4096
buffer_load_dwordx4 v12,s[56:59],s80 offen lds
M v[68:71],v[52:55],a[132:135],v[68:71]
ds_read_b64_tr_b16 v[36:37],v162 offset:8192
ds_read_b64_tr_b16 v[38:39],v162 offset:12288
M v[68:71],v[56:59],a[136:139],v[68:71]
ds_read_b64_tr_b16 v[40:41],v162 offset:16384
ds_read_b64_tr_b16 v[42:43],v162 offset:20480
M v[68:71],v[60:63],a[140:143],v[68:71]
ds_read_b64_tr_b16 v[44:45],v162 offset:24576
ds_read_b64_tr_b16 v[46:47],v162 offset:28672
s_xor_b32 s81,s73,0x181000
s_xor_b32 m0,s74,0x10400
M v[84:87],v[48:51],a[144:147],v[84:87]
buffer_load_dwordx4 v13,s[56:59],s81 offen lds
M v[84:87],v[52:55],a[148:151],v[84:87]
M v[84:87],v[56:59],a[152:155],v[84:87]
M v[84:87],v[60:63],a[156:159],v[84:87]
s_xor_b32 s80,s73,0x182000
s_xor_b32 m0,s74,0x10800
s_waitcnt lgkmcnt(0)
M v[72:75],v[32:35],a[128:131],v[72:75]
ds_read_b64_tr_b16 v[48:49],v163
ds_read_b64_tr_b16 v[50:51],v163 offset:4096
buffer_load_dwordx4 v12,s[56:59],s80 offen lds
M v[72:75],v[36:39],a[132:135],v[72:75]
ds_read_b64_tr_b16 v[52:53],v163 offset:8192
ds_read_b64_tr_b16 v[54:55],v163 offset:12288
M v[72:75],v[40:43],a[136:139],v[72:75]
ds_read_b64_tr_b16 v[56:57],v163 offset:16384
ds_read_b64_tr_b16 v[58:59],v163 offset:20480
s_xor_b32 s81,s73,0x183000
s_xor_b32 m0,s74,0x10c00
M v[72:75],v[44:47],a[140:143],v[72:75]
ds_read_b64_tr_b16 v[60:61],v163 offset:24576
ds_read_b64_tr_b16 v[62:63],v163 offset:28672
buffer_load_dwordx4 v13,s[56:59],s81 offen lds
M v[88:91],v[32:35],a[144:147],v[88:91]
M v[88:91],v[36:39],a[148:151],v[88:91]
M v[88:91],v[40:43],a[152:155],v[88:91]
s_xor_b32 s80,s73,0x184000
s_xor_b32 m0,s74,0x11000
M v[88:91],v[44:47],a[156:159],v[88:91]
buffer_load_dwordx4 v12,s[56:59],s80 offen lds
s_waitcnt lgkmcnt(0)
M v[76:79],v[48:51],a[128:131],v[76:79]
ds_read_b64_tr_b16 v[32:33],v164
ds_read_b64_tr_b16 v[34:35],v164 offset:4096
M v[76:79],v[52:55],a[132:135],v[76:79]
ds_read_b64_tr_b16 v[36:37],v164 offset:8192
ds_read_b64_tr_b16 v[38:39],v164 offset:12288
M v[76:79],v[56:59],a[136:139],v[76:79]
ds_read_b64_tr_b16 v[40:41],v164 offset:16384
ds_read_b64_tr_b16 v[42:43],v164 offset:20480
s_xor_b32 s81,s73,0x185000
s_xor_b32 m0,s74,0x11400
M v[76:79],v[60:63],a[140:143],v[76:79]
ds_read_b64_tr_b16 v[44:45],v164 offset:24576
ds_read_b64_tr_b16 v[46:47],v164 offset:28672
buffer_load_dwordx4 v13,s[56:59],s81 offen lds
M v[92:95],v[48:51],a[144:147],v[92:95]
M v[92:95],v[52:55],a[148:151],v[92:95]
M v[92:95],v[56:59],a[152:155],v[92:95]
s_xor_b32 s80,s73,0x186000
s_xor_b32 m0,s74,0x11800
M v[92:95],v[60:63],a[156:159],v[92:95]
buffer_load_dwordx4 v12,s[56:59],s80 offen lds
s_waitcnt lgkmcnt(0)
M v[96:99],v[32:35],a[128:131],v[96:99]
ds_read_b64_tr_b16 v[48:49],v165
ds_read_b64_tr_b16 v[50:51],v165 offset:4096
M v[96:99],v[36:39],a[132:135],v[96:99]
ds_read_b64_tr_b16 v[52:53],v165 offset:8192
ds_read_b64_tr_b16 v[54:55],v165 offset:12288
s_xor_b32 s81,s73,0x187000
s_xor_b32 m0,s74,0x11c00
M v[96:99],v[40:43],a[136:139],v[96:99]
ds_read_b64_tr_b16 v[56:57],v165 offset:16384
ds_read_b64_tr_b16 v[58:59],v165 offset:20480
buffer_load_dwordx4 v13,s[56:59],s81 offen lds
M v[96:99],v[44:47],a[140:143],v[96:99]
ds_read_b64_tr_b16 v[60:61],v165 offset:24576
ds_read_b64_tr_b16 v[62:63],v165 offset:28672
M v[112:115],v[32:35],a[144:147],v[112:115]
M v[112:115],v[36:39],a[148:151],v[112:115]
s_xor_b32 s80,s72,0xc400
M v[112:115],v[40:43],a[152:155],v[112:115]
buffer_load_dwordx4 a[196:199],v11,s[60:63],s80 offen sc1
M v[112:115],v[44:47],a[156:159],v[112:115]
s_waitcnt lgkmcnt(0)
M v[100:103],v[48:51],a[128:131],v[100:103]
ds_read_b64_tr_b16 v[32:33],v166
ds_read_b64_tr_b16 v[34:35],v166 offset:4096
M v[100:103],v[52:55],a[132:135],v[100:103]
ds_read_b64_tr_b16 v[36:37],v166 offset:8192
ds_read_b64_tr_b16 v[38:39],v166 offset:12288
s_xor_b32 s81,s72,0x2c400
M v[100:103],v[56:59],a[136:139],v[100:103]
ds_read_b64_tr_b16 v[40:41],v166 offset:16384
ds_read_b64_tr_b16 v[42:43],v166 offset:20480
buffer_load_dwordx4 a[212:215],v11,s[60:63],s81 offen sc1
M v[100:103],v[60:63],a[140:143],v[100:103]
ds_read_b64_tr_b16 v[44:45],v166 offset:24576
ds_read_b64_tr_b16 v[46:47],v166 offset:28672
M v[116:119],v[48:51],a[144:147],v[116:119]
M v[116:119],v[52:55],a[148:151],v[116:119]
s_xor_b32 s80,s72,0xc800
M v[116:119],v[56:59],a[152:155],v[116:119]
buffer_load_dwordx4 a[200:203],v11,s[60:63],s80 offen sc1
M v[116:119],v[60:63],a[156:159],v[116:119]
s_waitcnt lgkmcnt(0)
M v[104:107],v[32:35],a[128:131],v[104:107]
ds_read_b64_tr_b16 v[48:49],v167
ds_read_b64_tr_b16 v[50:51],v167 offset:4096
s_xor_b32 s81,s72,0x2c800
M v[104:107],v[36:39],a[132:135],v[104:107]
ds_read_b64_tr_b16 v[52:53],v167 offset:8192
ds_read_b64_tr_b16 v[54:55],v167 offset:12288
buffer_load_dwordx4 a[216:219],v11,s[60:63],s81 offen sc1
M v[104:107],v[40:43],a[136:139],v[104:107]
ds_read_b64_tr_b16 v[56:57],v167 offset:16384
ds_read_b64_tr_b16 v[58:59],v167 offset:20480
M v[104:107],v[44:47],a[140:143],v[104:107]
ds_read_b64_tr_b16 v[60:61],v167 offset:24576
ds_read_b64_tr_b16 v[62:63],v167 offset:28672
M v[120:123],v[32:35],a[144:147],v[120:123]
s_xor_b32 s80,s72,0xcc00
M v[120:123],v[36:39],a[148:151],v[120:123]
buffer_load_dwordx4 a[204:207],v11,s[60:63],s80 offen sc1
M v[120:123],v[40:43],a[152:155],v[120:123]
M v[120:123],v[44:47],a[156:159],v[120:123]
s_waitcnt vmcnt(21) lgkmcnt(0)
s_barrier
M v[108:111],v[48:51],a[128:131],v[108:111]
ds_read_b64_tr_b16 v[32:33],v160 offset:32768
ds_read_b64_tr_b16 v[34:35],v160 offset:36864
s_xor_b32 s81,s72,0x2cc00
M v[108:111],v[52:55],a[132:135],v[108:111]
ds_read_b64_tr_b16 v[36:37],v160 offset:40960
ds_read_b64_tr_b16 v[38:39],v160 offset:45056
buffer_load_dwordx4 a[220:223],v11,s[60:63],s81 offen sc1
M v[108:111],v[56:59],a[136:139],v[108:111]
ds_read_b64_tr_b16 v[40:41],v160 offset:49152
ds_read_b64_tr_b16 v[42:43],v160 offset:53248
M v[108:111],v[60:63],a[140:143],v[108:111]
ds_read_b64_tr_b16 v[44:45],v160 offset:57344
ds_read_b64_tr_b16 v[46:47],v160 offset:61440
M v[124:127],v[48:51],a[144:147],v[124:127]
M v[124:127],v[52:55],a[148:151],v[124:127]
M v[124:127],v[56:59],a[152:155],v[124:127]
M v[124:127],v[60:63],a[156:159],v[124:127]
s_waitcnt vmcnt(16) lgkmcnt(0)
M v[64:67],v[32:35],a[160:163],v[64:67]
ds_read_b64_tr_b16 v[48:49],v161 offset:32768
ds_read_b64_tr_b16 v[50:51],v161 offset:36864
s_xor_b32 s80,s73,0x20000
s_xor_b32 m0,s74,0
M v[64:67],v[36:39],a[164:167],v[64:67]
ds_read_b64_tr_b16 v[52:53],v161 offset:40960
ds_read_b64_tr_b16 v[54:55],v161 offset:45056
buffer_load_dwordx4 v12,s[56:59],s80 offen lds
M v[64:67],v[40:43],a[168:171],v[64:67]
ds_read_b64_tr_b16 v[56:57],v161 offset:49152
ds_read_b64_tr_b16 v[58:59],v161 offset:53248
M v[64:67],v[44:47],a[172:175],v[64:67]
ds_read_b64_tr_b16 v[60:61],v161 offset:57344
ds_read_b64_tr_b16 v[62:63],v161 offset:61440
M v[80:83],v[32:35],a[176:179],v[80:83]
s_xor_b32 s81,s73,0x1c1000
s_xor_b32 m0,s74,0x18400
M v[80:83],v[36:39],a[180:183],v[80:83]
buffer_load_dwordx4 v13,s[56:59],s81 offen lds
M v[80:83],v[40:43],a[184:187],v[80:83]
M v[80:83],v[44:47],a[188:191],v[80:83]
s_waitcnt lgkmcnt(0)
M v[68:71],v[48:51],a[160:163],v[68:71]
ds_read_b64_tr_b16 v[32:33],v162 offset:32768
ds_read_b64_tr_b16 v[34:35],v162 offset:36864
s_xor_b32 s80,s73,0x1c2000
s_xor_b32 m0,s74,0x18800
buffer_load_dword v15,v27,s[64:67],0 offen offset:2048 sc1
M v[68:71],v[52:55],a[164:167],v[68:71]
ds_read_b64_tr_b16 v[36:37],v162 offset:40960
ds_read_b64_tr_b16 v[38:39],v162 offset:45056
buffer_load_dwordx4 v12,s[56:59],s80 offen lds
M v[68:71],v[56:59],a[168:171],v[68:71]
ds_read_b64_tr_b16 v[40:41],v162 offset:49152
ds_read_b64_tr_b16 v[42:43],v162 offset:53248
M v[68:71],v[60:63],a[172:175],v[68:71]
ds_read_b64_tr_b16 v[44:45],v162 offset:57344
ds_read_b64_tr_b16 v[46:47],v162 offset:61440
M v[84:87],v[48:51],a[176:179],v[84:87]
s_xor_b32 s81,s73,0x1c3000
s_xor_b32 m0,s74,0x18c00
M v[84:87],v[52:55],a[180:183],v[84:87]
buffer_load_dwordx4 v13,s[56:59],s81 offen lds
M v[84:87],v[56:59],a[184:187],v[84:87]
M v[84:87],v[60:63],a[188:191],v[84:87]
s_waitcnt lgkmcnt(0)
M v[72:75],v[32:35],a[160:163],v[72:75]
ds_read_b64_tr_b16 v[48:49],v163 offset:32768
ds_read_b64_tr_b16 v[50:51],v163 offset:36864
M v[72:75],v[36:39],a[164:167],v[72:75]
ds_read_b64_tr_b16 v[52:53],v163 offset:40960
ds_read_b64_tr_b16 v[54:55],v163 offset:45056
s_xor_b32 s80,s73,0x1c4000
s_xor_b32 m0,s74,0x19000
M v[72:75],v[40:43],a[168:171],v[72:75]
ds_read_b64_tr_b16 v[56:57],v163 offset:49152
ds_read_b64_tr_b16 v[58:59],v163 offset:53248
buffer_load_dwordx4 v12,s[56:59],s80 offen lds
M v[72:75],v[44:47],a[172:175],v[72:75]
ds_read_b64_tr_b16 v[60:61],v163 offset:57344
ds_read_b64_tr_b16 v[62:63],v163 offset:61440
M v[88:91],v[32:35],a[176:179],v[88:91]
M v[88:91],v[36:39],a[180:183],v[88:91]
s_xor_b32 s81,s73,0x1c5000
s_xor_b32 m0,s74,0x19400
M v[88:91],v[40:43],a[184:187],v[88:91]
buffer_load_dwordx4 v13,s[56:59],s81 offen lds
M v[88:91],v[44:47],a[188:191],v[88:91]
s_waitcnt lgkmcnt(0)
M v[76:79],v[48:51],a[160:163],v[76:79]
ds_read_b64_tr_b16 v[32:33],v164 offset:32768
ds_read_b64_tr_b16 v[34:35],v164 offset:36864
M v[76:79],v[52:55],a[164:167],v[76:79]
ds_read_b64_tr_b16 v[36:37],v164 offset:40960
ds_read_b64_tr_b16 v[38:39],v164 offset:45056
s_xor_b32 s80,s73,0x1c6000
s_xor_b32 m0,s74,0x19800
M v[76:79],v[56:59],a[168:171],v[76:79]
ds_read_b64_tr_b16 v[40:41],v164 offset:49152
ds_read_b64_tr_b16 v[42:43],v164 offset:53248
buffer_load_dwordx4 v12,s[56:59],s80 offen lds
M v[76:79],v[60:63],a[172:175],v[76:79]
ds_read_b64_tr_b16 v[44:45],v164 offset:57344
ds_read_b64_tr_b16 v[46:47],v164 offset:61440
M v[92:95],v[48:51],a[176:179],v[92:95]
M v[92:95],v[52:55],a[180:183],v[92:95]
M v[92:95],v[56:59],a[184:187],v[92:95]
s_xor_b32 s81,s73,0x1c7000
s_xor_b32 m0,s74,0x19c00
M v[92:95],v[60:63],a[188:191],v[92:95]
buffer_load_dwordx4 v13,s[56:59],s81 offen lds
s_waitcnt lgkmcnt(0)
M v[96:99],v[32:35],a[160:163],v[96:99]
ds_read_b64_tr_b16 v[48:49],v165 offset:32768
ds_read_b64_tr_b16 v[50:51],v165 offset:36864
M v[96:99],v[36:39],a[164:167],v[96:99]
ds_read_b64_tr_b16 v[52:53],v165 offset:40960
ds_read_b64_tr_b16 v[54:55],v165 offset:45056
M v[96:99],v[40:43],a[168:171],v[96:99]
ds_read_b64_tr_b16 v[56:57],v165 offset:49152
ds_read_b64_tr_b16 v[58:59],v165 offset:53248
s_xor_b32 s80,s72,0xe400
M v[96:99],v[44:47],a[172:175],v[96:99]
ds_read_b64_tr_b16 v[60:61],v165 offset:57344
ds_read_b64_tr_b16 v[62:63],v165 offset:61440
buffer_load_dwordx4 a[228:231],v11,s[60:63],s80 offen sc1
M v[112:115],v[32:35],a[176:179],v[112:115]
M v[112:115],v[36:39],a[180:183],v[112:115]
M v[112:115],v[40:43],a[184:187],v[112:115]
s_xor_b32 s81,s72,0x2e400
M v[112:115],v[44:47],a[188:191],v[112:115]
buffer_load_dwordx4 a[244:247],v11,s[60:63],s81 offen sc1
s_waitcnt lgkmcnt(0)
M v[100:103],v[48:51],a[160:163],v[100:103]
ds_read_b64_tr_b16 v[32:33],v166 offset:32768
ds_read_b64_tr_b16 v[34:35],v166 offset:36864
M v[100:103],v[52:55],a[164:167],v[100:103]
ds_read_b64_tr_b16 v[36:37],v166 offset:40960
ds_read_b64_tr_b16 v[38:39],v166 offset:45056
M v[100:103],v[56:59],a[168:171],v[100:103]
ds_read_b64_tr_b16 v[40:41],v166 offset:49152
ds_read_b64_tr_b16 v[42:43],v166 offset:53248
s_xor_b32 s80,s72,0xe800
M v[100:103],v[60:63],a[172:175],v[100:103]
ds_read_b64_tr_b16 v[44:45],v166 offset:57344
ds_read_b64_tr_b16 v[46:47],v166 offset:61440
buffer_load_dwordx4 a[232:235],v11,s[60:63],s80 offen sc1
M v[116:119],v[48:51],a[176:179],v[116:119]
M v[116:119],v[52:55],a[180:183],v[116:119]
M v[116:119],v[56:59],a[184:187],v[116:119]
M v[116:119],v[60:63],a[188:191],v[116:119]
s_xor_b32 s81,s72,0x2e800
s_waitcnt lgkmcnt(0)
M v[104:107],v[32:35],a[160:163],v[104:107]
ds_read_b64_tr_b16 v[48:49],v167 offset:32768
ds_read_b64_tr_b16 v[50:51],v167 offset:36864
buffer_load_dwordx4 a[248:251],v11,s[60:63],s81 offen sc1
M v[104:107],v[36:39],a[164:167],v[104:107]
ds_read_b64_tr_b16 v[52:53],v167 offset:40960
ds_read_b64_tr_b16 v[54:55],v167 offset:45056
M v[104:107],v[40:43],a[168:171],v[104:107]
ds_read_b64_tr_b16 v[56:57],v167 offset:49152
ds_read_b64_tr_b16 v[58:59],v167 offset:53248
M v[104:107],v[44:47],a[172:175],v[104:107]
ds_read_b64_tr_b16 v[60:61],v167 offset:57344
ds_read_b64_tr_b16 v[62:63],v167 offset:61440
s_xor_b32 s80,s72,0xec00
M v[120:123],v[32:35],a[176:179],v[120:123]
buffer_load_dwordx4 a[236:239],v11,s[60:63],s80 offen sc1
M v[120:123],v[36:39],a[180:183],v[120:123]
M v[120:123],v[40:43],a[184:187],v[120:123]
M v[120:123],v[44:47],a[188:191],v[120:123]
s_xor_b32 s81,s72,0x2ec00
s_waitcnt vmcnt(20) lgkmcnt(0)
s_barrier
M v[108:111],v[48:51],a[160:163],v[108:111]
ds_read_b64_tr_b16 v[32:33],v168
ds_read_b64_tr_b16 v[34:35],v168 offset:4096
buffer_load_dwordx4 a[252:255],v11,s[60:63],s81 offen sc1
M v[108:111],v[52:55],a[164:167],v[108:111]
ds_read_b64_tr_b16 v[36:37],v168 offset:8192
ds_read_b64_tr_b16 v[38:39],v168 offset:12288
M v[108:111],v[56:59],a[168:171],v[108:111]
ds_read_b64_tr_b16 v[40:41],v168 offset:16384
ds_read_b64_tr_b16 v[42:43],v168 offset:20480
M v[108:111],v[60:63],a[172:175],v[108:111]
ds_read_b64_tr_b16 v[44:45],v168 offset:24576
ds_read_b64_tr_b16 v[46:47],v168 offset:28672
M v[124:127],v[48:51],a[176:179],v[124:127]
M v[124:127],v[52:55],a[180:183],v[124:127]
M v[124:127],v[56:59],a[184:187],v[124:127]
M v[124:127],v[60:63],a[188:191],v[124:127]
s_waitcnt vmcnt(12)
v_cmp_eq_u32 s[80:81],1,v15
s_nop 0
s_cmp_eq_u64 s[80:81],-1
s_cbranch_scc0 K2F_H1_SPIN
K2F_H1_BACK:
s_waitcnt lgkmcnt(0)
M v[64:67],v[32:35],a[192:195],v[64:67]
ds_read_b64_tr_b16 v[48:49],v169
ds_read_b64_tr_b16 v[50:51],v169 offset:4096
s_xor_b32 s80,s72,0x1000
M v[64:67],v[36:39],a[196:199],v[64:67]
ds_read_b64_tr_b16 v[52:53],v169 offset:8192
ds_read_b64_tr_b16 v[54:55],v169 offset:12288
buffer_load_dwordx4 a[128:131],v11,s[60:63],s80 offen sc1
M v[64:67],v[40:43],a[200:203],v[64:67]
ds_read_b64_tr_b16 v[56:57],v169 offset:16384
ds_read_b64_tr_b16 v[58:59],v169 offset:20480
M v[64:67],v[44:47],a[204:207],v[64:67]
ds_read_b64_tr_b16 v[60:61],v169 offset:24576
ds_read_b64_tr_b16 v[62:63],v169 offset:28672
s_xor_b32 s81,s72,0x21000
M v[80:83],v[32:35],a[208:211],v[80:83]
buffer_load_dwordx4 a[144:147],v11,s[60:63],s81 offen sc1
M v[80:83],v[36:39],a[212:215],v[80:83]
M v[80:83],v[40:43],a[216:219],v[80:83]
s_xor_b32 s80,s72,0x3000
M v[80:83],v[44:47],a[220:223],v[80:83]
buffer_load_dwordx4 a[160:163],v11,s[60:63],s80 offen sc1
s_waitcnt lgkmcnt(0)
M v[68:71],v[48:51],a[192:195],v[68:71]
ds_read_b64_tr_b16 v[32:33],v170
ds_read_b64_tr_b16 v[34:35],v170 offset:4096
M v[68:71],v[52:55],a[196:199],v[68:71]
ds_read_b64_tr_b16 v[36:37],v170 offset:8192
ds_read_b64_tr_b16 v[38:39],v170 offset:12288
M v[68:71],v[56:59],a[200:203],v[68:71]
ds_read_b64_tr_b16 v[40:41],v170 offset:16384
ds_read_b64_tr_b16 v[42:43],v170 offset:20480
s_xor_b32 s81,s72,0x23000
M v[68:71],v[60:63],a[204:207],v[68:71]
ds_read_b64_tr_b16 v[44:45],v170 offset:24576
ds_read_b64_tr_b16 v[46:47],v170 offset:28672
buffer_load_dwordx4 a[176:179],v11,s[60:63],s81 offen sc1
M v[84:87],v[48:51],a[208:211],v[84:87]
M v[84:87],v[52:55],a[212:215],v[84:87]
s_xor_b32 s80,s73,0x60000
s_xor_b32 m0,s74,0x8000
M v[84:87],v[56:59],a[216:219],v[84:87]
buffer_load_dwordx4 v12,s[56:59],s80 offen lds
M v[84:87],v[60:63],a[220:223],v[84:87]
s_waitcnt lgkmcnt(0)
M v[72:75],v[32:35],a[192:195],v[72:75]
ds_read_b64_tr_b16 v[48:49],v171
ds_read_b64_tr_b16 v[50:51],v171 offset:4096
s_xor_b32 s81,s73,0x21000
s_xor_b32 m0,s74,0x400
M v[72:75],v[36:39],a[196:199],v[72:75]
ds_read_b64_tr_b16 v[52:53],v171 offset:8192
ds_read_b64_tr_b16 v[54:55],v171 offset:12288
buffer_load_dwordx4 v13,s[56:59],s81 offen lds
M v[72:75],v[40:43],a[200:203],v[72:75]
ds_read_b64_tr_b16 v[56:57],v171 offset:16384
ds_read_b64_tr_b16 v[58:59],v171 offset:20480
M v[72:75],v[44:47],a[204:207],v[72:75]
ds_read_b64_tr_b16 v[60:61],v171 offset:24576
ds_read_b64_tr_b16 v[62:63],v171 offset:28672
M v[88:91],v[32:35],a[208:211],v[88:91]
s_xor_b32 s80,s73,0x22000
s_xor_b32 m0,s74,0x800
M v[88:91],v[36:39],a[212:215],v[88:91]
buffer_load_dwordx4 v12,s[56:59],s80 offen lds
M v[88:91],v[40:43],a[216:219],v[88:91]
M v[88:91],v[44:47],a[220:223],v[88:91]
s_xor_b32 s81,s73,0x23000
s_xor_b32 m0,s74,0xc00
s_waitcnt lgkmcnt(0)
M v[76:79],v[48:51],a[192:195],v[76:79]
ds_read_b64_tr_b16 v[32:33],v172
ds_read_b64_tr_b16 v[34:35],v172 offset:4096
buffer_load_dwordx4 v13,s[56:59],s81 offen lds
M v[76:79],v[52:55],a[196:199],v[76:79]
ds_read_b64_tr_b16 v[36:37],v172 offset:8192
ds_read_b64_tr_b16 v[38:39],v172 offset:12288
M v[76:79],v[56:59],a[200:203],v[76:79]
ds_read_b64_tr_b16 v[40:41],v172 offset:16384
ds_read_b64_tr_b16 v[42:43],v172 offset:20480
s_xor_b32 s80,s73,0x24000
s_xor_b32 m0,s74,0x1000
M v[76:79],v[60:63],a[204:207],v[76:79]
ds_read_b64_tr_b16 v[44:45],v172 offset:24576
ds_read_b64_tr_b16 v[46:47],v172 offset:28672
buffer_load_dwordx4 v12,s[56:59],s80 offen lds
M v[92:95],v[48:51],a[208:211],v[92:95]
M v[92:95],v[52:55],a[212:215],v[92:95]
M v[92:95],v[56:59],a[216:219],v[92:95]
s_xor_b32 s81,s73,0x25000
s_xor_b32 m0,s74,0x1400
M v[92:95],v[60:63],a[220:223],v[92:95]
buffer_load_dwordx4 v13,s[56:59],s81 offen lds
s_waitcnt lgkmcnt(0)
M v[96:99],v[32:35],a[192:195],v[96:99]
ds_read_b64_tr_b16 v[48:49],v173
ds_read_b64_tr_b16 v[50:51],v173 offset:4096
M v[96:99],v[36:39],a[196:199],v[96:99]
ds_read_b64_tr_b16 v[52:53],v173 offset:8192
ds_read_b64_tr_b16 v[54:55],v173 offset:12288
s_xor_b32 s80,s73,0x26000
s_xor_b32 m0,s74,0x1800
M v[96:99],v[40:43],a[200:203],v[96:99]
ds_read_b64_tr_b16 v[56:57],v173 offset:16384
ds_read_b64_tr_b16 v[58:59],v173 offset:20480
buffer_load_dwordx4 v12,s[56:59],s80 offen lds
M v[96:99],v[44:47],a[204:207],v[96:99]
ds_read_b64_tr_b16 v[60:61],v173 offset:24576
ds_read_b64_tr_b16 v[62:63],v173 offset:28672
M v[112:115],v[32:35],a[208:211],v[112:115]
s_xor_b32 s81,s73,0x27000
s_xor_b32 m0,s74,0x1c00
M v[112:115],v[36:39],a[212:215],v[112:115]
buffer_load_dwordx4 v13,s[56:59],s81 offen lds
M v[112:115],v[40:43],a[216:219],v[112:115]
M v[112:115],v[44:47],a[220:223],v[112:115]
s_waitcnt lgkmcnt(0)
M v[100:103],v[48:51],a[192:195],v[100:103]
ds_read_b64_tr_b16 v[32:33],v174
ds_read_b64_tr_b16 v[34:35],v174 offset:4096
s_xor_b32 s80,s72,0x1400
M v[100:103],v[52:55],a[196:199],v[100:103]
ds_read_b64_tr_b16 v[36:37],v174 offset:8192
ds_read_b64_tr_b16 v[38:39],v174 offset:12288
buffer_load_dwordx4 a[132:135],v11,s[60:63],s80 offen sc1
M v[100:103],v[56:59],a[200:203],v[100:103]
ds_read_b64_tr_b16 v[40:41],v174 offset:16384
ds_read_b64_tr_b16 v[42:43],v174 offset:20480
M v[100:103],v[60:63],a[204:207],v[100:103]
ds_read_b64_tr_b16 v[44:45],v174 offset:24576
ds_read_b64_tr_b16 v[46:47],v174 offset:28672
s_xor_b32 s81,s72,0x21400
M v[116:119],v[48:51],a[208:211],v[116:119]
buffer_load_dwordx4 a[148:151],v11,s[60:63],s81 offen sc1
M v[116:119],v[52:55],a[212:215],v[116:119]
M v[116:119],v[56:59],a[216:219],v[116:119]
s_xor_b32 s80,s72,0x1800
M v[116:119],v[60:63],a[220:223],v[116:119]
buffer_load_dwordx4 a[136:139],v11,s[60:63],s80 offen sc1
s_waitcnt lgkmcnt(0)
M v[104:107],v[32:35],a[192:195],v[104:107]
ds_read_b64_tr_b16 v[48:49],v175
ds_read_b64_tr_b16 v[50:51],v175 offset:4096
M v[104:107],v[36:39],a[196:199],v[104:107]
ds_read_b64_tr_b16 v[52:53],v175 offset:8192
ds_read_b64_tr_b16 v[54:55],v175 offset:12288
M v[104:107],v[40:43],a[200:203],v[104:107]
ds_read_b64_tr_b16 v[56:57],v175 offset:16384
ds_read_b64_tr_b16 v[58:59],v175 offset:20480
s_xor_b32 s81,s72,0x21800
M v[104:107],v[44:47],a[204:207],v[104:107]
ds_read_b64_tr_b16 v[60:61],v175 offset:24576
ds_read_b64_tr_b16 v[62:63],v175 offset:28672
buffer_load_dwordx4 a[152:155],v11,s[60:63],s81 offen sc1
M v[120:123],v[32:35],a[208:211],v[120:123]
M v[120:123],v[36:39],a[212:215],v[120:123]
s_xor_b32 s80,s72,0x1c00
M v[120:123],v[40:43],a[216:219],v[120:123]
buffer_load_dwordx4 a[140:143],v11,s[60:63],s80 offen sc1
M v[120:123],v[44:47],a[220:223],v[120:123]
s_waitcnt vmcnt(23) lgkmcnt(0)
s_barrier
M v[108:111],v[48:51],a[192:195],v[108:111]
ds_read_b64_tr_b16 v[32:33],v168 offset:32768
ds_read_b64_tr_b16 v[34:35],v168 offset:36864
s_xor_b32 s81,s72,0x21c00
M v[108:111],v[52:55],a[196:199],v[108:111]
ds_read_b64_tr_b16 v[36:37],v168 offset:40960
ds_read_b64_tr_b16 v[38:39],v168 offset:45056
buffer_load_dwordx4 a[156:159],v11,s[60:63],s81 offen sc1
M v[108:111],v[56:59],a[200:203],v[108:111]
ds_read_b64_tr_b16 v[40:41],v168 offset:49152
ds_read_b64_tr_b16 v[42:43],v168 offset:53248
M v[108:111],v[60:63],a[204:207],v[108:111]
ds_read_b64_tr_b16 v[44:45],v168 offset:57344
ds_read_b64_tr_b16 v[46:47],v168 offset:61440
M v[124:127],v[48:51],a[208:211],v[124:127]
M v[124:127],v[52:55],a[212:215],v[124:127]
M v[124:127],v[56:59],a[216:219],v[124:127]
M v[124:127],v[60:63],a[220:223],v[124:127]
s_waitcnt vmcnt(18) lgkmcnt(0)
M v[64:67],v[32:35],a[224:227],v[64:67]
ds_read_b64_tr_b16 v[48:49],v169 offset:32768
ds_read_b64_tr_b16 v[50:51],v169 offset:36864
s_xor_b32 s80,s72,0x5000
M v[64:67],v[36:39],a[228:231],v[64:67]
ds_read_b64_tr_b16 v[52:53],v169 offset:40960
ds_read_b64_tr_b16 v[54:55],v169 offset:45056
buffer_load_dwordx4 a[192:195],v11,s[60:63],s80 offen sc1
M v[64:67],v[40:43],a[232:235],v[64:67]
ds_read_b64_tr_b16 v[56:57],v169 offset:49152
ds_read_b64_tr_b16 v[58:59],v169 offset:53248
M v[64:67],v[44:47],a[236:239],v[64:67]
ds_read_b64_tr_b16 v[60:61],v169 offset:57344
ds_read_b64_tr_b16 v[62:63],v169 offset:61440
s_xor_b32 s81,s72,0x25000
M v[80:83],v[32:35],a[240:243],v[80:83]
buffer_load_dwordx4 a[208:211],v11,s[60:63],s81 offen sc1
M v[80:83],v[36:39],a[244:247],v[80:83]
M v[80:83],v[40:43],a[248:251],v[80:83]
M v[80:83],v[44:47],a[252:255],v[80:83]
s_xor_b32 s80,s73,0xa0000
s_xor_b32 m0,s74,0x10000
s_waitcnt lgkmcnt(0)
M v[68:71],v[48:51],a[224:227],v[68:71]
ds_read_b64_tr_b16 v[32:33],v170 offset:32768
ds_read_b64_tr_b16 v[34:35],v170 offset:36864
buffer_load_dwordx4 v12,s[56:59],s80 offen lds
M v[68:71],v[52:55],a[228:231],v[68:71]
ds_read_b64_tr_b16 v[36:37],v170 offset:40960
ds_read_b64_tr_b16 v[38:39],v170 offset:45056
M v[68:71],v[56:59],a[232:235],v[68:71]
ds_read_b64_tr_b16 v[40:41],v170 offset:49152
ds_read_b64_tr_b16 v[42:43],v170 offset:53248
M v[68:71],v[60:63],a[236:239],v[68:71]
ds_read_b64_tr_b16 v[44:45],v170 offset:57344
ds_read_b64_tr_b16 v[46:47],v170 offset:61440
s_xor_b32 s81,s73,0x61000
s_xor_b32 m0,s74,0x8400
M v[84:87],v[48:51],a[240:243],v[84:87]
buffer_load_dwordx4 v13,s[56:59],s81 offen lds
M v[84:87],v[52:55],a[244:247],v[84:87]
M v[84:87],v[56:59],a[248:251],v[84:87]
M v[84:87],v[60:63],a[252:255],v[84:87]
s_xor_b32 s80,s73,0x62000
s_xor_b32 m0,s74,0x8800
s_waitcnt lgkmcnt(0)
M v[72:75],v[32:35],a[224:227],v[72:75]
ds_read_b64_tr_b16 v[48:49],v171 offset:32768
ds_read_b64_tr_b16 v[50:51],v171 offset:36864
buffer_load_dwordx4 v12,s[56:59],s80 offen lds
M v[72:75],v[36:39],a[228:231],v[72:75]
ds_read_b64_tr_b16 v[52:53],v171 offset:40960
ds_read_b64_tr_b16 v[54:55],v171 offset:45056
M v[72:75],v[40:43],a[232:235],v[72:75]
ds_read_b64_tr_b16 v[56:57],v171 offset:49152
ds_read_b64_tr_b16 v[58:59],v171 offset:53248
s_xor_b32 s81,s73,0x63000
s_xor_b32 m0,s74,0x8c00
M v[72:75],v[44:47],a[236:239],v[72:75]
ds_read_b64_tr_b16 v[60:61],v171 offset:57344
ds_read_b64_tr_b16 v[62:63],v171 offset:61440
buffer_load_dwordx4 v13,s[56:59],s81 offen lds
M v[88:91],v[32:35],a[240:243],v[88:91]
M v[88:91],v[36:39],a[244:247],v[88:91]
M v[88:91],v[40:43],a[248:251],v[88:91]
s_xor_b32 s80,s73,0x64000
s_xor_b32 m0,s74,0x9000
M v[88:91],v[44:47],a[252:255],v[88:91]
buffer_load_dwordx4 v12,s[56:59],s80 offen lds
s_waitcnt lgkmcnt(0)
M v[76:79],v[48:51],a[224:227],v[76:79]
ds_read_b64_tr_b16 v[32:33],v172 offset:32768
ds_read_b64_tr_b16 v[34:35],v172 offset:36864
M v[76:79],v[52:55],a[228:231],v[76:79]
ds_read_b64_tr_b16 v[36:37],v172 offset:40960
ds_read_b64_tr_b16 v[38:39],v172 offset:45056
M v[76:79],v[56:59],a[232:235],v[76:79]
ds_read_b64_tr_b16 v[40:41],v172 offset:49152
ds_read_b64_tr_b16 v[42:43],v172 offset:53248
s_xor_b32 s81,s73,0x65000
s_xor_b32 m0,s74,0x9400
M v[76:79],v[60:63],a[236:239],v[76:79]
ds_read_b64_tr_b16 v[44:45],v172 offset:57344
ds_read_b64_tr_b16 v[46:47],v172 offset:61440
buffer_load_dwordx4 v13,s[56:59],s81 offen lds
M v[92:95],v[48:51],a[240:243],v[92:95]
M v[92:95],v[52:55],a[244:247],v[92:95]
M v[92:95],v[56:59],a[248:251],v[92:95]
s_xor_b32 s80,s73,0x66000
s_xor_b32 m0,s74,0x9800
M v[92:95],v[60:63],a[252:255],v[92:95]
buffer_load_dwordx4 v12,s[56:59],s80 offen lds
s_waitcnt lgkmcnt(0)
M v[96:99],v[32:35],a[224:227],v[96:99]
ds_read_b64_tr_b16 v[48:49],v173 offset:32768
ds_read_b64_tr_b16 v[50:51],v173 offset:36864
M v[96:99],v[36:39],a[228:231],v[96:99]
ds_read_b64_tr_b16 v[52:53],v173 offset:40960
ds_read_b64_tr_b16 v[54:55],v173 offset:45056
s_xor_b32 s81,s73,0x67000
s_xor_b32 m0,s74,0x9c00
M v[96:99],v[40:43],a[232:235],v[96:99]
ds_read_b64_tr_b16 v[56:57],v173 offset:49152
ds_read_b64_tr_b16 v[58:59],v173 offset:53248
buffer_load_dwordx4 v13,s[56:59],s81 offen lds
M v[96:99],v[44:47],a[236:239],v[96:99]
ds_read_b64_tr_b16 v[60:61],v173 offset:57344
ds_read_b64_tr_b16 v[62:63],v173 offset:61440
M v[112:115],v[32:35],a[240:243],v[112:115]
M v[112:115],v[36:39],a[244:247],v[112:115]
s_xor_b32 s80,s72,0x3400
M v[112:115],v[40:43],a[248:251],v[112:115]
buffer_load_dwordx4 a[164:167],v11,s[60:63],s80 offen sc1
M v[112:115],v[44:47],a[252:255],v[112:115]
s_waitcnt lgkmcnt(0)
M v[100:103],v[48:51],a[224:227],v[100:103]
ds_read_b64_tr_b16 v[32:33],v174 offset:32768
ds_read_b64_tr_b16 v[34:35],v174 offset:36864
M v[100:103],v[52:55],a[228:231],v[100:103]
ds_read_b64_tr_b16 v[36:37],v174 offset:40960
ds_read_b64_tr_b16 v[38:39],v174 offset:45056
s_xor_b32 s81,s72,0x23400
M v[100:103],v[56:59],a[232:235],v[100:103]
ds_read_b64_tr_b16 v[40:41],v174 offset:49152
ds_read_b64_tr_b16 v[42:43],v174 offset:53248
buffer_load_dwordx4 a[180:183],v11,s[60:63],s81 offen sc1
M v[100:103],v[60:63],a[236:239],v[100:103]
ds_read_b64_tr_b16 v[44:45],v174 offset:57344
ds_read_b64_tr_b16 v[46:47],v174 offset:61440
M v[116:119],v[48:51],a[240:243],v[116:119]
M v[116:119],v[52:55],a[244:247],v[116:119]
s_xor_b32 s80,s72,0x3800
M v[116:119],v[56:59],a[248:251],v[116:119]
buffer_load_dwordx4 a[168:171],v11,s[60:63],s80 offen sc1
M v[116:119],v[60:63],a[252:255],v[116:119]
s_waitcnt lgkmcnt(0)
M v[104:107],v[32:35],a[224:227],v[104:107]
ds_read_b64_tr_b16 v[48:49],v175 offset:32768
ds_read_b64_tr_b16 v[50:51],v175 offset:36864
s_xor_b32 s81,s72,0x23800
M v[104:107],v[36:39],a[228:231],v[104:107]
ds_read_b64_tr_b16 v[52:53],v175 offset:40960
ds_read_b64_tr_b16 v[54:55],v175 offset:45056
buffer_load_dwordx4 a[184:187],v11,s[60:63],s81 offen sc1
M v[104:107],v[40:43],a[232:235],v[104:107]
ds_read_b64_tr_b16 v[56:57],v175 offset:49152
ds_read_b64_tr_b16 v[58:59],v175 offset:53248
M v[104:107],v[44:47],a[236:239],v[104:107]
ds_read_b64_tr_b16 v[60:61],v175 offset:57344
ds_read_b64_tr_b16 v[62:63],v175 offset:61440
M v[120:123],v[32:35],a[240:243],v[120:123]
s_xor_b32 s80,s72,0x3c00
M v[120:123],v[36:39],a[244:247],v[120:123]
buffer_load_dwordx4 a[172:175],v11,s[60:63],s80 offen sc1
M v[120:123],v[40:43],a[248:251],v[120:123]
M v[120:123],v[44:47],a[252:255],v[120:123]
s_waitcnt vmcnt(21) lgkmcnt(0)
s_barrier
M v[108:111],v[48:51],a[224:227],v[108:111]
ds_read_b64_tr_b16 v[32:33],v160
ds_read_b64_tr_b16 v[34:35],v160 offset:4096
s_xor_b32 s81,s72,0x23c00
M v[108:111],v[52:55],a[228:231],v[108:111]
ds_read_b64_tr_b16 v[36:37],v160 offset:8192
ds_read_b64_tr_b16 v[38:39],v160 offset:12288
buffer_load_dwordx4 a[188:191],v11,s[60:63],s81 offen sc1
M v[108:111],v[56:59],a[232:235],v[108:111]
ds_read_b64_tr_b16 v[40:41],v160 offset:16384
ds_read_b64_tr_b16 v[42:43],v160 offset:20480
M v[108:111],v[60:63],a[236:239],v[108:111]
ds_read_b64_tr_b16 v[44:45],v160 offset:24576
ds_read_b64_tr_b16 v[46:47],v160 offset:28672
M v[124:127],v[48:51],a[240:243],v[124:127]
M v[124:127],v[52:55],a[244:247],v[124:127]
M v[124:127],v[56:59],a[248:251],v[124:127]
M v[124:127],v[60:63],a[252:255],v[124:127]
s_waitcnt vmcnt(16) lgkmcnt(0)
M v[64:67],v[32:35],a[128:131],v[64:67]
ds_read_b64_tr_b16 v[48:49],v161
ds_read_b64_tr_b16 v[50:51],v161 offset:4096
s_xor_b32 s80,s72,0x7000
M v[64:67],v[36:39],a[132:135],v[64:67]
ds_read_b64_tr_b16 v[52:53],v161 offset:8192
ds_read_b64_tr_b16 v[54:55],v161 offset:12288
buffer_load_dwordx4 a[224:227],v11,s[60:63],s80 offen sc1
M v[64:67],v[40:43],a[136:139],v[64:67]
ds_read_b64_tr_b16 v[56:57],v161 offset:16384
ds_read_b64_tr_b16 v[58:59],v161 offset:20480
M v[64:67],v[44:47],a[140:143],v[64:67]
ds_read_b64_tr_b16 v[60:61],v161 offset:24576
ds_read_b64_tr_b16 v[62:63],v161 offset:28672
s_xor_b32 s81,s72,0x27000
M v[80:83],v[32:35],a[144:147],v[80:83]
buffer_load_dwordx4 a[240:243],v11,s[60:63],s81 offen sc1
M v[80:83],v[36:39],a[148:151],v[80:83]
M v[80:83],v[40:43],a[152:155],v[80:83]
M v[80:83],v[44:47],a[156:159],v[80:83]
s_xor_b32 s80,s73,0xe0000
s_xor_b32 m0,s74,0x18000
s_waitcnt lgkmcnt(0)
M v[68:71],v[48:51],a[128:131],v[68:71]
ds_read_b64_tr_b16 v[32:33],v162
ds_read_b64_tr_b16 v[34:35],v162 offset:4096
buffer_load_dwordx4 v12,s[56:59],s80 offen lds
M v[68:71],v[52:55],a[132:135],v[68:71]
ds_read_b64_tr_b16 v[36:37],v162 offset:8192
ds_read_b64_tr_b16 v[38:39],v162 offset:12288
M v[68:71],v[56:59],a[136:139],v[68:71]
ds_read_b64_tr_b16 v[40:41],v162 offset:16384
ds_read_b64_tr_b16 v[42:43],v162 offset:20480
M v[68:71],v[60:63],a[140:143],v[68:71]
ds_read_b64_tr_b16 v[44:45],v162 offset:24576
ds_read_b64_tr_b16 v[46:47],v162 offset:28672
s_xor_b32 s81,s73,0xa1000
s_xor_b32 m0,s74,0x10400
M v[84:87],v[48:51],a[144:147],v[84:87]
buffer_load_dwordx4 v13,s[56:59],s81 offen lds
M v[84:87],v[52:55],a[148:151],v[84:87]
M v[84:87],v[56:59],a[152:155],v[84:87]
M v[84:87],v[60:63],a[156:159],v[84:87]
s_xor_b32 s80,s73,0xa2000
s_xor_b32 m0,s74,0x10800
s_waitcnt lgkmcnt(0)
M v[72:75],v[32:35],a[128:131],v[72:75]
ds_read_b64_tr_b16 v[48:49],v163
ds_read_b64_tr_b16 v[50:51],v163 offset:4096
buffer_load_dwordx4 v12,s[56:59],s80 offen lds
M v[72:75],v[36:39],a[132:135],v[72:75]
ds_read_b64_tr_b16 v[52:53],v163 offset:8192
ds_read_b64_tr_b16 v[54:55],v163 offset:12288
M v[72:75],v[40:43],a[136:139],v[72:75]
ds_read_b64_tr_b16 v[56:57],v163 offset:16384
ds_read_b64_tr_b16 v[58:59],v163 offset:20480
s_xor_b32 s81,s73,0xa3000
s_xor_b32 m0,s74,0x10c00
M v[72:75],v[44:47],a[140:143],v[72:75]
ds_read_b64_tr_b16 v[60:61],v163 offset:24576
ds_read_b64_tr_b16 v[62:63],v163 offset:28672
buffer_load_dwordx4 v13,s[56:59],s81 offen lds
M v[88:91],v[32:35],a[144:147],v[88:91]
M v[88:91],v[36:39],a[148:151],v[88:91]
M v[88:91],v[40:43],a[152:155],v[88:91]
s_xor_b32 s80,s73,0xa4000
s_xor_b32 m0,s74,0x11000
M v[88:91],v[44:47],a[156:159],v[88:91]
buffer_load_dwordx4 v12,s[56:59],s80 offen lds
s_waitcnt lgkmcnt(0)
M v[76:79],v[48:51],a[128:131],v[76:79]
ds_read_b64_tr_b16 v[32:33],v164
ds_read_b64_tr_b16 v[34:35],v164 offset:4096
M v[76:79],v[52:55],a[132:135],v[76:79]
ds_read_b64_tr_b16 v[36:37],v164 offset:8192
ds_read_b64_tr_b16 v[38:39],v164 offset:12288
M v[76:79],v[56:59],a[136:139],v[76:79]
ds_read_b64_tr_b16 v[40:41],v164 offset:16384
ds_read_b64_tr_b16 v[42:43],v164 offset:20480
s_xor_b32 s81,s73,0xa5000
s_xor_b32 m0,s74,0x11400
M v[76:79],v[60:63],a[140:143],v[76:79]
ds_read_b64_tr_b16 v[44:45],v164 offset:24576
ds_read_b64_tr_b16 v[46:47],v164 offset:28672
buffer_load_dwordx4 v13,s[56:59],s81 offen lds
M v[92:95],v[48:51],a[144:147],v[92:95]
M v[92:95],v[52:55],a[148:151],v[92:95]
M v[92:95],v[56:59],a[152:155],v[92:95]
s_xor_b32 s80,s73,0xa6000
s_xor_b32 m0,s74,0x11800
M v[92:95],v[60:63],a[156:159],v[92:95]
buffer_load_dwordx4 v12,s[56:59],s80 offen lds
s_waitcnt lgkmcnt(0)
M v[96:99],v[32:35],a[128:131],v[96:99]
ds_read_b64_tr_b16 v[48:49],v165
ds_read_b64_tr_b16 v[50:51],v165 offset:4096
M v[96:99],v[36:39],a[132:135],v[96:99]
ds_read_b64_tr_b16 v[52:53],v165 offset:8192
ds_read_b64_tr_b16 v[54:55],v165 offset:12288
s_xor_b32 s81,s73,0xa7000
s_xor_b32 m0,s74,0x11c00
M v[96:99],v[40:43],a[136:139],v[96:99]
ds_read_b64_tr_b16 v[56:57],v165 offset:16384
ds_read_b64_tr_b16 v[58:59],v165 offset:20480
buffer_load_dwordx4 v13,s[56:59],s81 offen lds
M v[96:99],v[44:47],a[140:143],v[96:99]
ds_read_b64_tr_b16 v[60:61],v165 offset:24576
ds_read_b64_tr_b16 v[62:63],v165 offset:28672
M v[112:115],v[32:35],a[144:147],v[112:115]
M v[112:115],v[36:39],a[148:151],v[112:115]
s_xor_b32 s80,s72,0x5400
M v[112:115],v[40:43],a[152:155],v[112:115]
buffer_load_dwordx4 a[196:199],v11,s[60:63],s80 offen sc1
M v[112:115],v[44:47],a[156:159],v[112:115]
s_waitcnt lgkmcnt(0)
M v[100:103],v[48:51],a[128:131],v[100:103]
ds_read_b64_tr_b16 v[32:33],v166
ds_read_b64_tr_b16 v[34:35],v166 offset:4096
M v[100:103],v[52:55],a[132:135],v[100:103]
ds_read_b64_tr_b16 v[36:37],v166 offset:8192
ds_read_b64_tr_b16 v[38:39],v166 offset:12288
s_xor_b32 s81,s72,0x25400
M v[100:103],v[56:59],a[136:139],v[100:103]
ds_read_b64_tr_b16 v[40:41],v166 offset:16384
ds_read_b64_tr_b16 v[42:43],v166 offset:20480
buffer_load_dwordx4 a[212:215],v11,s[60:63],s81 offen sc1
M v[100:103],v[60:63],a[140:143],v[100:103]
ds_read_b64_tr_b16 v[44:45],v166 offset:24576
ds_read_b64_tr_b16 v[46:47],v166 offset:28672
M v[116:119],v[48:51],a[144:147],v[116:119]
M v[116:119],v[52:55],a[148:151],v[116:119]
s_xor_b32 s80,s72,0x5800
M v[116:119],v[56:59],a[152:155],v[116:119]
buffer_load_dwordx4 a[200:203],v11,s[60:63],s80 offen sc1
M v[116:119],v[60:63],a[156:159],v[116:119]
s_waitcnt lgkmcnt(0)
M v[104:107],v[32:35],a[128:131],v[104:107]
ds_read_b64_tr_b16 v[48:49],v167
ds_read_b64_tr_b16 v[50:51],v167 offset:4096
s_xor_b32 s81,s72,0x25800
M v[104:107],v[36:39],a[132:135],v[104:107]
ds_read_b64_tr_b16 v[52:53],v167 offset:8192
ds_read_b64_tr_b16 v[54:55],v167 offset:12288
buffer_load_dwordx4 a[216:219],v11,s[60:63],s81 offen sc1
M v[104:107],v[40:43],a[136:139],v[104:107]
ds_read_b64_tr_b16 v[56:57],v167 offset:16384
ds_read_b64_tr_b16 v[58:59],v167 offset:20480
M v[104:107],v[44:47],a[140:143],v[104:107]
ds_read_b64_tr_b16 v[60:61],v167 offset:24576
ds_read_b64_tr_b16 v[62:63],v167 offset:28672
M v[120:123],v[32:35],a[144:147],v[120:123]
s_xor_b32 s80,s72,0x5c00
M v[120:123],v[36:39],a[148:151],v[120:123]
buffer_load_dwordx4 a[204:207],v11,s[60:63],s80 offen sc1
M v[120:123],v[40:43],a[152:155],v[120:123]
M v[120:123],v[44:47],a[156:159],v[120:123]
s_waitcnt vmcnt(21) lgkmcnt(0)
s_barrier
M v[108:111],v[48:51],a[128:131],v[108:111]
ds_read_b64_tr_b16 v[32:33],v160 offset:32768
ds_read_b64_tr_b16 v[34:35],v160 offset:36864
s_xor_b32 s81,s72,0x25c00
M v[108:111],v[52:55],a[132:135],v[108:111]
ds_read_b64_tr_b16 v[36:37],v160 offset:40960
ds_read_b64_tr_b16 v[38:39],v160 offset:45056
buffer_load_dwordx4 a[220:223],v11,s[60:63],s81 offen sc1
M v[108:111],v[56:59],a[136:139],v[108:111]
ds_read_b64_tr_b16 v[40:41],v160 offset:49152
ds_read_b64_tr_b16 v[42:43],v160 offset:53248
M v[108:111],v[60:63],a[140:143],v[108:111]
ds_read_b64_tr_b16 v[44:45],v160 offset:57344
ds_read_b64_tr_b16 v[46:47],v160 offset:61440
M v[124:127],v[48:51],a[144:147],v[124:127]
M v[124:127],v[52:55],a[148:151],v[124:127]
M v[124:127],v[56:59],a[152:155],v[124:127]
M v[124:127],v[60:63],a[156:159],v[124:127]
s_waitcnt vmcnt(16) lgkmcnt(0)
M v[64:67],v[32:35],a[160:163],v[64:67]
ds_read_b64_tr_b16 v[48:49],v161 offset:32768
ds_read_b64_tr_b16 v[50:51],v161 offset:36864
s_xor_b32 s80,s72,0x9000
M v[64:67],v[36:39],a[164:167],v[64:67]
ds_read_b64_tr_b16 v[52:53],v161 offset:40960
ds_read_b64_tr_b16 v[54:55],v161 offset:45056
buffer_load_dwordx4 a[128:131],v11,s[60:63],s80 offen sc1
M v[64:67],v[40:43],a[168:171],v[64:67]
ds_read_b64_tr_b16 v[56:57],v161 offset:49152
ds_read_b64_tr_b16 v[58:59],v161 offset:53248
M v[64:67],v[44:47],a[172:175],v[64:67]
ds_read_b64_tr_b16 v[60:61],v161 offset:57344
ds_read_b64_tr_b16 v[62:63],v161 offset:61440
s_xor_b32 s81,s72,0x29000
M v[80:83],v[32:35],a[176:179],v[80:83]
buffer_load_dwordx4 a[144:147],v11,s[60:63],s81 offen sc1
M v[80:83],v[36:39],a[180:183],v[80:83]
M v[80:83],v[40:43],a[184:187],v[80:83]
M v[80:83],v[44:47],a[188:191],v[80:83]
s_xor_b32 s80,s73,0x120000
s_xor_b32 m0,s74,0
s_waitcnt lgkmcnt(0)
M v[68:71],v[48:51],a[160:163],v[68:71]
ds_read_b64_tr_b16 v[32:33],v162 offset:32768
ds_read_b64_tr_b16 v[34:35],v162 offset:36864
buffer_load_dwordx4 v12,s[56:59],s80 offen lds
M v[68:71],v[52:55],a[164:167],v[68:71]
ds_read_b64_tr_b16 v[36:37],v162 offset:40960
ds_read_b64_tr_b16 v[38:39],v162 offset:45056
M v[68:71],v[56:59],a[168:171],v[68:71]
ds_read_b64_tr_b16 v[40:41],v162 offset:49152
ds_read_b64_tr_b16 v[42:43],v162 offset:53248
M v[68:71],v[60:63],a[172:175],v[68:71]
ds_read_b64_tr_b16 v[44:45],v162 offset:57344
ds_read_b64_tr_b16 v[46:47],v162 offset:61440
s_xor_b32 s81,s73,0xe1000
s_xor_b32 m0,s74,0x18400
M v[84:87],v[48:51],a[176:179],v[84:87]
buffer_load_dwordx4 v13,s[56:59],s81 offen lds
M v[84:87],v[52:55],a[180:183],v[84:87]
M v[84:87],v[56:59],a[184:187],v[84:87]
M v[84:87],v[60:63],a[188:191],v[84:87]
s_xor_b32 s80,s73,0xe2000
s_xor_b32 m0,s74,0x18800
s_waitcnt lgkmcnt(0)
M v[72:75],v[32:35],a[160:163],v[72:75]
ds_read_b64_tr_b16 v[48:49],v163 offset:32768
ds_read_b64_tr_b16 v[50:51],v163 offset:36864
buffer_load_dwordx4 v12,s[56:59],s80 offen lds
M v[72:75],v[36:39],a[164:167],v[72:75]
ds_read_b64_tr_b16 v[52:53],v163 offset:40960
ds_read_b64_tr_b16 v[54:55],v163 offset:45056
M v[72:75],v[40:43],a[168:171],v[72:75]
ds_read_b64_tr_b16 v[56:57],v163 offset:49152
ds_read_b64_tr_b16 v[58:59],v163 offset:53248
s_xor_b32 s81,s73,0xe3000
s_xor_b32 m0,s74,0x18c00
M v[72:75],v[44:47],a[172:175],v[72:75]
ds_read_b64_tr_b16 v[60:61],v163 offset:57344
ds_read_b64_tr_b16 v[62:63],v163 offset:61440
buffer_load_dwordx4 v13,s[56:59],s81 offen lds
M v[88:91],v[32:35],a[176:179],v[88:91]
M v[88:91],v[36:39],a[180:183],v[88:91]
M v[88:91],v[40:43],a[184:187],v[88:91]
s_xor_b32 s80,s73,0xe4000
s_xor_b32 m0,s74,0x19000
M v[88:91],v[44:47],a[188:191],v[88:91]
buffer_load_dwordx4 v12,s[56:59],s80 offen lds
s_waitcnt lgkmcnt(0)
M v[76:79],v[48:51],a[160:163],v[76:79]
ds_read_b64_tr_b16 v[32:33],v164 offset:32768
ds_read_b64_tr_b16 v[34:35],v164 offset:36864
M v[76:79],v[52:55],a[164:167],v[76:79]
ds_read_b64_tr_b16 v[36:37],v164 offset:40960
ds_read_b64_tr_b16 v[38:39],v164 offset:45056
M v[76:79],v[56:59],a[168:171],v[76:79]
ds_read_b64_tr_b16 v[40:41],v164 offset:49152
ds_read_b64_tr_b16 v[42:43],v164 offset:53248
s_xor_b32 s81,s73,0xe5000
s_xor_b32 m0,s74,0x19400
M v[76:79],v[60:63],a[172:175],v[76:79]
ds_read_b64_tr_b16 v[44:45],v164 offset:57344
ds_read_b64_tr_b16 v[46:47],v164 offset:61440
buffer_load_dwordx4 v13,s[56:59],s81 offen lds
M v[92:95],v[48:51],a[176:179],v[92:95]
M v[92:95],v[52:55],a[180:183],v[92:95]
M v[92:95],v[56:59],a[184:187],v[92:95]
s_xor_b32 s80,s73,0xe6000
s_xor_b32 m0,s74,0x19800
M v[92:95],v[60:63],a[188:191],v[92:95]
buffer_load_dwordx4 v12,s[56:59],s80 offen lds
s_waitcnt lgkmcnt(0)
M v[96:99],v[32:35],a[160:163],v[96:99]
ds_read_b64_tr_b16 v[48:49],v165 offset:32768
ds_read_b64_tr_b16 v[50:51],v165 offset:36864
M v[96:99],v[36:39],a[164:167],v[96:99]
ds_read_b64_tr_b16 v[52:53],v165 offset:40960
ds_read_b64_tr_b16 v[54:55],v165 offset:45056
s_xor_b32 s81,s73,0xe7000
s_xor_b32 m0,s74,0x19c00
M v[96:99],v[40:43],a[168:171],v[96:99]
ds_read_b64_tr_b16 v[56:57],v165 offset:49152
ds_read_b64_tr_b16 v[58:59],v165 offset:53248
buffer_load_dwordx4 v13,s[56:59],s81 offen lds
M v[96:99],v[44:47],a[172:175],v[96:99]
ds_read_b64_tr_b16 v[60:61],v165 offset:57344
ds_read_b64_tr_b16 v[62:63],v165 offset:61440
M v[112:115],v[32:35],a[176:179],v[112:115]
M v[112:115],v[36:39],a[180:183],v[112:115]
s_xor_b32 s80,s72,0x7400
M v[112:115],v[40:43],a[184:187],v[112:115]
buffer_load_dwordx4 a[228:231],v11,s[60:63],s80 offen sc1
M v[112:115],v[44:47],a[188:191],v[112:115]
s_waitcnt lgkmcnt(0)
M v[100:103],v[48:51],a[160:163],v[100:103]
ds_read_b64_tr_b16 v[32:33],v166 offset:32768
ds_read_b64_tr_b16 v[34:35],v166 offset:36864
M v[100:103],v[52:55],a[164:167],v[100:103]
ds_read_b64_tr_b16 v[36:37],v166 offset:40960
ds_read_b64_tr_b16 v[38:39],v166 offset:45056
s_xor_b32 s81,s72,0x27400
M v[100:103],v[56:59],a[168:171],v[100:103]
ds_read_b64_tr_b16 v[40:41],v166 offset:49152
ds_read_b64_tr_b16 v[42:43],v166 offset:53248
buffer_load_dwordx4 a[244:247],v11,s[60:63],s81 offen sc1
M v[100:103],v[60:63],a[172:175],v[100:103]
ds_read_b64_tr_b16 v[44:45],v166 offset:57344
ds_read_b64_tr_b16 v[46:47],v166 offset:61440
M v[116:119],v[48:51],a[176:179],v[116:119]
M v[116:119],v[52:55],a[180:183],v[116:119]
s_xor_b32 s80,s72,0x7800
M v[116:119],v[56:59],a[184:187],v[116:119]
buffer_load_dwordx4 a[232:235],v11,s[60:63],s80 offen sc1
M v[116:119],v[60:63],a[188:191],v[116:119]
s_waitcnt lgkmcnt(0)
M v[104:107],v[32:35],a[160:163],v[104:107]
ds_read_b64_tr_b16 v[48:49],v167 offset:32768
ds_read_b64_tr_b16 v[50:51],v167 offset:36864
s_xor_b32 s81,s72,0x27800
M v[104:107],v[36:39],a[164:167],v[104:107]
ds_read_b64_tr_b16 v[52:53],v167 offset:40960
ds_read_b64_tr_b16 v[54:55],v167 offset:45056
buffer_load_dwordx4 a[248:251],v11,s[60:63],s81 offen sc1
M v[104:107],v[40:43],a[168:171],v[104:107]
ds_read_b64_tr_b16 v[56:57],v167 offset:49152
ds_read_b64_tr_b16 v[58:59],v167 offset:53248
M v[104:107],v[44:47],a[172:175],v[104:107]
ds_read_b64_tr_b16 v[60:61],v167 offset:57344
ds_read_b64_tr_b16 v[62:63],v167 offset:61440
M v[120:123],v[32:35],a[176:179],v[120:123]
s_xor_b32 s80,s72,0x7c00
M v[120:123],v[36:39],a[180:183],v[120:123]
buffer_load_dwordx4 a[236:239],v11,s[60:63],s80 offen sc1
M v[120:123],v[40:43],a[184:187],v[120:123]
M v[120:123],v[44:47],a[188:191],v[120:123]
s_waitcnt vmcnt(21) lgkmcnt(0)
s_barrier
M v[108:111],v[48:51],a[160:163],v[108:111]
ds_read_b64_tr_b16 v[32:33],v168
ds_read_b64_tr_b16 v[34:35],v168 offset:4096
s_xor_b32 s81,s72,0x27c00
M v[108:111],v[52:55],a[164:167],v[108:111]
ds_read_b64_tr_b16 v[36:37],v168 offset:8192
ds_read_b64_tr_b16 v[38:39],v168 offset:12288
buffer_load_dwordx4 a[252:255],v11,s[60:63],s81 offen sc1
M v[108:111],v[56:59],a[168:171],v[108:111]
ds_read_b64_tr_b16 v[40:41],v168 offset:16384
ds_read_b64_tr_b16 v[42:43],v168 offset:20480
M v[108:111],v[60:63],a[172:175],v[108:111]
ds_read_b64_tr_b16 v[44:45],v168 offset:24576
ds_read_b64_tr_b16 v[46:47],v168 offset:28672
M v[124:127],v[48:51],a[176:179],v[124:127]
M v[124:127],v[52:55],a[180:183],v[124:127]
M v[124:127],v[56:59],a[184:187],v[124:127]
M v[124:127],v[60:63],a[188:191],v[124:127]
s_waitcnt vmcnt(16) lgkmcnt(0)
M v[64:67],v[32:35],a[192:195],v[64:67]
ds_read_b64_tr_b16 v[48:49],v169
ds_read_b64_tr_b16 v[50:51],v169 offset:4096
s_xor_b32 s80,s72,0xb000
M v[64:67],v[36:39],a[196:199],v[64:67]
ds_read_b64_tr_b16 v[52:53],v169 offset:8192
ds_read_b64_tr_b16 v[54:55],v169 offset:12288
buffer_load_dwordx4 a[160:163],v11,s[60:63],s80 offen sc1
M v[64:67],v[40:43],a[200:203],v[64:67]
ds_read_b64_tr_b16 v[56:57],v169 offset:16384
ds_read_b64_tr_b16 v[58:59],v169 offset:20480
M v[64:67],v[44:47],a[204:207],v[64:67]
ds_read_b64_tr_b16 v[60:61],v169 offset:24576
ds_read_b64_tr_b16 v[62:63],v169 offset:28672
s_xor_b32 s81,s72,0x2b000
M v[80:83],v[32:35],a[208:211],v[80:83]
buffer_load_dwordx4 a[176:179],v11,s[60:63],s81 offen sc1
M v[80:83],v[36:39],a[212:215],v[80:83]
M v[80:83],v[40:43],a[216:219],v[80:83]
M v[80:83],v[44:47],a[220:223],v[80:83]
s_xor_b32 s80,s73,0x160000
s_xor_b32 m0,s74,0x8000
s_waitcnt lgkmcnt(0)
M v[68:71],v[48:51],a[192:195],v[68:71]
ds_read_b64_tr_b16 v[32:33],v170
ds_read_b64_tr_b16 v[34:35],v170 offset:4096
buffer_load_dwordx4 v12,s[56:59],s80 offen lds
buffer_load_dword v15,v26,s[64:67],0 offen offset:2048 sc1
M v[68:71],v[52:55],a[196:199],v[68:71]
ds_read_b64_tr_b16 v[36:37],v170 offset:8192
ds_read_b64_tr_b16 v[38:39],v170 offset:12288
M v[68:71],v[56:59],a[200:203],v[68:71]
ds_read_b64_tr_b16 v[40:41],v170 offset:16384
ds_read_b64_tr_b16 v[42:43],v170 offset:20480
M v[68:71],v[60:63],a[204:207],v[68:71]
ds_read_b64_tr_b16 v[44:45],v170 offset:24576
ds_read_b64_tr_b16 v[46:47],v170 offset:28672
s_xor_b32 s81,s73,0x121000
s_xor_b32 m0,s74,0x400
M v[84:87],v[48:51],a[208:211],v[84:87]
buffer_load_dwordx4 v13,s[56:59],s81 offen lds
M v[84:87],v[52:55],a[212:215],v[84:87]
M v[84:87],v[56:59],a[216:219],v[84:87]
M v[84:87],v[60:63],a[220:223],v[84:87]
s_xor_b32 s80,s73,0x122000
s_xor_b32 m0,s74,0x800
s_waitcnt lgkmcnt(0)
M v[72:75],v[32:35],a[192:195],v[72:75]
ds_read_b64_tr_b16 v[48:49],v171
ds_read_b64_tr_b16 v[50:51],v171 offset:4096
buffer_load_dwordx4 v12,s[56:59],s80 offen lds
M v[72:75],v[36:39],a[196:199],v[72:75]
ds_read_b64_tr_b16 v[52:53],v171 offset:8192
ds_read_b64_tr_b16 v[54:55],v171 offset:12288
M v[72:75],v[40:43],a[200:203],v[72:75]
ds_read_b64_tr_b16 v[56:57],v171 offset:16384
ds_read_b64_tr_b16 v[58:59],v171 offset:20480
s_xor_b32 s81,s73,0x123000
s_xor_b32 m0,s74,0xc00
M v[72:75],v[44:47],a[204:207],v[72:75]
ds_read_b64_tr_b16 v[60:61],v171 offset:24576
ds_read_b64_tr_b16 v[62:63],v171 offset:28672
buffer_load_dwordx4 v13,s[56:59],s81 offen lds
M v[88:91],v[32:35],a[208:211],v[88:91]
M v[88:91],v[36:39],a[212:215],v[88:91]
M v[88:91],v[40:43],a[216:219],v[88:91]
s_xor_b32 s80,s73,0x124000
s_xor_b32 m0,s74,0x1000
M v[88:91],v[44:47],a[220:223],v[88:91]
buffer_load_dwordx4 v12,s[56:59],s80 offen lds
s_waitcnt lgkmcnt(0)
M v[76:79],v[48:51],a[192:195],v[76:79]
ds_read_b64_tr_b16 v[32:33],v172
ds_read_b64_tr_b16 v[34:35],v172 offset:4096
M v[76:79],v[52:55],a[196:199],v[76:79]
ds_read_b64_tr_b16 v[36:37],v172 offset:8192
ds_read_b64_tr_b16 v[38:39],v172 offset:12288
M v[76:79],v[56:59],a[200:203],v[76:79]
ds_read_b64_tr_b16 v[40:41],v172 offset:16384
ds_read_b64_tr_b16 v[42:43],v172 offset:20480
s_xor_b32 s81,s73,0x125000
s_xor_b32 m0,s74,0x1400
M v[76:79],v[60:63],a[204:207],v[76:79]
ds_read_b64_tr_b16 v[44:45],v172 offset:24576
ds_read_b64_tr_b16 v[46:47],v172 offset:28672
buffer_load_dwordx4 v13,s[56:59],s81 offen lds
M v[92:95],v[48:51],a[208:211],v[92:95]
M v[92:95],v[52:55],a[212:215],v[92:95]
M v[92:95],v[56:59],a[216:219],v[92:95]
s_xor_b32 s80,s73,0x126000
s_xor_b32 m0,s74,0x1800
M v[92:95],v[60:63],a[220:223],v[92:95]
buffer_load_dwordx4 v12,s[56:59],s80 offen lds
s_waitcnt lgkmcnt(0)
M v[96:99],v[32:35],a[192:195],v[96:99]
ds_read_b64_tr_b16 v[48:49],v173
ds_read_b64_tr_b16 v[50:51],v173 offset:4096
M v[96:99],v[36:39],a[196:199],v[96:99]
ds_read_b64_tr_b16 v[52:53],v173 offset:8192
ds_read_b64_tr_b16 v[54:55],v173 offset:12288
s_xor_b32 s81,s73,0x127000
s_xor_b32 m0,s74,0x1c00
M v[96:99],v[40:43],a[200:203],v[96:99]
ds_read_b64_tr_b16 v[56:57],v173 offset:16384
ds_read_b64_tr_b16 v[58:59],v173 offset:20480
buffer_load_dwordx4 v13,s[56:59],s81 offen lds
M v[96:99],v[44:47],a[204:207],v[96:99]
ds_read_b64_tr_b16 v[60:61],v173 offset:24576
ds_read_b64_tr_b16 v[62:63],v173 offset:28672
M v[112:115],v[32:35],a[208:211],v[112:115]
M v[112:115],v[36:39],a[212:215],v[112:115]
s_xor_b32 s80,s72,0x9400
M v[112:115],v[40:43],a[216:219],v[112:115]
buffer_load_dwordx4 a[132:135],v11,s[60:63],s80 offen sc1
M v[112:115],v[44:47],a[220:223],v[112:115]
s_waitcnt lgkmcnt(0)
M v[100:103],v[48:51],a[192:195],v[100:103]
ds_read_b64_tr_b16 v[32:33],v174
ds_read_b64_tr_b16 v[34:35],v174 offset:4096
M v[100:103],v[52:55],a[196:199],v[100:103]
ds_read_b64_tr_b16 v[36:37],v174 offset:8192
ds_read_b64_tr_b16 v[38:39],v174 offset:12288
s_xor_b32 s81,s72,0x29400
M v[100:103],v[56:59],a[200:203],v[100:103]
ds_read_b64_tr_b16 v[40:41],v174 offset:16384
ds_read_b64_tr_b16 v[42:43],v174 offset:20480
buffer_load_dwordx4 a[148:151],v11,s[60:63],s81 offen sc1
M v[100:103],v[60:63],a[204:207],v[100:103]
ds_read_b64_tr_b16 v[44:45],v174 offset:24576
ds_read_b64_tr_b16 v[46:47],v174 offset:28672
M v[116:119],v[48:51],a[208:211],v[116:119]
M v[116:119],v[52:55],a[212:215],v[116:119]
s_xor_b32 s80,s72,0x9800
M v[116:119],v[56:59],a[216:219],v[116:119]
buffer_load_dwordx4 a[136:139],v11,s[60:63],s80 offen sc1
M v[116:119],v[60:63],a[220:223],v[116:119]
s_waitcnt lgkmcnt(0)
M v[104:107],v[32:35],a[192:195],v[104:107]
ds_read_b64_tr_b16 v[48:49],v175
ds_read_b64_tr_b16 v[50:51],v175 offset:4096
s_xor_b32 s81,s72,0x29800
M v[104:107],v[36:39],a[196:199],v[104:107]
ds_read_b64_tr_b16 v[52:53],v175 offset:8192
ds_read_b64_tr_b16 v[54:55],v175 offset:12288
buffer_load_dwordx4 a[152:155],v11,s[60:63],s81 offen sc1
M v[104:107],v[40:43],a[200:203],v[104:107]
ds_read_b64_tr_b16 v[56:57],v175 offset:16384
ds_read_b64_tr_b16 v[58:59],v175 offset:20480
M v[104:107],v[44:47],a[204:207],v[104:107]
ds_read_b64_tr_b16 v[60:61],v175 offset:24576
ds_read_b64_tr_b16 v[62:63],v175 offset:28672
M v[120:123],v[32:35],a[208:211],v[120:123]
s_xor_b32 s80,s72,0x9c00
M v[120:123],v[36:39],a[212:215],v[120:123]
buffer_load_dwordx4 a[140:143],v11,s[60:63],s80 offen sc1
M v[120:123],v[40:43],a[216:219],v[120:123]
M v[120:123],v[44:47],a[220:223],v[120:123]
s_waitcnt vmcnt(22) lgkmcnt(0)
s_barrier
M v[108:111],v[48:51],a[192:195],v[108:111]
ds_read_b64_tr_b16 v[32:33],v168 offset:32768
ds_read_b64_tr_b16 v[34:35],v168 offset:36864
s_xor_b32 s81,s72,0x29c00
M v[108:111],v[52:55],a[196:199],v[108:111]
ds_read_b64_tr_b16 v[36:37],v168 offset:40960
ds_read_b64_tr_b16 v[38:39],v168 offset:45056
buffer_load_dwordx4 a[156:159],v11,s[60:63],s81 offen sc1
M v[108:111],v[56:59],a[200:203],v[108:111]
ds_read_b64_tr_b16 v[40:41],v168 offset:49152
ds_read_b64_tr_b16 v[42:43],v168 offset:53248
M v[108:111],v[60:63],a[204:207],v[108:111]
ds_read_b64_tr_b16 v[44:45],v168 offset:57344
ds_read_b64_tr_b16 v[46:47],v168 offset:61440
M v[124:127],v[48:51],a[208:211],v[124:127]
M v[124:127],v[52:55],a[212:215],v[124:127]
M v[124:127],v[56:59],a[216:219],v[124:127]
M v[124:127],v[60:63],a[220:223],v[124:127]
s_waitcnt vmcnt(13)
v_cmp_eq_u32 s[80:81],1,v15
s_nop 0
s_cmp_eq_u64 s[80:81],-1
s_cbranch_scc0 K2F_H1B_SPIN
K2F_H1B_BACK:
s_waitcnt lgkmcnt(0)
M v[64:67],v[32:35],a[224:227],v[64:67]
ds_read_b64_tr_b16 v[48:49],v169 offset:32768
ds_read_b64_tr_b16 v[50:51],v169 offset:36864
s_xor_b32 s80,s54,0xd000
M v[64:67],v[36:39],a[228:231],v[64:67]
ds_read_b64_tr_b16 v[52:53],v169 offset:40960
ds_read_b64_tr_b16 v[54:55],v169 offset:45056
buffer_load_dwordx4 a[192:195],v11,s[60:63],s80 offen sc1
M v[64:67],v[40:43],a[232:235],v[64:67]
ds_read_b64_tr_b16 v[56:57],v169 offset:49152
ds_read_b64_tr_b16 v[58:59],v169 offset:53248
M v[64:67],v[44:47],a[236:239],v[64:67]
ds_read_b64_tr_b16 v[60:61],v169 offset:57344
ds_read_b64_tr_b16 v[62:63],v169 offset:61440
s_xor_b32 s81,s54,0x2d000
M v[80:83],v[32:35],a[240:243],v[80:83]
buffer_load_dwordx4 a[208:211],v11,s[60:63],s81 offen sc1
M v[80:83],v[36:39],a[244:247],v[80:83]
M v[80:83],v[40:43],a[248:251],v[80:83]
M v[80:83],v[44:47],a[252:255],v[80:83]
s_xor_b32 s80,s55,0x1a0000
s_xor_b32 m0,s75,0x10000
s_waitcnt lgkmcnt(0)
M v[68:71],v[48:51],a[224:227],v[68:71]
ds_read_b64_tr_b16 v[32:33],v170 offset:32768
ds_read_b64_tr_b16 v[34:35],v170 offset:36864
buffer_load_dwordx4 v184,s[56:59],s80 offen lds
M v[68:71],v[52:55],a[228:231],v[68:71]
ds_read_b64_tr_b16 v[36:37],v170 offset:40960
ds_read_b64_tr_b16 v[38:39],v170 offset:45056
M v[68:71],v[56:59],a[232:235],v[68:71]
ds_read_b64_tr_b16 v[40:41],v170 offset:49152
ds_read_b64_tr_b16 v[42:43],v170 offset:53248
M v[68:71],v[60:63],a[236:239],v[68:71]
ds_read_b64_tr_b16 v[44:45],v170 offset:57344
ds_read_b64_tr_b16 v[46:47],v170 offset:61440
s_xor_b32 s81,s73,0x161000
s_xor_b32 m0,s74,0x8400
M v[84:87],v[48:51],a[240:243],v[84:87]
buffer_load_dwordx4 v13,s[56:59],s81 offen lds
M v[84:87],v[52:55],a[244:247],v[84:87]
M v[84:87],v[56:59],a[248:251],v[84:87]
M v[84:87],v[60:63],a[252:255],v[84:87]
s_xor_b32 s80,s73,0x162000
s_xor_b32 m0,s74,0x8800
s_waitcnt lgkmcnt(0)
M v[72:75],v[32:35],a[224:227],v[72:75]
ds_read_b64_tr_b16 v[48:49],v171 offset:32768
ds_read_b64_tr_b16 v[50:51],v171 offset:36864
buffer_load_dwordx4 v12,s[56:59],s80 offen lds
M v[72:75],v[36:39],a[228:231],v[72:75]
ds_read_b64_tr_b16 v[52:53],v171 offset:40960
ds_read_b64_tr_b16 v[54:55],v171 offset:45056
M v[72:75],v[40:43],a[232:235],v[72:75]
ds_read_b64_tr_b16 v[56:57],v171 offset:49152
ds_read_b64_tr_b16 v[58:59],v171 offset:53248
s_xor_b32 s81,s73,0x163000
s_xor_b32 m0,s74,0x8c00
M v[72:75],v[44:47],a[236:239],v[72:75]
ds_read_b64_tr_b16 v[60:61],v171 offset:57344
ds_read_b64_tr_b16 v[62:63],v171 offset:61440
buffer_load_dwordx4 v13,s[56:59],s81 offen lds
M v[88:91],v[32:35],a[240:243],v[88:91]
M v[88:91],v[36:39],a[244:247],v[88:91]
M v[88:91],v[40:43],a[248:251],v[88:91]
s_xor_b32 s80,s73,0x164000
s_xor_b32 m0,s74,0x9000
M v[88:91],v[44:47],a[252:255],v[88:91]
buffer_load_dwordx4 v12,s[56:59],s80 offen lds
s_waitcnt lgkmcnt(0)
M v[76:79],v[48:51],a[224:227],v[76:79]
ds_read_b64_tr_b16 v[32:33],v172 offset:32768
ds_read_b64_tr_b16 v[34:35],v172 offset:36864
M v[76:79],v[52:55],a[228:231],v[76:79]
ds_read_b64_tr_b16 v[36:37],v172 offset:40960
ds_read_b64_tr_b16 v[38:39],v172 offset:45056
M v[76:79],v[56:59],a[232:235],v[76:79]
ds_read_b64_tr_b16 v[40:41],v172 offset:49152
ds_read_b64_tr_b16 v[42:43],v172 offset:53248
s_xor_b32 s81,s73,0x165000
s_xor_b32 m0,s74,0x9400
M v[76:79],v[60:63],a[236:239],v[76:79]
ds_read_b64_tr_b16 v[44:45],v172 offset:57344
ds_read_b64_tr_b16 v[46:47],v172 offset:61440
buffer_load_dwordx4 v13,s[56:59],s81 offen lds
M v[92:95],v[48:51],a[240:243],v[92:95]
M v[92:95],v[52:55],a[244:247],v[92:95]
M v[92:95],v[56:59],a[248:251],v[92:95]
s_xor_b32 s80,s73,0x166000
s_xor_b32 m0,s74,0x9800
M v[92:95],v[60:63],a[252:255],v[92:95]
buffer_load_dwordx4 v12,s[56:59],s80 offen lds
s_waitcnt lgkmcnt(0)
M v[96:99],v[32:35],a[224:227],v[96:99]
ds_read_b64_tr_b16 v[48:49],v173 offset:32768
ds_read_b64_tr_b16 v[50:51],v173 offset:36864
M v[96:99],v[36:39],a[228:231],v[96:99]
ds_read_b64_tr_b16 v[52:53],v173 offset:40960
ds_read_b64_tr_b16 v[54:55],v173 offset:45056
s_xor_b32 s81,s73,0x167000
s_xor_b32 m0,s74,0x9c00
M v[96:99],v[40:43],a[232:235],v[96:99]
ds_read_b64_tr_b16 v[56:57],v173 offset:49152
ds_read_b64_tr_b16 v[58:59],v173 offset:53248
buffer_load_dwordx4 v13,s[56:59],s81 offen lds
M v[96:99],v[44:47],a[236:239],v[96:99]
ds_read_b64_tr_b16 v[60:61],v173 offset:57344
ds_read_b64_tr_b16 v[62:63],v173 offset:61440
M v[112:115],v[32:35],a[240:243],v[112:115]
M v[112:115],v[36:39],a[244:247],v[112:115]
s_xor_b32 s80,s72,0xb400
M v[112:115],v[40:43],a[248:251],v[112:115]
buffer_load_dwordx4 a[164:167],v11,s[60:63],s80 offen sc1
M v[112:115],v[44:47],a[252:255],v[112:115]
s_waitcnt lgkmcnt(0)
M v[100:103],v[48:51],a[224:227],v[100:103]
ds_read_b64_tr_b16 v[32:33],v174 offset:32768
ds_read_b64_tr_b16 v[34:35],v174 offset:36864
M v[100:103],v[52:55],a[228:231],v[100:103]
ds_read_b64_tr_b16 v[36:37],v174 offset:40960
ds_read_b64_tr_b16 v[38:39],v174 offset:45056
s_xor_b32 s81,s72,0x2b400
M v[100:103],v[56:59],a[232:235],v[100:103]
ds_read_b64_tr_b16 v[40:41],v174 offset:49152
ds_read_b64_tr_b16 v[42:43],v174 offset:53248
buffer_load_dwordx4 a[180:183],v11,s[60:63],s81 offen sc1
M v[100:103],v[60:63],a[236:239],v[100:103]
ds_read_b64_tr_b16 v[44:45],v174 offset:57344
ds_read_b64_tr_b16 v[46:47],v174 offset:61440
M v[116:119],v[48:51],a[240:243],v[116:119]
M v[116:119],v[52:55],a[244:247],v[116:119]
s_xor_b32 s80,s72,0xb800
M v[116:119],v[56:59],a[248:251],v[116:119]
buffer_load_dwordx4 a[168:171],v11,s[60:63],s80 offen sc1
M v[116:119],v[60:63],a[252:255],v[116:119]
s_waitcnt lgkmcnt(0)
M v[104:107],v[32:35],a[224:227],v[104:107]
ds_read_b64_tr_b16 v[48:49],v175 offset:32768
ds_read_b64_tr_b16 v[50:51],v175 offset:36864
s_xor_b32 s81,s72,0x2b800
M v[104:107],v[36:39],a[228:231],v[104:107]
ds_read_b64_tr_b16 v[52:53],v175 offset:40960
ds_read_b64_tr_b16 v[54:55],v175 offset:45056
buffer_load_dwordx4 a[184:187],v11,s[60:63],s81 offen sc1
M v[104:107],v[40:43],a[232:235],v[104:107]
ds_read_b64_tr_b16 v[56:57],v175 offset:49152
ds_read_b64_tr_b16 v[58:59],v175 offset:53248
M v[104:107],v[44:47],a[236:239],v[104:107]
ds_read_b64_tr_b16 v[60:61],v175 offset:57344
ds_read_b64_tr_b16 v[62:63],v175 offset:61440
M v[120:123],v[32:35],a[240:243],v[120:123]
s_xor_b32 s80,s72,0xbc00
M v[120:123],v[36:39],a[244:247],v[120:123]
buffer_load_dwordx4 a[172:175],v11,s[60:63],s80 offen sc1
M v[120:123],v[40:43],a[248:251],v[120:123]
M v[120:123],v[44:47],a[252:255],v[120:123]
s_waitcnt vmcnt(21) lgkmcnt(0)
s_barrier
M v[108:111],v[48:51],a[224:227],v[108:111]
ds_read_b64_tr_b16 v[32:33],v160
ds_read_b64_tr_b16 v[34:35],v160 offset:4096
s_xor_b32 s81,s72,0x2bc00
M v[108:111],v[52:55],a[228:231],v[108:111]
ds_read_b64_tr_b16 v[36:37],v160 offset:8192
ds_read_b64_tr_b16 v[38:39],v160 offset:12288
buffer_load_dwordx4 a[188:191],v11,s[60:63],s81 offen sc1
M v[108:111],v[56:59],a[232:235],v[108:111]
ds_read_b64_tr_b16 v[40:41],v160 offset:16384
ds_read_b64_tr_b16 v[42:43],v160 offset:20480
M v[108:111],v[60:63],a[236:239],v[108:111]
ds_read_b64_tr_b16 v[44:45],v160 offset:24576
ds_read_b64_tr_b16 v[46:47],v160 offset:28672
M v[124:127],v[48:51],a[240:243],v[124:127]
M v[124:127],v[52:55],a[244:247],v[124:127]
M v[124:127],v[56:59],a[248:251],v[124:127]
M v[124:127],v[60:63],a[252:255],v[124:127]
s_waitcnt vmcnt(16) lgkmcnt(0)
M v[64:67],v[32:35],a[128:131],v[64:67]
ds_read_b64_tr_b16 v[48:49],v161
ds_read_b64_tr_b16 v[50:51],v161 offset:4096
s_xor_b32 s80,s54,0xf000
M v[64:67],v[36:39],a[132:135],v[64:67]
ds_read_b64_tr_b16 v[52:53],v161 offset:8192
ds_read_b64_tr_b16 v[54:55],v161 offset:12288
buffer_load_dwordx4 a[224:227],v11,s[60:63],s80 offen sc1
M v[64:67],v[40:43],a[136:139],v[64:67]
ds_read_b64_tr_b16 v[56:57],v161 offset:16384
ds_read_b64_tr_b16 v[58:59],v161 offset:20480
M v[64:67],v[44:47],a[140:143],v[64:67]
ds_read_b64_tr_b16 v[60:61],v161 offset:24576
ds_read_b64_tr_b16 v[62:63],v161 offset:28672
M v[80:83],v[32:35],a[144:147],v[80:83]
M v[80:83],v[36:39],a[148:151],v[80:83]
s_xor_b32 s81,s54,0x2f000
M v[80:83],v[40:43],a[152:155],v[80:83]
buffer_load_dwordx4 a[240:243],v11,s[60:63],s81 offen sc1
M v[80:83],v[44:47],a[156:159],v[80:83]
s_waitcnt lgkmcnt(0)
M v[68:71],v[48:51],a[128:131],v[68:71]
ds_read_b64_tr_b16 v[32:33],v162
ds_read_b64_tr_b16 v[34:35],v162 offset:4096
M v[68:71],v[52:55],a[132:135],v[68:71]
ds_read_b64_tr_b16 v[36:37],v162 offset:8192
ds_read_b64_tr_b16 v[38:39],v162 offset:12288
M v[68:71],v[56:59],a[136:139],v[68:71]
ds_read_b64_tr_b16 v[40:41],v162 offset:16384
ds_read_b64_tr_b16 v[42:43],v162 offset:20480
s_xor_b32 s80,s55,0x1e0000
s_xor_b32 m0,s75,0x18000
M v[68:71],v[60:63],a[140:143],v[68:71]
ds_read_b64_tr_b16 v[44:45],v162 offset:24576
ds_read_b64_tr_b16 v[46:47],v162 offset:28672
buffer_load_dwordx4 v184,s[56:59],s80 offen lds
M v[84:87],v[48:51],a[144:147],v[84:87]
M v[84:87],v[52:55],a[148:151],v[84:87]
M v[84:87],v[56:59],a[152:155],v[84:87]
M v[84:87],v[60:63],a[156:159],v[84:87]
s_xor_b32 s81,s55,0x1a2000
s_xor_b32 m0,s75,0x10400
s_waitcnt lgkmcnt(0)
M v[72:75],v[32:35],a[128:131],v[72:75]
ds_read_b64_tr_b16 v[48:49],v163
ds_read_b64_tr_b16 v[50:51],v163 offset:4096
buffer_load_dwordx4 v184,s[56:59],s81 offen lds
M v[72:75],v[36:39],a[132:135],v[72:75]
ds_read_b64_tr_b16 v[52:53],v163 offset:8192
ds_read_b64_tr_b16 v[54:55],v163 offset:12288
M v[72:75],v[40:43],a[136:139],v[72:75]
ds_read_b64_tr_b16 v[56:57],v163 offset:16384
ds_read_b64_tr_b16 v[58:59],v163 offset:20480
M v[72:75],v[44:47],a[140:143],v[72:75]
ds_read_b64_tr_b16 v[60:61],v163 offset:24576
ds_read_b64_tr_b16 v[62:63],v163 offset:28672
M v[88:91],v[32:35],a[144:147],v[88:91]
s_xor_b32 s80,s55,0x1a4000
s_xor_b32 m0,s75,0x10800
M v[88:91],v[36:39],a[148:151],v[88:91]
buffer_load_dwordx4 v184,s[56:59],s80 offen lds
M v[88:91],v[40:43],a[152:155],v[88:91]
M v[88:91],v[44:47],a[156:159],v[88:91]
s_waitcnt lgkmcnt(0)
M v[76:79],v[48:51],a[128:131],v[76:79]
ds_read_b64_tr_b16 v[32:33],v164
ds_read_b64_tr_b16 v[34:35],v164 offset:4096
M v[76:79],v[52:55],a[132:135],v[76:79]
ds_read_b64_tr_b16 v[36:37],v164 offset:8192
ds_read_b64_tr_b16 v[38:39],v164 offset:12288
s_xor_b32 s81,s55,0x1a6000
s_xor_b32 m0,s75,0x10c00
M v[76:79],v[56:59],a[136:139],v[76:79]
ds_read_b64_tr_b16 v[40:41],v164 offset:16384
ds_read_b64_tr_b16 v[42:43],v164 offset:20480
buffer_load_dwordx4 v184,s[56:59],s81 offen lds
M v[76:79],v[60:63],a[140:143],v[76:79]
ds_read_b64_tr_b16 v[44:45],v164 offset:24576
ds_read_b64_tr_b16 v[46:47],v164 offset:28672
M v[92:95],v[48:51],a[144:147],v[92:95]
M v[92:95],v[52:55],a[148:151],v[92:95]
M v[92:95],v[56:59],a[152:155],v[92:95]
s_xor_b32 s80,s54,0xd400
M v[92:95],v[60:63],a[156:159],v[92:95]
buffer_load_dwordx4 a[196:199],v11,s[60:63],s80 offen sc1
s_waitcnt lgkmcnt(0)
M v[96:99],v[32:35],a[128:131],v[96:99]
ds_read_b64_tr_b16 v[48:49],v165
ds_read_b64_tr_b16 v[50:51],v165 offset:4096
M v[96:99],v[36:39],a[132:135],v[96:99]
ds_read_b64_tr_b16 v[52:53],v165 offset:8192
ds_read_b64_tr_b16 v[54:55],v165 offset:12288
M v[96:99],v[40:43],a[136:139],v[96:99]
ds_read_b64_tr_b16 v[56:57],v165 offset:16384
ds_read_b64_tr_b16 v[58:59],v165 offset:20480
M v[96:99],v[44:47],a[140:143],v[96:99]
ds_read_b64_tr_b16 v[60:61],v165 offset:24576
ds_read_b64_tr_b16 v[62:63],v165 offset:28672
s_xor_b32 s81,s54,0x2d400
M v[112:115],v[32:35],a[144:147],v[112:115]
buffer_load_dwordx4 a[212:215],v11,s[60:63],s81 offen sc1
M v[112:115],v[36:39],a[148:151],v[112:115]
M v[112:115],v[40:43],a[152:155],v[112:115]
M v[112:115],v[44:47],a[156:159],v[112:115]
s_waitcnt lgkmcnt(0)
M v[100:103],v[48:51],a[128:131],v[100:103]
ds_read_b64_tr_b16 v[32:33],v166
ds_read_b64_tr_b16 v[34:35],v166 offset:4096
s_xor_b32 s80,s54,0xd800
M v[100:103],v[52:55],a[132:135],v[100:103]
ds_read_b64_tr_b16 v[36:37],v166 offset:8192
ds_read_b64_tr_b16 v[38:39],v166 offset:12288
buffer_load_dwordx4 a[200:203],v11,s[60:63],s80 offen sc1
M v[100:103],v[56:59],a[136:139],v[100:103]
ds_read_b64_tr_b16 v[40:41],v166 offset:16384
ds_read_b64_tr_b16 v[42:43],v166 offset:20480
M v[100:103],v[60:63],a[140:143],v[100:103]
ds_read_b64_tr_b16 v[44:45],v166 offset:24576
ds_read_b64_tr_b16 v[46:47],v166 offset:28672
M v[116:119],v[48:51],a[144:147],v[116:119]
M v[116:119],v[52:55],a[148:151],v[116:119]
s_xor_b32 s81,s54,0x2d800
M v[116:119],v[56:59],a[152:155],v[116:119]
buffer_load_dwordx4 a[216:219],v11,s[60:63],s81 offen sc1
M v[116:119],v[60:63],a[156:159],v[116:119]
s_waitcnt lgkmcnt(0)
M v[104:107],v[32:35],a[128:131],v[104:107]
ds_read_b64_tr_b16 v[48:49],v167
ds_read_b64_tr_b16 v[50:51],v167 offset:4096
M v[104:107],v[36:39],a[132:135],v[104:107]
ds_read_b64_tr_b16 v[52:53],v167 offset:8192
ds_read_b64_tr_b16 v[54:55],v167 offset:12288
M v[104:107],v[40:43],a[136:139],v[104:107]
ds_read_b64_tr_b16 v[56:57],v167 offset:16384
ds_read_b64_tr_b16 v[58:59],v167 offset:20480
s_xor_b32 s80,s54,0xdc00
M v[104:107],v[44:47],a[140:143],v[104:107]
ds_read_b64_tr_b16 v[60:61],v167 offset:24576
ds_read_b64_tr_b16 v[62:63],v167 offset:28672
buffer_load_dwordx4 a[204:207],v11,s[60:63],s80 offen sc1
M v[120:123],v[32:35],a[144:147],v[120:123]
M v[120:123],v[36:39],a[148:151],v[120:123]
M v[120:123],v[40:43],a[152:155],v[120:123]
M v[120:123],v[44:47],a[156:159],v[120:123]
s_xor_b32 s81,s54,0x2dc00
s_waitcnt vmcnt(17) lgkmcnt(0)
s_barrier
M v[108:111],v[48:51],a[128:131],v[108:111]
ds_read_b64_tr_b16 v[32:33],v164 offset:32768
ds_read_b64_tr_b16 v[34:35],v164 offset:36864
buffer_load_dwordx4 a[220:223],v11,s[60:63],s81 offen sc1
M v[108:111],v[52:55],a[132:135],v[108:111]
ds_read_b64_tr_b16 v[36:37],v164 offset:40960
ds_read_b64_tr_b16 v[38:39],v164 offset:45056
M v[108:111],v[56:59],a[136:139],v[108:111]
ds_read_b64_tr_b16 v[40:41],v164 offset:49152
ds_read_b64_tr_b16 v[42:43],v164 offset:53248
M v[108:111],v[60:63],a[140:143],v[108:111]
ds_read_b64_tr_b16 v[44:45],v164 offset:57344
ds_read_b64_tr_b16 v[46:47],v164 offset:61440
M v[124:127],v[48:51],a[144:147],v[124:127]
M v[124:127],v[52:55],a[148:151],v[124:127]
M v[124:127],v[56:59],a[152:155],v[124:127]
M v[124:127],v[60:63],a[156:159],v[124:127]
s_waitcnt vmcnt(12) lgkmcnt(0)
M v[96:99],v[32:35],a[160:163],v[96:99]
ds_read_b64_tr_b16 v[48:49],v165 offset:32768
ds_read_b64_tr_b16 v[50:51],v165 offset:36864
s_xor_b32 s80,s54,0x1d000
M v[96:99],v[36:39],a[164:167],v[96:99]
ds_read_b64_tr_b16 v[52:53],v165 offset:40960
ds_read_b64_tr_b16 v[54:55],v165 offset:45056
buffer_load_dwordx4 a[128:131],v11,s[60:63],s80 offen sc1
M v[96:99],v[40:43],a[168:171],v[96:99]
ds_read_b64_tr_b16 v[56:57],v165 offset:49152
ds_read_b64_tr_b16 v[58:59],v165 offset:53248
s_xor_b32 s81,s54,0x3d000
M v[96:99],v[44:47],a[172:175],v[96:99]
ds_read_b64_tr_b16 v[60:61],v165 offset:57344
ds_read_b64_tr_b16 v[62:63],v165 offset:61440
buffer_load_dwordx4 a[144:147],v11,s[60:63],s81 offen sc1
M v[112:115],v[32:35],a[176:179],v[112:115]
M v[112:115],v[36:39],a[180:183],v[112:115]
s_xor_b32 s80,s55,0x3a0000
s_xor_b32 m0,s75,0
M v[112:115],v[40:43],a[184:187],v[112:115]
buffer_load_dwordx4 v184,s[56:59],s80 offen lds
M v[112:115],v[44:47],a[188:191],v[112:115]
s_waitcnt lgkmcnt(0)
M v[100:103],v[48:51],a[160:163],v[100:103]
ds_read_b64_tr_b16 v[32:33],v166 offset:32768
ds_read_b64_tr_b16 v[34:35],v166 offset:36864
s_xor_b32 s81,s55,0x1e2000
s_xor_b32 m0,s75,0x18400
M v[100:103],v[52:55],a[164:167],v[100:103]
ds_read_b64_tr_b16 v[36:37],v166 offset:40960
ds_read_b64_tr_b16 v[38:39],v166 offset:45056
buffer_load_dwordx4 v184,s[56:59],s81 offen lds
M v[100:103],v[56:59],a[168:171],v[100:103]
ds_read_b64_tr_b16 v[40:41],v166 offset:49152
ds_read_b64_tr_b16 v[42:43],v166 offset:53248
s_xor_b32 s80,s55,0x1e4000
s_xor_b32 m0,s75,0x18800
M v[100:103],v[60:63],a[172:175],v[100:103]
ds_read_b64_tr_b16 v[44:45],v166 offset:57344
ds_read_b64_tr_b16 v[46:47],v166 offset:61440
buffer_load_dwordx4 v184,s[56:59],s80 offen lds
M v[116:119],v[48:51],a[176:179],v[116:119]
M v[116:119],v[52:55],a[180:183],v[116:119]
s_xor_b32 s81,s55,0x1e6000
s_xor_b32 m0,s75,0x18c00
M v[116:119],v[56:59],a[184:187],v[116:119]
buffer_load_dwordx4 v184,s[56:59],s81 offen lds
M v[116:119],v[60:63],a[188:191],v[116:119]
s_waitcnt lgkmcnt(0)
M v[104:107],v[32:35],a[160:163],v[104:107]
ds_read_b64_tr_b16 v[48:49],v167 offset:32768
ds_read_b64_tr_b16 v[50:51],v167 offset:36864
s_xor_b32 s80,s54,0xf400
M v[104:107],v[36:39],a[164:167],v[104:107]
ds_read_b64_tr_b16 v[52:53],v167 offset:40960
ds_read_b64_tr_b16 v[54:55],v167 offset:45056
buffer_load_dwordx4 a[228:231],v11,s[60:63],s80 offen sc1
M v[104:107],v[40:43],a[168:171],v[104:107]
ds_read_b64_tr_b16 v[56:57],v167 offset:49152
ds_read_b64_tr_b16 v[58:59],v167 offset:53248
s_xor_b32 s81,s54,0x2f400
M v[104:107],v[44:47],a[172:175],v[104:107]
ds_read_b64_tr_b16 v[60:61],v167 offset:57344
ds_read_b64_tr_b16 v[62:63],v167 offset:61440
buffer_load_dwordx4 a[244:247],v11,s[60:63],s81 offen sc1
M v[120:123],v[32:35],a[176:179],v[120:123]
M v[120:123],v[36:39],a[180:183],v[120:123]
s_xor_b32 s80,s54,0xf800
M v[120:123],v[40:43],a[184:187],v[120:123]
buffer_load_dwordx4 a[232:235],v11,s[60:63],s80 offen sc1
M v[120:123],v[44:47],a[188:191],v[120:123]
s_waitcnt lgkmcnt(0)
M v[108:111],v[48:51],a[160:163],v[108:111]
ds_read_b64_tr_b16 v[32:33],v160 offset:32768
ds_read_b64_tr_b16 v[34:35],v160 offset:36864
s_xor_b32 s81,s54,0x2f800
M v[108:111],v[52:55],a[164:167],v[108:111]
ds_read_b64_tr_b16 v[36:37],v160 offset:40960
ds_read_b64_tr_b16 v[38:39],v160 offset:45056
buffer_load_dwordx4 a[248:251],v11,s[60:63],s81 offen sc1
v_cvt_pk_bf16_f32 v216,v96,v97
M v[108:111],v[56:59],a[168:171],v[108:111]
ds_read_b64_tr_b16 v[40:41],v160 offset:49152
ds_read_b64_tr_b16 v[42:43],v160 offset:53248
s_xor_b32 s80,s54,0xfc00
v_cvt_pk_bf16_f32 v217,v98,v99
M v[108:111],v[60:63],a[172:175],v[108:111]
ds_read_b64_tr_b16 v[44:45],v160 offset:57344
ds_read_b64_tr_b16 v[46:47],v160 offset:61440
buffer_load_dwordx4 a[236:239],v11,s[60:63],s80 offen sc1
v_cvt_pk_bf16_f32 v218,v100,v101
M v[124:127],v[48:51],a[176:179],v[124:127]
v_cvt_pk_bf16_f32 v219,v102,v103
M v[124:127],v[52:55],a[180:183],v[124:127]
s_xor_b32 s81,s54,0x2fc00
M v[124:127],v[56:59],a[184:187],v[124:127]
buffer_load_dwordx4 a[252:255],v11,s[60:63],s81 offen sc1
buffer_store_dwordx4 v[216:219],v11,s[64:67],s76 offen sc1
M v[124:127],v[60:63],a[188:191],v[124:127]
v_cvt_pk_bf16_f32 v220,v112,v113
s_waitcnt lgkmcnt(0)
M v[64:67],v[32:35],a[160:163],v[64:67]
ds_read_b64_tr_b16 v[48:49],v161 offset:32768
ds_read_b64_tr_b16 v[50:51],v161 offset:36864
v_cvt_pk_bf16_f32 v221,v114,v115
M v[64:67],v[36:39],a[164:167],v[64:67]
ds_read_b64_tr_b16 v[52:53],v161 offset:40960
ds_read_b64_tr_b16 v[54:55],v161 offset:45056
v_cvt_pk_bf16_f32 v222,v116,v117
v_cvt_pk_bf16_f32 v224,v104,v105
M v[64:67],v[40:43],a[168:171],v[64:67]
ds_read_b64_tr_b16 v[56:57],v161 offset:49152
ds_read_b64_tr_b16 v[58:59],v161 offset:53248
v_cvt_pk_bf16_f32 v223,v118,v119
v_cvt_pk_bf16_f32 v225,v106,v107
M v[64:67],v[44:47],a[172:175],v[64:67]
ds_read_b64_tr_b16 v[60:61],v161 offset:57344
ds_read_b64_tr_b16 v[62:63],v161 offset:61440
v_cvt_pk_bf16_f32 v226,v108,v109
M v[80:83],v[32:35],a[176:179],v[80:83]
buffer_store_dwordx4 v[220:223],v11,s[64:67],s76 offen offset:2048 sc1
v_cvt_pk_bf16_f32 v227,v110,v111
M v[80:83],v[36:39],a[180:183],v[80:83]
M v[80:83],v[40:43],a[184:187],v[80:83]
buffer_store_dwordx4 v[224:227],v11,s[64:67],s76 offen offset:1024 sc1
M v[80:83],v[44:47],a[188:191],v[80:83]
v_cvt_pk_bf16_f32 v228,v120,v121
s_waitcnt lgkmcnt(0)
M v[68:71],v[48:51],a[160:163],v[68:71]
ds_read_b64_tr_b16 v[32:33],v162 offset:32768
ds_read_b64_tr_b16 v[34:35],v162 offset:36864
v_cvt_pk_bf16_f32 v229,v122,v123
M v[68:71],v[52:55],a[164:167],v[68:71]
ds_read_b64_tr_b16 v[36:37],v162 offset:40960
ds_read_b64_tr_b16 v[38:39],v162 offset:45056
v_cvt_pk_bf16_f32 v230,v124,v125
M v[68:71],v[56:59],a[168:171],v[68:71]
ds_read_b64_tr_b16 v[40:41],v162 offset:49152
ds_read_b64_tr_b16 v[42:43],v162 offset:53248
v_cvt_pk_bf16_f32 v231,v126,v127
M v[68:71],v[60:63],a[172:175],v[68:71]
ds_read_b64_tr_b16 v[44:45],v162 offset:57344
ds_read_b64_tr_b16 v[46:47],v162 offset:61440
M v[84:87],v[48:51],a[176:179],v[84:87]
buffer_store_dwordx4 v[228:231],v11,s[64:67],s76 offen offset:3072 sc1
M v[84:87],v[52:55],a[180:183],v[84:87]
M v[84:87],v[56:59],a[184:187],v[84:87]
M v[84:87],v[60:63],a[188:191],v[84:87]
s_waitcnt lgkmcnt(0)
M v[72:75],v[32:35],a[160:163],v[72:75]
ds_read_b64_tr_b16 v[48:49],v163 offset:32768
ds_read_b64_tr_b16 v[50:51],v163 offset:36864
M v[72:75],v[36:39],a[164:167],v[72:75]
ds_read_b64_tr_b16 v[52:53],v163 offset:40960
ds_read_b64_tr_b16 v[54:55],v163 offset:45056
M v[72:75],v[40:43],a[168:171],v[72:75]
ds_read_b64_tr_b16 v[56:57],v163 offset:49152
ds_read_b64_tr_b16 v[58:59],v163 offset:53248
M v[72:75],v[44:47],a[172:175],v[72:75]
ds_read_b64_tr_b16 v[60:61],v163 offset:57344
ds_read_b64_tr_b16 v[62:63],v163 offset:61440
M v[88:91],v[32:35],a[176:179],v[88:91]
M v[88:91],v[36:39],a[180:183],v[88:91]
M v[88:91],v[40:43],a[184:187],v[88:91]
M v[88:91],v[44:47],a[188:191],v[88:91]
s_waitcnt vmcnt(22) lgkmcnt(0)
s_barrier
M v[76:79],v[48:51],a[160:163],v[76:79]
ds_read_b64_tr_b16 v[32:33],v180
ds_read_b64_tr_b16 v[34:35],v180 offset:2048
M v[76:79],v[52:55],a[164:167],v[76:79]
ds_read_b64_tr_b16 v[36:37],v180 offset:4096
ds_read_b64_tr_b16 v[38:39],v180 offset:6144
M v[76:79],v[56:59],a[168:171],v[76:79]
ds_read_b64_tr_b16 v[40:41],v180 offset:8192
ds_read_b64_tr_b16 v[42:43],v180 offset:10240
M v[76:79],v[60:63],a[172:175],v[76:79]
ds_read_b64_tr_b16 v[44:45],v180 offset:12288
ds_read_b64_tr_b16 v[46:47],v180 offset:14336
M v[92:95],v[48:51],a[176:179],v[92:95]
M v[92:95],v[52:55],a[180:183],v[92:95]
M v[92:95],v[56:59],a[184:187],v[92:95]
M v[92:95],v[60:63],a[188:191],v[92:95]
s_waitcnt vmcnt(16) lgkmcnt(0)
M v[64:67],v[32:35],a[192:195],v[64:67]
ds_read_b64_tr_b16 v[48:49],v181
ds_read_b64_tr_b16 v[50:51],v181 offset:2048
s_xor_b32 s80,s54,0x1f000
M v[64:67],v[36:39],a[196:199],v[64:67]
ds_read_b64_tr_b16 v[52:53],v181 offset:4096
ds_read_b64_tr_b16 v[54:55],v181 offset:6144
buffer_load_dwordx4 a[160:163],v11,s[60:63],s80 offen sc1
M v[64:67],v[40:43],a[200:203],v[64:67]
ds_read_b64_tr_b16 v[56:57],v181 offset:8192
ds_read_b64_tr_b16 v[58:59],v181 offset:10240
s_xor_b32 s81,s54,0x3f000
M v[64:67],v[44:47],a[204:207],v[64:67]
ds_read_b64_tr_b16 v[60:61],v181 offset:12288
ds_read_b64_tr_b16 v[62:63],v181 offset:14336
buffer_load_dwordx4 a[176:179],v11,s[60:63],s81 offen sc1
M v[80:83],v[32:35],a[208:211],v[80:83]
s_xor_b32 s80,s55,0x3e0000
s_xor_b32 m0,s75,0x8000
M v[80:83],v[36:39],a[212:215],v[80:83]
buffer_load_dwordx4 v184,s[56:59],s80 offen lds
M v[80:83],v[40:43],a[216:219],v[80:83]
M v[80:83],v[44:47],a[220:223],v[80:83]
s_xor_b32 s81,s55,0x3a2000
s_xor_b32 m0,s75,0x400
s_waitcnt lgkmcnt(0)
M v[68:71],v[48:51],a[192:195],v[68:71]
ds_read_b64_tr_b16 v[32:33],v182
ds_read_b64_tr_b16 v[34:35],v182 offset:2048
buffer_load_dwordx4 v184,s[56:59],s81 offen lds
M v[68:71],v[52:55],a[196:199],v[68:71]
ds_read_b64_tr_b16 v[36:37],v182 offset:4096
ds_read_b64_tr_b16 v[38:39],v182 offset:6144
s_xor_b32 s80,s55,0x3a4000
s_xor_b32 m0,s75,0x800
M v[68:71],v[56:59],a[200:203],v[68:71]
ds_read_b64_tr_b16 v[40:41],v182 offset:8192
ds_read_b64_tr_b16 v[42:43],v182 offset:10240
buffer_load_dwordx4 v184,s[56:59],s80 offen lds
M v[68:71],v[60:63],a[204:207],v[68:71]
ds_read_b64_tr_b16 v[44:45],v182 offset:12288
ds_read_b64_tr_b16 v[46:47],v182 offset:14336
s_xor_b32 s81,s55,0x3a6000
s_xor_b32 m0,s75,0xc00
M v[84:87],v[48:51],a[208:211],v[84:87]
buffer_load_dwordx4 v184,s[56:59],s81 offen lds
M v[84:87],v[52:55],a[212:215],v[84:87]
M v[84:87],v[56:59],a[216:219],v[84:87]
s_xor_b32 s80,s54,0x1d400
M v[84:87],v[60:63],a[220:223],v[84:87]
buffer_load_dwordx4 a[132:135],v11,s[60:63],s80 offen sc1
s_waitcnt lgkmcnt(0)
M v[72:75],v[32:35],a[192:195],v[72:75]
ds_read_b64_tr_b16 v[48:49],v183
ds_read_b64_tr_b16 v[50:51],v183 offset:2048
s_xor_b32 s81,s54,0x3d400
M v[72:75],v[36:39],a[196:199],v[72:75]
ds_read_b64_tr_b16 v[52:53],v183 offset:4096
ds_read_b64_tr_b16 v[54:55],v183 offset:6144
buffer_load_dwordx4 a[148:151],v11,s[60:63],s81 offen sc1
M v[72:75],v[40:43],a[200:203],v[72:75]
ds_read_b64_tr_b16 v[56:57],v183 offset:8192
ds_read_b64_tr_b16 v[58:59],v183 offset:10240
s_xor_b32 s80,s54,0x1d800
M v[72:75],v[44:47],a[204:207],v[72:75]
ds_read_b64_tr_b16 v[60:61],v183 offset:12288
ds_read_b64_tr_b16 v[62:63],v183 offset:14336
buffer_load_dwordx4 a[136:139],v11,s[60:63],s80 offen sc1
M v[88:91],v[32:35],a[208:211],v[88:91]
M v[88:91],v[36:39],a[212:215],v[88:91]
s_xor_b32 s81,s54,0x3d800
M v[88:91],v[40:43],a[216:219],v[88:91]
buffer_load_dwordx4 a[152:155],v11,s[60:63],s81 offen sc1
M v[88:91],v[44:47],a[220:223],v[88:91]
s_xor_b32 s80,s54,0x1dc00
s_waitcnt vmcnt(10) lgkmcnt(0)
s_barrier
M v[76:79],v[48:51],a[192:195],v[76:79]
ds_read_b64_tr_b16 v[32:33],v180 offset:32768
ds_read_b64_tr_b16 v[34:35],v180 offset:34816
buffer_load_dwordx4 a[140:143],v11,s[60:63],s80 offen sc1
M v[76:79],v[52:55],a[196:199],v[76:79]
ds_read_b64_tr_b16 v[36:37],v180 offset:36864
ds_read_b64_tr_b16 v[38:39],v180 offset:38912
s_xor_b32 s81,s54,0x3dc00
M v[76:79],v[56:59],a[200:203],v[76:79]
ds_read_b64_tr_b16 v[40:41],v180 offset:40960
ds_read_b64_tr_b16 v[42:43],v180 offset:43008
buffer_load_dwordx4 a[156:159],v11,s[60:63],s81 offen sc1
M v[76:79],v[60:63],a[204:207],v[76:79]
ds_read_b64_tr_b16 v[44:45],v180 offset:45056
ds_read_b64_tr_b16 v[46:47],v180 offset:47104
M v[92:95],v[48:51],a[208:211],v[92:95]
buffer_store_dword v186,v14,s[64:67],s78 offen sc1
M v[92:95],v[52:55],a[212:215],v[92:95]
M v[92:95],v[56:59],a[216:219],v[92:95]
M v[92:95],v[60:63],a[220:223],v[92:95]
s_waitcnt lgkmcnt(0)
M v[64:67],v[32:35],a[224:227],v[64:67]
ds_read_b64_tr_b16 v[48:49],v181 offset:32768
ds_read_b64_tr_b16 v[50:51],v181 offset:34816
M v[64:67],v[36:39],a[228:231],v[64:67]
ds_read_b64_tr_b16 v[52:53],v181 offset:36864
ds_read_b64_tr_b16 v[54:55],v181 offset:38912
buffer_load_dword v15,v28,s[64:67],s79 offen sc1
M v[64:67],v[40:43],a[232:235],v[64:67]
ds_read_b64_tr_b16 v[56:57],v181 offset:40960
ds_read_b64_tr_b16 v[58:59],v181 offset:43008
s_xor_b32 s80,s55,0x3e2000
s_xor_b32 m0,s75,0x8400
M v[64:67],v[44:47],a[236:239],v[64:67]
ds_read_b64_tr_b16 v[60:61],v181 offset:45056
ds_read_b64_tr_b16 v[62:63],v181 offset:47104
buffer_load_dwordx4 v184,s[56:59],s80 offen lds
M v[80:83],v[32:35],a[240:243],v[80:83]
M v[80:83],v[36:39],a[244:247],v[80:83]
s_xor_b32 s81,s55,0x3e4000
s_xor_b32 m0,s75,0x8800
M v[80:83],v[40:43],a[248:251],v[80:83]
buffer_load_dwordx4 v184,s[56:59],s81 offen lds
M v[80:83],v[44:47],a[252:255],v[80:83]
s_waitcnt lgkmcnt(0)
M v[68:71],v[48:51],a[224:227],v[68:71]
ds_read_b64_tr_b16 v[32:33],v182 offset:32768
ds_read_b64_tr_b16 v[34:35],v182 offset:34816
s_xor_b32 s80,s55,0x3e6000
s_xor_b32 m0,s75,0x8c00
M v[68:71],v[52:55],a[228:231],v[68:71]
ds_read_b64_tr_b16 v[36:37],v182 offset:36864
ds_read_b64_tr_b16 v[38:39],v182 offset:38912
buffer_load_dwordx4 v184,s[56:59],s80 offen lds
M v[68:71],v[56:59],a[232:235],v[68:71]
ds_read_b64_tr_b16 v[40:41],v182 offset:40960
ds_read_b64_tr_b16 v[42:43],v182 offset:43008
M v[68:71],v[60:63],a[236:239],v[68:71]
ds_read_b64_tr_b16 v[44:45],v182 offset:45056
ds_read_b64_tr_b16 v[46:47],v182 offset:47104
s_xor_b32 s81,s54,0x1f400
M v[84:87],v[48:51],a[240:243],v[84:87]
buffer_load_dwordx4 a[164:167],v11,s[60:63],s81 offen sc1
M v[84:87],v[52:55],a[244:247],v[84:87]
M v[84:87],v[56:59],a[248:251],v[84:87]
s_xor_b32 s80,s54,0x3f400
M v[84:87],v[60:63],a[252:255],v[84:87]
buffer_load_dwordx4 a[180:183],v11,s[60:63],s80 offen sc1
s_waitcnt lgkmcnt(0)
M v[72:75],v[32:35],a[224:227],v[72:75]
ds_read_b64_tr_b16 v[48:49],v183 offset:32768
ds_read_b64_tr_b16 v[50:51],v183 offset:34816
s_xor_b32 s81,s54,0x1f800
M v[72:75],v[36:39],a[228:231],v[72:75]
ds_read_b64_tr_b16 v[52:53],v183 offset:36864
ds_read_b64_tr_b16 v[54:55],v183 offset:38912
buffer_load_dwordx4 a[168:171],v11,s[60:63],s81 offen sc1
M v[72:75],v[40:43],a[232:235],v[72:75]
ds_read_b64_tr_b16 v[56:57],v183 offset:40960
ds_read_b64_tr_b16 v[58:59],v183 offset:43008
M v[72:75],v[44:47],a[236:239],v[72:75]
ds_read_b64_tr_b16 v[60:61],v183 offset:45056
ds_read_b64_tr_b16 v[62:63],v183 offset:47104
s_xor_b32 s80,s54,0x3f800
M v[88:91],v[32:35],a[240:243],v[88:91]
buffer_load_dwordx4 a[184:187],v11,s[60:63],s80 offen sc1
M v[88:91],v[36:39],a[244:247],v[88:91]
M v[88:91],v[40:43],a[248:251],v[88:91]
s_xor_b32 s81,s54,0x1fc00
M v[88:91],v[44:47],a[252:255],v[88:91]
buffer_load_dwordx4 a[172:175],v11,s[60:63],s81 offen sc1
s_waitcnt vmcnt(16) lgkmcnt(0)
s_barrier
M v[76:79],v[48:51],a[224:227],v[76:79]
ds_read_b64_tr_b16 v[32:33],v176
ds_read_b64_tr_b16 v[34:35],v176 offset:2048
M v[76:79],v[52:55],a[228:231],v[76:79]
ds_read_b64_tr_b16 v[36:37],v176 offset:4096
ds_read_b64_tr_b16 v[38:39],v176 offset:6144
s_xor_b32 s80,s54,0x3fc00
M v[76:79],v[56:59],a[232:235],v[76:79]
ds_read_b64_tr_b16 v[40:41],v176 offset:8192
ds_read_b64_tr_b16 v[42:43],v176 offset:10240
buffer_load_dwordx4 a[188:191],v11,s[60:63],s80 offen sc1
M v[76:79],v[60:63],a[236:239],v[76:79]
ds_read_b64_tr_b16 v[44:45],v176 offset:12288
ds_read_b64_tr_b16 v[46:47],v176 offset:14336
M v[92:95],v[48:51],a[240:243],v[92:95]
M v[92:95],v[52:55],a[244:247],v[92:95]
M v[92:95],v[56:59],a[248:251],v[92:95]
M v[92:95],v[60:63],a[252:255],v[92:95]
s_waitcnt vmcnt(9)
v_readfirstlane_b32 s80,v15
s_nop 0
s_cmp_eq_u32 s80,1
s_cbranch_scc0 K2F_PAIR_SPIN
K2F_PAIR_BACK:
s_waitcnt lgkmcnt(0)
M v[64:67],v[32:35],a[128:131],v[64:67]
ds_read_b64_tr_b16 v[48:49],v177
ds_read_b64_tr_b16 v[50:51],v177 offset:2048
M v[64:67],v[36:39],a[132:135],v[64:67]
ds_read_b64_tr_b16 v[52:53],v177 offset:4096
ds_read_b64_tr_b16 v[54:55],v177 offset:6144
buffer_load_dwordx4 v[96:99],v11,s[64:67],s77 offen sc1
M v[64:67],v[40:43],a[136:139],v[64:67]
ds_read_b64_tr_b16 v[56:57],v177 offset:8192
ds_read_b64_tr_b16 v[58:59],v177 offset:10240
M v[64:67],v[44:47],a[140:143],v[64:67]
ds_read_b64_tr_b16 v[60:61],v177 offset:12288
ds_read_b64_tr_b16 v[62:63],v177 offset:14336
M v[80:83],v[32:35],a[144:147],v[80:83]
buffer_load_dwordx4 v[104:107],v11,s[64:67],s77 offen offset:1024 sc1
M v[80:83],v[36:39],a[148:151],v[80:83]
M v[80:83],v[40:43],a[152:155],v[80:83]
M v[80:83],v[44:47],a[156:159],v[80:83]
buffer_load_dwordx4 v[112:115],v11,s[64:67],s77 offen offset:2048 sc1
s_waitcnt lgkmcnt(0)
M v[68:71],v[48:51],a[128:131],v[68:71]
ds_read_b64_tr_b16 v[32:33],v178
ds_read_b64_tr_b16 v[34:35],v178 offset:2048
M v[68:71],v[52:55],a[132:135],v[68:71]
ds_read_b64_tr_b16 v[36:37],v178 offset:4096
ds_read_b64_tr_b16 v[38:39],v178 offset:6144
M v[68:71],v[56:59],a[136:139],v[68:71]
ds_read_b64_tr_b16 v[40:41],v178 offset:8192
ds_read_b64_tr_b16 v[42:43],v178 offset:10240
buffer_load_dwordx4 v[120:123],v11,s[64:67],s77 offen offset:3072 sc1
M v[68:71],v[60:63],a[140:143],v[68:71]
ds_read_b64_tr_b16 v[44:45],v178 offset:12288
ds_read_b64_tr_b16 v[46:47],v178 offset:14336
M v[84:87],v[48:51],a[144:147],v[84:87]
M v[84:87],v[52:55],a[148:151],v[84:87]
M v[84:87],v[56:59],a[152:155],v[84:87]
M v[84:87],v[60:63],a[156:159],v[84:87]
s_waitcnt lgkmcnt(0)
M v[72:75],v[32:35],a[128:131],v[72:75]
ds_read_b64_tr_b16 v[48:49],v179
ds_read_b64_tr_b16 v[50:51],v179 offset:2048
M v[72:75],v[36:39],a[132:135],v[72:75]
ds_read_b64_tr_b16 v[52:53],v179 offset:4096
ds_read_b64_tr_b16 v[54:55],v179 offset:6144
M v[72:75],v[40:43],a[136:139],v[72:75]
ds_read_b64_tr_b16 v[56:57],v179 offset:8192
ds_read_b64_tr_b16 v[58:59],v179 offset:10240
M v[72:75],v[44:47],a[140:143],v[72:75]
ds_read_b64_tr_b16 v[60:61],v179 offset:12288
ds_read_b64_tr_b16 v[62:63],v179 offset:14336
M v[88:91],v[32:35],a[144:147],v[88:91]
M v[88:91],v[36:39],a[148:151],v[88:91]
M v[88:91],v[40:43],a[152:155],v[88:91]
M v[88:91],v[44:47],a[156:159],v[88:91]
s_waitcnt vmcnt(10) lgkmcnt(0)
s_barrier
M v[76:79],v[48:51],a[128:131],v[76:79]
ds_read_b64_tr_b16 v[32:33],v176 offset:32768
ds_read_b64_tr_b16 v[34:35],v176 offset:34816
M v[76:79],v[52:55],a[132:135],v[76:79]
ds_read_b64_tr_b16 v[36:37],v176 offset:36864
ds_read_b64_tr_b16 v[38:39],v176 offset:38912
M v[76:79],v[56:59],a[136:139],v[76:79]
ds_read_b64_tr_b16 v[40:41],v176 offset:40960
ds_read_b64_tr_b16 v[42:43],v176 offset:43008
M v[76:79],v[60:63],a[140:143],v[76:79]
ds_read_b64_tr_b16 v[44:45],v176 offset:45056
ds_read_b64_tr_b16 v[46:47],v176 offset:47104
M v[92:95],v[48:51],a[144:147],v[92:95]
M v[92:95],v[52:55],a[148:151],v[92:95]
M v[92:95],v[56:59],a[152:155],v[92:95]
M v[92:95],v[60:63],a[156:159],v[92:95]
s_waitcnt vmcnt(4) lgkmcnt(0)
M v[64:67],v[32:35],a[160:163],v[64:67]
ds_read_b64_tr_b16 v[48:49],v177 offset:32768
ds_read_b64_tr_b16 v[50:51],v177 offset:34816
M v[64:67],v[36:39],a[164:167],v[64:67]
ds_read_b64_tr_b16 v[52:53],v177 offset:36864
ds_read_b64_tr_b16 v[54:55],v177 offset:38912
M v[64:67],v[40:43],a[168:171],v[64:67]
ds_read_b64_tr_b16 v[56:57],v177 offset:40960
ds_read_b64_tr_b16 v[58:59],v177 offset:43008
M v[64:67],v[44:47],a[172:175],v[64:67]
ds_read_b64_tr_b16 v[60:61],v177 offset:45056
ds_read_b64_tr_b16 v[62:63],v177 offset:47104
M v[80:83],v[32:35],a[176:179],v[80:83]
M v[80:83],v[36:39],a[180:183],v[80:83]
M v[80:83],v[40:43],a[184:187],v[80:83]
M v[80:83],v[44:47],a[188:191],v[80:83]
s_waitcnt lgkmcnt(0)
M v[68:71],v[48:51],a[160:163],v[68:71]
ds_read_b64_tr_b16 v[32:33],v178 offset:32768
ds_read_b64_tr_b16 v[34:35],v178 offset:34816
M v[68:71],v[52:55],a[164:167],v[68:71]
ds_read_b64_tr_b16 v[36:37],v178 offset:36864
ds_read_b64_tr_b16 v[38:39],v178 offset:38912
M v[68:71],v[56:59],a[168:171],v[68:71]
ds_read_b64_tr_b16 v[40:41],v178 offset:40960
ds_read_b64_tr_b16 v[42:43],v178 offset:43008
M v[68:71],v[60:63],a[172:175],v[68:71]
ds_read_b64_tr_b16 v[44:45],v178 offset:45056
ds_read_b64_tr_b16 v[46:47],v178 offset:47104
M v[84:87],v[48:51],a[176:179],v[84:87]
M v[84:87],v[52:55],a[180:183],v[84:87]
M v[84:87],v[56:59],a[184:187],v[84:87]
M v[84:87],v[60:63],a[188:191],v[84:87]
s_waitcnt lgkmcnt(0)
M v[72:75],v[32:35],a[160:163],v[72:75]
ds_read_b64_tr_b16 v[48:49],v179 offset:32768
ds_read_b64_tr_b16 v[50:51],v179 offset:34816
M v[72:75],v[36:39],a[164:167],v[72:75]
ds_read_b64_tr_b16 v[52:53],v179 offset:36864
ds_read_b64_tr_b16 v[54:55],v179 offset:38912
M v[72:75],v[40:43],a[168:171],v[72:75]
ds_read_b64_tr_b16 v[56:57],v179 offset:40960
ds_read_b64_tr_b16 v[58:59],v179 offset:43008
M v[72:75],v[44:47],a[172:175],v[72:75]
ds_read_b64_tr_b16 v[60:61],v179 offset:45056
ds_read_b64_tr_b16 v[62:63],v179 offset:47104
M v[88:91],v[32:35],a[176:179],v[88:91]
M v[88:91],v[36:39],a[180:183],v[88:91]
M v[88:91],v[40:43],a[184:187],v[88:91]
M v[88:91],v[44:47],a[188:191],v[88:91]
s_waitcnt lgkmcnt(0)
M v[76:79],v[48:51],a[160:163],v[76:79]
M v[76:79],v[52:55],a[164:167],v[76:79]
M v[76:79],v[56:59],a[168:171],v[76:79]
M v[76:79],v[60:63],a[172:175],v[76:79]
M v[92:95],v[48:51],a[176:179],v[92:95]
M v[92:95],v[52:55],a[180:183],v[92:95]
M v[92:95],v[56:59],a[184:187],v[92:95]
M v[92:95],v[60:63],a[188:191],v[92:95]
s_mov_b32 s80,32768
s_waitcnt vmcnt(3)
M v[64:67],v[210:213],v[96:99],v[64:67]
M v[68:71],v[208:211],v[96:99],v[68:71]
s_waitcnt vmcnt(2)
M v[72:75],v[210:213],v[104:107],v[72:75]
M v[76:79],v[208:211],v[104:107],v[76:79]
s_waitcnt vmcnt(1)
M v[80:83],v[210:213],v[112:115],v[80:83]
M v[84:87],v[208:211],v[112:115],v[84:87]
s_waitcnt vmcnt(0)
M v[88:91],v[210:213],v[120:123],v[88:91]
M v[92:95],v[208:211],v[120:123],v[92:95]
v_cvt_pk_bf16_f32 v128,v64,v65
v_cvt_pk_bf16_f32 v129,v66,v67
v_cvt_pk_bf16_f32 v130,v68,v69
v_cvt_pk_bf16_f32 v131,v70,v71
s_nop 0
v_permlane32_swap_b32 v128,v130
v_permlane32_swap_b32 v129,v131
s_nop 0
v_permlane16_swap_b32 v128,v130
v_permlane16_swap_b32 v129,v131
buffer_store_dwordx4 v[128:131],v185,s[68:71],0 offen nt
v_cvt_pk_bf16_f32 v132,v72,v73
v_cvt_pk_bf16_f32 v133,v74,v75
v_cvt_pk_bf16_f32 v134,v76,v77
v_cvt_pk_bf16_f32 v135,v78,v79
s_nop 0
v_permlane32_swap_b32 v132,v134
v_permlane32_swap_b32 v133,v135
s_nop 0
v_permlane16_swap_b32 v132,v134
v_permlane16_swap_b32 v133,v135
buffer_store_dwordx4 v[132:135],v185,s[68:71],0 offen offset:64 nt
v_cvt_pk_bf16_f32 v136,v80,v81
v_cvt_pk_bf16_f32 v137,v82,v83
v_cvt_pk_bf16_f32 v138,v84,v85
v_cvt_pk_bf16_f32 v139,v86,v87
s_nop 0
v_permlane32_swap_b32 v136,v138
v_permlane32_swap_b32 v137,v139
s_nop 0
v_permlane16_swap_b32 v136,v138
v_permlane16_swap_b32 v137,v139
buffer_store_dwordx4 v[136:139],v185,s[68:71],s80 offen nt
v_cvt_pk_bf16_f32 v140,v88,v89
v_cvt_pk_bf16_f32 v141,v90,v91
v_cvt_pk_bf16_f32 v142,v92,v93
v_cvt_pk_bf16_f32 v143,v94,v95
s_nop 0
v_permlane32_swap_b32 v140,v142
v_permlane32_swap_b32 v141,v143
s_nop 0
v_permlane16_swap_b32 v140,v142
v_permlane16_swap_b32 v141,v143
buffer_store_dwordx4 v[140:143],v185,s[68:71],s80 offen offset:64 nt
s_endpgm
K2F_EXIT:
v_accvgpr_read_b32 v128,a0
v_accvgpr_read_b32 v129,a1
v_accvgpr_read_b32 v130,a2
v_accvgpr_read_b32 v131,a3
v_accvgpr_read_b32 v132,a4
v_accvgpr_read_b32 v133,a5
v_accvgpr_read_b32 v134,a6
v_accvgpr_read_b32 v135,a7
v_mul_f32 v128,v4,v128
v_mul_f32 v129,v4,v129
v_mul_f32 v130,v4,v130
v_mul_f32 v131,v4,v131
v_mul_f32 v132,v4,v132
v_mul_f32 v133,v4,v133
v_mul_f32 v134,v4,v134
v_mul_f32 v135,v4,v135
v_cvt_pk_bf16_f32 v144,v128,v129
v_cvt_pk_bf16_f32 v145,v130,v131
v_cvt_pk_bf16_f32 v146,v132,v133
v_cvt_pk_bf16_f32 v147,v134,v135
buffer_store_dwordx4 v[144:147],v20,s[20:23],s44 offen sc1
v_accvgpr_read_b32 v136,a8
v_accvgpr_read_b32 v137,a9
v_accvgpr_read_b32 v138,a10
v_accvgpr_read_b32 v139,a11
v_accvgpr_read_b32 v140,a12
v_accvgpr_read_b32 v141,a13
v_accvgpr_read_b32 v142,a14
v_accvgpr_read_b32 v143,a15
v_mul_f32 v136,v4,v136
v_mul_f32 v137,v4,v137
v_mul_f32 v138,v4,v138
v_mul_f32 v139,v4,v139
v_mul_f32 v140,v4,v140
v_mul_f32 v141,v4,v141
v_mul_f32 v142,v4,v142
v_mul_f32 v143,v4,v143
v_cvt_pk_bf16_f32 v148,v136,v137
v_cvt_pk_bf16_f32 v149,v138,v139
v_cvt_pk_bf16_f32 v150,v140,v141
v_cvt_pk_bf16_f32 v151,v142,v143
buffer_store_dwordx4 v[148:151],v20,s[20:23],s44 offen offset:1024 sc1
v_accvgpr_read_b32 v128,a16
v_accvgpr_read_b32 v129,a17
v_accvgpr_read_b32 v130,a18
v_accvgpr_read_b32 v131,a19
v_accvgpr_read_b32 v132,a20
v_accvgpr_read_b32 v133,a21
v_accvgpr_read_b32 v134,a22
v_accvgpr_read_b32 v135,a23
v_mul_f32 v128,v4,v128
v_mul_f32 v129,v4,v129
v_mul_f32 v130,v4,v130
v_mul_f32 v131,v4,v131
v_mul_f32 v132,v4,v132
v_mul_f32 v133,v4,v133
v_mul_f32 v134,v4,v134
v_mul_f32 v135,v4,v135
v_cvt_pk_bf16_f32 v152,v128,v129
v_cvt_pk_bf16_f32 v153,v130,v131
v_cvt_pk_bf16_f32 v154,v132,v133
v_cvt_pk_bf16_f32 v155,v134,v135
buffer_store_dwordx4 v[152:155],v20,s[20:23],s44 offen offset:2048 sc1
v_accvgpr_read_b32 v136,a24
v_accvgpr_read_b32 v137,a25
v_accvgpr_read_b32 v138,a26
v_accvgpr_read_b32 v139,a27
v_accvgpr_read_b32 v140,a28
v_accvgpr_read_b32 v141,a29
v_accvgpr_read_b32 v142,a30
v_accvgpr_read_b32 v143,a31
v_mul_f32 v136,v4,v136
v_mul_f32 v137,v4,v137
v_mul_f32 v138,v4,v138
v_mul_f32 v139,v4,v139
v_mul_f32 v140,v4,v140
v_mul_f32 v141,v4,v141
v_mul_f32 v142,v4,v142
v_mul_f32 v143,v4,v143
v_cvt_pk_bf16_f32 v144,v136,v137
v_cvt_pk_bf16_f32 v145,v138,v139
v_cvt_pk_bf16_f32 v146,v140,v141
v_cvt_pk_bf16_f32 v147,v142,v143
buffer_store_dwordx4 v[144:147],v20,s[20:23],s44 offen offset:3072 sc1
v_accvgpr_read_b32 v128,a32
v_accvgpr_read_b32 v129,a33
v_accvgpr_read_b32 v130,a34
v_accvgpr_read_b32 v131,a35
v_accvgpr_read_b32 v132,a36
v_accvgpr_read_b32 v133,a37
v_accvgpr_read_b32 v134,a38
v_accvgpr_read_b32 v135,a39
v_mul_f32 v128,v5,v128
v_mul_f32 v129,v5,v129
v_mul_f32 v130,v5,v130
v_mul_f32 v131,v5,v131
v_mul_f32 v132,v5,v132
v_mul_f32 v133,v5,v133
v_mul_f32 v134,v5,v134
v_mul_f32 v135,v5,v135
v_cvt_pk_bf16_f32 v148,v128,v129
v_cvt_pk_bf16_f32 v149,v130,v131
v_cvt_pk_bf16_f32 v150,v132,v133
v_cvt_pk_bf16_f32 v151,v134,v135
buffer_store_dwordx4 v[148:151],v20,s[20:23],s45 offen sc1
v_accvgpr_read_b32 v136,a40
v_accvgpr_read_b32 v137,a41
v_accvgpr_read_b32 v138,a42
v_accvgpr_read_b32 v139,a43
v_accvgpr_read_b32 v140,a44
v_accvgpr_read_b32 v141,a45
v_accvgpr_read_b32 v142,a46
v_accvgpr_read_b32 v143,a47
v_mul_f32 v136,v5,v136
v_mul_f32 v137,v5,v137
v_mul_f32 v138,v5,v138
v_mul_f32 v139,v5,v139
v_mul_f32 v140,v5,v140
v_mul_f32 v141,v5,v141
v_mul_f32 v142,v5,v142
v_mul_f32 v143,v5,v143
v_cvt_pk_bf16_f32 v152,v136,v137
v_cvt_pk_bf16_f32 v153,v138,v139
v_cvt_pk_bf16_f32 v154,v140,v141
v_cvt_pk_bf16_f32 v155,v142,v143
buffer_store_dwordx4 v[152:155],v20,s[20:23],s45 offen offset:1024 sc1
v_accvgpr_read_b32 v128,a48
v_accvgpr_read_b32 v129,a49
v_accvgpr_read_b32 v130,a50
v_accvgpr_read_b32 v131,a51
v_accvgpr_read_b32 v132,a52
v_accvgpr_read_b32 v133,a53
v_accvgpr_read_b32 v134,a54
v_accvgpr_read_b32 v135,a55
v_mul_f32 v128,v5,v128
v_mul_f32 v129,v5,v129
v_mul_f32 v130,v5,v130
v_mul_f32 v131,v5,v131
v_mul_f32 v132,v5,v132
v_mul_f32 v133,v5,v133
v_mul_f32 v134,v5,v134
v_mul_f32 v135,v5,v135
v_cvt_pk_bf16_f32 v144,v128,v129
v_cvt_pk_bf16_f32 v145,v130,v131
v_cvt_pk_bf16_f32 v146,v132,v133
v_cvt_pk_bf16_f32 v147,v134,v135
buffer_store_dwordx4 v[144:147],v20,s[20:23],s45 offen offset:2048 sc1
v_accvgpr_read_b32 v136,a56
v_accvgpr_read_b32 v137,a57
v_accvgpr_read_b32 v138,a58
v_accvgpr_read_b32 v139,a59
v_accvgpr_read_b32 v140,a60
v_accvgpr_read_b32 v141,a61
v_accvgpr_read_b32 v142,a62
v_accvgpr_read_b32 v143,a63
v_mul_f32 v136,v5,v136
v_mul_f32 v137,v5,v137
v_mul_f32 v138,v5,v138
v_mul_f32 v139,v5,v139
v_mul_f32 v140,v5,v140
v_mul_f32 v141,v5,v141
v_mul_f32 v142,v5,v142
v_mul_f32 v143,v5,v143
v_cvt_pk_bf16_f32 v148,v136,v137
v_cvt_pk_bf16_f32 v149,v138,v139
v_cvt_pk_bf16_f32 v150,v140,v141
v_cvt_pk_bf16_f32 v151,v142,v143
buffer_store_dwordx4 v[148:151],v20,s[20:23],s45 offen offset:3072 sc1
v_accvgpr_read_b32 v128,a64
v_accvgpr_read_b32 v129,a65
v_accvgpr_read_b32 v130,a66
v_accvgpr_read_b32 v131,a67
v_accvgpr_read_b32 v132,a68
v_accvgpr_read_b32 v133,a69
v_accvgpr_read_b32 v134,a70
v_accvgpr_read_b32 v135,a71
v_mul_f32 v128,v6,v128
v_mul_f32 v129,v6,v129
v_mul_f32 v130,v6,v130
v_mul_f32 v131,v6,v131
v_mul_f32 v132,v6,v132
v_mul_f32 v133,v6,v133
v_mul_f32 v134,v6,v134
v_mul_f32 v135,v6,v135
v_cvt_pk_bf16_f32 v152,v128,v129
v_cvt_pk_bf16_f32 v153,v130,v131
v_cvt_pk_bf16_f32 v154,v132,v133
v_cvt_pk_bf16_f32 v155,v134,v135
buffer_store_dwordx4 v[152:155],v20,s[20:23],s46 offen sc1
v_accvgpr_read_b32 v136,a72
v_accvgpr_read_b32 v137,a73
v_accvgpr_read_b32 v138,a74
v_accvgpr_read_b32 v139,a75
v_accvgpr_read_b32 v140,a76
v_accvgpr_read_b32 v141,a77
v_accvgpr_read_b32 v142,a78
v_accvgpr_read_b32 v143,a79
v_mul_f32 v136,v6,v136
v_mul_f32 v137,v6,v137
v_mul_f32 v138,v6,v138
v_mul_f32 v139,v6,v139
v_mul_f32 v140,v6,v140
v_mul_f32 v141,v6,v141
v_mul_f32 v142,v6,v142
v_mul_f32 v143,v6,v143
v_cvt_pk_bf16_f32 v144,v136,v137
v_cvt_pk_bf16_f32 v145,v138,v139
v_cvt_pk_bf16_f32 v146,v140,v141
v_cvt_pk_bf16_f32 v147,v142,v143
buffer_store_dwordx4 v[144:147],v20,s[20:23],s46 offen offset:1024 sc1
v_accvgpr_read_b32 v128,a80
v_accvgpr_read_b32 v129,a81
v_accvgpr_read_b32 v130,a82
v_accvgpr_read_b32 v131,a83
v_accvgpr_read_b32 v132,a84
v_accvgpr_read_b32 v133,a85
v_accvgpr_read_b32 v134,a86
v_accvgpr_read_b32 v135,a87
v_mul_f32 v128,v6,v128
v_mul_f32 v129,v6,v129
v_mul_f32 v130,v6,v130
v_mul_f32 v131,v6,v131
v_mul_f32 v132,v6,v132
v_mul_f32 v133,v6,v133
v_mul_f32 v134,v6,v134
v_mul_f32 v135,v6,v135
v_cvt_pk_bf16_f32 v148,v128,v129
v_cvt_pk_bf16_f32 v149,v130,v131
v_cvt_pk_bf16_f32 v150,v132,v133
v_cvt_pk_bf16_f32 v151,v134,v135
buffer_store_dwordx4 v[148:151],v20,s[20:23],s46 offen offset:2048 sc1
v_accvgpr_read_b32 v136,a88
v_accvgpr_read_b32 v137,a89
v_accvgpr_read_b32 v138,a90
v_accvgpr_read_b32 v139,a91
v_accvgpr_read_b32 v140,a92
v_accvgpr_read_b32 v141,a93
v_accvgpr_read_b32 v142,a94
v_accvgpr_read_b32 v143,a95
v_mul_f32 v136,v6,v136
v_mul_f32 v137,v6,v137
v_mul_f32 v138,v6,v138
v_mul_f32 v139,v6,v139
v_mul_f32 v140,v6,v140
v_mul_f32 v141,v6,v141
v_mul_f32 v142,v6,v142
v_mul_f32 v143,v6,v143
v_cvt_pk_bf16_f32 v152,v136,v137
v_cvt_pk_bf16_f32 v153,v138,v139
v_cvt_pk_bf16_f32 v154,v140,v141
v_cvt_pk_bf16_f32 v155,v142,v143
buffer_store_dwordx4 v[152:155],v20,s[20:23],s46 offen offset:3072 sc1
v_accvgpr_read_b32 v128,a96
v_accvgpr_read_b32 v129,a97
v_accvgpr_read_b32 v130,a98
v_accvgpr_read_b32 v131,a99
v_accvgpr_read_b32 v132,a100
v_accvgpr_read_b32 v133,a101
v_accvgpr_read_b32 v134,a102
v_accvgpr_read_b32 v135,a103
v_mul_f32 v128,v7,v128
v_mul_f32 v129,v7,v129
v_mul_f32 v130,v7,v130
v_mul_f32 v131,v7,v131
v_mul_f32 v132,v7,v132
v_mul_f32 v133,v7,v133
v_mul_f32 v134,v7,v134
v_mul_f32 v135,v7,v135
v_cvt_pk_bf16_f32 v144,v128,v129
v_cvt_pk_bf16_f32 v145,v130,v131
v_cvt_pk_bf16_f32 v146,v132,v133
v_cvt_pk_bf16_f32 v147,v134,v135
buffer_store_dwordx4 v[144:147],v20,s[20:23],s47 offen sc1
v_accvgpr_read_b32 v136,a104
v_accvgpr_read_b32 v137,a105
v_accvgpr_read_b32 v138,a106
v_accvgpr_read_b32 v139,a107
v_accvgpr_read_b32 v140,a108
v_accvgpr_read_b32 v141,a109
v_accvgpr_read_b32 v142,a110
v_accvgpr_read_b32 v143,a111
v_mul_f32 v136,v7,v136
v_mul_f32 v137,v7,v137
v_mul_f32 v138,v7,v138
v_mul_f32 v139,v7,v139
v_mul_f32 v140,v7,v140
v_mul_f32 v141,v7,v141
v_mul_f32 v142,v7,v142
v_mul_f32 v143,v7,v143
v_cvt_pk_bf16_f32 v148,v136,v137
v_cvt_pk_bf16_f32 v149,v138,v139
v_cvt_pk_bf16_f32 v150,v140,v141
v_cvt_pk_bf16_f32 v151,v142,v143
buffer_store_dwordx4 v[148:151],v20,s[20:23],s47 offen offset:1024 sc1
v_accvgpr_read_b32 v128,a112
v_accvgpr_read_b32 v129,a113
v_accvgpr_read_b32 v130,a114
v_accvgpr_read_b32 v131,a115
v_accvgpr_read_b32 v132,a116
v_accvgpr_read_b32 v133,a117
v_accvgpr_read_b32 v134,a118
v_accvgpr_read_b32 v135,a119
v_mul_f32 v128,v7,v128
v_mul_f32 v129,v7,v129
v_mul_f32 v130,v7,v130
v_mul_f32 v131,v7,v131
v_mul_f32 v132,v7,v132
v_mul_f32 v133,v7,v133
v_mul_f32 v134,v7,v134
v_mul_f32 v135,v7,v135
v_cvt_pk_bf16_f32 v152,v128,v129
v_cvt_pk_bf16_f32 v153,v130,v131
v_cvt_pk_bf16_f32 v154,v132,v133
v_cvt_pk_bf16_f32 v155,v134,v135
buffer_store_dwordx4 v[152:155],v20,s[20:23],s47 offen offset:2048 sc1
v_accvgpr_read_b32 v136,a120
v_accvgpr_read_b32 v137,a121
v_accvgpr_read_b32 v138,a122
v_accvgpr_read_b32 v139,a123
v_accvgpr_read_b32 v140,a124
v_accvgpr_read_b32 v141,a125
v_accvgpr_read_b32 v142,a126
v_accvgpr_read_b32 v143,a127
v_mul_f32 v136,v7,v136
v_mul_f32 v137,v7,v137
v_mul_f32 v138,v7,v138
v_mul_f32 v139,v7,v139
v_mul_f32 v140,v7,v140
v_mul_f32 v141,v7,v141
v_mul_f32 v142,v7,v142
v_mul_f32 v143,v7,v143
v_cvt_pk_bf16_f32 v144,v136,v137
v_cvt_pk_bf16_f32 v145,v138,v139
v_cvt_pk_bf16_f32 v146,v140,v141
v_cvt_pk_bf16_f32 v147,v142,v143
buffer_store_dwordx4 v[144:147],v20,s[20:23],s47 offen offset:3072 sc1
s_waitcnt vmcnt(0) lgkmcnt(0)
s_barrier
buffer_store_dword v186,v14,s[64:67],s82 offen offset:2048 sc1
s_endpgm

K2F_H1_SPIN:
s_mov_b32 s87,0
K2F_H1_LOOP:
buffer_load_dword v15,v27,s[64:67],0 offen offset:2048 sc1
s_waitcnt vmcnt(0)
v_cmp_eq_u32 s[80:81],1,v15
s_nop 0
s_cmp_eq_u64 s[80:81],-1
s_cbranch_scc1 K2F_H1_BACK
s_add_u32 s87,s87,1
s_cmp_lt_u32 s87,131072
s_cbranch_scc1 K2F_H1_LOOP
s_branch K2F_H1_BACK
K2F_H1B_SPIN:
s_mov_b32 s87,0
K2F_H1B_LOOP:
buffer_load_dword v15,v26,s[64:67],0 offen offset:2048 sc1
s_waitcnt vmcnt(0)
v_cmp_eq_u32 s[80:81],1,v15
s_nop 0
s_cmp_eq_u64 s[80:81],-1
s_cbranch_scc1 K2F_H1B_BACK
s_add_u32 s87,s87,1
s_cmp_lt_u32 s87,131072
s_cbranch_scc1 K2F_H1B_LOOP
s_branch K2F_H1B_BACK
K2F_PAIR_SPIN:
s_mov_b32 s87,0
K2F_PAIR_LOOP:
buffer_load_dword v15,v28,s[64:67],s79 offen sc1
s_waitcnt vmcnt(0)
v_readfirstlane_b32 s80,v15
s_nop 0
s_cmp_eq_u32 s80,1
s_cbranch_scc1 K2F_PAIR_BACK
s_add_u32 s87,s87,1
s_cmp_lt_u32 s87,131072
s_cbranch_scc1 K2F_PAIR_LOOP
s_branch K2F_PAIR_BACK
K1_SLOW:
s_waitcnt vmcnt(0)
v_mbcnt_lo_u32_b32 v0,-1,0
v_mbcnt_hi_u32_b32 v0,-1,v0
s_lshl_b32 s54,s28,6
v_add_u32 v0,s54,v0
s_waitcnt lgkmcnt(0)
s_barrier
v_mov_b32 v192,v0
s_load_dwordx4 s[56:59],s[0:1],0
s_load_dwordx4 s[60:63],s[0:1],16
s_load_dwordx2 s[64:65],s[0:1],40
s_load_dwordx2 s[70:71],s[0:1],64
s_load_dwordx2 s[66:67],s[0:1],48
s_load_dwordx2 s[68:69],s[0:1],56
s_load_dwordx2 s[72:73],s[0:1],96
s_load_dwordx2 s[82:83],s[0:1],32
s_load_dwordx2 s[100:101],s[0:1],72
v_lshrrev_b32 v194,6,v192
v_and_b32 v193,63,v192
s_and_b32 s74,s2,7
s_lshr_b32 s75,s2,3
v_readfirstlane_b32 s28,v194
s_lshr_b32 s76,s74,2
s_and_b32 s77,s74,3
s_and_b32 s78,s77,1
s_lshl_b32 s78,s78,2
s_and_b32 s80,s75,3
s_add_u32 s78,s78,s80
s_lshr_b32 s79,s77,1
s_lshl_b32 s79,s79,3
s_lshr_b32 s80,s75,2
s_add_u32 s79,s79,s80
v_and_b32 v195,15,v193
v_lshrrev_b32 v196,4,v193
v_lshrrev_b32 v197,2,v193
v_and_b32 v197,3,v197
v_and_b32 v198,3,v193
v_lshrrev_b32 v203,2,v193
v_and_b32 v203,7,v203
v_lshrrev_b32 v201,2,v203
v_sub_u32 v201,0,v201
v_and_b32 v201,3,v201
v_xor_b32 v201,v201,v198
v_lshlrev_b32 v201,4,v201
v_lshlrev_b32 v202,10,v203
v_add_u32 v201,v201,v202
v_lshrrev_b32 v202,5,v193
v_lshlrev_b32 v202,6,v202
v_add_u32 v205,v201,v202
v_lshrrev_b32 v203,3,v193
v_and_b32 v204,7,v193
v_lshrrev_b32 v201,1,v203
v_and_b32 v201,1,v201
v_lshlrev_b32 v201,2,v201
v_xor_b32 v201,v201,v204
v_lshlrev_b32 v201,4,v201
v_lshlrev_b32 v202,13,v203
v_add_u32 v206,v201,v202
s_cmp_lt_u32 s28,2
s_cselect_b64 s[80:81],-1,0
s_cselect_b32 s54,32,16
s_mov_b32 s87,64512
s_cselect_b32 s55,7168,s87
s_lshl_b32 s87,s55,1
v_cndmask_b32 v16,v206,v205,s[80:81]
v_xor_b32 v201,s54,v16
v_add_u32 v17,s55,v201
v_add_u32 v18,s87,v16
v_add_u32 v19,s87,v17
s_mul_i32 s80,s28,14336
s_add_u32 s81,s80,131072
s_cmp_lt_u32 s28,2
s_cselect_b32 s30,s81,49152
s_add_u32 s81,s80,98304
s_cmp_lt_u32 s28,2
s_cselect_b32 s31,s81,81920
s_mul_i32 s80,s28,114688
s_add_u32 s81,s80,0
s_cmp_lt_u32 s28,2
s_cselect_b32 s38,s81,0
s_add_u32 s81,s80,32768
s_cmp_lt_u32 s28,2
s_cselect_b32 s39,s81,262144
s_add_u32 s81,s80,65536
s_cmp_lt_u32 s28,2
s_cselect_b32 s40,s81,128
s_add_u32 s81,s80,98304
s_cmp_lt_u32 s28,2
s_cselect_b32 s41,s81,262272
s_cmp_lt_u32 s28,2
s_mov_b32 s81,128
s_cselect_b32 s36,s81,524288
s_cmp_eq_u32 s76,0
s_waitcnt lgkmcnt(0)
s_cselect_b32 s4,s56,s64
s_cselect_b32 s5,s57,s65
s_cselect_b32 s8,s62,s70
s_cselect_b32 s9,s63,s71
s_mul_i32 s80,s78,245760
s_add_u32 s4,s4,s80
s_addc_u32 s5,s5,0
s_mov_b32 s6,245760
s_mov_b32 s7,0x20000
s_lshl_b32 s80,s79,9
s_add_u32 s8,s8,s80
s_addc_u32 s9,s9,0
s_sub_u32 s10,4194304,s80
s_mov_b32 s11,0x20000
s_cmp_lt_u32 s28,2
s_cselect_b32 s24,s4,s8
s_cselect_b32 s25,s5,s9
s_cselect_b32 s26,s6,s10
s_mov_b32 s27,0x20000
s_cmp_eq_u32 s76,0
s_cselect_b32 s12,s58,s66
s_cselect_b32 s13,s59,s67
s_cselect_b32 s16,s60,s68
s_cselect_b32 s17,s61,s69
s_cselect_b32 s37,s82,s100
s_cselect_b32 s53,s83,s101
s_lshl_b32 s80,s78,5
s_lshl_b32 s81,s79,1
s_add_u32 s80,s80,s81
s_lshl_b32 s80,s80,17
s_add_u32 s12,s12,s80
s_addc_u32 s13,s13,0
s_mov_b32 s14,262144
s_mov_b32 s15,0x20000
s_add_u32 s16,s16,s80
s_addc_u32 s17,s17,0
s_mov_b32 s18,262144
s_mov_b32 s19,0x20000
s_mul_i32 s80,s76,120
s_mul_i32 s81,s78,15
s_add_u32 s80,s80,s81
s_mul_i32 s80,s80,131072
s_lshl_b32 s81,s79,13
s_add_u32 s80,s80,s81
s_add_u32 s20,s72,s80
s_addc_u32 s21,s73,0
s_sub_u32 s86,1966080,s81
s_mov_b32 s22,s86
s_mov_b32 s23,0x20000
s_lshl_b32 s80,s77,5
s_add_u32 s80,s80,s75
s_lshl_b32 s89,s80,15
s_mov_b32 s52,0x3e0293ee
s_mov_b32 s84,0xffff0000
s_mov_b32 s85,0xffff0000
s_mov_b32 s43,0
v_sub_u32 v200,0,v197
v_and_b32 v200,3,v200
v_xor_b32 v200,v200,v196
v_lshlrev_b32 v200,4,v200
v_lshlrev_b32 v201,10,v197
v_lshlrev_b32 v202,6,v198
v_add_u32 v201,v201,v202
v_add_u32 v8,v201,v200
v_lshrrev_b32 v201,3,v195
v_lshlrev_b32 v201,10,v201
v_and_b32 v202,7,v195
v_lshlrev_b32 v202,6,v202
v_add_u32 v201,v201,v202
v_add_u32 v201,v201,v200
s_lshl_b32 s80,s28,13
s_add_u32 s80,s80,98304
v_add_u32 v11,s80,v201
v_lshlrev_b32 v201,10,v196
v_lshlrev_b32 v202,6,v197
v_add_u32 v201,v201,v202
v_and_b32 v202,1,v198
v_lshlrev_b32 v202,3,v202
v_add_u32 v201,v201,v202
v_and_b32 v199,1,v196
v_lshlrev_b32 v199,1,v199
v_lshrrev_b32 v202,1,v198
v_xor_b32 v202,v202,v199
v_lshlrev_b32 v202,4,v202
v_add_u32 v201,v201,v202
v_add_u32 v9,65536,v201
v_xor_b32 v10,32,v9
v_lshrrev_b32 v201,1,v197
v_lshlrev_b32 v201,2,v201
v_and_b32 v202,1,v196
v_add_u32 v201,v201,v202
v_xor_b32 v201,v201,v198
v_lshlrev_b32 v201,4,v201
v_and_b32 v202,1,v198
v_lshlrev_b32 v202,3,v202
v_add_u32 v201,v201,v202
v_lshlrev_b32 v202,10,v196
v_add_u32 v201,v201,v202
v_lshlrev_b32 v202,7,v197
v_add_u32 v201,v201,v202
v_add_u32 v12,49152,v201
v_xor_b32 v13,8,v12
v_xor_b32 v14,64,v12
v_xor_b32 v15,72,v12
v_lshlrev_b32 v201,8,v197
v_lshlrev_b32 v202,6,v196
v_add_u32 v201,v201,v202
v_xor_b32 v202,0,v198
v_lshlrev_b32 v202,4,v202
v_add_u32 v21,v201,v202
v_xor_b32 v202,3,v198
v_lshlrev_b32 v202,4,v202
v_add_u32 v22,v201,v202
v_xor_b32 v202,2,v198
v_lshlrev_b32 v202,4,v202
v_add_u32 v23,v201,v202
v_xor_b32 v202,1,v198
v_lshlrev_b32 v202,4,v202
v_add_u32 v24,v201,v202
v_xor_b32 v202,0,v198
v_lshlrev_b32 v202,4,v202
v_add_u32 v25,v201,v202
v_xor_b32 v202,2,v198
v_lshlrev_b32 v202,4,v202
v_add_u32 v26,v201,v202
s_mul_i32 s80,s28,524288
v_lshlrev_b32 v201,4,v193
v_add_u32 v20,s80,v201
s_mov_b32 s22,s86
s_cmp_lg_u32 s3,0
s_cselect_b32 s29,0,1
v_and_b32 v8,0xffff7fff,v8
v_and_b32 v9,0xffff7fff,v9
v_and_b32 v10,0xffff7fff,v10
K1_SLOW_HEAD:
s_mov_b32 s32,s38
s_mov_b32 s33,s39
s_mov_b32 s34,s40
s_mov_b32 s35,s41
s_lshl_b32 s54,s29,8
s_cmp_lt_u32 s28,2
s_cselect_b32 s54,0,s54
s_add_u32 s32,s32,s54
s_add_u32 s33,s33,s54
s_add_u32 s34,s34,s54
s_add_u32 s35,s35,s54
v_mov_b32 v64,0
v_mov_b32 v65,0
v_mov_b32 v66,0
v_mov_b32 v67,0
v_mov_b32 v68,0
v_mov_b32 v69,0
v_mov_b32 v70,0
v_mov_b32 v71,0
v_mov_b32 v72,0
v_mov_b32 v73,0
v_mov_b32 v74,0
v_mov_b32 v75,0
v_mov_b32 v76,0
v_mov_b32 v77,0
v_mov_b32 v78,0
v_mov_b32 v79,0
v_mov_b32 v80,0
v_mov_b32 v81,0
v_mov_b32 v82,0
v_mov_b32 v83,0
v_mov_b32 v84,0
v_mov_b32 v85,0
v_mov_b32 v86,0
v_mov_b32 v87,0
v_mov_b32 v88,0
v_mov_b32 v89,0
v_mov_b32 v90,0
v_mov_b32 v91,0
v_mov_b32 v92,0
v_mov_b32 v93,0
v_mov_b32 v94,0
v_mov_b32 v95,0
v_mov_b32 v96,0
v_mov_b32 v97,0
v_mov_b32 v98,0
v_mov_b32 v99,0
v_mov_b32 v100,0
v_mov_b32 v101,0
v_mov_b32 v102,0
v_mov_b32 v103,0
v_mov_b32 v104,0
v_mov_b32 v105,0
v_mov_b32 v106,0
v_mov_b32 v107,0
v_mov_b32 v108,0
v_mov_b32 v109,0
v_mov_b32 v110,0
v_mov_b32 v111,0
v_mov_b32 v112,0
v_mov_b32 v113,0
v_mov_b32 v114,0
v_mov_b32 v115,0
v_mov_b32 v116,0
v_mov_b32 v117,0
v_mov_b32 v118,0
v_mov_b32 v119,0
v_mov_b32 v120,0
v_mov_b32 v121,0
v_mov_b32 v122,0
v_mov_b32 v123,0
v_mov_b32 v124,0
v_mov_b32 v125,0
v_mov_b32 v126,0
v_mov_b32 v127,0
v_mov_b32 v128,0
v_mov_b32 v129,0
v_mov_b32 v130,0
v_mov_b32 v131,0
v_mov_b32 v132,0
v_mov_b32 v133,0
v_mov_b32 v134,0
v_mov_b32 v135,0
v_mov_b32 v136,0
v_mov_b32 v137,0
v_mov_b32 v138,0
v_mov_b32 v139,0
v_mov_b32 v140,0
v_mov_b32 v141,0
v_mov_b32 v142,0
v_mov_b32 v143,0
v_mov_b32 v144,0
v_mov_b32 v145,0
v_mov_b32 v146,0
v_mov_b32 v147,0
v_mov_b32 v148,0
v_mov_b32 v149,0
v_mov_b32 v150,0
v_mov_b32 v151,0
v_mov_b32 v152,0
v_mov_b32 v153,0
v_mov_b32 v154,0
v_mov_b32 v155,0
v_mov_b32 v156,0
v_mov_b32 v157,0
v_mov_b32 v158,0
v_mov_b32 v159,0
v_mov_b32 v160,0
v_mov_b32 v161,0
v_mov_b32 v162,0
v_mov_b32 v163,0
v_mov_b32 v164,0
v_mov_b32 v165,0
v_mov_b32 v166,0
v_mov_b32 v167,0
v_mov_b32 v168,0
v_mov_b32 v169,0
v_mov_b32 v170,0
v_mov_b32 v171,0
v_mov_b32 v172,0
v_mov_b32 v173,0
v_mov_b32 v174,0
v_mov_b32 v175,0
v_mov_b32 v176,0
v_mov_b32 v177,0
v_mov_b32 v178,0
v_mov_b32 v179,0
v_mov_b32 v180,0
v_mov_b32 v181,0
v_mov_b32 v182,0
v_mov_b32 v183,0
v_mov_b32 v184,0
v_mov_b32 v185,0
v_mov_b32 v186,0
v_mov_b32 v187,0
v_mov_b32 v188,0
v_mov_b32 v189,0
v_mov_b32 v190,0
v_mov_b32 v191,0
s_mov_b32 s42,8
K1_SLOW_Q:
s_barrier
s_cmp_eq_u32 s28,3
s_cbranch_scc1 K1_SLOW_Q1
s_add_u32 m0,s30,0
s_nop 0
buffer_load_dwordx4 v16,s[24:27],s32 offen lds
buffer_load_dwordx4 v17,s[24:27],s32 offen offset:1024 lds
buffer_load_dwordx4 v18,s[24:27],s32 offen offset:2048 lds
buffer_load_dwordx4 v19,s[24:27],s32 offen offset:3072 lds
s_add_u32 s32,s32,s36
s_add_u32 m0,s30,4096
s_nop 0
buffer_load_dwordx4 v16,s[24:27],s33 offen lds
buffer_load_dwordx4 v17,s[24:27],s33 offen offset:1024 lds
buffer_load_dwordx4 v18,s[24:27],s33 offen offset:2048 lds
buffer_load_dwordx4 v19,s[24:27],s33 offen offset:3072 lds
s_add_u32 s33,s33,s36
s_add_u32 m0,s30,8192
s_nop 0
buffer_load_dwordx4 v16,s[24:27],s34 offen lds
buffer_load_dwordx4 v17,s[24:27],s34 offen offset:1024 lds
buffer_load_dwordx4 v18,s[24:27],s34 offen offset:2048 lds
buffer_load_dwordx4 v19,s[24:27],s34 offen offset:3072 lds
s_add_u32 s34,s34,s36
s_add_u32 m0,s30,12288
s_nop 0
buffer_load_dwordx4 v16,s[24:27],s35 offen lds
buffer_load_dwordx4 v17,s[24:27],s35 offen offset:1024 lds
buffer_load_dwordx4 v18,s[24:27],s35 offen offset:2048 lds
buffer_load_dwordx4 v19,s[24:27],s35 offen offset:3072 lds
s_add_u32 s35,s35,s36
K1_SLOW_Q1:
s_waitcnt vmcnt(0)
s_barrier
ds_read_b128 a[192:195],v11 offset:32768
ds_read_b128 a[196:199],v11 offset:33280
ds_read_b128 a[200:203],v11 offset:34816
ds_read_b128 a[204:207],v11 offset:35328
ds_read_b128 a[208:211],v11 offset:36864
ds_read_b128 a[212:215],v11 offset:37376
ds_read_b128 a[216:219],v11 offset:38912
ds_read_b128 a[220:223],v11 offset:39424
ds_read_b64_tr_b16 v[32:33],v12
ds_read_b64_tr_b16 v[34:35],v12 offset:512
ds_read_b64_tr_b16 v[36:37],v12 offset:4096
ds_read_b64_tr_b16 v[38:39],v12 offset:4608
s_waitcnt lgkmcnt(2)
M v[64:67],v[32:35],a[192:195],v[64:67]
s_waitcnt lgkmcnt(0)
M v[64:67],v[36:39],a[196:199],v[64:67]
M v[96:99],v[32:35],a[200:203],v[96:99]
M v[96:99],v[36:39],a[204:207],v[96:99]
M v[128:131],v[32:35],a[208:211],v[128:131]
M v[128:131],v[36:39],a[212:215],v[128:131]
M v[160:163],v[32:35],a[216:219],v[160:163]
M v[160:163],v[36:39],a[220:223],v[160:163]
ds_read_b64_tr_b16 v[32:33],v13
ds_read_b64_tr_b16 v[34:35],v13 offset:512
ds_read_b64_tr_b16 v[36:37],v13 offset:4096
ds_read_b64_tr_b16 v[38:39],v13 offset:4608
s_waitcnt lgkmcnt(2)
M v[68:71],v[32:35],a[192:195],v[68:71]
s_waitcnt lgkmcnt(0)
M v[68:71],v[36:39],a[196:199],v[68:71]
M v[100:103],v[32:35],a[200:203],v[100:103]
M v[100:103],v[36:39],a[204:207],v[100:103]
M v[132:135],v[32:35],a[208:211],v[132:135]
M v[132:135],v[36:39],a[212:215],v[132:135]
M v[164:167],v[32:35],a[216:219],v[164:167]
M v[164:167],v[36:39],a[220:223],v[164:167]
ds_read_b64_tr_b16 v[32:33],v14
ds_read_b64_tr_b16 v[34:35],v14 offset:512
ds_read_b64_tr_b16 v[36:37],v14 offset:4096
ds_read_b64_tr_b16 v[38:39],v14 offset:4608
s_waitcnt lgkmcnt(2)
M v[72:75],v[32:35],a[192:195],v[72:75]
s_waitcnt lgkmcnt(0)
M v[72:75],v[36:39],a[196:199],v[72:75]
M v[104:107],v[32:35],a[200:203],v[104:107]
M v[104:107],v[36:39],a[204:207],v[104:107]
M v[136:139],v[32:35],a[208:211],v[136:139]
M v[136:139],v[36:39],a[212:215],v[136:139]
M v[168:171],v[32:35],a[216:219],v[168:171]
M v[168:171],v[36:39],a[220:223],v[168:171]
ds_read_b64_tr_b16 v[32:33],v15
ds_read_b64_tr_b16 v[34:35],v15 offset:512
ds_read_b64_tr_b16 v[36:37],v15 offset:4096
ds_read_b64_tr_b16 v[38:39],v15 offset:4608
s_waitcnt lgkmcnt(2)
M v[76:79],v[32:35],a[192:195],v[76:79]
s_waitcnt lgkmcnt(0)
M v[76:79],v[36:39],a[196:199],v[76:79]
M v[108:111],v[32:35],a[200:203],v[108:111]
M v[108:111],v[36:39],a[204:207],v[108:111]
M v[140:143],v[32:35],a[208:211],v[140:143]
M v[140:143],v[36:39],a[212:215],v[140:143]
M v[172:175],v[32:35],a[216:219],v[172:175]
M v[172:175],v[36:39],a[220:223],v[172:175]
ds_read_b64_tr_b16 v[32:33],v12 offset:8192
ds_read_b64_tr_b16 v[34:35],v12 offset:8704
ds_read_b64_tr_b16 v[36:37],v12 offset:12288
ds_read_b64_tr_b16 v[38:39],v12 offset:12800
s_waitcnt lgkmcnt(2)
M v[80:83],v[32:35],a[192:195],v[80:83]
s_waitcnt lgkmcnt(0)
M v[80:83],v[36:39],a[196:199],v[80:83]
M v[112:115],v[32:35],a[200:203],v[112:115]
M v[112:115],v[36:39],a[204:207],v[112:115]
M v[144:147],v[32:35],a[208:211],v[144:147]
M v[144:147],v[36:39],a[212:215],v[144:147]
M v[176:179],v[32:35],a[216:219],v[176:179]
M v[176:179],v[36:39],a[220:223],v[176:179]
ds_read_b64_tr_b16 v[32:33],v13 offset:8192
ds_read_b64_tr_b16 v[34:35],v13 offset:8704
ds_read_b64_tr_b16 v[36:37],v13 offset:12288
ds_read_b64_tr_b16 v[38:39],v13 offset:12800
s_waitcnt lgkmcnt(2)
M v[84:87],v[32:35],a[192:195],v[84:87]
s_waitcnt lgkmcnt(0)
M v[84:87],v[36:39],a[196:199],v[84:87]
M v[116:119],v[32:35],a[200:203],v[116:119]
M v[116:119],v[36:39],a[204:207],v[116:119]
M v[148:151],v[32:35],a[208:211],v[148:151]
M v[148:151],v[36:39],a[212:215],v[148:151]
M v[180:183],v[32:35],a[216:219],v[180:183]
M v[180:183],v[36:39],a[220:223],v[180:183]
ds_read_b64_tr_b16 v[32:33],v14 offset:8192
ds_read_b64_tr_b16 v[34:35],v14 offset:8704
ds_read_b64_tr_b16 v[36:37],v14 offset:12288
ds_read_b64_tr_b16 v[38:39],v14 offset:12800
s_waitcnt lgkmcnt(2)
M v[88:91],v[32:35],a[192:195],v[88:91]
s_waitcnt lgkmcnt(0)
M v[88:91],v[36:39],a[196:199],v[88:91]
M v[120:123],v[32:35],a[200:203],v[120:123]
M v[120:123],v[36:39],a[204:207],v[120:123]
M v[152:155],v[32:35],a[208:211],v[152:155]
M v[152:155],v[36:39],a[212:215],v[152:155]
M v[184:187],v[32:35],a[216:219],v[184:187]
M v[184:187],v[36:39],a[220:223],v[184:187]
ds_read_b64_tr_b16 v[32:33],v15 offset:8192
ds_read_b64_tr_b16 v[34:35],v15 offset:8704
ds_read_b64_tr_b16 v[36:37],v15 offset:12288
ds_read_b64_tr_b16 v[38:39],v15 offset:12800
s_waitcnt lgkmcnt(2)
M v[92:95],v[32:35],a[192:195],v[92:95]
s_waitcnt lgkmcnt(0)
M v[92:95],v[36:39],a[196:199],v[92:95]
M v[124:127],v[32:35],a[200:203],v[124:127]
M v[124:127],v[36:39],a[204:207],v[124:127]
M v[156:159],v[32:35],a[208:211],v[156:159]
M v[156:159],v[36:39],a[212:215],v[156:159]
M v[188:191],v[32:35],a[216:219],v[188:191]
M v[188:191],v[36:39],a[220:223],v[188:191]
s_sub_u32 s42,s42,1
s_cmp_lg_u32 s42,0
s_cbranch_scc1 K1_SLOW_Q
v_mul_f32 v64,s52,v64
v_mul_f32 v65,s52,v65
v_mul_f32 v66,s52,v66
v_mul_f32 v67,s52,v67
v_mul_f32 v68,s52,v68
v_mul_f32 v69,s52,v69
v_mul_f32 v70,s52,v70
v_mul_f32 v71,s52,v71
v_cvt_pk_bf16_f32 v244,v64,v65
v_cvt_pk_bf16_f32 v245,v66,v67
v_cvt_pk_bf16_f32 v246,v68,v69
v_cvt_pk_bf16_f32 v247,v70,v71
s_mov_b64 exec,s[84:85]
v_swap_b32 v244,v246
v_swap_b32 v245,v247
s_mov_b64 exec,-1
v_accvgpr_write_b32 a128,v244
v_accvgpr_write_b32 a129,v245
v_accvgpr_write_b32 a130,v246
v_accvgpr_write_b32 a131,v247
v_mul_f32 v72,s52,v72
v_mul_f32 v73,s52,v73
v_mul_f32 v74,s52,v74
v_mul_f32 v75,s52,v75
v_mul_f32 v76,s52,v76
v_mul_f32 v77,s52,v77
v_mul_f32 v78,s52,v78
v_mul_f32 v79,s52,v79
v_cvt_pk_bf16_f32 v244,v72,v73
v_cvt_pk_bf16_f32 v245,v74,v75
v_cvt_pk_bf16_f32 v246,v76,v77
v_cvt_pk_bf16_f32 v247,v78,v79
s_mov_b64 exec,s[84:85]
v_swap_b32 v244,v246
v_swap_b32 v245,v247
s_mov_b64 exec,-1
v_accvgpr_write_b32 a132,v244
v_accvgpr_write_b32 a133,v245
v_accvgpr_write_b32 a134,v246
v_accvgpr_write_b32 a135,v247
v_mul_f32 v80,s52,v80
v_mul_f32 v81,s52,v81
v_mul_f32 v82,s52,v82
v_mul_f32 v83,s52,v83
v_mul_f32 v84,s52,v84
v_mul_f32 v85,s52,v85
v_mul_f32 v86,s52,v86
v_mul_f32 v87,s52,v87
v_cvt_pk_bf16_f32 v244,v80,v81
v_cvt_pk_bf16_f32 v245,v82,v83
v_cvt_pk_bf16_f32 v246,v84,v85
v_cvt_pk_bf16_f32 v247,v86,v87
s_mov_b64 exec,s[84:85]
v_swap_b32 v244,v246
v_swap_b32 v245,v247
s_mov_b64 exec,-1
v_accvgpr_write_b32 a136,v244
v_accvgpr_write_b32 a137,v245
v_accvgpr_write_b32 a138,v246
v_accvgpr_write_b32 a139,v247
v_mul_f32 v88,s52,v88
v_mul_f32 v89,s52,v89
v_mul_f32 v90,s52,v90
v_mul_f32 v91,s52,v91
v_mul_f32 v92,s52,v92
v_mul_f32 v93,s52,v93
v_mul_f32 v94,s52,v94
v_mul_f32 v95,s52,v95
v_cvt_pk_bf16_f32 v244,v88,v89
v_cvt_pk_bf16_f32 v245,v90,v91
v_cvt_pk_bf16_f32 v246,v92,v93
v_cvt_pk_bf16_f32 v247,v94,v95
s_mov_b64 exec,s[84:85]
v_swap_b32 v244,v246
v_swap_b32 v245,v247
s_mov_b64 exec,-1
v_accvgpr_write_b32 a140,v244
v_accvgpr_write_b32 a141,v245
v_accvgpr_write_b32 a142,v246
v_accvgpr_write_b32 a143,v247
v_mul_f32 v96,s52,v96
v_mul_f32 v97,s52,v97
v_mul_f32 v98,s52,v98
v_mul_f32 v99,s52,v99
v_mul_f32 v100,s52,v100
v_mul_f32 v101,s52,v101
v_mul_f32 v102,s52,v102
v_mul_f32 v103,s52,v103
v_cvt_pk_bf16_f32 v244,v96,v97
v_cvt_pk_bf16_f32 v245,v98,v99
v_cvt_pk_bf16_f32 v246,v100,v101
v_cvt_pk_bf16_f32 v247,v102,v103
s_mov_b64 exec,s[84:85]
v_swap_b32 v244,v246
v_swap_b32 v245,v247
s_mov_b64 exec,-1
v_accvgpr_write_b32 a144,v244
v_accvgpr_write_b32 a145,v245
v_accvgpr_write_b32 a146,v246
v_accvgpr_write_b32 a147,v247
v_mul_f32 v104,s52,v104
v_mul_f32 v105,s52,v105
v_mul_f32 v106,s52,v106
v_mul_f32 v107,s52,v107
v_mul_f32 v108,s52,v108
v_mul_f32 v109,s52,v109
v_mul_f32 v110,s52,v110
v_mul_f32 v111,s52,v111
v_cvt_pk_bf16_f32 v244,v104,v105
v_cvt_pk_bf16_f32 v245,v106,v107
v_cvt_pk_bf16_f32 v246,v108,v109
v_cvt_pk_bf16_f32 v247,v110,v111
s_mov_b64 exec,s[84:85]
v_swap_b32 v244,v246
v_swap_b32 v245,v247
s_mov_b64 exec,-1
v_accvgpr_write_b32 a148,v244
v_accvgpr_write_b32 a149,v245
v_accvgpr_write_b32 a150,v246
v_accvgpr_write_b32 a151,v247
v_mul_f32 v112,s52,v112
v_mul_f32 v113,s52,v113
v_mul_f32 v114,s52,v114
v_mul_f32 v115,s52,v115
v_mul_f32 v116,s52,v116
v_mul_f32 v117,s52,v117
v_mul_f32 v118,s52,v118
v_mul_f32 v119,s52,v119
v_cvt_pk_bf16_f32 v244,v112,v113
v_cvt_pk_bf16_f32 v245,v114,v115
v_cvt_pk_bf16_f32 v246,v116,v117
v_cvt_pk_bf16_f32 v247,v118,v119
s_mov_b64 exec,s[84:85]
v_swap_b32 v244,v246
v_swap_b32 v245,v247
s_mov_b64 exec,-1
v_accvgpr_write_b32 a152,v244
v_accvgpr_write_b32 a153,v245
v_accvgpr_write_b32 a154,v246
v_accvgpr_write_b32 a155,v247
v_mul_f32 v120,s52,v120
v_mul_f32 v121,s52,v121
v_mul_f32 v122,s52,v122
v_mul_f32 v123,s52,v123
v_mul_f32 v124,s52,v124
v_mul_f32 v125,s52,v125
v_mul_f32 v126,s52,v126
v_mul_f32 v127,s52,v127
v_cvt_pk_bf16_f32 v244,v120,v121
v_cvt_pk_bf16_f32 v245,v122,v123
v_cvt_pk_bf16_f32 v246,v124,v125
v_cvt_pk_bf16_f32 v247,v126,v127
s_mov_b64 exec,s[84:85]
v_swap_b32 v244,v246
v_swap_b32 v245,v247
s_mov_b64 exec,-1
v_accvgpr_write_b32 a156,v244
v_accvgpr_write_b32 a157,v245
v_accvgpr_write_b32 a158,v246
v_accvgpr_write_b32 a159,v247
v_mul_f32 v128,s52,v128
v_mul_f32 v129,s52,v129
v_mul_f32 v130,s52,v130
v_mul_f32 v131,s52,v131
v_mul_f32 v132,s52,v132
v_mul_f32 v133,s52,v133
v_mul_f32 v134,s52,v134
v_mul_f32 v135,s52,v135
v_cvt_pk_bf16_f32 v244,v128,v129
v_cvt_pk_bf16_f32 v245,v130,v131
v_cvt_pk_bf16_f32 v246,v132,v133
v_cvt_pk_bf16_f32 v247,v134,v135
s_mov_b64 exec,s[84:85]
v_swap_b32 v244,v246
v_swap_b32 v245,v247
s_mov_b64 exec,-1
v_accvgpr_write_b32 a160,v244
v_accvgpr_write_b32 a161,v245
v_accvgpr_write_b32 a162,v246
v_accvgpr_write_b32 a163,v247
v_mul_f32 v136,s52,v136
v_mul_f32 v137,s52,v137
v_mul_f32 v138,s52,v138
v_mul_f32 v139,s52,v139
v_mul_f32 v140,s52,v140
v_mul_f32 v141,s52,v141
v_mul_f32 v142,s52,v142
v_mul_f32 v143,s52,v143
v_cvt_pk_bf16_f32 v244,v136,v137
v_cvt_pk_bf16_f32 v245,v138,v139
v_cvt_pk_bf16_f32 v246,v140,v141
v_cvt_pk_bf16_f32 v247,v142,v143
s_mov_b64 exec,s[84:85]
v_swap_b32 v244,v246
v_swap_b32 v245,v247
s_mov_b64 exec,-1
v_accvgpr_write_b32 a164,v244
v_accvgpr_write_b32 a165,v245
v_accvgpr_write_b32 a166,v246
v_accvgpr_write_b32 a167,v247
v_mul_f32 v144,s52,v144
v_mul_f32 v145,s52,v145
v_mul_f32 v146,s52,v146
v_mul_f32 v147,s52,v147
v_mul_f32 v148,s52,v148
v_mul_f32 v149,s52,v149
v_mul_f32 v150,s52,v150
v_mul_f32 v151,s52,v151
v_cvt_pk_bf16_f32 v244,v144,v145
v_cvt_pk_bf16_f32 v245,v146,v147
v_cvt_pk_bf16_f32 v246,v148,v149
v_cvt_pk_bf16_f32 v247,v150,v151
s_mov_b64 exec,s[84:85]
v_swap_b32 v244,v246
v_swap_b32 v245,v247
s_mov_b64 exec,-1
v_accvgpr_write_b32 a168,v244
v_accvgpr_write_b32 a169,v245
v_accvgpr_write_b32 a170,v246
v_accvgpr_write_b32 a171,v247
v_mul_f32 v152,s52,v152
v_mul_f32 v153,s52,v153
v_mul_f32 v154,s52,v154
v_mul_f32 v155,s52,v155
v_mul_f32 v156,s52,v156
v_mul_f32 v157,s52,v157
v_mul_f32 v158,s52,v158
v_mul_f32 v159,s52,v159
v_cvt_pk_bf16_f32 v244,v152,v153
v_cvt_pk_bf16_f32 v245,v154,v155
v_cvt_pk_bf16_f32 v246,v156,v157
v_cvt_pk_bf16_f32 v247,v158,v159
s_mov_b64 exec,s[84:85]
v_swap_b32 v244,v246
v_swap_b32 v245,v247
s_mov_b64 exec,-1
v_accvgpr_write_b32 a172,v244
v_accvgpr_write_b32 a173,v245
v_accvgpr_write_b32 a174,v246
v_accvgpr_write_b32 a175,v247
v_mul_f32 v160,s52,v160
v_mul_f32 v161,s52,v161
v_mul_f32 v162,s52,v162
v_mul_f32 v163,s52,v163
v_mul_f32 v164,s52,v164
v_mul_f32 v165,s52,v165
v_mul_f32 v166,s52,v166
v_mul_f32 v167,s52,v167
v_cvt_pk_bf16_f32 v244,v160,v161
v_cvt_pk_bf16_f32 v245,v162,v163
v_cvt_pk_bf16_f32 v246,v164,v165
v_cvt_pk_bf16_f32 v247,v166,v167
s_mov_b64 exec,s[84:85]
v_swap_b32 v244,v246
v_swap_b32 v245,v247
s_mov_b64 exec,-1
v_accvgpr_write_b32 a176,v244
v_accvgpr_write_b32 a177,v245
v_accvgpr_write_b32 a178,v246
v_accvgpr_write_b32 a179,v247
v_mul_f32 v168,s52,v168
v_mul_f32 v169,s52,v169
v_mul_f32 v170,s52,v170
v_mul_f32 v171,s52,v171
v_mul_f32 v172,s52,v172
v_mul_f32 v173,s52,v173
v_mul_f32 v174,s52,v174
v_mul_f32 v175,s52,v175
v_cvt_pk_bf16_f32 v244,v168,v169
v_cvt_pk_bf16_f32 v245,v170,v171
v_cvt_pk_bf16_f32 v246,v172,v173
v_cvt_pk_bf16_f32 v247,v174,v175
s_mov_b64 exec,s[84:85]
v_swap_b32 v244,v246
v_swap_b32 v245,v247
s_mov_b64 exec,-1
v_accvgpr_write_b32 a180,v244
v_accvgpr_write_b32 a181,v245
v_accvgpr_write_b32 a182,v246
v_accvgpr_write_b32 a183,v247
v_mul_f32 v176,s52,v176
v_mul_f32 v177,s52,v177
v_mul_f32 v178,s52,v178
v_mul_f32 v179,s52,v179
v_mul_f32 v180,s52,v180
v_mul_f32 v181,s52,v181
v_mul_f32 v182,s52,v182
v_mul_f32 v183,s52,v183
v_cvt_pk_bf16_f32 v244,v176,v177
v_cvt_pk_bf16_f32 v245,v178,v179
v_cvt_pk_bf16_f32 v246,v180,v181
v_cvt_pk_bf16_f32 v247,v182,v183
s_mov_b64 exec,s[84:85]
v_swap_b32 v244,v246
v_swap_b32 v245,v247
s_mov_b64 exec,-1
v_accvgpr_write_b32 a184,v244
v_accvgpr_write_b32 a185,v245
v_accvgpr_write_b32 a186,v246
v_accvgpr_write_b32 a187,v247
v_mul_f32 v184,s52,v184
v_mul_f32 v185,s52,v185
v_mul_f32 v186,s52,v186
v_mul_f32 v187,s52,v187
v_mul_f32 v188,s52,v188
v_mul_f32 v189,s52,v189
v_mul_f32 v190,s52,v190
v_mul_f32 v191,s52,v191
v_cvt_pk_bf16_f32 v244,v184,v185
v_cvt_pk_bf16_f32 v245,v186,v187
v_cvt_pk_bf16_f32 v246,v188,v189
v_cvt_pk_bf16_f32 v247,v190,v191
s_mov_b64 exec,s[84:85]
v_swap_b32 v244,v246
v_swap_b32 v245,v247
s_mov_b64 exec,-1
v_accvgpr_write_b32 a188,v244
v_accvgpr_write_b32 a189,v245
v_accvgpr_write_b32 a190,v246
v_accvgpr_write_b32 a191,v247
v_mov_b32 v240,0xff800000
v_mov_b32 v241,0xff800000
v_mov_b32 v242,0xff800000
v_mov_b32 v243,0xff800000
s_lshl_b32 s48,s29,17
s_lshl_b32 s54,s28,12
s_add_u32 s48,s48,s54
s_mov_b32 s49,s48
s_mov_b32 s42,8
K1_SLOW_P1:
s_barrier
s_lshl_b32 s54,s28,12
s_add_u32 m0,s54,0
s_nop 0
buffer_load_dwordx4 v21,s[12:15],s48 offen lds
buffer_load_dwordx4 v22,s[12:15],s48 offen offset:1024 lds
buffer_load_dwordx4 v23,s[12:15],s48 offen offset:2048 lds
buffer_load_dwordx4 v24,s[12:15],s48 offen offset:3072 lds
s_add_u32 s48,s48,16384
s_waitcnt vmcnt(0)
s_barrier
ds_read_b128 v[32:35],v8
ds_read_b128 v[36:39],v8 offset:256
ds_read_b128 v[40:43],v8 offset:512
ds_read_b128 v[44:47],v8 offset:768
s_waitcnt lgkmcnt(3)
M v[64:67],v[32:35],a[128:131],0
s_waitcnt lgkmcnt(2)
M v[64:67],v[36:39],a[132:135],v[64:67]
s_waitcnt lgkmcnt(1)
M v[64:67],v[40:43],a[136:139],v[64:67]
s_waitcnt lgkmcnt(0)
M v[64:67],v[44:47],a[140:143],v[64:67]
M v[80:83],v[32:35],a[144:147],0
M v[80:83],v[36:39],a[148:151],v[80:83]
M v[80:83],v[40:43],a[152:155],v[80:83]
M v[80:83],v[44:47],a[156:159],v[80:83]
M v[96:99],v[32:35],a[160:163],0
M v[96:99],v[36:39],a[164:167],v[96:99]
M v[96:99],v[40:43],a[168:171],v[96:99]
M v[96:99],v[44:47],a[172:175],v[96:99]
M v[112:115],v[32:35],a[176:179],0
M v[112:115],v[36:39],a[180:183],v[112:115]
M v[112:115],v[40:43],a[184:187],v[112:115]
M v[112:115],v[44:47],a[188:191],v[112:115]
ds_read_b128 v[32:35],v8 offset:4096
ds_read_b128 v[36:39],v8 offset:4352
ds_read_b128 v[40:43],v8 offset:4608
ds_read_b128 v[44:47],v8 offset:4864
s_waitcnt lgkmcnt(3)
M v[68:71],v[32:35],a[128:131],0
s_waitcnt lgkmcnt(2)
M v[68:71],v[36:39],a[132:135],v[68:71]
s_waitcnt lgkmcnt(1)
M v[68:71],v[40:43],a[136:139],v[68:71]
s_waitcnt lgkmcnt(0)
M v[68:71],v[44:47],a[140:143],v[68:71]
M v[84:87],v[32:35],a[144:147],0
M v[84:87],v[36:39],a[148:151],v[84:87]
M v[84:87],v[40:43],a[152:155],v[84:87]
M v[84:87],v[44:47],a[156:159],v[84:87]
M v[100:103],v[32:35],a[160:163],0
M v[100:103],v[36:39],a[164:167],v[100:103]
M v[100:103],v[40:43],a[168:171],v[100:103]
M v[100:103],v[44:47],a[172:175],v[100:103]
M v[116:119],v[32:35],a[176:179],0
M v[116:119],v[36:39],a[180:183],v[116:119]
M v[116:119],v[40:43],a[184:187],v[116:119]
M v[116:119],v[44:47],a[188:191],v[116:119]
ds_read_b128 v[32:35],v8 offset:8192
ds_read_b128 v[36:39],v8 offset:8448
ds_read_b128 v[40:43],v8 offset:8704
ds_read_b128 v[44:47],v8 offset:8960
s_waitcnt lgkmcnt(3)
M v[72:75],v[32:35],a[128:131],0
s_waitcnt lgkmcnt(2)
M v[72:75],v[36:39],a[132:135],v[72:75]
s_waitcnt lgkmcnt(1)
M v[72:75],v[40:43],a[136:139],v[72:75]
s_waitcnt lgkmcnt(0)
M v[72:75],v[44:47],a[140:143],v[72:75]
M v[88:91],v[32:35],a[144:147],0
M v[88:91],v[36:39],a[148:151],v[88:91]
M v[88:91],v[40:43],a[152:155],v[88:91]
M v[88:91],v[44:47],a[156:159],v[88:91]
M v[104:107],v[32:35],a[160:163],0
M v[104:107],v[36:39],a[164:167],v[104:107]
M v[104:107],v[40:43],a[168:171],v[104:107]
M v[104:107],v[44:47],a[172:175],v[104:107]
M v[120:123],v[32:35],a[176:179],0
M v[120:123],v[36:39],a[180:183],v[120:123]
M v[120:123],v[40:43],a[184:187],v[120:123]
M v[120:123],v[44:47],a[188:191],v[120:123]
ds_read_b128 v[32:35],v8 offset:12288
ds_read_b128 v[36:39],v8 offset:12544
ds_read_b128 v[40:43],v8 offset:12800
ds_read_b128 v[44:47],v8 offset:13056
s_waitcnt lgkmcnt(3)
M v[76:79],v[32:35],a[128:131],0
s_waitcnt lgkmcnt(2)
M v[76:79],v[36:39],a[132:135],v[76:79]
s_waitcnt lgkmcnt(1)
M v[76:79],v[40:43],a[136:139],v[76:79]
s_waitcnt lgkmcnt(0)
M v[76:79],v[44:47],a[140:143],v[76:79]
M v[92:95],v[32:35],a[144:147],0
M v[92:95],v[36:39],a[148:151],v[92:95]
M v[92:95],v[40:43],a[152:155],v[92:95]
M v[92:95],v[44:47],a[156:159],v[92:95]
M v[108:111],v[32:35],a[160:163],0
M v[108:111],v[36:39],a[164:167],v[108:111]
M v[108:111],v[40:43],a[168:171],v[108:111]
M v[108:111],v[44:47],a[172:175],v[108:111]
M v[124:127],v[32:35],a[176:179],0
M v[124:127],v[36:39],a[180:183],v[124:127]
M v[124:127],v[40:43],a[184:187],v[124:127]
M v[124:127],v[44:47],a[188:191],v[124:127]
v_max_f32 v240,v240,v64
v_max_f32 v240,v240,v65
v_max_f32 v240,v240,v66
v_max_f32 v240,v240,v67
v_max_f32 v240,v240,v68
v_max_f32 v240,v240,v69
v_max_f32 v240,v240,v70
v_max_f32 v240,v240,v71
v_max_f32 v240,v240,v72
v_max_f32 v240,v240,v73
v_max_f32 v240,v240,v74
v_max_f32 v240,v240,v75
v_max_f32 v240,v240,v76
v_max_f32 v240,v240,v77
v_max_f32 v240,v240,v78
v_max_f32 v240,v240,v79
v_max_f32 v241,v241,v80
v_max_f32 v241,v241,v81
v_max_f32 v241,v241,v82
v_max_f32 v241,v241,v83
v_max_f32 v241,v241,v84
v_max_f32 v241,v241,v85
v_max_f32 v241,v241,v86
v_max_f32 v241,v241,v87
v_max_f32 v241,v241,v88
v_max_f32 v241,v241,v89
v_max_f32 v241,v241,v90
v_max_f32 v241,v241,v91
v_max_f32 v241,v241,v92
v_max_f32 v241,v241,v93
v_max_f32 v241,v241,v94
v_max_f32 v241,v241,v95
v_max_f32 v242,v242,v96
v_max_f32 v242,v242,v97
v_max_f32 v242,v242,v98
v_max_f32 v242,v242,v99
v_max_f32 v242,v242,v100
v_max_f32 v242,v242,v101
v_max_f32 v242,v242,v102
v_max_f32 v242,v242,v103
v_max_f32 v242,v242,v104
v_max_f32 v242,v242,v105
v_max_f32 v242,v242,v106
v_max_f32 v242,v242,v107
v_max_f32 v242,v242,v108
v_max_f32 v242,v242,v109
v_max_f32 v242,v242,v110
v_max_f32 v242,v242,v111
v_max_f32 v243,v243,v112
v_max_f32 v243,v243,v113
v_max_f32 v243,v243,v114
v_max_f32 v243,v243,v115
v_max_f32 v243,v243,v116
v_max_f32 v243,v243,v117
v_max_f32 v243,v243,v118
v_max_f32 v243,v243,v119
v_max_f32 v243,v243,v120
v_max_f32 v243,v243,v121
v_max_f32 v243,v243,v122
v_max_f32 v243,v243,v123
v_max_f32 v243,v243,v124
v_max_f32 v243,v243,v125
v_max_f32 v243,v243,v126
v_max_f32 v243,v243,v127
s_sub_u32 s42,s42,1
s_cmp_lg_u32 s42,0
s_cbranch_scc1 K1_SLOW_P1
v_mov_b32 v244,v240
s_nop 1
v_permlane16_swap_b32 v240,v244
v_max_f32 v240,v240,v244
v_mov_b32 v244,v240
s_nop 1
v_permlane32_swap_b32 v240,v244
v_max_f32 v240,v240,v244
v_sub_f32 v224,0,v240
v_sub_f32 v225,0,v240
v_sub_f32 v226,0,v240
v_sub_f32 v227,0,v240
v_mov_b32 v0,0
v_mov_b32 v244,v241
s_nop 1
v_permlane16_swap_b32 v241,v244
v_max_f32 v241,v241,v244
v_mov_b32 v244,v241
s_nop 1
v_permlane32_swap_b32 v241,v244
v_max_f32 v241,v241,v244
v_sub_f32 v228,0,v241
v_sub_f32 v229,0,v241
v_sub_f32 v230,0,v241
v_sub_f32 v231,0,v241
v_mov_b32 v1,0
v_mov_b32 v244,v242
s_nop 1
v_permlane16_swap_b32 v242,v244
v_max_f32 v242,v242,v244
v_mov_b32 v244,v242
s_nop 1
v_permlane32_swap_b32 v242,v244
v_max_f32 v242,v242,v244
v_sub_f32 v232,0,v242
v_sub_f32 v233,0,v242
v_sub_f32 v234,0,v242
v_sub_f32 v235,0,v242
v_mov_b32 v2,0
v_mov_b32 v244,v243
s_nop 1
v_permlane16_swap_b32 v243,v244
v_max_f32 v243,v243,v244
v_mov_b32 v244,v243
s_nop 1
v_permlane32_swap_b32 v243,v244
v_max_f32 v243,v243,v244
v_sub_f32 v236,0,v243
v_sub_f32 v237,0,v243
v_sub_f32 v238,0,v243
v_sub_f32 v239,0,v243
v_mov_b32 v3,0
v_accvgpr_write_b32 a0,0
v_accvgpr_write_b32 a1,0
v_accvgpr_write_b32 a2,0
v_accvgpr_write_b32 a3,0
v_accvgpr_write_b32 a4,0
v_accvgpr_write_b32 a5,0
v_accvgpr_write_b32 a6,0
v_accvgpr_write_b32 a7,0
v_accvgpr_write_b32 a8,0
v_accvgpr_write_b32 a9,0
v_accvgpr_write_b32 a10,0
v_accvgpr_write_b32 a11,0
v_accvgpr_write_b32 a12,0
v_accvgpr_write_b32 a13,0
v_accvgpr_write_b32 a14,0
v_accvgpr_write_b32 a15,0
v_accvgpr_write_b32 a16,0
v_accvgpr_write_b32 a17,0
v_accvgpr_write_b32 a18,0
v_accvgpr_write_b32 a19,0
v_accvgpr_write_b32 a20,0
v_accvgpr_write_b32 a21,0
v_accvgpr_write_b32 a22,0
v_accvgpr_write_b32 a23,0
v_accvgpr_write_b32 a24,0
v_accvgpr_write_b32 a25,0
v_accvgpr_write_b32 a26,0
v_accvgpr_write_b32 a27,0
v_accvgpr_write_b32 a28,0
v_accvgpr_write_b32 a29,0
v_accvgpr_write_b32 a30,0
v_accvgpr_write_b32 a31,0
v_accvgpr_write_b32 a32,0
v_accvgpr_write_b32 a33,0
v_accvgpr_write_b32 a34,0
v_accvgpr_write_b32 a35,0
v_accvgpr_write_b32 a36,0
v_accvgpr_write_b32 a37,0
v_accvgpr_write_b32 a38,0
v_accvgpr_write_b32 a39,0
v_accvgpr_write_b32 a40,0
v_accvgpr_write_b32 a41,0
v_accvgpr_write_b32 a42,0
v_accvgpr_write_b32 a43,0
v_accvgpr_write_b32 a44,0
v_accvgpr_write_b32 a45,0
v_accvgpr_write_b32 a46,0
v_accvgpr_write_b32 a47,0
v_accvgpr_write_b32 a48,0
v_accvgpr_write_b32 a49,0
v_accvgpr_write_b32 a50,0
v_accvgpr_write_b32 a51,0
v_accvgpr_write_b32 a52,0
v_accvgpr_write_b32 a53,0
v_accvgpr_write_b32 a54,0
v_accvgpr_write_b32 a55,0
v_accvgpr_write_b32 a56,0
v_accvgpr_write_b32 a57,0
v_accvgpr_write_b32 a58,0
v_accvgpr_write_b32 a59,0
v_accvgpr_write_b32 a60,0
v_accvgpr_write_b32 a61,0
v_accvgpr_write_b32 a62,0
v_accvgpr_write_b32 a63,0
v_accvgpr_write_b32 a64,0
v_accvgpr_write_b32 a65,0
v_accvgpr_write_b32 a66,0
v_accvgpr_write_b32 a67,0
v_accvgpr_write_b32 a68,0
v_accvgpr_write_b32 a69,0
v_accvgpr_write_b32 a70,0
v_accvgpr_write_b32 a71,0
v_accvgpr_write_b32 a72,0
v_accvgpr_write_b32 a73,0
v_accvgpr_write_b32 a74,0
v_accvgpr_write_b32 a75,0
v_accvgpr_write_b32 a76,0
v_accvgpr_write_b32 a77,0
v_accvgpr_write_b32 a78,0
v_accvgpr_write_b32 a79,0
v_accvgpr_write_b32 a80,0
v_accvgpr_write_b32 a81,0
v_accvgpr_write_b32 a82,0
v_accvgpr_write_b32 a83,0
v_accvgpr_write_b32 a84,0
v_accvgpr_write_b32 a85,0
v_accvgpr_write_b32 a86,0
v_accvgpr_write_b32 a87,0
v_accvgpr_write_b32 a88,0
v_accvgpr_write_b32 a89,0
v_accvgpr_write_b32 a90,0
v_accvgpr_write_b32 a91,0
v_accvgpr_write_b32 a92,0
v_accvgpr_write_b32 a93,0
v_accvgpr_write_b32 a94,0
v_accvgpr_write_b32 a95,0
v_accvgpr_write_b32 a96,0
v_accvgpr_write_b32 a97,0
v_accvgpr_write_b32 a98,0
v_accvgpr_write_b32 a99,0
v_accvgpr_write_b32 a100,0
v_accvgpr_write_b32 a101,0
v_accvgpr_write_b32 a102,0
v_accvgpr_write_b32 a103,0
v_accvgpr_write_b32 a104,0
v_accvgpr_write_b32 a105,0
v_accvgpr_write_b32 a106,0
v_accvgpr_write_b32 a107,0
v_accvgpr_write_b32 a108,0
v_accvgpr_write_b32 a109,0
v_accvgpr_write_b32 a110,0
v_accvgpr_write_b32 a111,0
v_accvgpr_write_b32 a112,0
v_accvgpr_write_b32 a113,0
v_accvgpr_write_b32 a114,0
v_accvgpr_write_b32 a115,0
v_accvgpr_write_b32 a116,0
v_accvgpr_write_b32 a117,0
v_accvgpr_write_b32 a118,0
v_accvgpr_write_b32 a119,0
v_accvgpr_write_b32 a120,0
v_accvgpr_write_b32 a121,0
v_accvgpr_write_b32 a122,0
v_accvgpr_write_b32 a123,0
v_accvgpr_write_b32 a124,0
v_accvgpr_write_b32 a125,0
v_accvgpr_write_b32 a126,0
v_accvgpr_write_b32 a127,0
s_mov_b32 s48,s49
s_mov_b32 s42,8
K1_SLOW_P2:
s_barrier
s_lshl_b32 s54,s28,12
s_add_u32 m0,s54,0
s_nop 0
buffer_load_dwordx4 v21,s[12:15],s48 offen lds
buffer_load_dwordx4 v22,s[12:15],s48 offen offset:1024 lds
buffer_load_dwordx4 v23,s[12:15],s48 offen offset:2048 lds
buffer_load_dwordx4 v24,s[12:15],s48 offen offset:3072 lds
s_add_u32 m0,s54,65536
s_nop 0
buffer_load_dwordx4 v25,s[16:19],s48 offen lds
buffer_load_dwordx4 v26,s[16:19],s48 offen offset:1024 lds
buffer_load_dwordx4 v25,s[16:19],s48 offen offset:2048 lds
buffer_load_dwordx4 v26,s[16:19],s48 offen offset:3072 lds
s_add_u32 s48,s48,16384
s_waitcnt vmcnt(0)
s_barrier
ds_read_b128 v[32:35],v8
ds_read_b128 v[36:39],v8 offset:256
ds_read_b128 v[40:43],v8 offset:512
ds_read_b128 v[44:47],v8 offset:768
s_waitcnt lgkmcnt(3)
M v[64:67],v[32:35],a[128:131],v[224:227]
s_waitcnt lgkmcnt(2)
M v[64:67],v[36:39],a[132:135],v[64:67]
s_waitcnt lgkmcnt(1)
M v[64:67],v[40:43],a[136:139],v[64:67]
s_waitcnt lgkmcnt(0)
M v[64:67],v[44:47],a[140:143],v[64:67]
M v[80:83],v[32:35],a[144:147],v[228:231]
M v[80:83],v[36:39],a[148:151],v[80:83]
M v[80:83],v[40:43],a[152:155],v[80:83]
M v[80:83],v[44:47],a[156:159],v[80:83]
M v[96:99],v[32:35],a[160:163],v[232:235]
M v[96:99],v[36:39],a[164:167],v[96:99]
M v[96:99],v[40:43],a[168:171],v[96:99]
M v[96:99],v[44:47],a[172:175],v[96:99]
M v[112:115],v[32:35],a[176:179],v[236:239]
M v[112:115],v[36:39],a[180:183],v[112:115]
M v[112:115],v[40:43],a[184:187],v[112:115]
M v[112:115],v[44:47],a[188:191],v[112:115]
ds_read_b128 v[32:35],v8 offset:4096
ds_read_b128 v[36:39],v8 offset:4352
ds_read_b128 v[40:43],v8 offset:4608
ds_read_b128 v[44:47],v8 offset:4864
s_waitcnt lgkmcnt(3)
M v[68:71],v[32:35],a[128:131],v[224:227]
s_waitcnt lgkmcnt(2)
M v[68:71],v[36:39],a[132:135],v[68:71]
s_waitcnt lgkmcnt(1)
M v[68:71],v[40:43],a[136:139],v[68:71]
s_waitcnt lgkmcnt(0)
M v[68:71],v[44:47],a[140:143],v[68:71]
M v[84:87],v[32:35],a[144:147],v[228:231]
M v[84:87],v[36:39],a[148:151],v[84:87]
M v[84:87],v[40:43],a[152:155],v[84:87]
M v[84:87],v[44:47],a[156:159],v[84:87]
M v[100:103],v[32:35],a[160:163],v[232:235]
M v[100:103],v[36:39],a[164:167],v[100:103]
M v[100:103],v[40:43],a[168:171],v[100:103]
M v[100:103],v[44:47],a[172:175],v[100:103]
M v[116:119],v[32:35],a[176:179],v[236:239]
M v[116:119],v[36:39],a[180:183],v[116:119]
M v[116:119],v[40:43],a[184:187],v[116:119]
M v[116:119],v[44:47],a[188:191],v[116:119]
ds_read_b128 v[32:35],v8 offset:8192
ds_read_b128 v[36:39],v8 offset:8448
ds_read_b128 v[40:43],v8 offset:8704
ds_read_b128 v[44:47],v8 offset:8960
s_waitcnt lgkmcnt(3)
M v[72:75],v[32:35],a[128:131],v[224:227]
s_waitcnt lgkmcnt(2)
M v[72:75],v[36:39],a[132:135],v[72:75]
s_waitcnt lgkmcnt(1)
M v[72:75],v[40:43],a[136:139],v[72:75]
s_waitcnt lgkmcnt(0)
M v[72:75],v[44:47],a[140:143],v[72:75]
M v[88:91],v[32:35],a[144:147],v[228:231]
M v[88:91],v[36:39],a[148:151],v[88:91]
M v[88:91],v[40:43],a[152:155],v[88:91]
M v[88:91],v[44:47],a[156:159],v[88:91]
M v[104:107],v[32:35],a[160:163],v[232:235]
M v[104:107],v[36:39],a[164:167],v[104:107]
M v[104:107],v[40:43],a[168:171],v[104:107]
M v[104:107],v[44:47],a[172:175],v[104:107]
M v[120:123],v[32:35],a[176:179],v[236:239]
M v[120:123],v[36:39],a[180:183],v[120:123]
M v[120:123],v[40:43],a[184:187],v[120:123]
M v[120:123],v[44:47],a[188:191],v[120:123]
ds_read_b128 v[32:35],v8 offset:12288
ds_read_b128 v[36:39],v8 offset:12544
ds_read_b128 v[40:43],v8 offset:12800
ds_read_b128 v[44:47],v8 offset:13056
s_waitcnt lgkmcnt(3)
M v[76:79],v[32:35],a[128:131],v[224:227]
s_waitcnt lgkmcnt(2)
M v[76:79],v[36:39],a[132:135],v[76:79]
s_waitcnt lgkmcnt(1)
M v[76:79],v[40:43],a[136:139],v[76:79]
s_waitcnt lgkmcnt(0)
M v[76:79],v[44:47],a[140:143],v[76:79]
M v[92:95],v[32:35],a[144:147],v[228:231]
M v[92:95],v[36:39],a[148:151],v[92:95]
M v[92:95],v[40:43],a[152:155],v[92:95]
M v[92:95],v[44:47],a[156:159],v[92:95]
M v[108:111],v[32:35],a[160:163],v[232:235]
M v[108:111],v[36:39],a[164:167],v[108:111]
M v[108:111],v[40:43],a[168:171],v[108:111]
M v[108:111],v[44:47],a[172:175],v[108:111]
M v[124:127],v[32:35],a[176:179],v[236:239]
M v[124:127],v[36:39],a[180:183],v[124:127]
M v[124:127],v[40:43],a[184:187],v[124:127]
M v[124:127],v[44:47],a[188:191],v[124:127]
v_exp_f32 v64,v64
v_exp_f32 v65,v65
v_exp_f32 v66,v66
v_exp_f32 v67,v67
v_add_f32 v0,v0,v64
v_add_f32 v0,v0,v65
v_add_f32 v0,v0,v66
v_add_f32 v0,v0,v67
v_cvt_pk_bf16_f32 v192,v64,v65
v_cvt_pk_bf16_f32 v193,v66,v67
v_exp_f32 v68,v68
v_exp_f32 v69,v69
v_exp_f32 v70,v70
v_exp_f32 v71,v71
v_add_f32 v0,v0,v68
v_add_f32 v0,v0,v69
v_add_f32 v0,v0,v70
v_add_f32 v0,v0,v71
v_cvt_pk_bf16_f32 v194,v68,v69
v_cvt_pk_bf16_f32 v195,v70,v71
v_exp_f32 v72,v72
v_exp_f32 v73,v73
v_exp_f32 v74,v74
v_exp_f32 v75,v75
v_add_f32 v0,v0,v72
v_add_f32 v0,v0,v73
v_add_f32 v0,v0,v74
v_add_f32 v0,v0,v75
v_cvt_pk_bf16_f32 v196,v72,v73
v_cvt_pk_bf16_f32 v197,v74,v75
v_exp_f32 v76,v76
v_exp_f32 v77,v77
v_exp_f32 v78,v78
v_exp_f32 v79,v79
v_add_f32 v0,v0,v76
v_add_f32 v0,v0,v77
v_add_f32 v0,v0,v78
v_add_f32 v0,v0,v79
v_cvt_pk_bf16_f32 v198,v76,v77
v_cvt_pk_bf16_f32 v199,v78,v79
v_exp_f32 v80,v80
v_exp_f32 v81,v81
v_exp_f32 v82,v82
v_exp_f32 v83,v83
v_add_f32 v1,v1,v80
v_add_f32 v1,v1,v81
v_add_f32 v1,v1,v82
v_add_f32 v1,v1,v83
v_cvt_pk_bf16_f32 v200,v80,v81
v_cvt_pk_bf16_f32 v201,v82,v83
v_exp_f32 v84,v84
v_exp_f32 v85,v85
v_exp_f32 v86,v86
v_exp_f32 v87,v87
v_add_f32 v1,v1,v84
v_add_f32 v1,v1,v85
v_add_f32 v1,v1,v86
v_add_f32 v1,v1,v87
v_cvt_pk_bf16_f32 v202,v84,v85
v_cvt_pk_bf16_f32 v203,v86,v87
v_exp_f32 v88,v88
v_exp_f32 v89,v89
v_exp_f32 v90,v90
v_exp_f32 v91,v91
v_add_f32 v1,v1,v88
v_add_f32 v1,v1,v89
v_add_f32 v1,v1,v90
v_add_f32 v1,v1,v91
v_cvt_pk_bf16_f32 v204,v88,v89
v_cvt_pk_bf16_f32 v205,v90,v91
v_exp_f32 v92,v92
v_exp_f32 v93,v93
v_exp_f32 v94,v94
v_exp_f32 v95,v95
v_add_f32 v1,v1,v92
v_add_f32 v1,v1,v93
v_add_f32 v1,v1,v94
v_add_f32 v1,v1,v95
v_cvt_pk_bf16_f32 v206,v92,v93
v_cvt_pk_bf16_f32 v207,v94,v95
v_exp_f32 v96,v96
v_exp_f32 v97,v97
v_exp_f32 v98,v98
v_exp_f32 v99,v99
v_add_f32 v2,v2,v96
v_add_f32 v2,v2,v97
v_add_f32 v2,v2,v98
v_add_f32 v2,v2,v99
v_cvt_pk_bf16_f32 v208,v96,v97
v_cvt_pk_bf16_f32 v209,v98,v99
v_exp_f32 v100,v100
v_exp_f32 v101,v101
v_exp_f32 v102,v102
v_exp_f32 v103,v103
v_add_f32 v2,v2,v100
v_add_f32 v2,v2,v101
v_add_f32 v2,v2,v102
v_add_f32 v2,v2,v103
v_cvt_pk_bf16_f32 v210,v100,v101
v_cvt_pk_bf16_f32 v211,v102,v103
v_exp_f32 v104,v104
v_exp_f32 v105,v105
v_exp_f32 v106,v106
v_exp_f32 v107,v107
v_add_f32 v2,v2,v104
v_add_f32 v2,v2,v105
v_add_f32 v2,v2,v106
v_add_f32 v2,v2,v107
v_cvt_pk_bf16_f32 v212,v104,v105
v_cvt_pk_bf16_f32 v213,v106,v107
v_exp_f32 v108,v108
v_exp_f32 v109,v109
v_exp_f32 v110,v110
v_exp_f32 v111,v111
v_add_f32 v2,v2,v108
v_add_f32 v2,v2,v109
v_add_f32 v2,v2,v110
v_add_f32 v2,v2,v111
v_cvt_pk_bf16_f32 v214,v108,v109
v_cvt_pk_bf16_f32 v215,v110,v111
v_exp_f32 v112,v112
v_exp_f32 v113,v113
v_exp_f32 v114,v114
v_exp_f32 v115,v115
v_add_f32 v3,v3,v112
v_add_f32 v3,v3,v113
v_add_f32 v3,v3,v114
v_add_f32 v3,v3,v115
v_cvt_pk_bf16_f32 v216,v112,v113
v_cvt_pk_bf16_f32 v217,v114,v115
v_exp_f32 v116,v116
v_exp_f32 v117,v117
v_exp_f32 v118,v118
v_exp_f32 v119,v119
v_add_f32 v3,v3,v116
v_add_f32 v3,v3,v117
v_add_f32 v3,v3,v118
v_add_f32 v3,v3,v119
v_cvt_pk_bf16_f32 v218,v116,v117
v_cvt_pk_bf16_f32 v219,v118,v119
v_exp_f32 v120,v120
v_exp_f32 v121,v121
v_exp_f32 v122,v122
v_exp_f32 v123,v123
v_add_f32 v3,v3,v120
v_add_f32 v3,v3,v121
v_add_f32 v3,v3,v122
v_add_f32 v3,v3,v123
v_cvt_pk_bf16_f32 v220,v120,v121
v_cvt_pk_bf16_f32 v221,v122,v123
v_exp_f32 v124,v124
v_exp_f32 v125,v125
v_exp_f32 v126,v126
v_exp_f32 v127,v127
v_add_f32 v3,v3,v124
v_add_f32 v3,v3,v125
v_add_f32 v3,v3,v126
v_add_f32 v3,v3,v127
v_cvt_pk_bf16_f32 v222,v124,v125
v_cvt_pk_bf16_f32 v223,v126,v127
ds_read_b64_tr_b16 v[48:49],v9
ds_read_b64_tr_b16 v[50:51],v9 offset:4096
ds_read_b64_tr_b16 v[52:53],v9 offset:8192
ds_read_b64_tr_b16 v[54:55],v9 offset:12288
s_waitcnt lgkmcnt(2)
M a[0:3],v[48:51],v[192:195],a[0:3]
s_waitcnt lgkmcnt(0)
M a[0:3],v[52:55],v[196:199],a[0:3]
M a[32:35],v[48:51],v[200:203],a[32:35]
M a[32:35],v[52:55],v[204:207],a[32:35]
M a[64:67],v[48:51],v[208:211],a[64:67]
M a[64:67],v[52:55],v[212:215],a[64:67]
M a[96:99],v[48:51],v[216:219],a[96:99]
M a[96:99],v[52:55],v[220:223],a[96:99]
ds_read_b64_tr_b16 v[48:49],v10
ds_read_b64_tr_b16 v[50:51],v10 offset:4096
ds_read_b64_tr_b16 v[52:53],v10 offset:8192
ds_read_b64_tr_b16 v[54:55],v10 offset:12288
s_waitcnt lgkmcnt(2)
M a[4:7],v[48:51],v[192:195],a[4:7]
s_waitcnt lgkmcnt(0)
M a[4:7],v[52:55],v[196:199],a[4:7]
M a[36:39],v[48:51],v[200:203],a[36:39]
M a[36:39],v[52:55],v[204:207],a[36:39]
M a[68:71],v[48:51],v[208:211],a[68:71]
M a[68:71],v[52:55],v[212:215],a[68:71]
M a[100:103],v[48:51],v[216:219],a[100:103]
M a[100:103],v[52:55],v[220:223],a[100:103]
ds_read_b64_tr_b16 v[48:49],v9 offset:256
ds_read_b64_tr_b16 v[50:51],v9 offset:4352
ds_read_b64_tr_b16 v[52:53],v9 offset:8448
ds_read_b64_tr_b16 v[54:55],v9 offset:12544
s_waitcnt lgkmcnt(2)
M a[8:11],v[48:51],v[192:195],a[8:11]
s_waitcnt lgkmcnt(0)
M a[8:11],v[52:55],v[196:199],a[8:11]
M a[40:43],v[48:51],v[200:203],a[40:43]
M a[40:43],v[52:55],v[204:207],a[40:43]
M a[72:75],v[48:51],v[208:211],a[72:75]
M a[72:75],v[52:55],v[212:215],a[72:75]
M a[104:107],v[48:51],v[216:219],a[104:107]
M a[104:107],v[52:55],v[220:223],a[104:107]
ds_read_b64_tr_b16 v[48:49],v10 offset:256
ds_read_b64_tr_b16 v[50:51],v10 offset:4352
ds_read_b64_tr_b16 v[52:53],v10 offset:8448
ds_read_b64_tr_b16 v[54:55],v10 offset:12544
s_waitcnt lgkmcnt(2)
M a[12:15],v[48:51],v[192:195],a[12:15]
s_waitcnt lgkmcnt(0)
M a[12:15],v[52:55],v[196:199],a[12:15]
M a[44:47],v[48:51],v[200:203],a[44:47]
M a[44:47],v[52:55],v[204:207],a[44:47]
M a[76:79],v[48:51],v[208:211],a[76:79]
M a[76:79],v[52:55],v[212:215],a[76:79]
M a[108:111],v[48:51],v[216:219],a[108:111]
M a[108:111],v[52:55],v[220:223],a[108:111]
ds_read_b64_tr_b16 v[48:49],v9 offset:512
ds_read_b64_tr_b16 v[50:51],v9 offset:4608
ds_read_b64_tr_b16 v[52:53],v9 offset:8704
ds_read_b64_tr_b16 v[54:55],v9 offset:12800
s_waitcnt lgkmcnt(2)
M a[16:19],v[48:51],v[192:195],a[16:19]
s_waitcnt lgkmcnt(0)
M a[16:19],v[52:55],v[196:199],a[16:19]
M a[48:51],v[48:51],v[200:203],a[48:51]
M a[48:51],v[52:55],v[204:207],a[48:51]
M a[80:83],v[48:51],v[208:211],a[80:83]
M a[80:83],v[52:55],v[212:215],a[80:83]
M a[112:115],v[48:51],v[216:219],a[112:115]
M a[112:115],v[52:55],v[220:223],a[112:115]
ds_read_b64_tr_b16 v[48:49],v10 offset:512
ds_read_b64_tr_b16 v[50:51],v10 offset:4608
ds_read_b64_tr_b16 v[52:53],v10 offset:8704
ds_read_b64_tr_b16 v[54:55],v10 offset:12800
s_waitcnt lgkmcnt(2)
M a[20:23],v[48:51],v[192:195],a[20:23]
s_waitcnt lgkmcnt(0)
M a[20:23],v[52:55],v[196:199],a[20:23]
M a[52:55],v[48:51],v[200:203],a[52:55]
M a[52:55],v[52:55],v[204:207],a[52:55]
M a[84:87],v[48:51],v[208:211],a[84:87]
M a[84:87],v[52:55],v[212:215],a[84:87]
M a[116:119],v[48:51],v[216:219],a[116:119]
M a[116:119],v[52:55],v[220:223],a[116:119]
ds_read_b64_tr_b16 v[48:49],v9 offset:768
ds_read_b64_tr_b16 v[50:51],v9 offset:4864
ds_read_b64_tr_b16 v[52:53],v9 offset:8960
ds_read_b64_tr_b16 v[54:55],v9 offset:13056
s_waitcnt lgkmcnt(2)
M a[24:27],v[48:51],v[192:195],a[24:27]
s_waitcnt lgkmcnt(0)
M a[24:27],v[52:55],v[196:199],a[24:27]
M a[56:59],v[48:51],v[200:203],a[56:59]
M a[56:59],v[52:55],v[204:207],a[56:59]
M a[88:91],v[48:51],v[208:211],a[88:91]
M a[88:91],v[52:55],v[212:215],a[88:91]
M a[120:123],v[48:51],v[216:219],a[120:123]
M a[120:123],v[52:55],v[220:223],a[120:123]
ds_read_b64_tr_b16 v[48:49],v10 offset:768
ds_read_b64_tr_b16 v[50:51],v10 offset:4864
ds_read_b64_tr_b16 v[52:53],v10 offset:8960
ds_read_b64_tr_b16 v[54:55],v10 offset:13056
s_waitcnt lgkmcnt(2)
M a[28:31],v[48:51],v[192:195],a[28:31]
s_waitcnt lgkmcnt(0)
M a[28:31],v[52:55],v[196:199],a[28:31]
M a[60:63],v[48:51],v[200:203],a[60:63]
M a[60:63],v[52:55],v[204:207],a[60:63]
M a[92:95],v[48:51],v[208:211],a[92:95]
M a[92:95],v[52:55],v[212:215],a[92:95]
M a[124:127],v[48:51],v[216:219],a[124:127]
M a[124:127],v[52:55],v[220:223],a[124:127]
s_sub_u32 s42,s42,1
s_cmp_lg_u32 s42,0
s_cbranch_scc1 K1_SLOW_P2
s_lshl_b32 s54,s29,12
s_add_u32 s44,s54,0
s_add_u32 s45,s54,131072
s_add_u32 s46,s54,262144
s_add_u32 s47,s54,393216
v_mov_b32 v244,v0
s_nop 1
v_permlane16_swap_b32 v0,v244
v_add_f32 v0,v0,v244
v_mov_b32 v244,v0
s_nop 1
v_permlane32_swap_b32 v0,v244
v_add_f32 v0,v0,v244
v_rcp_f32 v4,v0
v_accvgpr_read_b32 v248,a0
v_accvgpr_read_b32 v249,a1
v_accvgpr_read_b32 v250,a2
v_accvgpr_read_b32 v251,a3
v_accvgpr_read_b32 v252,a4
v_accvgpr_read_b32 v253,a5
v_accvgpr_read_b32 v254,a6
v_accvgpr_read_b32 v255,a7
v_mul_f32 v248,v4,v248
v_mul_f32 v249,v4,v249
v_mul_f32 v250,v4,v250
v_mul_f32 v251,v4,v251
v_mul_f32 v252,v4,v252
v_mul_f32 v253,v4,v253
v_mul_f32 v254,v4,v254
v_mul_f32 v255,v4,v255
v_cvt_pk_bf16_f32 v244,v248,v249
v_cvt_pk_bf16_f32 v245,v250,v251
v_cvt_pk_bf16_f32 v246,v252,v253
v_cvt_pk_bf16_f32 v247,v254,v255
buffer_store_dwordx4 v[244:247],v20,s[20:23],s44 offen sc1
v_accvgpr_read_b32 v248,a8
v_accvgpr_read_b32 v249,a9
v_accvgpr_read_b32 v250,a10
v_accvgpr_read_b32 v251,a11
v_accvgpr_read_b32 v252,a12
v_accvgpr_read_b32 v253,a13
v_accvgpr_read_b32 v254,a14
v_accvgpr_read_b32 v255,a15
v_mul_f32 v248,v4,v248
v_mul_f32 v249,v4,v249
v_mul_f32 v250,v4,v250
v_mul_f32 v251,v4,v251
v_mul_f32 v252,v4,v252
v_mul_f32 v253,v4,v253
v_mul_f32 v254,v4,v254
v_mul_f32 v255,v4,v255
v_cvt_pk_bf16_f32 v244,v248,v249
v_cvt_pk_bf16_f32 v245,v250,v251
v_cvt_pk_bf16_f32 v246,v252,v253
v_cvt_pk_bf16_f32 v247,v254,v255
buffer_store_dwordx4 v[244:247],v20,s[20:23],s44 offen offset:1024 sc1
v_accvgpr_read_b32 v248,a16
v_accvgpr_read_b32 v249,a17
v_accvgpr_read_b32 v250,a18
v_accvgpr_read_b32 v251,a19
v_accvgpr_read_b32 v252,a20
v_accvgpr_read_b32 v253,a21
v_accvgpr_read_b32 v254,a22
v_accvgpr_read_b32 v255,a23
v_mul_f32 v248,v4,v248
v_mul_f32 v249,v4,v249
v_mul_f32 v250,v4,v250
v_mul_f32 v251,v4,v251
v_mul_f32 v252,v4,v252
v_mul_f32 v253,v4,v253
v_mul_f32 v254,v4,v254
v_mul_f32 v255,v4,v255
v_cvt_pk_bf16_f32 v244,v248,v249
v_cvt_pk_bf16_f32 v245,v250,v251
v_cvt_pk_bf16_f32 v246,v252,v253
v_cvt_pk_bf16_f32 v247,v254,v255
buffer_store_dwordx4 v[244:247],v20,s[20:23],s44 offen offset:2048 sc1
v_accvgpr_read_b32 v248,a24
v_accvgpr_read_b32 v249,a25
v_accvgpr_read_b32 v250,a26
v_accvgpr_read_b32 v251,a27
v_accvgpr_read_b32 v252,a28
v_accvgpr_read_b32 v253,a29
v_accvgpr_read_b32 v254,a30
v_accvgpr_read_b32 v255,a31
v_mul_f32 v248,v4,v248
v_mul_f32 v249,v4,v249
v_mul_f32 v250,v4,v250
v_mul_f32 v251,v4,v251
v_mul_f32 v252,v4,v252
v_mul_f32 v253,v4,v253
v_mul_f32 v254,v4,v254
v_mul_f32 v255,v4,v255
v_cvt_pk_bf16_f32 v244,v248,v249
v_cvt_pk_bf16_f32 v245,v250,v251
v_cvt_pk_bf16_f32 v246,v252,v253
v_cvt_pk_bf16_f32 v247,v254,v255
buffer_store_dwordx4 v[244:247],v20,s[20:23],s44 offen offset:3072 sc1
s_nop 1
v_mov_b32 v244,v1
s_nop 1
v_permlane16_swap_b32 v1,v244
v_add_f32 v1,v1,v244
v_mov_b32 v244,v1
s_nop 1
v_permlane32_swap_b32 v1,v244
v_add_f32 v1,v1,v244
v_rcp_f32 v5,v1
v_accvgpr_read_b32 v248,a32
v_accvgpr_read_b32 v249,a33
v_accvgpr_read_b32 v250,a34
v_accvgpr_read_b32 v251,a35
v_accvgpr_read_b32 v252,a36
v_accvgpr_read_b32 v253,a37
v_accvgpr_read_b32 v254,a38
v_accvgpr_read_b32 v255,a39
v_mul_f32 v248,v5,v248
v_mul_f32 v249,v5,v249
v_mul_f32 v250,v5,v250
v_mul_f32 v251,v5,v251
v_mul_f32 v252,v5,v252
v_mul_f32 v253,v5,v253
v_mul_f32 v254,v5,v254
v_mul_f32 v255,v5,v255
v_cvt_pk_bf16_f32 v244,v248,v249
v_cvt_pk_bf16_f32 v245,v250,v251
v_cvt_pk_bf16_f32 v246,v252,v253
v_cvt_pk_bf16_f32 v247,v254,v255
buffer_store_dwordx4 v[244:247],v20,s[20:23],s45 offen sc1
v_accvgpr_read_b32 v248,a40
v_accvgpr_read_b32 v249,a41
v_accvgpr_read_b32 v250,a42
v_accvgpr_read_b32 v251,a43
v_accvgpr_read_b32 v252,a44
v_accvgpr_read_b32 v253,a45
v_accvgpr_read_b32 v254,a46
v_accvgpr_read_b32 v255,a47
v_mul_f32 v248,v5,v248
v_mul_f32 v249,v5,v249
v_mul_f32 v250,v5,v250
v_mul_f32 v251,v5,v251
v_mul_f32 v252,v5,v252
v_mul_f32 v253,v5,v253
v_mul_f32 v254,v5,v254
v_mul_f32 v255,v5,v255
v_cvt_pk_bf16_f32 v244,v248,v249
v_cvt_pk_bf16_f32 v245,v250,v251
v_cvt_pk_bf16_f32 v246,v252,v253
v_cvt_pk_bf16_f32 v247,v254,v255
buffer_store_dwordx4 v[244:247],v20,s[20:23],s45 offen offset:1024 sc1
v_accvgpr_read_b32 v248,a48
v_accvgpr_read_b32 v249,a49
v_accvgpr_read_b32 v250,a50
v_accvgpr_read_b32 v251,a51
v_accvgpr_read_b32 v252,a52
v_accvgpr_read_b32 v253,a53
v_accvgpr_read_b32 v254,a54
v_accvgpr_read_b32 v255,a55
v_mul_f32 v248,v5,v248
v_mul_f32 v249,v5,v249
v_mul_f32 v250,v5,v250
v_mul_f32 v251,v5,v251
v_mul_f32 v252,v5,v252
v_mul_f32 v253,v5,v253
v_mul_f32 v254,v5,v254
v_mul_f32 v255,v5,v255
v_cvt_pk_bf16_f32 v244,v248,v249
v_cvt_pk_bf16_f32 v245,v250,v251
v_cvt_pk_bf16_f32 v246,v252,v253
v_cvt_pk_bf16_f32 v247,v254,v255
buffer_store_dwordx4 v[244:247],v20,s[20:23],s45 offen offset:2048 sc1
v_accvgpr_read_b32 v248,a56
v_accvgpr_read_b32 v249,a57
v_accvgpr_read_b32 v250,a58
v_accvgpr_read_b32 v251,a59
v_accvgpr_read_b32 v252,a60
v_accvgpr_read_b32 v253,a61
v_accvgpr_read_b32 v254,a62
v_accvgpr_read_b32 v255,a63
v_mul_f32 v248,v5,v248
v_mul_f32 v249,v5,v249
v_mul_f32 v250,v5,v250
v_mul_f32 v251,v5,v251
v_mul_f32 v252,v5,v252
v_mul_f32 v253,v5,v253
v_mul_f32 v254,v5,v254
v_mul_f32 v255,v5,v255
v_cvt_pk_bf16_f32 v244,v248,v249
v_cvt_pk_bf16_f32 v245,v250,v251
v_cvt_pk_bf16_f32 v246,v252,v253
v_cvt_pk_bf16_f32 v247,v254,v255
buffer_store_dwordx4 v[244:247],v20,s[20:23],s45 offen offset:3072 sc1
s_nop 1
v_mov_b32 v244,v2
s_nop 1
v_permlane16_swap_b32 v2,v244
v_add_f32 v2,v2,v244
v_mov_b32 v244,v2
s_nop 1
v_permlane32_swap_b32 v2,v244
v_add_f32 v2,v2,v244
v_rcp_f32 v6,v2
v_accvgpr_read_b32 v248,a64
v_accvgpr_read_b32 v249,a65
v_accvgpr_read_b32 v250,a66
v_accvgpr_read_b32 v251,a67
v_accvgpr_read_b32 v252,a68
v_accvgpr_read_b32 v253,a69
v_accvgpr_read_b32 v254,a70
v_accvgpr_read_b32 v255,a71
v_mul_f32 v248,v6,v248
v_mul_f32 v249,v6,v249
v_mul_f32 v250,v6,v250
v_mul_f32 v251,v6,v251
v_mul_f32 v252,v6,v252
v_mul_f32 v253,v6,v253
v_mul_f32 v254,v6,v254
v_mul_f32 v255,v6,v255
v_cvt_pk_bf16_f32 v244,v248,v249
v_cvt_pk_bf16_f32 v245,v250,v251
v_cvt_pk_bf16_f32 v246,v252,v253
v_cvt_pk_bf16_f32 v247,v254,v255
buffer_store_dwordx4 v[244:247],v20,s[20:23],s46 offen sc1
v_accvgpr_read_b32 v248,a72
v_accvgpr_read_b32 v249,a73
v_accvgpr_read_b32 v250,a74
v_accvgpr_read_b32 v251,a75
v_accvgpr_read_b32 v252,a76
v_accvgpr_read_b32 v253,a77
v_accvgpr_read_b32 v254,a78
v_accvgpr_read_b32 v255,a79
v_mul_f32 v248,v6,v248
v_mul_f32 v249,v6,v249
v_mul_f32 v250,v6,v250
v_mul_f32 v251,v6,v251
v_mul_f32 v252,v6,v252
v_mul_f32 v253,v6,v253
v_mul_f32 v254,v6,v254
v_mul_f32 v255,v6,v255
v_cvt_pk_bf16_f32 v244,v248,v249
v_cvt_pk_bf16_f32 v245,v250,v251
v_cvt_pk_bf16_f32 v246,v252,v253
v_cvt_pk_bf16_f32 v247,v254,v255
buffer_store_dwordx4 v[244:247],v20,s[20:23],s46 offen offset:1024 sc1
v_accvgpr_read_b32 v248,a80
v_accvgpr_read_b32 v249,a81
v_accvgpr_read_b32 v250,a82
v_accvgpr_read_b32 v251,a83
v_accvgpr_read_b32 v252,a84
v_accvgpr_read_b32 v253,a85
v_accvgpr_read_b32 v254,a86
v_accvgpr_read_b32 v255,a87
v_mul_f32 v248,v6,v248
v_mul_f32 v249,v6,v249
v_mul_f32 v250,v6,v250
v_mul_f32 v251,v6,v251
v_mul_f32 v252,v6,v252
v_mul_f32 v253,v6,v253
v_mul_f32 v254,v6,v254
v_mul_f32 v255,v6,v255
v_cvt_pk_bf16_f32 v244,v248,v249
v_cvt_pk_bf16_f32 v245,v250,v251
v_cvt_pk_bf16_f32 v246,v252,v253
v_cvt_pk_bf16_f32 v247,v254,v255
buffer_store_dwordx4 v[244:247],v20,s[20:23],s46 offen offset:2048 sc1
v_accvgpr_read_b32 v248,a88
v_accvgpr_read_b32 v249,a89
v_accvgpr_read_b32 v250,a90
v_accvgpr_read_b32 v251,a91
v_accvgpr_read_b32 v252,a92
v_accvgpr_read_b32 v253,a93
v_accvgpr_read_b32 v254,a94
v_accvgpr_read_b32 v255,a95
v_mul_f32 v248,v6,v248
v_mul_f32 v249,v6,v249
v_mul_f32 v250,v6,v250
v_mul_f32 v251,v6,v251
v_mul_f32 v252,v6,v252
v_mul_f32 v253,v6,v253
v_mul_f32 v254,v6,v254
v_mul_f32 v255,v6,v255
v_cvt_pk_bf16_f32 v244,v248,v249
v_cvt_pk_bf16_f32 v245,v250,v251
v_cvt_pk_bf16_f32 v246,v252,v253
v_cvt_pk_bf16_f32 v247,v254,v255
buffer_store_dwordx4 v[244:247],v20,s[20:23],s46 offen offset:3072 sc1
s_nop 1
v_mov_b32 v244,v3
s_nop 1
v_permlane16_swap_b32 v3,v244
v_add_f32 v3,v3,v244
v_mov_b32 v244,v3
s_nop 1
v_permlane32_swap_b32 v3,v244
v_add_f32 v3,v3,v244
v_rcp_f32 v7,v3
v_accvgpr_read_b32 v248,a96
v_accvgpr_read_b32 v249,a97
v_accvgpr_read_b32 v250,a98
v_accvgpr_read_b32 v251,a99
v_accvgpr_read_b32 v252,a100
v_accvgpr_read_b32 v253,a101
v_accvgpr_read_b32 v254,a102
v_accvgpr_read_b32 v255,a103
v_mul_f32 v248,v7,v248
v_mul_f32 v249,v7,v249
v_mul_f32 v250,v7,v250
v_mul_f32 v251,v7,v251
v_mul_f32 v252,v7,v252
v_mul_f32 v253,v7,v253
v_mul_f32 v254,v7,v254
v_mul_f32 v255,v7,v255
v_cvt_pk_bf16_f32 v244,v248,v249
v_cvt_pk_bf16_f32 v245,v250,v251
v_cvt_pk_bf16_f32 v246,v252,v253
v_cvt_pk_bf16_f32 v247,v254,v255
buffer_store_dwordx4 v[244:247],v20,s[20:23],s47 offen sc1
v_accvgpr_read_b32 v248,a104
v_accvgpr_read_b32 v249,a105
v_accvgpr_read_b32 v250,a106
v_accvgpr_read_b32 v251,a107
v_accvgpr_read_b32 v252,a108
v_accvgpr_read_b32 v253,a109
v_accvgpr_read_b32 v254,a110
v_accvgpr_read_b32 v255,a111
v_mul_f32 v248,v7,v248
v_mul_f32 v249,v7,v249
v_mul_f32 v250,v7,v250
v_mul_f32 v251,v7,v251
v_mul_f32 v252,v7,v252
v_mul_f32 v253,v7,v253
v_mul_f32 v254,v7,v254
v_mul_f32 v255,v7,v255
v_cvt_pk_bf16_f32 v244,v248,v249
v_cvt_pk_bf16_f32 v245,v250,v251
v_cvt_pk_bf16_f32 v246,v252,v253
v_cvt_pk_bf16_f32 v247,v254,v255
buffer_store_dwordx4 v[244:247],v20,s[20:23],s47 offen offset:1024 sc1
v_accvgpr_read_b32 v248,a112
v_accvgpr_read_b32 v249,a113
v_accvgpr_read_b32 v250,a114
v_accvgpr_read_b32 v251,a115
v_accvgpr_read_b32 v252,a116
v_accvgpr_read_b32 v253,a117
v_accvgpr_read_b32 v254,a118
v_accvgpr_read_b32 v255,a119
v_mul_f32 v248,v7,v248
v_mul_f32 v249,v7,v249
v_mul_f32 v250,v7,v250
v_mul_f32 v251,v7,v251
v_mul_f32 v252,v7,v252
v_mul_f32 v253,v7,v253
v_mul_f32 v254,v7,v254
v_mul_f32 v255,v7,v255
v_cvt_pk_bf16_f32 v244,v248,v249
v_cvt_pk_bf16_f32 v245,v250,v251
v_cvt_pk_bf16_f32 v246,v252,v253
v_cvt_pk_bf16_f32 v247,v254,v255
buffer_store_dwordx4 v[244:247],v20,s[20:23],s47 offen offset:2048 sc1
v_accvgpr_read_b32 v248,a120
v_accvgpr_read_b32 v249,a121
v_accvgpr_read_b32 v250,a122
v_accvgpr_read_b32 v251,a123
v_accvgpr_read_b32 v252,a124
v_accvgpr_read_b32 v253,a125
v_accvgpr_read_b32 v254,a126
v_accvgpr_read_b32 v255,a127
v_mul_f32 v248,v7,v248
v_mul_f32 v249,v7,v249
v_mul_f32 v250,v7,v250
v_mul_f32 v251,v7,v251
v_mul_f32 v252,v7,v252
v_mul_f32 v253,v7,v253
v_mul_f32 v254,v7,v254
v_mul_f32 v255,v7,v255
v_cvt_pk_bf16_f32 v244,v248,v249
v_cvt_pk_bf16_f32 v245,v250,v251
v_cvt_pk_bf16_f32 v246,v252,v253
v_cvt_pk_bf16_f32 v247,v254,v255
buffer_store_dwordx4 v[244:247],v20,s[20:23],s47 offen offset:3072 sc1
s_add_u32 s29,s29,1
s_cmp_lt_u32 s29,2
s_cbranch_scc1 K1_SLOW_HEAD
K1_SLOW_END:
s_waitcnt vmcnt(0)
s_barrier
v_mbcnt_lo_u32_b32 v0,-1,0
v_mbcnt_hi_u32_b32 v0,-1,v0
s_lshl_b32 s80,s28,6
v_add_u32 v0,s80,v0
v_mov_b32 v192,v0
s_load_dwordx4 s[56:59],s[0:1],0
s_load_dwordx4 s[60:63],s[0:1],16
s_load_dwordx2 s[64:65],s[0:1],40
s_load_dwordx2 s[70:71],s[0:1],64
s_load_dwordx2 s[66:67],s[0:1],48
s_load_dwordx2 s[68:69],s[0:1],56
s_load_dwordx2 s[72:73],s[0:1],96
s_load_dwordx2 s[82:83],s[0:1],32
s_load_dwordx2 s[100:101],s[0:1],72
v_lshrrev_b32 v194,6,v192
v_and_b32 v193,63,v192
s_and_b32 s74,s2,7
s_lshr_b32 s75,s2,3
v_readfirstlane_b32 s28,v194
s_lshr_b32 s76,s74,2
s_and_b32 s77,s74,3
s_and_b32 s78,s77,1
s_lshl_b32 s78,s78,2
s_and_b32 s80,s75,3
s_add_u32 s78,s78,s80
s_lshr_b32 s79,s77,1
s_lshl_b32 s79,s79,3
s_lshr_b32 s80,s75,2
s_add_u32 s79,s79,s80
v_and_b32 v195,15,v193
v_lshrrev_b32 v196,4,v193
v_lshrrev_b32 v197,2,v193
v_and_b32 v197,3,v197
v_and_b32 v198,3,v193
s_load_dwordx2 s[94:95],s[0:1],80
s_load_dwordx2 s[92:93],s[0:1],88
s_lshl_b32 s80,s76,3
s_add_u32 s80,s80,s78
s_lshl_b32 s80,s80,7
s_lshl_b32 s81,s79,2
s_add_u32 s80,s80,s81
s_waitcnt lgkmcnt(0)
s_add_u32 s82,s80,8454144
s_lshr_b32 s54,s74,1
s_and_b32 s54,1,s54
s_and_b32 s55,1,s74
s_mul_i32 s55,s55,30
s_add_u32 s55,s55,s75
s_lshr_b32 s87,s55,2
s_and_b32 s55,3,s55
s_lshl_b32 s80,s76,3
s_lshr_b32 s81,s87,1
s_add_u32 s80,s80,s81
s_lshl_b32 s80,s80,7
s_and_b32 s81,1,s87
s_add_u32 s80,s80,s81
s_add_u32 s83,s80,8454144
s_mul_i32 s80,s76,120
s_lshl_b32 s81,s87,3
s_add_u32 s80,s80,s81
s_lshl_b32 s81,s28,1
s_add_u32 s80,s80,s81
s_mul_i32 s80,s80,131072
s_add_u32 s60,s72,s80
s_addc_u32 s61,s73,0
s_cmp_lt_u32 s2,240
s_cselect_b32 s62,262144,0
s_mov_b32 s63,0x20000
s_add_u32 s64,s72,33554432
s_addc_u32 s65,s73,0
s_mov_b32 s66,8458240
s_mov_b32 s67,0x20000
s_lshl_b32 s80,s55,8
s_add_u32 s56,s37,s80
s_addc_u32 s57,s53,0
s_sub_u32 s80,4194304,s80
s_cmp_lt_u32 s2,240
s_cselect_b32 s58,s80,0
s_mov_b32 s59,0x20000
s_lshl_b32 s80,s76,10
s_lshl_b32 s81,s55,8
s_add_u32 s80,s80,s81
s_lshl_b32 s81,s54,7
s_add_u32 s80,s80,s81
s_lshl_b32 s81,s87,18
s_add_u32 s80,s80,s81
s_add_u32 s68,s94,s80
s_addc_u32 s69,s95,0
s_sub_u32 s80,3932160,s80
s_cmp_lt_u32 s2,240
s_cselect_b32 s70,s80,0
s_mov_b32 s71,0x20000
s_mov_b32 s94,256
s_mov_b32 s95,0x20000
s_lshl_b32 s80,s54,16
s_lshl_b32 s81,s55,10
s_or_b32 s72,s80,s81
s_and_b32 s81,7,s87
s_lshl_b32 s80,s54,21
s_lshl_b32 s54,s81,12
s_or_b32 s73,s80,s54
s_lshl_b32 s81,s81,10
s_lshl_b32 s80,s28,13
s_or_b32 s74,s80,s81
s_and_b32 s81,0xc00,s81
s_lshl_b32 s55,s28,12
s_or_b32 s75,s55,s81
s_lshl_b32 s81,s2,15
s_add_u32 s76,s81,s80
s_xor_b32 s77,s76,65536
s_lshl_b32 s81,s2,8
s_add_u32 s78,s81,8388608
s_xor_b32 s79,s78,512
v_mbcnt_lo_u32_b32 v0,-1,0
v_mbcnt_hi_u32_b32 v0,-1,v0
v_lshlrev_b32 v11,4,v0
v_lshrrev_b32 v1,4,v0
v_and_b32 v2,15,v0
s_lshr_b32 s80,s72,13
s_and_b32 s80,8,s80
v_lshlrev_b32 v3,1,v1
v_xor_b32 v3,v3,v2
v_xor_b32 v3,s80,v3
v_lshlrev_b32 v3,4,v3
s_lshr_b32 s81,s74,3
s_and_b32 s81,128,s81
v_xor_b32 v3,s81,v3
v_lshlrev_b32 v12,10,v1
v_add_u32 v3,v3,v12
s_lshr_b32 s80,s72,10
s_and_b32 s80,3,s80
s_xor_b32 s80,s80,s28
s_lshl_b32 s80,s80,15
v_add_u32 v12,s80,v3
v_xor_b32 v13,128,v12
s_and_b32 s80,1,s83
s_lshl_b32 s80,s80,7
v_and_b32 v1,1,v1
v_mul_u32_u24 v1,s80,v1
v_and_b32 v2,7,v2
s_lshr_b32 s80,s72,13
s_and_b32 s80,8,s80
v_or_b32 v2,s80,v2
v_lshlrev_b32 v2,2,v2
v_add_u32 v1,v1,v2
s_and_b32 s81,0xfffffffe,s83
v_add_u32 v27,s81,v1
v_mov_b32 v28,0
v_bfrev_b32 v14,2
s_cmp_eq_u32 s28,3
s_cselect_b32 s80,0,0x40000000
v_writelane_b32 v14,s80,0
v_mov_b32 v186,1
buffer_store_dword v186,v14,s[64:67],s82 offen sc1
buffer_store_dword v186,v14,s[64:67],s82 offen offset:2048 sc1
s_mov_b32 s44,0x40000000
s_mov_b32 s45,0x40000000
s_mov_b32 s46,0x40000000
s_mov_b32 s47,0x40000000
s_cmp_lt_u32 s2,240
s_cbranch_scc1 KS_GO
s_endpgm
KS_GO:
buffer_load_dword v15,v27,s[64:67],0 offen sc1
s_waitcnt vmcnt(0)
v_cmp_eq_u32 s[80:81],1,v15
s_nop 0
s_cmp_eq_u64 s[80:81],-1
s_cbranch_scc0 KS_S0_SPIN
KS_S0_BACK:
s_xor_b32 m0,s74,0
s_nop 0
buffer_load_dwordx4 v12,s[56:59],s73 offen lds
s_xor_b32 s81,s73,0x1000
s_xor_b32 m0,s74,0x400
s_nop 0
buffer_load_dwordx4 v13,s[56:59],s81 offen lds
s_xor_b32 s80,s73,0x2000
s_xor_b32 m0,s74,0x800
s_nop 0
buffer_load_dwordx4 v12,s[56:59],s80 offen lds
s_xor_b32 s81,s73,0x3000
s_xor_b32 m0,s74,0xc00
s_nop 0
buffer_load_dwordx4 v13,s[56:59],s81 offen lds
s_xor_b32 s80,s73,0x4000
s_xor_b32 m0,s74,0x1000
s_nop 0
buffer_load_dwordx4 v12,s[56:59],s80 offen lds
s_xor_b32 s81,s73,0x5000
s_xor_b32 m0,s74,0x1400
s_nop 0
buffer_load_dwordx4 v13,s[56:59],s81 offen lds
s_xor_b32 s80,s73,0x6000
s_xor_b32 m0,s74,0x1800
s_nop 0
buffer_load_dwordx4 v12,s[56:59],s80 offen lds
s_xor_b32 s81,s73,0x7000
s_xor_b32 m0,s74,0x1c00
s_nop 0
buffer_load_dwordx4 v13,s[56:59],s81 offen lds
buffer_load_dwordx4 a[128:131],v11,s[60:63],s72 offen sc1
s_xor_b32 s80,s72,0x20000
buffer_load_dwordx4 a[144:147],v11,s[60:63],s80 offen sc1
s_xor_b32 s81,s72,0x400
buffer_load_dwordx4 a[132:135],v11,s[60:63],s81 offen sc1
s_xor_b32 s80,s72,0x20400
buffer_load_dwordx4 a[148:151],v11,s[60:63],s80 offen sc1
s_xor_b32 s81,s72,0x800
buffer_load_dwordx4 a[136:139],v11,s[60:63],s81 offen sc1
s_xor_b32 s80,s72,0x20800
buffer_load_dwordx4 a[152:155],v11,s[60:63],s80 offen sc1
s_xor_b32 s81,s72,0xc00
buffer_load_dwordx4 a[140:143],v11,s[60:63],s81 offen sc1
s_xor_b32 s80,s72,0x20c00
buffer_load_dwordx4 a[156:159],v11,s[60:63],s80 offen sc1
s_xor_b32 s81,s73,0x40000
s_xor_b32 m0,s74,0x8000
s_nop 0
buffer_load_dwordx4 v12,s[56:59],s81 offen lds
s_xor_b32 s80,s73,0x41000
s_xor_b32 m0,s74,0x8400
s_nop 0
buffer_load_dwordx4 v13,s[56:59],s80 offen lds
s_xor_b32 s81,s73,0x42000
s_xor_b32 m0,s74,0x8800
s_nop 0
buffer_load_dwordx4 v12,s[56:59],s81 offen lds
s_xor_b32 s80,s73,0x43000
s_xor_b32 m0,s74,0x8c00
s_nop 0
buffer_load_dwordx4 v13,s[56:59],s80 offen lds
s_xor_b32 s81,s73,0x44000
s_xor_b32 m0,s74,0x9000
s_nop 0
buffer_load_dwordx4 v12,s[56:59],s81 offen lds
s_xor_b32 s80,s73,0x45000
s_xor_b32 m0,s74,0x9400
s_nop 0
buffer_load_dwordx4 v13,s[56:59],s80 offen lds
s_xor_b32 s81,s73,0x46000
s_xor_b32 m0,s74,0x9800
s_nop 0
buffer_load_dwordx4 v12,s[56:59],s81 offen lds
s_xor_b32 s80,s73,0x47000
s_xor_b32 m0,s74,0x9c00
s_nop 0
buffer_load_dwordx4 v13,s[56:59],s80 offen lds
s_xor_b32 s81,s72,0x2000
buffer_load_dwordx4 a[160:163],v11,s[60:63],s81 offen sc1
s_xor_b32 s80,s72,0x22000
buffer_load_dwordx4 a[176:179],v11,s[60:63],s80 offen sc1
s_xor_b32 s81,s72,0x2400
buffer_load_dwordx4 a[164:167],v11,s[60:63],s81 offen sc1
s_xor_b32 s80,s72,0x22400
buffer_load_dwordx4 a[180:183],v11,s[60:63],s80 offen sc1
s_xor_b32 s81,s72,0x2800
buffer_load_dwordx4 a[168:171],v11,s[60:63],s81 offen sc1
s_xor_b32 s80,s72,0x22800
buffer_load_dwordx4 a[184:187],v11,s[60:63],s80 offen sc1
s_xor_b32 s81,s72,0x2c00
buffer_load_dwordx4 a[172:175],v11,s[60:63],s81 offen sc1
s_xor_b32 s80,s72,0x22c00
buffer_load_dwordx4 a[188:191],v11,s[60:63],s80 offen sc1
s_xor_b32 s81,s73,0x80000
s_xor_b32 m0,s74,0x10000
s_nop 0
buffer_load_dwordx4 v12,s[56:59],s81 offen lds
s_xor_b32 s80,s73,0x81000
s_xor_b32 m0,s74,0x10400
s_nop 0
buffer_load_dwordx4 v13,s[56:59],s80 offen lds
s_xor_b32 s81,s73,0x82000
s_xor_b32 m0,s74,0x10800
s_nop 0
buffer_load_dwordx4 v12,s[56:59],s81 offen lds
s_xor_b32 s80,s73,0x83000
s_xor_b32 m0,s74,0x10c00
s_nop 0
buffer_load_dwordx4 v13,s[56:59],s80 offen lds
s_xor_b32 s81,s73,0x84000
s_xor_b32 m0,s74,0x11000
s_nop 0
buffer_load_dwordx4 v12,s[56:59],s81 offen lds
s_xor_b32 s80,s73,0x85000
s_xor_b32 m0,s74,0x11400
s_nop 0
buffer_load_dwordx4 v13,s[56:59],s80 offen lds
s_xor_b32 s81,s73,0x86000
s_xor_b32 m0,s74,0x11800
s_nop 0
buffer_load_dwordx4 v12,s[56:59],s81 offen lds
s_xor_b32 s80,s73,0x87000
s_xor_b32 m0,s74,0x11c00
s_nop 0
buffer_load_dwordx4 v13,s[56:59],s80 offen lds
s_xor_b32 s81,s72,0x4000
buffer_load_dwordx4 a[192:195],v11,s[60:63],s81 offen sc1
s_xor_b32 s80,s72,0x24000
buffer_load_dwordx4 a[208:211],v11,s[60:63],s80 offen sc1
s_xor_b32 s81,s72,0x4400
buffer_load_dwordx4 a[196:199],v11,s[60:63],s81 offen sc1
s_xor_b32 s80,s72,0x24400
buffer_load_dwordx4 a[212:215],v11,s[60:63],s80 offen sc1
s_xor_b32 s81,s72,0x4800
buffer_load_dwordx4 a[200:203],v11,s[60:63],s81 offen sc1
s_xor_b32 s80,s72,0x24800
buffer_load_dwordx4 a[216:219],v11,s[60:63],s80 offen sc1
s_xor_b32 s81,s72,0x4c00
buffer_load_dwordx4 a[204:207],v11,s[60:63],s81 offen sc1
s_xor_b32 s80,s72,0x24c00
buffer_load_dwordx4 a[220:223],v11,s[60:63],s80 offen sc1
v_lshrrev_b32 v192,4,v11
v_lshrrev_b32 v193,4,v192
v_lshrrev_b32 v194,2,v192
v_and_b32 v194,3,v194
v_and_b32 v195,3,v192
v_and_b32 v196,1,v193
v_lshlrev_b32 v196,2,v196
v_add_u32 v196,v196,v194
v_lshlrev_b32 v196,1,v196
v_lshrrev_b32 v198,1,v195
v_xor_b32 v196,v196,v198
v_lshlrev_b32 v196,4,v196
v_and_b32 v197,1,v195
v_lshlrev_b32 v199,3,v197
v_add_u32 v196,v196,v199
v_lshlrev_b32 v197,10,v193
v_add_u32 v196,v196,v197
v_lshlrev_b32 v197,8,v194
v_add_u32 v160,v196,v197
v_xor_b32 v161,32,v160
v_xor_b32 v162,64,v160
v_xor_b32 v163,96,v160
v_xor_b32 v164,128,v160
v_xor_b32 v165,160,v160
v_xor_b32 v166,192,v160
v_xor_b32 v167,224,v160
v_add_u32 v168,65536,v160
v_add_u32 v169,65536,v161
v_add_u32 v170,65536,v162
v_add_u32 v171,65536,v163
v_add_u32 v172,65536,v164
v_add_u32 v173,65536,v165
v_add_u32 v174,65536,v166
v_add_u32 v175,65536,v167
s_waitcnt vmcnt(40)
s_barrier
ds_read_b64_tr_b16 v[32:33],v160
ds_read_b64_tr_b16 v[34:35],v160 offset:4096
ds_read_b64_tr_b16 v[36:37],v160 offset:8192
ds_read_b64_tr_b16 v[38:39],v160 offset:12288
ds_read_b64_tr_b16 v[40:41],v160 offset:16384
ds_read_b64_tr_b16 v[42:43],v160 offset:20480
ds_read_b64_tr_b16 v[44:45],v160 offset:24576
ds_read_b64_tr_b16 v[46:47],v160 offset:28672
s_branch K2F_GO
KS_S0_SPIN:
s_mov_b32 s87,0
KS_S0_LOOP:
buffer_load_dword v15,v27,s[64:67],0 offen sc1
s_waitcnt vmcnt(0)
v_cmp_eq_u32 s[80:81],1,v15
s_nop 0
s_cmp_eq_u64 s[80:81],-1
s_cbranch_scc1 KS_S0_BACK
s_add_u32 s87,s87,1
s_cmp_lt_u32 s87,131072
s_cbranch_scc1 KS_S0_LOOP
s_branch KS_S0_BACK
CODE_END:

.section .rodata,"a"
.p2align 6
.amdhsa_kernel concat_heads__mha_block_cached__mha_block_cached__near_ridge_kernel
  .amdhsa_next_free_vgpr 512
  .amdhsa_next_free_sgpr 102
  .amdhsa_accum_offset 256
  .amdhsa_group_segment_fixed_size 0
  .amdhsa_kernarg_size 104
  .amdhsa_user_sgpr_count 2
  .amdhsa_user_sgpr_kernarg_segment_ptr 1
  .amdhsa_system_sgpr_workgroup_id_x 1
.end_amdhsa_kernel
```
